```python
import torch

def _softmax(x, axis=-1):
    return torch.softmax(x, dim=axis)
def _gelu(x):
    return torch.nn.functional.gelu(x, approximate="tanh")
def _silu(x):
    return torch.nn.functional.silu(x)
def _sigmoid(x):
    return torch.sigmoid(x)
def _layernorm(x, axis=-1, eps=1e-5):
    m = x.mean(dim=axis, keepdim=True)
    v = x.var(dim=axis, keepdim=True, unbiased=False)
    return (x - m) / torch.sqrt(v + eps)
def _scatter_add(tgt, idx, src, axis=0):
    return tgt.clone().index_add_(axis, idx, src)
def _segment_sum(src, seg, n):
    out = torch.zeros((n,) + src.shape[1:], dtype=src.dtype)
    return out.index_add_(0, seg, src)
def _pad(x, pw):
    flat = tuple(v for pair in reversed(pw) for v in pair)
    return torch.nn.functional.pad(x, flat)

kernel_name = 'concat_heads__mha_block_cached__compressed_kv_cla__decode'

def setup_inputs():

    _w = (lambda a: (lambda t: t.to(torch.bfloat16) if t.is_floating_point() else t)(torch.as_tensor(a)))
    def _A_setup():
        B, Sq, D = 4, 1, 576
        H, Sk, Dh = 32, 4096, 128
        return {
            "x": _w((lambda *s: torch.randn(*s, dtype=torch.bfloat16) * 1.6)(B, Sq, D)),
            "k_cache": _w((lambda *s: torch.randn(*s, dtype=torch.bfloat16) * 1.6)(B, H, Sk, Dh)),
            "v_cache": _w((lambda *s: torch.randn(*s, dtype=torch.bfloat16) * 0.05)(B, H, Sk, Dh)),
            "wq": _w((lambda *s: torch.randn(*s, dtype=torch.bfloat16) * 1.6)(D, H * Dh) * (D ** -0.5)),
            "wo": _w((lambda *s: torch.randn(*s, dtype=torch.bfloat16) * 0.05)(H * Dh, D) * ((H * Dh) ** -0.5)),
        }
    _A_in = _A_setup()

    def _B_setup():
        B, H, Sq, Sk, D, M = 4, 32, 1, 4096, 128, 576
        Dc = 4 * D
        return {
            "x": _w((lambda *s: torch.randn(*s, dtype=torch.bfloat16) * 3.2)(B, Sq, M)),
            "c_kv": _w((lambda *s: torch.randn(*s, dtype=torch.bfloat16) * 0.1)(B, Sk, Dc)),
            "w_q": _w((lambda *s: torch.randn(*s, dtype=torch.bfloat16) * 6.4)(M, H, D) * (M ** -0.5)),
            "w_uk": _w((lambda *s: torch.randn(*s, dtype=torch.bfloat16) * 6.4)(Dc, H, D) * (Dc ** -0.5)),
            "w_uv": _w((lambda *s: torch.randn(*s, dtype=torch.bfloat16) * 0.1)(Dc, H, D) * (Dc ** -0.5)),
            "w_o": _w((lambda *s: torch.randn(*s, dtype=torch.bfloat16) * 0.1)(H, D, M) * ((H * D) ** -0.5)),
        }
    _B_in = _B_setup()

    return {
        "A_x": _A_in["x"],
        "A_k_cache": _A_in["k_cache"],
        "A_v_cache": _A_in["v_cache"],
        "A_wq": _A_in["wq"],
        "A_wo": _A_in["wo"],
        "B_x": _B_in["x"],
        "B_c_kv": _B_in["c_kv"],
        "B_w_q": _B_in["w_q"],
        "B_w_uk": _B_in["w_uk"],
        "B_w_uv": _B_in["w_uv"],
        "B_w_o": _B_in["w_o"],
    }

def reference(A_x, A_k_cache, A_v_cache, A_wq, A_wo, B_x, B_c_kv, B_w_q, B_w_uk, B_w_uv, B_w_o):
    def _A_ref(x, k_cache, v_cache, wq, wo):
        B, Sq, D = x.shape
        H, Dh = 32, 128
        q = (lambda x, *d: x.permute(*d))((x @ wq).reshape(B, Sq, H, Dh), 0, 2, 1, 3)
        scores = torch.einsum("bhqd,bhkd->bhqk", q, k_cache) * (Dh ** -0.5)
        p = _softmax(scores, axis=-1)
        o = torch.einsum("bhqk,bhkd->bhqd", p, v_cache)
        return (lambda x, *d: x.permute(*d))(o, 0, 2, 1, 3).reshape(B, Sq, H * Dh) @ wo

    def _B_ref(x, c_kv, w_q, w_uk, w_uv, w_o):
        B, Sq, M = x.shape[0], x.shape[1], x.shape[2]
        Sk = c_kv.shape[1]
        H, D = w_q.shape[1], w_q.shape[2]
        q = torch.einsum("bqm,mhd->bhqd", x, w_q)
        k = torch.einsum("bkc,chd->bhkd", c_kv, w_uk)
        v = torch.einsum("bkc,chd->bhkd", c_kv, w_uv)
        scores = torch.einsum("bhqd,bhkd->bhqk", q, k) * (D ** -0.5)
        off = Sk - Sq
        qi = torch.arange(Sq)[:, None]
        kj = torch.arange(Sk)[None, :]
        cmask = kj <= (qi + off)
        scores = torch.where(cmask[None, None], scores, -1e9)
        p = _softmax(scores, axis=-1)
        ctx = torch.einsum("bhqk,bhkd->bhqd", p, v)
        return torch.einsum("bhqd,hdm->bqm", ctx, w_o)

    a = _A_ref(A_x, A_k_cache, A_v_cache, A_wq, A_wo)
    b = _B_ref(B_x, B_c_kv, B_w_q, B_w_uk, B_w_uv, B_w_o)
    return torch.concatenate([a, b], axis=-1)
```

```asm
; @launch grid=(256,1,1) block=(256,1,1) lds=163840
.amdgcn_target "amdgcn-amd-amdhsa--gfx950"
.text
.globl concat_heads__mha_block_cached__compressed_kv_cla__decode_kernel
.p2align 8
.type concat_heads__mha_block_cached__compressed_kv_cla__decode_kernel,@function
concat_heads__mha_block_cached__compressed_kv_cla__decode_kernel:
    s_cmp_ge_u32 s2, 256
    s_cbranch_scc1 L_exit
    s_load_dwordx16 s[4:19], s[0:1], 0
    s_load_dwordx8 s[20:27], s[0:1], 64
    s_load_dwordx4 s[28:31], s[0:1], 96
    v_lshrrev_b32 v2, 6, v0
    v_and_b32 v1, 63, v0
    v_readfirstlane_b32 s3, v2
    v_and_b32 v3, 15, v0
    v_bfe_u32 v4, v0, 4, 2
    v_lshlrev_b32 v2, 4, v1
    s_cmp_lt_u32 s2, 32
    s_cbranch_scc1 L_roleB
L_roleA:
    s_sub_u32 s54, s2, 32
    s_and_b32 s55, s54, 7
    s_lshr_b32 s54, s54, 3
    s_mul_hi_u32 s56, s54, 613566757
    s_lshl_b32 s52, s55, 2
    s_add_u32 s52, s52, s56
    s_mul_i32 s56, s56, 7
    s_sub_u32 s53, s54, s56
    s_lshl_b32 s58, s53, 8
    s_add_u32 s59, s58, 256
    s_mul_hi_u32 s58, s58, 613566757
    s_mul_hi_u32 s59, s59, 613566757
    s_sub_u32 s62, s59, s58
    s_lshl_b32 s54, s3, 25
    s_lshl_b32 s55, s52, 20
    s_add_u32 s54, s54, s55
    s_lshl_b32 s58, s58, 12
    s_lshl_b32 s59, s59, 12
    s_add_u32 s58, s58, s54
    s_add_u32 s59, s59, s54
    s_lshl_b32 s63, s52, 3
    s_add_u32 s63, s63, s53
    s_lshl_b32 s63, s63, 2
    s_add_u32 s63, s63, s3
    s_lshl_b32 s63, s63, 10
    v_mul_u32_u24 v120, 294912, v4
    v_lshl_add_u32 v120, v3, 4, v120
    s_mul_i32 s61, s3, 1179648
    s_lshl_b32 s54, s52, 8
    s_add_u32 s61, s61, s54
    s_getpc_b64 s[56:57]
L_pc_1:
    s_sub_u32 s56, s56, L_pc_1-L_roleA
    s_subb_u32 s57, s57, 0
    v_lshlrev_b32 v5, 7, v0
    v_min_u32 v6, L_roleA_end-L_roleA-4, v5
    global_load_dword v122, v6, s[56:57]
    v_mov_b32 v20, -1
    v_mov_b32 v21, -1
    v_mov_b32 v22, -1
    v_mov_b32 v23, -1
    s_waitcnt lgkmcnt(0)
    s_mov_b32 s32, s6
    s_mov_b32 s33, s7
    s_mov_b32 s34, 134217728
    s_mov_b32 s35, 0x20000
    s_mov_b32 s36, s8
    s_mov_b32 s37, s9
    s_mov_b32 s38, 134217728
    s_mov_b32 s39, 0x20000
    s_mov_b32 s40, s10
    s_mov_b32 s41, s11
    s_mov_b32 s42, 4718592
    s_mov_b32 s43, 0x20000
    s_mov_b32 s48, s4
    s_mov_b32 s49, s5
    s_mov_b32 s50, 4608
    s_mov_b32 s51, 0x20000
    s_mov_b32 s44, s30
    s_mov_b32 s45, s31
    s_mov_b32 s46, 536870912
    s_mov_b32 s47, 0x20000
    v_lshrrev_b32 v5, 3, v3
    v_mul_u32_u24 v5, 1152, v5
    v_mul_u32_u24 v6, 72, v4
    v_add_u32 v5, v5, v6
    s_mul_i32 s54, s3, 288
    buffer_load_dwordx4 v[48:51], v5, s[48:51], s54 offen offset:0
    buffer_load_dwordx4 v[52:55], v5, s[48:51], s54 offen offset:16
    buffer_load_dwordx4 v[56:59], v5, s[48:51], s54 offen offset:32
    buffer_load_dwordx4 v[60:63], v5, s[48:51], s54 offen offset:48
    buffer_load_dwordx2 v[64:65], v5, s[48:51], s54 offen offset:64
    buffer_load_dwordx4 v[68:71], v5, s[48:51], s54 offen offset:2304
    buffer_load_dwordx4 v[72:75], v5, s[48:51], s54 offen offset:2320
    buffer_load_dwordx4 v[76:79], v5, s[48:51], s54 offen offset:2336
    buffer_load_dwordx4 v[80:83], v5, s[48:51], s54 offen offset:2352
    buffer_load_dwordx2 v[84:85], v5, s[48:51], s54 offen offset:2368
    buffer_load_dwordx4 a[112:115], v120, s[40:43], s61 offen
    s_add_u32 s61, s61, 8192
    buffer_load_dwordx4 a[116:119], v120, s[40:43], s61 offen
    s_add_u32 s61, s61, 8192
    buffer_load_dwordx4 a[120:123], v120, s[40:43], s61 offen
    s_add_u32 s61, s61, 8192
    buffer_load_dwordx4 a[124:127], v120, s[40:43], s61 offen
    s_add_u32 s61, s61, 8192
    buffer_load_dwordx4 a[128:131], v120, s[40:43], s61 offen
    s_add_u32 s61, s61, 8192
    buffer_load_dwordx4 a[132:135], v120, s[40:43], s61 offen
    s_add_u32 s61, s61, 8192
    buffer_load_dwordx4 a[136:139], v120, s[40:43], s61 offen
    s_add_u32 s61, s61, 8192
    buffer_load_dwordx4 a[140:143], v120, s[40:43], s61 offen
    s_add_u32 s61, s61, 8192
    buffer_load_dwordx4 a[144:147], v120, s[40:43], s61 offen
    s_add_u32 s61, s61, 8192
    s_cmp_lt_u32 s58, s59
    s_cselect_b32 s60, s58, 0x8000000
    s_add_u32 s58, s58, 4096
    buffer_load_dwordx4 v[144:147], v2, s[32:35], s60 offen offset:0 nt
    buffer_load_dwordx4 v[148:151], v2, s[32:35], s60 offen offset:1024 nt
    buffer_load_dwordx4 v[152:155], v2, s[32:35], s60 offen offset:2048 nt
    buffer_load_dwordx4 v[156:159], v2, s[32:35], s60 offen offset:3072 nt
    buffer_load_dwordx4 a[0:3], v2, s[36:39], s60 offen offset:0 nt
    buffer_load_dwordx4 a[4:7], v2, s[36:39], s60 offen offset:1024 nt
    buffer_load_dwordx4 a[8:11], v2, s[36:39], s60 offen offset:2048 nt
    buffer_load_dwordx4 a[12:15], v2, s[36:39], s60 offen offset:3072 nt
    buffer_store_dwordx4 v[20:23], v2, s[44:47], s63 offen sc1
    buffer_load_dwordx4 a[148:151], v120, s[40:43], s61 offen
    s_add_u32 s61, s61, 8192
    buffer_load_dwordx4 a[152:155], v120, s[40:43], s61 offen
    s_add_u32 s61, s61, 8192
    buffer_load_dwordx4 a[156:159], v120, s[40:43], s61 offen
    s_add_u32 s61, s61, 8192
    buffer_load_dwordx4 a[160:163], v120, s[40:43], s61 offen
    s_add_u32 s61, s61, 8192
    buffer_load_dwordx4 a[164:167], v120, s[40:43], s61 offen
    s_add_u32 s61, s61, 8192
    buffer_load_dwordx4 a[168:171], v120, s[40:43], s61 offen
    s_add_u32 s61, s61, 8192
    buffer_load_dwordx4 a[172:175], v120, s[40:43], s61 offen
    s_add_u32 s61, s61, 8192
    buffer_load_dwordx4 a[176:179], v120, s[40:43], s61 offen
    s_add_u32 s61, s61, 8192
    buffer_load_dwordx4 a[180:183], v120, s[40:43], s61 offen
    s_add_u32 s61, s61, 8192
    s_cmp_lt_u32 s58, s59
    s_cselect_b32 s60, s58, 0x8000000
    s_add_u32 s58, s58, 4096
    buffer_load_dwordx4 v[160:163], v2, s[32:35], s60 offen offset:0 nt
    buffer_load_dwordx4 v[164:167], v2, s[32:35], s60 offen offset:1024 nt
    buffer_load_dwordx4 v[168:171], v2, s[32:35], s60 offen offset:2048 nt
    buffer_load_dwordx4 v[172:175], v2, s[32:35], s60 offen offset:3072 nt
    buffer_load_dwordx4 a[16:19], v2, s[36:39], s60 offen offset:0 nt
    buffer_load_dwordx4 a[20:23], v2, s[36:39], s60 offen offset:1024 nt
    buffer_load_dwordx4 a[24:27], v2, s[36:39], s60 offen offset:2048 nt
    buffer_load_dwordx4 a[28:31], v2, s[36:39], s60 offen offset:3072 nt
    buffer_load_dwordx4 a[184:187], v120, s[40:43], s61 offen
    s_add_u32 s61, s61, 8192
    buffer_load_dwordx4 a[188:191], v120, s[40:43], s61 offen
    s_add_u32 s61, s61, 8192
    buffer_load_dwordx4 a[192:195], v120, s[40:43], s61 offen
    s_add_u32 s61, s61, 8192
    buffer_load_dwordx4 a[196:199], v120, s[40:43], s61 offen
    s_add_u32 s61, s61, 8192
    buffer_load_dwordx4 a[200:203], v120, s[40:43], s61 offen
    s_add_u32 s61, s61, 8192
    buffer_load_dwordx4 a[204:207], v120, s[40:43], s61 offen
    s_add_u32 s61, s61, 8192
    buffer_load_dwordx4 a[208:211], v120, s[40:43], s61 offen
    s_add_u32 s61, s61, 8192
    buffer_load_dwordx4 a[212:215], v120, s[40:43], s61 offen
    s_add_u32 s61, s61, 8192
    buffer_load_dwordx4 a[216:219], v120, s[40:43], s61 offen
    s_add_u32 s61, s61, 8192
    s_cmp_lt_u32 s58, s59
    s_cselect_b32 s60, s58, 0x8000000
    s_add_u32 s58, s58, 4096
    buffer_load_dwordx4 v[176:179], v2, s[32:35], s60 offen offset:0 nt
    buffer_load_dwordx4 v[180:183], v2, s[32:35], s60 offen offset:1024 nt
    buffer_load_dwordx4 v[184:187], v2, s[32:35], s60 offen offset:2048 nt
    buffer_load_dwordx4 v[188:191], v2, s[32:35], s60 offen offset:3072 nt
    buffer_load_dwordx4 a[32:35], v2, s[36:39], s60 offen offset:0 nt
    buffer_load_dwordx4 a[36:39], v2, s[36:39], s60 offen offset:1024 nt
    buffer_load_dwordx4 a[40:43], v2, s[36:39], s60 offen offset:2048 nt
    buffer_load_dwordx4 a[44:47], v2, s[36:39], s60 offen offset:3072 nt
    v_and_b32 v5, 1, v3
    v_cmp_eq_u32 vcc, 1, v5
    v_mov_b32 v5, 0x0c0c0100
    v_mov_b32 v6, 0x01000c0c
    v_cndmask_b32 v5, v5, v6, vcc
    v_mov_b32 v6, 0x0c0c0302
    v_mov_b32 v7, 0x03020c0c
    v_cndmask_b32 v6, v6, v7, vcc
    v_bfe_u32 v7, v3, 1, 2
    v_mov_b32 v16, 0x0c0c0c0c
    v_cmp_eq_u32 vcc, 0, v7
    s_nop 1
    v_cndmask_b32 v8, v16, v5, vcc
    v_cndmask_b32 v9, v16, v6, vcc
    v_cmp_eq_u32 vcc, 1, v7
    s_nop 1
    v_cndmask_b32 v10, v16, v5, vcc
    v_cndmask_b32 v11, v16, v6, vcc
    v_cmp_eq_u32 vcc, 2, v7
    s_nop 1
    v_cndmask_b32 v12, v16, v5, vcc
    v_cndmask_b32 v13, v16, v6, vcc
    v_cmp_eq_u32 vcc, 3, v7
    s_nop 1
    v_cndmask_b32 v14, v16, v5, vcc
    v_cndmask_b32 v15, v16, v6, vcc
    s_waitcnt vmcnt(43)
    buffer_load_dwordx4 a[220:223], v120, s[40:43], s61 offen
    s_add_u32 s61, s61, 8192
    buffer_load_dwordx4 a[224:227], v120, s[40:43], s61 offen
    s_add_u32 s61, s61, 8192
    buffer_load_dwordx4 a[228:231], v120, s[40:43], s61 offen
    s_add_u32 s61, s61, 8192
    buffer_load_dwordx4 a[232:235], v120, s[40:43], s61 offen
    s_add_u32 s61, s61, 8192
    buffer_load_dwordx4 a[236:239], v120, s[40:43], s61 offen
    s_add_u32 s61, s61, 8192
    buffer_load_dwordx4 a[240:243], v120, s[40:43], s61 offen
    s_add_u32 s61, s61, 8192
    buffer_load_dwordx4 a[244:247], v120, s[40:43], s61 offen
    s_add_u32 s61, s61, 8192
    buffer_load_dwordx4 a[248:251], v120, s[40:43], s61 offen
    s_add_u32 s61, s61, 8192
    buffer_load_dwordx4 a[252:255], v120, s[40:43], s61 offen
    s_add_u32 s61, s61, 8192
    s_cmp_lt_u32 s58, s59
    s_cselect_b32 s60, s58, 0x8000000
    s_add_u32 s58, s58, 4096
    buffer_load_dwordx4 v[192:195], v2, s[32:35], s60 offen offset:0 nt
    buffer_load_dwordx4 v[196:199], v2, s[32:35], s60 offen offset:1024 nt
    buffer_load_dwordx4 v[200:203], v2, s[32:35], s60 offen offset:2048 nt
    buffer_load_dwordx4 v[204:207], v2, s[32:35], s60 offen offset:3072 nt
    buffer_load_dwordx4 a[48:51], v2, s[36:39], s60 offen offset:0 nt
    buffer_load_dwordx4 a[52:55], v2, s[36:39], s60 offen offset:1024 nt
    buffer_load_dwordx4 a[56:59], v2, s[36:39], s60 offen offset:2048 nt
    buffer_load_dwordx4 a[60:63], v2, s[36:39], s60 offen offset:3072 nt
    v_perm_b32 v96, v48, v48, v8
    v_perm_b32 v97, v48, v48, v10
    v_perm_b32 v98, v48, v48, v12
    v_perm_b32 v99, v48, v48, v14
    s_nop 1
    v_mfma_f32_16x16x32_bf16 v[112:115], v[96:99], a[112:115], 0
    v_perm_b32 v100, v68, v68, v8
    v_perm_b32 v101, v68, v68, v10
    v_perm_b32 v102, v68, v68, v12
    v_perm_b32 v103, v68, v68, v14
    s_nop 1
    v_mfma_f32_16x16x32_bf16 v[116:119], v[100:103], a[112:115], 0
    v_perm_b32 v104, v48, v48, v9
    v_perm_b32 v105, v48, v48, v11
    v_perm_b32 v106, v48, v48, v13
    v_perm_b32 v107, v48, v48, v15
    s_nop 1
    v_mfma_f32_16x16x32_bf16 v[112:115], v[104:107], a[116:119], v[112:115]
    v_perm_b32 v108, v68, v68, v9
    v_perm_b32 v109, v68, v68, v11
    v_perm_b32 v110, v68, v68, v13
    v_perm_b32 v111, v68, v68, v15
    s_nop 1
    v_mfma_f32_16x16x32_bf16 v[116:119], v[108:111], a[116:119], v[116:119]
    v_perm_b32 v96, v49, v49, v8
    v_perm_b32 v97, v49, v49, v10
    v_perm_b32 v98, v49, v49, v12
    v_perm_b32 v99, v49, v49, v14
    s_nop 1
    v_mfma_f32_16x16x32_bf16 v[112:115], v[96:99], a[120:123], v[112:115]
    v_perm_b32 v100, v69, v69, v8
    v_perm_b32 v101, v69, v69, v10
    v_perm_b32 v102, v69, v69, v12
    v_perm_b32 v103, v69, v69, v14
    s_nop 1
    v_mfma_f32_16x16x32_bf16 v[116:119], v[100:103], a[120:123], v[116:119]
    v_perm_b32 v104, v49, v49, v9
    v_perm_b32 v105, v49, v49, v11
    v_perm_b32 v106, v49, v49, v13
    v_perm_b32 v107, v49, v49, v15
    s_nop 1
    v_mfma_f32_16x16x32_bf16 v[112:115], v[104:107], a[124:127], v[112:115]
    v_perm_b32 v108, v69, v69, v9
    v_perm_b32 v109, v69, v69, v11
    v_perm_b32 v110, v69, v69, v13
    v_perm_b32 v111, v69, v69, v15
    s_nop 1
    v_mfma_f32_16x16x32_bf16 v[116:119], v[108:111], a[124:127], v[116:119]
    v_perm_b32 v96, v50, v50, v8
    v_perm_b32 v97, v50, v50, v10
    v_perm_b32 v98, v50, v50, v12
    v_perm_b32 v99, v50, v50, v14
    s_nop 1
    v_mfma_f32_16x16x32_bf16 v[112:115], v[96:99], a[128:131], v[112:115]
    v_perm_b32 v100, v70, v70, v8
    v_perm_b32 v101, v70, v70, v10
    v_perm_b32 v102, v70, v70, v12
    v_perm_b32 v103, v70, v70, v14
    s_nop 1
    v_mfma_f32_16x16x32_bf16 v[116:119], v[100:103], a[128:131], v[116:119]
    v_perm_b32 v104, v50, v50, v9
    v_perm_b32 v105, v50, v50, v11
    v_perm_b32 v106, v50, v50, v13
    v_perm_b32 v107, v50, v50, v15
    s_nop 1
    v_mfma_f32_16x16x32_bf16 v[112:115], v[104:107], a[132:135], v[112:115]
    v_perm_b32 v108, v70, v70, v9
    v_perm_b32 v109, v70, v70, v11
    v_perm_b32 v110, v70, v70, v13
    v_perm_b32 v111, v70, v70, v15
    s_nop 1
    v_mfma_f32_16x16x32_bf16 v[116:119], v[108:111], a[132:135], v[116:119]
    v_perm_b32 v96, v51, v51, v8
    v_perm_b32 v97, v51, v51, v10
    v_perm_b32 v98, v51, v51, v12
    v_perm_b32 v99, v51, v51, v14
    s_nop 1
    v_mfma_f32_16x16x32_bf16 v[112:115], v[96:99], a[136:139], v[112:115]
    v_perm_b32 v100, v71, v71, v8
    v_perm_b32 v101, v71, v71, v10
    v_perm_b32 v102, v71, v71, v12
    v_perm_b32 v103, v71, v71, v14
    s_nop 1
    v_mfma_f32_16x16x32_bf16 v[116:119], v[100:103], a[136:139], v[116:119]
    v_perm_b32 v104, v51, v51, v9
    v_perm_b32 v105, v51, v51, v11
    v_perm_b32 v106, v51, v51, v13
    v_perm_b32 v107, v51, v51, v15
    s_nop 1
    v_mfma_f32_16x16x32_bf16 v[112:115], v[104:107], a[140:143], v[112:115]
    v_perm_b32 v108, v71, v71, v9
    v_perm_b32 v109, v71, v71, v11
    v_perm_b32 v110, v71, v71, v13
    v_perm_b32 v111, v71, v71, v15
    s_nop 1
    v_mfma_f32_16x16x32_bf16 v[116:119], v[108:111], a[140:143], v[116:119]
    v_perm_b32 v96, v52, v52, v8
    v_perm_b32 v97, v52, v52, v10
    v_perm_b32 v98, v52, v52, v12
    v_perm_b32 v99, v52, v52, v14
    s_nop 1
    v_mfma_f32_16x16x32_bf16 v[112:115], v[96:99], a[144:147], v[112:115]
    v_perm_b32 v100, v72, v72, v8
    v_perm_b32 v101, v72, v72, v10
    v_perm_b32 v102, v72, v72, v12
    v_perm_b32 v103, v72, v72, v14
    s_nop 1
    v_mfma_f32_16x16x32_bf16 v[116:119], v[100:103], a[144:147], v[116:119]
    s_waitcnt vmcnt(42)
    s_cmp_lt_u32 s58, s59
    s_cselect_b32 s60, s58, 0x8000000
    s_add_u32 s58, s58, 4096
    buffer_load_dwordx4 v[208:211], v2, s[32:35], s60 offen offset:0 nt
    buffer_load_dwordx4 v[212:215], v2, s[32:35], s60 offen offset:1024 nt
    buffer_load_dwordx4 v[216:219], v2, s[32:35], s60 offen offset:2048 nt
    buffer_load_dwordx4 v[220:223], v2, s[32:35], s60 offen offset:3072 nt
    buffer_load_dwordx4 a[64:67], v2, s[36:39], s60 offen offset:0 nt
    buffer_load_dwordx4 a[68:71], v2, s[36:39], s60 offen offset:1024 nt
    buffer_load_dwordx4 a[72:75], v2, s[36:39], s60 offen offset:2048 nt
    buffer_load_dwordx4 a[76:79], v2, s[36:39], s60 offen offset:3072 nt
    s_cmp_lt_u32 s58, s59
    s_cselect_b32 s60, s58, 0x8000000
    s_add_u32 s58, s58, 4096
    buffer_load_dwordx4 v[224:227], v2, s[32:35], s60 offen offset:0 nt
    buffer_load_dwordx4 v[228:231], v2, s[32:35], s60 offen offset:1024 nt
    buffer_load_dwordx4 v[232:235], v2, s[32:35], s60 offen offset:2048 nt
    buffer_load_dwordx4 v[236:239], v2, s[32:35], s60 offen offset:3072 nt
    buffer_load_dwordx4 a[80:83], v2, s[36:39], s60 offen offset:0 nt
    buffer_load_dwordx4 a[84:87], v2, s[36:39], s60 offen offset:1024 nt
    buffer_load_dwordx4 a[88:91], v2, s[36:39], s60 offen offset:2048 nt
    buffer_load_dwordx4 a[92:95], v2, s[36:39], s60 offen offset:3072 nt
    v_perm_b32 v104, v52, v52, v9
    v_perm_b32 v105, v52, v52, v11
    v_perm_b32 v106, v52, v52, v13
    v_perm_b32 v107, v52, v52, v15
    s_nop 1
    v_mfma_f32_16x16x32_bf16 v[112:115], v[104:107], a[148:151], v[112:115]
    v_perm_b32 v108, v72, v72, v9
    v_perm_b32 v109, v72, v72, v11
    v_perm_b32 v110, v72, v72, v13
    v_perm_b32 v111, v72, v72, v15
    s_nop 1
    v_mfma_f32_16x16x32_bf16 v[116:119], v[108:111], a[148:151], v[116:119]
    v_perm_b32 v96, v53, v53, v8
    v_perm_b32 v97, v53, v53, v10
    v_perm_b32 v98, v53, v53, v12
    v_perm_b32 v99, v53, v53, v14
    s_nop 1
    v_mfma_f32_16x16x32_bf16 v[112:115], v[96:99], a[152:155], v[112:115]
    v_perm_b32 v100, v73, v73, v8
    v_perm_b32 v101, v73, v73, v10
    v_perm_b32 v102, v73, v73, v12
    v_perm_b32 v103, v73, v73, v14
    s_nop 1
    v_mfma_f32_16x16x32_bf16 v[116:119], v[100:103], a[152:155], v[116:119]
    v_perm_b32 v104, v53, v53, v9
    v_perm_b32 v105, v53, v53, v11
    v_perm_b32 v106, v53, v53, v13
    v_perm_b32 v107, v53, v53, v15
    s_nop 1
    v_mfma_f32_16x16x32_bf16 v[112:115], v[104:107], a[156:159], v[112:115]
    v_perm_b32 v108, v73, v73, v9
    v_perm_b32 v109, v73, v73, v11
    v_perm_b32 v110, v73, v73, v13
    v_perm_b32 v111, v73, v73, v15
    s_nop 1
    v_mfma_f32_16x16x32_bf16 v[116:119], v[108:111], a[156:159], v[116:119]
    v_perm_b32 v96, v54, v54, v8
    v_perm_b32 v97, v54, v54, v10
    v_perm_b32 v98, v54, v54, v12
    v_perm_b32 v99, v54, v54, v14
    s_nop 1
    v_mfma_f32_16x16x32_bf16 v[112:115], v[96:99], a[160:163], v[112:115]
    v_perm_b32 v100, v74, v74, v8
    v_perm_b32 v101, v74, v74, v10
    v_perm_b32 v102, v74, v74, v12
    v_perm_b32 v103, v74, v74, v14
    s_nop 1
    v_mfma_f32_16x16x32_bf16 v[116:119], v[100:103], a[160:163], v[116:119]
    v_perm_b32 v104, v54, v54, v9
    v_perm_b32 v105, v54, v54, v11
    v_perm_b32 v106, v54, v54, v13
    v_perm_b32 v107, v54, v54, v15
    s_nop 1
    v_mfma_f32_16x16x32_bf16 v[112:115], v[104:107], a[164:167], v[112:115]
    v_perm_b32 v108, v74, v74, v9
    v_perm_b32 v109, v74, v74, v11
    v_perm_b32 v110, v74, v74, v13
    v_perm_b32 v111, v74, v74, v15
    s_nop 1
    v_mfma_f32_16x16x32_bf16 v[116:119], v[108:111], a[164:167], v[116:119]
    v_perm_b32 v96, v55, v55, v8
    v_perm_b32 v97, v55, v55, v10
    v_perm_b32 v98, v55, v55, v12
    v_perm_b32 v99, v55, v55, v14
    s_nop 1
    v_mfma_f32_16x16x32_bf16 v[112:115], v[96:99], a[168:171], v[112:115]
    v_perm_b32 v100, v75, v75, v8
    v_perm_b32 v101, v75, v75, v10
    v_perm_b32 v102, v75, v75, v12
    v_perm_b32 v103, v75, v75, v14
    s_nop 1
    v_mfma_f32_16x16x32_bf16 v[116:119], v[100:103], a[168:171], v[116:119]
    v_perm_b32 v104, v55, v55, v9
    v_perm_b32 v105, v55, v55, v11
    v_perm_b32 v106, v55, v55, v13
    v_perm_b32 v107, v55, v55, v15
    s_nop 1
    v_mfma_f32_16x16x32_bf16 v[112:115], v[104:107], a[172:175], v[112:115]
    v_perm_b32 v108, v75, v75, v9
    v_perm_b32 v109, v75, v75, v11
    v_perm_b32 v110, v75, v75, v13
    v_perm_b32 v111, v75, v75, v15
    s_nop 1
    v_mfma_f32_16x16x32_bf16 v[116:119], v[108:111], a[172:175], v[116:119]
    v_perm_b32 v96, v56, v56, v8
    v_perm_b32 v97, v56, v56, v10
    v_perm_b32 v98, v56, v56, v12
    v_perm_b32 v99, v56, v56, v14
    s_nop 1
    v_mfma_f32_16x16x32_bf16 v[112:115], v[96:99], a[176:179], v[112:115]
    v_perm_b32 v100, v76, v76, v8
    v_perm_b32 v101, v76, v76, v10
    v_perm_b32 v102, v76, v76, v12
    v_perm_b32 v103, v76, v76, v14
    s_nop 1
    v_mfma_f32_16x16x32_bf16 v[116:119], v[100:103], a[176:179], v[116:119]
    v_perm_b32 v104, v56, v56, v9
    v_perm_b32 v105, v56, v56, v11
    v_perm_b32 v106, v56, v56, v13
    v_perm_b32 v107, v56, v56, v15
    s_nop 1
    v_mfma_f32_16x16x32_bf16 v[112:115], v[104:107], a[180:183], v[112:115]
    v_perm_b32 v108, v76, v76, v9
    v_perm_b32 v109, v76, v76, v11
    v_perm_b32 v110, v76, v76, v13
    v_perm_b32 v111, v76, v76, v15
    s_nop 1
    v_mfma_f32_16x16x32_bf16 v[116:119], v[108:111], a[180:183], v[116:119]
    s_waitcnt vmcnt(41)
    s_cmp_lt_u32 s58, s59
    s_cselect_b32 s60, s58, 0x8000000
    s_add_u32 s58, s58, 4096
    buffer_load_dwordx4 v[240:243], v2, s[32:35], s60 offen offset:0 nt
    buffer_load_dwordx4 v[244:247], v2, s[32:35], s60 offen offset:1024 nt
    buffer_load_dwordx4 v[248:251], v2, s[32:35], s60 offen offset:2048 nt
    buffer_load_dwordx4 v[252:255], v2, s[32:35], s60 offen offset:3072 nt
    buffer_load_dwordx4 a[96:99], v2, s[36:39], s60 offen offset:0 nt
    buffer_load_dwordx4 a[100:103], v2, s[36:39], s60 offen offset:1024 nt
    buffer_load_dwordx4 a[104:107], v2, s[36:39], s60 offen offset:2048 nt
    buffer_load_dwordx4 a[108:111], v2, s[36:39], s60 offen offset:3072 nt
    v_perm_b32 v96, v57, v57, v8
    v_perm_b32 v97, v57, v57, v10
    v_perm_b32 v98, v57, v57, v12
    v_perm_b32 v99, v57, v57, v14
    s_nop 1
    v_mfma_f32_16x16x32_bf16 v[112:115], v[96:99], a[184:187], v[112:115]
    v_perm_b32 v100, v77, v77, v8
    v_perm_b32 v101, v77, v77, v10
    v_perm_b32 v102, v77, v77, v12
    v_perm_b32 v103, v77, v77, v14
    s_nop 1
    v_mfma_f32_16x16x32_bf16 v[116:119], v[100:103], a[184:187], v[116:119]
    v_perm_b32 v104, v57, v57, v9
    v_perm_b32 v105, v57, v57, v11
    v_perm_b32 v106, v57, v57, v13
    v_perm_b32 v107, v57, v57, v15
    s_nop 1
    v_mfma_f32_16x16x32_bf16 v[112:115], v[104:107], a[188:191], v[112:115]
    v_perm_b32 v108, v77, v77, v9
    v_perm_b32 v109, v77, v77, v11
    v_perm_b32 v110, v77, v77, v13
    v_perm_b32 v111, v77, v77, v15
    s_nop 1
    v_mfma_f32_16x16x32_bf16 v[116:119], v[108:111], a[188:191], v[116:119]
    v_perm_b32 v96, v58, v58, v8
    v_perm_b32 v97, v58, v58, v10
    v_perm_b32 v98, v58, v58, v12
    v_perm_b32 v99, v58, v58, v14
    s_nop 1
    v_mfma_f32_16x16x32_bf16 v[112:115], v[96:99], a[192:195], v[112:115]
    v_perm_b32 v100, v78, v78, v8
    v_perm_b32 v101, v78, v78, v10
    v_perm_b32 v102, v78, v78, v12
    v_perm_b32 v103, v78, v78, v14
    s_nop 1
    v_mfma_f32_16x16x32_bf16 v[116:119], v[100:103], a[192:195], v[116:119]
    v_perm_b32 v104, v58, v58, v9
    v_perm_b32 v105, v58, v58, v11
    v_perm_b32 v106, v58, v58, v13
    v_perm_b32 v107, v58, v58, v15
    s_nop 1
    v_mfma_f32_16x16x32_bf16 v[112:115], v[104:107], a[196:199], v[112:115]
    v_perm_b32 v108, v78, v78, v9
    v_perm_b32 v109, v78, v78, v11
    v_perm_b32 v110, v78, v78, v13
    v_perm_b32 v111, v78, v78, v15
    s_nop 1
    v_mfma_f32_16x16x32_bf16 v[116:119], v[108:111], a[196:199], v[116:119]
    v_perm_b32 v96, v59, v59, v8
    v_perm_b32 v97, v59, v59, v10
    v_perm_b32 v98, v59, v59, v12
    v_perm_b32 v99, v59, v59, v14
    s_nop 1
    v_mfma_f32_16x16x32_bf16 v[112:115], v[96:99], a[200:203], v[112:115]
    v_perm_b32 v100, v79, v79, v8
    v_perm_b32 v101, v79, v79, v10
    v_perm_b32 v102, v79, v79, v12
    v_perm_b32 v103, v79, v79, v14
    s_nop 1
    v_mfma_f32_16x16x32_bf16 v[116:119], v[100:103], a[200:203], v[116:119]
    v_perm_b32 v104, v59, v59, v9
    v_perm_b32 v105, v59, v59, v11
    v_perm_b32 v106, v59, v59, v13
    v_perm_b32 v107, v59, v59, v15
    s_nop 1
    v_mfma_f32_16x16x32_bf16 v[112:115], v[104:107], a[204:207], v[112:115]
    v_perm_b32 v108, v79, v79, v9
    v_perm_b32 v109, v79, v79, v11
    v_perm_b32 v110, v79, v79, v13
    v_perm_b32 v111, v79, v79, v15
    s_nop 1
    v_mfma_f32_16x16x32_bf16 v[116:119], v[108:111], a[204:207], v[116:119]
    v_perm_b32 v96, v60, v60, v8
    v_perm_b32 v97, v60, v60, v10
    v_perm_b32 v98, v60, v60, v12
    v_perm_b32 v99, v60, v60, v14
    s_nop 1
    v_mfma_f32_16x16x32_bf16 v[112:115], v[96:99], a[208:211], v[112:115]
    v_perm_b32 v100, v80, v80, v8
    v_perm_b32 v101, v80, v80, v10
    v_perm_b32 v102, v80, v80, v12
    v_perm_b32 v103, v80, v80, v14
    s_nop 1
    v_mfma_f32_16x16x32_bf16 v[116:119], v[100:103], a[208:211], v[116:119]
    v_perm_b32 v104, v60, v60, v9
    v_perm_b32 v105, v60, v60, v11
    v_perm_b32 v106, v60, v60, v13
    v_perm_b32 v107, v60, v60, v15
    s_nop 1
    v_mfma_f32_16x16x32_bf16 v[112:115], v[104:107], a[212:215], v[112:115]
    v_perm_b32 v108, v80, v80, v9
    v_perm_b32 v109, v80, v80, v11
    v_perm_b32 v110, v80, v80, v13
    v_perm_b32 v111, v80, v80, v15
    s_nop 1
    v_mfma_f32_16x16x32_bf16 v[116:119], v[108:111], a[212:215], v[116:119]
    v_perm_b32 v96, v61, v61, v8
    v_perm_b32 v97, v61, v61, v10
    v_perm_b32 v98, v61, v61, v12
    v_perm_b32 v99, v61, v61, v14
    s_nop 1
    v_mfma_f32_16x16x32_bf16 v[112:115], v[96:99], a[216:219], v[112:115]
    v_perm_b32 v100, v81, v81, v8
    v_perm_b32 v101, v81, v81, v10
    v_perm_b32 v102, v81, v81, v12
    v_perm_b32 v103, v81, v81, v14
    s_nop 1
    v_mfma_f32_16x16x32_bf16 v[116:119], v[100:103], a[216:219], v[116:119]
    s_waitcnt vmcnt(32)
    v_perm_b32 v104, v61, v61, v9
    v_perm_b32 v105, v61, v61, v11
    v_perm_b32 v106, v61, v61, v13
    v_perm_b32 v107, v61, v61, v15
    s_nop 1
    v_mfma_f32_16x16x32_bf16 v[112:115], v[104:107], a[220:223], v[112:115]
    v_perm_b32 v108, v81, v81, v9
    v_perm_b32 v109, v81, v81, v11
    v_perm_b32 v110, v81, v81, v13
    v_perm_b32 v111, v81, v81, v15
    s_nop 1
    v_mfma_f32_16x16x32_bf16 v[116:119], v[108:111], a[220:223], v[116:119]
    v_perm_b32 v96, v62, v62, v8
    v_perm_b32 v97, v62, v62, v10
    v_perm_b32 v98, v62, v62, v12
    v_perm_b32 v99, v62, v62, v14
    s_nop 1
    v_mfma_f32_16x16x32_bf16 v[112:115], v[96:99], a[224:227], v[112:115]
    v_perm_b32 v100, v82, v82, v8
    v_perm_b32 v101, v82, v82, v10
    v_perm_b32 v102, v82, v82, v12
    v_perm_b32 v103, v82, v82, v14
    s_nop 1
    v_mfma_f32_16x16x32_bf16 v[116:119], v[100:103], a[224:227], v[116:119]
    v_perm_b32 v104, v62, v62, v9
    v_perm_b32 v105, v62, v62, v11
    v_perm_b32 v106, v62, v62, v13
    v_perm_b32 v107, v62, v62, v15
    s_nop 1
    v_mfma_f32_16x16x32_bf16 v[112:115], v[104:107], a[228:231], v[112:115]
    v_perm_b32 v108, v82, v82, v9
    v_perm_b32 v109, v82, v82, v11
    v_perm_b32 v110, v82, v82, v13
    v_perm_b32 v111, v82, v82, v15
    s_nop 1
    v_mfma_f32_16x16x32_bf16 v[116:119], v[108:111], a[228:231], v[116:119]
    v_perm_b32 v96, v63, v63, v8
    v_perm_b32 v97, v63, v63, v10
    v_perm_b32 v98, v63, v63, v12
    v_perm_b32 v99, v63, v63, v14
    s_nop 1
    v_mfma_f32_16x16x32_bf16 v[112:115], v[96:99], a[232:235], v[112:115]
    v_perm_b32 v100, v83, v83, v8
    v_perm_b32 v101, v83, v83, v10
    v_perm_b32 v102, v83, v83, v12
    v_perm_b32 v103, v83, v83, v14
    s_nop 1
    v_mfma_f32_16x16x32_bf16 v[116:119], v[100:103], a[232:235], v[116:119]
    v_perm_b32 v104, v63, v63, v9
    v_perm_b32 v105, v63, v63, v11
    v_perm_b32 v106, v63, v63, v13
    v_perm_b32 v107, v63, v63, v15
    s_nop 1
    v_mfma_f32_16x16x32_bf16 v[112:115], v[104:107], a[236:239], v[112:115]
    v_perm_b32 v108, v83, v83, v9
    v_perm_b32 v109, v83, v83, v11
    v_perm_b32 v110, v83, v83, v13
    v_perm_b32 v111, v83, v83, v15
    s_nop 1
    v_mfma_f32_16x16x32_bf16 v[116:119], v[108:111], a[236:239], v[116:119]
    v_perm_b32 v96, v64, v64, v8
    v_perm_b32 v97, v64, v64, v10
    v_perm_b32 v98, v64, v64, v12
    v_perm_b32 v99, v64, v64, v14
    s_nop 1
    v_mfma_f32_16x16x32_bf16 v[112:115], v[96:99], a[240:243], v[112:115]
    v_perm_b32 v100, v84, v84, v8
    v_perm_b32 v101, v84, v84, v10
    v_perm_b32 v102, v84, v84, v12
    v_perm_b32 v103, v84, v84, v14
    s_nop 1
    v_mfma_f32_16x16x32_bf16 v[116:119], v[100:103], a[240:243], v[116:119]
    v_perm_b32 v104, v64, v64, v9
    v_perm_b32 v105, v64, v64, v11
    v_perm_b32 v106, v64, v64, v13
    v_perm_b32 v107, v64, v64, v15
    s_nop 1
    v_mfma_f32_16x16x32_bf16 v[112:115], v[104:107], a[244:247], v[112:115]
    v_perm_b32 v108, v84, v84, v9
    v_perm_b32 v109, v84, v84, v11
    v_perm_b32 v110, v84, v84, v13
    v_perm_b32 v111, v84, v84, v15
    s_nop 1
    v_mfma_f32_16x16x32_bf16 v[116:119], v[108:111], a[244:247], v[116:119]
    v_perm_b32 v96, v65, v65, v8
    v_perm_b32 v97, v65, v65, v10
    v_perm_b32 v98, v65, v65, v12
    v_perm_b32 v99, v65, v65, v14
    s_nop 1
    v_mfma_f32_16x16x32_bf16 v[112:115], v[96:99], a[248:251], v[112:115]
    v_perm_b32 v100, v85, v85, v8
    v_perm_b32 v101, v85, v85, v10
    v_perm_b32 v102, v85, v85, v12
    v_perm_b32 v103, v85, v85, v14
    s_nop 1
    v_mfma_f32_16x16x32_bf16 v[116:119], v[100:103], a[248:251], v[116:119]
    v_perm_b32 v104, v65, v65, v9
    v_perm_b32 v105, v65, v65, v11
    v_perm_b32 v106, v65, v65, v13
    v_perm_b32 v107, v65, v65, v15
    s_nop 1
    v_mfma_f32_16x16x32_bf16 v[112:115], v[104:107], a[252:255], v[112:115]
    v_perm_b32 v108, v85, v85, v9
    v_perm_b32 v109, v85, v85, v11
    v_perm_b32 v110, v85, v85, v13
    v_perm_b32 v111, v85, v85, v15
    s_nop 1
    v_mfma_f32_16x16x32_bf16 v[116:119], v[108:111], a[252:255], v[116:119]
    v_lshrrev_b32 v5, 1, v4
    v_lshlrev_b32 v5, 9, v5
    v_lshl_add_u32 v5, v3, 5, v5
    v_and_b32 v6, 1, v4
    v_lshl_add_u32 v5, v6, 4, v5
    s_lshl_b32 s54, s3, 11
    s_add_u32 s54, s54, 131072
    v_add_u32 v5, s54, v5
    ds_write_b128 v5, v[112:115]
    ds_write_b128 v5, v[116:119] offset:1024
    s_waitcnt lgkmcnt(0)
    s_barrier
    s_cmp_lg_u32 s3, 0
    s_cbranch_scc1 L_nosig_2
    s_lshl_b32 s54, s52, 2
    v_mov_b32 v5, s54
    v_mov_b32 v6, 1
    s_mov_b64 exec, 1
    global_atomic_add v5, v6, s[28:29]
    s_mov_b64 exec, -1
L_nosig_2:
    s_lshl_b32 s54, s3, 9
    s_add_u32 s54, s54, 131072
    v_lshl_add_u32 v5, v3, 5, s54
    ds_read_b128 v[48:51], v5 offset:0
    ds_read_b128 v[52:55], v5 offset:16
    ds_read_b128 v[56:59], v5 offset:2048
    ds_read_b128 v[60:63], v5 offset:2064
    ds_read_b128 v[64:67], v5 offset:4096
    ds_read_b128 v[68:71], v5 offset:4112
    ds_read_b128 v[72:75], v5 offset:6144
    ds_read_b128 v[76:79], v5 offset:6160
    s_waitcnt lgkmcnt(0)
    v_add_f32 v48, v48, v56
    v_add_f32 v64, v64, v72
    v_add_f32 v49, v49, v57
    v_add_f32 v65, v65, v73
    v_add_f32 v50, v50, v58
    v_add_f32 v66, v66, v74
    v_add_f32 v51, v51, v59
    v_add_f32 v67, v67, v75
    v_add_f32 v52, v52, v60
    v_add_f32 v68, v68, v76
    v_add_f32 v53, v53, v61
    v_add_f32 v69, v69, v77
    v_add_f32 v54, v54, v62
    v_add_f32 v70, v70, v78
    v_add_f32 v55, v55, v63
    v_add_f32 v71, v71, v79
    v_add_f32 v48, v48, v64
    v_add_f32 v49, v49, v65
    v_add_f32 v50, v50, v66
    v_add_f32 v51, v51, v67
    v_add_f32 v52, v52, v68
    v_add_f32 v53, v53, v69
    v_add_f32 v54, v54, v70
    v_add_f32 v55, v55, v71
    v_cvt_pk_bf16_f32 v124, v48, v49
    v_cvt_pk_bf16_f32 v125, v50, v51
    v_cvt_pk_bf16_f32 v126, v52, v53
    v_cvt_pk_bf16_f32 v127, v54, v55
    v_and_b32 v5, 1, v3
    v_cmp_eq_u32 vcc, 1, v5
    v_mov_b32 v5, 0xffff
    v_mov_b32 v6, 0xffff0000
    v_cndmask_b32 v5, v5, v6, vcc
    v_lshrrev_b32 v6, 1, v3
    v_cmp_eq_u32 vcc, 0, v6
    s_nop 1
    v_cndmask_b32 v8, 0, v5, vcc
    v_cmp_eq_u32 vcc, 1, v6
    s_nop 1
    v_cndmask_b32 v9, 0, v5, vcc
    v_cmp_eq_u32 vcc, 2, v6
    s_nop 1
    v_cndmask_b32 v10, 0, v5, vcc
    v_cmp_eq_u32 vcc, 3, v6
    s_nop 1
    v_cndmask_b32 v11, 0, v5, vcc
    v_mov_b32 v12, 0
    v_mov_b32 v13, 0
    v_mov_b32 v14, 0
    v_mov_b32 v15, 0
    v_mov_b32 v16, 0xff800000
    v_mov_b32 v17, 0
    s_mov_b32 s96, 1035273459
    s_mov_b32 s97, 1069066811
    s_mov_b32 s98, 0xffff0000
L_aloop:
    s_waitcnt vmcnt(52)
    v_dot2_f32_bf16 v20, v144, v124, 0
    v_dot2_f32_bf16 v21, v148, v124, 0
    v_dot2_f32_bf16 v22, v152, v124, 0
    v_dot2_f32_bf16 v23, v156, v124, 0
    v_dot2_f32_bf16 v20, v145, v125, v20
    v_dot2_f32_bf16 v21, v149, v125, v21
    v_dot2_f32_bf16 v22, v153, v125, v22
    v_dot2_f32_bf16 v23, v157, v125, v23
    v_dot2_f32_bf16 v20, v146, v126, v20
    v_dot2_f32_bf16 v21, v150, v126, v21
    v_dot2_f32_bf16 v22, v154, v126, v22
    v_dot2_f32_bf16 v23, v158, v126, v23
    v_dot2_f32_bf16 v20, v147, v127, v20
    v_dot2_f32_bf16 v21, v151, v127, v21
    v_dot2_f32_bf16 v22, v155, v127, v22
    v_dot2_f32_bf16 v23, v159, v127, v23
    s_cmp_lt_u32 s58, s59
    s_cselect_b32 s60, s58, 0x8000000
    s_add_u32 s58, s58, 4096
    buffer_load_dwordx4 v[144:147], v2, s[32:35], s60 offen offset:0 nt
    buffer_load_dwordx4 v[148:151], v2, s[32:35], s60 offen offset:1024 nt
    buffer_load_dwordx4 v[152:155], v2, s[32:35], s60 offen offset:2048 nt
    buffer_load_dwordx4 v[156:159], v2, s[32:35], s60 offen offset:3072 nt
    v_add_f32_dpp v24, v20, v20 row_ror:8 row_mask:0xf bank_mask:0x3
    v_add_f32_dpp v25, v22, v22 row_ror:8 row_mask:0xf bank_mask:0x3
    v_add_f32_dpp v24, v21, v21 row_ror:8 row_mask:0xf bank_mask:0xc
    v_add_f32_dpp v25, v23, v23 row_ror:8 row_mask:0xf bank_mask:0xc
    s_nop 0
    v_add_f32_dpp v26, v24, v24 row_shl:4 row_mask:0xf bank_mask:0x5
    v_add_f32_dpp v26, v25, v25 row_shr:4 row_mask:0xf bank_mask:0xa
    s_nop 1
    v_add_f32_dpp v26, v26, v26 quad_perm:[1,0,3,2] row_mask:0xf bank_mask:0xf
    s_nop 1
    v_add_f32_dpp v26, v26, v26 quad_perm:[2,3,0,1] row_mask:0xf bank_mask:0xf
    v_cvt_pk_bf16_f32 v26, v26, v26
    v_and_b32 v26, s98, v26
    v_mul_f32 v26, s96, v26
    v_cvt_pk_bf16_f32 v26, v26, v26
    v_and_b32 v26, s98, v26
    s_nop 1
    v_max_f32_dpp v27, v26, v26 row_ror:4 row_mask:0xf bank_mask:0xf
    s_nop 1
    v_max_f32_dpp v27, v27, v27 row_ror:8 row_mask:0xf bank_mask:0xf
    v_mov_b32 v28, v27
    s_nop 1
    v_permlane16_swap_b32 v27, v28
    v_max_f32 v27, v27, v28
    v_mov_b32 v28, v27
    s_nop 1
    v_permlane32_swap_b32 v27, v28
    v_max3_f32 v27, v27, v28, v16
    v_sub_f32 v28, v16, v27
    v_sub_f32 v29, v26, v27
    v_mul_f32 v28, s97, v28
    v_mul_f32 v29, s97, v29
    v_exp_f32 v28, v28
    v_exp_f32 v29, v29
    v_mov_b32 v16, v27
    v_fma_f32 v17, v17, v28, v29
    v_cvt_pk_bf16_f32 v29, v29, v29
    v_mul_f32 v12, v12, v28
    v_mul_f32 v13, v13, v28
    v_mul_f32 v14, v14, v28
    v_mul_f32 v15, v15, v28
    s_waitcnt vmcnt(52)
    v_and_b32_dpp v32, v29, v8 row_newbcast:0 row_mask:0xf bank_mask:0xf
    v_and_b32_dpp v33, v29, v9 row_newbcast:0 row_mask:0xf bank_mask:0xf
    v_and_b32_dpp v34, v29, v10 row_newbcast:0 row_mask:0xf bank_mask:0xf
    v_and_b32_dpp v35, v29, v11 row_newbcast:0 row_mask:0xf bank_mask:0xf
    v_and_b32_dpp v36, v29, v8 row_newbcast:8 row_mask:0xf bank_mask:0xf
    v_and_b32_dpp v37, v29, v9 row_newbcast:8 row_mask:0xf bank_mask:0xf
    v_and_b32_dpp v38, v29, v10 row_newbcast:8 row_mask:0xf bank_mask:0xf
    v_and_b32_dpp v39, v29, v11 row_newbcast:8 row_mask:0xf bank_mask:0xf
    v_and_b32_dpp v40, v29, v8 row_newbcast:4 row_mask:0xf bank_mask:0xf
    v_and_b32_dpp v41, v29, v9 row_newbcast:4 row_mask:0xf bank_mask:0xf
    v_and_b32_dpp v42, v29, v10 row_newbcast:4 row_mask:0xf bank_mask:0xf
    v_and_b32_dpp v43, v29, v11 row_newbcast:4 row_mask:0xf bank_mask:0xf
    v_and_b32_dpp v44, v29, v8 row_newbcast:12 row_mask:0xf bank_mask:0xf
    v_and_b32_dpp v45, v29, v9 row_newbcast:12 row_mask:0xf bank_mask:0xf
    v_and_b32_dpp v46, v29, v10 row_newbcast:12 row_mask:0xf bank_mask:0xf
    v_and_b32_dpp v47, v29, v11 row_newbcast:12 row_mask:0xf bank_mask:0xf
    v_mfma_f32_16x16x32_bf16 v[12:15], v[32:35], a[0:3], v[12:15]
    v_mfma_f32_16x16x32_bf16 v[12:15], v[36:39], a[4:7], v[12:15]
    v_mfma_f32_16x16x32_bf16 v[12:15], v[40:43], a[8:11], v[12:15]
    v_mfma_f32_16x16x32_bf16 v[12:15], v[44:47], a[12:15], v[12:15]
    buffer_load_dwordx4 a[0:3], v2, s[36:39], s60 offen offset:0 nt
    buffer_load_dwordx4 a[4:7], v2, s[36:39], s60 offen offset:1024 nt
    buffer_load_dwordx4 a[8:11], v2, s[36:39], s60 offen offset:2048 nt
    buffer_load_dwordx4 a[12:15], v2, s[36:39], s60 offen offset:3072 nt
    s_sub_u32 s62, s62, 1
    s_cmp_eq_u32 s62, 0
    s_cbranch_scc1 L_adone
    s_waitcnt vmcnt(52)
    v_dot2_f32_bf16 v20, v160, v124, 0
    v_dot2_f32_bf16 v21, v164, v124, 0
    v_dot2_f32_bf16 v22, v168, v124, 0
    v_dot2_f32_bf16 v23, v172, v124, 0
    v_dot2_f32_bf16 v20, v161, v125, v20
    v_dot2_f32_bf16 v21, v165, v125, v21
    v_dot2_f32_bf16 v22, v169, v125, v22
    v_dot2_f32_bf16 v23, v173, v125, v23
    v_dot2_f32_bf16 v20, v162, v126, v20
    v_dot2_f32_bf16 v21, v166, v126, v21
    v_dot2_f32_bf16 v22, v170, v126, v22
    v_dot2_f32_bf16 v23, v174, v126, v23
    v_dot2_f32_bf16 v20, v163, v127, v20
    v_dot2_f32_bf16 v21, v167, v127, v21
    v_dot2_f32_bf16 v22, v171, v127, v22
    v_dot2_f32_bf16 v23, v175, v127, v23
    s_cmp_lt_u32 s58, s59
    s_cselect_b32 s60, s58, 0x8000000
    s_add_u32 s58, s58, 4096
    buffer_load_dwordx4 v[160:163], v2, s[32:35], s60 offen offset:0 nt
    buffer_load_dwordx4 v[164:167], v2, s[32:35], s60 offen offset:1024 nt
    buffer_load_dwordx4 v[168:171], v2, s[32:35], s60 offen offset:2048 nt
    buffer_load_dwordx4 v[172:175], v2, s[32:35], s60 offen offset:3072 nt
    v_add_f32_dpp v24, v20, v20 row_ror:8 row_mask:0xf bank_mask:0x3
    v_add_f32_dpp v25, v22, v22 row_ror:8 row_mask:0xf bank_mask:0x3
    v_add_f32_dpp v24, v21, v21 row_ror:8 row_mask:0xf bank_mask:0xc
    v_add_f32_dpp v25, v23, v23 row_ror:8 row_mask:0xf bank_mask:0xc
    s_nop 0
    v_add_f32_dpp v26, v24, v24 row_shl:4 row_mask:0xf bank_mask:0x5
    v_add_f32_dpp v26, v25, v25 row_shr:4 row_mask:0xf bank_mask:0xa
    s_nop 1
    v_add_f32_dpp v26, v26, v26 quad_perm:[1,0,3,2] row_mask:0xf bank_mask:0xf
    s_nop 1
    v_add_f32_dpp v26, v26, v26 quad_perm:[2,3,0,1] row_mask:0xf bank_mask:0xf
    v_cvt_pk_bf16_f32 v26, v26, v26
    v_and_b32 v26, s98, v26
    v_mul_f32 v26, s96, v26
    v_cvt_pk_bf16_f32 v26, v26, v26
    v_and_b32 v26, s98, v26
    s_nop 1
    v_max_f32_dpp v27, v26, v26 row_ror:4 row_mask:0xf bank_mask:0xf
    s_nop 1
    v_max_f32_dpp v27, v27, v27 row_ror:8 row_mask:0xf bank_mask:0xf
    v_mov_b32 v28, v27
    s_nop 1
    v_permlane16_swap_b32 v27, v28
    v_max_f32 v27, v27, v28
    v_mov_b32 v28, v27
    s_nop 1
    v_permlane32_swap_b32 v27, v28
    v_max3_f32 v27, v27, v28, v16
    v_sub_f32 v28, v16, v27
    v_sub_f32 v29, v26, v27
    v_mul_f32 v28, s97, v28
    v_mul_f32 v29, s97, v29
    v_exp_f32 v28, v28
    v_exp_f32 v29, v29
    v_mov_b32 v16, v27
    v_fma_f32 v17, v17, v28, v29
    v_cvt_pk_bf16_f32 v29, v29, v29
    v_mul_f32 v12, v12, v28
    v_mul_f32 v13, v13, v28
    v_mul_f32 v14, v14, v28
    v_mul_f32 v15, v15, v28
    s_waitcnt vmcnt(52)
    v_and_b32_dpp v32, v29, v8 row_newbcast:0 row_mask:0xf bank_mask:0xf
    v_and_b32_dpp v33, v29, v9 row_newbcast:0 row_mask:0xf bank_mask:0xf
    v_and_b32_dpp v34, v29, v10 row_newbcast:0 row_mask:0xf bank_mask:0xf
    v_and_b32_dpp v35, v29, v11 row_newbcast:0 row_mask:0xf bank_mask:0xf
    v_and_b32_dpp v36, v29, v8 row_newbcast:8 row_mask:0xf bank_mask:0xf
    v_and_b32_dpp v37, v29, v9 row_newbcast:8 row_mask:0xf bank_mask:0xf
    v_and_b32_dpp v38, v29, v10 row_newbcast:8 row_mask:0xf bank_mask:0xf
    v_and_b32_dpp v39, v29, v11 row_newbcast:8 row_mask:0xf bank_mask:0xf
    v_and_b32_dpp v40, v29, v8 row_newbcast:4 row_mask:0xf bank_mask:0xf
    v_and_b32_dpp v41, v29, v9 row_newbcast:4 row_mask:0xf bank_mask:0xf
    v_and_b32_dpp v42, v29, v10 row_newbcast:4 row_mask:0xf bank_mask:0xf
    v_and_b32_dpp v43, v29, v11 row_newbcast:4 row_mask:0xf bank_mask:0xf
    v_and_b32_dpp v44, v29, v8 row_newbcast:12 row_mask:0xf bank_mask:0xf
    v_and_b32_dpp v45, v29, v9 row_newbcast:12 row_mask:0xf bank_mask:0xf
    v_and_b32_dpp v46, v29, v10 row_newbcast:12 row_mask:0xf bank_mask:0xf
    v_and_b32_dpp v47, v29, v11 row_newbcast:12 row_mask:0xf bank_mask:0xf
    v_mfma_f32_16x16x32_bf16 v[12:15], v[32:35], a[16:19], v[12:15]
    v_mfma_f32_16x16x32_bf16 v[12:15], v[36:39], a[20:23], v[12:15]
    v_mfma_f32_16x16x32_bf16 v[12:15], v[40:43], a[24:27], v[12:15]
    v_mfma_f32_16x16x32_bf16 v[12:15], v[44:47], a[28:31], v[12:15]
    buffer_load_dwordx4 a[16:19], v2, s[36:39], s60 offen offset:0 nt
    buffer_load_dwordx4 a[20:23], v2, s[36:39], s60 offen offset:1024 nt
    buffer_load_dwordx4 a[24:27], v2, s[36:39], s60 offen offset:2048 nt
    buffer_load_dwordx4 a[28:31], v2, s[36:39], s60 offen offset:3072 nt
    s_sub_u32 s62, s62, 1
    s_cmp_eq_u32 s62, 0
    s_cbranch_scc1 L_adone
    s_waitcnt vmcnt(52)
    v_dot2_f32_bf16 v20, v176, v124, 0
    v_dot2_f32_bf16 v21, v180, v124, 0
    v_dot2_f32_bf16 v22, v184, v124, 0
    v_dot2_f32_bf16 v23, v188, v124, 0
    v_dot2_f32_bf16 v20, v177, v125, v20
    v_dot2_f32_bf16 v21, v181, v125, v21
    v_dot2_f32_bf16 v22, v185, v125, v22
    v_dot2_f32_bf16 v23, v189, v125, v23
    v_dot2_f32_bf16 v20, v178, v126, v20
    v_dot2_f32_bf16 v21, v182, v126, v21
    v_dot2_f32_bf16 v22, v186, v126, v22
    v_dot2_f32_bf16 v23, v190, v126, v23
    v_dot2_f32_bf16 v20, v179, v127, v20
    v_dot2_f32_bf16 v21, v183, v127, v21
    v_dot2_f32_bf16 v22, v187, v127, v22
    v_dot2_f32_bf16 v23, v191, v127, v23
    s_cmp_lt_u32 s58, s59
    s_cselect_b32 s60, s58, 0x8000000
    s_add_u32 s58, s58, 4096
    buffer_load_dwordx4 v[176:179], v2, s[32:35], s60 offen offset:0 nt
    buffer_load_dwordx4 v[180:183], v2, s[32:35], s60 offen offset:1024 nt
    buffer_load_dwordx4 v[184:187], v2, s[32:35], s60 offen offset:2048 nt
    buffer_load_dwordx4 v[188:191], v2, s[32:35], s60 offen offset:3072 nt
    v_add_f32_dpp v24, v20, v20 row_ror:8 row_mask:0xf bank_mask:0x3
    v_add_f32_dpp v25, v22, v22 row_ror:8 row_mask:0xf bank_mask:0x3
    v_add_f32_dpp v24, v21, v21 row_ror:8 row_mask:0xf bank_mask:0xc
    v_add_f32_dpp v25, v23, v23 row_ror:8 row_mask:0xf bank_mask:0xc
    s_nop 0
    v_add_f32_dpp v26, v24, v24 row_shl:4 row_mask:0xf bank_mask:0x5
    v_add_f32_dpp v26, v25, v25 row_shr:4 row_mask:0xf bank_mask:0xa
    s_nop 1
    v_add_f32_dpp v26, v26, v26 quad_perm:[1,0,3,2] row_mask:0xf bank_mask:0xf
    s_nop 1
    v_add_f32_dpp v26, v26, v26 quad_perm:[2,3,0,1] row_mask:0xf bank_mask:0xf
    v_cvt_pk_bf16_f32 v26, v26, v26
    v_and_b32 v26, s98, v26
    v_mul_f32 v26, s96, v26
    v_cvt_pk_bf16_f32 v26, v26, v26
    v_and_b32 v26, s98, v26
    s_nop 1
    v_max_f32_dpp v27, v26, v26 row_ror:4 row_mask:0xf bank_mask:0xf
    s_nop 1
    v_max_f32_dpp v27, v27, v27 row_ror:8 row_mask:0xf bank_mask:0xf
    v_mov_b32 v28, v27
    s_nop 1
    v_permlane16_swap_b32 v27, v28
    v_max_f32 v27, v27, v28
    v_mov_b32 v28, v27
    s_nop 1
    v_permlane32_swap_b32 v27, v28
    v_max3_f32 v27, v27, v28, v16
    v_sub_f32 v28, v16, v27
    v_sub_f32 v29, v26, v27
    v_mul_f32 v28, s97, v28
    v_mul_f32 v29, s97, v29
    v_exp_f32 v28, v28
    v_exp_f32 v29, v29
    v_mov_b32 v16, v27
    v_fma_f32 v17, v17, v28, v29
    v_cvt_pk_bf16_f32 v29, v29, v29
    v_mul_f32 v12, v12, v28
    v_mul_f32 v13, v13, v28
    v_mul_f32 v14, v14, v28
    v_mul_f32 v15, v15, v28
    s_waitcnt vmcnt(52)
    v_and_b32_dpp v32, v29, v8 row_newbcast:0 row_mask:0xf bank_mask:0xf
    v_and_b32_dpp v33, v29, v9 row_newbcast:0 row_mask:0xf bank_mask:0xf
    v_and_b32_dpp v34, v29, v10 row_newbcast:0 row_mask:0xf bank_mask:0xf
    v_and_b32_dpp v35, v29, v11 row_newbcast:0 row_mask:0xf bank_mask:0xf
    v_and_b32_dpp v36, v29, v8 row_newbcast:8 row_mask:0xf bank_mask:0xf
    v_and_b32_dpp v37, v29, v9 row_newbcast:8 row_mask:0xf bank_mask:0xf
    v_and_b32_dpp v38, v29, v10 row_newbcast:8 row_mask:0xf bank_mask:0xf
    v_and_b32_dpp v39, v29, v11 row_newbcast:8 row_mask:0xf bank_mask:0xf
    v_and_b32_dpp v40, v29, v8 row_newbcast:4 row_mask:0xf bank_mask:0xf
    v_and_b32_dpp v41, v29, v9 row_newbcast:4 row_mask:0xf bank_mask:0xf
    v_and_b32_dpp v42, v29, v10 row_newbcast:4 row_mask:0xf bank_mask:0xf
    v_and_b32_dpp v43, v29, v11 row_newbcast:4 row_mask:0xf bank_mask:0xf
    v_and_b32_dpp v44, v29, v8 row_newbcast:12 row_mask:0xf bank_mask:0xf
    v_and_b32_dpp v45, v29, v9 row_newbcast:12 row_mask:0xf bank_mask:0xf
    v_and_b32_dpp v46, v29, v10 row_newbcast:12 row_mask:0xf bank_mask:0xf
    v_and_b32_dpp v47, v29, v11 row_newbcast:12 row_mask:0xf bank_mask:0xf
    v_mfma_f32_16x16x32_bf16 v[12:15], v[32:35], a[32:35], v[12:15]
    v_mfma_f32_16x16x32_bf16 v[12:15], v[36:39], a[36:39], v[12:15]
    v_mfma_f32_16x16x32_bf16 v[12:15], v[40:43], a[40:43], v[12:15]
    v_mfma_f32_16x16x32_bf16 v[12:15], v[44:47], a[44:47], v[12:15]
    buffer_load_dwordx4 a[32:35], v2, s[36:39], s60 offen offset:0 nt
    buffer_load_dwordx4 a[36:39], v2, s[36:39], s60 offen offset:1024 nt
    buffer_load_dwordx4 a[40:43], v2, s[36:39], s60 offen offset:2048 nt
    buffer_load_dwordx4 a[44:47], v2, s[36:39], s60 offen offset:3072 nt
    s_sub_u32 s62, s62, 1
    s_cmp_eq_u32 s62, 0
    s_cbranch_scc1 L_adone
    s_waitcnt vmcnt(52)
    v_dot2_f32_bf16 v20, v192, v124, 0
    v_dot2_f32_bf16 v21, v196, v124, 0
    v_dot2_f32_bf16 v22, v200, v124, 0
    v_dot2_f32_bf16 v23, v204, v124, 0
    v_dot2_f32_bf16 v20, v193, v125, v20
    v_dot2_f32_bf16 v21, v197, v125, v21
    v_dot2_f32_bf16 v22, v201, v125, v22
    v_dot2_f32_bf16 v23, v205, v125, v23
    v_dot2_f32_bf16 v20, v194, v126, v20
    v_dot2_f32_bf16 v21, v198, v126, v21
    v_dot2_f32_bf16 v22, v202, v126, v22
    v_dot2_f32_bf16 v23, v206, v126, v23
    v_dot2_f32_bf16 v20, v195, v127, v20
    v_dot2_f32_bf16 v21, v199, v127, v21
    v_dot2_f32_bf16 v22, v203, v127, v22
    v_dot2_f32_bf16 v23, v207, v127, v23
    s_cmp_lt_u32 s58, s59
    s_cselect_b32 s60, s58, 0x8000000
    s_add_u32 s58, s58, 4096
    buffer_load_dwordx4 v[192:195], v2, s[32:35], s60 offen offset:0 nt
    buffer_load_dwordx4 v[196:199], v2, s[32:35], s60 offen offset:1024 nt
    buffer_load_dwordx4 v[200:203], v2, s[32:35], s60 offen offset:2048 nt
    buffer_load_dwordx4 v[204:207], v2, s[32:35], s60 offen offset:3072 nt
    v_add_f32_dpp v24, v20, v20 row_ror:8 row_mask:0xf bank_mask:0x3
    v_add_f32_dpp v25, v22, v22 row_ror:8 row_mask:0xf bank_mask:0x3
    v_add_f32_dpp v24, v21, v21 row_ror:8 row_mask:0xf bank_mask:0xc
    v_add_f32_dpp v25, v23, v23 row_ror:8 row_mask:0xf bank_mask:0xc
    s_nop 0
    v_add_f32_dpp v26, v24, v24 row_shl:4 row_mask:0xf bank_mask:0x5
    v_add_f32_dpp v26, v25, v25 row_shr:4 row_mask:0xf bank_mask:0xa
    s_nop 1
    v_add_f32_dpp v26, v26, v26 quad_perm:[1,0,3,2] row_mask:0xf bank_mask:0xf
    s_nop 1
    v_add_f32_dpp v26, v26, v26 quad_perm:[2,3,0,1] row_mask:0xf bank_mask:0xf
    v_cvt_pk_bf16_f32 v26, v26, v26
    v_and_b32 v26, s98, v26
    v_mul_f32 v26, s96, v26
    v_cvt_pk_bf16_f32 v26, v26, v26
    v_and_b32 v26, s98, v26
    s_nop 1
    v_max_f32_dpp v27, v26, v26 row_ror:4 row_mask:0xf bank_mask:0xf
    s_nop 1
    v_max_f32_dpp v27, v27, v27 row_ror:8 row_mask:0xf bank_mask:0xf
    v_mov_b32 v28, v27
    s_nop 1
    v_permlane16_swap_b32 v27, v28
    v_max_f32 v27, v27, v28
    v_mov_b32 v28, v27
    s_nop 1
    v_permlane32_swap_b32 v27, v28
    v_max3_f32 v27, v27, v28, v16
    v_sub_f32 v28, v16, v27
    v_sub_f32 v29, v26, v27
    v_mul_f32 v28, s97, v28
    v_mul_f32 v29, s97, v29
    v_exp_f32 v28, v28
    v_exp_f32 v29, v29
    v_mov_b32 v16, v27
    v_fma_f32 v17, v17, v28, v29
    v_cvt_pk_bf16_f32 v29, v29, v29
    v_mul_f32 v12, v12, v28
    v_mul_f32 v13, v13, v28
    v_mul_f32 v14, v14, v28
    v_mul_f32 v15, v15, v28
    s_waitcnt vmcnt(52)
    v_and_b32_dpp v32, v29, v8 row_newbcast:0 row_mask:0xf bank_mask:0xf
    v_and_b32_dpp v33, v29, v9 row_newbcast:0 row_mask:0xf bank_mask:0xf
    v_and_b32_dpp v34, v29, v10 row_newbcast:0 row_mask:0xf bank_mask:0xf
    v_and_b32_dpp v35, v29, v11 row_newbcast:0 row_mask:0xf bank_mask:0xf
    v_and_b32_dpp v36, v29, v8 row_newbcast:8 row_mask:0xf bank_mask:0xf
    v_and_b32_dpp v37, v29, v9 row_newbcast:8 row_mask:0xf bank_mask:0xf
    v_and_b32_dpp v38, v29, v10 row_newbcast:8 row_mask:0xf bank_mask:0xf
    v_and_b32_dpp v39, v29, v11 row_newbcast:8 row_mask:0xf bank_mask:0xf
    v_and_b32_dpp v40, v29, v8 row_newbcast:4 row_mask:0xf bank_mask:0xf
    v_and_b32_dpp v41, v29, v9 row_newbcast:4 row_mask:0xf bank_mask:0xf
    v_and_b32_dpp v42, v29, v10 row_newbcast:4 row_mask:0xf bank_mask:0xf
    v_and_b32_dpp v43, v29, v11 row_newbcast:4 row_mask:0xf bank_mask:0xf
    v_and_b32_dpp v44, v29, v8 row_newbcast:12 row_mask:0xf bank_mask:0xf
    v_and_b32_dpp v45, v29, v9 row_newbcast:12 row_mask:0xf bank_mask:0xf
    v_and_b32_dpp v46, v29, v10 row_newbcast:12 row_mask:0xf bank_mask:0xf
    v_and_b32_dpp v47, v29, v11 row_newbcast:12 row_mask:0xf bank_mask:0xf
    v_mfma_f32_16x16x32_bf16 v[12:15], v[32:35], a[48:51], v[12:15]
    v_mfma_f32_16x16x32_bf16 v[12:15], v[36:39], a[52:55], v[12:15]
    v_mfma_f32_16x16x32_bf16 v[12:15], v[40:43], a[56:59], v[12:15]
    v_mfma_f32_16x16x32_bf16 v[12:15], v[44:47], a[60:63], v[12:15]
    buffer_load_dwordx4 a[48:51], v2, s[36:39], s60 offen offset:0 nt
    buffer_load_dwordx4 a[52:55], v2, s[36:39], s60 offen offset:1024 nt
    buffer_load_dwordx4 a[56:59], v2, s[36:39], s60 offen offset:2048 nt
    buffer_load_dwordx4 a[60:63], v2, s[36:39], s60 offen offset:3072 nt
    s_sub_u32 s62, s62, 1
    s_cmp_eq_u32 s62, 0
    s_cbranch_scc1 L_adone
    s_waitcnt vmcnt(52)
    v_dot2_f32_bf16 v20, v208, v124, 0
    v_dot2_f32_bf16 v21, v212, v124, 0
    v_dot2_f32_bf16 v22, v216, v124, 0
    v_dot2_f32_bf16 v23, v220, v124, 0
    v_dot2_f32_bf16 v20, v209, v125, v20
    v_dot2_f32_bf16 v21, v213, v125, v21
    v_dot2_f32_bf16 v22, v217, v125, v22
    v_dot2_f32_bf16 v23, v221, v125, v23
    v_dot2_f32_bf16 v20, v210, v126, v20
    v_dot2_f32_bf16 v21, v214, v126, v21
    v_dot2_f32_bf16 v22, v218, v126, v22
    v_dot2_f32_bf16 v23, v222, v126, v23
    v_dot2_f32_bf16 v20, v211, v127, v20
    v_dot2_f32_bf16 v21, v215, v127, v21
    v_dot2_f32_bf16 v22, v219, v127, v22
    v_dot2_f32_bf16 v23, v223, v127, v23
    s_cmp_lt_u32 s58, s59
    s_cselect_b32 s60, s58, 0x8000000
    s_add_u32 s58, s58, 4096
    buffer_load_dwordx4 v[208:211], v2, s[32:35], s60 offen offset:0 nt
    buffer_load_dwordx4 v[212:215], v2, s[32:35], s60 offen offset:1024 nt
    buffer_load_dwordx4 v[216:219], v2, s[32:35], s60 offen offset:2048 nt
    buffer_load_dwordx4 v[220:223], v2, s[32:35], s60 offen offset:3072 nt
    v_add_f32_dpp v24, v20, v20 row_ror:8 row_mask:0xf bank_mask:0x3
    v_add_f32_dpp v25, v22, v22 row_ror:8 row_mask:0xf bank_mask:0x3
    v_add_f32_dpp v24, v21, v21 row_ror:8 row_mask:0xf bank_mask:0xc
    v_add_f32_dpp v25, v23, v23 row_ror:8 row_mask:0xf bank_mask:0xc
    s_nop 0
    v_add_f32_dpp v26, v24, v24 row_shl:4 row_mask:0xf bank_mask:0x5
    v_add_f32_dpp v26, v25, v25 row_shr:4 row_mask:0xf bank_mask:0xa
    s_nop 1
    v_add_f32_dpp v26, v26, v26 quad_perm:[1,0,3,2] row_mask:0xf bank_mask:0xf
    s_nop 1
    v_add_f32_dpp v26, v26, v26 quad_perm:[2,3,0,1] row_mask:0xf bank_mask:0xf
    v_cvt_pk_bf16_f32 v26, v26, v26
    v_and_b32 v26, s98, v26
    v_mul_f32 v26, s96, v26
    v_cvt_pk_bf16_f32 v26, v26, v26
    v_and_b32 v26, s98, v26
    s_nop 1
    v_max_f32_dpp v27, v26, v26 row_ror:4 row_mask:0xf bank_mask:0xf
    s_nop 1
    v_max_f32_dpp v27, v27, v27 row_ror:8 row_mask:0xf bank_mask:0xf
    v_mov_b32 v28, v27
    s_nop 1
    v_permlane16_swap_b32 v27, v28
    v_max_f32 v27, v27, v28
    v_mov_b32 v28, v27
    s_nop 1
    v_permlane32_swap_b32 v27, v28
    v_max3_f32 v27, v27, v28, v16
    v_sub_f32 v28, v16, v27
    v_sub_f32 v29, v26, v27
    v_mul_f32 v28, s97, v28
    v_mul_f32 v29, s97, v29
    v_exp_f32 v28, v28
    v_exp_f32 v29, v29
    v_mov_b32 v16, v27
    v_fma_f32 v17, v17, v28, v29
    v_cvt_pk_bf16_f32 v29, v29, v29
    v_mul_f32 v12, v12, v28
    v_mul_f32 v13, v13, v28
    v_mul_f32 v14, v14, v28
    v_mul_f32 v15, v15, v28
    s_waitcnt vmcnt(52)
    v_and_b32_dpp v32, v29, v8 row_newbcast:0 row_mask:0xf bank_mask:0xf
    v_and_b32_dpp v33, v29, v9 row_newbcast:0 row_mask:0xf bank_mask:0xf
    v_and_b32_dpp v34, v29, v10 row_newbcast:0 row_mask:0xf bank_mask:0xf
    v_and_b32_dpp v35, v29, v11 row_newbcast:0 row_mask:0xf bank_mask:0xf
    v_and_b32_dpp v36, v29, v8 row_newbcast:8 row_mask:0xf bank_mask:0xf
    v_and_b32_dpp v37, v29, v9 row_newbcast:8 row_mask:0xf bank_mask:0xf
    v_and_b32_dpp v38, v29, v10 row_newbcast:8 row_mask:0xf bank_mask:0xf
    v_and_b32_dpp v39, v29, v11 row_newbcast:8 row_mask:0xf bank_mask:0xf
    v_and_b32_dpp v40, v29, v8 row_newbcast:4 row_mask:0xf bank_mask:0xf
    v_and_b32_dpp v41, v29, v9 row_newbcast:4 row_mask:0xf bank_mask:0xf
    v_and_b32_dpp v42, v29, v10 row_newbcast:4 row_mask:0xf bank_mask:0xf
    v_and_b32_dpp v43, v29, v11 row_newbcast:4 row_mask:0xf bank_mask:0xf
    v_and_b32_dpp v44, v29, v8 row_newbcast:12 row_mask:0xf bank_mask:0xf
    v_and_b32_dpp v45, v29, v9 row_newbcast:12 row_mask:0xf bank_mask:0xf
    v_and_b32_dpp v46, v29, v10 row_newbcast:12 row_mask:0xf bank_mask:0xf
    v_and_b32_dpp v47, v29, v11 row_newbcast:12 row_mask:0xf bank_mask:0xf
    v_mfma_f32_16x16x32_bf16 v[12:15], v[32:35], a[64:67], v[12:15]
    v_mfma_f32_16x16x32_bf16 v[12:15], v[36:39], a[68:71], v[12:15]
    v_mfma_f32_16x16x32_bf16 v[12:15], v[40:43], a[72:75], v[12:15]
    v_mfma_f32_16x16x32_bf16 v[12:15], v[44:47], a[76:79], v[12:15]
    buffer_load_dwordx4 a[64:67], v2, s[36:39], s60 offen offset:0 nt
    buffer_load_dwordx4 a[68:71], v2, s[36:39], s60 offen offset:1024 nt
    buffer_load_dwordx4 a[72:75], v2, s[36:39], s60 offen offset:2048 nt
    buffer_load_dwordx4 a[76:79], v2, s[36:39], s60 offen offset:3072 nt
    s_sub_u32 s62, s62, 1
    s_cmp_eq_u32 s62, 0
    s_cbranch_scc1 L_adone
    s_waitcnt vmcnt(52)
    v_dot2_f32_bf16 v20, v224, v124, 0
    v_dot2_f32_bf16 v21, v228, v124, 0
    v_dot2_f32_bf16 v22, v232, v124, 0
    v_dot2_f32_bf16 v23, v236, v124, 0
    v_dot2_f32_bf16 v20, v225, v125, v20
    v_dot2_f32_bf16 v21, v229, v125, v21
    v_dot2_f32_bf16 v22, v233, v125, v22
    v_dot2_f32_bf16 v23, v237, v125, v23
    v_dot2_f32_bf16 v20, v226, v126, v20
    v_dot2_f32_bf16 v21, v230, v126, v21
    v_dot2_f32_bf16 v22, v234, v126, v22
    v_dot2_f32_bf16 v23, v238, v126, v23
    v_dot2_f32_bf16 v20, v227, v127, v20
    v_dot2_f32_bf16 v21, v231, v127, v21
    v_dot2_f32_bf16 v22, v235, v127, v22
    v_dot2_f32_bf16 v23, v239, v127, v23
    s_cmp_lt_u32 s58, s59
    s_cselect_b32 s60, s58, 0x8000000
    s_add_u32 s58, s58, 4096
    buffer_load_dwordx4 v[224:227], v2, s[32:35], s60 offen offset:0 nt
    buffer_load_dwordx4 v[228:231], v2, s[32:35], s60 offen offset:1024 nt
    buffer_load_dwordx4 v[232:235], v2, s[32:35], s60 offen offset:2048 nt
    buffer_load_dwordx4 v[236:239], v2, s[32:35], s60 offen offset:3072 nt
    v_add_f32_dpp v24, v20, v20 row_ror:8 row_mask:0xf bank_mask:0x3
    v_add_f32_dpp v25, v22, v22 row_ror:8 row_mask:0xf bank_mask:0x3
    v_add_f32_dpp v24, v21, v21 row_ror:8 row_mask:0xf bank_mask:0xc
    v_add_f32_dpp v25, v23, v23 row_ror:8 row_mask:0xf bank_mask:0xc
    s_nop 0
    v_add_f32_dpp v26, v24, v24 row_shl:4 row_mask:0xf bank_mask:0x5
    v_add_f32_dpp v26, v25, v25 row_shr:4 row_mask:0xf bank_mask:0xa
    s_nop 1
    v_add_f32_dpp v26, v26, v26 quad_perm:[1,0,3,2] row_mask:0xf bank_mask:0xf
    s_nop 1
    v_add_f32_dpp v26, v26, v26 quad_perm:[2,3,0,1] row_mask:0xf bank_mask:0xf
    v_cvt_pk_bf16_f32 v26, v26, v26
    v_and_b32 v26, s98, v26
    v_mul_f32 v26, s96, v26
    v_cvt_pk_bf16_f32 v26, v26, v26
    v_and_b32 v26, s98, v26
    s_nop 1
    v_max_f32_dpp v27, v26, v26 row_ror:4 row_mask:0xf bank_mask:0xf
    s_nop 1
    v_max_f32_dpp v27, v27, v27 row_ror:8 row_mask:0xf bank_mask:0xf
    v_mov_b32 v28, v27
    s_nop 1
    v_permlane16_swap_b32 v27, v28
    v_max_f32 v27, v27, v28
    v_mov_b32 v28, v27
    s_nop 1
    v_permlane32_swap_b32 v27, v28
    v_max3_f32 v27, v27, v28, v16
    v_sub_f32 v28, v16, v27
    v_sub_f32 v29, v26, v27
    v_mul_f32 v28, s97, v28
    v_mul_f32 v29, s97, v29
    v_exp_f32 v28, v28
    v_exp_f32 v29, v29
    v_mov_b32 v16, v27
    v_fma_f32 v17, v17, v28, v29
    v_cvt_pk_bf16_f32 v29, v29, v29
    v_mul_f32 v12, v12, v28
    v_mul_f32 v13, v13, v28
    v_mul_f32 v14, v14, v28
    v_mul_f32 v15, v15, v28
    s_waitcnt vmcnt(52)
    v_and_b32_dpp v32, v29, v8 row_newbcast:0 row_mask:0xf bank_mask:0xf
    v_and_b32_dpp v33, v29, v9 row_newbcast:0 row_mask:0xf bank_mask:0xf
    v_and_b32_dpp v34, v29, v10 row_newbcast:0 row_mask:0xf bank_mask:0xf
    v_and_b32_dpp v35, v29, v11 row_newbcast:0 row_mask:0xf bank_mask:0xf
    v_and_b32_dpp v36, v29, v8 row_newbcast:8 row_mask:0xf bank_mask:0xf
    v_and_b32_dpp v37, v29, v9 row_newbcast:8 row_mask:0xf bank_mask:0xf
    v_and_b32_dpp v38, v29, v10 row_newbcast:8 row_mask:0xf bank_mask:0xf
    v_and_b32_dpp v39, v29, v11 row_newbcast:8 row_mask:0xf bank_mask:0xf
    v_and_b32_dpp v40, v29, v8 row_newbcast:4 row_mask:0xf bank_mask:0xf
    v_and_b32_dpp v41, v29, v9 row_newbcast:4 row_mask:0xf bank_mask:0xf
    v_and_b32_dpp v42, v29, v10 row_newbcast:4 row_mask:0xf bank_mask:0xf
    v_and_b32_dpp v43, v29, v11 row_newbcast:4 row_mask:0xf bank_mask:0xf
    v_and_b32_dpp v44, v29, v8 row_newbcast:12 row_mask:0xf bank_mask:0xf
    v_and_b32_dpp v45, v29, v9 row_newbcast:12 row_mask:0xf bank_mask:0xf
    v_and_b32_dpp v46, v29, v10 row_newbcast:12 row_mask:0xf bank_mask:0xf
    v_and_b32_dpp v47, v29, v11 row_newbcast:12 row_mask:0xf bank_mask:0xf
    v_mfma_f32_16x16x32_bf16 v[12:15], v[32:35], a[80:83], v[12:15]
    v_mfma_f32_16x16x32_bf16 v[12:15], v[36:39], a[84:87], v[12:15]
    v_mfma_f32_16x16x32_bf16 v[12:15], v[40:43], a[88:91], v[12:15]
    v_mfma_f32_16x16x32_bf16 v[12:15], v[44:47], a[92:95], v[12:15]
    buffer_load_dwordx4 a[80:83], v2, s[36:39], s60 offen offset:0 nt
    buffer_load_dwordx4 a[84:87], v2, s[36:39], s60 offen offset:1024 nt
    buffer_load_dwordx4 a[88:91], v2, s[36:39], s60 offen offset:2048 nt
    buffer_load_dwordx4 a[92:95], v2, s[36:39], s60 offen offset:3072 nt
    s_sub_u32 s62, s62, 1
    s_cmp_eq_u32 s62, 0
    s_cbranch_scc1 L_adone
    s_waitcnt vmcnt(52)
    v_dot2_f32_bf16 v20, v240, v124, 0
    v_dot2_f32_bf16 v21, v244, v124, 0
    v_dot2_f32_bf16 v22, v248, v124, 0
    v_dot2_f32_bf16 v23, v252, v124, 0
    v_dot2_f32_bf16 v20, v241, v125, v20
    v_dot2_f32_bf16 v21, v245, v125, v21
    v_dot2_f32_bf16 v22, v249, v125, v22
    v_dot2_f32_bf16 v23, v253, v125, v23
    v_dot2_f32_bf16 v20, v242, v126, v20
    v_dot2_f32_bf16 v21, v246, v126, v21
    v_dot2_f32_bf16 v22, v250, v126, v22
    v_dot2_f32_bf16 v23, v254, v126, v23
    v_dot2_f32_bf16 v20, v243, v127, v20
    v_dot2_f32_bf16 v21, v247, v127, v21
    v_dot2_f32_bf16 v22, v251, v127, v22
    v_dot2_f32_bf16 v23, v255, v127, v23
    s_cmp_lt_u32 s58, s59
    s_cselect_b32 s60, s58, 0x8000000
    s_add_u32 s58, s58, 4096
    buffer_load_dwordx4 v[240:243], v2, s[32:35], s60 offen offset:0 nt
    buffer_load_dwordx4 v[244:247], v2, s[32:35], s60 offen offset:1024 nt
    buffer_load_dwordx4 v[248:251], v2, s[32:35], s60 offen offset:2048 nt
    buffer_load_dwordx4 v[252:255], v2, s[32:35], s60 offen offset:3072 nt
    v_add_f32_dpp v24, v20, v20 row_ror:8 row_mask:0xf bank_mask:0x3
    v_add_f32_dpp v25, v22, v22 row_ror:8 row_mask:0xf bank_mask:0x3
    v_add_f32_dpp v24, v21, v21 row_ror:8 row_mask:0xf bank_mask:0xc
    v_add_f32_dpp v25, v23, v23 row_ror:8 row_mask:0xf bank_mask:0xc
    s_nop 0
    v_add_f32_dpp v26, v24, v24 row_shl:4 row_mask:0xf bank_mask:0x5
    v_add_f32_dpp v26, v25, v25 row_shr:4 row_mask:0xf bank_mask:0xa
    s_nop 1
    v_add_f32_dpp v26, v26, v26 quad_perm:[1,0,3,2] row_mask:0xf bank_mask:0xf
    s_nop 1
    v_add_f32_dpp v26, v26, v26 quad_perm:[2,3,0,1] row_mask:0xf bank_mask:0xf
    v_cvt_pk_bf16_f32 v26, v26, v26
    v_and_b32 v26, s98, v26
    v_mul_f32 v26, s96, v26
    v_cvt_pk_bf16_f32 v26, v26, v26
    v_and_b32 v26, s98, v26
    s_nop 1
    v_max_f32_dpp v27, v26, v26 row_ror:4 row_mask:0xf bank_mask:0xf
    s_nop 1
    v_max_f32_dpp v27, v27, v27 row_ror:8 row_mask:0xf bank_mask:0xf
    v_mov_b32 v28, v27
    s_nop 1
    v_permlane16_swap_b32 v27, v28
    v_max_f32 v27, v27, v28
    v_mov_b32 v28, v27
    s_nop 1
    v_permlane32_swap_b32 v27, v28
    v_max3_f32 v27, v27, v28, v16
    v_sub_f32 v28, v16, v27
    v_sub_f32 v29, v26, v27
    v_mul_f32 v28, s97, v28
    v_mul_f32 v29, s97, v29
    v_exp_f32 v28, v28
    v_exp_f32 v29, v29
    v_mov_b32 v16, v27
    v_fma_f32 v17, v17, v28, v29
    v_cvt_pk_bf16_f32 v29, v29, v29
    v_mul_f32 v12, v12, v28
    v_mul_f32 v13, v13, v28
    v_mul_f32 v14, v14, v28
    v_mul_f32 v15, v15, v28
    s_waitcnt vmcnt(52)
    v_and_b32_dpp v32, v29, v8 row_newbcast:0 row_mask:0xf bank_mask:0xf
    v_and_b32_dpp v33, v29, v9 row_newbcast:0 row_mask:0xf bank_mask:0xf
    v_and_b32_dpp v34, v29, v10 row_newbcast:0 row_mask:0xf bank_mask:0xf
    v_and_b32_dpp v35, v29, v11 row_newbcast:0 row_mask:0xf bank_mask:0xf
    v_and_b32_dpp v36, v29, v8 row_newbcast:8 row_mask:0xf bank_mask:0xf
    v_and_b32_dpp v37, v29, v9 row_newbcast:8 row_mask:0xf bank_mask:0xf
    v_and_b32_dpp v38, v29, v10 row_newbcast:8 row_mask:0xf bank_mask:0xf
    v_and_b32_dpp v39, v29, v11 row_newbcast:8 row_mask:0xf bank_mask:0xf
    v_and_b32_dpp v40, v29, v8 row_newbcast:4 row_mask:0xf bank_mask:0xf
    v_and_b32_dpp v41, v29, v9 row_newbcast:4 row_mask:0xf bank_mask:0xf
    v_and_b32_dpp v42, v29, v10 row_newbcast:4 row_mask:0xf bank_mask:0xf
    v_and_b32_dpp v43, v29, v11 row_newbcast:4 row_mask:0xf bank_mask:0xf
    v_and_b32_dpp v44, v29, v8 row_newbcast:12 row_mask:0xf bank_mask:0xf
    v_and_b32_dpp v45, v29, v9 row_newbcast:12 row_mask:0xf bank_mask:0xf
    v_and_b32_dpp v46, v29, v10 row_newbcast:12 row_mask:0xf bank_mask:0xf
    v_and_b32_dpp v47, v29, v11 row_newbcast:12 row_mask:0xf bank_mask:0xf
    v_mfma_f32_16x16x32_bf16 v[12:15], v[32:35], a[96:99], v[12:15]
    v_mfma_f32_16x16x32_bf16 v[12:15], v[36:39], a[100:103], v[12:15]
    v_mfma_f32_16x16x32_bf16 v[12:15], v[40:43], a[104:107], v[12:15]
    v_mfma_f32_16x16x32_bf16 v[12:15], v[44:47], a[108:111], v[12:15]
    buffer_load_dwordx4 a[96:99], v2, s[36:39], s60 offen offset:0 nt
    buffer_load_dwordx4 a[100:103], v2, s[36:39], s60 offen offset:1024 nt
    buffer_load_dwordx4 a[104:107], v2, s[36:39], s60 offen offset:2048 nt
    buffer_load_dwordx4 a[108:111], v2, s[36:39], s60 offen offset:3072 nt
    s_sub_u32 s62, s62, 1
    s_cmp_eq_u32 s62, 0
    s_cbranch_scc1 L_adone
    s_branch L_aloop
L_adone:
    v_add_f32_dpp v17, v17, v17 row_ror:4 row_mask:0xf bank_mask:0xf
    s_nop 1
    v_add_f32_dpp v17, v17, v17 row_ror:8 row_mask:0xf bank_mask:0xf
    v_mov_b32 v28, v17
    s_nop 1
    v_permlane16_swap_b32 v17, v28
    v_add_f32 v17, v17, v28
    v_mov_b32 v28, v17
    s_nop 1
    v_permlane32_swap_b32 v17, v28
    v_add_f32 v17, v17, v28
    v_lshlrev_b32 v5, 5, v3
    v_lshl_add_u32 v5, v4, 4, v5
    v_cmp_gt_u32 vcc, 32, v1
    s_nop 1
    v_cndmask_b32 v5, v2, v5, vcc
    v_cndmask_b32 v20, v16, v12, vcc
    v_cndmask_b32 v21, v17, v13, vcc
    v_cndmask_b32 v22, v16, v14, vcc
    v_cndmask_b32 v23, v17, v15, vcc
    v_min_u32 v20, -2, v20
    v_min_u32 v21, -2, v21
    v_min_u32 v22, -2, v22
    v_min_u32 v23, -2, v23
    buffer_store_dwordx4 v[20:23], v5, s[44:47], s63 offen sc1
    s_endpgm
L_roleA_end:
L_roleB:
    s_mov_b32 s101, 100000
    s_and_b32 s54, s2, 7
    s_lshl_b32 s52, s54, 2
    s_lshr_b32 s54, s2, 3
    s_add_u32 s52, s52, s54
    v_mul_u32_u24 v120, 294912, v4
    v_lshl_add_u32 v120, v3, 4, v120
    s_mul_i32 s61, s3, 1179648
    s_lshl_b32 s54, s52, 8
    s_add_u32 s61, s61, s54
    s_getpc_b64 s[56:57]
L_pc_3:
    s_sub_u32 s56, s56, L_pc_3-L_roleB
    s_subb_u32 s57, s57, 0
    v_lshlrev_b32 v5, 7, v0
    v_min_u32 v6, L_roleB_end-L_roleB-4, v5
    global_load_dword v122, v6, s[56:57]
    v_mov_b32 v20, -1
    v_mov_b32 v21, -1
    v_mov_b32 v22, -1
    v_mov_b32 v23, -1
    s_waitcnt lgkmcnt(0)
    s_mov_b32 s40, s18
    s_mov_b32 s41, s19
    s_mov_b32 s42, 4718592
    s_mov_b32 s43, 0x20000
    s_mov_b32 s48, s14
    s_mov_b32 s49, s15
    s_mov_b32 s50, 4608
    s_mov_b32 s51, 0x20000
    s_mov_b32 s44, s30
    s_mov_b32 s45, s31
    s_mov_b32 s46, 536870912
    s_mov_b32 s47, 0x20000
    s_mov_b32 s36, s20
    s_mov_b32 s37, s21
    s_mov_b32 s38, 4194304
    s_mov_b32 s39, 0x20000
    s_mov_b32 s32, s16
    s_mov_b32 s33, s17
    s_mov_b32 s34, 16777216
    s_mov_b32 s35, 0x20000
    v_lshrrev_b32 v5, 3, v3
    v_mul_u32_u24 v5, 1152, v5
    v_mul_u32_u24 v6, 72, v4
    v_add_u32 v5, v5, v6
    s_mul_i32 s54, s3, 288
    buffer_load_dwordx4 v[48:51], v5, s[48:51], s54 offen offset:0
    buffer_load_dwordx4 v[52:55], v5, s[48:51], s54 offen offset:16
    buffer_load_dwordx4 v[56:59], v5, s[48:51], s54 offen offset:32
    buffer_load_dwordx4 v[60:63], v5, s[48:51], s54 offen offset:48
    buffer_load_dwordx2 v[64:65], v5, s[48:51], s54 offen offset:64
    buffer_load_dwordx4 v[68:71], v5, s[48:51], s54 offen offset:2304
    buffer_load_dwordx4 v[72:75], v5, s[48:51], s54 offen offset:2320
    buffer_load_dwordx4 v[76:79], v5, s[48:51], s54 offen offset:2336
    buffer_load_dwordx4 v[80:83], v5, s[48:51], s54 offen offset:2352
    buffer_load_dwordx2 v[84:85], v5, s[48:51], s54 offen offset:2368
    buffer_load_dwordx4 a[112:115], v120, s[40:43], s61 offen nt
    s_add_u32 s61, s61, 8192
    buffer_load_dwordx4 a[116:119], v120, s[40:43], s61 offen nt
    s_add_u32 s61, s61, 8192
    buffer_load_dwordx4 a[120:123], v120, s[40:43], s61 offen nt
    s_add_u32 s61, s61, 8192
    buffer_load_dwordx4 a[124:127], v120, s[40:43], s61 offen nt
    s_add_u32 s61, s61, 8192
    buffer_load_dwordx4 a[128:131], v120, s[40:43], s61 offen nt
    s_add_u32 s61, s61, 8192
    buffer_load_dwordx4 a[132:135], v120, s[40:43], s61 offen nt
    s_add_u32 s61, s61, 8192
    buffer_load_dwordx4 a[136:139], v120, s[40:43], s61 offen nt
    s_add_u32 s61, s61, 8192
    buffer_load_dwordx4 a[140:143], v120, s[40:43], s61 offen nt
    s_add_u32 s61, s61, 8192
    buffer_load_dwordx4 a[144:147], v120, s[40:43], s61 offen nt
    s_add_u32 s61, s61, 8192
    buffer_load_dwordx4 a[148:151], v120, s[40:43], s61 offen nt
    s_add_u32 s61, s61, 8192
    buffer_load_dwordx4 a[152:155], v120, s[40:43], s61 offen nt
    s_add_u32 s61, s61, 8192
    buffer_load_dwordx4 a[156:159], v120, s[40:43], s61 offen nt
    s_add_u32 s61, s61, 8192
    buffer_load_dwordx4 a[160:163], v120, s[40:43], s61 offen nt
    s_add_u32 s61, s61, 8192
    buffer_load_dwordx4 a[164:167], v120, s[40:43], s61 offen nt
    s_add_u32 s61, s61, 8192
    buffer_load_dwordx4 a[168:171], v120, s[40:43], s61 offen nt
    s_add_u32 s61, s61, 8192
    buffer_load_dwordx4 a[172:175], v120, s[40:43], s61 offen nt
    s_add_u32 s61, s61, 8192
    buffer_load_dwordx4 a[176:179], v120, s[40:43], s61 offen nt
    s_add_u32 s61, s61, 8192
    buffer_load_dwordx4 a[180:183], v120, s[40:43], s61 offen nt
    s_add_u32 s61, s61, 8192
    buffer_load_dwordx4 a[184:187], v120, s[40:43], s61 offen nt
    s_add_u32 s61, s61, 8192
    buffer_load_dwordx4 a[188:191], v120, s[40:43], s61 offen nt
    s_add_u32 s61, s61, 8192
    buffer_load_dwordx4 a[192:195], v120, s[40:43], s61 offen nt
    s_add_u32 s61, s61, 8192
    buffer_load_dwordx4 a[196:199], v120, s[40:43], s61 offen nt
    s_add_u32 s61, s61, 8192
    buffer_load_dwordx4 a[200:203], v120, s[40:43], s61 offen nt
    s_add_u32 s61, s61, 8192
    buffer_load_dwordx4 a[204:207], v120, s[40:43], s61 offen nt
    s_add_u32 s61, s61, 8192
    buffer_load_dwordx4 a[208:211], v120, s[40:43], s61 offen nt
    s_add_u32 s61, s61, 8192
    buffer_load_dwordx4 a[212:215], v120, s[40:43], s61 offen nt
    s_add_u32 s61, s61, 8192
    buffer_load_dwordx4 a[216:219], v120, s[40:43], s61 offen nt
    s_add_u32 s61, s61, 8192
    buffer_load_dwordx4 a[220:223], v120, s[40:43], s61 offen nt
    s_add_u32 s61, s61, 8192
    buffer_load_dwordx4 a[224:227], v120, s[40:43], s61 offen nt
    s_add_u32 s61, s61, 8192
    buffer_load_dwordx4 a[228:231], v120, s[40:43], s61 offen nt
    s_add_u32 s61, s61, 8192
    buffer_load_dwordx4 a[232:235], v120, s[40:43], s61 offen nt
    s_add_u32 s61, s61, 8192
    buffer_load_dwordx4 a[236:239], v120, s[40:43], s61 offen nt
    s_add_u32 s61, s61, 8192
    buffer_load_dwordx4 a[240:243], v120, s[40:43], s61 offen nt
    s_add_u32 s61, s61, 8192
    buffer_load_dwordx4 a[244:247], v120, s[40:43], s61 offen nt
    s_add_u32 s61, s61, 8192
    buffer_load_dwordx4 a[248:251], v120, s[40:43], s61 offen nt
    s_add_u32 s61, s61, 8192
    buffer_load_dwordx4 a[252:255], v120, s[40:43], s61 offen nt
    s_add_u32 s61, s61, 8192
    v_mul_u32_u24 v7, 73728, v4
    v_lshrrev_b32 v5, 3, v3
    v_lshl_add_u32 v6, v5, 13, v7
    v_and_b32 v5, 7, v3
    v_lshl_add_u32 v6, v5, 4, v6
    v_lshl_add_u32 v7, v3, 3, v7
    v_add_u32 v7, 65536, v7
    s_lshl_b32 s56, s52, 7
    s_add_u32 s56, s56, 4194304
    s_lshl_b32 s54, s3, 14
    s_add_u32 s54, s54, s56
    s_add_u32 s55, s54, 4096
    s_and_b32 s57, s3, 1
    s_lshl_b32 s57, s57, 12
    s_add_u32 s56, s56, s57
    buffer_store_dwordx4 v[20:23], v6, s[44:47], s54 offen sc1
    buffer_store_dwordx4 v[20:23], v6, s[44:47], s55 offen sc1
    buffer_store_dwordx2 v[20:21], v7, s[44:47], s56 offen sc1
    s_lshl_b32 s56, s52, 7
    s_add_u32 s56, s56, 4718592
    s_lshl_b32 s54, s3, 14
    s_add_u32 s54, s54, s56
    s_add_u32 s55, s54, 4096
    s_and_b32 s57, s3, 1
    s_lshl_b32 s57, s57, 12
    s_add_u32 s56, s56, s57
    buffer_store_dwordx4 v[20:23], v6, s[44:47], s54 offen sc1
    buffer_store_dwordx4 v[20:23], v6, s[44:47], s55 offen sc1
    buffer_store_dwordx2 v[20:21], v7, s[44:47], s56 offen sc1
    v_lshrrev_b32 v5, 2, v3
    v_lshlrev_b32 v5, 3, v5
    v_and_b32 v6, 3, v3
    v_add_u32 v5, v5, v6
    v_lshlrev_b32 v121, 13, v5
    v_lshl_add_u32 v121, v4, 4, v121
    s_lshl_b32 s62, s3, 20
    s_lshl_b32 s54, s52, 8
    s_add_u32 s62, s62, s54
    s_add_u32 s54, s62, 0
    buffer_load_dwordx4 v[128:131], v121, s[36:39], s54 offen offset:0 nt
    buffer_load_dwordx4 v[132:135], v121, s[36:39], s54 offen offset:64 nt
    buffer_load_dwordx4 v[136:139], v121, s[36:39], s54 offen offset:128 nt
    buffer_load_dwordx4 v[140:143], v121, s[36:39], s54 offen offset:192 nt
    s_add_u32 s54, s62, 32768
    buffer_load_dwordx4 v[144:147], v121, s[36:39], s54 offen offset:0 nt
    buffer_load_dwordx4 v[148:151], v121, s[36:39], s54 offen offset:64 nt
    buffer_load_dwordx4 v[152:155], v121, s[36:39], s54 offen offset:128 nt
    buffer_load_dwordx4 v[156:159], v121, s[36:39], s54 offen offset:192 nt
    v_and_b32 v5, 1, v3
    v_cmp_eq_u32 vcc, 1, v5
    v_mov_b32 v5, 0x0c0c0100
    v_mov_b32 v6, 0x01000c0c
    v_cndmask_b32 v5, v5, v6, vcc
    v_mov_b32 v6, 0x0c0c0302
    v_mov_b32 v7, 0x03020c0c
    v_cndmask_b32 v6, v6, v7, vcc
    v_bfe_u32 v7, v3, 1, 2
    v_mov_b32 v16, 0x0c0c0c0c
    v_cmp_eq_u32 vcc, 0, v7
    s_nop 1
    v_cndmask_b32 v8, v16, v5, vcc
    v_cndmask_b32 v9, v16, v6, vcc
    v_cmp_eq_u32 vcc, 1, v7
    s_nop 1
    v_cndmask_b32 v10, v16, v5, vcc
    v_cndmask_b32 v11, v16, v6, vcc
    v_cmp_eq_u32 vcc, 2, v7
    s_nop 1
    v_cndmask_b32 v12, v16, v5, vcc
    v_cndmask_b32 v13, v16, v6, vcc
    v_cmp_eq_u32 vcc, 3, v7
    s_nop 1
    v_cndmask_b32 v14, v16, v5, vcc
    v_cndmask_b32 v15, v16, v6, vcc
    s_waitcnt vmcnt(41)
    s_add_u32 s54, s62, 262144
    buffer_load_dwordx4 v[160:163], v121, s[36:39], s54 offen offset:0 nt
    buffer_load_dwordx4 v[164:167], v121, s[36:39], s54 offen offset:64 nt
    buffer_load_dwordx4 v[168:171], v121, s[36:39], s54 offen offset:128 nt
    buffer_load_dwordx4 v[172:175], v121, s[36:39], s54 offen offset:192 nt
    s_add_u32 s54, s62, 294912
    buffer_load_dwordx4 v[176:179], v121, s[36:39], s54 offen offset:0 nt
    buffer_load_dwordx4 v[180:183], v121, s[36:39], s54 offen offset:64 nt
    buffer_load_dwordx4 v[184:187], v121, s[36:39], s54 offen offset:128 nt
    buffer_load_dwordx4 v[188:191], v121, s[36:39], s54 offen offset:192 nt
    s_add_u32 s54, s62, 524288
    buffer_load_dwordx4 v[192:195], v121, s[36:39], s54 offen offset:0 nt
    buffer_load_dwordx4 v[196:199], v121, s[36:39], s54 offen offset:64 nt
    buffer_load_dwordx4 v[200:203], v121, s[36:39], s54 offen offset:128 nt
    buffer_load_dwordx4 v[204:207], v121, s[36:39], s54 offen offset:192 nt
    s_add_u32 s54, s62, 557056
    buffer_load_dwordx4 v[208:211], v121, s[36:39], s54 offen offset:0 nt
    buffer_load_dwordx4 v[212:215], v121, s[36:39], s54 offen offset:64 nt
    buffer_load_dwordx4 v[216:219], v121, s[36:39], s54 offen offset:128 nt
    buffer_load_dwordx4 v[220:223], v121, s[36:39], s54 offen offset:192 nt
    v_perm_b32 v96, v48, v48, v8
    v_perm_b32 v97, v48, v48, v10
    v_perm_b32 v98, v48, v48, v12
    v_perm_b32 v99, v48, v48, v14
    s_nop 1
    v_mfma_f32_16x16x32_bf16 v[112:115], v[96:99], a[112:115], 0
    v_perm_b32 v100, v68, v68, v8
    v_perm_b32 v101, v68, v68, v10
    v_perm_b32 v102, v68, v68, v12
    v_perm_b32 v103, v68, v68, v14
    s_nop 1
    v_mfma_f32_16x16x32_bf16 v[116:119], v[100:103], a[112:115], 0
    v_perm_b32 v104, v48, v48, v9
    v_perm_b32 v105, v48, v48, v11
    v_perm_b32 v106, v48, v48, v13
    v_perm_b32 v107, v48, v48, v15
    s_nop 1
    v_mfma_f32_16x16x32_bf16 v[112:115], v[104:107], a[116:119], v[112:115]
    v_perm_b32 v108, v68, v68, v9
    v_perm_b32 v109, v68, v68, v11
    v_perm_b32 v110, v68, v68, v13
    v_perm_b32 v111, v68, v68, v15
    s_nop 1
    v_mfma_f32_16x16x32_bf16 v[116:119], v[108:111], a[116:119], v[116:119]
    v_perm_b32 v96, v49, v49, v8
    v_perm_b32 v97, v49, v49, v10
    v_perm_b32 v98, v49, v49, v12
    v_perm_b32 v99, v49, v49, v14
    s_nop 1
    v_mfma_f32_16x16x32_bf16 v[112:115], v[96:99], a[120:123], v[112:115]
    v_perm_b32 v100, v69, v69, v8
    v_perm_b32 v101, v69, v69, v10
    v_perm_b32 v102, v69, v69, v12
    v_perm_b32 v103, v69, v69, v14
    s_nop 1
    v_mfma_f32_16x16x32_bf16 v[116:119], v[100:103], a[120:123], v[116:119]
    v_perm_b32 v104, v49, v49, v9
    v_perm_b32 v105, v49, v49, v11
    v_perm_b32 v106, v49, v49, v13
    v_perm_b32 v107, v49, v49, v15
    s_nop 1
    v_mfma_f32_16x16x32_bf16 v[112:115], v[104:107], a[124:127], v[112:115]
    v_perm_b32 v108, v69, v69, v9
    v_perm_b32 v109, v69, v69, v11
    v_perm_b32 v110, v69, v69, v13
    v_perm_b32 v111, v69, v69, v15
    s_nop 1
    v_mfma_f32_16x16x32_bf16 v[116:119], v[108:111], a[124:127], v[116:119]
    v_perm_b32 v96, v50, v50, v8
    v_perm_b32 v97, v50, v50, v10
    v_perm_b32 v98, v50, v50, v12
    v_perm_b32 v99, v50, v50, v14
    s_nop 1
    v_mfma_f32_16x16x32_bf16 v[112:115], v[96:99], a[128:131], v[112:115]
    v_perm_b32 v100, v70, v70, v8
    v_perm_b32 v101, v70, v70, v10
    v_perm_b32 v102, v70, v70, v12
    v_perm_b32 v103, v70, v70, v14
    s_nop 1
    v_mfma_f32_16x16x32_bf16 v[116:119], v[100:103], a[128:131], v[116:119]
    v_perm_b32 v104, v50, v50, v9
    v_perm_b32 v105, v50, v50, v11
    v_perm_b32 v106, v50, v50, v13
    v_perm_b32 v107, v50, v50, v15
    s_nop 1
    v_mfma_f32_16x16x32_bf16 v[112:115], v[104:107], a[132:135], v[112:115]
    v_perm_b32 v108, v70, v70, v9
    v_perm_b32 v109, v70, v70, v11
    v_perm_b32 v110, v70, v70, v13
    v_perm_b32 v111, v70, v70, v15
    s_nop 1
    v_mfma_f32_16x16x32_bf16 v[116:119], v[108:111], a[132:135], v[116:119]
    v_perm_b32 v96, v51, v51, v8
    v_perm_b32 v97, v51, v51, v10
    v_perm_b32 v98, v51, v51, v12
    v_perm_b32 v99, v51, v51, v14
    s_nop 1
    v_mfma_f32_16x16x32_bf16 v[112:115], v[96:99], a[136:139], v[112:115]
    v_perm_b32 v100, v71, v71, v8
    v_perm_b32 v101, v71, v71, v10
    v_perm_b32 v102, v71, v71, v12
    v_perm_b32 v103, v71, v71, v14
    s_nop 1
    v_mfma_f32_16x16x32_bf16 v[116:119], v[100:103], a[136:139], v[116:119]
    v_perm_b32 v104, v51, v51, v9
    v_perm_b32 v105, v51, v51, v11
    v_perm_b32 v106, v51, v51, v13
    v_perm_b32 v107, v51, v51, v15
    s_nop 1
    v_mfma_f32_16x16x32_bf16 v[112:115], v[104:107], a[140:143], v[112:115]
    v_perm_b32 v108, v71, v71, v9
    v_perm_b32 v109, v71, v71, v11
    v_perm_b32 v110, v71, v71, v13
    v_perm_b32 v111, v71, v71, v15
    s_nop 1
    v_mfma_f32_16x16x32_bf16 v[116:119], v[108:111], a[140:143], v[116:119]
    v_perm_b32 v96, v52, v52, v8
    v_perm_b32 v97, v52, v52, v10
    v_perm_b32 v98, v52, v52, v12
    v_perm_b32 v99, v52, v52, v14
    s_nop 1
    v_mfma_f32_16x16x32_bf16 v[112:115], v[96:99], a[144:147], v[112:115]
    v_perm_b32 v100, v72, v72, v8
    v_perm_b32 v101, v72, v72, v10
    v_perm_b32 v102, v72, v72, v12
    v_perm_b32 v103, v72, v72, v14
    s_nop 1
    v_mfma_f32_16x16x32_bf16 v[116:119], v[100:103], a[144:147], v[116:119]
    s_waitcnt vmcnt(48)
    s_add_u32 s54, s62, 786432
    buffer_load_dwordx4 v[224:227], v121, s[36:39], s54 offen offset:0 nt
    buffer_load_dwordx4 v[228:231], v121, s[36:39], s54 offen offset:64 nt
    buffer_load_dwordx4 v[232:235], v121, s[36:39], s54 offen offset:128 nt
    buffer_load_dwordx4 v[236:239], v121, s[36:39], s54 offen offset:192 nt
    s_add_u32 s54, s62, 819200
    buffer_load_dwordx4 v[240:243], v121, s[36:39], s54 offen offset:0 nt
    buffer_load_dwordx4 v[244:247], v121, s[36:39], s54 offen offset:64 nt
    buffer_load_dwordx4 v[248:251], v121, s[36:39], s54 offen offset:128 nt
    buffer_load_dwordx4 v[252:255], v121, s[36:39], s54 offen offset:192 nt
    v_perm_b32 v104, v52, v52, v9
    v_perm_b32 v105, v52, v52, v11
    v_perm_b32 v106, v52, v52, v13
    v_perm_b32 v107, v52, v52, v15
    s_nop 1
    v_mfma_f32_16x16x32_bf16 v[112:115], v[104:107], a[148:151], v[112:115]
    v_perm_b32 v108, v72, v72, v9
    v_perm_b32 v109, v72, v72, v11
    v_perm_b32 v110, v72, v72, v13
    v_perm_b32 v111, v72, v72, v15
    s_nop 1
    v_mfma_f32_16x16x32_bf16 v[116:119], v[108:111], a[148:151], v[116:119]
    v_perm_b32 v96, v53, v53, v8
    v_perm_b32 v97, v53, v53, v10
    v_perm_b32 v98, v53, v53, v12
    v_perm_b32 v99, v53, v53, v14
    s_nop 1
    v_mfma_f32_16x16x32_bf16 v[112:115], v[96:99], a[152:155], v[112:115]
    v_perm_b32 v100, v73, v73, v8
    v_perm_b32 v101, v73, v73, v10
    v_perm_b32 v102, v73, v73, v12
    v_perm_b32 v103, v73, v73, v14
    s_nop 1
    v_mfma_f32_16x16x32_bf16 v[116:119], v[100:103], a[152:155], v[116:119]
    v_perm_b32 v104, v53, v53, v9
    v_perm_b32 v105, v53, v53, v11
    v_perm_b32 v106, v53, v53, v13
    v_perm_b32 v107, v53, v53, v15
    s_nop 1
    v_mfma_f32_16x16x32_bf16 v[112:115], v[104:107], a[156:159], v[112:115]
    v_perm_b32 v108, v73, v73, v9
    v_perm_b32 v109, v73, v73, v11
    v_perm_b32 v110, v73, v73, v13
    v_perm_b32 v111, v73, v73, v15
    s_nop 1
    v_mfma_f32_16x16x32_bf16 v[116:119], v[108:111], a[156:159], v[116:119]
    v_perm_b32 v96, v54, v54, v8
    v_perm_b32 v97, v54, v54, v10
    v_perm_b32 v98, v54, v54, v12
    v_perm_b32 v99, v54, v54, v14
    s_nop 1
    v_mfma_f32_16x16x32_bf16 v[112:115], v[96:99], a[160:163], v[112:115]
    v_perm_b32 v100, v74, v74, v8
    v_perm_b32 v101, v74, v74, v10
    v_perm_b32 v102, v74, v74, v12
    v_perm_b32 v103, v74, v74, v14
    s_nop 1
    v_mfma_f32_16x16x32_bf16 v[116:119], v[100:103], a[160:163], v[116:119]
    v_perm_b32 v104, v54, v54, v9
    v_perm_b32 v105, v54, v54, v11
    v_perm_b32 v106, v54, v54, v13
    v_perm_b32 v107, v54, v54, v15
    s_nop 1
    v_mfma_f32_16x16x32_bf16 v[112:115], v[104:107], a[164:167], v[112:115]
    v_perm_b32 v108, v74, v74, v9
    v_perm_b32 v109, v74, v74, v11
    v_perm_b32 v110, v74, v74, v13
    v_perm_b32 v111, v74, v74, v15
    s_nop 1
    v_mfma_f32_16x16x32_bf16 v[116:119], v[108:111], a[164:167], v[116:119]
    v_perm_b32 v96, v55, v55, v8
    v_perm_b32 v97, v55, v55, v10
    v_perm_b32 v98, v55, v55, v12
    v_perm_b32 v99, v55, v55, v14
    s_nop 1
    v_mfma_f32_16x16x32_bf16 v[112:115], v[96:99], a[168:171], v[112:115]
    v_perm_b32 v100, v75, v75, v8
    v_perm_b32 v101, v75, v75, v10
    v_perm_b32 v102, v75, v75, v12
    v_perm_b32 v103, v75, v75, v14
    s_nop 1
    v_mfma_f32_16x16x32_bf16 v[116:119], v[100:103], a[168:171], v[116:119]
    v_perm_b32 v104, v55, v55, v9
    v_perm_b32 v105, v55, v55, v11
    v_perm_b32 v106, v55, v55, v13
    v_perm_b32 v107, v55, v55, v15
    s_nop 1
    v_mfma_f32_16x16x32_bf16 v[112:115], v[104:107], a[172:175], v[112:115]
    v_perm_b32 v108, v75, v75, v9
    v_perm_b32 v109, v75, v75, v11
    v_perm_b32 v110, v75, v75, v13
    v_perm_b32 v111, v75, v75, v15
    s_nop 1
    v_mfma_f32_16x16x32_bf16 v[116:119], v[108:111], a[172:175], v[116:119]
    v_perm_b32 v96, v56, v56, v8
    v_perm_b32 v97, v56, v56, v10
    v_perm_b32 v98, v56, v56, v12
    v_perm_b32 v99, v56, v56, v14
    s_nop 1
    v_mfma_f32_16x16x32_bf16 v[112:115], v[96:99], a[176:179], v[112:115]
    v_perm_b32 v100, v76, v76, v8
    v_perm_b32 v101, v76, v76, v10
    v_perm_b32 v102, v76, v76, v12
    v_perm_b32 v103, v76, v76, v14
    s_nop 1
    v_mfma_f32_16x16x32_bf16 v[116:119], v[100:103], a[176:179], v[116:119]
    v_perm_b32 v104, v56, v56, v9
    v_perm_b32 v105, v56, v56, v11
    v_perm_b32 v106, v56, v56, v13
    v_perm_b32 v107, v56, v56, v15
    s_nop 1
    v_mfma_f32_16x16x32_bf16 v[112:115], v[104:107], a[180:183], v[112:115]
    v_perm_b32 v108, v76, v76, v9
    v_perm_b32 v109, v76, v76, v11
    v_perm_b32 v110, v76, v76, v13
    v_perm_b32 v111, v76, v76, v15
    s_nop 1
    v_mfma_f32_16x16x32_bf16 v[116:119], v[108:111], a[180:183], v[116:119]
    s_waitcnt vmcnt(47)
    v_perm_b32 v96, v57, v57, v8
    v_perm_b32 v97, v57, v57, v10
    v_perm_b32 v98, v57, v57, v12
    v_perm_b32 v99, v57, v57, v14
    s_nop 1
    v_mfma_f32_16x16x32_bf16 v[112:115], v[96:99], a[184:187], v[112:115]
    v_perm_b32 v100, v77, v77, v8
    v_perm_b32 v101, v77, v77, v10
    v_perm_b32 v102, v77, v77, v12
    v_perm_b32 v103, v77, v77, v14
    s_nop 1
    v_mfma_f32_16x16x32_bf16 v[116:119], v[100:103], a[184:187], v[116:119]
    v_perm_b32 v104, v57, v57, v9
    v_perm_b32 v105, v57, v57, v11
    v_perm_b32 v106, v57, v57, v13
    v_perm_b32 v107, v57, v57, v15
    s_nop 1
    v_mfma_f32_16x16x32_bf16 v[112:115], v[104:107], a[188:191], v[112:115]
    v_perm_b32 v108, v77, v77, v9
    v_perm_b32 v109, v77, v77, v11
    v_perm_b32 v110, v77, v77, v13
    v_perm_b32 v111, v77, v77, v15
    s_nop 1
    v_mfma_f32_16x16x32_bf16 v[116:119], v[108:111], a[188:191], v[116:119]
    v_perm_b32 v96, v58, v58, v8
    v_perm_b32 v97, v58, v58, v10
    v_perm_b32 v98, v58, v58, v12
    v_perm_b32 v99, v58, v58, v14
    s_nop 1
    v_mfma_f32_16x16x32_bf16 v[112:115], v[96:99], a[192:195], v[112:115]
    v_perm_b32 v100, v78, v78, v8
    v_perm_b32 v101, v78, v78, v10
    v_perm_b32 v102, v78, v78, v12
    v_perm_b32 v103, v78, v78, v14
    s_nop 1
    v_mfma_f32_16x16x32_bf16 v[116:119], v[100:103], a[192:195], v[116:119]
    v_perm_b32 v104, v58, v58, v9
    v_perm_b32 v105, v58, v58, v11
    v_perm_b32 v106, v58, v58, v13
    v_perm_b32 v107, v58, v58, v15
    s_nop 1
    v_mfma_f32_16x16x32_bf16 v[112:115], v[104:107], a[196:199], v[112:115]
    v_perm_b32 v108, v78, v78, v9
    v_perm_b32 v109, v78, v78, v11
    v_perm_b32 v110, v78, v78, v13
    v_perm_b32 v111, v78, v78, v15
    s_nop 1
    v_mfma_f32_16x16x32_bf16 v[116:119], v[108:111], a[196:199], v[116:119]
    v_perm_b32 v96, v59, v59, v8
    v_perm_b32 v97, v59, v59, v10
    v_perm_b32 v98, v59, v59, v12
    v_perm_b32 v99, v59, v59, v14
    s_nop 1
    v_mfma_f32_16x16x32_bf16 v[112:115], v[96:99], a[200:203], v[112:115]
    v_perm_b32 v100, v79, v79, v8
    v_perm_b32 v101, v79, v79, v10
    v_perm_b32 v102, v79, v79, v12
    v_perm_b32 v103, v79, v79, v14
    s_nop 1
    v_mfma_f32_16x16x32_bf16 v[116:119], v[100:103], a[200:203], v[116:119]
    v_perm_b32 v104, v59, v59, v9
    v_perm_b32 v105, v59, v59, v11
    v_perm_b32 v106, v59, v59, v13
    v_perm_b32 v107, v59, v59, v15
    s_nop 1
    v_mfma_f32_16x16x32_bf16 v[112:115], v[104:107], a[204:207], v[112:115]
    v_perm_b32 v108, v79, v79, v9
    v_perm_b32 v109, v79, v79, v11
    v_perm_b32 v110, v79, v79, v13
    v_perm_b32 v111, v79, v79, v15
    s_nop 1
    v_mfma_f32_16x16x32_bf16 v[116:119], v[108:111], a[204:207], v[116:119]
    v_perm_b32 v96, v60, v60, v8
    v_perm_b32 v97, v60, v60, v10
    v_perm_b32 v98, v60, v60, v12
    v_perm_b32 v99, v60, v60, v14
    s_nop 1
    v_mfma_f32_16x16x32_bf16 v[112:115], v[96:99], a[208:211], v[112:115]
    v_perm_b32 v100, v80, v80, v8
    v_perm_b32 v101, v80, v80, v10
    v_perm_b32 v102, v80, v80, v12
    v_perm_b32 v103, v80, v80, v14
    s_nop 1
    v_mfma_f32_16x16x32_bf16 v[116:119], v[100:103], a[208:211], v[116:119]
    v_perm_b32 v104, v60, v60, v9
    v_perm_b32 v105, v60, v60, v11
    v_perm_b32 v106, v60, v60, v13
    v_perm_b32 v107, v60, v60, v15
    s_nop 1
    v_mfma_f32_16x16x32_bf16 v[112:115], v[104:107], a[212:215], v[112:115]
    v_perm_b32 v108, v80, v80, v9
    v_perm_b32 v109, v80, v80, v11
    v_perm_b32 v110, v80, v80, v13
    v_perm_b32 v111, v80, v80, v15
    s_nop 1
    v_mfma_f32_16x16x32_bf16 v[116:119], v[108:111], a[212:215], v[116:119]
    v_perm_b32 v96, v61, v61, v8
    v_perm_b32 v97, v61, v61, v10
    v_perm_b32 v98, v61, v61, v12
    v_perm_b32 v99, v61, v61, v14
    s_nop 1
    v_mfma_f32_16x16x32_bf16 v[112:115], v[96:99], a[216:219], v[112:115]
    v_perm_b32 v100, v81, v81, v8
    v_perm_b32 v101, v81, v81, v10
    v_perm_b32 v102, v81, v81, v12
    v_perm_b32 v103, v81, v81, v14
    s_nop 1
    v_mfma_f32_16x16x32_bf16 v[116:119], v[100:103], a[216:219], v[116:119]
    s_waitcnt vmcnt(38)
    v_perm_b32 v104, v61, v61, v9
    v_perm_b32 v105, v61, v61, v11
    v_perm_b32 v106, v61, v61, v13
    v_perm_b32 v107, v61, v61, v15
    s_nop 1
    v_mfma_f32_16x16x32_bf16 v[112:115], v[104:107], a[220:223], v[112:115]
    v_perm_b32 v108, v81, v81, v9
    v_perm_b32 v109, v81, v81, v11
    v_perm_b32 v110, v81, v81, v13
    v_perm_b32 v111, v81, v81, v15
    s_nop 1
    v_mfma_f32_16x16x32_bf16 v[116:119], v[108:111], a[220:223], v[116:119]
    v_perm_b32 v96, v62, v62, v8
    v_perm_b32 v97, v62, v62, v10
    v_perm_b32 v98, v62, v62, v12
    v_perm_b32 v99, v62, v62, v14
    s_nop 1
    v_mfma_f32_16x16x32_bf16 v[112:115], v[96:99], a[224:227], v[112:115]
    v_perm_b32 v100, v82, v82, v8
    v_perm_b32 v101, v82, v82, v10
    v_perm_b32 v102, v82, v82, v12
    v_perm_b32 v103, v82, v82, v14
    s_nop 1
    v_mfma_f32_16x16x32_bf16 v[116:119], v[100:103], a[224:227], v[116:119]
    v_perm_b32 v104, v62, v62, v9
    v_perm_b32 v105, v62, v62, v11
    v_perm_b32 v106, v62, v62, v13
    v_perm_b32 v107, v62, v62, v15
    s_nop 1
    v_mfma_f32_16x16x32_bf16 v[112:115], v[104:107], a[228:231], v[112:115]
    v_perm_b32 v108, v82, v82, v9
    v_perm_b32 v109, v82, v82, v11
    v_perm_b32 v110, v82, v82, v13
    v_perm_b32 v111, v82, v82, v15
    s_nop 1
    v_mfma_f32_16x16x32_bf16 v[116:119], v[108:111], a[228:231], v[116:119]
    v_perm_b32 v96, v63, v63, v8
    v_perm_b32 v97, v63, v63, v10
    v_perm_b32 v98, v63, v63, v12
    v_perm_b32 v99, v63, v63, v14
    s_nop 1
    v_mfma_f32_16x16x32_bf16 v[112:115], v[96:99], a[232:235], v[112:115]
    v_perm_b32 v100, v83, v83, v8
    v_perm_b32 v101, v83, v83, v10
    v_perm_b32 v102, v83, v83, v12
    v_perm_b32 v103, v83, v83, v14
    s_nop 1
    v_mfma_f32_16x16x32_bf16 v[116:119], v[100:103], a[232:235], v[116:119]
    v_perm_b32 v104, v63, v63, v9
    v_perm_b32 v105, v63, v63, v11
    v_perm_b32 v106, v63, v63, v13
    v_perm_b32 v107, v63, v63, v15
    s_nop 1
    v_mfma_f32_16x16x32_bf16 v[112:115], v[104:107], a[236:239], v[112:115]
    v_perm_b32 v108, v83, v83, v9
    v_perm_b32 v109, v83, v83, v11
    v_perm_b32 v110, v83, v83, v13
    v_perm_b32 v111, v83, v83, v15
    s_nop 1
    v_mfma_f32_16x16x32_bf16 v[116:119], v[108:111], a[236:239], v[116:119]
    v_perm_b32 v96, v64, v64, v8
    v_perm_b32 v97, v64, v64, v10
    v_perm_b32 v98, v64, v64, v12
    v_perm_b32 v99, v64, v64, v14
    s_nop 1
    v_mfma_f32_16x16x32_bf16 v[112:115], v[96:99], a[240:243], v[112:115]
    v_perm_b32 v100, v84, v84, v8
    v_perm_b32 v101, v84, v84, v10
    v_perm_b32 v102, v84, v84, v12
    v_perm_b32 v103, v84, v84, v14
    s_nop 1
    v_mfma_f32_16x16x32_bf16 v[116:119], v[100:103], a[240:243], v[116:119]
    v_perm_b32 v104, v64, v64, v9
    v_perm_b32 v105, v64, v64, v11
    v_perm_b32 v106, v64, v64, v13
    v_perm_b32 v107, v64, v64, v15
    s_nop 1
    v_mfma_f32_16x16x32_bf16 v[112:115], v[104:107], a[244:247], v[112:115]
    v_perm_b32 v108, v84, v84, v9
    v_perm_b32 v109, v84, v84, v11
    v_perm_b32 v110, v84, v84, v13
    v_perm_b32 v111, v84, v84, v15
    s_nop 1
    v_mfma_f32_16x16x32_bf16 v[116:119], v[108:111], a[244:247], v[116:119]
    v_perm_b32 v96, v65, v65, v8
    v_perm_b32 v97, v65, v65, v10
    v_perm_b32 v98, v65, v65, v12
    v_perm_b32 v99, v65, v65, v14
    s_nop 1
    v_mfma_f32_16x16x32_bf16 v[112:115], v[96:99], a[248:251], v[112:115]
    v_perm_b32 v100, v85, v85, v8
    v_perm_b32 v101, v85, v85, v10
    v_perm_b32 v102, v85, v85, v12
    v_perm_b32 v103, v85, v85, v14
    s_nop 1
    v_mfma_f32_16x16x32_bf16 v[116:119], v[100:103], a[248:251], v[116:119]
    v_perm_b32 v104, v65, v65, v9
    v_perm_b32 v105, v65, v65, v11
    v_perm_b32 v106, v65, v65, v13
    v_perm_b32 v107, v65, v65, v15
    s_nop 1
    v_mfma_f32_16x16x32_bf16 v[112:115], v[104:107], a[252:255], v[112:115]
    v_perm_b32 v108, v85, v85, v9
    v_perm_b32 v109, v85, v85, v11
    v_perm_b32 v110, v85, v85, v13
    v_perm_b32 v111, v85, v85, v15
    s_nop 1
    v_mfma_f32_16x16x32_bf16 v[116:119], v[108:111], a[252:255], v[116:119]
    v_lshrrev_b32 v5, 1, v4
    v_lshlrev_b32 v5, 9, v5
    v_lshl_add_u32 v5, v3, 5, v5
    v_and_b32 v6, 1, v4
    v_lshl_add_u32 v5, v6, 4, v5
    s_lshl_b32 s54, s3, 11
    s_add_u32 s54, s54, 131072
    v_add_u32 v5, s54, v5
    ds_write_b128 v5, v[112:115]
    ds_write_b128 v5, v[116:119] offset:1024
    s_waitcnt lgkmcnt(0)
    s_barrier
    v_lshrrev_b32 v5, 2, v3
    v_lshlrev_b32 v5, 9, v5
    v_lshl_add_u32 v5, v4, 5, v5
    v_add_u32 v5, 131072, v5
    ds_read_b128 v[48:51], v5 offset:0
    ds_read_b128 v[52:55], v5 offset:16
    ds_read_b128 v[56:59], v5 offset:2048
    ds_read_b128 v[60:63], v5 offset:2064
    ds_read_b128 v[64:67], v5 offset:4096
    ds_read_b128 v[68:71], v5 offset:4112
    ds_read_b128 v[72:75], v5 offset:6144
    ds_read_b128 v[76:79], v5 offset:6160
    s_waitcnt lgkmcnt(0)
    v_add_f32 v48, v48, v56
    v_add_f32 v64, v64, v72
    v_add_f32 v49, v49, v57
    v_add_f32 v65, v65, v73
    v_add_f32 v50, v50, v58
    v_add_f32 v66, v66, v74
    v_add_f32 v51, v51, v59
    v_add_f32 v67, v67, v75
    v_add_f32 v52, v52, v60
    v_add_f32 v68, v68, v76
    v_add_f32 v53, v53, v61
    v_add_f32 v69, v69, v77
    v_add_f32 v54, v54, v62
    v_add_f32 v70, v70, v78
    v_add_f32 v55, v55, v63
    v_add_f32 v71, v71, v79
    v_add_f32 v48, v48, v64
    v_add_f32 v49, v49, v65
    v_add_f32 v50, v50, v66
    v_add_f32 v51, v51, v67
    v_add_f32 v52, v52, v68
    v_add_f32 v53, v53, v69
    v_add_f32 v54, v54, v70
    v_add_f32 v55, v55, v71
    v_cvt_pk_bf16_f32 v96, v48, v49
    v_cvt_pk_bf16_f32 v97, v50, v51
    v_cvt_pk_bf16_f32 v98, v52, v53
    v_cvt_pk_bf16_f32 v99, v54, v55
    ds_read_b128 v[48:51], v5 offset:128
    ds_read_b128 v[52:55], v5 offset:144
    ds_read_b128 v[56:59], v5 offset:2176
    ds_read_b128 v[60:63], v5 offset:2192
    ds_read_b128 v[64:67], v5 offset:4224
    ds_read_b128 v[68:71], v5 offset:4240
    ds_read_b128 v[72:75], v5 offset:6272
    ds_read_b128 v[76:79], v5 offset:6288
    s_waitcnt lgkmcnt(0)
    v_add_f32 v48, v48, v56
    v_add_f32 v64, v64, v72
    v_add_f32 v49, v49, v57
    v_add_f32 v65, v65, v73
    v_add_f32 v50, v50, v58
    v_add_f32 v66, v66, v74
    v_add_f32 v51, v51, v59
    v_add_f32 v67, v67, v75
    v_add_f32 v52, v52, v60
    v_add_f32 v68, v68, v76
    v_add_f32 v53, v53, v61
    v_add_f32 v69, v69, v77
    v_add_f32 v54, v54, v62
    v_add_f32 v70, v70, v78
    v_add_f32 v55, v55, v63
    v_add_f32 v71, v71, v79
    v_add_f32 v48, v48, v64
    v_add_f32 v49, v49, v65
    v_add_f32 v50, v50, v66
    v_add_f32 v51, v51, v67
    v_add_f32 v52, v52, v68
    v_add_f32 v53, v53, v69
    v_add_f32 v54, v54, v70
    v_add_f32 v55, v55, v71
    v_cvt_pk_bf16_f32 v100, v48, v49
    v_cvt_pk_bf16_f32 v101, v50, v51
    v_cvt_pk_bf16_f32 v102, v52, v53
    v_cvt_pk_bf16_f32 v103, v54, v55
    ds_read_b128 v[48:51], v5 offset:256
    ds_read_b128 v[52:55], v5 offset:272
    ds_read_b128 v[56:59], v5 offset:2304
    ds_read_b128 v[60:63], v5 offset:2320
    ds_read_b128 v[64:67], v5 offset:4352
    ds_read_b128 v[68:71], v5 offset:4368
    ds_read_b128 v[72:75], v5 offset:6400
    ds_read_b128 v[76:79], v5 offset:6416
    s_waitcnt lgkmcnt(0)
    v_add_f32 v48, v48, v56
    v_add_f32 v64, v64, v72
    v_add_f32 v49, v49, v57
    v_add_f32 v65, v65, v73
    v_add_f32 v50, v50, v58
    v_add_f32 v66, v66, v74
    v_add_f32 v51, v51, v59
    v_add_f32 v67, v67, v75
    v_add_f32 v52, v52, v60
    v_add_f32 v68, v68, v76
    v_add_f32 v53, v53, v61
    v_add_f32 v69, v69, v77
    v_add_f32 v54, v54, v62
    v_add_f32 v70, v70, v78
    v_add_f32 v55, v55, v63
    v_add_f32 v71, v71, v79
    v_add_f32 v48, v48, v64
    v_add_f32 v49, v49, v65
    v_add_f32 v50, v50, v66
    v_add_f32 v51, v51, v67
    v_add_f32 v52, v52, v68
    v_add_f32 v53, v53, v69
    v_add_f32 v54, v54, v70
    v_add_f32 v55, v55, v71
    v_cvt_pk_bf16_f32 v104, v48, v49
    v_cvt_pk_bf16_f32 v105, v50, v51
    v_cvt_pk_bf16_f32 v106, v52, v53
    v_cvt_pk_bf16_f32 v107, v54, v55
    ds_read_b128 v[48:51], v5 offset:384
    ds_read_b128 v[52:55], v5 offset:400
    ds_read_b128 v[56:59], v5 offset:2432
    ds_read_b128 v[60:63], v5 offset:2448
    ds_read_b128 v[64:67], v5 offset:4480
    ds_read_b128 v[68:71], v5 offset:4496
    ds_read_b128 v[72:75], v5 offset:6528
    ds_read_b128 v[76:79], v5 offset:6544
    s_waitcnt lgkmcnt(0)
    v_add_f32 v48, v48, v56
    v_add_f32 v64, v64, v72
    v_add_f32 v49, v49, v57
    v_add_f32 v65, v65, v73
    v_add_f32 v50, v50, v58
    v_add_f32 v66, v66, v74
    v_add_f32 v51, v51, v59
    v_add_f32 v67, v67, v75
    v_add_f32 v52, v52, v60
    v_add_f32 v68, v68, v76
    v_add_f32 v53, v53, v61
    v_add_f32 v69, v69, v77
    v_add_f32 v54, v54, v62
    v_add_f32 v70, v70, v78
    v_add_f32 v55, v55, v63
    v_add_f32 v71, v71, v79
    v_add_f32 v48, v48, v64
    v_add_f32 v49, v49, v65
    v_add_f32 v50, v50, v66
    v_add_f32 v51, v51, v67
    v_add_f32 v52, v52, v68
    v_add_f32 v53, v53, v69
    v_add_f32 v54, v54, v70
    v_add_f32 v55, v55, v71
    v_cvt_pk_bf16_f32 v108, v48, v49
    v_cvt_pk_bf16_f32 v109, v50, v51
    v_cvt_pk_bf16_f32 v110, v52, v53
    v_cvt_pk_bf16_f32 v111, v54, v55
    s_waitcnt vmcnt(28)
    v_mfma_f32_16x16x32_bf16 v[48:51], v[128:131], v[96:99], 0
    v_mfma_f32_16x16x32_bf16 v[48:51], v[132:135], v[100:103], v[48:51]
    v_mfma_f32_16x16x32_bf16 v[48:51], v[136:139], v[104:107], v[48:51]
    v_mfma_f32_16x16x32_bf16 v[48:51], v[140:143], v[108:111], v[48:51]
    s_waitcnt vmcnt(24)
    v_mfma_f32_16x16x32_bf16 v[52:55], v[144:147], v[96:99], 0
    v_mfma_f32_16x16x32_bf16 v[52:55], v[148:151], v[100:103], v[52:55]
    v_mfma_f32_16x16x32_bf16 v[52:55], v[152:155], v[104:107], v[52:55]
    v_mfma_f32_16x16x32_bf16 v[52:55], v[156:159], v[108:111], v[52:55]
    s_waitcnt vmcnt(20)
    v_mfma_f32_16x16x32_bf16 v[56:59], v[160:163], v[96:99], 0
    v_mfma_f32_16x16x32_bf16 v[56:59], v[164:167], v[100:103], v[56:59]
    v_mfma_f32_16x16x32_bf16 v[56:59], v[168:171], v[104:107], v[56:59]
    v_mfma_f32_16x16x32_bf16 v[56:59], v[172:175], v[108:111], v[56:59]
    s_waitcnt vmcnt(16)
    v_mfma_f32_16x16x32_bf16 v[60:63], v[176:179], v[96:99], 0
    v_mfma_f32_16x16x32_bf16 v[60:63], v[180:183], v[100:103], v[60:63]
    v_mfma_f32_16x16x32_bf16 v[60:63], v[184:187], v[104:107], v[60:63]
    v_mfma_f32_16x16x32_bf16 v[60:63], v[188:191], v[108:111], v[60:63]
    s_waitcnt vmcnt(12)
    v_mfma_f32_16x16x32_bf16 v[64:67], v[192:195], v[96:99], 0
    v_mfma_f32_16x16x32_bf16 v[64:67], v[196:199], v[100:103], v[64:67]
    v_mfma_f32_16x16x32_bf16 v[64:67], v[200:203], v[104:107], v[64:67]
    v_mfma_f32_16x16x32_bf16 v[64:67], v[204:207], v[108:111], v[64:67]
    s_waitcnt vmcnt(8)
    v_mfma_f32_16x16x32_bf16 v[68:71], v[208:211], v[96:99], 0
    v_mfma_f32_16x16x32_bf16 v[68:71], v[212:215], v[100:103], v[68:71]
    v_mfma_f32_16x16x32_bf16 v[68:71], v[216:219], v[104:107], v[68:71]
    v_mfma_f32_16x16x32_bf16 v[68:71], v[220:223], v[108:111], v[68:71]
    s_waitcnt vmcnt(4)
    v_mfma_f32_16x16x32_bf16 v[72:75], v[224:227], v[96:99], 0
    v_mfma_f32_16x16x32_bf16 v[72:75], v[228:231], v[100:103], v[72:75]
    v_mfma_f32_16x16x32_bf16 v[72:75], v[232:235], v[104:107], v[72:75]
    v_mfma_f32_16x16x32_bf16 v[72:75], v[236:239], v[108:111], v[72:75]
    s_waitcnt vmcnt(0)
    v_mfma_f32_16x16x32_bf16 v[76:79], v[240:243], v[96:99], 0
    v_mfma_f32_16x16x32_bf16 v[76:79], v[244:247], v[100:103], v[76:79]
    v_mfma_f32_16x16x32_bf16 v[76:79], v[248:251], v[104:107], v[76:79]
    v_mfma_f32_16x16x32_bf16 v[76:79], v[252:255], v[108:111], v[76:79]
    s_mov_b32 s96, 1040356334
    v_lshrrev_b32 v5, 2, v3
    v_lshlrev_b32 v5, 15, v5
    v_lshl_add_u32 v5, v4, 4, v5
    s_lshl_b32 s54, s52, 10
    s_lshl_b32 s55, s3, 8
    s_add_u32 s54, s54, s55
    s_add_u32 s54, s54, 1048576
    v_mul_f32 v48, s96, v48
    v_mul_f32 v49, s96, v49
    v_mul_f32 v50, s96, v50
    v_mul_f32 v51, s96, v51
    v_mul_f32 v52, s96, v52
    v_mul_f32 v53, s96, v53
    v_mul_f32 v54, s96, v54
    v_mul_f32 v55, s96, v55
    v_mul_f32 v56, s96, v56
    v_mul_f32 v57, s96, v57
    v_mul_f32 v58, s96, v58
    v_mul_f32 v59, s96, v59
    v_mul_f32 v60, s96, v60
    v_mul_f32 v61, s96, v61
    v_mul_f32 v62, s96, v62
    v_mul_f32 v63, s96, v63
    v_mul_f32 v64, s96, v64
    v_mul_f32 v65, s96, v65
    v_mul_f32 v66, s96, v66
    v_mul_f32 v67, s96, v67
    v_mul_f32 v68, s96, v68
    v_mul_f32 v69, s96, v69
    v_mul_f32 v70, s96, v70
    v_mul_f32 v71, s96, v71
    v_mul_f32 v72, s96, v72
    v_mul_f32 v73, s96, v73
    v_mul_f32 v74, s96, v74
    v_mul_f32 v75, s96, v75
    v_mul_f32 v76, s96, v76
    v_mul_f32 v77, s96, v77
    v_mul_f32 v78, s96, v78
    v_mul_f32 v79, s96, v79
    v_cvt_pk_bf16_f32 v80, v48, v49
    v_cvt_pk_bf16_f32 v81, v50, v51
    v_cvt_pk_bf16_f32 v82, v52, v53
    v_cvt_pk_bf16_f32 v83, v54, v55
    v_cvt_pk_bf16_f32 v84, v56, v57
    v_cvt_pk_bf16_f32 v85, v58, v59
    v_cvt_pk_bf16_f32 v86, v60, v61
    v_cvt_pk_bf16_f32 v87, v62, v63
    v_cvt_pk_bf16_f32 v88, v64, v65
    v_cvt_pk_bf16_f32 v89, v66, v67
    v_cvt_pk_bf16_f32 v90, v68, v69
    v_cvt_pk_bf16_f32 v91, v70, v71
    v_cvt_pk_bf16_f32 v92, v72, v73
    v_cvt_pk_bf16_f32 v93, v74, v75
    v_cvt_pk_bf16_f32 v94, v76, v77
    v_cvt_pk_bf16_f32 v95, v78, v79
    s_mov_b32 s56, 0x11111111
    s_mov_b32 s57, 0x11111111
    s_mov_b64 exec, s[56:57]
    buffer_store_dwordx4 v[80:83], v5, s[44:47], s54 offen offset:0 sc1
    buffer_store_dwordx4 v[84:87], v5, s[44:47], s54 offen offset:64 sc1
    buffer_store_dwordx4 v[88:91], v5, s[44:47], s54 offen offset:128 sc1
    buffer_store_dwordx4 v[92:95], v5, s[44:47], s54 offen offset:192 sc1
    s_mov_b64 exec, -1
    v_lshlrev_b32 v5, 2, v4
    v_xor_b32 v5, v5, v3
    v_lshlrev_b32 v6, 10, v4
    v_xor_b32 v7, 0, v5
    v_lshl_add_u32 v20, v7, 4, v6
    v_xor_b32 v7, 1, v5
    v_lshl_add_u32 v21, v7, 4, v6
    v_xor_b32 v7, 2, v5
    v_lshl_add_u32 v22, v7, 4, v6
    v_xor_b32 v7, 3, v5
    v_lshl_add_u32 v23, v7, 4, v6
    s_lshl_b32 s58, s2, 19
    s_lshl_b32 s54, s3, 8
    s_add_u32 s58, s58, s54
    s_add_u32 s60, s58, 524288
    s_lshl_b32 s63, s3, 15
    s_mov_b32 s59, s63
    s_add_u32 m0, s59, 0
    s_add_u32 s54, s58, 0
    buffer_load_dwordx4 v20, s[32:35], s54 offen nt lds
    s_add_u32 m0, s59, 1024
    s_add_u32 s54, s58, 4096
    buffer_load_dwordx4 v21, s[32:35], s54 offen nt lds
    s_add_u32 m0, s59, 2048
    s_add_u32 s54, s58, 8192
    buffer_load_dwordx4 v22, s[32:35], s54 offen nt lds
    s_add_u32 m0, s59, 3072
    s_add_u32 s54, s58, 12288
    buffer_load_dwordx4 v23, s[32:35], s54 offen nt lds
    s_add_u32 m0, s59, 4096
    s_add_u32 s54, s58, 16384
    buffer_load_dwordx4 v20, s[32:35], s54 offen nt lds
    s_add_u32 m0, s59, 5120
    s_add_u32 s54, s58, 20480
    buffer_load_dwordx4 v21, s[32:35], s54 offen nt lds
    s_add_u32 m0, s59, 6144
    s_add_u32 s54, s58, 24576
    buffer_load_dwordx4 v22, s[32:35], s54 offen nt lds
    s_add_u32 m0, s59, 7168
    s_add_u32 s54, s58, 28672
    buffer_load_dwordx4 v23, s[32:35], s54 offen nt lds
    s_add_u32 s58, s58, 32768
    s_add_u32 s59, s59, 8192
    s_and_b32 s59, s59, 0x7fff
    s_or_b32 s59, s59, s63
    s_cmp_lt_u32 s58, s60
    s_cselect_b32 s58, s58, 0x1000000
    s_add_u32 m0, s59, 0
    s_add_u32 s54, s58, 0
    buffer_load_dwordx4 v20, s[32:35], s54 offen nt lds
    s_add_u32 m0, s59, 1024
    s_add_u32 s54, s58, 4096
    buffer_load_dwordx4 v21, s[32:35], s54 offen nt lds
    s_add_u32 m0, s59, 2048
    s_add_u32 s54, s58, 8192
    buffer_load_dwordx4 v22, s[32:35], s54 offen nt lds
    s_add_u32 m0, s59, 3072
    s_add_u32 s54, s58, 12288
    buffer_load_dwordx4 v23, s[32:35], s54 offen nt lds
    s_add_u32 m0, s59, 4096
    s_add_u32 s54, s58, 16384
    buffer_load_dwordx4 v20, s[32:35], s54 offen nt lds
    s_add_u32 m0, s59, 5120
    s_add_u32 s54, s58, 20480
    buffer_load_dwordx4 v21, s[32:35], s54 offen nt lds
    s_add_u32 m0, s59, 6144
    s_add_u32 s54, s58, 24576
    buffer_load_dwordx4 v22, s[32:35], s54 offen nt lds
    s_add_u32 m0, s59, 7168
    s_add_u32 s54, s58, 28672
    buffer_load_dwordx4 v23, s[32:35], s54 offen nt lds
    s_add_u32 s58, s58, 32768
    s_add_u32 s59, s59, 8192
    s_and_b32 s59, s59, 0x7fff
    s_or_b32 s59, s59, s63
    s_cmp_lt_u32 s58, s60
    s_cselect_b32 s58, s58, 0x1000000
    s_add_u32 m0, s59, 0
    s_add_u32 s54, s58, 0
    buffer_load_dwordx4 v20, s[32:35], s54 offen nt lds
    s_add_u32 m0, s59, 1024
    s_add_u32 s54, s58, 4096
    buffer_load_dwordx4 v21, s[32:35], s54 offen nt lds
    s_add_u32 m0, s59, 2048
    s_add_u32 s54, s58, 8192
    buffer_load_dwordx4 v22, s[32:35], s54 offen nt lds
    s_add_u32 m0, s59, 3072
    s_add_u32 s54, s58, 12288
    buffer_load_dwordx4 v23, s[32:35], s54 offen nt lds
    s_add_u32 m0, s59, 4096
    s_add_u32 s54, s58, 16384
    buffer_load_dwordx4 v20, s[32:35], s54 offen nt lds
    s_add_u32 m0, s59, 5120
    s_add_u32 s54, s58, 20480
    buffer_load_dwordx4 v21, s[32:35], s54 offen nt lds
    s_add_u32 m0, s59, 6144
    s_add_u32 s54, s58, 24576
    buffer_load_dwordx4 v22, s[32:35], s54 offen nt lds
    s_add_u32 m0, s59, 7168
    s_add_u32 s54, s58, 28672
    buffer_load_dwordx4 v23, s[32:35], s54 offen nt lds
    s_add_u32 s58, s58, 32768
    s_add_u32 s59, s59, 8192
    s_and_b32 s59, s59, 0x7fff
    s_or_b32 s59, s59, s63
    s_cmp_lt_u32 s58, s60
    s_cselect_b32 s58, s58, 0x1000000
    s_waitcnt vmcnt(24)
    s_barrier
    s_cmp_lg_u32 s3, 0
    s_cbranch_scc1 L_nosig_4
    v_mov_b32 v5, 0
    v_mov_b32 v6, 1
    s_mov_b64 exec, 1
    global_atomic_add v5, v6, s[28:29] offset:128
    s_mov_b64 exec, -1
L_nosig_4:
    s_cmp_lg_u32 s3, 0
    s_cbranch_scc1 L_polled_6
    v_mov_b32 v5, 128
L_poll_5:
    global_load_dword v6, v5, s[28:29] sc1
    s_waitcnt vmcnt(0)
    v_cmp_le_u32 vcc, 32, v6
    s_cbranch_vccnz L_polled_6
    s_sleep 2
    s_sub_u32 s101, s101, 1
    s_cbranch_scc0 L_poll_5
    s_mov_b32 s101, 0
L_polled_6:
    s_barrier
    v_and_b32 v24, 31, v1
    v_lshrrev_b32 v25, 5, v1
    v_lshlrev_b32 v5, 10, v24
    v_lshl_add_u32 v5, v25, 4, v5
    s_lshr_b32 s54, s2, 3
    s_lshl_b32 s54, s54, 15
    s_lshl_b32 s55, s3, 8
    s_add_u32 s54, s54, s55
    s_add_u32 s54, s54, 1048576
    buffer_load_dwordx4 a[0:3], v5, s[44:47], s54 offen offset:0 sc1
    buffer_load_dwordx4 a[4:7], v5, s[44:47], s54 offen offset:32 sc1
    buffer_load_dwordx4 a[8:11], v5, s[44:47], s54 offen offset:64 sc1
    buffer_load_dwordx4 a[12:15], v5, s[44:47], s54 offen offset:96 sc1
    buffer_load_dwordx4 a[16:19], v5, s[44:47], s54 offen offset:128 sc1
    buffer_load_dwordx4 a[20:23], v5, s[44:47], s54 offen offset:160 sc1
    buffer_load_dwordx4 a[24:27], v5, s[44:47], s54 offen offset:192 sc1
    buffer_load_dwordx4 a[28:31], v5, s[44:47], s54 offen offset:224 sc1
    v_and_b32 v5, 3, v24
    v_lshlrev_b32 v5, 2, v5
    v_bfe_u32 v6, v24, 2, 2
    v_or_b32 v5, v5, v6
    v_xor_b32 v5, v5, v25
    v_lshlrev_b32 v26, 8, v24
    v_lshl_add_u32 v26, v5, 4, v26
    v_add_u32 v26, s63, v26
    v_bfe_u32 v5, v1, 2, 2
    v_lshl_add_u32 v6, v25, 2, v5
    v_lshlrev_b32 v27, 8, v6
    v_and_b32 v6, 1, v1
    v_lshl_add_u32 v27, v6, 3, v27
    v_bfe_u32 v6, v1, 4, 1
    v_lshlrev_b32 v6, 1, v6
    v_bfe_u32 v7, v1, 1, 1
    v_or_b32 v6, v6, v7
    v_xor_b32 v6, v6, v25
    v_lshl_or_b32 v6, v5, 2, v6
    v_lshl_add_u32 v27, v6, 4, v27
    v_add_u32 v27, s63, v27
    v_add_u32 v29, 131072, v2
    s_lshl_b32 s54, s3, 12
    v_add_u32 v28, s54, v29
    v_mov_b32 v64, 0
    v_mov_b32 v65, 0
    v_mov_b32 v66, 0
    v_mov_b32 v67, 0
    v_mov_b32 v68, 0
    v_mov_b32 v69, 0
    v_mov_b32 v70, 0
    v_mov_b32 v71, 0
    v_mov_b32 v72, 0
    v_mov_b32 v73, 0
    v_mov_b32 v74, 0
    v_mov_b32 v75, 0
    v_mov_b32 v76, 0
    v_mov_b32 v77, 0
    v_mov_b32 v78, 0
    v_mov_b32 v79, 0
    v_mov_b32 v80, 0
    v_mov_b32 v81, 0
    v_mov_b32 v82, 0
    v_mov_b32 v83, 0
    v_mov_b32 v84, 0
    v_mov_b32 v85, 0
    v_mov_b32 v86, 0
    v_mov_b32 v87, 0
    v_mov_b32 v88, 0
    v_mov_b32 v89, 0
    v_mov_b32 v90, 0
    v_mov_b32 v91, 0
    v_mov_b32 v92, 0
    v_mov_b32 v93, 0
    v_mov_b32 v94, 0
    v_mov_b32 v95, 0
    v_mov_b32 v96, 0
    v_mov_b32 v97, 0
    v_mov_b32 v98, 0
    v_mov_b32 v99, 0
    v_mov_b32 v100, 0
    v_mov_b32 v101, 0
    v_mov_b32 v102, 0
    v_mov_b32 v103, 0
    v_mov_b32 v104, 0
    v_mov_b32 v105, 0
    v_mov_b32 v106, 0
    v_mov_b32 v107, 0
    v_mov_b32 v108, 0
    v_mov_b32 v109, 0
    v_mov_b32 v110, 0
    v_mov_b32 v111, 0
    v_mov_b32 v112, 0
    v_mov_b32 v113, 0
    v_mov_b32 v114, 0
    v_mov_b32 v115, 0
    v_mov_b32 v116, 0
    v_mov_b32 v117, 0
    v_mov_b32 v118, 0
    v_mov_b32 v119, 0
    v_mov_b32 v120, 0
    v_mov_b32 v121, 0
    v_mov_b32 v122, 0
    v_mov_b32 v123, 0
    v_mov_b32 v124, 0
    v_mov_b32 v125, 0
    v_mov_b32 v126, 0
    v_mov_b32 v127, 0
    v_mov_b32 v216, 0xff800000
    v_mov_b32 v217, 0
    s_mov_b32 s62, 16
    s_mov_b32 s61, 0
    s_waitcnt vmcnt(0)
L_bloop:
    s_waitcnt vmcnt(16)
    s_add_u32 m0, s59, 0
    s_add_u32 s54, s58, 0
    buffer_load_dwordx4 v20, s[32:35], s54 offen nt lds
    s_add_u32 m0, s59, 1024
    s_add_u32 s54, s58, 4096
    buffer_load_dwordx4 v21, s[32:35], s54 offen nt lds
    s_add_u32 m0, s59, 2048
    s_add_u32 s54, s58, 8192
    buffer_load_dwordx4 v22, s[32:35], s54 offen nt lds
    s_add_u32 m0, s59, 3072
    s_add_u32 s54, s58, 12288
    buffer_load_dwordx4 v23, s[32:35], s54 offen nt lds
    s_add_u32 m0, s59, 4096
    s_add_u32 s54, s58, 16384
    buffer_load_dwordx4 v20, s[32:35], s54 offen nt lds
    s_add_u32 m0, s59, 5120
    s_add_u32 s54, s58, 20480
    buffer_load_dwordx4 v21, s[32:35], s54 offen nt lds
    s_add_u32 m0, s59, 6144
    s_add_u32 s54, s58, 24576
    buffer_load_dwordx4 v22, s[32:35], s54 offen nt lds
    s_add_u32 m0, s59, 7168
    s_add_u32 s54, s58, 28672
    buffer_load_dwordx4 v23, s[32:35], s54 offen nt lds
    s_add_u32 s58, s58, 32768
    s_add_u32 s59, s59, 8192
    s_and_b32 s59, s59, 0x7fff
    s_or_b32 s59, s59, s63
    s_cmp_lt_u32 s58, s60
    s_cselect_b32 s58, s58, 0x1000000
    v_add_u32 v30, s61, v26
    v_add_u32 v31, s61, v27
    ds_read_b128 a[32:35], v30
    v_xor_b32 v33, 32, v30
    ds_read_b128 a[36:39], v33
    v_xor_b32 v34, 64, v30
    ds_read_b128 a[40:43], v34
    v_xor_b32 v35, 96, v30
    ds_read_b128 a[44:47], v35
    v_xor_b32 v36, 128, v30
    ds_read_b128 a[48:51], v36
    v_xor_b32 v37, 160, v30
    ds_read_b128 a[52:55], v37
    v_xor_b32 v38, 192, v30
    ds_read_b128 a[56:59], v38
    v_xor_b32 v39, 224, v30
    ds_read_b128 a[60:63], v39
    s_waitcnt lgkmcnt(7)
    v_mfma_f32_32x32x16_bf16 v[128:143], a[32:35], a[0:3], 0
    s_waitcnt lgkmcnt(6)
    v_mfma_f32_32x32x16_bf16 v[128:143], a[36:39], a[4:7], v[128:143]
    s_waitcnt lgkmcnt(5)
    v_mfma_f32_32x32x16_bf16 v[128:143], a[40:43], a[8:11], v[128:143]
    s_waitcnt lgkmcnt(4)
    v_mfma_f32_32x32x16_bf16 v[128:143], a[44:47], a[12:15], v[128:143]
    s_waitcnt lgkmcnt(3)
    v_mfma_f32_32x32x16_bf16 v[128:143], a[48:51], a[16:19], v[128:143]
    s_waitcnt lgkmcnt(2)
    v_mfma_f32_32x32x16_bf16 v[128:143], a[52:55], a[20:23], v[128:143]
    s_waitcnt lgkmcnt(1)
    v_mfma_f32_32x32x16_bf16 v[128:143], a[56:59], a[24:27], v[128:143]
    s_waitcnt lgkmcnt(0)
    v_mfma_f32_32x32x16_bf16 v[128:143], a[60:63], a[28:31], v[128:143]
    ds_read_b64_tr_b16 a[64:65], v31 offset:0
    ds_read_b64_tr_b16 a[68:69], v31 offset:4096
    v_xor_b32 v41, 32, v31
    ds_read_b64_tr_b16 a[66:67], v41 offset:2048
    ds_read_b64_tr_b16 a[70:71], v41 offset:6144
    v_xor_b32 v42, 64, v31
    ds_read_b64_tr_b16 a[72:73], v42 offset:0
    ds_read_b64_tr_b16 a[76:77], v42 offset:4096
    v_xor_b32 v43, 96, v31
    ds_read_b64_tr_b16 a[74:75], v43 offset:2048
    ds_read_b64_tr_b16 a[78:79], v43 offset:6144
    v_xor_b32 v44, 128, v31
    ds_read_b64_tr_b16 a[80:81], v44 offset:0
    ds_read_b64_tr_b16 a[84:85], v44 offset:4096
    v_xor_b32 v45, 160, v31
    ds_read_b64_tr_b16 a[82:83], v45 offset:2048
    ds_read_b64_tr_b16 a[86:87], v45 offset:6144
    v_xor_b32 v46, 192, v31
    ds_read_b64_tr_b16 a[88:89], v46 offset:0
    ds_read_b64_tr_b16 a[92:93], v46 offset:4096
    v_xor_b32 v47, 224, v31
    ds_read_b64_tr_b16 a[90:91], v47 offset:2048
    ds_read_b64_tr_b16 a[94:95], v47 offset:6144
    ds_write_b128 v28, v[128:131] offset:0
    ds_write_b128 v28, v[132:135] offset:1024
    ds_write_b128 v28, v[136:139] offset:2048
    ds_write_b128 v28, v[140:143] offset:3072
    s_waitcnt lgkmcnt(0)
    s_barrier
    ds_read_b128 v[144:147], v29 offset:0
    ds_read_b128 v[148:151], v29 offset:1024
    ds_read_b128 v[152:155], v29 offset:2048
    ds_read_b128 v[156:159], v29 offset:3072
    ds_read_b128 v[160:163], v29 offset:4096
    ds_read_b128 v[164:167], v29 offset:5120
    ds_read_b128 v[168:171], v29 offset:6144
    ds_read_b128 v[172:175], v29 offset:7168
    ds_read_b128 v[176:179], v29 offset:8192
    ds_read_b128 v[180:183], v29 offset:9216
    ds_read_b128 v[184:187], v29 offset:10240
    ds_read_b128 v[188:191], v29 offset:11264
    ds_read_b128 v[192:195], v29 offset:12288
    ds_read_b128 v[196:199], v29 offset:13312
    ds_read_b128 v[200:203], v29 offset:14336
    ds_read_b128 v[204:207], v29 offset:15360
    v_xor_b32 v28, 16384, v28
    v_xor_b32 v29, 16384, v29
    s_add_u32 s61, s61, 8192
    s_and_b32 s61, s61, 0x7fff
    s_waitcnt lgkmcnt(8)
    v_add_f32 v144, v144, v160
    v_add_f32 v145, v145, v161
    v_add_f32 v146, v146, v162
    v_add_f32 v147, v147, v163
    v_add_f32 v148, v148, v164
    v_add_f32 v149, v149, v165
    v_add_f32 v150, v150, v166
    v_add_f32 v151, v151, v167
    v_add_f32 v152, v152, v168
    v_add_f32 v153, v153, v169
    v_add_f32 v154, v154, v170
    v_add_f32 v155, v155, v171
    v_add_f32 v156, v156, v172
    v_add_f32 v157, v157, v173
    v_add_f32 v158, v158, v174
    v_add_f32 v159, v159, v175
    s_waitcnt lgkmcnt(0)
    v_add_f32 v176, v176, v192
    v_add_f32 v177, v177, v193
    v_add_f32 v178, v178, v194
    v_add_f32 v179, v179, v195
    v_add_f32 v180, v180, v196
    v_add_f32 v181, v181, v197
    v_add_f32 v182, v182, v198
    v_add_f32 v183, v183, v199
    v_add_f32 v184, v184, v200
    v_add_f32 v185, v185, v201
    v_add_f32 v186, v186, v202
    v_add_f32 v187, v187, v203
    v_add_f32 v188, v188, v204
    v_add_f32 v189, v189, v205
    v_add_f32 v190, v190, v206
    v_add_f32 v191, v191, v207
    v_add_f32 v144, v144, v176
    v_add_f32 v145, v145, v177
    v_add_f32 v146, v146, v178
    v_add_f32 v147, v147, v179
    v_add_f32 v148, v148, v180
    v_add_f32 v149, v149, v181
    v_add_f32 v150, v150, v182
    v_add_f32 v151, v151, v183
    v_add_f32 v152, v152, v184
    v_add_f32 v153, v153, v185
    v_add_f32 v154, v154, v186
    v_add_f32 v155, v155, v187
    v_add_f32 v156, v156, v188
    v_add_f32 v157, v157, v189
    v_add_f32 v158, v158, v190
    v_add_f32 v159, v159, v191
    v_max3_f32 v218, v144, v145, v146
    v_max3_f32 v219, v147, v148, v149
    v_max3_f32 v220, v150, v151, v152
    v_max3_f32 v221, v153, v154, v155
    v_max3_f32 v218, v218, v156, v157
    v_max3_f32 v219, v219, v158, v159
    v_max3_f32 v218, v218, v219, v220
    v_max_f32 v218, v218, v221
    v_mov_b32 v219, v218
    s_nop 1
    v_permlane32_swap_b32 v218, v219
    v_max3_f32 v218, v218, v219, v216
    v_sub_f32 v220, v216, v218
    v_exp_f32 v220, v220
    v_mov_b32 v216, v218
    v_sub_f32 v144, v144, v218
    v_sub_f32 v145, v145, v218
    v_sub_f32 v146, v146, v218
    v_sub_f32 v147, v147, v218
    v_sub_f32 v148, v148, v218
    v_sub_f32 v149, v149, v218
    v_sub_f32 v150, v150, v218
    v_sub_f32 v151, v151, v218
    v_sub_f32 v152, v152, v218
    v_sub_f32 v153, v153, v218
    v_sub_f32 v154, v154, v218
    v_sub_f32 v155, v155, v218
    v_sub_f32 v156, v156, v218
    v_sub_f32 v157, v157, v218
    v_sub_f32 v158, v158, v218
    v_sub_f32 v159, v159, v218
    v_exp_f32 v144, v144
    v_exp_f32 v145, v145
    v_exp_f32 v146, v146
    v_exp_f32 v147, v147
    v_exp_f32 v148, v148
    v_exp_f32 v149, v149
    v_exp_f32 v150, v150
    v_exp_f32 v151, v151
    v_exp_f32 v152, v152
    v_exp_f32 v153, v153
    v_exp_f32 v154, v154
    v_exp_f32 v155, v155
    v_exp_f32 v156, v156
    v_exp_f32 v157, v157
    v_exp_f32 v158, v158
    v_exp_f32 v159, v159
    v_mul_f32 v217, v217, v220
    v_mul_f32 v64, v64, v220
    v_mul_f32 v65, v65, v220
    v_mul_f32 v66, v66, v220
    v_mul_f32 v67, v67, v220
    v_mul_f32 v68, v68, v220
    v_mul_f32 v69, v69, v220
    v_mul_f32 v70, v70, v220
    v_mul_f32 v71, v71, v220
    v_mul_f32 v72, v72, v220
    v_mul_f32 v73, v73, v220
    v_mul_f32 v74, v74, v220
    v_mul_f32 v75, v75, v220
    v_mul_f32 v76, v76, v220
    v_mul_f32 v77, v77, v220
    v_mul_f32 v78, v78, v220
    v_mul_f32 v79, v79, v220
    v_mul_f32 v80, v80, v220
    v_mul_f32 v81, v81, v220
    v_mul_f32 v82, v82, v220
    v_mul_f32 v83, v83, v220
    v_mul_f32 v84, v84, v220
    v_mul_f32 v85, v85, v220
    v_mul_f32 v86, v86, v220
    v_mul_f32 v87, v87, v220
    v_mul_f32 v88, v88, v220
    v_mul_f32 v89, v89, v220
    v_mul_f32 v90, v90, v220
    v_mul_f32 v91, v91, v220
    v_mul_f32 v92, v92, v220
    v_mul_f32 v93, v93, v220
    v_mul_f32 v94, v94, v220
    v_mul_f32 v95, v95, v220
    v_mul_f32 v96, v96, v220
    v_mul_f32 v97, v97, v220
    v_mul_f32 v98, v98, v220
    v_mul_f32 v99, v99, v220
    v_mul_f32 v100, v100, v220
    v_mul_f32 v101, v101, v220
    v_mul_f32 v102, v102, v220
    v_mul_f32 v103, v103, v220
    v_mul_f32 v104, v104, v220
    v_mul_f32 v105, v105, v220
    v_mul_f32 v106, v106, v220
    v_mul_f32 v107, v107, v220
    v_mul_f32 v108, v108, v220
    v_mul_f32 v109, v109, v220
    v_mul_f32 v110, v110, v220
    v_mul_f32 v111, v111, v220
    v_mul_f32 v112, v112, v220
    v_mul_f32 v113, v113, v220
    v_mul_f32 v114, v114, v220
    v_mul_f32 v115, v115, v220
    v_mul_f32 v116, v116, v220
    v_mul_f32 v117, v117, v220
    v_mul_f32 v118, v118, v220
    v_mul_f32 v119, v119, v220
    v_mul_f32 v120, v120, v220
    v_mul_f32 v121, v121, v220
    v_mul_f32 v122, v122, v220
    v_mul_f32 v123, v123, v220
    v_mul_f32 v124, v124, v220
    v_mul_f32 v125, v125, v220
    v_mul_f32 v126, v126, v220
    v_mul_f32 v127, v127, v220
    v_cvt_pk_bf16_f32 v208, v144, v145
    v_cvt_pk_bf16_f32 v209, v146, v147
    v_cvt_pk_bf16_f32 v210, v148, v149
    v_cvt_pk_bf16_f32 v211, v150, v151
    v_cvt_pk_bf16_f32 v212, v152, v153
    v_cvt_pk_bf16_f32 v213, v154, v155
    v_cvt_pk_bf16_f32 v214, v156, v157
    v_cvt_pk_bf16_f32 v215, v158, v159
    v_mfma_f32_32x32x16_bf16 v[64:79], a[64:67], v[208:211], v[64:79]
    v_mfma_f32_32x32x16_bf16 v[80:95], a[72:75], v[208:211], v[80:95]
    v_mfma_f32_32x32x16_bf16 v[96:111], a[80:83], v[208:211], v[96:111]
    v_mfma_f32_32x32x16_bf16 v[112:127], a[88:91], v[208:211], v[112:127]
    v_mfma_f32_32x32x16_bf16 v[64:79], a[68:71], v[212:215], v[64:79]
    v_mfma_f32_32x32x16_bf16 v[80:95], a[76:79], v[212:215], v[80:95]
    v_mfma_f32_32x32x16_bf16 v[96:111], a[84:87], v[212:215], v[96:111]
    v_mfma_f32_32x32x16_bf16 v[112:127], a[92:95], v[212:215], v[112:127]
    v_add_f32 v160, v144, v145
    v_add_f32 v161, v146, v147
    v_add_f32 v162, v148, v149
    v_add_f32 v163, v150, v151
    v_add_f32 v164, v152, v153
    v_add_f32 v165, v154, v155
    v_add_f32 v166, v156, v157
    v_add_f32 v167, v158, v159
    v_add_f32 v160, v160, v164
    v_add_f32 v161, v161, v165
    v_add_f32 v162, v162, v166
    v_add_f32 v163, v163, v167
    v_add_f32 v160, v160, v161
    v_add_f32 v162, v162, v163
    v_add_f32 v160, v160, v162
    v_add_f32 v217, v217, v160
    s_sub_u32 s62, s62, 1
    s_cmp_lg_u32 s62, 0
    s_cbranch_scc1 L_bloop
    s_waitcnt vmcnt(0)
    v_mov_b32 v219, v217
    s_nop 1
    v_permlane32_swap_b32 v217, v219
    v_add_f32 v217, v217, v219
    v_rcp_f32 v220, v217
    v_mul_u32_u24 v5, 272, v24
    v_lshl_add_u32 v5, v25, 3, v5
    v_add_u32 v5, s63, v5
    v_mul_f32 v64, v64, v220
    v_mul_f32 v65, v65, v220
    v_mul_f32 v66, v66, v220
    v_mul_f32 v67, v67, v220
    v_mul_f32 v68, v68, v220
    v_mul_f32 v69, v69, v220
    v_mul_f32 v70, v70, v220
    v_mul_f32 v71, v71, v220
    v_mul_f32 v72, v72, v220
    v_mul_f32 v73, v73, v220
    v_mul_f32 v74, v74, v220
    v_mul_f32 v75, v75, v220
    v_mul_f32 v76, v76, v220
    v_mul_f32 v77, v77, v220
    v_mul_f32 v78, v78, v220
    v_mul_f32 v79, v79, v220
    v_mul_f32 v80, v80, v220
    v_mul_f32 v81, v81, v220
    v_mul_f32 v82, v82, v220
    v_mul_f32 v83, v83, v220
    v_mul_f32 v84, v84, v220
    v_mul_f32 v85, v85, v220
    v_mul_f32 v86, v86, v220
    v_mul_f32 v87, v87, v220
    v_mul_f32 v88, v88, v220
    v_mul_f32 v89, v89, v220
    v_mul_f32 v90, v90, v220
    v_mul_f32 v91, v91, v220
    v_mul_f32 v92, v92, v220
    v_mul_f32 v93, v93, v220
    v_mul_f32 v94, v94, v220
    v_mul_f32 v95, v95, v220
    v_mul_f32 v96, v96, v220
    v_mul_f32 v97, v97, v220
    v_mul_f32 v98, v98, v220
    v_mul_f32 v99, v99, v220
    v_mul_f32 v100, v100, v220
    v_mul_f32 v101, v101, v220
    v_mul_f32 v102, v102, v220
    v_mul_f32 v103, v103, v220
    v_mul_f32 v104, v104, v220
    v_mul_f32 v105, v105, v220
    v_mul_f32 v106, v106, v220
    v_mul_f32 v107, v107, v220
    v_mul_f32 v108, v108, v220
    v_mul_f32 v109, v109, v220
    v_mul_f32 v110, v110, v220
    v_mul_f32 v111, v111, v220
    v_mul_f32 v112, v112, v220
    v_mul_f32 v113, v113, v220
    v_mul_f32 v114, v114, v220
    v_mul_f32 v115, v115, v220
    v_mul_f32 v116, v116, v220
    v_mul_f32 v117, v117, v220
    v_mul_f32 v118, v118, v220
    v_mul_f32 v119, v119, v220
    v_mul_f32 v120, v120, v220
    v_mul_f32 v121, v121, v220
    v_mul_f32 v122, v122, v220
    v_mul_f32 v123, v123, v220
    v_mul_f32 v124, v124, v220
    v_mul_f32 v125, v125, v220
    v_mul_f32 v126, v126, v220
    v_mul_f32 v127, v127, v220
    v_cvt_pk_bf16_f32 v128, v64, v65
    v_cvt_pk_bf16_f32 v129, v66, v67
    v_cvt_pk_bf16_f32 v130, v68, v69
    v_cvt_pk_bf16_f32 v131, v70, v71
    v_cvt_pk_bf16_f32 v132, v72, v73
    v_cvt_pk_bf16_f32 v133, v74, v75
    v_cvt_pk_bf16_f32 v134, v76, v77
    v_cvt_pk_bf16_f32 v135, v78, v79
    v_cvt_pk_bf16_f32 v136, v80, v81
    v_cvt_pk_bf16_f32 v137, v82, v83
    v_cvt_pk_bf16_f32 v138, v84, v85
    v_cvt_pk_bf16_f32 v139, v86, v87
    v_cvt_pk_bf16_f32 v140, v88, v89
    v_cvt_pk_bf16_f32 v141, v90, v91
    v_cvt_pk_bf16_f32 v142, v92, v93
    v_cvt_pk_bf16_f32 v143, v94, v95
    v_cvt_pk_bf16_f32 v144, v96, v97
    v_cvt_pk_bf16_f32 v145, v98, v99
    v_cvt_pk_bf16_f32 v146, v100, v101
    v_cvt_pk_bf16_f32 v147, v102, v103
    v_cvt_pk_bf16_f32 v148, v104, v105
    v_cvt_pk_bf16_f32 v149, v106, v107
    v_cvt_pk_bf16_f32 v150, v108, v109
    v_cvt_pk_bf16_f32 v151, v110, v111
    v_cvt_pk_bf16_f32 v152, v112, v113
    v_cvt_pk_bf16_f32 v153, v114, v115
    v_cvt_pk_bf16_f32 v154, v116, v117
    v_cvt_pk_bf16_f32 v155, v118, v119
    v_cvt_pk_bf16_f32 v156, v120, v121
    v_cvt_pk_bf16_f32 v157, v122, v123
    v_cvt_pk_bf16_f32 v158, v124, v125
    v_cvt_pk_bf16_f32 v159, v126, v127
    ds_write_b64 v5, v[128:129] offset:0
    ds_write_b64 v5, v[130:131] offset:16
    ds_write_b64 v5, v[132:133] offset:32
    ds_write_b64 v5, v[134:135] offset:48
    ds_write_b64 v5, v[136:137] offset:64
    ds_write_b64 v5, v[138:139] offset:80
    ds_write_b64 v5, v[140:141] offset:96
    ds_write_b64 v5, v[142:143] offset:112
    ds_write_b64 v5, v[144:145] offset:128
    ds_write_b64 v5, v[146:147] offset:144
    ds_write_b64 v5, v[148:149] offset:160
    ds_write_b64 v5, v[150:151] offset:176
    ds_write_b64 v5, v[152:153] offset:192
    ds_write_b64 v5, v[154:155] offset:208
    ds_write_b64 v5, v[156:157] offset:224
    ds_write_b64 v5, v[158:159] offset:240
    v_mul_u32_u24 v6, 272, v4
    v_lshl_add_u32 v6, v3, 4, v6
    v_add_u32 v6, s63, v6
    s_waitcnt lgkmcnt(0)
    ds_read_b128 v[64:67], v6 offset:0
    ds_read_b128 v[68:71], v6 offset:1088
    ds_read_b128 v[72:75], v6 offset:2176
    ds_read_b128 v[76:79], v6 offset:3264
    ds_read_b128 v[80:83], v6 offset:4352
    ds_read_b128 v[84:87], v6 offset:5440
    ds_read_b128 v[88:91], v6 offset:6528
    ds_read_b128 v[92:95], v6 offset:7616
    v_lshlrev_b32 v7, 15, v4
    v_lshl_add_u32 v7, v3, 4, v7
    s_lshl_b32 s54, s2, 10
    s_lshl_b32 s55, s3, 8
    s_add_u32 s54, s54, s55
    s_add_u32 s54, s54, 2097152
    s_waitcnt lgkmcnt(7)
    buffer_store_dwordx4 v[64:67], v7, s[44:47], s54 offen sc1
    s_add_u32 s54, s54, 131072
    s_waitcnt lgkmcnt(6)
    buffer_store_dwordx4 v[68:71], v7, s[44:47], s54 offen sc1
    s_add_u32 s54, s54, 131072
    s_waitcnt lgkmcnt(5)
    buffer_store_dwordx4 v[72:75], v7, s[44:47], s54 offen sc1
    s_add_u32 s54, s54, 131072
    s_waitcnt lgkmcnt(4)
    buffer_store_dwordx4 v[76:79], v7, s[44:47], s54 offen sc1
    s_add_u32 s54, s54, 131072
    s_waitcnt lgkmcnt(3)
    buffer_store_dwordx4 v[80:83], v7, s[44:47], s54 offen sc1
    s_add_u32 s54, s54, 131072
    s_waitcnt lgkmcnt(2)
    buffer_store_dwordx4 v[84:87], v7, s[44:47], s54 offen sc1
    s_add_u32 s54, s54, 131072
    s_waitcnt lgkmcnt(1)
    buffer_store_dwordx4 v[88:91], v7, s[44:47], s54 offen sc1
    s_add_u32 s54, s54, 131072
    s_waitcnt lgkmcnt(0)
    buffer_store_dwordx4 v[92:95], v7, s[44:47], s54 offen sc1
    s_add_u32 s54, s54, 131072
    v_lshlrev_b32 v5, 8, v24
    s_lshl_b32 s54, s2, 3
    s_add_u32 s54, s54, 3145728
    buffer_store_dwordx2 v[216:217], v5, s[44:47], s54 offen sc1
    s_mov_b32 s40, s22
    s_mov_b32 s41, s23
    s_mov_b32 s42, 4194304
    s_mov_b32 s43, 0x20000
    v_lshlrev_b32 v120, 18, v4
    v_lshl_add_u32 v120, v3, 4, v120
    s_lshl_b32 s61, s3, 20
    s_lshl_b32 s54, s52, 8
    s_add_u32 s61, s61, s54
    buffer_load_dwordx4 a[112:115], v120, s[40:43], s61 offen nt
    s_add_u32 s61, s61, 8192
    buffer_load_dwordx4 a[116:119], v120, s[40:43], s61 offen nt
    s_add_u32 s61, s61, 8192
    buffer_load_dwordx4 a[120:123], v120, s[40:43], s61 offen nt
    s_add_u32 s61, s61, 8192
    buffer_load_dwordx4 a[124:127], v120, s[40:43], s61 offen nt
    s_add_u32 s61, s61, 8192
    buffer_load_dwordx4 a[128:131], v120, s[40:43], s61 offen nt
    s_add_u32 s61, s61, 8192
    buffer_load_dwordx4 a[132:135], v120, s[40:43], s61 offen nt
    s_add_u32 s61, s61, 8192
    buffer_load_dwordx4 a[136:139], v120, s[40:43], s61 offen nt
    s_add_u32 s61, s61, 8192
    buffer_load_dwordx4 a[140:143], v120, s[40:43], s61 offen nt
    s_add_u32 s61, s61, 8192
    buffer_load_dwordx4 a[144:147], v120, s[40:43], s61 offen nt
    s_add_u32 s61, s61, 8192
    buffer_load_dwordx4 a[148:151], v120, s[40:43], s61 offen nt
    s_add_u32 s61, s61, 8192
    buffer_load_dwordx4 a[152:155], v120, s[40:43], s61 offen nt
    s_add_u32 s61, s61, 8192
    buffer_load_dwordx4 a[156:159], v120, s[40:43], s61 offen nt
    s_add_u32 s61, s61, 8192
    buffer_load_dwordx4 a[160:163], v120, s[40:43], s61 offen nt
    s_add_u32 s61, s61, 8192
    buffer_load_dwordx4 a[164:167], v120, s[40:43], s61 offen nt
    s_add_u32 s61, s61, 8192
    buffer_load_dwordx4 a[168:171], v120, s[40:43], s61 offen nt
    s_add_u32 s61, s61, 8192
    buffer_load_dwordx4 a[172:175], v120, s[40:43], s61 offen nt
    s_add_u32 s61, s61, 8192
    buffer_load_dwordx4 a[176:179], v120, s[40:43], s61 offen nt
    s_add_u32 s61, s61, 8192
    buffer_load_dwordx4 a[180:183], v120, s[40:43], s61 offen nt
    s_add_u32 s61, s61, 8192
    buffer_load_dwordx4 a[184:187], v120, s[40:43], s61 offen nt
    s_add_u32 s61, s61, 8192
    buffer_load_dwordx4 a[188:191], v120, s[40:43], s61 offen nt
    s_add_u32 s61, s61, 8192
    buffer_load_dwordx4 a[192:195], v120, s[40:43], s61 offen nt
    s_add_u32 s61, s61, 8192
    buffer_load_dwordx4 a[196:199], v120, s[40:43], s61 offen nt
    s_add_u32 s61, s61, 8192
    buffer_load_dwordx4 a[200:203], v120, s[40:43], s61 offen nt
    s_add_u32 s61, s61, 8192
    buffer_load_dwordx4 a[204:207], v120, s[40:43], s61 offen nt
    s_add_u32 s61, s61, 8192
    buffer_load_dwordx4 a[208:211], v120, s[40:43], s61 offen nt
    s_add_u32 s61, s61, 8192
    buffer_load_dwordx4 a[212:215], v120, s[40:43], s61 offen nt
    s_add_u32 s61, s61, 8192
    buffer_load_dwordx4 a[216:219], v120, s[40:43], s61 offen nt
    s_add_u32 s61, s61, 8192
    buffer_load_dwordx4 a[220:223], v120, s[40:43], s61 offen nt
    s_add_u32 s61, s61, 8192
    buffer_load_dwordx4 a[224:227], v120, s[40:43], s61 offen nt
    s_add_u32 s61, s61, 8192
    buffer_load_dwordx4 a[228:231], v120, s[40:43], s61 offen nt
    s_add_u32 s61, s61, 8192
    buffer_load_dwordx4 a[232:235], v120, s[40:43], s61 offen nt
    s_add_u32 s61, s61, 8192
    buffer_load_dwordx4 a[236:239], v120, s[40:43], s61 offen nt
    s_add_u32 s61, s61, 8192
    s_waitcnt vmcnt(32)
    s_barrier
    s_cmp_lg_u32 s3, 0
    s_cbranch_scc1 L_nosig_7
    v_mov_b32 v5, 0
    v_mov_b32 v6, 1
    s_mov_b64 exec, 1
    global_atomic_add v5, v6, s[28:29] offset:192
    s_mov_b64 exec, -1
L_nosig_7:
    s_cmp_lg_u32 s3, 0
    s_cbranch_scc1 L_polled_9
    v_mov_b32 v5, 192
L_poll_8:
    global_load_dword v6, v5, s[28:29] sc1
    s_waitcnt vmcnt(0)
    v_cmp_le_u32 vcc, 32, v6
    s_cbranch_vccnz L_polled_9
    s_sleep 2
    s_sub_u32 s101, s101, 1
    s_cbranch_scc0 L_poll_8
    s_mov_b32 s101, 0
L_polled_9:
    s_barrier
    s_lshl_b32 s54, s52, 2
    s_add_u32 s54, s54, s3
    s_lshl_b32 s55, s54, 6
    s_add_u32 s55, s55, 3145728
    s_lshl_b32 s54, s54, 13
    s_add_u32 s54, s54, 2097152
    s_add_u32 s56, s54, 4096
    v_mov_b32 v5, 0
    buffer_load_dwordx4 v[48:51], v5, s[44:47], s55 offen offset:0 sc1
    buffer_load_dwordx4 v[52:55], v5, s[44:47], s55 offen offset:16 sc1
    buffer_load_dwordx4 v[56:59], v5, s[44:47], s55 offen offset:32 sc1
    buffer_load_dwordx4 v[60:63], v5, s[44:47], s55 offen offset:48 sc1
    buffer_load_dwordx4 v[16:19], v2, s[44:47], s54 offen offset:0 sc1
    buffer_load_dwordx4 v[20:23], v2, s[44:47], s54 offen offset:1024 sc1
    buffer_load_dwordx4 v[24:27], v2, s[44:47], s54 offen offset:2048 sc1
    buffer_load_dwordx4 v[28:31], v2, s[44:47], s54 offen offset:3072 sc1
    buffer_load_dwordx4 v[32:35], v2, s[44:47], s56 offen offset:0 sc1
    buffer_load_dwordx4 v[36:39], v2, s[44:47], s56 offen offset:1024 sc1
    buffer_load_dwordx4 v[40:43], v2, s[44:47], s56 offen offset:2048 sc1
    buffer_load_dwordx4 v[44:47], v2, s[44:47], s56 offen offset:3072 sc1
    s_mov_b32 s36, s24
    s_mov_b32 s37, s25
    s_mov_b32 s38, 4718592
    s_mov_b32 s39, 0x20000
    v_mul_u32_u24 v81, 9216, v4
    v_lshl_add_u32 v80, v3, 4, v81
    v_lshl_add_u32 v81, v3, 2, v81
    s_mul_i32 s100, s52, 147456
    s_lshl_b32 s54, s3, 8
    s_add_u32 s99, s100, s54
    s_and_b32 s54, s3, 1
    s_lshl_b32 s54, s54, 6
    s_add_u32 s100, s100, s54
    s_add_u32 s100, s100, 1024
    s_waitcnt vmcnt(12)
    s_add_u32 s54, s99, 0
    s_add_u32 s55, s100, 0
    buffer_load_dwordx4 v[96:99], v80, s[36:39], s54 offen offset:0 nt
    buffer_load_dwordx4 v[100:103], v80, s[36:39], s54 offen offset:1152 nt
    buffer_load_dwordx4 v[104:107], v80, s[36:39], s54 offen offset:2304 nt
    buffer_load_dwordx4 v[108:111], v80, s[36:39], s54 offen offset:3456 nt
    buffer_load_dword v224, v81, s[36:39], s55 offen offset:0 nt
    buffer_load_dword v225, v81, s[36:39], s55 offen offset:1152 nt
    buffer_load_dword v226, v81, s[36:39], s55 offen offset:2304 nt
    buffer_load_dword v227, v81, s[36:39], s55 offen offset:3456 nt
    s_add_u32 s54, s99, 4608
    s_add_u32 s55, s100, 4608
    buffer_load_dwordx4 v[112:115], v80, s[36:39], s54 offen offset:0 nt
    buffer_load_dwordx4 v[116:119], v80, s[36:39], s54 offen offset:1152 nt
    buffer_load_dwordx4 v[120:123], v80, s[36:39], s54 offen offset:2304 nt
    buffer_load_dwordx4 v[124:127], v80, s[36:39], s54 offen offset:3456 nt
    buffer_load_dword v228, v81, s[36:39], s55 offen offset:0 nt
    buffer_load_dword v229, v81, s[36:39], s55 offen offset:1152 nt
    buffer_load_dword v230, v81, s[36:39], s55 offen offset:2304 nt
    buffer_load_dword v231, v81, s[36:39], s55 offen offset:3456 nt
    s_add_u32 s54, s99, 36864
    s_add_u32 s55, s100, 36864
    buffer_load_dwordx4 v[128:131], v80, s[36:39], s54 offen offset:0 nt
    buffer_load_dwordx4 v[132:135], v80, s[36:39], s54 offen offset:1152 nt
    buffer_load_dwordx4 v[136:139], v80, s[36:39], s54 offen offset:2304 nt
    buffer_load_dwordx4 v[140:143], v80, s[36:39], s54 offen offset:3456 nt
    buffer_load_dword v232, v81, s[36:39], s55 offen offset:0 nt
    buffer_load_dword v233, v81, s[36:39], s55 offen offset:1152 nt
    buffer_load_dword v234, v81, s[36:39], s55 offen offset:2304 nt
    buffer_load_dword v235, v81, s[36:39], s55 offen offset:3456 nt
    s_add_u32 s54, s99, 41472
    s_add_u32 s55, s100, 41472
    buffer_load_dwordx4 v[144:147], v80, s[36:39], s54 offen offset:0 nt
    buffer_load_dwordx4 v[148:151], v80, s[36:39], s54 offen offset:1152 nt
    buffer_load_dwordx4 v[152:155], v80, s[36:39], s54 offen offset:2304 nt
    buffer_load_dwordx4 v[156:159], v80, s[36:39], s54 offen offset:3456 nt
    buffer_load_dword v236, v81, s[36:39], s55 offen offset:0 nt
    buffer_load_dword v237, v81, s[36:39], s55 offen offset:1152 nt
    buffer_load_dword v238, v81, s[36:39], s55 offen offset:2304 nt
    buffer_load_dword v239, v81, s[36:39], s55 offen offset:3456 nt
    s_add_u32 s54, s99, 73728
    s_add_u32 s55, s100, 73728
    buffer_load_dwordx4 v[160:163], v80, s[36:39], s54 offen offset:0 nt
    buffer_load_dwordx4 v[164:167], v80, s[36:39], s54 offen offset:1152 nt
    buffer_load_dwordx4 v[168:171], v80, s[36:39], s54 offen offset:2304 nt
    buffer_load_dwordx4 v[172:175], v80, s[36:39], s54 offen offset:3456 nt
    buffer_load_dword v240, v81, s[36:39], s55 offen offset:0 nt
    buffer_load_dword v241, v81, s[36:39], s55 offen offset:1152 nt
    buffer_load_dword v242, v81, s[36:39], s55 offen offset:2304 nt
    buffer_load_dword v243, v81, s[36:39], s55 offen offset:3456 nt
    s_add_u32 s54, s99, 78336
    s_add_u32 s55, s100, 78336
    buffer_load_dwordx4 v[176:179], v80, s[36:39], s54 offen offset:0 nt
    buffer_load_dwordx4 v[180:183], v80, s[36:39], s54 offen offset:1152 nt
    buffer_load_dwordx4 v[184:187], v80, s[36:39], s54 offen offset:2304 nt
    buffer_load_dwordx4 v[188:191], v80, s[36:39], s54 offen offset:3456 nt
    buffer_load_dword v244, v81, s[36:39], s55 offen offset:0 nt
    buffer_load_dword v245, v81, s[36:39], s55 offen offset:1152 nt
    buffer_load_dword v246, v81, s[36:39], s55 offen offset:2304 nt
    buffer_load_dword v247, v81, s[36:39], s55 offen offset:3456 nt
    s_waitcnt vmcnt(56)
    v_max3_f32 v64, v48, v50, v52
    v_max3_f32 v65, v54, v56, v58
    v_max3_f32 v64, v64, v60, v62
    v_max_f32 v64, v64, v65
    v_sub_f32 v72, v48, v64
    v_sub_f32 v73, v50, v64
    v_sub_f32 v74, v52, v64
    v_sub_f32 v75, v54, v64
    v_sub_f32 v76, v56, v64
    v_sub_f32 v77, v58, v64
    v_sub_f32 v78, v60, v64
    v_sub_f32 v79, v62, v64
    v_exp_f32 v72, v72
    v_exp_f32 v73, v73
    v_exp_f32 v74, v74
    v_exp_f32 v75, v75
    v_exp_f32 v76, v76
    v_exp_f32 v77, v77
    v_exp_f32 v78, v78
    v_exp_f32 v79, v79
    v_mul_f32 v72, v72, v49
    v_mul_f32 v73, v73, v51
    v_mul_f32 v74, v74, v53
    v_mul_f32 v75, v75, v55
    v_mul_f32 v76, v76, v57
    v_mul_f32 v77, v77, v59
    v_mul_f32 v78, v78, v61
    v_mul_f32 v79, v79, v63
    v_add_f32 v64, v72, v73
    v_add_f32 v65, v74, v75
    v_add_f32 v66, v76, v77
    v_add_f32 v67, v78, v79
    v_add_f32 v64, v64, v65
    v_add_f32 v66, v66, v67
    v_add_f32 v64, v64, v66
    v_rcp_f32 v64, v64
    s_nop 0
    v_mul_f32 v72, v72, v64
    v_mul_f32 v73, v73, v64
    v_mul_f32 v74, v74, v64
    v_mul_f32 v75, v75, v64
    v_mul_f32 v76, v76, v64
    v_mul_f32 v77, v77, v64
    v_mul_f32 v78, v78, v64
    v_mul_f32 v79, v79, v64
    s_waitcnt vmcnt(48)
    s_mov_b32 s98, 0xffff0000
    v_lshlrev_b32 v82, 16, v16
    v_and_b32 v83, s98, v16
    v_mul_f32 v64, v82, v72
    v_mul_f32 v65, v83, v72
    v_lshlrev_b32 v82, 16, v17
    v_and_b32 v83, s98, v17
    v_mul_f32 v66, v82, v72
    v_mul_f32 v67, v83, v72
    v_lshlrev_b32 v82, 16, v18
    v_and_b32 v83, s98, v18
    v_mul_f32 v68, v82, v72
    v_mul_f32 v69, v83, v72
    v_lshlrev_b32 v82, 16, v19
    v_and_b32 v83, s98, v19
    v_mul_f32 v70, v82, v72
    v_mul_f32 v71, v83, v72
    v_lshlrev_b32 v82, 16, v20
    v_and_b32 v83, s98, v20
    v_fmac_f32 v64, v82, v73
    v_fmac_f32 v65, v83, v73
    v_lshlrev_b32 v82, 16, v21
    v_and_b32 v83, s98, v21
    v_fmac_f32 v66, v82, v73
    v_fmac_f32 v67, v83, v73
    v_lshlrev_b32 v82, 16, v22
    v_and_b32 v83, s98, v22
    v_fmac_f32 v68, v82, v73
    v_fmac_f32 v69, v83, v73
    v_lshlrev_b32 v82, 16, v23
    v_and_b32 v83, s98, v23
    v_fmac_f32 v70, v82, v73
    v_fmac_f32 v71, v83, v73
    v_lshlrev_b32 v82, 16, v24
    v_and_b32 v83, s98, v24
    v_fmac_f32 v64, v82, v74
    v_fmac_f32 v65, v83, v74
    v_lshlrev_b32 v82, 16, v25
    v_and_b32 v83, s98, v25
    v_fmac_f32 v66, v82, v74
    v_fmac_f32 v67, v83, v74
    v_lshlrev_b32 v82, 16, v26
    v_and_b32 v83, s98, v26
    v_fmac_f32 v68, v82, v74
    v_fmac_f32 v69, v83, v74
    v_lshlrev_b32 v82, 16, v27
    v_and_b32 v83, s98, v27
    v_fmac_f32 v70, v82, v74
    v_fmac_f32 v71, v83, v74
    v_lshlrev_b32 v82, 16, v28
    v_and_b32 v83, s98, v28
    v_fmac_f32 v64, v82, v75
    v_fmac_f32 v65, v83, v75
    v_lshlrev_b32 v82, 16, v29
    v_and_b32 v83, s98, v29
    v_fmac_f32 v66, v82, v75
    v_fmac_f32 v67, v83, v75
    v_lshlrev_b32 v82, 16, v30
    v_and_b32 v83, s98, v30
    v_fmac_f32 v68, v82, v75
    v_fmac_f32 v69, v83, v75
    v_lshlrev_b32 v82, 16, v31
    v_and_b32 v83, s98, v31
    v_fmac_f32 v70, v82, v75
    v_fmac_f32 v71, v83, v75
    v_lshlrev_b32 v82, 16, v32
    v_and_b32 v83, s98, v32
    v_fmac_f32 v64, v82, v76
    v_fmac_f32 v65, v83, v76
    v_lshlrev_b32 v82, 16, v33
    v_and_b32 v83, s98, v33
    v_fmac_f32 v66, v82, v76
    v_fmac_f32 v67, v83, v76
    v_lshlrev_b32 v82, 16, v34
    v_and_b32 v83, s98, v34
    v_fmac_f32 v68, v82, v76
    v_fmac_f32 v69, v83, v76
    v_lshlrev_b32 v82, 16, v35
    v_and_b32 v83, s98, v35
    v_fmac_f32 v70, v82, v76
    v_fmac_f32 v71, v83, v76
    v_lshlrev_b32 v82, 16, v36
    v_and_b32 v83, s98, v36
    v_fmac_f32 v64, v82, v77
    v_fmac_f32 v65, v83, v77
    v_lshlrev_b32 v82, 16, v37
    v_and_b32 v83, s98, v37
    v_fmac_f32 v66, v82, v77
    v_fmac_f32 v67, v83, v77
    v_lshlrev_b32 v82, 16, v38
    v_and_b32 v83, s98, v38
    v_fmac_f32 v68, v82, v77
    v_fmac_f32 v69, v83, v77
    v_lshlrev_b32 v82, 16, v39
    v_and_b32 v83, s98, v39
    v_fmac_f32 v70, v82, v77
    v_fmac_f32 v71, v83, v77
    v_lshlrev_b32 v82, 16, v40
    v_and_b32 v83, s98, v40
    v_fmac_f32 v64, v82, v78
    v_fmac_f32 v65, v83, v78
    v_lshlrev_b32 v82, 16, v41
    v_and_b32 v83, s98, v41
    v_fmac_f32 v66, v82, v78
    v_fmac_f32 v67, v83, v78
    v_lshlrev_b32 v82, 16, v42
    v_and_b32 v83, s98, v42
    v_fmac_f32 v68, v82, v78
    v_fmac_f32 v69, v83, v78
    v_lshlrev_b32 v82, 16, v43
    v_and_b32 v83, s98, v43
    v_fmac_f32 v70, v82, v78
    v_fmac_f32 v71, v83, v78
    v_lshlrev_b32 v82, 16, v44
    v_and_b32 v83, s98, v44
    v_fmac_f32 v64, v82, v79
    v_fmac_f32 v65, v83, v79
    v_lshlrev_b32 v82, 16, v45
    v_and_b32 v83, s98, v45
    v_fmac_f32 v66, v82, v79
    v_fmac_f32 v67, v83, v79
    v_lshlrev_b32 v82, 16, v46
    v_and_b32 v83, s98, v46
    v_fmac_f32 v68, v82, v79
    v_fmac_f32 v69, v83, v79
    v_lshlrev_b32 v82, 16, v47
    v_and_b32 v83, s98, v47
    v_fmac_f32 v70, v82, v79
    v_fmac_f32 v71, v83, v79
    v_cvt_pk_bf16_f32 v84, v64, v65
    v_cvt_pk_bf16_f32 v85, v66, v67
    v_cvt_pk_bf16_f32 v86, v68, v69
    v_cvt_pk_bf16_f32 v87, v70, v71
    s_lshl_b32 s54, s3, 10
    v_add_u32 v5, s54, v2
    ds_write_b128 v5, v[84:87]
    s_waitcnt vmcnt(40)
    s_add_u32 s54, s99, 110592
    s_add_u32 s55, s100, 110592
    buffer_load_dwordx4 v[192:195], v80, s[36:39], s54 offen offset:0 nt
    buffer_load_dwordx4 v[196:199], v80, s[36:39], s54 offen offset:1152 nt
    buffer_load_dwordx4 v[200:203], v80, s[36:39], s54 offen offset:2304 nt
    buffer_load_dwordx4 v[204:207], v80, s[36:39], s54 offen offset:3456 nt
    buffer_load_dword v248, v81, s[36:39], s55 offen offset:0 nt
    buffer_load_dword v249, v81, s[36:39], s55 offen offset:1152 nt
    buffer_load_dword v250, v81, s[36:39], s55 offen offset:2304 nt
    buffer_load_dword v251, v81, s[36:39], s55 offen offset:3456 nt
    s_add_u32 s54, s99, 115200
    s_add_u32 s55, s100, 115200
    buffer_load_dwordx4 v[208:211], v80, s[36:39], s54 offen offset:0 nt
    buffer_load_dwordx4 v[212:215], v80, s[36:39], s54 offen offset:1152 nt
    buffer_load_dwordx4 v[216:219], v80, s[36:39], s54 offen offset:2304 nt
    buffer_load_dwordx4 v[220:223], v80, s[36:39], s54 offen offset:3456 nt
    buffer_load_dword v252, v81, s[36:39], s55 offen offset:0 nt
    buffer_load_dword v253, v81, s[36:39], s55 offen offset:1152 nt
    buffer_load_dword v254, v81, s[36:39], s55 offen offset:2304 nt
    buffer_load_dword v255, v81, s[36:39], s55 offen offset:3456 nt
    s_waitcnt lgkmcnt(0)
    s_barrier
    v_lshrrev_b32 v5, 3, v3
    v_lshlrev_b32 v5, 10, v5
    v_lshl_add_u32 v5, v4, 6, v5
    s_lshl_b32 s54, s3, 8
    v_add_u32 v5, s54, v5
    ds_read_b128 v[16:19], v5 offset:0
    ds_read_b128 v[20:23], v5 offset:16
    ds_read_b128 v[24:27], v5 offset:32
    ds_read_b128 v[28:31], v5 offset:48
    ds_read_b128 v[32:35], v5 offset:2048
    ds_read_b128 v[36:39], v5 offset:2064
    ds_read_b128 v[40:43], v5 offset:2080
    ds_read_b128 v[44:47], v5 offset:2096
    s_waitcnt lgkmcnt(0)
    v_perm_b32 v48, v16, v16, v8
    v_perm_b32 v49, v16, v16, v10
    v_perm_b32 v50, v16, v16, v12
    v_perm_b32 v51, v16, v16, v14
    s_nop 1
    v_mfma_f32_16x16x32_bf16 v[64:67], v[48:51], a[112:115], 0
    v_perm_b32 v52, v32, v32, v8
    v_perm_b32 v53, v32, v32, v10
    v_perm_b32 v54, v32, v32, v12
    v_perm_b32 v55, v32, v32, v14
    s_nop 1
    v_mfma_f32_16x16x32_bf16 v[68:71], v[52:55], a[112:115], 0
    v_perm_b32 v56, v16, v16, v9
    v_perm_b32 v57, v16, v16, v11
    v_perm_b32 v58, v16, v16, v13
    v_perm_b32 v59, v16, v16, v15
    s_nop 1
    v_mfma_f32_16x16x32_bf16 v[64:67], v[56:59], a[116:119], v[64:67]
    v_perm_b32 v60, v32, v32, v9
    v_perm_b32 v61, v32, v32, v11
    v_perm_b32 v62, v32, v32, v13
    v_perm_b32 v63, v32, v32, v15
    s_nop 1
    v_mfma_f32_16x16x32_bf16 v[68:71], v[60:63], a[116:119], v[68:71]
    v_perm_b32 v48, v17, v17, v8
    v_perm_b32 v49, v17, v17, v10
    v_perm_b32 v50, v17, v17, v12
    v_perm_b32 v51, v17, v17, v14
    s_nop 1
    v_mfma_f32_16x16x32_bf16 v[64:67], v[48:51], a[120:123], v[64:67]
    v_perm_b32 v52, v33, v33, v8
    v_perm_b32 v53, v33, v33, v10
    v_perm_b32 v54, v33, v33, v12
    v_perm_b32 v55, v33, v33, v14
    s_nop 1
    v_mfma_f32_16x16x32_bf16 v[68:71], v[52:55], a[120:123], v[68:71]
    v_perm_b32 v56, v17, v17, v9
    v_perm_b32 v57, v17, v17, v11
    v_perm_b32 v58, v17, v17, v13
    v_perm_b32 v59, v17, v17, v15
    s_nop 1
    v_mfma_f32_16x16x32_bf16 v[64:67], v[56:59], a[124:127], v[64:67]
    v_perm_b32 v60, v33, v33, v9
    v_perm_b32 v61, v33, v33, v11
    v_perm_b32 v62, v33, v33, v13
    v_perm_b32 v63, v33, v33, v15
    s_nop 1
    v_mfma_f32_16x16x32_bf16 v[68:71], v[60:63], a[124:127], v[68:71]
    v_perm_b32 v48, v18, v18, v8
    v_perm_b32 v49, v18, v18, v10
    v_perm_b32 v50, v18, v18, v12
    v_perm_b32 v51, v18, v18, v14
    s_nop 1
    v_mfma_f32_16x16x32_bf16 v[64:67], v[48:51], a[128:131], v[64:67]
    v_perm_b32 v52, v34, v34, v8
    v_perm_b32 v53, v34, v34, v10
    v_perm_b32 v54, v34, v34, v12
    v_perm_b32 v55, v34, v34, v14
    s_nop 1
    v_mfma_f32_16x16x32_bf16 v[68:71], v[52:55], a[128:131], v[68:71]
    v_perm_b32 v56, v18, v18, v9
    v_perm_b32 v57, v18, v18, v11
    v_perm_b32 v58, v18, v18, v13
    v_perm_b32 v59, v18, v18, v15
    s_nop 1
    v_mfma_f32_16x16x32_bf16 v[64:67], v[56:59], a[132:135], v[64:67]
    v_perm_b32 v60, v34, v34, v9
    v_perm_b32 v61, v34, v34, v11
    v_perm_b32 v62, v34, v34, v13
    v_perm_b32 v63, v34, v34, v15
    s_nop 1
    v_mfma_f32_16x16x32_bf16 v[68:71], v[60:63], a[132:135], v[68:71]
    v_perm_b32 v48, v19, v19, v8
    v_perm_b32 v49, v19, v19, v10
    v_perm_b32 v50, v19, v19, v12
    v_perm_b32 v51, v19, v19, v14
    s_nop 1
    v_mfma_f32_16x16x32_bf16 v[64:67], v[48:51], a[136:139], v[64:67]
    v_perm_b32 v52, v35, v35, v8
    v_perm_b32 v53, v35, v35, v10
    v_perm_b32 v54, v35, v35, v12
    v_perm_b32 v55, v35, v35, v14
    s_nop 1
    v_mfma_f32_16x16x32_bf16 v[68:71], v[52:55], a[136:139], v[68:71]
    v_perm_b32 v56, v19, v19, v9
    v_perm_b32 v57, v19, v19, v11
    v_perm_b32 v58, v19, v19, v13
    v_perm_b32 v59, v19, v19, v15
    s_nop 1
    v_mfma_f32_16x16x32_bf16 v[64:67], v[56:59], a[140:143], v[64:67]
    v_perm_b32 v60, v35, v35, v9
    v_perm_b32 v61, v35, v35, v11
    v_perm_b32 v62, v35, v35, v13
    v_perm_b32 v63, v35, v35, v15
    s_nop 1
    v_mfma_f32_16x16x32_bf16 v[68:71], v[60:63], a[140:143], v[68:71]
    v_perm_b32 v48, v20, v20, v8
    v_perm_b32 v49, v20, v20, v10
    v_perm_b32 v50, v20, v20, v12
    v_perm_b32 v51, v20, v20, v14
    s_nop 1
    v_mfma_f32_16x16x32_bf16 v[64:67], v[48:51], a[144:147], v[64:67]
    v_perm_b32 v52, v36, v36, v8
    v_perm_b32 v53, v36, v36, v10
    v_perm_b32 v54, v36, v36, v12
    v_perm_b32 v55, v36, v36, v14
    s_nop 1
    v_mfma_f32_16x16x32_bf16 v[68:71], v[52:55], a[144:147], v[68:71]
    v_perm_b32 v56, v20, v20, v9
    v_perm_b32 v57, v20, v20, v11
    v_perm_b32 v58, v20, v20, v13
    v_perm_b32 v59, v20, v20, v15
    s_nop 1
    v_mfma_f32_16x16x32_bf16 v[64:67], v[56:59], a[148:151], v[64:67]
    v_perm_b32 v60, v36, v36, v9
    v_perm_b32 v61, v36, v36, v11
    v_perm_b32 v62, v36, v36, v13
    v_perm_b32 v63, v36, v36, v15
    s_nop 1
    v_mfma_f32_16x16x32_bf16 v[68:71], v[60:63], a[148:151], v[68:71]
    v_perm_b32 v48, v21, v21, v8
    v_perm_b32 v49, v21, v21, v10
    v_perm_b32 v50, v21, v21, v12
    v_perm_b32 v51, v21, v21, v14
    s_nop 1
    v_mfma_f32_16x16x32_bf16 v[64:67], v[48:51], a[152:155], v[64:67]
    v_perm_b32 v52, v37, v37, v8
    v_perm_b32 v53, v37, v37, v10
    v_perm_b32 v54, v37, v37, v12
    v_perm_b32 v55, v37, v37, v14
    s_nop 1
    v_mfma_f32_16x16x32_bf16 v[68:71], v[52:55], a[152:155], v[68:71]
    v_perm_b32 v56, v21, v21, v9
    v_perm_b32 v57, v21, v21, v11
    v_perm_b32 v58, v21, v21, v13
    v_perm_b32 v59, v21, v21, v15
    s_nop 1
    v_mfma_f32_16x16x32_bf16 v[64:67], v[56:59], a[156:159], v[64:67]
    v_perm_b32 v60, v37, v37, v9
    v_perm_b32 v61, v37, v37, v11
    v_perm_b32 v62, v37, v37, v13
    v_perm_b32 v63, v37, v37, v15
    s_nop 1
    v_mfma_f32_16x16x32_bf16 v[68:71], v[60:63], a[156:159], v[68:71]
    v_perm_b32 v48, v22, v22, v8
    v_perm_b32 v49, v22, v22, v10
    v_perm_b32 v50, v22, v22, v12
    v_perm_b32 v51, v22, v22, v14
    s_nop 1
    v_mfma_f32_16x16x32_bf16 v[64:67], v[48:51], a[160:163], v[64:67]
    v_perm_b32 v52, v38, v38, v8
    v_perm_b32 v53, v38, v38, v10
    v_perm_b32 v54, v38, v38, v12
    v_perm_b32 v55, v38, v38, v14
    s_nop 1
    v_mfma_f32_16x16x32_bf16 v[68:71], v[52:55], a[160:163], v[68:71]
    v_perm_b32 v56, v22, v22, v9
    v_perm_b32 v57, v22, v22, v11
    v_perm_b32 v58, v22, v22, v13
    v_perm_b32 v59, v22, v22, v15
    s_nop 1
    v_mfma_f32_16x16x32_bf16 v[64:67], v[56:59], a[164:167], v[64:67]
    v_perm_b32 v60, v38, v38, v9
    v_perm_b32 v61, v38, v38, v11
    v_perm_b32 v62, v38, v38, v13
    v_perm_b32 v63, v38, v38, v15
    s_nop 1
    v_mfma_f32_16x16x32_bf16 v[68:71], v[60:63], a[164:167], v[68:71]
    v_perm_b32 v48, v23, v23, v8
    v_perm_b32 v49, v23, v23, v10
    v_perm_b32 v50, v23, v23, v12
    v_perm_b32 v51, v23, v23, v14
    s_nop 1
    v_mfma_f32_16x16x32_bf16 v[64:67], v[48:51], a[168:171], v[64:67]
    v_perm_b32 v52, v39, v39, v8
    v_perm_b32 v53, v39, v39, v10
    v_perm_b32 v54, v39, v39, v12
    v_perm_b32 v55, v39, v39, v14
    s_nop 1
    v_mfma_f32_16x16x32_bf16 v[68:71], v[52:55], a[168:171], v[68:71]
    v_perm_b32 v56, v23, v23, v9
    v_perm_b32 v57, v23, v23, v11
    v_perm_b32 v58, v23, v23, v13
    v_perm_b32 v59, v23, v23, v15
    s_nop 1
    v_mfma_f32_16x16x32_bf16 v[64:67], v[56:59], a[172:175], v[64:67]
    v_perm_b32 v60, v39, v39, v9
    v_perm_b32 v61, v39, v39, v11
    v_perm_b32 v62, v39, v39, v13
    v_perm_b32 v63, v39, v39, v15
    s_nop 1
    v_mfma_f32_16x16x32_bf16 v[68:71], v[60:63], a[172:175], v[68:71]
    v_perm_b32 v48, v24, v24, v8
    v_perm_b32 v49, v24, v24, v10
    v_perm_b32 v50, v24, v24, v12
    v_perm_b32 v51, v24, v24, v14
    s_nop 1
    v_mfma_f32_16x16x32_bf16 v[64:67], v[48:51], a[176:179], v[64:67]
    v_perm_b32 v52, v40, v40, v8
    v_perm_b32 v53, v40, v40, v10
    v_perm_b32 v54, v40, v40, v12
    v_perm_b32 v55, v40, v40, v14
    s_nop 1
    v_mfma_f32_16x16x32_bf16 v[68:71], v[52:55], a[176:179], v[68:71]
    v_perm_b32 v56, v24, v24, v9
    v_perm_b32 v57, v24, v24, v11
    v_perm_b32 v58, v24, v24, v13
    v_perm_b32 v59, v24, v24, v15
    s_nop 1
    v_mfma_f32_16x16x32_bf16 v[64:67], v[56:59], a[180:183], v[64:67]
    v_perm_b32 v60, v40, v40, v9
    v_perm_b32 v61, v40, v40, v11
    v_perm_b32 v62, v40, v40, v13
    v_perm_b32 v63, v40, v40, v15
    s_nop 1
    v_mfma_f32_16x16x32_bf16 v[68:71], v[60:63], a[180:183], v[68:71]
    v_perm_b32 v48, v25, v25, v8
    v_perm_b32 v49, v25, v25, v10
    v_perm_b32 v50, v25, v25, v12
    v_perm_b32 v51, v25, v25, v14
    s_nop 1
    v_mfma_f32_16x16x32_bf16 v[64:67], v[48:51], a[184:187], v[64:67]
    v_perm_b32 v52, v41, v41, v8
    v_perm_b32 v53, v41, v41, v10
    v_perm_b32 v54, v41, v41, v12
    v_perm_b32 v55, v41, v41, v14
    s_nop 1
    v_mfma_f32_16x16x32_bf16 v[68:71], v[52:55], a[184:187], v[68:71]
    v_perm_b32 v56, v25, v25, v9
    v_perm_b32 v57, v25, v25, v11
    v_perm_b32 v58, v25, v25, v13
    v_perm_b32 v59, v25, v25, v15
    s_nop 1
    v_mfma_f32_16x16x32_bf16 v[64:67], v[56:59], a[188:191], v[64:67]
    v_perm_b32 v60, v41, v41, v9
    v_perm_b32 v61, v41, v41, v11
    v_perm_b32 v62, v41, v41, v13
    v_perm_b32 v63, v41, v41, v15
    s_nop 1
    v_mfma_f32_16x16x32_bf16 v[68:71], v[60:63], a[188:191], v[68:71]
    v_perm_b32 v48, v26, v26, v8
    v_perm_b32 v49, v26, v26, v10
    v_perm_b32 v50, v26, v26, v12
    v_perm_b32 v51, v26, v26, v14
    s_nop 1
    v_mfma_f32_16x16x32_bf16 v[64:67], v[48:51], a[192:195], v[64:67]
    v_perm_b32 v52, v42, v42, v8
    v_perm_b32 v53, v42, v42, v10
    v_perm_b32 v54, v42, v42, v12
    v_perm_b32 v55, v42, v42, v14
    s_nop 1
    v_mfma_f32_16x16x32_bf16 v[68:71], v[52:55], a[192:195], v[68:71]
    v_perm_b32 v56, v26, v26, v9
    v_perm_b32 v57, v26, v26, v11
    v_perm_b32 v58, v26, v26, v13
    v_perm_b32 v59, v26, v26, v15
    s_nop 1
    v_mfma_f32_16x16x32_bf16 v[64:67], v[56:59], a[196:199], v[64:67]
    v_perm_b32 v60, v42, v42, v9
    v_perm_b32 v61, v42, v42, v11
    v_perm_b32 v62, v42, v42, v13
    v_perm_b32 v63, v42, v42, v15
    s_nop 1
    v_mfma_f32_16x16x32_bf16 v[68:71], v[60:63], a[196:199], v[68:71]
    v_perm_b32 v48, v27, v27, v8
    v_perm_b32 v49, v27, v27, v10
    v_perm_b32 v50, v27, v27, v12
    v_perm_b32 v51, v27, v27, v14
    s_nop 1
    v_mfma_f32_16x16x32_bf16 v[64:67], v[48:51], a[200:203], v[64:67]
    v_perm_b32 v52, v43, v43, v8
    v_perm_b32 v53, v43, v43, v10
    v_perm_b32 v54, v43, v43, v12
    v_perm_b32 v55, v43, v43, v14
    s_nop 1
    v_mfma_f32_16x16x32_bf16 v[68:71], v[52:55], a[200:203], v[68:71]
    v_perm_b32 v56, v27, v27, v9
    v_perm_b32 v57, v27, v27, v11
    v_perm_b32 v58, v27, v27, v13
    v_perm_b32 v59, v27, v27, v15
    s_nop 1
    v_mfma_f32_16x16x32_bf16 v[64:67], v[56:59], a[204:207], v[64:67]
    v_perm_b32 v60, v43, v43, v9
    v_perm_b32 v61, v43, v43, v11
    v_perm_b32 v62, v43, v43, v13
    v_perm_b32 v63, v43, v43, v15
    s_nop 1
    v_mfma_f32_16x16x32_bf16 v[68:71], v[60:63], a[204:207], v[68:71]
    v_perm_b32 v48, v28, v28, v8
    v_perm_b32 v49, v28, v28, v10
    v_perm_b32 v50, v28, v28, v12
    v_perm_b32 v51, v28, v28, v14
    s_nop 1
    v_mfma_f32_16x16x32_bf16 v[64:67], v[48:51], a[208:211], v[64:67]
    v_perm_b32 v52, v44, v44, v8
    v_perm_b32 v53, v44, v44, v10
    v_perm_b32 v54, v44, v44, v12
    v_perm_b32 v55, v44, v44, v14
    s_nop 1
    v_mfma_f32_16x16x32_bf16 v[68:71], v[52:55], a[208:211], v[68:71]
    v_perm_b32 v56, v28, v28, v9
    v_perm_b32 v57, v28, v28, v11
    v_perm_b32 v58, v28, v28, v13
    v_perm_b32 v59, v28, v28, v15
    s_nop 1
    v_mfma_f32_16x16x32_bf16 v[64:67], v[56:59], a[212:215], v[64:67]
    v_perm_b32 v60, v44, v44, v9
    v_perm_b32 v61, v44, v44, v11
    v_perm_b32 v62, v44, v44, v13
    v_perm_b32 v63, v44, v44, v15
    s_nop 1
    v_mfma_f32_16x16x32_bf16 v[68:71], v[60:63], a[212:215], v[68:71]
    v_perm_b32 v48, v29, v29, v8
    v_perm_b32 v49, v29, v29, v10
    v_perm_b32 v50, v29, v29, v12
    v_perm_b32 v51, v29, v29, v14
    s_nop 1
    v_mfma_f32_16x16x32_bf16 v[64:67], v[48:51], a[216:219], v[64:67]
    v_perm_b32 v52, v45, v45, v8
    v_perm_b32 v53, v45, v45, v10
    v_perm_b32 v54, v45, v45, v12
    v_perm_b32 v55, v45, v45, v14
    s_nop 1
    v_mfma_f32_16x16x32_bf16 v[68:71], v[52:55], a[216:219], v[68:71]
    v_perm_b32 v56, v29, v29, v9
    v_perm_b32 v57, v29, v29, v11
    v_perm_b32 v58, v29, v29, v13
    v_perm_b32 v59, v29, v29, v15
    s_nop 1
    v_mfma_f32_16x16x32_bf16 v[64:67], v[56:59], a[220:223], v[64:67]
    v_perm_b32 v60, v45, v45, v9
    v_perm_b32 v61, v45, v45, v11
    v_perm_b32 v62, v45, v45, v13
    v_perm_b32 v63, v45, v45, v15
    s_nop 1
    v_mfma_f32_16x16x32_bf16 v[68:71], v[60:63], a[220:223], v[68:71]
    v_perm_b32 v48, v30, v30, v8
    v_perm_b32 v49, v30, v30, v10
    v_perm_b32 v50, v30, v30, v12
    v_perm_b32 v51, v30, v30, v14
    s_nop 1
    v_mfma_f32_16x16x32_bf16 v[64:67], v[48:51], a[224:227], v[64:67]
    v_perm_b32 v52, v46, v46, v8
    v_perm_b32 v53, v46, v46, v10
    v_perm_b32 v54, v46, v46, v12
    v_perm_b32 v55, v46, v46, v14
    s_nop 1
    v_mfma_f32_16x16x32_bf16 v[68:71], v[52:55], a[224:227], v[68:71]
    v_perm_b32 v56, v30, v30, v9
    v_perm_b32 v57, v30, v30, v11
    v_perm_b32 v58, v30, v30, v13
    v_perm_b32 v59, v30, v30, v15
    s_nop 1
    v_mfma_f32_16x16x32_bf16 v[64:67], v[56:59], a[228:231], v[64:67]
    v_perm_b32 v60, v46, v46, v9
    v_perm_b32 v61, v46, v46, v11
    v_perm_b32 v62, v46, v46, v13
    v_perm_b32 v63, v46, v46, v15
    s_nop 1
    v_mfma_f32_16x16x32_bf16 v[68:71], v[60:63], a[228:231], v[68:71]
    v_perm_b32 v48, v31, v31, v8
    v_perm_b32 v49, v31, v31, v10
    v_perm_b32 v50, v31, v31, v12
    v_perm_b32 v51, v31, v31, v14
    s_nop 1
    v_mfma_f32_16x16x32_bf16 v[64:67], v[48:51], a[232:235], v[64:67]
    v_perm_b32 v52, v47, v47, v8
    v_perm_b32 v53, v47, v47, v10
    v_perm_b32 v54, v47, v47, v12
    v_perm_b32 v55, v47, v47, v14
    s_nop 1
    v_mfma_f32_16x16x32_bf16 v[68:71], v[52:55], a[232:235], v[68:71]
    v_perm_b32 v56, v31, v31, v9
    v_perm_b32 v57, v31, v31, v11
    v_perm_b32 v58, v31, v31, v13
    v_perm_b32 v59, v31, v31, v15
    s_nop 1
    v_mfma_f32_16x16x32_bf16 v[64:67], v[56:59], a[236:239], v[64:67]
    v_perm_b32 v60, v47, v47, v9
    v_perm_b32 v61, v47, v47, v11
    v_perm_b32 v62, v47, v47, v13
    v_perm_b32 v63, v47, v47, v15
    s_nop 1
    v_mfma_f32_16x16x32_bf16 v[68:71], v[60:63], a[236:239], v[68:71]
    v_lshrrev_b32 v5, 1, v4
    v_lshlrev_b32 v5, 9, v5
    v_lshl_add_u32 v5, v3, 5, v5
    v_and_b32 v6, 1, v4
    v_lshl_add_u32 v5, v6, 4, v5
    s_lshl_b32 s54, s3, 11
    s_add_u32 s54, s54, 131072
    v_add_u32 v5, s54, v5
    ds_write_b128 v5, v[64:67]
    ds_write_b128 v5, v[68:71] offset:1024
    s_waitcnt lgkmcnt(0)
    s_barrier
    v_lshrrev_b32 v5, 2, v3
    v_lshlrev_b32 v5, 9, v5
    v_lshl_add_u32 v5, v4, 5, v5
    v_add_u32 v5, 131072, v5
    ds_read_b128 v[16:19], v5 offset:0
    ds_read_b128 v[20:23], v5 offset:16
    ds_read_b128 v[24:27], v5 offset:2048
    ds_read_b128 v[28:31], v5 offset:2064
    ds_read_b128 v[32:35], v5 offset:4096
    ds_read_b128 v[36:39], v5 offset:4112
    ds_read_b128 v[40:43], v5 offset:6144
    ds_read_b128 v[44:47], v5 offset:6160
    s_waitcnt lgkmcnt(0)
    v_add_f32 v16, v16, v24
    v_add_f32 v32, v32, v40
    v_add_f32 v17, v17, v25
    v_add_f32 v33, v33, v41
    v_add_f32 v18, v18, v26
    v_add_f32 v34, v34, v42
    v_add_f32 v19, v19, v27
    v_add_f32 v35, v35, v43
    v_add_f32 v20, v20, v28
    v_add_f32 v36, v36, v44
    v_add_f32 v21, v21, v29
    v_add_f32 v37, v37, v45
    v_add_f32 v22, v22, v30
    v_add_f32 v38, v38, v46
    v_add_f32 v23, v23, v31
    v_add_f32 v39, v39, v47
    v_add_f32 v16, v16, v32
    v_add_f32 v17, v17, v33
    v_add_f32 v18, v18, v34
    v_add_f32 v19, v19, v35
    v_add_f32 v20, v20, v36
    v_add_f32 v21, v21, v37
    v_add_f32 v22, v22, v38
    v_add_f32 v23, v23, v39
    v_cvt_pk_bf16_f32 v48, v16, v17
    v_cvt_pk_bf16_f32 v49, v18, v19
    v_cvt_pk_bf16_f32 v50, v20, v21
    v_cvt_pk_bf16_f32 v51, v22, v23
    ds_read_b128 v[16:19], v5 offset:128
    ds_read_b128 v[20:23], v5 offset:144
    ds_read_b128 v[24:27], v5 offset:2176
    ds_read_b128 v[28:31], v5 offset:2192
    ds_read_b128 v[32:35], v5 offset:4224
    ds_read_b128 v[36:39], v5 offset:4240
    ds_read_b128 v[40:43], v5 offset:6272
    ds_read_b128 v[44:47], v5 offset:6288
    s_waitcnt lgkmcnt(0)
    v_add_f32 v16, v16, v24
    v_add_f32 v32, v32, v40
    v_add_f32 v17, v17, v25
    v_add_f32 v33, v33, v41
    v_add_f32 v18, v18, v26
    v_add_f32 v34, v34, v42
    v_add_f32 v19, v19, v27
    v_add_f32 v35, v35, v43
    v_add_f32 v20, v20, v28
    v_add_f32 v36, v36, v44
    v_add_f32 v21, v21, v29
    v_add_f32 v37, v37, v45
    v_add_f32 v22, v22, v30
    v_add_f32 v38, v38, v46
    v_add_f32 v23, v23, v31
    v_add_f32 v39, v39, v47
    v_add_f32 v16, v16, v32
    v_add_f32 v17, v17, v33
    v_add_f32 v18, v18, v34
    v_add_f32 v19, v19, v35
    v_add_f32 v20, v20, v36
    v_add_f32 v21, v21, v37
    v_add_f32 v22, v22, v38
    v_add_f32 v23, v23, v39
    v_cvt_pk_bf16_f32 v52, v16, v17
    v_cvt_pk_bf16_f32 v53, v18, v19
    v_cvt_pk_bf16_f32 v54, v20, v21
    v_cvt_pk_bf16_f32 v55, v22, v23
    ds_read_b128 v[16:19], v5 offset:256
    ds_read_b128 v[20:23], v5 offset:272
    ds_read_b128 v[24:27], v5 offset:2304
    ds_read_b128 v[28:31], v5 offset:2320
    ds_read_b128 v[32:35], v5 offset:4352
    ds_read_b128 v[36:39], v5 offset:4368
    ds_read_b128 v[40:43], v5 offset:6400
    ds_read_b128 v[44:47], v5 offset:6416
    s_waitcnt lgkmcnt(0)
    v_add_f32 v16, v16, v24
    v_add_f32 v32, v32, v40
    v_add_f32 v17, v17, v25
    v_add_f32 v33, v33, v41
    v_add_f32 v18, v18, v26
    v_add_f32 v34, v34, v42
    v_add_f32 v19, v19, v27
    v_add_f32 v35, v35, v43
    v_add_f32 v20, v20, v28
    v_add_f32 v36, v36, v44
    v_add_f32 v21, v21, v29
    v_add_f32 v37, v37, v45
    v_add_f32 v22, v22, v30
    v_add_f32 v38, v38, v46
    v_add_f32 v23, v23, v31
    v_add_f32 v39, v39, v47
    v_add_f32 v16, v16, v32
    v_add_f32 v17, v17, v33
    v_add_f32 v18, v18, v34
    v_add_f32 v19, v19, v35
    v_add_f32 v20, v20, v36
    v_add_f32 v21, v21, v37
    v_add_f32 v22, v22, v38
    v_add_f32 v23, v23, v39
    v_cvt_pk_bf16_f32 v56, v16, v17
    v_cvt_pk_bf16_f32 v57, v18, v19
    v_cvt_pk_bf16_f32 v58, v20, v21
    v_cvt_pk_bf16_f32 v59, v22, v23
    ds_read_b128 v[16:19], v5 offset:384
    ds_read_b128 v[20:23], v5 offset:400
    ds_read_b128 v[24:27], v5 offset:2432
    ds_read_b128 v[28:31], v5 offset:2448
    ds_read_b128 v[32:35], v5 offset:4480
    ds_read_b128 v[36:39], v5 offset:4496
    ds_read_b128 v[40:43], v5 offset:6528
    ds_read_b128 v[44:47], v5 offset:6544
    s_waitcnt lgkmcnt(0)
    v_add_f32 v16, v16, v24
    v_add_f32 v32, v32, v40
    v_add_f32 v17, v17, v25
    v_add_f32 v33, v33, v41
    v_add_f32 v18, v18, v26
    v_add_f32 v34, v34, v42
    v_add_f32 v19, v19, v27
    v_add_f32 v35, v35, v43
    v_add_f32 v20, v20, v28
    v_add_f32 v36, v36, v44
    v_add_f32 v21, v21, v29
    v_add_f32 v37, v37, v45
    v_add_f32 v22, v22, v30
    v_add_f32 v38, v38, v46
    v_add_f32 v23, v23, v31
    v_add_f32 v39, v39, v47
    v_add_f32 v16, v16, v32
    v_add_f32 v17, v17, v33
    v_add_f32 v18, v18, v34
    v_add_f32 v19, v19, v35
    v_add_f32 v20, v20, v36
    v_add_f32 v21, v21, v37
    v_add_f32 v22, v22, v38
    v_add_f32 v23, v23, v39
    v_cvt_pk_bf16_f32 v60, v16, v17
    v_cvt_pk_bf16_f32 v61, v18, v19
    v_cvt_pk_bf16_f32 v62, v20, v21
    v_cvt_pk_bf16_f32 v63, v22, v23
    s_waitcnt vmcnt(0)
    s_mov_b32 s54, 0x05040100
    s_mov_b32 s55, 0x07060302
    v_perm_b32 v64, v100, v96, s54
    v_perm_b32 v65, v108, v104, s54
    v_perm_b32 v66, v116, v112, s54
    v_perm_b32 v67, v124, v120, s54
    v_perm_b32 v68, v100, v96, s55
    v_perm_b32 v69, v108, v104, s55
    v_perm_b32 v70, v116, v112, s55
    v_perm_b32 v71, v124, v120, s55
    v_perm_b32 v72, v101, v97, s54
    v_perm_b32 v73, v109, v105, s54
    v_perm_b32 v74, v117, v113, s54
    v_perm_b32 v75, v125, v121, s54
    v_perm_b32 v76, v101, v97, s55
    v_perm_b32 v77, v109, v105, s55
    v_perm_b32 v78, v117, v113, s55
    v_perm_b32 v79, v125, v121, s55
    v_perm_b32 v80, v102, v98, s54
    v_perm_b32 v81, v110, v106, s54
    v_perm_b32 v82, v118, v114, s54
    v_perm_b32 v83, v126, v122, s54
    v_perm_b32 v84, v102, v98, s55
    v_perm_b32 v85, v110, v106, s55
    v_perm_b32 v86, v118, v114, s55
    v_perm_b32 v87, v126, v122, s55
    v_perm_b32 v88, v103, v99, s54
    v_perm_b32 v89, v111, v107, s54
    v_perm_b32 v90, v119, v115, s54
    v_perm_b32 v91, v127, v123, s54
    v_perm_b32 v92, v103, v99, s55
    v_perm_b32 v93, v111, v107, s55
    v_perm_b32 v94, v119, v115, s55
    v_perm_b32 v95, v127, v123, s55
    v_perm_b32 v96, v132, v128, s54
    v_perm_b32 v97, v140, v136, s54
    v_perm_b32 v98, v148, v144, s54
    v_perm_b32 v99, v156, v152, s54
    v_perm_b32 v100, v132, v128, s55
    v_perm_b32 v101, v140, v136, s55
    v_perm_b32 v102, v148, v144, s55
    v_perm_b32 v103, v156, v152, s55
    v_perm_b32 v104, v133, v129, s54
    v_perm_b32 v105, v141, v137, s54
    v_perm_b32 v106, v149, v145, s54
    v_perm_b32 v107, v157, v153, s54
    v_perm_b32 v108, v133, v129, s55
    v_perm_b32 v109, v141, v137, s55
    v_perm_b32 v110, v149, v145, s55
    v_perm_b32 v111, v157, v153, s55
    v_perm_b32 v112, v134, v130, s54
    v_perm_b32 v113, v142, v138, s54
    v_perm_b32 v114, v150, v146, s54
    v_perm_b32 v115, v158, v154, s54
    v_perm_b32 v116, v134, v130, s55
    v_perm_b32 v117, v142, v138, s55
    v_perm_b32 v118, v150, v146, s55
    v_perm_b32 v119, v158, v154, s55
    v_perm_b32 v120, v135, v131, s54
    v_perm_b32 v121, v143, v139, s54
    v_perm_b32 v122, v151, v147, s54
    v_perm_b32 v123, v159, v155, s54
    v_perm_b32 v124, v135, v131, s55
    v_perm_b32 v125, v143, v139, s55
    v_perm_b32 v126, v151, v147, s55
    v_perm_b32 v127, v159, v155, s55
    v_perm_b32 v128, v164, v160, s54
    v_perm_b32 v129, v172, v168, s54
    v_perm_b32 v130, v180, v176, s54
    v_perm_b32 v131, v188, v184, s54
    v_perm_b32 v132, v164, v160, s55
    v_perm_b32 v133, v172, v168, s55
    v_perm_b32 v134, v180, v176, s55
    v_perm_b32 v135, v188, v184, s55
    v_perm_b32 v136, v165, v161, s54
    v_perm_b32 v137, v173, v169, s54
    v_perm_b32 v138, v181, v177, s54
    v_perm_b32 v139, v189, v185, s54
    v_perm_b32 v140, v165, v161, s55
    v_perm_b32 v141, v173, v169, s55
    v_perm_b32 v142, v181, v177, s55
    v_perm_b32 v143, v189, v185, s55
    v_perm_b32 v144, v166, v162, s54
    v_perm_b32 v145, v174, v170, s54
    v_perm_b32 v146, v182, v178, s54
    v_perm_b32 v147, v190, v186, s54
    v_perm_b32 v148, v166, v162, s55
    v_perm_b32 v149, v174, v170, s55
    v_perm_b32 v150, v182, v178, s55
    v_perm_b32 v151, v190, v186, s55
    v_perm_b32 v152, v167, v163, s54
    v_perm_b32 v153, v175, v171, s54
    v_perm_b32 v154, v183, v179, s54
    v_perm_b32 v155, v191, v187, s54
    v_perm_b32 v156, v167, v163, s55
    v_perm_b32 v157, v175, v171, s55
    v_perm_b32 v158, v183, v179, s55
    v_perm_b32 v159, v191, v187, s55
    v_perm_b32 v160, v196, v192, s54
    v_perm_b32 v161, v204, v200, s54
    v_perm_b32 v162, v212, v208, s54
    v_perm_b32 v163, v220, v216, s54
    v_perm_b32 v164, v196, v192, s55
    v_perm_b32 v165, v204, v200, s55
    v_perm_b32 v166, v212, v208, s55
    v_perm_b32 v167, v220, v216, s55
    v_perm_b32 v168, v197, v193, s54
    v_perm_b32 v169, v205, v201, s54
    v_perm_b32 v170, v213, v209, s54
    v_perm_b32 v171, v221, v217, s54
    v_perm_b32 v172, v197, v193, s55
    v_perm_b32 v173, v205, v201, s55
    v_perm_b32 v174, v213, v209, s55
    v_perm_b32 v175, v221, v217, s55
    v_perm_b32 v176, v198, v194, s54
    v_perm_b32 v177, v206, v202, s54
    v_perm_b32 v178, v214, v210, s54
    v_perm_b32 v179, v222, v218, s54
    v_perm_b32 v180, v198, v194, s55
    v_perm_b32 v181, v206, v202, s55
    v_perm_b32 v182, v214, v210, s55
    v_perm_b32 v183, v222, v218, s55
    v_perm_b32 v184, v199, v195, s54
    v_perm_b32 v185, v207, v203, s54
    v_perm_b32 v186, v215, v211, s54
    v_perm_b32 v187, v223, v219, s54
    v_perm_b32 v188, v199, v195, s55
    v_perm_b32 v189, v207, v203, s55
    v_perm_b32 v190, v215, v211, s55
    v_perm_b32 v191, v223, v219, s55
    v_perm_b32 v192, v225, v224, s54
    v_perm_b32 v193, v227, v226, s54
    v_perm_b32 v194, v229, v228, s54
    v_perm_b32 v195, v231, v230, s54
    v_perm_b32 v196, v225, v224, s55
    v_perm_b32 v197, v227, v226, s55
    v_perm_b32 v198, v229, v228, s55
    v_perm_b32 v199, v231, v230, s55
    v_perm_b32 v200, v233, v232, s54
    v_perm_b32 v201, v235, v234, s54
    v_perm_b32 v202, v237, v236, s54
    v_perm_b32 v203, v239, v238, s54
    v_perm_b32 v204, v233, v232, s55
    v_perm_b32 v205, v235, v234, s55
    v_perm_b32 v206, v237, v236, s55
    v_perm_b32 v207, v239, v238, s55
    v_perm_b32 v208, v241, v240, s54
    v_perm_b32 v209, v243, v242, s54
    v_perm_b32 v210, v245, v244, s54
    v_perm_b32 v211, v247, v246, s54
    v_perm_b32 v212, v241, v240, s55
    v_perm_b32 v213, v243, v242, s55
    v_perm_b32 v214, v245, v244, s55
    v_perm_b32 v215, v247, v246, s55
    v_perm_b32 v216, v249, v248, s54
    v_perm_b32 v217, v251, v250, s54
    v_perm_b32 v218, v253, v252, s54
    v_perm_b32 v219, v255, v254, s54
    v_perm_b32 v220, v249, v248, s55
    v_perm_b32 v221, v251, v250, s55
    v_perm_b32 v222, v253, v252, s55
    v_perm_b32 v223, v255, v254, s55
    v_mfma_f32_16x16x32_bf16 v[224:227], v[48:51], v[64:67], 0
    v_mfma_f32_16x16x32_bf16 v[228:231], v[48:51], v[68:71], 0
    v_mfma_f32_16x16x32_bf16 v[232:235], v[48:51], v[72:75], 0
    v_mfma_f32_16x16x32_bf16 v[236:239], v[48:51], v[76:79], 0
    v_mfma_f32_16x16x32_bf16 v[240:243], v[48:51], v[80:83], 0
    v_mfma_f32_16x16x32_bf16 v[244:247], v[48:51], v[84:87], 0
    v_mfma_f32_16x16x32_bf16 v[248:251], v[48:51], v[88:91], 0
    v_mfma_f32_16x16x32_bf16 v[252:255], v[48:51], v[92:95], 0
    v_mfma_f32_16x16x32_bf16 v[40:43], v[48:51], v[192:195], 0
    v_mfma_f32_16x16x32_bf16 v[44:47], v[48:51], v[196:199], 0
    v_mfma_f32_16x16x32_bf16 v[224:227], v[52:55], v[96:99], v[224:227]
    v_mfma_f32_16x16x32_bf16 v[228:231], v[52:55], v[100:103], v[228:231]
    v_mfma_f32_16x16x32_bf16 v[232:235], v[52:55], v[104:107], v[232:235]
    v_mfma_f32_16x16x32_bf16 v[236:239], v[52:55], v[108:111], v[236:239]
    v_mfma_f32_16x16x32_bf16 v[240:243], v[52:55], v[112:115], v[240:243]
    v_mfma_f32_16x16x32_bf16 v[244:247], v[52:55], v[116:119], v[244:247]
    v_mfma_f32_16x16x32_bf16 v[248:251], v[52:55], v[120:123], v[248:251]
    v_mfma_f32_16x16x32_bf16 v[252:255], v[52:55], v[124:127], v[252:255]
    v_mfma_f32_16x16x32_bf16 v[40:43], v[52:55], v[200:203], v[40:43]
    v_mfma_f32_16x16x32_bf16 v[44:47], v[52:55], v[204:207], v[44:47]
    v_mfma_f32_16x16x32_bf16 v[224:227], v[56:59], v[128:131], v[224:227]
    v_mfma_f32_16x16x32_bf16 v[228:231], v[56:59], v[132:135], v[228:231]
    v_mfma_f32_16x16x32_bf16 v[232:235], v[56:59], v[136:139], v[232:235]
    v_mfma_f32_16x16x32_bf16 v[236:239], v[56:59], v[140:143], v[236:239]
    v_mfma_f32_16x16x32_bf16 v[240:243], v[56:59], v[144:147], v[240:243]
    v_mfma_f32_16x16x32_bf16 v[244:247], v[56:59], v[148:151], v[244:247]
    v_mfma_f32_16x16x32_bf16 v[248:251], v[56:59], v[152:155], v[248:251]
    v_mfma_f32_16x16x32_bf16 v[252:255], v[56:59], v[156:159], v[252:255]
    v_mfma_f32_16x16x32_bf16 v[40:43], v[56:59], v[208:211], v[40:43]
    v_mfma_f32_16x16x32_bf16 v[44:47], v[56:59], v[212:215], v[44:47]
    v_mfma_f32_16x16x32_bf16 v[224:227], v[60:63], v[160:163], v[224:227]
    v_mfma_f32_16x16x32_bf16 v[228:231], v[60:63], v[164:167], v[228:231]
    v_mfma_f32_16x16x32_bf16 v[232:235], v[60:63], v[168:171], v[232:235]
    v_mfma_f32_16x16x32_bf16 v[236:239], v[60:63], v[172:175], v[236:239]
    v_mfma_f32_16x16x32_bf16 v[240:243], v[60:63], v[176:179], v[240:243]
    v_mfma_f32_16x16x32_bf16 v[244:247], v[60:63], v[180:183], v[244:247]
    v_mfma_f32_16x16x32_bf16 v[248:251], v[60:63], v[184:187], v[248:251]
    v_mfma_f32_16x16x32_bf16 v[252:255], v[60:63], v[188:191], v[252:255]
    v_mfma_f32_16x16x32_bf16 v[40:43], v[60:63], v[216:219], v[40:43]
    v_mfma_f32_16x16x32_bf16 v[44:47], v[60:63], v[220:223], v[44:47]
    v_mul_u32_u24 v7, 73728, v4
    v_lshrrev_b32 v5, 3, v3
    v_lshl_add_u32 v6, v5, 13, v7
    v_and_b32 v5, 7, v3
    v_lshl_add_u32 v6, v5, 4, v6
    v_lshl_add_u32 v7, v3, 3, v7
    v_add_u32 v7, 65536, v7
    s_lshl_b32 s56, s52, 7
    s_add_u32 s56, s56, 4718592
    s_lshl_b32 s54, s3, 14
    s_add_u32 s54, s54, s56
    s_add_u32 s55, s54, 4096
    s_and_b32 s57, s3, 1
    s_lshl_b32 s57, s57, 12
    s_add_u32 s56, s56, s57
    v_min_u32 v16, -2, v224
    v_min_u32 v17, -2, v228
    v_min_u32 v18, -2, v232
    v_min_u32 v19, -2, v236
    v_min_u32 v20, -2, v240
    v_min_u32 v21, -2, v244
    v_min_u32 v22, -2, v248
    v_min_u32 v23, -2, v252
    v_min_u32 v24, -2, v40
    v_min_u32 v25, -2, v44
    buffer_store_dwordx4 v[16:19], v6, s[44:47], s54 offen sc1
    buffer_store_dwordx4 v[20:23], v6, s[44:47], s55 offen sc1
    buffer_store_dwordx2 v[24:25], v7, s[44:47], s56 offen sc1
    s_mov_b32 s36, s12
    s_mov_b32 s37, s13
    s_mov_b32 s38, 4718592
    s_mov_b32 s39, 0x20000
    v_mul_u32_u24 v81, 9216, v4
    v_lshl_add_u32 v80, v3, 4, v81
    v_lshl_add_u32 v81, v3, 2, v81
    s_mul_i32 s100, s52, 147456
    s_lshl_b32 s54, s3, 8
    s_add_u32 s99, s100, s54
    s_and_b32 s54, s3, 1
    s_lshl_b32 s54, s54, 6
    s_add_u32 s100, s100, s54
    s_add_u32 s100, s100, 1024
    s_add_u32 s54, s99, 0
    s_add_u32 s55, s100, 0
    buffer_load_dwordx4 v[96:99], v80, s[36:39], s54 offen offset:0 nt
    buffer_load_dwordx4 v[100:103], v80, s[36:39], s54 offen offset:1152 nt
    buffer_load_dwordx4 v[104:107], v80, s[36:39], s54 offen offset:2304 nt
    buffer_load_dwordx4 v[108:111], v80, s[36:39], s54 offen offset:3456 nt
    buffer_load_dword v224, v81, s[36:39], s55 offen offset:0 nt
    buffer_load_dword v225, v81, s[36:39], s55 offen offset:1152 nt
    buffer_load_dword v226, v81, s[36:39], s55 offen offset:2304 nt
    buffer_load_dword v227, v81, s[36:39], s55 offen offset:3456 nt
    s_add_u32 s54, s99, 4608
    s_add_u32 s55, s100, 4608
    buffer_load_dwordx4 v[112:115], v80, s[36:39], s54 offen offset:0 nt
    buffer_load_dwordx4 v[116:119], v80, s[36:39], s54 offen offset:1152 nt
    buffer_load_dwordx4 v[120:123], v80, s[36:39], s54 offen offset:2304 nt
    buffer_load_dwordx4 v[124:127], v80, s[36:39], s54 offen offset:3456 nt
    buffer_load_dword v228, v81, s[36:39], s55 offen offset:0 nt
    buffer_load_dword v229, v81, s[36:39], s55 offen offset:1152 nt
    buffer_load_dword v230, v81, s[36:39], s55 offen offset:2304 nt
    buffer_load_dword v231, v81, s[36:39], s55 offen offset:3456 nt
    s_add_u32 s54, s99, 36864
    s_add_u32 s55, s100, 36864
    buffer_load_dwordx4 v[128:131], v80, s[36:39], s54 offen offset:0 nt
    buffer_load_dwordx4 v[132:135], v80, s[36:39], s54 offen offset:1152 nt
    buffer_load_dwordx4 v[136:139], v80, s[36:39], s54 offen offset:2304 nt
    buffer_load_dwordx4 v[140:143], v80, s[36:39], s54 offen offset:3456 nt
    buffer_load_dword v232, v81, s[36:39], s55 offen offset:0 nt
    buffer_load_dword v233, v81, s[36:39], s55 offen offset:1152 nt
    buffer_load_dword v234, v81, s[36:39], s55 offen offset:2304 nt
    buffer_load_dword v235, v81, s[36:39], s55 offen offset:3456 nt
    s_add_u32 s54, s99, 41472
    s_add_u32 s55, s100, 41472
    buffer_load_dwordx4 v[144:147], v80, s[36:39], s54 offen offset:0 nt
    buffer_load_dwordx4 v[148:151], v80, s[36:39], s54 offen offset:1152 nt
    buffer_load_dwordx4 v[152:155], v80, s[36:39], s54 offen offset:2304 nt
    buffer_load_dwordx4 v[156:159], v80, s[36:39], s54 offen offset:3456 nt
    buffer_load_dword v236, v81, s[36:39], s55 offen offset:0 nt
    buffer_load_dword v237, v81, s[36:39], s55 offen offset:1152 nt
    buffer_load_dword v238, v81, s[36:39], s55 offen offset:2304 nt
    buffer_load_dword v239, v81, s[36:39], s55 offen offset:3456 nt
    s_add_u32 s54, s99, 73728
    s_add_u32 s55, s100, 73728
    buffer_load_dwordx4 v[160:163], v80, s[36:39], s54 offen offset:0 nt
    buffer_load_dwordx4 v[164:167], v80, s[36:39], s54 offen offset:1152 nt
    buffer_load_dwordx4 v[168:171], v80, s[36:39], s54 offen offset:2304 nt
    buffer_load_dwordx4 v[172:175], v80, s[36:39], s54 offen offset:3456 nt
    buffer_load_dword v240, v81, s[36:39], s55 offen offset:0 nt
    buffer_load_dword v241, v81, s[36:39], s55 offen offset:1152 nt
    buffer_load_dword v242, v81, s[36:39], s55 offen offset:2304 nt
    buffer_load_dword v243, v81, s[36:39], s55 offen offset:3456 nt
    s_add_u32 s54, s99, 78336
    s_add_u32 s55, s100, 78336
    buffer_load_dwordx4 v[176:179], v80, s[36:39], s54 offen offset:0 nt
    buffer_load_dwordx4 v[180:183], v80, s[36:39], s54 offen offset:1152 nt
    buffer_load_dwordx4 v[184:187], v80, s[36:39], s54 offen offset:2304 nt
    buffer_load_dwordx4 v[188:191], v80, s[36:39], s54 offen offset:3456 nt
    buffer_load_dword v244, v81, s[36:39], s55 offen offset:0 nt
    buffer_load_dword v245, v81, s[36:39], s55 offen offset:1152 nt
    buffer_load_dword v246, v81, s[36:39], s55 offen offset:2304 nt
    buffer_load_dword v247, v81, s[36:39], s55 offen offset:3456 nt
    s_waitcnt vmcnt(40)
    s_add_u32 s54, s99, 110592
    s_add_u32 s55, s100, 110592
    buffer_load_dwordx4 v[192:195], v80, s[36:39], s54 offen offset:0 nt
    buffer_load_dwordx4 v[196:199], v80, s[36:39], s54 offen offset:1152 nt
    buffer_load_dwordx4 v[200:203], v80, s[36:39], s54 offen offset:2304 nt
    buffer_load_dwordx4 v[204:207], v80, s[36:39], s54 offen offset:3456 nt
    buffer_load_dword v248, v81, s[36:39], s55 offen offset:0 nt
    buffer_load_dword v249, v81, s[36:39], s55 offen offset:1152 nt
    buffer_load_dword v250, v81, s[36:39], s55 offen offset:2304 nt
    buffer_load_dword v251, v81, s[36:39], s55 offen offset:3456 nt
    s_add_u32 s54, s99, 115200
    s_add_u32 s55, s100, 115200
    buffer_load_dwordx4 v[208:211], v80, s[36:39], s54 offen offset:0 nt
    buffer_load_dwordx4 v[212:215], v80, s[36:39], s54 offen offset:1152 nt
    buffer_load_dwordx4 v[216:219], v80, s[36:39], s54 offen offset:2304 nt
    buffer_load_dwordx4 v[220:223], v80, s[36:39], s54 offen offset:3456 nt
    buffer_load_dword v252, v81, s[36:39], s55 offen offset:0 nt
    buffer_load_dword v253, v81, s[36:39], s55 offen offset:1152 nt
    buffer_load_dword v254, v81, s[36:39], s55 offen offset:2304 nt
    buffer_load_dword v255, v81, s[36:39], s55 offen offset:3456 nt
    s_waitcnt vmcnt(0)
    s_mov_b32 s54, 0x05040100
    s_mov_b32 s55, 0x07060302
    v_perm_b32 v64, v100, v96, s54
    v_perm_b32 v65, v108, v104, s54
    v_perm_b32 v66, v116, v112, s54
    v_perm_b32 v67, v124, v120, s54
    v_perm_b32 v68, v100, v96, s55
    v_perm_b32 v69, v108, v104, s55
    v_perm_b32 v70, v116, v112, s55
    v_perm_b32 v71, v124, v120, s55
    v_perm_b32 v72, v101, v97, s54
    v_perm_b32 v73, v109, v105, s54
    v_perm_b32 v74, v117, v113, s54
    v_perm_b32 v75, v125, v121, s54
    v_perm_b32 v76, v101, v97, s55
    v_perm_b32 v77, v109, v105, s55
    v_perm_b32 v78, v117, v113, s55
    v_perm_b32 v79, v125, v121, s55
    v_perm_b32 v80, v102, v98, s54
    v_perm_b32 v81, v110, v106, s54
    v_perm_b32 v82, v118, v114, s54
    v_perm_b32 v83, v126, v122, s54
    v_perm_b32 v84, v102, v98, s55
    v_perm_b32 v85, v110, v106, s55
    v_perm_b32 v86, v118, v114, s55
    v_perm_b32 v87, v126, v122, s55
    v_perm_b32 v88, v103, v99, s54
    v_perm_b32 v89, v111, v107, s54
    v_perm_b32 v90, v119, v115, s54
    v_perm_b32 v91, v127, v123, s54
    v_perm_b32 v92, v103, v99, s55
    v_perm_b32 v93, v111, v107, s55
    v_perm_b32 v94, v119, v115, s55
    v_perm_b32 v95, v127, v123, s55
    v_perm_b32 v96, v132, v128, s54
    v_perm_b32 v97, v140, v136, s54
    v_perm_b32 v98, v148, v144, s54
    v_perm_b32 v99, v156, v152, s54
    v_perm_b32 v100, v132, v128, s55
    v_perm_b32 v101, v140, v136, s55
    v_perm_b32 v102, v148, v144, s55
    v_perm_b32 v103, v156, v152, s55
    v_perm_b32 v104, v133, v129, s54
    v_perm_b32 v105, v141, v137, s54
    v_perm_b32 v106, v149, v145, s54
    v_perm_b32 v107, v157, v153, s54
    v_perm_b32 v108, v133, v129, s55
    v_perm_b32 v109, v141, v137, s55
    v_perm_b32 v110, v149, v145, s55
    v_perm_b32 v111, v157, v153, s55
    v_perm_b32 v112, v134, v130, s54
    v_perm_b32 v113, v142, v138, s54
    v_perm_b32 v114, v150, v146, s54
    v_perm_b32 v115, v158, v154, s54
    v_perm_b32 v116, v134, v130, s55
    v_perm_b32 v117, v142, v138, s55
    v_perm_b32 v118, v150, v146, s55
    v_perm_b32 v119, v158, v154, s55
    v_perm_b32 v120, v135, v131, s54
    v_perm_b32 v121, v143, v139, s54
    v_perm_b32 v122, v151, v147, s54
    v_perm_b32 v123, v159, v155, s54
    v_perm_b32 v124, v135, v131, s55
    v_perm_b32 v125, v143, v139, s55
    v_perm_b32 v126, v151, v147, s55
    v_perm_b32 v127, v159, v155, s55
    v_perm_b32 v128, v164, v160, s54
    v_perm_b32 v129, v172, v168, s54
    v_perm_b32 v130, v180, v176, s54
    v_perm_b32 v131, v188, v184, s54
    v_perm_b32 v132, v164, v160, s55
    v_perm_b32 v133, v172, v168, s55
    v_perm_b32 v134, v180, v176, s55
    v_perm_b32 v135, v188, v184, s55
    v_perm_b32 v136, v165, v161, s54
    v_perm_b32 v137, v173, v169, s54
    v_perm_b32 v138, v181, v177, s54
    v_perm_b32 v139, v189, v185, s54
    v_perm_b32 v140, v165, v161, s55
    v_perm_b32 v141, v173, v169, s55
    v_perm_b32 v142, v181, v177, s55
    v_perm_b32 v143, v189, v185, s55
    v_perm_b32 v144, v166, v162, s54
    v_perm_b32 v145, v174, v170, s54
    v_perm_b32 v146, v182, v178, s54
    v_perm_b32 v147, v190, v186, s54
    v_perm_b32 v148, v166, v162, s55
    v_perm_b32 v149, v174, v170, s55
    v_perm_b32 v150, v182, v178, s55
    v_perm_b32 v151, v190, v186, s55
    v_perm_b32 v152, v167, v163, s54
    v_perm_b32 v153, v175, v171, s54
    v_perm_b32 v154, v183, v179, s54
    v_perm_b32 v155, v191, v187, s54
    v_perm_b32 v156, v167, v163, s55
    v_perm_b32 v157, v175, v171, s55
    v_perm_b32 v158, v183, v179, s55
    v_perm_b32 v159, v191, v187, s55
    v_perm_b32 v160, v196, v192, s54
    v_perm_b32 v161, v204, v200, s54
    v_perm_b32 v162, v212, v208, s54
    v_perm_b32 v163, v220, v216, s54
    v_perm_b32 v164, v196, v192, s55
    v_perm_b32 v165, v204, v200, s55
    v_perm_b32 v166, v212, v208, s55
    v_perm_b32 v167, v220, v216, s55
    v_perm_b32 v168, v197, v193, s54
    v_perm_b32 v169, v205, v201, s54
    v_perm_b32 v170, v213, v209, s54
    v_perm_b32 v171, v221, v217, s54
    v_perm_b32 v172, v197, v193, s55
    v_perm_b32 v173, v205, v201, s55
    v_perm_b32 v174, v213, v209, s55
    v_perm_b32 v175, v221, v217, s55
    v_perm_b32 v176, v198, v194, s54
    v_perm_b32 v177, v206, v202, s54
    v_perm_b32 v178, v214, v210, s54
    v_perm_b32 v179, v222, v218, s54
    v_perm_b32 v180, v198, v194, s55
    v_perm_b32 v181, v206, v202, s55
    v_perm_b32 v182, v214, v210, s55
    v_perm_b32 v183, v222, v218, s55
    v_perm_b32 v184, v199, v195, s54
    v_perm_b32 v185, v207, v203, s54
    v_perm_b32 v186, v215, v211, s54
    v_perm_b32 v187, v223, v219, s54
    v_perm_b32 v188, v199, v195, s55
    v_perm_b32 v189, v207, v203, s55
    v_perm_b32 v190, v215, v211, s55
    v_perm_b32 v191, v223, v219, s55
    v_perm_b32 v192, v225, v224, s54
    v_perm_b32 v193, v227, v226, s54
    v_perm_b32 v194, v229, v228, s54
    v_perm_b32 v195, v231, v230, s54
    v_perm_b32 v196, v225, v224, s55
    v_perm_b32 v197, v227, v226, s55
    v_perm_b32 v198, v229, v228, s55
    v_perm_b32 v199, v231, v230, s55
    v_perm_b32 v200, v233, v232, s54
    v_perm_b32 v201, v235, v234, s54
    v_perm_b32 v202, v237, v236, s54
    v_perm_b32 v203, v239, v238, s54
    v_perm_b32 v204, v233, v232, s55
    v_perm_b32 v205, v235, v234, s55
    v_perm_b32 v206, v237, v236, s55
    v_perm_b32 v207, v239, v238, s55
    v_perm_b32 v208, v241, v240, s54
    v_perm_b32 v209, v243, v242, s54
    v_perm_b32 v210, v245, v244, s54
    v_perm_b32 v211, v247, v246, s54
    v_perm_b32 v212, v241, v240, s55
    v_perm_b32 v213, v243, v242, s55
    v_perm_b32 v214, v245, v244, s55
    v_perm_b32 v215, v247, v246, s55
    v_perm_b32 v216, v249, v248, s54
    v_perm_b32 v217, v251, v250, s54
    v_perm_b32 v218, v253, v252, s54
    v_perm_b32 v219, v255, v254, s54
    v_perm_b32 v220, v249, v248, s55
    v_perm_b32 v221, v251, v250, s55
    v_perm_b32 v222, v253, v252, s55
    v_perm_b32 v223, v255, v254, s55
    s_lshl_b32 s54, s3, 5
    s_add_u32 s54, s54, s2
    s_cmp_ge_u32 s54, 72
    s_cbranch_scc1 L_nored_10
    s_lshl_b32 s55, s54, 12
    s_add_u32 s55, s55, 4718592
    s_mul_hi_u32 s56, s54, 238609295
    s_mul_i32 s57, s56, 18
    s_sub_u32 s57, s54, s57
    s_mul_i32 s56, s56, 2304
    s_add_u32 s56, s56, 1152
    s_lshr_b32 s58, s57, 1
    s_lshl_b32 s58, s58, 7
    s_and_b32 s59, s57, 1
    s_cmp_lt_u32 s57, 16
    s_cselect_b32 s60, 3, 6
    s_cselect_b32 s61, 4, 3
    s_lshl_b32 s59, s59, s60
    s_add_u32 s56, s56, s58
    s_add_u32 s56, s56, s59
    v_lshlrev_b32 v5, s61, v1
    s_mov_b32 s48, s26
    s_mov_b32 s49, s27
    s_mov_b32 s50, 9216
    s_mov_b32 s51, 0x20000
L_redpoll_11:
    buffer_load_dwordx4 v[16:19], v2, s[44:47], s55 offen offset:0 sc1
    buffer_load_dwordx4 v[20:23], v2, s[44:47], s55 offen offset:1024 sc1
    buffer_load_dwordx4 v[24:27], v2, s[44:47], s55 offen offset:2048 sc1
    buffer_load_dwordx4 v[28:31], v2, s[44:47], s55 offen offset:3072 sc1
    s_waitcnt vmcnt(0)
    v_max3_u32 v32, v16, v17, v18
    v_max3_u32 v33, v19, v20, v21
    v_max3_u32 v34, v22, v23, v24
    v_max3_u32 v35, v25, v26, v27
    v_max3_u32 v32, v32, v28, v29
    v_max3_u32 v33, v33, v30, v31
    v_max3_u32 v32, v32, v33, v34
    v_max_u32 v32, v32, v35
    v_cmp_eq_u32 vcc, -1, v32
    s_cbranch_vccz L_redok_12
    s_sub_u32 s101, s101, 1
    s_cbranch_scc0 L_redpoll_11
    s_mov_b32 s101, 0
L_redok_12:
    v_add_f32 v16, v16, v20
    v_add_f32 v24, v24, v28
    v_add_f32 v17, v17, v21
    v_add_f32 v25, v25, v29
    v_add_f32 v18, v18, v22
    v_add_f32 v26, v26, v30
    v_add_f32 v19, v19, v23
    v_add_f32 v27, v27, v31
    v_add_f32 v16, v16, v24
    v_add_f32 v17, v17, v25
    v_add_f32 v18, v18, v26
    v_add_f32 v19, v19, v27
    v_add_f32_dpp v16, v16, v16 row_ror:8 row_mask:0xf bank_mask:0xf
    v_add_f32_dpp v17, v17, v17 row_ror:8 row_mask:0xf bank_mask:0xf
    v_add_f32_dpp v18, v18, v18 row_ror:8 row_mask:0xf bank_mask:0xf
    v_add_f32_dpp v19, v19, v19 row_ror:8 row_mask:0xf bank_mask:0xf
    v_mov_b32 v20, v16
    v_mov_b32 v21, v17
    v_mov_b32 v22, v18
    v_mov_b32 v23, v19
    v_permlane16_swap_b32 v16, v20
    v_permlane16_swap_b32 v17, v21
    v_permlane16_swap_b32 v18, v22
    v_permlane16_swap_b32 v19, v23
    v_add_f32 v16, v16, v20
    v_add_f32 v17, v17, v21
    v_add_f32 v18, v18, v22
    v_add_f32 v19, v19, v23
    v_mov_b32 v20, v16
    v_mov_b32 v21, v17
    v_mov_b32 v22, v18
    v_mov_b32 v23, v19
    v_permlane32_swap_b32 v16, v20
    v_permlane32_swap_b32 v17, v21
    v_permlane32_swap_b32 v18, v22
    v_permlane32_swap_b32 v19, v23
    v_add_f32 v16, v16, v20
    v_add_f32 v17, v17, v21
    v_add_f32 v18, v18, v22
    v_add_f32 v19, v19, v23
    v_cvt_pk_bf16_f32 v16, v16, v17
    v_cvt_pk_bf16_f32 v17, v18, v19
    s_mov_b64 exec, 0xff
    buffer_store_dwordx2 v[16:17], v5, s[48:51], s56 offen
    s_mov_b64 exec, -1
L_nored_10:
    s_cmp_lg_u32 s3, 0
    s_cbranch_scc1 L_polled_14
    s_lshl_b32 s54, s52, 2
    v_mov_b32 v5, s54
L_poll_13:
    global_load_dword v6, v5, s[28:29] sc1
    s_waitcnt vmcnt(0)
    v_cmp_le_u32 vcc, 7, v6
    s_cbranch_vccnz L_polled_14
    s_sleep 2
    s_sub_u32 s101, s101, 1
    s_cbranch_scc0 L_poll_13
    s_mov_b32 s101, 0
L_polled_14:
    s_barrier
    s_lshl_b32 s58, s52, 15
    s_lshl_b32 s54, s3, 10
    s_add_u32 s58, s58, s54
    v_min_u32 v5, 6, v1
    v_lshlrev_b32 v5, 12, v5
L_light_15:
    buffer_load_dword v6, v5, s[44:47], s58 offen offset:512 sc1
    s_waitcnt vmcnt(0)
    v_cmp_ne_u32 vcc, -1, v6
    s_cbranch_vccnz L_heavy_16
    s_sleep 4
    s_sub_u32 s101, s101, 1
    s_cbranch_scc0 L_light_15
    s_mov_b32 s101, 0
L_heavy_16:
    s_add_u32 s54, s58, 0
    buffer_load_dwordx4 v[16:19], v2, s[44:47], s54 offen sc1
    s_add_u32 s54, s58, 4096
    buffer_load_dwordx4 v[20:23], v2, s[44:47], s54 offen sc1
    s_add_u32 s54, s58, 8192
    buffer_load_dwordx4 v[24:27], v2, s[44:47], s54 offen sc1
    s_add_u32 s54, s58, 12288
    buffer_load_dwordx4 v[28:31], v2, s[44:47], s54 offen sc1
    s_add_u32 s54, s58, 16384
    buffer_load_dwordx4 v[32:35], v2, s[44:47], s54 offen sc1
    s_add_u32 s54, s58, 20480
    buffer_load_dwordx4 v[36:39], v2, s[44:47], s54 offen sc1
    s_add_u32 s54, s58, 24576
    buffer_load_dwordx4 v[40:43], v2, s[44:47], s54 offen sc1
    s_waitcnt vmcnt(0)
    v_max3_u32 v224, v16, v17, v18
    v_max3_u32 v224, v224, v19, v20
    v_max3_u32 v224, v224, v21, v22
    v_max3_u32 v224, v224, v23, v24
    v_max3_u32 v224, v224, v25, v26
    v_max3_u32 v224, v224, v27, v28
    v_max3_u32 v224, v224, v29, v30
    v_max3_u32 v224, v224, v31, v32
    v_max3_u32 v224, v224, v33, v34
    v_max3_u32 v224, v224, v35, v36
    v_max3_u32 v224, v224, v37, v38
    v_max3_u32 v224, v224, v39, v40
    v_max3_u32 v224, v224, v41, v42
    v_max_u32 v224, v224, v43
    v_cmp_eq_u32 vcc, -1, v224
    s_cbranch_vccz L_heavyok_17
    s_sub_u32 s101, s101, 1
    s_cbranch_scc0 L_heavy_16
    s_mov_b32 s101, 0
L_heavyok_17:
    s_mov_b32 s97, 1069066811
    v_max3_f32 v224, v16, v20, v24
    v_max3_f32 v225, v28, v32, v36
    v_max3_f32 v224, v224, v225, v40
    v_sub_f32 v232, v16, v224
    v_sub_f32 v233, v20, v224
    v_sub_f32 v234, v24, v224
    v_sub_f32 v235, v28, v224
    v_sub_f32 v236, v32, v224
    v_sub_f32 v237, v36, v224
    v_sub_f32 v238, v40, v224
    v_mul_f32 v232, s97, v232
    v_mul_f32 v233, s97, v233
    v_mul_f32 v234, s97, v234
    v_mul_f32 v235, s97, v235
    v_mul_f32 v236, s97, v236
    v_mul_f32 v237, s97, v237
    v_mul_f32 v238, s97, v238
    v_exp_f32 v232, v232
    v_exp_f32 v233, v233
    v_exp_f32 v234, v234
    v_exp_f32 v235, v235
    v_exp_f32 v236, v236
    v_exp_f32 v237, v237
    v_exp_f32 v238, v238
    v_mul_f32 v224, v232, v17
    v_mul_f32 v225, v233, v21
    v_fmac_f32 v224, v234, v25
    v_fmac_f32 v225, v235, v29
    v_fmac_f32 v224, v236, v33
    v_fmac_f32 v225, v237, v37
    v_fmac_f32 v224, v238, v41
    v_add_f32 v224, v224, v225
    v_rcp_f32 v224, v224
    s_nop 0
    v_mul_f32 v232, v232, v224
    v_mul_f32 v233, v233, v224
    v_mul_f32 v234, v234, v224
    v_mul_f32 v235, v235, v224
    v_mul_f32 v236, v236, v224
    v_mul_f32 v237, v237, v224
    v_mul_f32 v238, v238, v224
    v_permlane32_swap_b32 v232, v240
    v_permlane32_swap_b32 v233, v241
    v_permlane32_swap_b32 v234, v242
    v_permlane32_swap_b32 v235, v243
    v_permlane32_swap_b32 v236, v244
    v_permlane32_swap_b32 v237, v245
    v_permlane32_swap_b32 v238, v246
    v_mul_f32 v224, v16, v240
    v_mul_f32 v225, v17, v240
    v_mul_f32 v226, v18, v240
    v_mul_f32 v227, v19, v240
    v_fmac_f32 v224, v20, v241
    v_fmac_f32 v225, v21, v241
    v_fmac_f32 v226, v22, v241
    v_fmac_f32 v227, v23, v241
    v_fmac_f32 v224, v24, v242
    v_fmac_f32 v225, v25, v242
    v_fmac_f32 v226, v26, v242
    v_fmac_f32 v227, v27, v242
    v_fmac_f32 v224, v28, v243
    v_fmac_f32 v225, v29, v243
    v_fmac_f32 v226, v30, v243
    v_fmac_f32 v227, v31, v243
    v_fmac_f32 v224, v32, v244
    v_fmac_f32 v225, v33, v244
    v_fmac_f32 v226, v34, v244
    v_fmac_f32 v227, v35, v244
    v_fmac_f32 v224, v36, v245
    v_fmac_f32 v225, v37, v245
    v_fmac_f32 v226, v38, v245
    v_fmac_f32 v227, v39, v245
    v_fmac_f32 v224, v40, v246
    v_fmac_f32 v225, v41, v246
    v_fmac_f32 v226, v42, v246
    v_fmac_f32 v227, v43, v246
    v_cvt_pk_bf16_f32 v224, v224, v225
    v_cvt_pk_bf16_f32 v225, v226, v227
    s_lshl_b32 s54, s3, 9
    v_lshl_add_u32 v5, v1, 3, s54
    ds_write_b64 v5, v[224:225]
    v_lshrrev_b32 v5, 2, v3
    v_lshlrev_b32 v5, 9, v5
    v_lshl_add_u32 v5, v4, 4, v5
    s_waitcnt lgkmcnt(0)
    s_barrier
    ds_read_b128 v[48:51], v5 offset:0
    ds_read_b128 v[52:55], v5 offset:64
    ds_read_b128 v[56:59], v5 offset:128
    ds_read_b128 v[60:63], v5 offset:192
    s_waitcnt lgkmcnt(0)
    v_mfma_f32_16x16x32_bf16 v[224:227], v[48:51], v[64:67], 0
    v_mfma_f32_16x16x32_bf16 v[228:231], v[48:51], v[68:71], 0
    v_mfma_f32_16x16x32_bf16 v[232:235], v[48:51], v[72:75], 0
    v_mfma_f32_16x16x32_bf16 v[236:239], v[48:51], v[76:79], 0
    v_mfma_f32_16x16x32_bf16 v[240:243], v[48:51], v[80:83], 0
    v_mfma_f32_16x16x32_bf16 v[244:247], v[48:51], v[84:87], 0
    v_mfma_f32_16x16x32_bf16 v[248:251], v[48:51], v[88:91], 0
    v_mfma_f32_16x16x32_bf16 v[252:255], v[48:51], v[92:95], 0
    v_mfma_f32_16x16x32_bf16 v[40:43], v[48:51], v[192:195], 0
    v_mfma_f32_16x16x32_bf16 v[44:47], v[48:51], v[196:199], 0
    v_mfma_f32_16x16x32_bf16 v[224:227], v[52:55], v[96:99], v[224:227]
    v_mfma_f32_16x16x32_bf16 v[228:231], v[52:55], v[100:103], v[228:231]
    v_mfma_f32_16x16x32_bf16 v[232:235], v[52:55], v[104:107], v[232:235]
    v_mfma_f32_16x16x32_bf16 v[236:239], v[52:55], v[108:111], v[236:239]
    v_mfma_f32_16x16x32_bf16 v[240:243], v[52:55], v[112:115], v[240:243]
    v_mfma_f32_16x16x32_bf16 v[244:247], v[52:55], v[116:119], v[244:247]
    v_mfma_f32_16x16x32_bf16 v[248:251], v[52:55], v[120:123], v[248:251]
    v_mfma_f32_16x16x32_bf16 v[252:255], v[52:55], v[124:127], v[252:255]
    v_mfma_f32_16x16x32_bf16 v[40:43], v[52:55], v[200:203], v[40:43]
    v_mfma_f32_16x16x32_bf16 v[44:47], v[52:55], v[204:207], v[44:47]
    v_mfma_f32_16x16x32_bf16 v[224:227], v[56:59], v[128:131], v[224:227]
    v_mfma_f32_16x16x32_bf16 v[228:231], v[56:59], v[132:135], v[228:231]
    v_mfma_f32_16x16x32_bf16 v[232:235], v[56:59], v[136:139], v[232:235]
    v_mfma_f32_16x16x32_bf16 v[236:239], v[56:59], v[140:143], v[236:239]
    v_mfma_f32_16x16x32_bf16 v[240:243], v[56:59], v[144:147], v[240:243]
    v_mfma_f32_16x16x32_bf16 v[244:247], v[56:59], v[148:151], v[244:247]
    v_mfma_f32_16x16x32_bf16 v[248:251], v[56:59], v[152:155], v[248:251]
    v_mfma_f32_16x16x32_bf16 v[252:255], v[56:59], v[156:159], v[252:255]
    v_mfma_f32_16x16x32_bf16 v[40:43], v[56:59], v[208:211], v[40:43]
    v_mfma_f32_16x16x32_bf16 v[44:47], v[56:59], v[212:215], v[44:47]
    v_mfma_f32_16x16x32_bf16 v[224:227], v[60:63], v[160:163], v[224:227]
    v_mfma_f32_16x16x32_bf16 v[228:231], v[60:63], v[164:167], v[228:231]
    v_mfma_f32_16x16x32_bf16 v[232:235], v[60:63], v[168:171], v[232:235]
    v_mfma_f32_16x16x32_bf16 v[236:239], v[60:63], v[172:175], v[236:239]
    v_mfma_f32_16x16x32_bf16 v[240:243], v[60:63], v[176:179], v[240:243]
    v_mfma_f32_16x16x32_bf16 v[244:247], v[60:63], v[180:183], v[244:247]
    v_mfma_f32_16x16x32_bf16 v[248:251], v[60:63], v[184:187], v[248:251]
    v_mfma_f32_16x16x32_bf16 v[252:255], v[60:63], v[188:191], v[252:255]
    v_mfma_f32_16x16x32_bf16 v[40:43], v[60:63], v[216:219], v[40:43]
    v_mfma_f32_16x16x32_bf16 v[44:47], v[60:63], v[220:223], v[44:47]
    v_mul_u32_u24 v7, 73728, v4
    v_lshrrev_b32 v5, 3, v3
    v_lshl_add_u32 v6, v5, 13, v7
    v_and_b32 v5, 7, v3
    v_lshl_add_u32 v6, v5, 4, v6
    v_lshl_add_u32 v7, v3, 3, v7
    v_add_u32 v7, 65536, v7
    s_lshl_b32 s56, s52, 7
    s_add_u32 s56, s56, 4194304
    s_lshl_b32 s54, s3, 14
    s_add_u32 s54, s54, s56
    s_add_u32 s55, s54, 4096
    s_and_b32 s57, s3, 1
    s_lshl_b32 s57, s57, 12
    s_add_u32 s56, s56, s57
    v_min_u32 v16, -2, v224
    v_min_u32 v17, -2, v228
    v_min_u32 v18, -2, v232
    v_min_u32 v19, -2, v236
    v_min_u32 v20, -2, v240
    v_min_u32 v21, -2, v244
    v_min_u32 v22, -2, v248
    v_min_u32 v23, -2, v252
    v_min_u32 v24, -2, v40
    v_min_u32 v25, -2, v44
    buffer_store_dwordx4 v[16:19], v6, s[44:47], s54 offen sc1
    buffer_store_dwordx4 v[20:23], v6, s[44:47], s55 offen sc1
    buffer_store_dwordx2 v[24:25], v7, s[44:47], s56 offen sc1
    s_lshl_b32 s54, s3, 5
    s_add_u32 s54, s54, s2
    s_cmp_ge_u32 s54, 72
    s_cbranch_scc1 L_nored_18
    s_lshl_b32 s55, s54, 12
    s_add_u32 s55, s55, 4194304
    s_mul_hi_u32 s56, s54, 238609295
    s_mul_i32 s57, s56, 18
    s_sub_u32 s57, s54, s57
    s_mul_i32 s56, s56, 2304
    s_add_u32 s56, s56, 0
    s_lshr_b32 s58, s57, 1
    s_lshl_b32 s58, s58, 7
    s_and_b32 s59, s57, 1
    s_cmp_lt_u32 s57, 16
    s_cselect_b32 s60, 3, 6
    s_cselect_b32 s61, 4, 3
    s_lshl_b32 s59, s59, s60
    s_add_u32 s56, s56, s58
    s_add_u32 s56, s56, s59
    v_lshlrev_b32 v5, s61, v1
    s_mov_b32 s48, s26
    s_mov_b32 s49, s27
    s_mov_b32 s50, 9216
    s_mov_b32 s51, 0x20000
L_redpoll_19:
    buffer_load_dwordx4 v[16:19], v2, s[44:47], s55 offen offset:0 sc1
    buffer_load_dwordx4 v[20:23], v2, s[44:47], s55 offen offset:1024 sc1
    buffer_load_dwordx4 v[24:27], v2, s[44:47], s55 offen offset:2048 sc1
    buffer_load_dwordx4 v[28:31], v2, s[44:47], s55 offen offset:3072 sc1
    s_waitcnt vmcnt(0)
    v_max3_u32 v32, v16, v17, v18
    v_max3_u32 v33, v19, v20, v21
    v_max3_u32 v34, v22, v23, v24
    v_max3_u32 v35, v25, v26, v27
    v_max3_u32 v32, v32, v28, v29
    v_max3_u32 v33, v33, v30, v31
    v_max3_u32 v32, v32, v33, v34
    v_max_u32 v32, v32, v35
    v_cmp_eq_u32 vcc, -1, v32
    s_cbranch_vccz L_redok_20
    s_sub_u32 s101, s101, 1
    s_cbranch_scc0 L_redpoll_19
    s_mov_b32 s101, 0
L_redok_20:
    v_add_f32 v16, v16, v20
    v_add_f32 v24, v24, v28
    v_add_f32 v17, v17, v21
    v_add_f32 v25, v25, v29
    v_add_f32 v18, v18, v22
    v_add_f32 v26, v26, v30
    v_add_f32 v19, v19, v23
    v_add_f32 v27, v27, v31
    v_add_f32 v16, v16, v24
    v_add_f32 v17, v17, v25
    v_add_f32 v18, v18, v26
    v_add_f32 v19, v19, v27
    v_add_f32_dpp v16, v16, v16 row_ror:8 row_mask:0xf bank_mask:0xf
    v_add_f32_dpp v17, v17, v17 row_ror:8 row_mask:0xf bank_mask:0xf
    v_add_f32_dpp v18, v18, v18 row_ror:8 row_mask:0xf bank_mask:0xf
    v_add_f32_dpp v19, v19, v19 row_ror:8 row_mask:0xf bank_mask:0xf
    v_mov_b32 v20, v16
    v_mov_b32 v21, v17
    v_mov_b32 v22, v18
    v_mov_b32 v23, v19
    v_permlane16_swap_b32 v16, v20
    v_permlane16_swap_b32 v17, v21
    v_permlane16_swap_b32 v18, v22
    v_permlane16_swap_b32 v19, v23
    v_add_f32 v16, v16, v20
    v_add_f32 v17, v17, v21
    v_add_f32 v18, v18, v22
    v_add_f32 v19, v19, v23
    v_mov_b32 v20, v16
    v_mov_b32 v21, v17
    v_mov_b32 v22, v18
    v_mov_b32 v23, v19
    v_permlane32_swap_b32 v16, v20
    v_permlane32_swap_b32 v17, v21
    v_permlane32_swap_b32 v18, v22
    v_permlane32_swap_b32 v19, v23
    v_add_f32 v16, v16, v20
    v_add_f32 v17, v17, v21
    v_add_f32 v18, v18, v22
    v_add_f32 v19, v19, v23
    v_cvt_pk_bf16_f32 v16, v16, v17
    v_cvt_pk_bf16_f32 v17, v18, v19
    s_mov_b64 exec, 0xff
    buffer_store_dwordx2 v[16:17], v5, s[48:51], s56 offen
    s_mov_b64 exec, -1
L_nored_18:
    s_endpgm
L_roleB_end:
L_exit:
    s_endpgm
.section .rodata,"a"
.p2align 6
.amdhsa_kernel concat_heads__mha_block_cached__compressed_kv_cla__decode_kernel
  .amdhsa_next_free_vgpr 512
  .amdhsa_next_free_sgpr 102
  .amdhsa_accum_offset 256
  .amdhsa_group_segment_fixed_size 0
  .amdhsa_kernarg_size 112
  .amdhsa_user_sgpr_count 2
  .amdhsa_user_sgpr_kernarg_segment_ptr 1
  .amdhsa_system_sgpr_workgroup_id_x 1
.end_amdhsa_kernel
```

```asm
; @launch grid=(256,1,1) block=(256,1,1) lds=163840
.amdgcn_target "amdgcn-amd-amdhsa--gfx950"
.text
.globl concat_heads__mha_block_cached__compressed_kv_cla__decode_kernel
.p2align 8
.type concat_heads__mha_block_cached__compressed_kv_cla__decode_kernel,@function
concat_heads__mha_block_cached__compressed_kv_cla__decode_kernel:
    s_cmp_ge_u32 s2, 256
    s_cbranch_scc1 L_exit
    s_load_dwordx16 s[4:19], s[0:1], 0
    s_load_dwordx8 s[20:27], s[0:1], 64
    s_load_dwordx4 s[28:31], s[0:1], 96
    v_lshrrev_b32 v2, 6, v0
    v_and_b32 v1, 63, v0
    v_readfirstlane_b32 s3, v2
    v_and_b32 v3, 15, v0
    v_bfe_u32 v4, v0, 4, 2
    v_lshlrev_b32 v2, 4, v1
    s_and_b32 s52, s2, 31
    s_mov_b32 s53, s52
    s_cmp_lt_u32 s2, 32
    s_cbranch_scc1 L_roleH
    s_cmp_lt_u32 s2, 64
    s_cbranch_scc1 L_roleC
L_roleA:
    s_sub_u32 s54, s2, 64
    s_mul_hi_u32 s52, s54, 715827883
    s_mul_i32 s56, s52, 6
    s_sub_u32 s53, s54, s56
    s_lshl_b32 s100, s3, 25
    s_lshl_b32 s55, s52, 20
    s_add_u32 s100, s100, s55
    s_lshl_b32 s99, s52, 2
    s_add_u32 s99, s99, s3
    s_mul_i32 s99, s99, 151552
    s_mul_i32 s58, s53, 135168
    s_add_u32 s59, s58, 135168
    s_sub_u32 s61, s59, 8192
    s_lshl_b32 s63, s52, 3
    s_add_u32 s63, s63, s53
    s_lshl_b32 s63, s63, 2
    s_add_u32 s63, s63, s3
    s_lshl_b32 s63, s63, 10
    s_getpc_b64 s[56:57]
L_pc_1:
    s_sub_u32 s56, s56, L_pc_1-L_roleA
    s_subb_u32 s57, s57, 0
    v_lshlrev_b32 v5, 7, v0
    v_min_u32 v6, L_roleA_end-L_roleA-4, v5
    global_load_dword v56, v6, s[56:57]
    s_mov_b32 s53, 536870912
    v_mov_b32 v18, s53
    v_cmp_eq_u32 vcc, 0, v1
    s_nop 1
    v_cndmask_b32 v18, v18, v1, vcc
    s_waitcnt lgkmcnt(0)
    s_mov_b32 s32, s6
    s_mov_b32 s33, s7
    s_mov_b32 s34, 134217728
    s_mov_b32 s35, 0x20000
    s_mov_b32 s36, s8
    s_mov_b32 s37, s9
    s_mov_b32 s38, 134217728
    s_mov_b32 s39, 0x20000
    s_mov_b32 s44, s30
    s_mov_b32 s45, s31
    s_mov_b32 s46, 536870912
    s_mov_b32 s47, 0x20000
    s_add_u32 s60, s58, s99
    s_and_b32 s60, s60, 0xfffff
    s_or_b32 s60, s60, s100
    s_add_u32 s58, s58, 4096
    buffer_load_dwordx4 v[96:99], v2, s[32:35], s60 offen offset:0 nt
    buffer_load_dwordx4 v[100:103], v2, s[32:35], s60 offen offset:1024 nt
    buffer_load_dwordx4 v[104:107], v2, s[32:35], s60 offen offset:2048 nt
    buffer_load_dwordx4 v[108:111], v2, s[32:35], s60 offen offset:3072 nt
    buffer_load_dwordx4 a[32:35], v2, s[36:39], s60 offen offset:0 nt
    buffer_load_dwordx4 a[36:39], v2, s[36:39], s60 offen offset:1024 nt
    buffer_load_dwordx4 a[40:43], v2, s[36:39], s60 offen offset:2048 nt
    buffer_load_dwordx4 a[44:47], v2, s[36:39], s60 offen offset:3072 nt
    s_add_u32 s60, s58, s99
    s_and_b32 s60, s60, 0xfffff
    s_or_b32 s60, s60, s100
    s_add_u32 s58, s58, 4096
    buffer_load_dwordx4 v[112:115], v2, s[32:35], s60 offen offset:0 nt
    buffer_load_dwordx4 v[116:119], v2, s[32:35], s60 offen offset:1024 nt
    buffer_load_dwordx4 v[120:123], v2, s[32:35], s60 offen offset:2048 nt
    buffer_load_dwordx4 v[124:127], v2, s[32:35], s60 offen offset:3072 nt
    buffer_load_dwordx4 a[48:51], v2, s[36:39], s60 offen offset:0 nt
    buffer_load_dwordx4 a[52:55], v2, s[36:39], s60 offen offset:1024 nt
    buffer_load_dwordx4 a[56:59], v2, s[36:39], s60 offen offset:2048 nt
    buffer_load_dwordx4 a[60:63], v2, s[36:39], s60 offen offset:3072 nt
    s_add_u32 s60, s58, s99
    s_and_b32 s60, s60, 0xfffff
    s_or_b32 s60, s60, s100
    s_add_u32 s58, s58, 4096
    buffer_load_dwordx4 v[128:131], v2, s[32:35], s60 offen offset:0 nt
    buffer_load_dwordx4 v[132:135], v2, s[32:35], s60 offen offset:1024 nt
    buffer_load_dwordx4 v[136:139], v2, s[32:35], s60 offen offset:2048 nt
    buffer_load_dwordx4 v[140:143], v2, s[32:35], s60 offen offset:3072 nt
    buffer_load_dwordx4 a[64:67], v2, s[36:39], s60 offen offset:0 nt
    buffer_load_dwordx4 a[68:71], v2, s[36:39], s60 offen offset:1024 nt
    buffer_load_dwordx4 a[72:75], v2, s[36:39], s60 offen offset:2048 nt
    buffer_load_dwordx4 a[76:79], v2, s[36:39], s60 offen offset:3072 nt
    s_add_u32 s60, s58, s99
    s_and_b32 s60, s60, 0xfffff
    s_or_b32 s60, s60, s100
    s_add_u32 s58, s58, 4096
    buffer_load_dwordx4 v[144:147], v2, s[32:35], s60 offen offset:0 nt
    buffer_load_dwordx4 v[148:151], v2, s[32:35], s60 offen offset:1024 nt
    buffer_load_dwordx4 v[152:155], v2, s[32:35], s60 offen offset:2048 nt
    buffer_load_dwordx4 v[156:159], v2, s[32:35], s60 offen offset:3072 nt
    buffer_load_dwordx4 a[80:83], v2, s[36:39], s60 offen offset:0 nt
    buffer_load_dwordx4 a[84:87], v2, s[36:39], s60 offen offset:1024 nt
    buffer_load_dwordx4 a[88:91], v2, s[36:39], s60 offen offset:2048 nt
    buffer_load_dwordx4 a[92:95], v2, s[36:39], s60 offen offset:3072 nt
    s_add_u32 s60, s58, s99
    s_and_b32 s60, s60, 0xfffff
    s_or_b32 s60, s60, s100
    s_add_u32 s58, s58, 4096
    buffer_load_dwordx4 v[160:163], v2, s[32:35], s60 offen offset:0 nt
    buffer_load_dwordx4 v[164:167], v2, s[32:35], s60 offen offset:1024 nt
    buffer_load_dwordx4 v[168:171], v2, s[32:35], s60 offen offset:2048 nt
    buffer_load_dwordx4 v[172:175], v2, s[32:35], s60 offen offset:3072 nt
    buffer_load_dwordx4 a[96:99], v2, s[36:39], s60 offen offset:0 nt
    buffer_load_dwordx4 a[100:103], v2, s[36:39], s60 offen offset:1024 nt
    buffer_load_dwordx4 a[104:107], v2, s[36:39], s60 offen offset:2048 nt
    buffer_load_dwordx4 a[108:111], v2, s[36:39], s60 offen offset:3072 nt
    s_add_u32 s60, s58, s99
    s_and_b32 s60, s60, 0xfffff
    s_or_b32 s60, s60, s100
    s_add_u32 s58, s58, 4096
    buffer_load_dwordx4 v[176:179], v2, s[32:35], s60 offen offset:0 nt
    buffer_load_dwordx4 v[180:183], v2, s[32:35], s60 offen offset:1024 nt
    buffer_load_dwordx4 v[184:187], v2, s[32:35], s60 offen offset:2048 nt
    buffer_load_dwordx4 v[188:191], v2, s[32:35], s60 offen offset:3072 nt
    buffer_load_dwordx4 a[112:115], v2, s[36:39], s60 offen offset:0 nt
    buffer_load_dwordx4 a[116:119], v2, s[36:39], s60 offen offset:1024 nt
    buffer_load_dwordx4 a[120:123], v2, s[36:39], s60 offen offset:2048 nt
    buffer_load_dwordx4 a[124:127], v2, s[36:39], s60 offen offset:3072 nt
    s_lshl_b32 s54, s52, 2
    v_mov_b32 v58, s54
    global_load_dword v57, v58, s[28:29]
    s_add_u32 s60, s58, s99
    s_and_b32 s60, s60, 0xfffff
    s_or_b32 s60, s60, s100
    s_add_u32 s58, s58, 4096
    buffer_load_dwordx4 v[192:195], v2, s[32:35], s60 offen offset:0 nt
    buffer_load_dwordx4 v[196:199], v2, s[32:35], s60 offen offset:1024 nt
    buffer_load_dwordx4 v[200:203], v2, s[32:35], s60 offen offset:2048 nt
    buffer_load_dwordx4 v[204:207], v2, s[32:35], s60 offen offset:3072 nt
    buffer_load_dwordx4 a[128:131], v2, s[36:39], s60 offen offset:0 nt
    buffer_load_dwordx4 a[132:135], v2, s[36:39], s60 offen offset:1024 nt
    buffer_load_dwordx4 a[136:139], v2, s[36:39], s60 offen offset:2048 nt
    buffer_load_dwordx4 a[140:143], v2, s[36:39], s60 offen offset:3072 nt
    s_waitcnt vmcnt(49)
    s_add_u32 s60, s58, s99
    s_and_b32 s60, s60, 0xfffff
    s_or_b32 s60, s60, s100
    s_add_u32 s58, s58, 4096
    buffer_load_dwordx4 v[208:211], v2, s[32:35], s60 offen offset:0 nt
    buffer_load_dwordx4 v[212:215], v2, s[32:35], s60 offen offset:1024 nt
    buffer_load_dwordx4 v[216:219], v2, s[32:35], s60 offen offset:2048 nt
    buffer_load_dwordx4 v[220:223], v2, s[32:35], s60 offen offset:3072 nt
    buffer_load_dwordx4 a[144:147], v2, s[36:39], s60 offen offset:0 nt
    buffer_load_dwordx4 a[148:151], v2, s[36:39], s60 offen offset:1024 nt
    buffer_load_dwordx4 a[152:155], v2, s[36:39], s60 offen offset:2048 nt
    buffer_load_dwordx4 a[156:159], v2, s[36:39], s60 offen offset:3072 nt
    s_waitcnt vmcnt(49)
    s_add_u32 s60, s58, s99
    s_and_b32 s60, s60, 0xfffff
    s_or_b32 s60, s60, s100
    s_add_u32 s58, s58, 4096
    buffer_load_dwordx4 v[224:227], v2, s[32:35], s60 offen offset:0 nt
    buffer_load_dwordx4 v[228:231], v2, s[32:35], s60 offen offset:1024 nt
    buffer_load_dwordx4 v[232:235], v2, s[32:35], s60 offen offset:2048 nt
    buffer_load_dwordx4 v[236:239], v2, s[32:35], s60 offen offset:3072 nt
    buffer_load_dwordx4 a[160:163], v2, s[36:39], s60 offen offset:0 nt
    buffer_load_dwordx4 a[164:167], v2, s[36:39], s60 offen offset:1024 nt
    buffer_load_dwordx4 a[168:171], v2, s[36:39], s60 offen offset:2048 nt
    buffer_load_dwordx4 a[172:175], v2, s[36:39], s60 offen offset:3072 nt
    v_and_b32 v5, 1, v3
    v_cmp_eq_u32 vcc, 1, v5
    v_mov_b32 v5, 0xffff
    v_mov_b32 v6, 0xffff0000
    v_cndmask_b32 v5, v5, v6, vcc
    v_lshrrev_b32 v6, 1, v3
    v_cmp_eq_u32 vcc, 0, v6
    s_nop 1
    v_cndmask_b32 v8, 0, v5, vcc
    v_cmp_eq_u32 vcc, 1, v6
    s_nop 1
    v_cndmask_b32 v9, 0, v5, vcc
    v_cmp_eq_u32 vcc, 2, v6
    s_nop 1
    v_cndmask_b32 v10, 0, v5, vcc
    v_cmp_eq_u32 vcc, 3, v6
    s_nop 1
    v_cndmask_b32 v11, 0, v5, vcc
    v_mov_b32 v12, 0
    v_mov_b32 v13, 0
    v_mov_b32 v14, 0
    v_mov_b32 v15, 0
    v_mov_b32 v16, 0xff800000
    v_mov_b32 v17, 0
    s_mov_b32 s96, 1035273459
    s_mov_b32 s97, 1069066811
    s_mov_b32 s98, 0xffff0000
    v_lshrrev_b32 v5, 1, v4
    v_lshlrev_b32 v59, 5, v3
    v_lshl_add_u32 v59, v5, 4, v59
    v_and_b32 v5, 1, v4
    v_lshl_add_u32 v59, v5, 11, v59
    v_lshlrev_b32 v3, 5, v3
    v_lshl_add_u32 v3, v4, 4, v3
    v_cmp_gt_u32 vcc, 32, v1
    s_nop 1
    v_cndmask_b32 v3, v2, v3, vcc
    s_lshl_b32 s57, s52, 2
    s_add_u32 s57, s57, s3
    s_lshl_b32 s57, s57, 7
    s_add_u32 s57, s57, 5373952
    s_lshl_b32 s56, s52, 12
    s_lshl_b32 s54, s3, 9
    s_add_u32 s56, s56, s54
    s_add_u32 s56, s56, 5242880
    s_mov_b32 s62, 2
    s_mov_b32 s101, 100000
    s_waitcnt vmcnt(24)
    v_cmp_le_u32 vcc, 2, v57
    s_cbranch_vccz L_aflag
L_aflag_ok:
    buffer_load_dwordx4 v[60:63], v59, s[44:47], s56 offen sc1
    s_add_u32 s60, s58, s99
    s_and_b32 s60, s60, 0xfffff
    s_or_b32 s60, s60, s100
    s_add_u32 s58, s58, 4096
    buffer_load_dwordx4 v[240:243], v2, s[32:35], s60 offen offset:0 nt
    buffer_load_dwordx4 v[244:247], v2, s[32:35], s60 offen offset:1024 nt
    buffer_load_dwordx4 v[248:251], v2, s[32:35], s60 offen offset:2048 nt
    buffer_load_dwordx4 v[252:255], v2, s[32:35], s60 offen offset:3072 nt
    buffer_load_dwordx4 a[176:179], v2, s[36:39], s60 offen offset:0 nt
    buffer_load_dwordx4 a[180:183], v2, s[36:39], s60 offen offset:1024 nt
    buffer_load_dwordx4 a[184:187], v2, s[36:39], s60 offen offset:2048 nt
    buffer_load_dwordx4 a[188:191], v2, s[36:39], s60 offen offset:3072 nt
    buffer_atomic_add v48, v18, s[44:47], s53 offen sc0
    s_add_u32 s60, s58, s99
    s_and_b32 s60, s60, 0xfffff
    s_or_b32 s60, s60, s100
    s_add_u32 s58, s58, 4096
    buffer_load_dwordx4 v[64:67], v2, s[32:35], s60 offen offset:0 nt
    buffer_load_dwordx4 v[68:71], v2, s[32:35], s60 offen offset:1024 nt
    buffer_load_dwordx4 v[72:75], v2, s[32:35], s60 offen offset:2048 nt
    buffer_load_dwordx4 v[76:79], v2, s[32:35], s60 offen offset:3072 nt
    buffer_load_dwordx4 a[0:3], v2, s[36:39], s60 offen offset:0 nt
    buffer_load_dwordx4 a[4:7], v2, s[36:39], s60 offen offset:1024 nt
    buffer_load_dwordx4 a[8:11], v2, s[36:39], s60 offen offset:2048 nt
    buffer_load_dwordx4 a[12:15], v2, s[36:39], s60 offen offset:3072 nt
    buffer_atomic_add v49, v18, s[44:47], s53 offen sc0
    s_add_u32 s60, s58, s99
    s_and_b32 s60, s60, 0xfffff
    s_or_b32 s60, s60, s100
    s_add_u32 s58, s58, 4096
    buffer_load_dwordx4 v[80:83], v2, s[32:35], s60 offen offset:0 nt
    buffer_load_dwordx4 v[84:87], v2, s[32:35], s60 offen offset:1024 nt
    buffer_load_dwordx4 v[88:91], v2, s[32:35], s60 offen offset:2048 nt
    buffer_load_dwordx4 v[92:95], v2, s[32:35], s60 offen offset:3072 nt
    buffer_load_dwordx4 a[16:19], v2, s[36:39], s60 offen offset:0 nt
    buffer_load_dwordx4 a[20:23], v2, s[36:39], s60 offen offset:1024 nt
    buffer_load_dwordx4 a[24:27], v2, s[36:39], s60 offen offset:2048 nt
    buffer_load_dwordx4 a[28:31], v2, s[36:39], s60 offen offset:3072 nt
    s_waitcnt vmcnt(26)
    v_max3_u32 v20, v60, v61, v62
    v_max_u32 v20, v20, v63
    v_cmp_eq_u32 vcc, -1, v20
    s_cbranch_vccnz L_aq
L_aq_ok:
    v_mov_b32 v20, v60
    v_mov_b32 v21, v61
    v_mov_b32 v22, v62
    v_mov_b32 v23, v63
    v_permlane16_swap_b32 v60, v20
    v_permlane16_swap_b32 v61, v21
    v_permlane16_swap_b32 v62, v22
    v_permlane16_swap_b32 v63, v23
    v_add_f32 v60, v60, v20
    v_add_f32 v61, v61, v21
    v_add_f32 v62, v62, v22
    v_add_f32 v63, v63, v23
    v_cvt_pk_bf16_f32 v4, v60, v61
    v_cvt_pk_bf16_f32 v5, v62, v63
    v_mov_b32 v6, v4
    v_mov_b32 v7, v5
    s_nop 0
    v_permlane32_swap_b32 v4, v6
    v_permlane32_swap_b32 v5, v7
    s_mov_b32 s56, 1
L_aloop:
    s_waitcnt vmcnt(13)
    v_dot2_f32_bf16 v20, v64, v4, 0
    v_dot2_f32_bf16 v21, v68, v4, 0
    v_dot2_f32_bf16 v22, v72, v4, 0
    v_dot2_f32_bf16 v23, v76, v4, 0
    v_dot2_f32_bf16 v20, v65, v5, v20
    v_dot2_f32_bf16 v21, v69, v5, v21
    v_dot2_f32_bf16 v22, v73, v5, v22
    v_dot2_f32_bf16 v23, v77, v5, v23
    v_dot2_f32_bf16 v20, v66, v6, v20
    v_dot2_f32_bf16 v21, v70, v6, v21
    v_dot2_f32_bf16 v22, v74, v6, v22
    v_dot2_f32_bf16 v23, v78, v6, v23
    v_dot2_f32_bf16 v20, v67, v7, v20
    v_dot2_f32_bf16 v21, v71, v7, v21
    v_dot2_f32_bf16 v22, v75, v7, v22
    v_dot2_f32_bf16 v23, v79, v7, v23
    v_readfirstlane_b32 s54, v48
    v_mov_b32 v48, 1
    s_cmp_ge_u32 s58, s61
    s_cselect_b32 s55, s57, s53
    s_lshl_b32 s54, s54, 12
    s_add_u32 s54, s54, 811008
    s_cmp_lt_u32 s58, s59
    s_cselect_b32 s54, s58, s54
    s_add_u32 s58, s58, 4096
    s_add_u32 s60, s54, s99
    s_and_b32 s60, s60, 0xfffff
    s_or_b32 s60, s60, s100
    s_cmp_lt_u32 s54, 0x100000
    s_cselect_b32 s60, s60, 0x8000000
    s_cselect_b32 s55, s55, s53
    s_addc_u32 s62, s62, -1
    buffer_atomic_add v48, v18, s[44:47], s55 offen sc0
    buffer_load_dwordx4 v[64:67], v2, s[32:35], s60 offen offset:0 nt
    buffer_load_dwordx4 v[68:71], v2, s[32:35], s60 offen offset:1024 nt
    buffer_load_dwordx4 v[72:75], v2, s[32:35], s60 offen offset:2048 nt
    buffer_load_dwordx4 v[76:79], v2, s[32:35], s60 offen offset:3072 nt
    v_add_f32_dpp v24, v20, v20 row_ror:8 row_mask:0xf bank_mask:0x3
    v_add_f32_dpp v25, v22, v22 row_ror:8 row_mask:0xf bank_mask:0x3
    v_add_f32_dpp v24, v21, v21 row_ror:8 row_mask:0xf bank_mask:0xc
    v_add_f32_dpp v25, v23, v23 row_ror:8 row_mask:0xf bank_mask:0xc
    s_nop 0
    v_add_f32_dpp v26, v24, v24 row_shl:4 row_mask:0xf bank_mask:0x5
    v_add_f32_dpp v26, v25, v25 row_shr:4 row_mask:0xf bank_mask:0xa
    s_nop 1
    v_add_f32_dpp v26, v26, v26 quad_perm:[1,0,3,2] row_mask:0xf bank_mask:0xf
    s_nop 1
    v_add_f32_dpp v26, v26, v26 quad_perm:[2,3,0,1] row_mask:0xf bank_mask:0xf
    v_cvt_pk_bf16_f32 v26, v26, v26
    v_and_b32 v26, s98, v26
    v_mul_f32 v26, s96, v26
    v_cvt_pk_bf16_f32 v26, v26, v26
    v_and_b32 v26, s98, v26
    s_nop 1
    v_max_f32_dpp v27, v26, v26 row_ror:4 row_mask:0xf bank_mask:0xf
    s_nop 1
    v_max_f32_dpp v27, v27, v27 row_ror:8 row_mask:0xf bank_mask:0xf
    v_mov_b32 v28, v27
    s_nop 1
    v_permlane16_swap_b32 v27, v28
    v_max_f32 v27, v27, v28
    v_mov_b32 v28, v27
    s_nop 1
    v_permlane32_swap_b32 v27, v28
    v_max3_f32 v27, v27, v28, v16
    v_sub_f32 v28, v16, v27
    v_sub_f32 v29, v26, v27
    v_mul_f32 v28, s97, v28
    v_mul_f32 v29, s97, v29
    v_exp_f32 v28, v28
    v_exp_f32 v29, v29
    v_mov_b32 v16, v27
    v_fma_f32 v17, v17, v28, v29
    v_cvt_pk_bf16_f32 v29, v29, v29
    v_mul_f32 v12, v12, v28
    v_mul_f32 v13, v13, v28
    v_mul_f32 v14, v14, v28
    v_mul_f32 v15, v15, v28
    s_waitcnt vmcnt(14)
    v_and_b32_dpp v32, v29, v8 row_newbcast:0 row_mask:0xf bank_mask:0xf
    v_and_b32_dpp v33, v29, v9 row_newbcast:0 row_mask:0xf bank_mask:0xf
    v_and_b32_dpp v34, v29, v10 row_newbcast:0 row_mask:0xf bank_mask:0xf
    v_and_b32_dpp v35, v29, v11 row_newbcast:0 row_mask:0xf bank_mask:0xf
    v_and_b32_dpp v36, v29, v8 row_newbcast:8 row_mask:0xf bank_mask:0xf
    v_and_b32_dpp v37, v29, v9 row_newbcast:8 row_mask:0xf bank_mask:0xf
    v_and_b32_dpp v38, v29, v10 row_newbcast:8 row_mask:0xf bank_mask:0xf
    v_and_b32_dpp v39, v29, v11 row_newbcast:8 row_mask:0xf bank_mask:0xf
    v_and_b32_dpp v40, v29, v8 row_newbcast:4 row_mask:0xf bank_mask:0xf
    v_and_b32_dpp v41, v29, v9 row_newbcast:4 row_mask:0xf bank_mask:0xf
    v_and_b32_dpp v42, v29, v10 row_newbcast:4 row_mask:0xf bank_mask:0xf
    v_and_b32_dpp v43, v29, v11 row_newbcast:4 row_mask:0xf bank_mask:0xf
    v_and_b32_dpp v44, v29, v8 row_newbcast:12 row_mask:0xf bank_mask:0xf
    v_and_b32_dpp v45, v29, v9 row_newbcast:12 row_mask:0xf bank_mask:0xf
    v_and_b32_dpp v46, v29, v10 row_newbcast:12 row_mask:0xf bank_mask:0xf
    v_and_b32_dpp v47, v29, v11 row_newbcast:12 row_mask:0xf bank_mask:0xf
    v_mfma_f32_16x16x32_bf16 v[12:15], v[32:35], a[0:3], v[12:15]
    v_mfma_f32_16x16x32_bf16 v[12:15], v[36:39], a[4:7], v[12:15]
    v_mfma_f32_16x16x32_bf16 v[12:15], v[40:43], a[8:11], v[12:15]
    v_mfma_f32_16x16x32_bf16 v[12:15], v[44:47], a[12:15], v[12:15]
    buffer_load_dwordx4 a[0:3], v2, s[36:39], s60 offen offset:0 nt
    buffer_load_dwordx4 a[4:7], v2, s[36:39], s60 offen offset:1024 nt
    buffer_load_dwordx4 a[8:11], v2, s[36:39], s60 offen offset:2048 nt
    buffer_load_dwordx4 a[12:15], v2, s[36:39], s60 offen offset:3072 nt
    s_cmp_eq_u32 s62, 0
    s_cbranch_scc1 L_adone
    s_cmp_lg_u32 s56, 0
    s_cbranch_scc1 L_aext0
L_aback0:
    s_waitcnt vmcnt(13)
    v_dot2_f32_bf16 v20, v80, v4, 0
    v_dot2_f32_bf16 v21, v84, v4, 0
    v_dot2_f32_bf16 v22, v88, v4, 0
    v_dot2_f32_bf16 v23, v92, v4, 0
    v_dot2_f32_bf16 v20, v81, v5, v20
    v_dot2_f32_bf16 v21, v85, v5, v21
    v_dot2_f32_bf16 v22, v89, v5, v22
    v_dot2_f32_bf16 v23, v93, v5, v23
    v_dot2_f32_bf16 v20, v82, v6, v20
    v_dot2_f32_bf16 v21, v86, v6, v21
    v_dot2_f32_bf16 v22, v90, v6, v22
    v_dot2_f32_bf16 v23, v94, v6, v23
    v_dot2_f32_bf16 v20, v83, v7, v20
    v_dot2_f32_bf16 v21, v87, v7, v21
    v_dot2_f32_bf16 v22, v91, v7, v22
    v_dot2_f32_bf16 v23, v95, v7, v23
    v_readfirstlane_b32 s54, v49
    v_mov_b32 v49, 1
    s_cmp_ge_u32 s58, s61
    s_cselect_b32 s55, s57, s53
    s_lshl_b32 s54, s54, 12
    s_add_u32 s54, s54, 811008
    s_cmp_lt_u32 s58, s59
    s_cselect_b32 s54, s58, s54
    s_add_u32 s58, s58, 4096
    s_add_u32 s60, s54, s99
    s_and_b32 s60, s60, 0xfffff
    s_or_b32 s60, s60, s100
    s_cmp_lt_u32 s54, 0x100000
    s_cselect_b32 s60, s60, 0x8000000
    s_cselect_b32 s55, s55, s53
    s_addc_u32 s62, s62, -1
    buffer_atomic_add v49, v18, s[44:47], s55 offen sc0
    buffer_load_dwordx4 v[80:83], v2, s[32:35], s60 offen offset:0 nt
    buffer_load_dwordx4 v[84:87], v2, s[32:35], s60 offen offset:1024 nt
    buffer_load_dwordx4 v[88:91], v2, s[32:35], s60 offen offset:2048 nt
    buffer_load_dwordx4 v[92:95], v2, s[32:35], s60 offen offset:3072 nt
    v_add_f32_dpp v24, v20, v20 row_ror:8 row_mask:0xf bank_mask:0x3
    v_add_f32_dpp v25, v22, v22 row_ror:8 row_mask:0xf bank_mask:0x3
    v_add_f32_dpp v24, v21, v21 row_ror:8 row_mask:0xf bank_mask:0xc
    v_add_f32_dpp v25, v23, v23 row_ror:8 row_mask:0xf bank_mask:0xc
    s_nop 0
    v_add_f32_dpp v26, v24, v24 row_shl:4 row_mask:0xf bank_mask:0x5
    v_add_f32_dpp v26, v25, v25 row_shr:4 row_mask:0xf bank_mask:0xa
    s_nop 1
    v_add_f32_dpp v26, v26, v26 quad_perm:[1,0,3,2] row_mask:0xf bank_mask:0xf
    s_nop 1
    v_add_f32_dpp v26, v26, v26 quad_perm:[2,3,0,1] row_mask:0xf bank_mask:0xf
    v_cvt_pk_bf16_f32 v26, v26, v26
    v_and_b32 v26, s98, v26
    v_mul_f32 v26, s96, v26
    v_cvt_pk_bf16_f32 v26, v26, v26
    v_and_b32 v26, s98, v26
    s_nop 1
    v_max_f32_dpp v27, v26, v26 row_ror:4 row_mask:0xf bank_mask:0xf
    s_nop 1
    v_max_f32_dpp v27, v27, v27 row_ror:8 row_mask:0xf bank_mask:0xf
    v_mov_b32 v28, v27
    s_nop 1
    v_permlane16_swap_b32 v27, v28
    v_max_f32 v27, v27, v28
    v_mov_b32 v28, v27
    s_nop 1
    v_permlane32_swap_b32 v27, v28
    v_max3_f32 v27, v27, v28, v16
    v_sub_f32 v28, v16, v27
    v_sub_f32 v29, v26, v27
    v_mul_f32 v28, s97, v28
    v_mul_f32 v29, s97, v29
    v_exp_f32 v28, v28
    v_exp_f32 v29, v29
    v_mov_b32 v16, v27
    v_fma_f32 v17, v17, v28, v29
    v_cvt_pk_bf16_f32 v29, v29, v29
    v_mul_f32 v12, v12, v28
    v_mul_f32 v13, v13, v28
    v_mul_f32 v14, v14, v28
    v_mul_f32 v15, v15, v28
    s_waitcnt vmcnt(14)
    v_and_b32_dpp v32, v29, v8 row_newbcast:0 row_mask:0xf bank_mask:0xf
    v_and_b32_dpp v33, v29, v9 row_newbcast:0 row_mask:0xf bank_mask:0xf
    v_and_b32_dpp v34, v29, v10 row_newbcast:0 row_mask:0xf bank_mask:0xf
    v_and_b32_dpp v35, v29, v11 row_newbcast:0 row_mask:0xf bank_mask:0xf
    v_and_b32_dpp v36, v29, v8 row_newbcast:8 row_mask:0xf bank_mask:0xf
    v_and_b32_dpp v37, v29, v9 row_newbcast:8 row_mask:0xf bank_mask:0xf
    v_and_b32_dpp v38, v29, v10 row_newbcast:8 row_mask:0xf bank_mask:0xf
    v_and_b32_dpp v39, v29, v11 row_newbcast:8 row_mask:0xf bank_mask:0xf
    v_and_b32_dpp v40, v29, v8 row_newbcast:4 row_mask:0xf bank_mask:0xf
    v_and_b32_dpp v41, v29, v9 row_newbcast:4 row_mask:0xf bank_mask:0xf
    v_and_b32_dpp v42, v29, v10 row_newbcast:4 row_mask:0xf bank_mask:0xf
    v_and_b32_dpp v43, v29, v11 row_newbcast:4 row_mask:0xf bank_mask:0xf
    v_and_b32_dpp v44, v29, v8 row_newbcast:12 row_mask:0xf bank_mask:0xf
    v_and_b32_dpp v45, v29, v9 row_newbcast:12 row_mask:0xf bank_mask:0xf
    v_and_b32_dpp v46, v29, v10 row_newbcast:12 row_mask:0xf bank_mask:0xf
    v_and_b32_dpp v47, v29, v11 row_newbcast:12 row_mask:0xf bank_mask:0xf
    v_mfma_f32_16x16x32_bf16 v[12:15], v[32:35], a[16:19], v[12:15]
    v_mfma_f32_16x16x32_bf16 v[12:15], v[36:39], a[20:23], v[12:15]
    v_mfma_f32_16x16x32_bf16 v[12:15], v[40:43], a[24:27], v[12:15]
    v_mfma_f32_16x16x32_bf16 v[12:15], v[44:47], a[28:31], v[12:15]
    buffer_load_dwordx4 a[16:19], v2, s[36:39], s60 offen offset:0 nt
    buffer_load_dwordx4 a[20:23], v2, s[36:39], s60 offen offset:1024 nt
    buffer_load_dwordx4 a[24:27], v2, s[36:39], s60 offen offset:2048 nt
    buffer_load_dwordx4 a[28:31], v2, s[36:39], s60 offen offset:3072 nt
    s_cmp_eq_u32 s62, 0
    s_cbranch_scc1 L_adone
    s_cmp_lg_u32 s56, 0
    s_cbranch_scc1 L_aext1
L_aback1:
    s_branch L_aloop
L_aext0:
    v_dot2_f32_bf16 v20, v96, v4, 0
    v_dot2_f32_bf16 v21, v100, v4, 0
    v_dot2_f32_bf16 v22, v104, v4, 0
    v_dot2_f32_bf16 v23, v108, v4, 0
    v_dot2_f32_bf16 v20, v97, v5, v20
    v_dot2_f32_bf16 v21, v101, v5, v21
    v_dot2_f32_bf16 v22, v105, v5, v22
    v_dot2_f32_bf16 v23, v109, v5, v23
    v_dot2_f32_bf16 v20, v98, v6, v20
    v_dot2_f32_bf16 v21, v102, v6, v21
    v_dot2_f32_bf16 v22, v106, v6, v22
    v_dot2_f32_bf16 v23, v110, v6, v23
    v_dot2_f32_bf16 v20, v99, v7, v20
    v_dot2_f32_bf16 v21, v103, v7, v21
    v_dot2_f32_bf16 v22, v107, v7, v22
    v_dot2_f32_bf16 v23, v111, v7, v23
    v_add_f32_dpp v24, v20, v20 row_ror:8 row_mask:0xf bank_mask:0x3
    s_nop 0
    v_add_f32_dpp v25, v22, v22 row_ror:8 row_mask:0xf bank_mask:0x3
    v_add_f32_dpp v24, v21, v21 row_ror:8 row_mask:0xf bank_mask:0xc
    v_add_f32_dpp v25, v23, v23 row_ror:8 row_mask:0xf bank_mask:0xc
    s_nop 0
    v_add_f32_dpp v26, v24, v24 row_shl:4 row_mask:0xf bank_mask:0x5
    v_add_f32_dpp v26, v25, v25 row_shr:4 row_mask:0xf bank_mask:0xa
    s_nop 1
    v_add_f32_dpp v26, v26, v26 quad_perm:[1,0,3,2] row_mask:0xf bank_mask:0xf
    s_nop 1
    v_add_f32_dpp v26, v26, v26 quad_perm:[2,3,0,1] row_mask:0xf bank_mask:0xf
    v_cvt_pk_bf16_f32 v26, v26, v26
    v_and_b32 v26, s98, v26
    v_mul_f32 v26, s96, v26
    v_cvt_pk_bf16_f32 v26, v26, v26
    v_and_b32 v26, s98, v26
    s_nop 1
    v_max_f32_dpp v27, v26, v26 row_ror:4 row_mask:0xf bank_mask:0xf
    s_nop 1
    v_max_f32_dpp v27, v27, v27 row_ror:8 row_mask:0xf bank_mask:0xf
    v_mov_b32 v28, v27
    s_nop 1
    v_permlane16_swap_b32 v27, v28
    v_max_f32 v27, v27, v28
    v_mov_b32 v28, v27
    s_nop 1
    v_permlane32_swap_b32 v27, v28
    v_max3_f32 v27, v27, v28, v16
    v_sub_f32 v28, v16, v27
    v_sub_f32 v29, v26, v27
    v_mul_f32 v28, s97, v28
    v_mul_f32 v29, s97, v29
    v_exp_f32 v28, v28
    v_exp_f32 v29, v29
    v_mov_b32 v16, v27
    v_fma_f32 v17, v17, v28, v29
    v_cvt_pk_bf16_f32 v29, v29, v29
    v_mul_f32 v12, v12, v28
    v_mul_f32 v13, v13, v28
    v_mul_f32 v14, v14, v28
    v_mul_f32 v15, v15, v28
    v_and_b32_dpp v32, v29, v8 row_newbcast:0 row_mask:0xf bank_mask:0xf
    v_and_b32_dpp v33, v29, v9 row_newbcast:0 row_mask:0xf bank_mask:0xf
    v_and_b32_dpp v34, v29, v10 row_newbcast:0 row_mask:0xf bank_mask:0xf
    v_and_b32_dpp v35, v29, v11 row_newbcast:0 row_mask:0xf bank_mask:0xf
    v_and_b32_dpp v36, v29, v8 row_newbcast:8 row_mask:0xf bank_mask:0xf
    v_and_b32_dpp v37, v29, v9 row_newbcast:8 row_mask:0xf bank_mask:0xf
    v_and_b32_dpp v38, v29, v10 row_newbcast:8 row_mask:0xf bank_mask:0xf
    v_and_b32_dpp v39, v29, v11 row_newbcast:8 row_mask:0xf bank_mask:0xf
    v_and_b32_dpp v40, v29, v8 row_newbcast:4 row_mask:0xf bank_mask:0xf
    v_and_b32_dpp v41, v29, v9 row_newbcast:4 row_mask:0xf bank_mask:0xf
    v_and_b32_dpp v42, v29, v10 row_newbcast:4 row_mask:0xf bank_mask:0xf
    v_and_b32_dpp v43, v29, v11 row_newbcast:4 row_mask:0xf bank_mask:0xf
    v_and_b32_dpp v44, v29, v8 row_newbcast:12 row_mask:0xf bank_mask:0xf
    v_and_b32_dpp v45, v29, v9 row_newbcast:12 row_mask:0xf bank_mask:0xf
    v_and_b32_dpp v46, v29, v10 row_newbcast:12 row_mask:0xf bank_mask:0xf
    v_and_b32_dpp v47, v29, v11 row_newbcast:12 row_mask:0xf bank_mask:0xf
    v_mfma_f32_16x16x32_bf16 v[12:15], v[32:35], a[32:35], v[12:15]
    v_mfma_f32_16x16x32_bf16 v[12:15], v[36:39], a[36:39], v[12:15]
    v_mfma_f32_16x16x32_bf16 v[12:15], v[40:43], a[40:43], v[12:15]
    v_mfma_f32_16x16x32_bf16 v[12:15], v[44:47], a[44:47], v[12:15]
    v_dot2_f32_bf16 v20, v112, v4, 0
    v_dot2_f32_bf16 v21, v116, v4, 0
    v_dot2_f32_bf16 v22, v120, v4, 0
    v_dot2_f32_bf16 v23, v124, v4, 0
    v_dot2_f32_bf16 v20, v113, v5, v20
    v_dot2_f32_bf16 v21, v117, v5, v21
    v_dot2_f32_bf16 v22, v121, v5, v22
    v_dot2_f32_bf16 v23, v125, v5, v23
    v_dot2_f32_bf16 v20, v114, v6, v20
    v_dot2_f32_bf16 v21, v118, v6, v21
    v_dot2_f32_bf16 v22, v122, v6, v22
    v_dot2_f32_bf16 v23, v126, v6, v23
    v_dot2_f32_bf16 v20, v115, v7, v20
    v_dot2_f32_bf16 v21, v119, v7, v21
    v_dot2_f32_bf16 v22, v123, v7, v22
    v_dot2_f32_bf16 v23, v127, v7, v23
    v_add_f32_dpp v24, v20, v20 row_ror:8 row_mask:0xf bank_mask:0x3
    s_nop 0
    v_add_f32_dpp v25, v22, v22 row_ror:8 row_mask:0xf bank_mask:0x3
    v_add_f32_dpp v24, v21, v21 row_ror:8 row_mask:0xf bank_mask:0xc
    v_add_f32_dpp v25, v23, v23 row_ror:8 row_mask:0xf bank_mask:0xc
    s_nop 0
    v_add_f32_dpp v26, v24, v24 row_shl:4 row_mask:0xf bank_mask:0x5
    v_add_f32_dpp v26, v25, v25 row_shr:4 row_mask:0xf bank_mask:0xa
    s_nop 1
    v_add_f32_dpp v26, v26, v26 quad_perm:[1,0,3,2] row_mask:0xf bank_mask:0xf
    s_nop 1
    v_add_f32_dpp v26, v26, v26 quad_perm:[2,3,0,1] row_mask:0xf bank_mask:0xf
    v_cvt_pk_bf16_f32 v26, v26, v26
    v_and_b32 v26, s98, v26
    v_mul_f32 v26, s96, v26
    v_cvt_pk_bf16_f32 v26, v26, v26
    v_and_b32 v26, s98, v26
    s_nop 1
    v_max_f32_dpp v27, v26, v26 row_ror:4 row_mask:0xf bank_mask:0xf
    s_nop 1
    v_max_f32_dpp v27, v27, v27 row_ror:8 row_mask:0xf bank_mask:0xf
    v_mov_b32 v28, v27
    s_nop 1
    v_permlane16_swap_b32 v27, v28
    v_max_f32 v27, v27, v28
    v_mov_b32 v28, v27
    s_nop 1
    v_permlane32_swap_b32 v27, v28
    v_max3_f32 v27, v27, v28, v16
    v_sub_f32 v28, v16, v27
    v_sub_f32 v29, v26, v27
    v_mul_f32 v28, s97, v28
    v_mul_f32 v29, s97, v29
    v_exp_f32 v28, v28
    v_exp_f32 v29, v29
    v_mov_b32 v16, v27
    v_fma_f32 v17, v17, v28, v29
    v_cvt_pk_bf16_f32 v29, v29, v29
    v_mul_f32 v12, v12, v28
    v_mul_f32 v13, v13, v28
    v_mul_f32 v14, v14, v28
    v_mul_f32 v15, v15, v28
    v_and_b32_dpp v32, v29, v8 row_newbcast:0 row_mask:0xf bank_mask:0xf
    v_and_b32_dpp v33, v29, v9 row_newbcast:0 row_mask:0xf bank_mask:0xf
    v_and_b32_dpp v34, v29, v10 row_newbcast:0 row_mask:0xf bank_mask:0xf
    v_and_b32_dpp v35, v29, v11 row_newbcast:0 row_mask:0xf bank_mask:0xf
    v_and_b32_dpp v36, v29, v8 row_newbcast:8 row_mask:0xf bank_mask:0xf
    v_and_b32_dpp v37, v29, v9 row_newbcast:8 row_mask:0xf bank_mask:0xf
    v_and_b32_dpp v38, v29, v10 row_newbcast:8 row_mask:0xf bank_mask:0xf
    v_and_b32_dpp v39, v29, v11 row_newbcast:8 row_mask:0xf bank_mask:0xf
    v_and_b32_dpp v40, v29, v8 row_newbcast:4 row_mask:0xf bank_mask:0xf
    v_and_b32_dpp v41, v29, v9 row_newbcast:4 row_mask:0xf bank_mask:0xf
    v_and_b32_dpp v42, v29, v10 row_newbcast:4 row_mask:0xf bank_mask:0xf
    v_and_b32_dpp v43, v29, v11 row_newbcast:4 row_mask:0xf bank_mask:0xf
    v_and_b32_dpp v44, v29, v8 row_newbcast:12 row_mask:0xf bank_mask:0xf
    v_and_b32_dpp v45, v29, v9 row_newbcast:12 row_mask:0xf bank_mask:0xf
    v_and_b32_dpp v46, v29, v10 row_newbcast:12 row_mask:0xf bank_mask:0xf
    v_and_b32_dpp v47, v29, v11 row_newbcast:12 row_mask:0xf bank_mask:0xf
    v_mfma_f32_16x16x32_bf16 v[12:15], v[32:35], a[48:51], v[12:15]
    v_mfma_f32_16x16x32_bf16 v[12:15], v[36:39], a[52:55], v[12:15]
    v_mfma_f32_16x16x32_bf16 v[12:15], v[40:43], a[56:59], v[12:15]
    v_mfma_f32_16x16x32_bf16 v[12:15], v[44:47], a[60:63], v[12:15]
    v_dot2_f32_bf16 v20, v128, v4, 0
    v_dot2_f32_bf16 v21, v132, v4, 0
    v_dot2_f32_bf16 v22, v136, v4, 0
    v_dot2_f32_bf16 v23, v140, v4, 0
    v_dot2_f32_bf16 v20, v129, v5, v20
    v_dot2_f32_bf16 v21, v133, v5, v21
    v_dot2_f32_bf16 v22, v137, v5, v22
    v_dot2_f32_bf16 v23, v141, v5, v23
    v_dot2_f32_bf16 v20, v130, v6, v20
    v_dot2_f32_bf16 v21, v134, v6, v21
    v_dot2_f32_bf16 v22, v138, v6, v22
    v_dot2_f32_bf16 v23, v142, v6, v23
    v_dot2_f32_bf16 v20, v131, v7, v20
    v_dot2_f32_bf16 v21, v135, v7, v21
    v_dot2_f32_bf16 v22, v139, v7, v22
    v_dot2_f32_bf16 v23, v143, v7, v23
    v_add_f32_dpp v24, v20, v20 row_ror:8 row_mask:0xf bank_mask:0x3
    s_nop 0
    v_add_f32_dpp v25, v22, v22 row_ror:8 row_mask:0xf bank_mask:0x3
    v_add_f32_dpp v24, v21, v21 row_ror:8 row_mask:0xf bank_mask:0xc
    v_add_f32_dpp v25, v23, v23 row_ror:8 row_mask:0xf bank_mask:0xc
    s_nop 0
    v_add_f32_dpp v26, v24, v24 row_shl:4 row_mask:0xf bank_mask:0x5
    v_add_f32_dpp v26, v25, v25 row_shr:4 row_mask:0xf bank_mask:0xa
    s_nop 1
    v_add_f32_dpp v26, v26, v26 quad_perm:[1,0,3,2] row_mask:0xf bank_mask:0xf
    s_nop 1
    v_add_f32_dpp v26, v26, v26 quad_perm:[2,3,0,1] row_mask:0xf bank_mask:0xf
    v_cvt_pk_bf16_f32 v26, v26, v26
    v_and_b32 v26, s98, v26
    v_mul_f32 v26, s96, v26
    v_cvt_pk_bf16_f32 v26, v26, v26
    v_and_b32 v26, s98, v26
    s_nop 1
    v_max_f32_dpp v27, v26, v26 row_ror:4 row_mask:0xf bank_mask:0xf
    s_nop 1
    v_max_f32_dpp v27, v27, v27 row_ror:8 row_mask:0xf bank_mask:0xf
    v_mov_b32 v28, v27
    s_nop 1
    v_permlane16_swap_b32 v27, v28
    v_max_f32 v27, v27, v28
    v_mov_b32 v28, v27
    s_nop 1
    v_permlane32_swap_b32 v27, v28
    v_max3_f32 v27, v27, v28, v16
    v_sub_f32 v28, v16, v27
    v_sub_f32 v29, v26, v27
    v_mul_f32 v28, s97, v28
    v_mul_f32 v29, s97, v29
    v_exp_f32 v28, v28
    v_exp_f32 v29, v29
    v_mov_b32 v16, v27
    v_fma_f32 v17, v17, v28, v29
    v_cvt_pk_bf16_f32 v29, v29, v29
    v_mul_f32 v12, v12, v28
    v_mul_f32 v13, v13, v28
    v_mul_f32 v14, v14, v28
    v_mul_f32 v15, v15, v28
    v_and_b32_dpp v32, v29, v8 row_newbcast:0 row_mask:0xf bank_mask:0xf
    v_and_b32_dpp v33, v29, v9 row_newbcast:0 row_mask:0xf bank_mask:0xf
    v_and_b32_dpp v34, v29, v10 row_newbcast:0 row_mask:0xf bank_mask:0xf
    v_and_b32_dpp v35, v29, v11 row_newbcast:0 row_mask:0xf bank_mask:0xf
    v_and_b32_dpp v36, v29, v8 row_newbcast:8 row_mask:0xf bank_mask:0xf
    v_and_b32_dpp v37, v29, v9 row_newbcast:8 row_mask:0xf bank_mask:0xf
    v_and_b32_dpp v38, v29, v10 row_newbcast:8 row_mask:0xf bank_mask:0xf
    v_and_b32_dpp v39, v29, v11 row_newbcast:8 row_mask:0xf bank_mask:0xf
    v_and_b32_dpp v40, v29, v8 row_newbcast:4 row_mask:0xf bank_mask:0xf
    v_and_b32_dpp v41, v29, v9 row_newbcast:4 row_mask:0xf bank_mask:0xf
    v_and_b32_dpp v42, v29, v10 row_newbcast:4 row_mask:0xf bank_mask:0xf
    v_and_b32_dpp v43, v29, v11 row_newbcast:4 row_mask:0xf bank_mask:0xf
    v_and_b32_dpp v44, v29, v8 row_newbcast:12 row_mask:0xf bank_mask:0xf
    v_and_b32_dpp v45, v29, v9 row_newbcast:12 row_mask:0xf bank_mask:0xf
    v_and_b32_dpp v46, v29, v10 row_newbcast:12 row_mask:0xf bank_mask:0xf
    v_and_b32_dpp v47, v29, v11 row_newbcast:12 row_mask:0xf bank_mask:0xf
    v_mfma_f32_16x16x32_bf16 v[12:15], v[32:35], a[64:67], v[12:15]
    v_mfma_f32_16x16x32_bf16 v[12:15], v[36:39], a[68:71], v[12:15]
    v_mfma_f32_16x16x32_bf16 v[12:15], v[40:43], a[72:75], v[12:15]
    v_mfma_f32_16x16x32_bf16 v[12:15], v[44:47], a[76:79], v[12:15]
    v_dot2_f32_bf16 v20, v144, v4, 0
    v_dot2_f32_bf16 v21, v148, v4, 0
    v_dot2_f32_bf16 v22, v152, v4, 0
    v_dot2_f32_bf16 v23, v156, v4, 0
    v_dot2_f32_bf16 v20, v145, v5, v20
    v_dot2_f32_bf16 v21, v149, v5, v21
    v_dot2_f32_bf16 v22, v153, v5, v22
    v_dot2_f32_bf16 v23, v157, v5, v23
    v_dot2_f32_bf16 v20, v146, v6, v20
    v_dot2_f32_bf16 v21, v150, v6, v21
    v_dot2_f32_bf16 v22, v154, v6, v22
    v_dot2_f32_bf16 v23, v158, v6, v23
    v_dot2_f32_bf16 v20, v147, v7, v20
    v_dot2_f32_bf16 v21, v151, v7, v21
    v_dot2_f32_bf16 v22, v155, v7, v22
    v_dot2_f32_bf16 v23, v159, v7, v23
    v_add_f32_dpp v24, v20, v20 row_ror:8 row_mask:0xf bank_mask:0x3
    s_nop 0
    v_add_f32_dpp v25, v22, v22 row_ror:8 row_mask:0xf bank_mask:0x3
    v_add_f32_dpp v24, v21, v21 row_ror:8 row_mask:0xf bank_mask:0xc
    v_add_f32_dpp v25, v23, v23 row_ror:8 row_mask:0xf bank_mask:0xc
    s_nop 0
    v_add_f32_dpp v26, v24, v24 row_shl:4 row_mask:0xf bank_mask:0x5
    v_add_f32_dpp v26, v25, v25 row_shr:4 row_mask:0xf bank_mask:0xa
    s_nop 1
    v_add_f32_dpp v26, v26, v26 quad_perm:[1,0,3,2] row_mask:0xf bank_mask:0xf
    s_nop 1
    v_add_f32_dpp v26, v26, v26 quad_perm:[2,3,0,1] row_mask:0xf bank_mask:0xf
    v_cvt_pk_bf16_f32 v26, v26, v26
    v_and_b32 v26, s98, v26
    v_mul_f32 v26, s96, v26
    v_cvt_pk_bf16_f32 v26, v26, v26
    v_and_b32 v26, s98, v26
    s_nop 1
    v_max_f32_dpp v27, v26, v26 row_ror:4 row_mask:0xf bank_mask:0xf
    s_nop 1
    v_max_f32_dpp v27, v27, v27 row_ror:8 row_mask:0xf bank_mask:0xf
    v_mov_b32 v28, v27
    s_nop 1
    v_permlane16_swap_b32 v27, v28
    v_max_f32 v27, v27, v28
    v_mov_b32 v28, v27
    s_nop 1
    v_permlane32_swap_b32 v27, v28
    v_max3_f32 v27, v27, v28, v16
    v_sub_f32 v28, v16, v27
    v_sub_f32 v29, v26, v27
    v_mul_f32 v28, s97, v28
    v_mul_f32 v29, s97, v29
    v_exp_f32 v28, v28
    v_exp_f32 v29, v29
    v_mov_b32 v16, v27
    v_fma_f32 v17, v17, v28, v29
    v_cvt_pk_bf16_f32 v29, v29, v29
    v_mul_f32 v12, v12, v28
    v_mul_f32 v13, v13, v28
    v_mul_f32 v14, v14, v28
    v_mul_f32 v15, v15, v28
    v_and_b32_dpp v32, v29, v8 row_newbcast:0 row_mask:0xf bank_mask:0xf
    v_and_b32_dpp v33, v29, v9 row_newbcast:0 row_mask:0xf bank_mask:0xf
    v_and_b32_dpp v34, v29, v10 row_newbcast:0 row_mask:0xf bank_mask:0xf
    v_and_b32_dpp v35, v29, v11 row_newbcast:0 row_mask:0xf bank_mask:0xf
    v_and_b32_dpp v36, v29, v8 row_newbcast:8 row_mask:0xf bank_mask:0xf
    v_and_b32_dpp v37, v29, v9 row_newbcast:8 row_mask:0xf bank_mask:0xf
    v_and_b32_dpp v38, v29, v10 row_newbcast:8 row_mask:0xf bank_mask:0xf
    v_and_b32_dpp v39, v29, v11 row_newbcast:8 row_mask:0xf bank_mask:0xf
    v_and_b32_dpp v40, v29, v8 row_newbcast:4 row_mask:0xf bank_mask:0xf
    v_and_b32_dpp v41, v29, v9 row_newbcast:4 row_mask:0xf bank_mask:0xf
    v_and_b32_dpp v42, v29, v10 row_newbcast:4 row_mask:0xf bank_mask:0xf
    v_and_b32_dpp v43, v29, v11 row_newbcast:4 row_mask:0xf bank_mask:0xf
    v_and_b32_dpp v44, v29, v8 row_newbcast:12 row_mask:0xf bank_mask:0xf
    v_and_b32_dpp v45, v29, v9 row_newbcast:12 row_mask:0xf bank_mask:0xf
    v_and_b32_dpp v46, v29, v10 row_newbcast:12 row_mask:0xf bank_mask:0xf
    v_and_b32_dpp v47, v29, v11 row_newbcast:12 row_mask:0xf bank_mask:0xf
    v_mfma_f32_16x16x32_bf16 v[12:15], v[32:35], a[80:83], v[12:15]
    v_mfma_f32_16x16x32_bf16 v[12:15], v[36:39], a[84:87], v[12:15]
    v_mfma_f32_16x16x32_bf16 v[12:15], v[40:43], a[88:91], v[12:15]
    v_mfma_f32_16x16x32_bf16 v[12:15], v[44:47], a[92:95], v[12:15]
    v_dot2_f32_bf16 v20, v160, v4, 0
    v_dot2_f32_bf16 v21, v164, v4, 0
    v_dot2_f32_bf16 v22, v168, v4, 0
    v_dot2_f32_bf16 v23, v172, v4, 0
    v_dot2_f32_bf16 v20, v161, v5, v20
    v_dot2_f32_bf16 v21, v165, v5, v21
    v_dot2_f32_bf16 v22, v169, v5, v22
    v_dot2_f32_bf16 v23, v173, v5, v23
    v_dot2_f32_bf16 v20, v162, v6, v20
    v_dot2_f32_bf16 v21, v166, v6, v21
    v_dot2_f32_bf16 v22, v170, v6, v22
    v_dot2_f32_bf16 v23, v174, v6, v23
    v_dot2_f32_bf16 v20, v163, v7, v20
    v_dot2_f32_bf16 v21, v167, v7, v21
    v_dot2_f32_bf16 v22, v171, v7, v22
    v_dot2_f32_bf16 v23, v175, v7, v23
    v_add_f32_dpp v24, v20, v20 row_ror:8 row_mask:0xf bank_mask:0x3
    s_nop 0
    v_add_f32_dpp v25, v22, v22 row_ror:8 row_mask:0xf bank_mask:0x3
    v_add_f32_dpp v24, v21, v21 row_ror:8 row_mask:0xf bank_mask:0xc
    v_add_f32_dpp v25, v23, v23 row_ror:8 row_mask:0xf bank_mask:0xc
    s_nop 0
    v_add_f32_dpp v26, v24, v24 row_shl:4 row_mask:0xf bank_mask:0x5
    v_add_f32_dpp v26, v25, v25 row_shr:4 row_mask:0xf bank_mask:0xa
    s_nop 1
    v_add_f32_dpp v26, v26, v26 quad_perm:[1,0,3,2] row_mask:0xf bank_mask:0xf
    s_nop 1
    v_add_f32_dpp v26, v26, v26 quad_perm:[2,3,0,1] row_mask:0xf bank_mask:0xf
    v_cvt_pk_bf16_f32 v26, v26, v26
    v_and_b32 v26, s98, v26
    v_mul_f32 v26, s96, v26
    v_cvt_pk_bf16_f32 v26, v26, v26
    v_and_b32 v26, s98, v26
    s_nop 1
    v_max_f32_dpp v27, v26, v26 row_ror:4 row_mask:0xf bank_mask:0xf
    s_nop 1
    v_max_f32_dpp v27, v27, v27 row_ror:8 row_mask:0xf bank_mask:0xf
    v_mov_b32 v28, v27
    s_nop 1
    v_permlane16_swap_b32 v27, v28
    v_max_f32 v27, v27, v28
    v_mov_b32 v28, v27
    s_nop 1
    v_permlane32_swap_b32 v27, v28
    v_max3_f32 v27, v27, v28, v16
    v_sub_f32 v28, v16, v27
    v_sub_f32 v29, v26, v27
    v_mul_f32 v28, s97, v28
    v_mul_f32 v29, s97, v29
    v_exp_f32 v28, v28
    v_exp_f32 v29, v29
    v_mov_b32 v16, v27
    v_fma_f32 v17, v17, v28, v29
    v_cvt_pk_bf16_f32 v29, v29, v29
    v_mul_f32 v12, v12, v28
    v_mul_f32 v13, v13, v28
    v_mul_f32 v14, v14, v28
    v_mul_f32 v15, v15, v28
    v_and_b32_dpp v32, v29, v8 row_newbcast:0 row_mask:0xf bank_mask:0xf
    v_and_b32_dpp v33, v29, v9 row_newbcast:0 row_mask:0xf bank_mask:0xf
    v_and_b32_dpp v34, v29, v10 row_newbcast:0 row_mask:0xf bank_mask:0xf
    v_and_b32_dpp v35, v29, v11 row_newbcast:0 row_mask:0xf bank_mask:0xf
    v_and_b32_dpp v36, v29, v8 row_newbcast:8 row_mask:0xf bank_mask:0xf
    v_and_b32_dpp v37, v29, v9 row_newbcast:8 row_mask:0xf bank_mask:0xf
    v_and_b32_dpp v38, v29, v10 row_newbcast:8 row_mask:0xf bank_mask:0xf
    v_and_b32_dpp v39, v29, v11 row_newbcast:8 row_mask:0xf bank_mask:0xf
    v_and_b32_dpp v40, v29, v8 row_newbcast:4 row_mask:0xf bank_mask:0xf
    v_and_b32_dpp v41, v29, v9 row_newbcast:4 row_mask:0xf bank_mask:0xf
    v_and_b32_dpp v42, v29, v10 row_newbcast:4 row_mask:0xf bank_mask:0xf
    v_and_b32_dpp v43, v29, v11 row_newbcast:4 row_mask:0xf bank_mask:0xf
    v_and_b32_dpp v44, v29, v8 row_newbcast:12 row_mask:0xf bank_mask:0xf
    v_and_b32_dpp v45, v29, v9 row_newbcast:12 row_mask:0xf bank_mask:0xf
    v_and_b32_dpp v46, v29, v10 row_newbcast:12 row_mask:0xf bank_mask:0xf
    v_and_b32_dpp v47, v29, v11 row_newbcast:12 row_mask:0xf bank_mask:0xf
    v_mfma_f32_16x16x32_bf16 v[12:15], v[32:35], a[96:99], v[12:15]
    v_mfma_f32_16x16x32_bf16 v[12:15], v[36:39], a[100:103], v[12:15]
    v_mfma_f32_16x16x32_bf16 v[12:15], v[40:43], a[104:107], v[12:15]
    v_mfma_f32_16x16x32_bf16 v[12:15], v[44:47], a[108:111], v[12:15]
    s_branch L_aback0
L_aext1:
    v_dot2_f32_bf16 v20, v176, v4, 0
    v_dot2_f32_bf16 v21, v180, v4, 0
    v_dot2_f32_bf16 v22, v184, v4, 0
    v_dot2_f32_bf16 v23, v188, v4, 0
    v_dot2_f32_bf16 v20, v177, v5, v20
    v_dot2_f32_bf16 v21, v181, v5, v21
    v_dot2_f32_bf16 v22, v185, v5, v22
    v_dot2_f32_bf16 v23, v189, v5, v23
    v_dot2_f32_bf16 v20, v178, v6, v20
    v_dot2_f32_bf16 v21, v182, v6, v21
    v_dot2_f32_bf16 v22, v186, v6, v22
    v_dot2_f32_bf16 v23, v190, v6, v23
    v_dot2_f32_bf16 v20, v179, v7, v20
    v_dot2_f32_bf16 v21, v183, v7, v21
    v_dot2_f32_bf16 v22, v187, v7, v22
    v_dot2_f32_bf16 v23, v191, v7, v23
    v_add_f32_dpp v24, v20, v20 row_ror:8 row_mask:0xf bank_mask:0x3
    s_nop 0
    v_add_f32_dpp v25, v22, v22 row_ror:8 row_mask:0xf bank_mask:0x3
    v_add_f32_dpp v24, v21, v21 row_ror:8 row_mask:0xf bank_mask:0xc
    v_add_f32_dpp v25, v23, v23 row_ror:8 row_mask:0xf bank_mask:0xc
    s_nop 0
    v_add_f32_dpp v26, v24, v24 row_shl:4 row_mask:0xf bank_mask:0x5
    v_add_f32_dpp v26, v25, v25 row_shr:4 row_mask:0xf bank_mask:0xa
    s_nop 1
    v_add_f32_dpp v26, v26, v26 quad_perm:[1,0,3,2] row_mask:0xf bank_mask:0xf
    s_nop 1
    v_add_f32_dpp v26, v26, v26 quad_perm:[2,3,0,1] row_mask:0xf bank_mask:0xf
    v_cvt_pk_bf16_f32 v26, v26, v26
    v_and_b32 v26, s98, v26
    v_mul_f32 v26, s96, v26
    v_cvt_pk_bf16_f32 v26, v26, v26
    v_and_b32 v26, s98, v26
    s_nop 1
    v_max_f32_dpp v27, v26, v26 row_ror:4 row_mask:0xf bank_mask:0xf
    s_nop 1
    v_max_f32_dpp v27, v27, v27 row_ror:8 row_mask:0xf bank_mask:0xf
    v_mov_b32 v28, v27
    s_nop 1
    v_permlane16_swap_b32 v27, v28
    v_max_f32 v27, v27, v28
    v_mov_b32 v28, v27
    s_nop 1
    v_permlane32_swap_b32 v27, v28
    v_max3_f32 v27, v27, v28, v16
    v_sub_f32 v28, v16, v27
    v_sub_f32 v29, v26, v27
    v_mul_f32 v28, s97, v28
    v_mul_f32 v29, s97, v29
    v_exp_f32 v28, v28
    v_exp_f32 v29, v29
    v_mov_b32 v16, v27
    v_fma_f32 v17, v17, v28, v29
    v_cvt_pk_bf16_f32 v29, v29, v29
    v_mul_f32 v12, v12, v28
    v_mul_f32 v13, v13, v28
    v_mul_f32 v14, v14, v28
    v_mul_f32 v15, v15, v28
    v_and_b32_dpp v32, v29, v8 row_newbcast:0 row_mask:0xf bank_mask:0xf
    v_and_b32_dpp v33, v29, v9 row_newbcast:0 row_mask:0xf bank_mask:0xf
    v_and_b32_dpp v34, v29, v10 row_newbcast:0 row_mask:0xf bank_mask:0xf
    v_and_b32_dpp v35, v29, v11 row_newbcast:0 row_mask:0xf bank_mask:0xf
    v_and_b32_dpp v36, v29, v8 row_newbcast:8 row_mask:0xf bank_mask:0xf
    v_and_b32_dpp v37, v29, v9 row_newbcast:8 row_mask:0xf bank_mask:0xf
    v_and_b32_dpp v38, v29, v10 row_newbcast:8 row_mask:0xf bank_mask:0xf
    v_and_b32_dpp v39, v29, v11 row_newbcast:8 row_mask:0xf bank_mask:0xf
    v_and_b32_dpp v40, v29, v8 row_newbcast:4 row_mask:0xf bank_mask:0xf
    v_and_b32_dpp v41, v29, v9 row_newbcast:4 row_mask:0xf bank_mask:0xf
    v_and_b32_dpp v42, v29, v10 row_newbcast:4 row_mask:0xf bank_mask:0xf
    v_and_b32_dpp v43, v29, v11 row_newbcast:4 row_mask:0xf bank_mask:0xf
    v_and_b32_dpp v44, v29, v8 row_newbcast:12 row_mask:0xf bank_mask:0xf
    v_and_b32_dpp v45, v29, v9 row_newbcast:12 row_mask:0xf bank_mask:0xf
    v_and_b32_dpp v46, v29, v10 row_newbcast:12 row_mask:0xf bank_mask:0xf
    v_and_b32_dpp v47, v29, v11 row_newbcast:12 row_mask:0xf bank_mask:0xf
    v_mfma_f32_16x16x32_bf16 v[12:15], v[32:35], a[112:115], v[12:15]
    v_mfma_f32_16x16x32_bf16 v[12:15], v[36:39], a[116:119], v[12:15]
    v_mfma_f32_16x16x32_bf16 v[12:15], v[40:43], a[120:123], v[12:15]
    v_mfma_f32_16x16x32_bf16 v[12:15], v[44:47], a[124:127], v[12:15]
    v_dot2_f32_bf16 v20, v192, v4, 0
    v_dot2_f32_bf16 v21, v196, v4, 0
    v_dot2_f32_bf16 v22, v200, v4, 0
    v_dot2_f32_bf16 v23, v204, v4, 0
    v_dot2_f32_bf16 v20, v193, v5, v20
    v_dot2_f32_bf16 v21, v197, v5, v21
    v_dot2_f32_bf16 v22, v201, v5, v22
    v_dot2_f32_bf16 v23, v205, v5, v23
    v_dot2_f32_bf16 v20, v194, v6, v20
    v_dot2_f32_bf16 v21, v198, v6, v21
    v_dot2_f32_bf16 v22, v202, v6, v22
    v_dot2_f32_bf16 v23, v206, v6, v23
    v_dot2_f32_bf16 v20, v195, v7, v20
    v_dot2_f32_bf16 v21, v199, v7, v21
    v_dot2_f32_bf16 v22, v203, v7, v22
    v_dot2_f32_bf16 v23, v207, v7, v23
    v_add_f32_dpp v24, v20, v20 row_ror:8 row_mask:0xf bank_mask:0x3
    s_nop 0
    v_add_f32_dpp v25, v22, v22 row_ror:8 row_mask:0xf bank_mask:0x3
    v_add_f32_dpp v24, v21, v21 row_ror:8 row_mask:0xf bank_mask:0xc
    v_add_f32_dpp v25, v23, v23 row_ror:8 row_mask:0xf bank_mask:0xc
    s_nop 0
    v_add_f32_dpp v26, v24, v24 row_shl:4 row_mask:0xf bank_mask:0x5
    v_add_f32_dpp v26, v25, v25 row_shr:4 row_mask:0xf bank_mask:0xa
    s_nop 1
    v_add_f32_dpp v26, v26, v26 quad_perm:[1,0,3,2] row_mask:0xf bank_mask:0xf
    s_nop 1
    v_add_f32_dpp v26, v26, v26 quad_perm:[2,3,0,1] row_mask:0xf bank_mask:0xf
    v_cvt_pk_bf16_f32 v26, v26, v26
    v_and_b32 v26, s98, v26
    v_mul_f32 v26, s96, v26
    v_cvt_pk_bf16_f32 v26, v26, v26
    v_and_b32 v26, s98, v26
    s_nop 1
    v_max_f32_dpp v27, v26, v26 row_ror:4 row_mask:0xf bank_mask:0xf
    s_nop 1
    v_max_f32_dpp v27, v27, v27 row_ror:8 row_mask:0xf bank_mask:0xf
    v_mov_b32 v28, v27
    s_nop 1
    v_permlane16_swap_b32 v27, v28
    v_max_f32 v27, v27, v28
    v_mov_b32 v28, v27
    s_nop 1
    v_permlane32_swap_b32 v27, v28
    v_max3_f32 v27, v27, v28, v16
    v_sub_f32 v28, v16, v27
    v_sub_f32 v29, v26, v27
    v_mul_f32 v28, s97, v28
    v_mul_f32 v29, s97, v29
    v_exp_f32 v28, v28
    v_exp_f32 v29, v29
    v_mov_b32 v16, v27
    v_fma_f32 v17, v17, v28, v29
    v_cvt_pk_bf16_f32 v29, v29, v29
    v_mul_f32 v12, v12, v28
    v_mul_f32 v13, v13, v28
    v_mul_f32 v14, v14, v28
    v_mul_f32 v15, v15, v28
    v_and_b32_dpp v32, v29, v8 row_newbcast:0 row_mask:0xf bank_mask:0xf
    v_and_b32_dpp v33, v29, v9 row_newbcast:0 row_mask:0xf bank_mask:0xf
    v_and_b32_dpp v34, v29, v10 row_newbcast:0 row_mask:0xf bank_mask:0xf
    v_and_b32_dpp v35, v29, v11 row_newbcast:0 row_mask:0xf bank_mask:0xf
    v_and_b32_dpp v36, v29, v8 row_newbcast:8 row_mask:0xf bank_mask:0xf
    v_and_b32_dpp v37, v29, v9 row_newbcast:8 row_mask:0xf bank_mask:0xf
    v_and_b32_dpp v38, v29, v10 row_newbcast:8 row_mask:0xf bank_mask:0xf
    v_and_b32_dpp v39, v29, v11 row_newbcast:8 row_mask:0xf bank_mask:0xf
    v_and_b32_dpp v40, v29, v8 row_newbcast:4 row_mask:0xf bank_mask:0xf
    v_and_b32_dpp v41, v29, v9 row_newbcast:4 row_mask:0xf bank_mask:0xf
    v_and_b32_dpp v42, v29, v10 row_newbcast:4 row_mask:0xf bank_mask:0xf
    v_and_b32_dpp v43, v29, v11 row_newbcast:4 row_mask:0xf bank_mask:0xf
    v_and_b32_dpp v44, v29, v8 row_newbcast:12 row_mask:0xf bank_mask:0xf
    v_and_b32_dpp v45, v29, v9 row_newbcast:12 row_mask:0xf bank_mask:0xf
    v_and_b32_dpp v46, v29, v10 row_newbcast:12 row_mask:0xf bank_mask:0xf
    v_and_b32_dpp v47, v29, v11 row_newbcast:12 row_mask:0xf bank_mask:0xf
    v_mfma_f32_16x16x32_bf16 v[12:15], v[32:35], a[128:131], v[12:15]
    v_mfma_f32_16x16x32_bf16 v[12:15], v[36:39], a[132:135], v[12:15]
    v_mfma_f32_16x16x32_bf16 v[12:15], v[40:43], a[136:139], v[12:15]
    v_mfma_f32_16x16x32_bf16 v[12:15], v[44:47], a[140:143], v[12:15]
    v_dot2_f32_bf16 v20, v208, v4, 0
    v_dot2_f32_bf16 v21, v212, v4, 0
    v_dot2_f32_bf16 v22, v216, v4, 0
    v_dot2_f32_bf16 v23, v220, v4, 0
    v_dot2_f32_bf16 v20, v209, v5, v20
    v_dot2_f32_bf16 v21, v213, v5, v21
    v_dot2_f32_bf16 v22, v217, v5, v22
    v_dot2_f32_bf16 v23, v221, v5, v23
    v_dot2_f32_bf16 v20, v210, v6, v20
    v_dot2_f32_bf16 v21, v214, v6, v21
    v_dot2_f32_bf16 v22, v218, v6, v22
    v_dot2_f32_bf16 v23, v222, v6, v23
    v_dot2_f32_bf16 v20, v211, v7, v20
    v_dot2_f32_bf16 v21, v215, v7, v21
    v_dot2_f32_bf16 v22, v219, v7, v22
    v_dot2_f32_bf16 v23, v223, v7, v23
    v_add_f32_dpp v24, v20, v20 row_ror:8 row_mask:0xf bank_mask:0x3
    s_nop 0
    v_add_f32_dpp v25, v22, v22 row_ror:8 row_mask:0xf bank_mask:0x3
    v_add_f32_dpp v24, v21, v21 row_ror:8 row_mask:0xf bank_mask:0xc
    v_add_f32_dpp v25, v23, v23 row_ror:8 row_mask:0xf bank_mask:0xc
    s_nop 0
    v_add_f32_dpp v26, v24, v24 row_shl:4 row_mask:0xf bank_mask:0x5
    v_add_f32_dpp v26, v25, v25 row_shr:4 row_mask:0xf bank_mask:0xa
    s_nop 1
    v_add_f32_dpp v26, v26, v26 quad_perm:[1,0,3,2] row_mask:0xf bank_mask:0xf
    s_nop 1
    v_add_f32_dpp v26, v26, v26 quad_perm:[2,3,0,1] row_mask:0xf bank_mask:0xf
    v_cvt_pk_bf16_f32 v26, v26, v26
    v_and_b32 v26, s98, v26
    v_mul_f32 v26, s96, v26
    v_cvt_pk_bf16_f32 v26, v26, v26
    v_and_b32 v26, s98, v26
    s_nop 1
    v_max_f32_dpp v27, v26, v26 row_ror:4 row_mask:0xf bank_mask:0xf
    s_nop 1
    v_max_f32_dpp v27, v27, v27 row_ror:8 row_mask:0xf bank_mask:0xf
    v_mov_b32 v28, v27
    s_nop 1
    v_permlane16_swap_b32 v27, v28
    v_max_f32 v27, v27, v28
    v_mov_b32 v28, v27
    s_nop 1
    v_permlane32_swap_b32 v27, v28
    v_max3_f32 v27, v27, v28, v16
    v_sub_f32 v28, v16, v27
    v_sub_f32 v29, v26, v27
    v_mul_f32 v28, s97, v28
    v_mul_f32 v29, s97, v29
    v_exp_f32 v28, v28
    v_exp_f32 v29, v29
    v_mov_b32 v16, v27
    v_fma_f32 v17, v17, v28, v29
    v_cvt_pk_bf16_f32 v29, v29, v29
    v_mul_f32 v12, v12, v28
    v_mul_f32 v13, v13, v28
    v_mul_f32 v14, v14, v28
    v_mul_f32 v15, v15, v28
    v_and_b32_dpp v32, v29, v8 row_newbcast:0 row_mask:0xf bank_mask:0xf
    v_and_b32_dpp v33, v29, v9 row_newbcast:0 row_mask:0xf bank_mask:0xf
    v_and_b32_dpp v34, v29, v10 row_newbcast:0 row_mask:0xf bank_mask:0xf
    v_and_b32_dpp v35, v29, v11 row_newbcast:0 row_mask:0xf bank_mask:0xf
    v_and_b32_dpp v36, v29, v8 row_newbcast:8 row_mask:0xf bank_mask:0xf
    v_and_b32_dpp v37, v29, v9 row_newbcast:8 row_mask:0xf bank_mask:0xf
    v_and_b32_dpp v38, v29, v10 row_newbcast:8 row_mask:0xf bank_mask:0xf
    v_and_b32_dpp v39, v29, v11 row_newbcast:8 row_mask:0xf bank_mask:0xf
    v_and_b32_dpp v40, v29, v8 row_newbcast:4 row_mask:0xf bank_mask:0xf
    v_and_b32_dpp v41, v29, v9 row_newbcast:4 row_mask:0xf bank_mask:0xf
    v_and_b32_dpp v42, v29, v10 row_newbcast:4 row_mask:0xf bank_mask:0xf
    v_and_b32_dpp v43, v29, v11 row_newbcast:4 row_mask:0xf bank_mask:0xf
    v_and_b32_dpp v44, v29, v8 row_newbcast:12 row_mask:0xf bank_mask:0xf
    v_and_b32_dpp v45, v29, v9 row_newbcast:12 row_mask:0xf bank_mask:0xf
    v_and_b32_dpp v46, v29, v10 row_newbcast:12 row_mask:0xf bank_mask:0xf
    v_and_b32_dpp v47, v29, v11 row_newbcast:12 row_mask:0xf bank_mask:0xf
    v_mfma_f32_16x16x32_bf16 v[12:15], v[32:35], a[144:147], v[12:15]
    v_mfma_f32_16x16x32_bf16 v[12:15], v[36:39], a[148:151], v[12:15]
    v_mfma_f32_16x16x32_bf16 v[12:15], v[40:43], a[152:155], v[12:15]
    v_mfma_f32_16x16x32_bf16 v[12:15], v[44:47], a[156:159], v[12:15]
    v_dot2_f32_bf16 v20, v224, v4, 0
    v_dot2_f32_bf16 v21, v228, v4, 0
    v_dot2_f32_bf16 v22, v232, v4, 0
    v_dot2_f32_bf16 v23, v236, v4, 0
    v_dot2_f32_bf16 v20, v225, v5, v20
    v_dot2_f32_bf16 v21, v229, v5, v21
    v_dot2_f32_bf16 v22, v233, v5, v22
    v_dot2_f32_bf16 v23, v237, v5, v23
    v_dot2_f32_bf16 v20, v226, v6, v20
    v_dot2_f32_bf16 v21, v230, v6, v21
    v_dot2_f32_bf16 v22, v234, v6, v22
    v_dot2_f32_bf16 v23, v238, v6, v23
    v_dot2_f32_bf16 v20, v227, v7, v20
    v_dot2_f32_bf16 v21, v231, v7, v21
    v_dot2_f32_bf16 v22, v235, v7, v22
    v_dot2_f32_bf16 v23, v239, v7, v23
    v_add_f32_dpp v24, v20, v20 row_ror:8 row_mask:0xf bank_mask:0x3
    s_nop 0
    v_add_f32_dpp v25, v22, v22 row_ror:8 row_mask:0xf bank_mask:0x3
    v_add_f32_dpp v24, v21, v21 row_ror:8 row_mask:0xf bank_mask:0xc
    v_add_f32_dpp v25, v23, v23 row_ror:8 row_mask:0xf bank_mask:0xc
    s_nop 0
    v_add_f32_dpp v26, v24, v24 row_shl:4 row_mask:0xf bank_mask:0x5
    v_add_f32_dpp v26, v25, v25 row_shr:4 row_mask:0xf bank_mask:0xa
    s_nop 1
    v_add_f32_dpp v26, v26, v26 quad_perm:[1,0,3,2] row_mask:0xf bank_mask:0xf
    s_nop 1
    v_add_f32_dpp v26, v26, v26 quad_perm:[2,3,0,1] row_mask:0xf bank_mask:0xf
    v_cvt_pk_bf16_f32 v26, v26, v26
    v_and_b32 v26, s98, v26
    v_mul_f32 v26, s96, v26
    v_cvt_pk_bf16_f32 v26, v26, v26
    v_and_b32 v26, s98, v26
    s_nop 1
    v_max_f32_dpp v27, v26, v26 row_ror:4 row_mask:0xf bank_mask:0xf
    s_nop 1
    v_max_f32_dpp v27, v27, v27 row_ror:8 row_mask:0xf bank_mask:0xf
    v_mov_b32 v28, v27
    s_nop 1
    v_permlane16_swap_b32 v27, v28
    v_max_f32 v27, v27, v28
    v_mov_b32 v28, v27
    s_nop 1
    v_permlane32_swap_b32 v27, v28
    v_max3_f32 v27, v27, v28, v16
    v_sub_f32 v28, v16, v27
    v_sub_f32 v29, v26, v27
    v_mul_f32 v28, s97, v28
    v_mul_f32 v29, s97, v29
    v_exp_f32 v28, v28
    v_exp_f32 v29, v29
    v_mov_b32 v16, v27
    v_fma_f32 v17, v17, v28, v29
    v_cvt_pk_bf16_f32 v29, v29, v29
    v_mul_f32 v12, v12, v28
    v_mul_f32 v13, v13, v28
    v_mul_f32 v14, v14, v28
    v_mul_f32 v15, v15, v28
    v_and_b32_dpp v32, v29, v8 row_newbcast:0 row_mask:0xf bank_mask:0xf
    v_and_b32_dpp v33, v29, v9 row_newbcast:0 row_mask:0xf bank_mask:0xf
    v_and_b32_dpp v34, v29, v10 row_newbcast:0 row_mask:0xf bank_mask:0xf
    v_and_b32_dpp v35, v29, v11 row_newbcast:0 row_mask:0xf bank_mask:0xf
    v_and_b32_dpp v36, v29, v8 row_newbcast:8 row_mask:0xf bank_mask:0xf
    v_and_b32_dpp v37, v29, v9 row_newbcast:8 row_mask:0xf bank_mask:0xf
    v_and_b32_dpp v38, v29, v10 row_newbcast:8 row_mask:0xf bank_mask:0xf
    v_and_b32_dpp v39, v29, v11 row_newbcast:8 row_mask:0xf bank_mask:0xf
    v_and_b32_dpp v40, v29, v8 row_newbcast:4 row_mask:0xf bank_mask:0xf
    v_and_b32_dpp v41, v29, v9 row_newbcast:4 row_mask:0xf bank_mask:0xf
    v_and_b32_dpp v42, v29, v10 row_newbcast:4 row_mask:0xf bank_mask:0xf
    v_and_b32_dpp v43, v29, v11 row_newbcast:4 row_mask:0xf bank_mask:0xf
    v_and_b32_dpp v44, v29, v8 row_newbcast:12 row_mask:0xf bank_mask:0xf
    v_and_b32_dpp v45, v29, v9 row_newbcast:12 row_mask:0xf bank_mask:0xf
    v_and_b32_dpp v46, v29, v10 row_newbcast:12 row_mask:0xf bank_mask:0xf
    v_and_b32_dpp v47, v29, v11 row_newbcast:12 row_mask:0xf bank_mask:0xf
    v_mfma_f32_16x16x32_bf16 v[12:15], v[32:35], a[160:163], v[12:15]
    v_mfma_f32_16x16x32_bf16 v[12:15], v[36:39], a[164:167], v[12:15]
    v_mfma_f32_16x16x32_bf16 v[12:15], v[40:43], a[168:171], v[12:15]
    v_mfma_f32_16x16x32_bf16 v[12:15], v[44:47], a[172:175], v[12:15]
    v_dot2_f32_bf16 v20, v240, v4, 0
    v_dot2_f32_bf16 v21, v244, v4, 0
    v_dot2_f32_bf16 v22, v248, v4, 0
    v_dot2_f32_bf16 v23, v252, v4, 0
    v_dot2_f32_bf16 v20, v241, v5, v20
    v_dot2_f32_bf16 v21, v245, v5, v21
    v_dot2_f32_bf16 v22, v249, v5, v22
    v_dot2_f32_bf16 v23, v253, v5, v23
    v_dot2_f32_bf16 v20, v242, v6, v20
    v_dot2_f32_bf16 v21, v246, v6, v21
    v_dot2_f32_bf16 v22, v250, v6, v22
    v_dot2_f32_bf16 v23, v254, v6, v23
    v_dot2_f32_bf16 v20, v243, v7, v20
    v_dot2_f32_bf16 v21, v247, v7, v21
    v_dot2_f32_bf16 v22, v251, v7, v22
    v_dot2_f32_bf16 v23, v255, v7, v23
    v_add_f32_dpp v24, v20, v20 row_ror:8 row_mask:0xf bank_mask:0x3
    s_nop 0
    v_add_f32_dpp v25, v22, v22 row_ror:8 row_mask:0xf bank_mask:0x3
    v_add_f32_dpp v24, v21, v21 row_ror:8 row_mask:0xf bank_mask:0xc
    v_add_f32_dpp v25, v23, v23 row_ror:8 row_mask:0xf bank_mask:0xc
    s_nop 0
    v_add_f32_dpp v26, v24, v24 row_shl:4 row_mask:0xf bank_mask:0x5
    v_add_f32_dpp v26, v25, v25 row_shr:4 row_mask:0xf bank_mask:0xa
    s_nop 1
    v_add_f32_dpp v26, v26, v26 quad_perm:[1,0,3,2] row_mask:0xf bank_mask:0xf
    s_nop 1
    v_add_f32_dpp v26, v26, v26 quad_perm:[2,3,0,1] row_mask:0xf bank_mask:0xf
    v_cvt_pk_bf16_f32 v26, v26, v26
    v_and_b32 v26, s98, v26
    v_mul_f32 v26, s96, v26
    v_cvt_pk_bf16_f32 v26, v26, v26
    v_and_b32 v26, s98, v26
    s_nop 1
    v_max_f32_dpp v27, v26, v26 row_ror:4 row_mask:0xf bank_mask:0xf
    s_nop 1
    v_max_f32_dpp v27, v27, v27 row_ror:8 row_mask:0xf bank_mask:0xf
    v_mov_b32 v28, v27
    s_nop 1
    v_permlane16_swap_b32 v27, v28
    v_max_f32 v27, v27, v28
    v_mov_b32 v28, v27
    s_nop 1
    v_permlane32_swap_b32 v27, v28
    v_max3_f32 v27, v27, v28, v16
    v_sub_f32 v28, v16, v27
    v_sub_f32 v29, v26, v27
    v_mul_f32 v28, s97, v28
    v_mul_f32 v29, s97, v29
    v_exp_f32 v28, v28
    v_exp_f32 v29, v29
    v_mov_b32 v16, v27
    v_fma_f32 v17, v17, v28, v29
    v_cvt_pk_bf16_f32 v29, v29, v29
    v_mul_f32 v12, v12, v28
    v_mul_f32 v13, v13, v28
    v_mul_f32 v14, v14, v28
    v_mul_f32 v15, v15, v28
    v_and_b32_dpp v32, v29, v8 row_newbcast:0 row_mask:0xf bank_mask:0xf
    v_and_b32_dpp v33, v29, v9 row_newbcast:0 row_mask:0xf bank_mask:0xf
    v_and_b32_dpp v34, v29, v10 row_newbcast:0 row_mask:0xf bank_mask:0xf
    v_and_b32_dpp v35, v29, v11 row_newbcast:0 row_mask:0xf bank_mask:0xf
    v_and_b32_dpp v36, v29, v8 row_newbcast:8 row_mask:0xf bank_mask:0xf
    v_and_b32_dpp v37, v29, v9 row_newbcast:8 row_mask:0xf bank_mask:0xf
    v_and_b32_dpp v38, v29, v10 row_newbcast:8 row_mask:0xf bank_mask:0xf
    v_and_b32_dpp v39, v29, v11 row_newbcast:8 row_mask:0xf bank_mask:0xf
    v_and_b32_dpp v40, v29, v8 row_newbcast:4 row_mask:0xf bank_mask:0xf
    v_and_b32_dpp v41, v29, v9 row_newbcast:4 row_mask:0xf bank_mask:0xf
    v_and_b32_dpp v42, v29, v10 row_newbcast:4 row_mask:0xf bank_mask:0xf
    v_and_b32_dpp v43, v29, v11 row_newbcast:4 row_mask:0xf bank_mask:0xf
    v_and_b32_dpp v44, v29, v8 row_newbcast:12 row_mask:0xf bank_mask:0xf
    v_and_b32_dpp v45, v29, v9 row_newbcast:12 row_mask:0xf bank_mask:0xf
    v_and_b32_dpp v46, v29, v10 row_newbcast:12 row_mask:0xf bank_mask:0xf
    v_and_b32_dpp v47, v29, v11 row_newbcast:12 row_mask:0xf bank_mask:0xf
    v_mfma_f32_16x16x32_bf16 v[12:15], v[32:35], a[176:179], v[12:15]
    v_mfma_f32_16x16x32_bf16 v[12:15], v[36:39], a[180:183], v[12:15]
    v_mfma_f32_16x16x32_bf16 v[12:15], v[40:43], a[184:187], v[12:15]
    v_mfma_f32_16x16x32_bf16 v[12:15], v[44:47], a[188:191], v[12:15]
    s_mov_b32 s56, 0
    s_branch L_aback1
L_aflag:
    s_sleep 2
    global_load_dword v57, v58, s[28:29] sc1
    s_waitcnt vmcnt(0)
    v_cmp_le_u32 vcc, 2, v57
    s_cbranch_vccnz L_aflag_ok
    s_sub_u32 s101, s101, 1
    s_cbranch_scc0 L_aflag
    s_mov_b32 s101, 0
    s_branch L_aflag_ok
L_aq:
    buffer_load_dwordx4 v[60:63], v59, s[44:47], s56 offen sc1
    s_waitcnt vmcnt(0)
    v_max3_u32 v20, v60, v61, v62
    v_max_u32 v20, v20, v63
    v_cmp_eq_u32 vcc, -1, v20
    s_cbranch_vccz L_aq_ok
    s_sleep 1
    s_sub_u32 s101, s101, 1
    s_cbranch_scc0 L_aq
    s_branch L_aq_ok
L_adone:
    v_add_f32_dpp v17, v17, v17 row_ror:4 row_mask:0xf bank_mask:0xf
    s_nop 1
    v_add_f32_dpp v17, v17, v17 row_ror:8 row_mask:0xf bank_mask:0xf
    v_mov_b32 v28, v17
    s_nop 1
    v_permlane16_swap_b32 v17, v28
    v_add_f32 v17, v17, v28
    v_mov_b32 v28, v17
    s_nop 1
    v_permlane32_swap_b32 v17, v28
    v_add_f32 v17, v17, v28
    v_cmp_gt_u32 vcc, 32, v1
    s_nop 1
    v_cndmask_b32 v20, v16, v12, vcc
    v_cndmask_b32 v21, v17, v13, vcc
    v_cndmask_b32 v22, v16, v14, vcc
    v_cndmask_b32 v23, v17, v15, vcc
    v_min_u32 v20, -2, v20
    v_min_u32 v21, -2, v21
    v_min_u32 v22, -2, v22
    v_min_u32 v23, -2, v23
    buffer_store_dwordx4 v[20:23], v3, s[44:47], s63 offen sc1
    s_endpgm
L_roleA_end:
L_roleH:
    s_mov_b32 s101, 100000
    s_getpc_b64 s[56:57]
L_pc_2:
    s_sub_u32 s56, s56, L_pc_2-L_roleH
    s_subb_u32 s57, s57, 0
    v_lshlrev_b32 v5, 7, v0
    v_min_u32 v6, L_roleH_end-L_roleH-4, v5
    global_load_dword v122, v6, s[56:57]
    v_mov_b32 v20, -1
    v_mov_b32 v21, -1
    v_mov_b32 v22, -1
    v_mov_b32 v23, -1
    v_mul_u32_u24 v7, 73728, v4
    v_lshrrev_b32 v5, 3, v3
    v_lshl_add_u32 v6, v5, 13, v7
    v_and_b32 v5, 7, v3
    v_lshl_add_u32 v6, v5, 4, v6
    v_lshl_add_u32 v7, v3, 3, v7
    v_add_u32 v7, 65536, v7
    s_lshl_b32 s56, s52, 7
    s_add_u32 s56, s56, 4718592
    s_lshl_b32 s54, s3, 14
    s_add_u32 s54, s54, s56
    s_add_u32 s55, s54, 4096
    s_and_b32 s57, s3, 1
    s_lshl_b32 s57, s57, 12
    s_add_u32 s56, s56, s57
    s_waitcnt lgkmcnt(0)
    s_mov_b32 s44, s30
    s_mov_b32 s45, s31
    s_mov_b32 s46, 536870912
    s_mov_b32 s47, 0x20000
    buffer_store_dwordx4 v[20:23], v6, s[44:47], s54 offen sc1
    buffer_store_dwordx4 v[20:23], v6, s[44:47], s55 offen sc1
    buffer_store_dwordx2 v[20:21], v7, s[44:47], s56 offen sc1
    v_mov_b32 v7, 536870912
    v_cmp_gt_u32 vcc, 32, v1
    s_nop 1
    v_cndmask_b32 v123, v7, v2, vcc
    s_lshl_b32 s98, s52, 12
    s_lshl_b32 s54, s3, 9
    s_add_u32 s98, s98, s54
    s_add_u32 s98, s98, 5242880
    buffer_store_dwordx4 v[20:23], v123, s[44:47], s98 offen sc1
    s_mov_b32 s40, s10
    s_mov_b32 s41, s11
    s_mov_b32 s42, 4718592
    s_mov_b32 s43, 0x20000
    s_mov_b32 s48, s4
    s_mov_b32 s49, s5
    s_mov_b32 s50, 4608
    s_mov_b32 s51, 0x20000
    v_lshrrev_b32 v5, 3, v3
    v_mul_u32_u24 v5, 1152, v5
    v_mul_u32_u24 v6, 36, v4
    v_add_u32 v5, v5, v6
    s_mul_i32 s54, s3, 144
    buffer_load_dwordx4 v[24:27], v5, s[48:51], s54 offen offset:0
    buffer_load_dwordx4 v[28:31], v5, s[48:51], s54 offen offset:16
    buffer_load_dword v32, v5, s[48:51], s54 offen offset:32
    buffer_load_dwordx4 v[36:39], v5, s[48:51], s54 offen offset:2304
    buffer_load_dwordx4 v[40:43], v5, s[48:51], s54 offen offset:2320
    buffer_load_dword v44, v5, s[48:51], s54 offen offset:2336
    v_mul_u32_u24 v120, 147456, v4
    v_lshl_add_u32 v120, v3, 4, v120
    s_mul_i32 s61, s3, 589824
    s_lshl_b32 s54, s52, 8
    s_add_u32 s61, s61, s54
    buffer_load_dwordx4 a[0:3], v120, s[40:43], s61 offen nt
    s_add_u32 s61, s61, 8192
    buffer_load_dwordx4 a[4:7], v120, s[40:43], s61 offen nt
    s_add_u32 s61, s61, 8192
    buffer_load_dwordx4 a[8:11], v120, s[40:43], s61 offen nt
    s_add_u32 s61, s61, 8192
    buffer_load_dwordx4 a[12:15], v120, s[40:43], s61 offen nt
    s_add_u32 s61, s61, 8192
    buffer_load_dwordx4 a[16:19], v120, s[40:43], s61 offen nt
    s_add_u32 s61, s61, 8192
    buffer_load_dwordx4 a[20:23], v120, s[40:43], s61 offen nt
    s_add_u32 s61, s61, 8192
    buffer_load_dwordx4 a[24:27], v120, s[40:43], s61 offen nt
    s_add_u32 s61, s61, 8192
    buffer_load_dwordx4 a[28:31], v120, s[40:43], s61 offen nt
    s_add_u32 s61, s61, 8192
    buffer_load_dwordx4 a[32:35], v120, s[40:43], s61 offen nt
    s_add_u32 s61, s61, 8192
    buffer_load_dwordx4 a[36:39], v120, s[40:43], s61 offen nt
    s_add_u32 s61, s61, 8192
    buffer_load_dwordx4 a[40:43], v120, s[40:43], s61 offen nt
    s_add_u32 s61, s61, 8192
    buffer_load_dwordx4 a[44:47], v120, s[40:43], s61 offen nt
    s_add_u32 s61, s61, 8192
    buffer_load_dwordx4 a[48:51], v120, s[40:43], s61 offen nt
    s_add_u32 s61, s61, 8192
    buffer_load_dwordx4 a[52:55], v120, s[40:43], s61 offen nt
    s_add_u32 s61, s61, 8192
    buffer_load_dwordx4 a[56:59], v120, s[40:43], s61 offen nt
    s_add_u32 s61, s61, 8192
    buffer_load_dwordx4 a[60:63], v120, s[40:43], s61 offen nt
    s_add_u32 s61, s61, 8192
    buffer_load_dwordx4 a[64:67], v120, s[40:43], s61 offen nt
    s_add_u32 s61, s61, 8192
    buffer_load_dwordx4 a[68:71], v120, s[40:43], s61 offen nt
    s_add_u32 s61, s61, 8192
    s_mov_b32 s32, s18
    s_mov_b32 s33, s19
    s_mov_b32 s34, 4718592
    s_mov_b32 s35, 0x20000
    s_mov_b32 s36, s14
    s_mov_b32 s37, s15
    s_mov_b32 s38, 4608
    s_mov_b32 s39, 0x20000
    v_lshrrev_b32 v5, 3, v3
    v_mul_u32_u24 v5, 1152, v5
    v_mul_u32_u24 v6, 72, v4
    v_add_u32 v5, v5, v6
    s_mul_i32 s54, s3, 288
    buffer_load_dwordx4 v[48:51], v5, s[36:39], s54 offen offset:0
    buffer_load_dwordx4 v[52:55], v5, s[36:39], s54 offen offset:16
    buffer_load_dwordx4 v[56:59], v5, s[36:39], s54 offen offset:32
    buffer_load_dwordx4 v[60:63], v5, s[36:39], s54 offen offset:48
    buffer_load_dwordx2 v[64:65], v5, s[36:39], s54 offen offset:64
    buffer_load_dwordx4 v[68:71], v5, s[36:39], s54 offen offset:2304
    buffer_load_dwordx4 v[72:75], v5, s[36:39], s54 offen offset:2320
    buffer_load_dwordx4 v[76:79], v5, s[36:39], s54 offen offset:2336
    buffer_load_dwordx4 v[80:83], v5, s[36:39], s54 offen offset:2352
    buffer_load_dwordx2 v[84:85], v5, s[36:39], s54 offen offset:2368
    v_mul_u32_u24 v120, 294912, v4
    v_lshl_add_u32 v120, v3, 4, v120
    s_mul_i32 s61, s3, 1179648
    s_lshl_b32 s54, s52, 8
    s_add_u32 s61, s61, s54
    buffer_load_dwordx4 a[112:115], v120, s[32:35], s61 offen nt
    s_add_u32 s61, s61, 8192
    buffer_load_dwordx4 a[116:119], v120, s[32:35], s61 offen nt
    s_add_u32 s61, s61, 8192
    buffer_load_dwordx4 a[120:123], v120, s[32:35], s61 offen nt
    s_add_u32 s61, s61, 8192
    buffer_load_dwordx4 a[124:127], v120, s[32:35], s61 offen nt
    s_add_u32 s61, s61, 8192
    buffer_load_dwordx4 a[128:131], v120, s[32:35], s61 offen nt
    s_add_u32 s61, s61, 8192
    buffer_load_dwordx4 a[132:135], v120, s[32:35], s61 offen nt
    s_add_u32 s61, s61, 8192
    buffer_load_dwordx4 a[136:139], v120, s[32:35], s61 offen nt
    s_add_u32 s61, s61, 8192
    buffer_load_dwordx4 a[140:143], v120, s[32:35], s61 offen nt
    s_add_u32 s61, s61, 8192
    buffer_load_dwordx4 a[144:147], v120, s[32:35], s61 offen nt
    s_add_u32 s61, s61, 8192
    s_mov_b32 s36, s20
    s_mov_b32 s37, s21
    s_mov_b32 s38, 4194304
    s_mov_b32 s39, 0x20000
    s_mov_b32 s40, s22
    s_mov_b32 s41, s23
    s_mov_b32 s42, 4194304
    s_mov_b32 s43, 0x20000
    v_lshlrev_b32 v5, 2, v4
    v_xor_b32 v5, v5, v3
    v_lshlrev_b32 v6, 13, v4
    v_xor_b32 v7, 0, v5
    v_lshl_add_u32 v88, v7, 4, v6
    v_xor_b32 v7, 1, v5
    v_lshl_add_u32 v89, v7, 4, v6
    v_xor_b32 v7, 2, v5
    v_lshl_add_u32 v90, v7, 4, v6
    v_xor_b32 v7, 3, v5
    v_lshl_add_u32 v91, v7, 4, v6
    s_lshl_b32 s62, s3, 20
    s_lshl_b32 s54, s52, 8
    s_add_u32 s62, s62, s54
    s_mov_b32 s60, s62
    s_lshl_b32 s63, s3, 15
    v_lshlrev_b32 v121, 18, v4
    v_lshl_add_u32 v121, v3, 4, v121
    v_lshrrev_b32 v5, 2, v3
    v_and_b32 v6, 3, v3
    v_lshl_add_u32 v7, v5, 3, v6
    v_lshlrev_b32 v92, 8, v7
    v_lshl_or_b32 v5, v6, 2, v5
    v_xor_b32 v5, v5, v4
    v_lshl_add_u32 v92, v5, 4, v92
    v_add_u32 v92, s63, v92
    v_xor_b32 v93, 64, v92
    v_xor_b32 v94, 128, v92
    v_xor_b32 v95, 192, v92
    v_and_b32 v5, 1, v3
    v_cmp_eq_u32 vcc, 1, v5
    v_mov_b32 v5, 0x0c0c0100
    v_mov_b32 v6, 0x01000c0c
    v_cndmask_b32 v5, v5, v6, vcc
    v_mov_b32 v6, 0x0c0c0302
    v_mov_b32 v7, 0x03020c0c
    v_cndmask_b32 v6, v6, v7, vcc
    v_bfe_u32 v7, v3, 1, 2
    v_mov_b32 v16, 0x0c0c0c0c
    v_cmp_eq_u32 vcc, 0, v7
    s_nop 1
    v_cndmask_b32 v8, v16, v5, vcc
    v_cndmask_b32 v9, v16, v6, vcc
    v_cmp_eq_u32 vcc, 1, v7
    s_nop 1
    v_cndmask_b32 v10, v16, v5, vcc
    v_cndmask_b32 v11, v16, v6, vcc
    v_cmp_eq_u32 vcc, 2, v7
    s_nop 1
    v_cndmask_b32 v12, v16, v5, vcc
    v_cndmask_b32 v13, v16, v6, vcc
    v_cmp_eq_u32 vcc, 3, v7
    s_nop 1
    v_cndmask_b32 v14, v16, v5, vcc
    v_cndmask_b32 v15, v16, v6, vcc
    s_waitcnt vmcnt(43)
    s_barrier
    s_cmp_lg_u32 s3, 0
    s_cbranch_scc1 L_nosig_3
    s_lshl_b32 s54, s52, 2
    v_mov_b32 v5, s54
    v_mov_b32 v6, 1
    s_mov_b64 exec, 1
    global_atomic_add v5, v6, s[28:29]
    s_mov_b64 exec, -1
L_nosig_3:
    s_waitcnt vmcnt(28)
    buffer_load_dwordx4 a[148:151], v120, s[32:35], s61 offen nt
    s_add_u32 s61, s61, 8192
    buffer_load_dwordx4 a[152:155], v120, s[32:35], s61 offen nt
    s_add_u32 s61, s61, 8192
    buffer_load_dwordx4 a[156:159], v120, s[32:35], s61 offen nt
    s_add_u32 s61, s61, 8192
    buffer_load_dwordx4 a[160:163], v120, s[32:35], s61 offen nt
    s_add_u32 s61, s61, 8192
    buffer_load_dwordx4 a[164:167], v120, s[32:35], s61 offen nt
    s_add_u32 s61, s61, 8192
    buffer_load_dwordx4 a[168:171], v120, s[32:35], s61 offen nt
    s_add_u32 s61, s61, 8192
    buffer_load_dwordx4 a[172:175], v120, s[32:35], s61 offen nt
    s_add_u32 s61, s61, 8192
    buffer_load_dwordx4 a[176:179], v120, s[32:35], s61 offen nt
    s_add_u32 s61, s61, 8192
    buffer_load_dwordx4 a[180:183], v120, s[32:35], s61 offen nt
    s_add_u32 s61, s61, 8192
    buffer_load_dwordx4 a[184:187], v120, s[32:35], s61 offen nt
    s_add_u32 s61, s61, 8192
    v_perm_b32 v96, v24, v24, v8
    v_perm_b32 v97, v24, v24, v10
    v_perm_b32 v98, v24, v24, v12
    v_perm_b32 v99, v24, v24, v14
    s_nop 1
    v_mfma_f32_16x16x32_bf16 v[112:115], v[96:99], a[0:3], 0
    v_perm_b32 v100, v36, v36, v8
    v_perm_b32 v101, v36, v36, v10
    v_perm_b32 v102, v36, v36, v12
    v_perm_b32 v103, v36, v36, v14
    s_nop 1
    v_mfma_f32_16x16x32_bf16 v[116:119], v[100:103], a[0:3], 0
    v_perm_b32 v104, v24, v24, v9
    v_perm_b32 v105, v24, v24, v11
    v_perm_b32 v106, v24, v24, v13
    v_perm_b32 v107, v24, v24, v15
    s_nop 1
    v_mfma_f32_16x16x32_bf16 v[112:115], v[104:107], a[4:7], v[112:115]
    v_perm_b32 v108, v36, v36, v9
    v_perm_b32 v109, v36, v36, v11
    v_perm_b32 v110, v36, v36, v13
    v_perm_b32 v111, v36, v36, v15
    s_nop 1
    v_mfma_f32_16x16x32_bf16 v[116:119], v[108:111], a[4:7], v[116:119]
    v_perm_b32 v96, v25, v25, v8
    v_perm_b32 v97, v25, v25, v10
    v_perm_b32 v98, v25, v25, v12
    v_perm_b32 v99, v25, v25, v14
    s_nop 1
    v_mfma_f32_16x16x32_bf16 v[112:115], v[96:99], a[8:11], v[112:115]
    v_perm_b32 v100, v37, v37, v8
    v_perm_b32 v101, v37, v37, v10
    v_perm_b32 v102, v37, v37, v12
    v_perm_b32 v103, v37, v37, v14
    s_nop 1
    v_mfma_f32_16x16x32_bf16 v[116:119], v[100:103], a[8:11], v[116:119]
    v_perm_b32 v104, v25, v25, v9
    v_perm_b32 v105, v25, v25, v11
    v_perm_b32 v106, v25, v25, v13
    v_perm_b32 v107, v25, v25, v15
    s_nop 1
    v_mfma_f32_16x16x32_bf16 v[112:115], v[104:107], a[12:15], v[112:115]
    v_perm_b32 v108, v37, v37, v9
    v_perm_b32 v109, v37, v37, v11
    v_perm_b32 v110, v37, v37, v13
    v_perm_b32 v111, v37, v37, v15
    s_nop 1
    v_mfma_f32_16x16x32_bf16 v[116:119], v[108:111], a[12:15], v[116:119]
    v_perm_b32 v96, v26, v26, v8
    v_perm_b32 v97, v26, v26, v10
    v_perm_b32 v98, v26, v26, v12
    v_perm_b32 v99, v26, v26, v14
    s_nop 1
    v_mfma_f32_16x16x32_bf16 v[112:115], v[96:99], a[16:19], v[112:115]
    v_perm_b32 v100, v38, v38, v8
    v_perm_b32 v101, v38, v38, v10
    v_perm_b32 v102, v38, v38, v12
    v_perm_b32 v103, v38, v38, v14
    s_nop 1
    v_mfma_f32_16x16x32_bf16 v[116:119], v[100:103], a[16:19], v[116:119]
    v_perm_b32 v104, v26, v26, v9
    v_perm_b32 v105, v26, v26, v11
    v_perm_b32 v106, v26, v26, v13
    v_perm_b32 v107, v26, v26, v15
    s_nop 1
    v_mfma_f32_16x16x32_bf16 v[112:115], v[104:107], a[20:23], v[112:115]
    v_perm_b32 v108, v38, v38, v9
    v_perm_b32 v109, v38, v38, v11
    v_perm_b32 v110, v38, v38, v13
    v_perm_b32 v111, v38, v38, v15
    s_nop 1
    v_mfma_f32_16x16x32_bf16 v[116:119], v[108:111], a[20:23], v[116:119]
    v_perm_b32 v96, v27, v27, v8
    v_perm_b32 v97, v27, v27, v10
    v_perm_b32 v98, v27, v27, v12
    v_perm_b32 v99, v27, v27, v14
    s_nop 1
    v_mfma_f32_16x16x32_bf16 v[112:115], v[96:99], a[24:27], v[112:115]
    v_perm_b32 v100, v39, v39, v8
    v_perm_b32 v101, v39, v39, v10
    v_perm_b32 v102, v39, v39, v12
    v_perm_b32 v103, v39, v39, v14
    s_nop 1
    v_mfma_f32_16x16x32_bf16 v[116:119], v[100:103], a[24:27], v[116:119]
    v_perm_b32 v104, v27, v27, v9
    v_perm_b32 v105, v27, v27, v11
    v_perm_b32 v106, v27, v27, v13
    v_perm_b32 v107, v27, v27, v15
    s_nop 1
    v_mfma_f32_16x16x32_bf16 v[112:115], v[104:107], a[28:31], v[112:115]
    v_perm_b32 v108, v39, v39, v9
    v_perm_b32 v109, v39, v39, v11
    v_perm_b32 v110, v39, v39, v13
    v_perm_b32 v111, v39, v39, v15
    s_nop 1
    v_mfma_f32_16x16x32_bf16 v[116:119], v[108:111], a[28:31], v[116:119]
    v_perm_b32 v96, v28, v28, v8
    v_perm_b32 v97, v28, v28, v10
    v_perm_b32 v98, v28, v28, v12
    v_perm_b32 v99, v28, v28, v14
    s_nop 1
    v_mfma_f32_16x16x32_bf16 v[112:115], v[96:99], a[32:35], v[112:115]
    v_perm_b32 v100, v40, v40, v8
    v_perm_b32 v101, v40, v40, v10
    v_perm_b32 v102, v40, v40, v12
    v_perm_b32 v103, v40, v40, v14
    s_nop 1
    v_mfma_f32_16x16x32_bf16 v[116:119], v[100:103], a[32:35], v[116:119]
    s_waitcnt vmcnt(29)
    buffer_load_dwordx4 a[188:191], v120, s[32:35], s61 offen nt
    s_add_u32 s61, s61, 8192
    buffer_load_dwordx4 a[192:195], v120, s[32:35], s61 offen nt
    s_add_u32 s61, s61, 8192
    buffer_load_dwordx4 a[196:199], v120, s[32:35], s61 offen nt
    s_add_u32 s61, s61, 8192
    buffer_load_dwordx4 a[200:203], v120, s[32:35], s61 offen nt
    s_add_u32 s61, s61, 8192
    buffer_load_dwordx4 a[204:207], v120, s[32:35], s61 offen nt
    s_add_u32 s61, s61, 8192
    buffer_load_dwordx4 a[208:211], v120, s[32:35], s61 offen nt
    s_add_u32 s61, s61, 8192
    buffer_load_dwordx4 a[212:215], v120, s[32:35], s61 offen nt
    s_add_u32 s61, s61, 8192
    buffer_load_dwordx4 a[216:219], v120, s[32:35], s61 offen nt
    s_add_u32 s61, s61, 8192
    buffer_load_dwordx4 a[220:223], v120, s[32:35], s61 offen nt
    s_add_u32 s61, s61, 8192
    v_perm_b32 v104, v28, v28, v9
    v_perm_b32 v105, v28, v28, v11
    v_perm_b32 v106, v28, v28, v13
    v_perm_b32 v107, v28, v28, v15
    s_nop 1
    v_mfma_f32_16x16x32_bf16 v[112:115], v[104:107], a[36:39], v[112:115]
    v_perm_b32 v108, v40, v40, v9
    v_perm_b32 v109, v40, v40, v11
    v_perm_b32 v110, v40, v40, v13
    v_perm_b32 v111, v40, v40, v15
    s_nop 1
    v_mfma_f32_16x16x32_bf16 v[116:119], v[108:111], a[36:39], v[116:119]
    v_perm_b32 v96, v29, v29, v8
    v_perm_b32 v97, v29, v29, v10
    v_perm_b32 v98, v29, v29, v12
    v_perm_b32 v99, v29, v29, v14
    s_nop 1
    v_mfma_f32_16x16x32_bf16 v[112:115], v[96:99], a[40:43], v[112:115]
    v_perm_b32 v100, v41, v41, v8
    v_perm_b32 v101, v41, v41, v10
    v_perm_b32 v102, v41, v41, v12
    v_perm_b32 v103, v41, v41, v14
    s_nop 1
    v_mfma_f32_16x16x32_bf16 v[116:119], v[100:103], a[40:43], v[116:119]
    v_perm_b32 v104, v29, v29, v9
    v_perm_b32 v105, v29, v29, v11
    v_perm_b32 v106, v29, v29, v13
    v_perm_b32 v107, v29, v29, v15
    s_nop 1
    v_mfma_f32_16x16x32_bf16 v[112:115], v[104:107], a[44:47], v[112:115]
    v_perm_b32 v108, v41, v41, v9
    v_perm_b32 v109, v41, v41, v11
    v_perm_b32 v110, v41, v41, v13
    v_perm_b32 v111, v41, v41, v15
    s_nop 1
    v_mfma_f32_16x16x32_bf16 v[116:119], v[108:111], a[44:47], v[116:119]
    v_perm_b32 v96, v30, v30, v8
    v_perm_b32 v97, v30, v30, v10
    v_perm_b32 v98, v30, v30, v12
    v_perm_b32 v99, v30, v30, v14
    s_nop 1
    v_mfma_f32_16x16x32_bf16 v[112:115], v[96:99], a[48:51], v[112:115]
    v_perm_b32 v100, v42, v42, v8
    v_perm_b32 v101, v42, v42, v10
    v_perm_b32 v102, v42, v42, v12
    v_perm_b32 v103, v42, v42, v14
    s_nop 1
    v_mfma_f32_16x16x32_bf16 v[116:119], v[100:103], a[48:51], v[116:119]
    v_perm_b32 v104, v30, v30, v9
    v_perm_b32 v105, v30, v30, v11
    v_perm_b32 v106, v30, v30, v13
    v_perm_b32 v107, v30, v30, v15
    s_nop 1
    v_mfma_f32_16x16x32_bf16 v[112:115], v[104:107], a[52:55], v[112:115]
    v_perm_b32 v108, v42, v42, v9
    v_perm_b32 v109, v42, v42, v11
    v_perm_b32 v110, v42, v42, v13
    v_perm_b32 v111, v42, v42, v15
    s_nop 1
    v_mfma_f32_16x16x32_bf16 v[116:119], v[108:111], a[52:55], v[116:119]
    v_perm_b32 v96, v31, v31, v8
    v_perm_b32 v97, v31, v31, v10
    v_perm_b32 v98, v31, v31, v12
    v_perm_b32 v99, v31, v31, v14
    s_nop 1
    v_mfma_f32_16x16x32_bf16 v[112:115], v[96:99], a[56:59], v[112:115]
    v_perm_b32 v100, v43, v43, v8
    v_perm_b32 v101, v43, v43, v10
    v_perm_b32 v102, v43, v43, v12
    v_perm_b32 v103, v43, v43, v14
    s_nop 1
    v_mfma_f32_16x16x32_bf16 v[116:119], v[100:103], a[56:59], v[116:119]
    v_perm_b32 v104, v31, v31, v9
    v_perm_b32 v105, v31, v31, v11
    v_perm_b32 v106, v31, v31, v13
    v_perm_b32 v107, v31, v31, v15
    s_nop 1
    v_mfma_f32_16x16x32_bf16 v[112:115], v[104:107], a[60:63], v[112:115]
    v_perm_b32 v108, v43, v43, v9
    v_perm_b32 v109, v43, v43, v11
    v_perm_b32 v110, v43, v43, v13
    v_perm_b32 v111, v43, v43, v15
    s_nop 1
    v_mfma_f32_16x16x32_bf16 v[116:119], v[108:111], a[60:63], v[116:119]
    v_perm_b32 v96, v32, v32, v8
    v_perm_b32 v97, v32, v32, v10
    v_perm_b32 v98, v32, v32, v12
    v_perm_b32 v99, v32, v32, v14
    s_nop 1
    v_mfma_f32_16x16x32_bf16 v[112:115], v[96:99], a[64:67], v[112:115]
    v_perm_b32 v100, v44, v44, v8
    v_perm_b32 v101, v44, v44, v10
    v_perm_b32 v102, v44, v44, v12
    v_perm_b32 v103, v44, v44, v14
    s_nop 1
    v_mfma_f32_16x16x32_bf16 v[116:119], v[100:103], a[64:67], v[116:119]
    v_perm_b32 v104, v32, v32, v9
    v_perm_b32 v105, v32, v32, v11
    v_perm_b32 v106, v32, v32, v13
    v_perm_b32 v107, v32, v32, v15
    s_nop 1
    v_mfma_f32_16x16x32_bf16 v[112:115], v[104:107], a[68:71], v[112:115]
    v_perm_b32 v108, v44, v44, v9
    v_perm_b32 v109, v44, v44, v11
    v_perm_b32 v110, v44, v44, v13
    v_perm_b32 v111, v44, v44, v15
    s_nop 1
    v_mfma_f32_16x16x32_bf16 v[116:119], v[108:111], a[68:71], v[116:119]
    v_lshrrev_b32 v5, 1, v4
    v_lshlrev_b32 v5, 9, v5
    v_lshl_add_u32 v5, v3, 5, v5
    v_and_b32 v6, 1, v4
    v_lshl_add_u32 v5, v6, 4, v5
    s_lshl_b32 s54, s3, 11
    s_add_u32 s54, s54, 139264
    v_add_u32 v5, s54, v5
    ds_write_b128 v5, v[112:115]
    ds_write_b128 v5, v[116:119] offset:1024
    s_waitcnt lgkmcnt(0)
    s_barrier
    s_lshl_b32 s54, s3, 9
    s_add_u32 s54, s54, 139264
    v_add_u32 v5, s54, v2
    ds_read_b128 v[96:99], v5 offset:0
    ds_read_b128 v[100:103], v5 offset:2048
    ds_read_b128 v[104:107], v5 offset:4096
    ds_read_b128 v[108:111], v5 offset:6144
    s_waitcnt lgkmcnt(0)
    v_add_f32 v96, v96, v100
    v_add_f32 v104, v104, v108
    v_add_f32 v97, v97, v101
    v_add_f32 v105, v105, v109
    v_add_f32 v98, v98, v102
    v_add_f32 v106, v106, v110
    v_add_f32 v99, v99, v103
    v_add_f32 v107, v107, v111
    v_add_f32 v96, v96, v104
    v_add_f32 v97, v97, v105
    v_add_f32 v98, v98, v106
    v_add_f32 v99, v99, v107
    v_min_u32 v124, -2, v96
    v_min_u32 v125, -2, v97
    v_min_u32 v126, -2, v98
    v_min_u32 v127, -2, v99
    buffer_store_dwordx4 v[124:127], v123, s[44:47], s98 offen sc1
    s_waitcnt vmcnt(20)
    buffer_load_dwordx4 a[224:227], v120, s[32:35], s61 offen nt
    s_add_u32 s61, s61, 8192
    buffer_load_dwordx4 a[228:231], v120, s[32:35], s61 offen nt
    s_add_u32 s61, s61, 8192
    buffer_load_dwordx4 a[232:235], v120, s[32:35], s61 offen nt
    s_add_u32 s61, s61, 8192
    buffer_load_dwordx4 a[236:239], v120, s[32:35], s61 offen nt
    s_add_u32 s61, s61, 8192
    buffer_load_dwordx4 a[240:243], v120, s[32:35], s61 offen nt
    s_add_u32 s61, s61, 8192
    buffer_load_dwordx4 a[244:247], v120, s[32:35], s61 offen nt
    s_add_u32 s61, s61, 8192
    buffer_load_dwordx4 a[248:251], v120, s[32:35], s61 offen nt
    s_add_u32 s61, s61, 8192
    buffer_load_dwordx4 a[252:255], v120, s[32:35], s61 offen nt
    s_add_u32 s61, s61, 8192
    s_add_u32 m0, s63, 0
    s_nop 0
    buffer_load_dwordx4 v88, s[36:39], s60 offen nt lds
    s_add_u32 s60, s60, 32768
    v_perm_b32 v96, v48, v48, v8
    v_perm_b32 v97, v48, v48, v10
    v_perm_b32 v98, v48, v48, v12
    v_perm_b32 v99, v48, v48, v14
    s_nop 1
    v_mfma_f32_16x16x32_bf16 v[112:115], v[96:99], a[112:115], 0
    v_perm_b32 v100, v68, v68, v8
    v_perm_b32 v101, v68, v68, v10
    v_perm_b32 v102, v68, v68, v12
    v_perm_b32 v103, v68, v68, v14
    s_nop 1
    v_mfma_f32_16x16x32_bf16 v[116:119], v[100:103], a[112:115], 0
    v_perm_b32 v104, v48, v48, v9
    v_perm_b32 v105, v48, v48, v11
    v_perm_b32 v106, v48, v48, v13
    v_perm_b32 v107, v48, v48, v15
    s_nop 1
    v_mfma_f32_16x16x32_bf16 v[112:115], v[104:107], a[116:119], v[112:115]
    v_perm_b32 v108, v68, v68, v9
    v_perm_b32 v109, v68, v68, v11
    v_perm_b32 v110, v68, v68, v13
    v_perm_b32 v111, v68, v68, v15
    s_nop 1
    v_mfma_f32_16x16x32_bf16 v[116:119], v[108:111], a[116:119], v[116:119]
    v_perm_b32 v96, v49, v49, v8
    v_perm_b32 v97, v49, v49, v10
    v_perm_b32 v98, v49, v49, v12
    v_perm_b32 v99, v49, v49, v14
    s_nop 1
    v_mfma_f32_16x16x32_bf16 v[112:115], v[96:99], a[120:123], v[112:115]
    v_perm_b32 v100, v69, v69, v8
    v_perm_b32 v101, v69, v69, v10
    v_perm_b32 v102, v69, v69, v12
    v_perm_b32 v103, v69, v69, v14
    s_nop 1
    v_mfma_f32_16x16x32_bf16 v[116:119], v[100:103], a[120:123], v[116:119]
    v_perm_b32 v104, v49, v49, v9
    v_perm_b32 v105, v49, v49, v11
    v_perm_b32 v106, v49, v49, v13
    v_perm_b32 v107, v49, v49, v15
    s_nop 1
    v_mfma_f32_16x16x32_bf16 v[112:115], v[104:107], a[124:127], v[112:115]
    v_perm_b32 v108, v69, v69, v9
    v_perm_b32 v109, v69, v69, v11
    v_perm_b32 v110, v69, v69, v13
    v_perm_b32 v111, v69, v69, v15
    s_nop 1
    v_mfma_f32_16x16x32_bf16 v[116:119], v[108:111], a[124:127], v[116:119]
    v_perm_b32 v96, v50, v50, v8
    v_perm_b32 v97, v50, v50, v10
    v_perm_b32 v98, v50, v50, v12
    v_perm_b32 v99, v50, v50, v14
    s_nop 1
    v_mfma_f32_16x16x32_bf16 v[112:115], v[96:99], a[128:131], v[112:115]
    v_perm_b32 v100, v70, v70, v8
    v_perm_b32 v101, v70, v70, v10
    v_perm_b32 v102, v70, v70, v12
    v_perm_b32 v103, v70, v70, v14
    s_nop 1
    v_mfma_f32_16x16x32_bf16 v[116:119], v[100:103], a[128:131], v[116:119]
    v_perm_b32 v104, v50, v50, v9
    v_perm_b32 v105, v50, v50, v11
    v_perm_b32 v106, v50, v50, v13
    v_perm_b32 v107, v50, v50, v15
    s_nop 1
    v_mfma_f32_16x16x32_bf16 v[112:115], v[104:107], a[132:135], v[112:115]
    v_perm_b32 v108, v70, v70, v9
    v_perm_b32 v109, v70, v70, v11
    v_perm_b32 v110, v70, v70, v13
    v_perm_b32 v111, v70, v70, v15
    s_nop 1
    v_mfma_f32_16x16x32_bf16 v[116:119], v[108:111], a[132:135], v[116:119]
    v_perm_b32 v96, v51, v51, v8
    v_perm_b32 v97, v51, v51, v10
    v_perm_b32 v98, v51, v51, v12
    v_perm_b32 v99, v51, v51, v14
    s_nop 1
    v_mfma_f32_16x16x32_bf16 v[112:115], v[96:99], a[136:139], v[112:115]
    v_perm_b32 v100, v71, v71, v8
    v_perm_b32 v101, v71, v71, v10
    v_perm_b32 v102, v71, v71, v12
    v_perm_b32 v103, v71, v71, v14
    s_nop 1
    v_mfma_f32_16x16x32_bf16 v[116:119], v[100:103], a[136:139], v[116:119]
    v_perm_b32 v104, v51, v51, v9
    v_perm_b32 v105, v51, v51, v11
    v_perm_b32 v106, v51, v51, v13
    v_perm_b32 v107, v51, v51, v15
    s_nop 1
    v_mfma_f32_16x16x32_bf16 v[112:115], v[104:107], a[140:143], v[112:115]
    v_perm_b32 v108, v71, v71, v9
    v_perm_b32 v109, v71, v71, v11
    v_perm_b32 v110, v71, v71, v13
    v_perm_b32 v111, v71, v71, v15
    s_nop 1
    v_mfma_f32_16x16x32_bf16 v[116:119], v[108:111], a[140:143], v[116:119]
    v_perm_b32 v96, v52, v52, v8
    v_perm_b32 v97, v52, v52, v10
    v_perm_b32 v98, v52, v52, v12
    v_perm_b32 v99, v52, v52, v14
    s_nop 1
    v_mfma_f32_16x16x32_bf16 v[112:115], v[96:99], a[144:147], v[112:115]
    v_perm_b32 v100, v72, v72, v8
    v_perm_b32 v101, v72, v72, v10
    v_perm_b32 v102, v72, v72, v12
    v_perm_b32 v103, v72, v72, v14
    s_nop 1
    v_mfma_f32_16x16x32_bf16 v[116:119], v[100:103], a[144:147], v[116:119]
    s_waitcnt vmcnt(20)
    s_add_u32 m0, s63, 1024
    s_nop 0
    buffer_load_dwordx4 v88, s[36:39], s60 offen nt lds
    s_add_u32 s60, s60, 32768
    s_add_u32 m0, s63, 2048
    s_nop 0
    buffer_load_dwordx4 v89, s[36:39], s60 offen nt lds
    s_add_u32 s60, s60, 32768
    s_add_u32 m0, s63, 3072
    s_nop 0
    buffer_load_dwordx4 v89, s[36:39], s60 offen nt lds
    s_add_u32 s60, s60, 32768
    s_add_u32 m0, s63, 4096
    s_nop 0
    buffer_load_dwordx4 v90, s[36:39], s60 offen nt lds
    s_add_u32 s60, s60, 32768
    s_add_u32 m0, s63, 5120
    s_nop 0
    buffer_load_dwordx4 v90, s[36:39], s60 offen nt lds
    s_add_u32 s60, s60, 32768
    s_add_u32 m0, s63, 6144
    s_nop 0
    buffer_load_dwordx4 v91, s[36:39], s60 offen nt lds
    s_add_u32 s60, s60, 32768
    s_add_u32 m0, s63, 7168
    s_nop 0
    buffer_load_dwordx4 v91, s[36:39], s60 offen nt lds
    s_add_u32 s60, s60, 32768
    s_add_u32 m0, s63, 8192
    s_nop 0
    buffer_load_dwordx4 v88, s[36:39], s60 offen nt lds
    s_add_u32 s60, s60, 32768
    s_add_u32 m0, s63, 9216
    s_nop 0
    buffer_load_dwordx4 v88, s[36:39], s60 offen nt lds
    s_add_u32 s60, s60, 32768
    v_perm_b32 v104, v52, v52, v9
    v_perm_b32 v105, v52, v52, v11
    v_perm_b32 v106, v52, v52, v13
    v_perm_b32 v107, v52, v52, v15
    s_nop 1
    v_mfma_f32_16x16x32_bf16 v[112:115], v[104:107], a[148:151], v[112:115]
    v_perm_b32 v108, v72, v72, v9
    v_perm_b32 v109, v72, v72, v11
    v_perm_b32 v110, v72, v72, v13
    v_perm_b32 v111, v72, v72, v15
    s_nop 1
    v_mfma_f32_16x16x32_bf16 v[116:119], v[108:111], a[148:151], v[116:119]
    v_perm_b32 v96, v53, v53, v8
    v_perm_b32 v97, v53, v53, v10
    v_perm_b32 v98, v53, v53, v12
    v_perm_b32 v99, v53, v53, v14
    s_nop 1
    v_mfma_f32_16x16x32_bf16 v[112:115], v[96:99], a[152:155], v[112:115]
    v_perm_b32 v100, v73, v73, v8
    v_perm_b32 v101, v73, v73, v10
    v_perm_b32 v102, v73, v73, v12
    v_perm_b32 v103, v73, v73, v14
    s_nop 1
    v_mfma_f32_16x16x32_bf16 v[116:119], v[100:103], a[152:155], v[116:119]
    v_perm_b32 v104, v53, v53, v9
    v_perm_b32 v105, v53, v53, v11
    v_perm_b32 v106, v53, v53, v13
    v_perm_b32 v107, v53, v53, v15
    s_nop 1
    v_mfma_f32_16x16x32_bf16 v[112:115], v[104:107], a[156:159], v[112:115]
    v_perm_b32 v108, v73, v73, v9
    v_perm_b32 v109, v73, v73, v11
    v_perm_b32 v110, v73, v73, v13
    v_perm_b32 v111, v73, v73, v15
    s_nop 1
    v_mfma_f32_16x16x32_bf16 v[116:119], v[108:111], a[156:159], v[116:119]
    v_perm_b32 v96, v54, v54, v8
    v_perm_b32 v97, v54, v54, v10
    v_perm_b32 v98, v54, v54, v12
    v_perm_b32 v99, v54, v54, v14
    s_nop 1
    v_mfma_f32_16x16x32_bf16 v[112:115], v[96:99], a[160:163], v[112:115]
    v_perm_b32 v100, v74, v74, v8
    v_perm_b32 v101, v74, v74, v10
    v_perm_b32 v102, v74, v74, v12
    v_perm_b32 v103, v74, v74, v14
    s_nop 1
    v_mfma_f32_16x16x32_bf16 v[116:119], v[100:103], a[160:163], v[116:119]
    v_perm_b32 v104, v54, v54, v9
    v_perm_b32 v105, v54, v54, v11
    v_perm_b32 v106, v54, v54, v13
    v_perm_b32 v107, v54, v54, v15
    s_nop 1
    v_mfma_f32_16x16x32_bf16 v[112:115], v[104:107], a[164:167], v[112:115]
    v_perm_b32 v108, v74, v74, v9
    v_perm_b32 v109, v74, v74, v11
    v_perm_b32 v110, v74, v74, v13
    v_perm_b32 v111, v74, v74, v15
    s_nop 1
    v_mfma_f32_16x16x32_bf16 v[116:119], v[108:111], a[164:167], v[116:119]
    v_perm_b32 v96, v55, v55, v8
    v_perm_b32 v97, v55, v55, v10
    v_perm_b32 v98, v55, v55, v12
    v_perm_b32 v99, v55, v55, v14
    s_nop 1
    v_mfma_f32_16x16x32_bf16 v[112:115], v[96:99], a[168:171], v[112:115]
    v_perm_b32 v100, v75, v75, v8
    v_perm_b32 v101, v75, v75, v10
    v_perm_b32 v102, v75, v75, v12
    v_perm_b32 v103, v75, v75, v14
    s_nop 1
    v_mfma_f32_16x16x32_bf16 v[116:119], v[100:103], a[168:171], v[116:119]
    v_perm_b32 v104, v55, v55, v9
    v_perm_b32 v105, v55, v55, v11
    v_perm_b32 v106, v55, v55, v13
    v_perm_b32 v107, v55, v55, v15
    s_nop 1
    v_mfma_f32_16x16x32_bf16 v[112:115], v[104:107], a[172:175], v[112:115]
    v_perm_b32 v108, v75, v75, v9
    v_perm_b32 v109, v75, v75, v11
    v_perm_b32 v110, v75, v75, v13
    v_perm_b32 v111, v75, v75, v15
    s_nop 1
    v_mfma_f32_16x16x32_bf16 v[116:119], v[108:111], a[172:175], v[116:119]
    v_perm_b32 v96, v56, v56, v8
    v_perm_b32 v97, v56, v56, v10
    v_perm_b32 v98, v56, v56, v12
    v_perm_b32 v99, v56, v56, v14
    s_nop 1
    v_mfma_f32_16x16x32_bf16 v[112:115], v[96:99], a[176:179], v[112:115]
    v_perm_b32 v100, v76, v76, v8
    v_perm_b32 v101, v76, v76, v10
    v_perm_b32 v102, v76, v76, v12
    v_perm_b32 v103, v76, v76, v14
    s_nop 1
    v_mfma_f32_16x16x32_bf16 v[116:119], v[100:103], a[176:179], v[116:119]
    v_perm_b32 v104, v56, v56, v9
    v_perm_b32 v105, v56, v56, v11
    v_perm_b32 v106, v56, v56, v13
    v_perm_b32 v107, v56, v56, v15
    s_nop 1
    v_mfma_f32_16x16x32_bf16 v[112:115], v[104:107], a[180:183], v[112:115]
    v_perm_b32 v108, v76, v76, v9
    v_perm_b32 v109, v76, v76, v11
    v_perm_b32 v110, v76, v76, v13
    v_perm_b32 v111, v76, v76, v15
    s_nop 1
    v_mfma_f32_16x16x32_bf16 v[116:119], v[108:111], a[180:183], v[116:119]
    s_waitcnt vmcnt(20)
    s_add_u32 m0, s63, 10240
    s_nop 0
    buffer_load_dwordx4 v89, s[36:39], s60 offen nt lds
    s_add_u32 s60, s60, 32768
    s_add_u32 m0, s63, 11264
    s_nop 0
    buffer_load_dwordx4 v89, s[36:39], s60 offen nt lds
    s_add_u32 s60, s60, 32768
    s_add_u32 m0, s63, 12288
    s_nop 0
    buffer_load_dwordx4 v90, s[36:39], s60 offen nt lds
    s_add_u32 s60, s60, 32768
    s_add_u32 m0, s63, 13312
    s_nop 0
    buffer_load_dwordx4 v90, s[36:39], s60 offen nt lds
    s_add_u32 s60, s60, 32768
    s_add_u32 m0, s63, 14336
    s_nop 0
    buffer_load_dwordx4 v91, s[36:39], s60 offen nt lds
    s_add_u32 s60, s60, 32768
    s_add_u32 m0, s63, 15360
    s_nop 0
    buffer_load_dwordx4 v91, s[36:39], s60 offen nt lds
    s_add_u32 s60, s60, 32768
    s_add_u32 m0, s63, 16384
    s_nop 0
    buffer_load_dwordx4 v88, s[36:39], s60 offen nt lds
    s_add_u32 s60, s60, 32768
    s_add_u32 m0, s63, 17408
    s_nop 0
    buffer_load_dwordx4 v88, s[36:39], s60 offen nt lds
    s_add_u32 s60, s60, 32768
    s_add_u32 m0, s63, 18432
    s_nop 0
    buffer_load_dwordx4 v89, s[36:39], s60 offen nt lds
    s_add_u32 s60, s60, 32768
    v_perm_b32 v96, v57, v57, v8
    v_perm_b32 v97, v57, v57, v10
    v_perm_b32 v98, v57, v57, v12
    v_perm_b32 v99, v57, v57, v14
    s_nop 1
    v_mfma_f32_16x16x32_bf16 v[112:115], v[96:99], a[184:187], v[112:115]
    v_perm_b32 v100, v77, v77, v8
    v_perm_b32 v101, v77, v77, v10
    v_perm_b32 v102, v77, v77, v12
    v_perm_b32 v103, v77, v77, v14
    s_nop 1
    v_mfma_f32_16x16x32_bf16 v[116:119], v[100:103], a[184:187], v[116:119]
    v_perm_b32 v104, v57, v57, v9
    v_perm_b32 v105, v57, v57, v11
    v_perm_b32 v106, v57, v57, v13
    v_perm_b32 v107, v57, v57, v15
    s_nop 1
    v_mfma_f32_16x16x32_bf16 v[112:115], v[104:107], a[188:191], v[112:115]
    v_perm_b32 v108, v77, v77, v9
    v_perm_b32 v109, v77, v77, v11
    v_perm_b32 v110, v77, v77, v13
    v_perm_b32 v111, v77, v77, v15
    s_nop 1
    v_mfma_f32_16x16x32_bf16 v[116:119], v[108:111], a[188:191], v[116:119]
    v_perm_b32 v96, v58, v58, v8
    v_perm_b32 v97, v58, v58, v10
    v_perm_b32 v98, v58, v58, v12
    v_perm_b32 v99, v58, v58, v14
    s_nop 1
    v_mfma_f32_16x16x32_bf16 v[112:115], v[96:99], a[192:195], v[112:115]
    v_perm_b32 v100, v78, v78, v8
    v_perm_b32 v101, v78, v78, v10
    v_perm_b32 v102, v78, v78, v12
    v_perm_b32 v103, v78, v78, v14
    s_nop 1
    v_mfma_f32_16x16x32_bf16 v[116:119], v[100:103], a[192:195], v[116:119]
    v_perm_b32 v104, v58, v58, v9
    v_perm_b32 v105, v58, v58, v11
    v_perm_b32 v106, v58, v58, v13
    v_perm_b32 v107, v58, v58, v15
    s_nop 1
    v_mfma_f32_16x16x32_bf16 v[112:115], v[104:107], a[196:199], v[112:115]
    v_perm_b32 v108, v78, v78, v9
    v_perm_b32 v109, v78, v78, v11
    v_perm_b32 v110, v78, v78, v13
    v_perm_b32 v111, v78, v78, v15
    s_nop 1
    v_mfma_f32_16x16x32_bf16 v[116:119], v[108:111], a[196:199], v[116:119]
    v_perm_b32 v96, v59, v59, v8
    v_perm_b32 v97, v59, v59, v10
    v_perm_b32 v98, v59, v59, v12
    v_perm_b32 v99, v59, v59, v14
    s_nop 1
    v_mfma_f32_16x16x32_bf16 v[112:115], v[96:99], a[200:203], v[112:115]
    v_perm_b32 v100, v79, v79, v8
    v_perm_b32 v101, v79, v79, v10
    v_perm_b32 v102, v79, v79, v12
    v_perm_b32 v103, v79, v79, v14
    s_nop 1
    v_mfma_f32_16x16x32_bf16 v[116:119], v[100:103], a[200:203], v[116:119]
    v_perm_b32 v104, v59, v59, v9
    v_perm_b32 v105, v59, v59, v11
    v_perm_b32 v106, v59, v59, v13
    v_perm_b32 v107, v59, v59, v15
    s_nop 1
    v_mfma_f32_16x16x32_bf16 v[112:115], v[104:107], a[204:207], v[112:115]
    v_perm_b32 v108, v79, v79, v9
    v_perm_b32 v109, v79, v79, v11
    v_perm_b32 v110, v79, v79, v13
    v_perm_b32 v111, v79, v79, v15
    s_nop 1
    v_mfma_f32_16x16x32_bf16 v[116:119], v[108:111], a[204:207], v[116:119]
    v_perm_b32 v96, v60, v60, v8
    v_perm_b32 v97, v60, v60, v10
    v_perm_b32 v98, v60, v60, v12
    v_perm_b32 v99, v60, v60, v14
    s_nop 1
    v_mfma_f32_16x16x32_bf16 v[112:115], v[96:99], a[208:211], v[112:115]
    v_perm_b32 v100, v80, v80, v8
    v_perm_b32 v101, v80, v80, v10
    v_perm_b32 v102, v80, v80, v12
    v_perm_b32 v103, v80, v80, v14
    s_nop 1
    v_mfma_f32_16x16x32_bf16 v[116:119], v[100:103], a[208:211], v[116:119]
    v_perm_b32 v104, v60, v60, v9
    v_perm_b32 v105, v60, v60, v11
    v_perm_b32 v106, v60, v60, v13
    v_perm_b32 v107, v60, v60, v15
    s_nop 1
    v_mfma_f32_16x16x32_bf16 v[112:115], v[104:107], a[212:215], v[112:115]
    v_perm_b32 v108, v80, v80, v9
    v_perm_b32 v109, v80, v80, v11
    v_perm_b32 v110, v80, v80, v13
    v_perm_b32 v111, v80, v80, v15
    s_nop 1
    v_mfma_f32_16x16x32_bf16 v[116:119], v[108:111], a[212:215], v[116:119]
    v_perm_b32 v96, v61, v61, v8
    v_perm_b32 v97, v61, v61, v10
    v_perm_b32 v98, v61, v61, v12
    v_perm_b32 v99, v61, v61, v14
    s_nop 1
    v_mfma_f32_16x16x32_bf16 v[112:115], v[96:99], a[216:219], v[112:115]
    v_perm_b32 v100, v81, v81, v8
    v_perm_b32 v101, v81, v81, v10
    v_perm_b32 v102, v81, v81, v12
    v_perm_b32 v103, v81, v81, v14
    s_nop 1
    v_mfma_f32_16x16x32_bf16 v[116:119], v[100:103], a[216:219], v[116:119]
    s_waitcnt vmcnt(19)
    s_add_u32 m0, s63, 19456
    s_nop 0
    buffer_load_dwordx4 v89, s[36:39], s60 offen nt lds
    s_add_u32 s60, s60, 32768
    s_add_u32 m0, s63, 20480
    s_nop 0
    buffer_load_dwordx4 v90, s[36:39], s60 offen nt lds
    s_add_u32 s60, s60, 32768
    s_add_u32 m0, s63, 21504
    s_nop 0
    buffer_load_dwordx4 v90, s[36:39], s60 offen nt lds
    s_add_u32 s60, s60, 32768
    s_add_u32 m0, s63, 22528
    s_nop 0
    buffer_load_dwordx4 v91, s[36:39], s60 offen nt lds
    s_add_u32 s60, s60, 32768
    s_add_u32 m0, s63, 23552
    s_nop 0
    buffer_load_dwordx4 v91, s[36:39], s60 offen nt lds
    s_add_u32 s60, s60, 32768
    s_add_u32 m0, s63, 24576
    s_nop 0
    buffer_load_dwordx4 v88, s[36:39], s60 offen nt lds
    s_add_u32 s60, s60, 32768
    s_add_u32 m0, s63, 25600
    s_nop 0
    buffer_load_dwordx4 v88, s[36:39], s60 offen nt lds
    s_add_u32 s60, s60, 32768
    s_add_u32 m0, s63, 26624
    s_nop 0
    buffer_load_dwordx4 v89, s[36:39], s60 offen nt lds
    s_add_u32 s60, s60, 32768
    s_add_u32 m0, s63, 27648
    s_nop 0
    buffer_load_dwordx4 v89, s[36:39], s60 offen nt lds
    s_add_u32 s60, s60, 32768
    v_perm_b32 v104, v61, v61, v9
    v_perm_b32 v105, v61, v61, v11
    v_perm_b32 v106, v61, v61, v13
    v_perm_b32 v107, v61, v61, v15
    s_nop 1
    v_mfma_f32_16x16x32_bf16 v[112:115], v[104:107], a[220:223], v[112:115]
    v_perm_b32 v108, v81, v81, v9
    v_perm_b32 v109, v81, v81, v11
    v_perm_b32 v110, v81, v81, v13
    v_perm_b32 v111, v81, v81, v15
    s_nop 1
    v_mfma_f32_16x16x32_bf16 v[116:119], v[108:111], a[220:223], v[116:119]
    v_perm_b32 v96, v62, v62, v8
    v_perm_b32 v97, v62, v62, v10
    v_perm_b32 v98, v62, v62, v12
    v_perm_b32 v99, v62, v62, v14
    s_nop 1
    v_mfma_f32_16x16x32_bf16 v[112:115], v[96:99], a[224:227], v[112:115]
    v_perm_b32 v100, v82, v82, v8
    v_perm_b32 v101, v82, v82, v10
    v_perm_b32 v102, v82, v82, v12
    v_perm_b32 v103, v82, v82, v14
    s_nop 1
    v_mfma_f32_16x16x32_bf16 v[116:119], v[100:103], a[224:227], v[116:119]
    v_perm_b32 v104, v62, v62, v9
    v_perm_b32 v105, v62, v62, v11
    v_perm_b32 v106, v62, v62, v13
    v_perm_b32 v107, v62, v62, v15
    s_nop 1
    v_mfma_f32_16x16x32_bf16 v[112:115], v[104:107], a[228:231], v[112:115]
    v_perm_b32 v108, v82, v82, v9
    v_perm_b32 v109, v82, v82, v11
    v_perm_b32 v110, v82, v82, v13
    v_perm_b32 v111, v82, v82, v15
    s_nop 1
    v_mfma_f32_16x16x32_bf16 v[116:119], v[108:111], a[228:231], v[116:119]
    v_perm_b32 v96, v63, v63, v8
    v_perm_b32 v97, v63, v63, v10
    v_perm_b32 v98, v63, v63, v12
    v_perm_b32 v99, v63, v63, v14
    s_nop 1
    v_mfma_f32_16x16x32_bf16 v[112:115], v[96:99], a[232:235], v[112:115]
    v_perm_b32 v100, v83, v83, v8
    v_perm_b32 v101, v83, v83, v10
    v_perm_b32 v102, v83, v83, v12
    v_perm_b32 v103, v83, v83, v14
    s_nop 1
    v_mfma_f32_16x16x32_bf16 v[116:119], v[100:103], a[232:235], v[116:119]
    v_perm_b32 v104, v63, v63, v9
    v_perm_b32 v105, v63, v63, v11
    v_perm_b32 v106, v63, v63, v13
    v_perm_b32 v107, v63, v63, v15
    s_nop 1
    v_mfma_f32_16x16x32_bf16 v[112:115], v[104:107], a[236:239], v[112:115]
    v_perm_b32 v108, v83, v83, v9
    v_perm_b32 v109, v83, v83, v11
    v_perm_b32 v110, v83, v83, v13
    v_perm_b32 v111, v83, v83, v15
    s_nop 1
    v_mfma_f32_16x16x32_bf16 v[116:119], v[108:111], a[236:239], v[116:119]
    v_perm_b32 v96, v64, v64, v8
    v_perm_b32 v97, v64, v64, v10
    v_perm_b32 v98, v64, v64, v12
    v_perm_b32 v99, v64, v64, v14
    s_nop 1
    v_mfma_f32_16x16x32_bf16 v[112:115], v[96:99], a[240:243], v[112:115]
    v_perm_b32 v100, v84, v84, v8
    v_perm_b32 v101, v84, v84, v10
    v_perm_b32 v102, v84, v84, v12
    v_perm_b32 v103, v84, v84, v14
    s_nop 1
    v_mfma_f32_16x16x32_bf16 v[116:119], v[100:103], a[240:243], v[116:119]
    v_perm_b32 v104, v64, v64, v9
    v_perm_b32 v105, v64, v64, v11
    v_perm_b32 v106, v64, v64, v13
    v_perm_b32 v107, v64, v64, v15
    s_nop 1
    v_mfma_f32_16x16x32_bf16 v[112:115], v[104:107], a[244:247], v[112:115]
    v_perm_b32 v108, v84, v84, v9
    v_perm_b32 v109, v84, v84, v11
    v_perm_b32 v110, v84, v84, v13
    v_perm_b32 v111, v84, v84, v15
    s_nop 1
    v_mfma_f32_16x16x32_bf16 v[116:119], v[108:111], a[244:247], v[116:119]
    v_perm_b32 v96, v65, v65, v8
    v_perm_b32 v97, v65, v65, v10
    v_perm_b32 v98, v65, v65, v12
    v_perm_b32 v99, v65, v65, v14
    s_nop 1
    v_mfma_f32_16x16x32_bf16 v[112:115], v[96:99], a[248:251], v[112:115]
    v_perm_b32 v100, v85, v85, v8
    v_perm_b32 v101, v85, v85, v10
    v_perm_b32 v102, v85, v85, v12
    v_perm_b32 v103, v85, v85, v14
    s_nop 1
    v_mfma_f32_16x16x32_bf16 v[116:119], v[100:103], a[248:251], v[116:119]
    v_perm_b32 v104, v65, v65, v9
    v_perm_b32 v105, v65, v65, v11
    v_perm_b32 v106, v65, v65, v13
    v_perm_b32 v107, v65, v65, v15
    s_nop 1
    v_mfma_f32_16x16x32_bf16 v[112:115], v[104:107], a[252:255], v[112:115]
    v_perm_b32 v108, v85, v85, v9
    v_perm_b32 v109, v85, v85, v11
    v_perm_b32 v110, v85, v85, v13
    v_perm_b32 v111, v85, v85, v15
    s_nop 1
    v_mfma_f32_16x16x32_bf16 v[116:119], v[108:111], a[252:255], v[116:119]
    v_lshrrev_b32 v5, 1, v4
    v_lshlrev_b32 v5, 9, v5
    v_lshl_add_u32 v5, v3, 5, v5
    v_and_b32 v6, 1, v4
    v_lshl_add_u32 v5, v6, 4, v5
    s_lshl_b32 s54, s3, 11
    s_add_u32 s54, s54, 131072
    v_add_u32 v5, s54, v5
    ds_write_b128 v5, v[112:115]
    ds_write_b128 v5, v[116:119] offset:1024
    s_waitcnt lgkmcnt(0)
    s_barrier
    s_add_u32 m0, s63, 28672
    s_nop 0
    buffer_load_dwordx4 v90, s[36:39], s60 offen nt lds
    s_add_u32 s60, s60, 32768
    s_add_u32 m0, s63, 29696
    s_nop 0
    buffer_load_dwordx4 v90, s[36:39], s60 offen nt lds
    s_add_u32 s60, s60, 32768
    s_add_u32 m0, s63, 30720
    s_nop 0
    buffer_load_dwordx4 v91, s[36:39], s60 offen nt lds
    s_add_u32 s60, s60, 32768
    s_add_u32 m0, s63, 31744
    s_nop 0
    buffer_load_dwordx4 v91, s[36:39], s60 offen nt lds
    s_add_u32 s60, s60, 32768
    v_lshrrev_b32 v5, 2, v3
    v_lshlrev_b32 v5, 9, v5
    v_lshl_add_u32 v5, v4, 5, v5
    v_add_u32 v5, 131072, v5
    ds_read_b128 v[48:51], v5 offset:0
    ds_read_b128 v[52:55], v5 offset:16
    ds_read_b128 v[56:59], v5 offset:2048
    ds_read_b128 v[60:63], v5 offset:2064
    ds_read_b128 v[64:67], v5 offset:4096
    ds_read_b128 v[68:71], v5 offset:4112
    ds_read_b128 v[72:75], v5 offset:6144
    ds_read_b128 v[76:79], v5 offset:6160
    s_waitcnt lgkmcnt(0)
    v_add_f32 v48, v48, v56
    v_add_f32 v64, v64, v72
    v_add_f32 v49, v49, v57
    v_add_f32 v65, v65, v73
    v_add_f32 v50, v50, v58
    v_add_f32 v66, v66, v74
    v_add_f32 v51, v51, v59
    v_add_f32 v67, v67, v75
    v_add_f32 v52, v52, v60
    v_add_f32 v68, v68, v76
    v_add_f32 v53, v53, v61
    v_add_f32 v69, v69, v77
    v_add_f32 v54, v54, v62
    v_add_f32 v70, v70, v78
    v_add_f32 v55, v55, v63
    v_add_f32 v71, v71, v79
    v_add_f32 v48, v48, v64
    v_add_f32 v49, v49, v65
    v_add_f32 v50, v50, v66
    v_add_f32 v51, v51, v67
    v_add_f32 v52, v52, v68
    v_add_f32 v53, v53, v69
    v_add_f32 v54, v54, v70
    v_add_f32 v55, v55, v71
    v_cvt_pk_bf16_f32 v96, v48, v49
    v_cvt_pk_bf16_f32 v97, v50, v51
    v_cvt_pk_bf16_f32 v98, v52, v53
    v_cvt_pk_bf16_f32 v99, v54, v55
    ds_read_b128 v[48:51], v5 offset:128
    ds_read_b128 v[52:55], v5 offset:144
    ds_read_b128 v[56:59], v5 offset:2176
    ds_read_b128 v[60:63], v5 offset:2192
    ds_read_b128 v[64:67], v5 offset:4224
    ds_read_b128 v[68:71], v5 offset:4240
    ds_read_b128 v[72:75], v5 offset:6272
    ds_read_b128 v[76:79], v5 offset:6288
    s_waitcnt lgkmcnt(0)
    v_add_f32 v48, v48, v56
    v_add_f32 v64, v64, v72
    v_add_f32 v49, v49, v57
    v_add_f32 v65, v65, v73
    v_add_f32 v50, v50, v58
    v_add_f32 v66, v66, v74
    v_add_f32 v51, v51, v59
    v_add_f32 v67, v67, v75
    v_add_f32 v52, v52, v60
    v_add_f32 v68, v68, v76
    v_add_f32 v53, v53, v61
    v_add_f32 v69, v69, v77
    v_add_f32 v54, v54, v62
    v_add_f32 v70, v70, v78
    v_add_f32 v55, v55, v63
    v_add_f32 v71, v71, v79
    v_add_f32 v48, v48, v64
    v_add_f32 v49, v49, v65
    v_add_f32 v50, v50, v66
    v_add_f32 v51, v51, v67
    v_add_f32 v52, v52, v68
    v_add_f32 v53, v53, v69
    v_add_f32 v54, v54, v70
    v_add_f32 v55, v55, v71
    v_cvt_pk_bf16_f32 v100, v48, v49
    v_cvt_pk_bf16_f32 v101, v50, v51
    v_cvt_pk_bf16_f32 v102, v52, v53
    v_cvt_pk_bf16_f32 v103, v54, v55
    ds_read_b128 v[48:51], v5 offset:256
    ds_read_b128 v[52:55], v5 offset:272
    ds_read_b128 v[56:59], v5 offset:2304
    ds_read_b128 v[60:63], v5 offset:2320
    ds_read_b128 v[64:67], v5 offset:4352
    ds_read_b128 v[68:71], v5 offset:4368
    ds_read_b128 v[72:75], v5 offset:6400
    ds_read_b128 v[76:79], v5 offset:6416
    s_waitcnt lgkmcnt(0)
    v_add_f32 v48, v48, v56
    v_add_f32 v64, v64, v72
    v_add_f32 v49, v49, v57
    v_add_f32 v65, v65, v73
    v_add_f32 v50, v50, v58
    v_add_f32 v66, v66, v74
    v_add_f32 v51, v51, v59
    v_add_f32 v67, v67, v75
    v_add_f32 v52, v52, v60
    v_add_f32 v68, v68, v76
    v_add_f32 v53, v53, v61
    v_add_f32 v69, v69, v77
    v_add_f32 v54, v54, v62
    v_add_f32 v70, v70, v78
    v_add_f32 v55, v55, v63
    v_add_f32 v71, v71, v79
    v_add_f32 v48, v48, v64
    v_add_f32 v49, v49, v65
    v_add_f32 v50, v50, v66
    v_add_f32 v51, v51, v67
    v_add_f32 v52, v52, v68
    v_add_f32 v53, v53, v69
    v_add_f32 v54, v54, v70
    v_add_f32 v55, v55, v71
    v_cvt_pk_bf16_f32 v104, v48, v49
    v_cvt_pk_bf16_f32 v105, v50, v51
    v_cvt_pk_bf16_f32 v106, v52, v53
    v_cvt_pk_bf16_f32 v107, v54, v55
    ds_read_b128 v[48:51], v5 offset:384
    ds_read_b128 v[52:55], v5 offset:400
    ds_read_b128 v[56:59], v5 offset:2432
    ds_read_b128 v[60:63], v5 offset:2448
    ds_read_b128 v[64:67], v5 offset:4480
    ds_read_b128 v[68:71], v5 offset:4496
    ds_read_b128 v[72:75], v5 offset:6528
    ds_read_b128 v[76:79], v5 offset:6544
    s_waitcnt lgkmcnt(0)
    v_add_f32 v48, v48, v56
    v_add_f32 v64, v64, v72
    v_add_f32 v49, v49, v57
    v_add_f32 v65, v65, v73
    v_add_f32 v50, v50, v58
    v_add_f32 v66, v66, v74
    v_add_f32 v51, v51, v59
    v_add_f32 v67, v67, v75
    v_add_f32 v52, v52, v60
    v_add_f32 v68, v68, v76
    v_add_f32 v53, v53, v61
    v_add_f32 v69, v69, v77
    v_add_f32 v54, v54, v62
    v_add_f32 v70, v70, v78
    v_add_f32 v55, v55, v63
    v_add_f32 v71, v71, v79
    v_add_f32 v48, v48, v64
    v_add_f32 v49, v49, v65
    v_add_f32 v50, v50, v66
    v_add_f32 v51, v51, v67
    v_add_f32 v52, v52, v68
    v_add_f32 v53, v53, v69
    v_add_f32 v54, v54, v70
    v_add_f32 v55, v55, v71
    v_cvt_pk_bf16_f32 v108, v48, v49
    v_cvt_pk_bf16_f32 v109, v50, v51
    v_cvt_pk_bf16_f32 v110, v52, v53
    v_cvt_pk_bf16_f32 v111, v54, v55
    s_waitcnt vmcnt(24)
    ds_read_b128 v[128:131], v92 offset:0
    ds_read_b128 v[132:135], v93 offset:0
    ds_read_b128 v[136:139], v94 offset:0
    ds_read_b128 v[140:143], v95 offset:0
    ds_read_b128 v[144:147], v92 offset:1024
    ds_read_b128 v[148:151], v93 offset:1024
    ds_read_b128 v[152:155], v94 offset:1024
    ds_read_b128 v[156:159], v95 offset:1024
    s_waitcnt lgkmcnt(7)
    v_mfma_f32_16x16x32_bf16 v[48:51], v[128:131], v[96:99], 0
    s_waitcnt lgkmcnt(6)
    v_mfma_f32_16x16x32_bf16 v[48:51], v[132:135], v[100:103], v[48:51]
    s_waitcnt lgkmcnt(5)
    v_mfma_f32_16x16x32_bf16 v[48:51], v[136:139], v[104:107], v[48:51]
    s_waitcnt lgkmcnt(4)
    v_mfma_f32_16x16x32_bf16 v[48:51], v[140:143], v[108:111], v[48:51]
    s_waitcnt lgkmcnt(3)
    v_mfma_f32_16x16x32_bf16 v[52:55], v[144:147], v[96:99], 0
    s_waitcnt lgkmcnt(2)
    v_mfma_f32_16x16x32_bf16 v[52:55], v[148:151], v[100:103], v[52:55]
    s_waitcnt lgkmcnt(1)
    v_mfma_f32_16x16x32_bf16 v[52:55], v[152:155], v[104:107], v[52:55]
    s_waitcnt lgkmcnt(0)
    v_mfma_f32_16x16x32_bf16 v[52:55], v[156:159], v[108:111], v[52:55]
    s_waitcnt vmcnt(16)
    ds_read_b128 v[160:163], v92 offset:8192
    ds_read_b128 v[164:167], v93 offset:8192
    ds_read_b128 v[168:171], v94 offset:8192
    ds_read_b128 v[172:175], v95 offset:8192
    ds_read_b128 v[176:179], v92 offset:9216
    ds_read_b128 v[180:183], v93 offset:9216
    ds_read_b128 v[184:187], v94 offset:9216
    ds_read_b128 v[188:191], v95 offset:9216
    s_waitcnt lgkmcnt(7)
    v_mfma_f32_16x16x32_bf16 v[56:59], v[160:163], v[96:99], 0
    s_waitcnt lgkmcnt(6)
    v_mfma_f32_16x16x32_bf16 v[56:59], v[164:167], v[100:103], v[56:59]
    s_waitcnt lgkmcnt(5)
    v_mfma_f32_16x16x32_bf16 v[56:59], v[168:171], v[104:107], v[56:59]
    s_waitcnt lgkmcnt(4)
    v_mfma_f32_16x16x32_bf16 v[56:59], v[172:175], v[108:111], v[56:59]
    s_waitcnt lgkmcnt(3)
    v_mfma_f32_16x16x32_bf16 v[60:63], v[176:179], v[96:99], 0
    s_waitcnt lgkmcnt(2)
    v_mfma_f32_16x16x32_bf16 v[60:63], v[180:183], v[100:103], v[60:63]
    s_waitcnt lgkmcnt(1)
    v_mfma_f32_16x16x32_bf16 v[60:63], v[184:187], v[104:107], v[60:63]
    s_waitcnt lgkmcnt(0)
    v_mfma_f32_16x16x32_bf16 v[60:63], v[188:191], v[108:111], v[60:63]
    s_waitcnt vmcnt(8)
    ds_read_b128 v[128:131], v92 offset:16384
    ds_read_b128 v[132:135], v93 offset:16384
    ds_read_b128 v[136:139], v94 offset:16384
    ds_read_b128 v[140:143], v95 offset:16384
    ds_read_b128 v[144:147], v92 offset:17408
    ds_read_b128 v[148:151], v93 offset:17408
    ds_read_b128 v[152:155], v94 offset:17408
    ds_read_b128 v[156:159], v95 offset:17408
    s_waitcnt lgkmcnt(7)
    v_mfma_f32_16x16x32_bf16 v[64:67], v[128:131], v[96:99], 0
    s_waitcnt lgkmcnt(6)
    v_mfma_f32_16x16x32_bf16 v[64:67], v[132:135], v[100:103], v[64:67]
    s_waitcnt lgkmcnt(5)
    v_mfma_f32_16x16x32_bf16 v[64:67], v[136:139], v[104:107], v[64:67]
    s_waitcnt lgkmcnt(4)
    v_mfma_f32_16x16x32_bf16 v[64:67], v[140:143], v[108:111], v[64:67]
    s_waitcnt lgkmcnt(3)
    v_mfma_f32_16x16x32_bf16 v[68:71], v[144:147], v[96:99], 0
    s_waitcnt lgkmcnt(2)
    v_mfma_f32_16x16x32_bf16 v[68:71], v[148:151], v[100:103], v[68:71]
    s_waitcnt lgkmcnt(1)
    v_mfma_f32_16x16x32_bf16 v[68:71], v[152:155], v[104:107], v[68:71]
    s_waitcnt lgkmcnt(0)
    v_mfma_f32_16x16x32_bf16 v[68:71], v[156:159], v[108:111], v[68:71]
    s_waitcnt vmcnt(0)
    ds_read_b128 v[160:163], v92 offset:24576
    ds_read_b128 v[164:167], v93 offset:24576
    ds_read_b128 v[168:171], v94 offset:24576
    ds_read_b128 v[172:175], v95 offset:24576
    ds_read_b128 v[176:179], v92 offset:25600
    ds_read_b128 v[180:183], v93 offset:25600
    ds_read_b128 v[184:187], v94 offset:25600
    ds_read_b128 v[188:191], v95 offset:25600
    s_waitcnt lgkmcnt(7)
    v_mfma_f32_16x16x32_bf16 v[72:75], v[160:163], v[96:99], 0
    s_waitcnt lgkmcnt(6)
    v_mfma_f32_16x16x32_bf16 v[72:75], v[164:167], v[100:103], v[72:75]
    s_waitcnt lgkmcnt(5)
    v_mfma_f32_16x16x32_bf16 v[72:75], v[168:171], v[104:107], v[72:75]
    s_waitcnt lgkmcnt(4)
    v_mfma_f32_16x16x32_bf16 v[72:75], v[172:175], v[108:111], v[72:75]
    s_waitcnt lgkmcnt(3)
    v_mfma_f32_16x16x32_bf16 v[76:79], v[176:179], v[96:99], 0
    s_waitcnt lgkmcnt(2)
    v_mfma_f32_16x16x32_bf16 v[76:79], v[180:183], v[100:103], v[76:79]
    s_waitcnt lgkmcnt(1)
    v_mfma_f32_16x16x32_bf16 v[76:79], v[184:187], v[104:107], v[76:79]
    s_waitcnt lgkmcnt(0)
    v_mfma_f32_16x16x32_bf16 v[76:79], v[188:191], v[108:111], v[76:79]
    s_mov_b32 s96, 1040356334
    v_lshrrev_b32 v5, 2, v3
    v_lshlrev_b32 v5, 15, v5
    v_lshl_add_u32 v5, v4, 4, v5
    s_lshl_b32 s54, s52, 10
    s_lshl_b32 s55, s3, 8
    s_add_u32 s54, s54, s55
    s_add_u32 s54, s54, 1048576
    v_mul_f32 v48, s96, v48
    v_mul_f32 v49, s96, v49
    v_mul_f32 v50, s96, v50
    v_mul_f32 v51, s96, v51
    v_mul_f32 v52, s96, v52
    v_mul_f32 v53, s96, v53
    v_mul_f32 v54, s96, v54
    v_mul_f32 v55, s96, v55
    v_mul_f32 v56, s96, v56
    v_mul_f32 v57, s96, v57
    v_mul_f32 v58, s96, v58
    v_mul_f32 v59, s96, v59
    v_mul_f32 v60, s96, v60
    v_mul_f32 v61, s96, v61
    v_mul_f32 v62, s96, v62
    v_mul_f32 v63, s96, v63
    v_mul_f32 v64, s96, v64
    v_mul_f32 v65, s96, v65
    v_mul_f32 v66, s96, v66
    v_mul_f32 v67, s96, v67
    v_mul_f32 v68, s96, v68
    v_mul_f32 v69, s96, v69
    v_mul_f32 v70, s96, v70
    v_mul_f32 v71, s96, v71
    v_mul_f32 v72, s96, v72
    v_mul_f32 v73, s96, v73
    v_mul_f32 v74, s96, v74
    v_mul_f32 v75, s96, v75
    v_mul_f32 v76, s96, v76
    v_mul_f32 v77, s96, v77
    v_mul_f32 v78, s96, v78
    v_mul_f32 v79, s96, v79
    v_cvt_pk_bf16_f32 v24, v48, v49
    v_cvt_pk_bf16_f32 v25, v50, v51
    v_cvt_pk_bf16_f32 v26, v52, v53
    v_cvt_pk_bf16_f32 v27, v54, v55
    v_cvt_pk_bf16_f32 v28, v56, v57
    v_cvt_pk_bf16_f32 v29, v58, v59
    v_cvt_pk_bf16_f32 v30, v60, v61
    v_cvt_pk_bf16_f32 v31, v62, v63
    v_cvt_pk_bf16_f32 v32, v64, v65
    v_cvt_pk_bf16_f32 v33, v66, v67
    v_cvt_pk_bf16_f32 v34, v68, v69
    v_cvt_pk_bf16_f32 v35, v70, v71
    v_cvt_pk_bf16_f32 v36, v72, v73
    v_cvt_pk_bf16_f32 v37, v74, v75
    v_cvt_pk_bf16_f32 v38, v76, v77
    v_cvt_pk_bf16_f32 v39, v78, v79
    s_mov_b32 s56, 0x11111111
    s_mov_b32 s57, 0x11111111
    s_mov_b64 exec, s[56:57]
    buffer_store_dwordx4 v[24:27], v5, s[44:47], s54 offen offset:0 sc1
    buffer_store_dwordx4 v[28:31], v5, s[44:47], s54 offen offset:64 sc1
    buffer_store_dwordx4 v[32:35], v5, s[44:47], s54 offen offset:128 sc1
    buffer_store_dwordx4 v[36:39], v5, s[44:47], s54 offen offset:192 sc1
    s_mov_b64 exec, -1
    s_waitcnt vmcnt(0)
    s_barrier
    s_cmp_lg_u32 s3, 0
    s_cbranch_scc1 L_nosig_4
    v_mov_b32 v5, 128
    v_mov_b32 v6, 1
    s_mov_b64 exec, 1
    global_atomic_add v5, v6, s[28:29]
    s_mov_b64 exec, -1
L_nosig_4:
    buffer_load_dwordx4 a[0:3], v121, s[40:43], s62 offen nt
    s_add_u32 s62, s62, 8192
    buffer_load_dwordx4 a[4:7], v121, s[40:43], s62 offen nt
    s_add_u32 s62, s62, 8192
    buffer_load_dwordx4 a[8:11], v121, s[40:43], s62 offen nt
    s_add_u32 s62, s62, 8192
    buffer_load_dwordx4 a[12:15], v121, s[40:43], s62 offen nt
    s_add_u32 s62, s62, 8192
    buffer_load_dwordx4 a[16:19], v121, s[40:43], s62 offen nt
    s_add_u32 s62, s62, 8192
    buffer_load_dwordx4 a[20:23], v121, s[40:43], s62 offen nt
    s_add_u32 s62, s62, 8192
    buffer_load_dwordx4 a[24:27], v121, s[40:43], s62 offen nt
    s_add_u32 s62, s62, 8192
    buffer_load_dwordx4 a[28:31], v121, s[40:43], s62 offen nt
    s_add_u32 s62, s62, 8192
    buffer_load_dwordx4 a[32:35], v121, s[40:43], s62 offen nt
    s_add_u32 s62, s62, 8192
    buffer_load_dwordx4 a[36:39], v121, s[40:43], s62 offen nt
    s_add_u32 s62, s62, 8192
    buffer_load_dwordx4 a[40:43], v121, s[40:43], s62 offen nt
    s_add_u32 s62, s62, 8192
    buffer_load_dwordx4 a[44:47], v121, s[40:43], s62 offen nt
    s_add_u32 s62, s62, 8192
    buffer_load_dwordx4 a[48:51], v121, s[40:43], s62 offen nt
    s_add_u32 s62, s62, 8192
    buffer_load_dwordx4 a[52:55], v121, s[40:43], s62 offen nt
    s_add_u32 s62, s62, 8192
    buffer_load_dwordx4 a[56:59], v121, s[40:43], s62 offen nt
    s_add_u32 s62, s62, 8192
    buffer_load_dwordx4 a[60:63], v121, s[40:43], s62 offen nt
    s_add_u32 s62, s62, 8192
    buffer_load_dwordx4 a[64:67], v121, s[40:43], s62 offen nt
    s_add_u32 s62, s62, 8192
    buffer_load_dwordx4 a[68:71], v121, s[40:43], s62 offen nt
    s_add_u32 s62, s62, 8192
    buffer_load_dwordx4 a[72:75], v121, s[40:43], s62 offen nt
    s_add_u32 s62, s62, 8192
    buffer_load_dwordx4 a[76:79], v121, s[40:43], s62 offen nt
    s_add_u32 s62, s62, 8192
    buffer_load_dwordx4 a[80:83], v121, s[40:43], s62 offen nt
    s_add_u32 s62, s62, 8192
    buffer_load_dwordx4 a[84:87], v121, s[40:43], s62 offen nt
    s_add_u32 s62, s62, 8192
    buffer_load_dwordx4 a[88:91], v121, s[40:43], s62 offen nt
    s_add_u32 s62, s62, 8192
    buffer_load_dwordx4 a[92:95], v121, s[40:43], s62 offen nt
    s_add_u32 s62, s62, 8192
    buffer_load_dwordx4 a[96:99], v121, s[40:43], s62 offen nt
    s_add_u32 s62, s62, 8192
    buffer_load_dwordx4 a[100:103], v121, s[40:43], s62 offen nt
    s_add_u32 s62, s62, 8192
    buffer_load_dwordx4 a[104:107], v121, s[40:43], s62 offen nt
    s_add_u32 s62, s62, 8192
    buffer_load_dwordx4 a[108:111], v121, s[40:43], s62 offen nt
    s_add_u32 s62, s62, 8192
    buffer_load_dwordx4 a[112:115], v121, s[40:43], s62 offen nt
    s_add_u32 s62, s62, 8192
    buffer_load_dwordx4 a[116:119], v121, s[40:43], s62 offen nt
    s_add_u32 s62, s62, 8192
    buffer_load_dwordx4 a[120:123], v121, s[40:43], s62 offen nt
    s_add_u32 s62, s62, 8192
    buffer_load_dwordx4 a[124:127], v121, s[40:43], s62 offen nt
    s_add_u32 s62, s62, 8192
    s_mov_b32 s36, s24
    s_mov_b32 s37, s25
    s_mov_b32 s38, 4718592
    s_mov_b32 s39, 0x20000
    v_mul_u32_u24 v81, 9216, v4
    v_lshl_add_u32 v80, v3, 4, v81
    v_lshl_add_u32 v81, v3, 2, v81
    s_mul_i32 s100, s52, 147456
    s_lshl_b32 s54, s3, 8
    s_add_u32 s99, s100, s54
    s_and_b32 s54, s3, 1
    s_lshl_b32 s54, s54, 6
    s_add_u32 s100, s100, s54
    s_add_u32 s100, s100, 1024
    s_waitcnt vmcnt(40)
    s_add_u32 s54, s99, 0
    s_add_u32 s55, s100, 0
    buffer_load_dwordx4 v[96:99], v80, s[36:39], s54 offen offset:0 nt
    buffer_load_dwordx4 v[100:103], v80, s[36:39], s54 offen offset:1152 nt
    buffer_load_dwordx4 v[104:107], v80, s[36:39], s54 offen offset:2304 nt
    buffer_load_dwordx4 v[108:111], v80, s[36:39], s54 offen offset:3456 nt
    buffer_load_dword v224, v81, s[36:39], s55 offen offset:0 nt
    buffer_load_dword v225, v81, s[36:39], s55 offen offset:1152 nt
    buffer_load_dword v226, v81, s[36:39], s55 offen offset:2304 nt
    buffer_load_dword v227, v81, s[36:39], s55 offen offset:3456 nt
    s_add_u32 s54, s99, 4608
    s_add_u32 s55, s100, 4608
    buffer_load_dwordx4 v[112:115], v80, s[36:39], s54 offen offset:0 nt
    buffer_load_dwordx4 v[116:119], v80, s[36:39], s54 offen offset:1152 nt
    buffer_load_dwordx4 v[120:123], v80, s[36:39], s54 offen offset:2304 nt
    buffer_load_dwordx4 v[124:127], v80, s[36:39], s54 offen offset:3456 nt
    buffer_load_dword v228, v81, s[36:39], s55 offen offset:0 nt
    buffer_load_dword v229, v81, s[36:39], s55 offen offset:1152 nt
    buffer_load_dword v230, v81, s[36:39], s55 offen offset:2304 nt
    buffer_load_dword v231, v81, s[36:39], s55 offen offset:3456 nt
    s_waitcnt vmcnt(40)
    s_add_u32 s54, s99, 36864
    s_add_u32 s55, s100, 36864
    buffer_load_dwordx4 v[128:131], v80, s[36:39], s54 offen offset:0 nt
    buffer_load_dwordx4 v[132:135], v80, s[36:39], s54 offen offset:1152 nt
    buffer_load_dwordx4 v[136:139], v80, s[36:39], s54 offen offset:2304 nt
    buffer_load_dwordx4 v[140:143], v80, s[36:39], s54 offen offset:3456 nt
    buffer_load_dword v232, v81, s[36:39], s55 offen offset:0 nt
    buffer_load_dword v233, v81, s[36:39], s55 offen offset:1152 nt
    buffer_load_dword v234, v81, s[36:39], s55 offen offset:2304 nt
    buffer_load_dword v235, v81, s[36:39], s55 offen offset:3456 nt
    s_add_u32 s54, s99, 41472
    s_add_u32 s55, s100, 41472
    buffer_load_dwordx4 v[144:147], v80, s[36:39], s54 offen offset:0 nt
    buffer_load_dwordx4 v[148:151], v80, s[36:39], s54 offen offset:1152 nt
    buffer_load_dwordx4 v[152:155], v80, s[36:39], s54 offen offset:2304 nt
    buffer_load_dwordx4 v[156:159], v80, s[36:39], s54 offen offset:3456 nt
    buffer_load_dword v236, v81, s[36:39], s55 offen offset:0 nt
    buffer_load_dword v237, v81, s[36:39], s55 offen offset:1152 nt
    buffer_load_dword v238, v81, s[36:39], s55 offen offset:2304 nt
    buffer_load_dword v239, v81, s[36:39], s55 offen offset:3456 nt
    s_waitcnt vmcnt(40)
    s_add_u32 s54, s99, 73728
    s_add_u32 s55, s100, 73728
    buffer_load_dwordx4 v[160:163], v80, s[36:39], s54 offen offset:0 nt
    buffer_load_dwordx4 v[164:167], v80, s[36:39], s54 offen offset:1152 nt
    buffer_load_dwordx4 v[168:171], v80, s[36:39], s54 offen offset:2304 nt
    buffer_load_dwordx4 v[172:175], v80, s[36:39], s54 offen offset:3456 nt
    buffer_load_dword v240, v81, s[36:39], s55 offen offset:0 nt
    buffer_load_dword v241, v81, s[36:39], s55 offen offset:1152 nt
    buffer_load_dword v242, v81, s[36:39], s55 offen offset:2304 nt
    buffer_load_dword v243, v81, s[36:39], s55 offen offset:3456 nt
    s_add_u32 s54, s99, 78336
    s_add_u32 s55, s100, 78336
    buffer_load_dwordx4 v[176:179], v80, s[36:39], s54 offen offset:0 nt
    buffer_load_dwordx4 v[180:183], v80, s[36:39], s54 offen offset:1152 nt
    buffer_load_dwordx4 v[184:187], v80, s[36:39], s54 offen offset:2304 nt
    buffer_load_dwordx4 v[188:191], v80, s[36:39], s54 offen offset:3456 nt
    buffer_load_dword v244, v81, s[36:39], s55 offen offset:0 nt
    buffer_load_dword v245, v81, s[36:39], s55 offen offset:1152 nt
    buffer_load_dword v246, v81, s[36:39], s55 offen offset:2304 nt
    buffer_load_dword v247, v81, s[36:39], s55 offen offset:3456 nt
    s_waitcnt vmcnt(40)
    s_add_u32 s54, s99, 110592
    s_add_u32 s55, s100, 110592
    buffer_load_dwordx4 v[192:195], v80, s[36:39], s54 offen offset:0 nt
    buffer_load_dwordx4 v[196:199], v80, s[36:39], s54 offen offset:1152 nt
    buffer_load_dwordx4 v[200:203], v80, s[36:39], s54 offen offset:2304 nt
    buffer_load_dwordx4 v[204:207], v80, s[36:39], s54 offen offset:3456 nt
    buffer_load_dword v248, v81, s[36:39], s55 offen offset:0 nt
    buffer_load_dword v249, v81, s[36:39], s55 offen offset:1152 nt
    buffer_load_dword v250, v81, s[36:39], s55 offen offset:2304 nt
    buffer_load_dword v251, v81, s[36:39], s55 offen offset:3456 nt
    s_add_u32 s54, s99, 115200
    s_add_u32 s55, s100, 115200
    buffer_load_dwordx4 v[208:211], v80, s[36:39], s54 offen offset:0 nt
    buffer_load_dwordx4 v[212:215], v80, s[36:39], s54 offen offset:1152 nt
    buffer_load_dwordx4 v[216:219], v80, s[36:39], s54 offen offset:2304 nt
    buffer_load_dwordx4 v[220:223], v80, s[36:39], s54 offen offset:3456 nt
    buffer_load_dword v252, v81, s[36:39], s55 offen offset:0 nt
    buffer_load_dword v253, v81, s[36:39], s55 offen offset:1152 nt
    buffer_load_dword v254, v81, s[36:39], s55 offen offset:2304 nt
    buffer_load_dword v255, v81, s[36:39], s55 offen offset:3456 nt
    s_waitcnt vmcnt(0)
    s_mov_b32 s54, 0x05040100
    s_mov_b32 s55, 0x07060302
    v_perm_b32 v64, v100, v96, s54
    v_perm_b32 v65, v108, v104, s54
    v_perm_b32 v66, v116, v112, s54
    v_perm_b32 v67, v124, v120, s54
    v_perm_b32 v68, v100, v96, s55
    v_perm_b32 v69, v108, v104, s55
    v_perm_b32 v70, v116, v112, s55
    v_perm_b32 v71, v124, v120, s55
    v_perm_b32 v72, v101, v97, s54
    v_perm_b32 v73, v109, v105, s54
    v_perm_b32 v74, v117, v113, s54
    v_perm_b32 v75, v125, v121, s54
    v_perm_b32 v76, v101, v97, s55
    v_perm_b32 v77, v109, v105, s55
    v_perm_b32 v78, v117, v113, s55
    v_perm_b32 v79, v125, v121, s55
    v_perm_b32 v80, v102, v98, s54
    v_perm_b32 v81, v110, v106, s54
    v_perm_b32 v82, v118, v114, s54
    v_perm_b32 v83, v126, v122, s54
    v_perm_b32 v84, v102, v98, s55
    v_perm_b32 v85, v110, v106, s55
    v_perm_b32 v86, v118, v114, s55
    v_perm_b32 v87, v126, v122, s55
    v_perm_b32 v88, v103, v99, s54
    v_perm_b32 v89, v111, v107, s54
    v_perm_b32 v90, v119, v115, s54
    v_perm_b32 v91, v127, v123, s54
    v_perm_b32 v92, v103, v99, s55
    v_perm_b32 v93, v111, v107, s55
    v_perm_b32 v94, v119, v115, s55
    v_perm_b32 v95, v127, v123, s55
    v_perm_b32 v96, v132, v128, s54
    v_perm_b32 v97, v140, v136, s54
    v_perm_b32 v98, v148, v144, s54
    v_perm_b32 v99, v156, v152, s54
    v_perm_b32 v100, v132, v128, s55
    v_perm_b32 v101, v140, v136, s55
    v_perm_b32 v102, v148, v144, s55
    v_perm_b32 v103, v156, v152, s55
    v_perm_b32 v104, v133, v129, s54
    v_perm_b32 v105, v141, v137, s54
    v_perm_b32 v106, v149, v145, s54
    v_perm_b32 v107, v157, v153, s54
    v_perm_b32 v108, v133, v129, s55
    v_perm_b32 v109, v141, v137, s55
    v_perm_b32 v110, v149, v145, s55
    v_perm_b32 v111, v157, v153, s55
    v_perm_b32 v112, v134, v130, s54
    v_perm_b32 v113, v142, v138, s54
    v_perm_b32 v114, v150, v146, s54
    v_perm_b32 v115, v158, v154, s54
    v_perm_b32 v116, v134, v130, s55
    v_perm_b32 v117, v142, v138, s55
    v_perm_b32 v118, v150, v146, s55
    v_perm_b32 v119, v158, v154, s55
    v_perm_b32 v120, v135, v131, s54
    v_perm_b32 v121, v143, v139, s54
    v_perm_b32 v122, v151, v147, s54
    v_perm_b32 v123, v159, v155, s54
    v_perm_b32 v124, v135, v131, s55
    v_perm_b32 v125, v143, v139, s55
    v_perm_b32 v126, v151, v147, s55
    v_perm_b32 v127, v159, v155, s55
    v_perm_b32 v128, v164, v160, s54
    v_perm_b32 v129, v172, v168, s54
    v_perm_b32 v130, v180, v176, s54
    v_perm_b32 v131, v188, v184, s54
    v_perm_b32 v132, v164, v160, s55
    v_perm_b32 v133, v172, v168, s55
    v_perm_b32 v134, v180, v176, s55
    v_perm_b32 v135, v188, v184, s55
    v_perm_b32 v136, v165, v161, s54
    v_perm_b32 v137, v173, v169, s54
    v_perm_b32 v138, v181, v177, s54
    v_perm_b32 v139, v189, v185, s54
    v_perm_b32 v140, v165, v161, s55
    v_perm_b32 v141, v173, v169, s55
    v_perm_b32 v142, v181, v177, s55
    v_perm_b32 v143, v189, v185, s55
    v_perm_b32 v144, v166, v162, s54
    v_perm_b32 v145, v174, v170, s54
    v_perm_b32 v146, v182, v178, s54
    v_perm_b32 v147, v190, v186, s54
    v_perm_b32 v148, v166, v162, s55
    v_perm_b32 v149, v174, v170, s55
    v_perm_b32 v150, v182, v178, s55
    v_perm_b32 v151, v190, v186, s55
    v_perm_b32 v152, v167, v163, s54
    v_perm_b32 v153, v175, v171, s54
    v_perm_b32 v154, v183, v179, s54
    v_perm_b32 v155, v191, v187, s54
    v_perm_b32 v156, v167, v163, s55
    v_perm_b32 v157, v175, v171, s55
    v_perm_b32 v158, v183, v179, s55
    v_perm_b32 v159, v191, v187, s55
    v_perm_b32 v160, v196, v192, s54
    v_perm_b32 v161, v204, v200, s54
    v_perm_b32 v162, v212, v208, s54
    v_perm_b32 v163, v220, v216, s54
    v_perm_b32 v164, v196, v192, s55
    v_perm_b32 v165, v204, v200, s55
    v_perm_b32 v166, v212, v208, s55
    v_perm_b32 v167, v220, v216, s55
    v_perm_b32 v168, v197, v193, s54
    v_perm_b32 v169, v205, v201, s54
    v_perm_b32 v170, v213, v209, s54
    v_perm_b32 v171, v221, v217, s54
    v_perm_b32 v172, v197, v193, s55
    v_perm_b32 v173, v205, v201, s55
    v_perm_b32 v174, v213, v209, s55
    v_perm_b32 v175, v221, v217, s55
    v_perm_b32 v176, v198, v194, s54
    v_perm_b32 v177, v206, v202, s54
    v_perm_b32 v178, v214, v210, s54
    v_perm_b32 v179, v222, v218, s54
    v_perm_b32 v180, v198, v194, s55
    v_perm_b32 v181, v206, v202, s55
    v_perm_b32 v182, v214, v210, s55
    v_perm_b32 v183, v222, v218, s55
    v_perm_b32 v184, v199, v195, s54
    v_perm_b32 v185, v207, v203, s54
    v_perm_b32 v186, v215, v211, s54
    v_perm_b32 v187, v223, v219, s54
    v_perm_b32 v188, v199, v195, s55
    v_perm_b32 v189, v207, v203, s55
    v_perm_b32 v190, v215, v211, s55
    v_perm_b32 v191, v223, v219, s55
    v_perm_b32 v192, v225, v224, s54
    v_perm_b32 v193, v227, v226, s54
    v_perm_b32 v194, v229, v228, s54
    v_perm_b32 v195, v231, v230, s54
    v_perm_b32 v196, v225, v224, s55
    v_perm_b32 v197, v227, v226, s55
    v_perm_b32 v198, v229, v228, s55
    v_perm_b32 v199, v231, v230, s55
    v_perm_b32 v200, v233, v232, s54
    v_perm_b32 v201, v235, v234, s54
    v_perm_b32 v202, v237, v236, s54
    v_perm_b32 v203, v239, v238, s54
    v_perm_b32 v204, v233, v232, s55
    v_perm_b32 v205, v235, v234, s55
    v_perm_b32 v206, v237, v236, s55
    v_perm_b32 v207, v239, v238, s55
    v_perm_b32 v208, v241, v240, s54
    v_perm_b32 v209, v243, v242, s54
    v_perm_b32 v210, v245, v244, s54
    v_perm_b32 v211, v247, v246, s54
    v_perm_b32 v212, v241, v240, s55
    v_perm_b32 v213, v243, v242, s55
    v_perm_b32 v214, v245, v244, s55
    v_perm_b32 v215, v247, v246, s55
    v_perm_b32 v216, v249, v248, s54
    v_perm_b32 v217, v251, v250, s54
    v_perm_b32 v218, v253, v252, s54
    v_perm_b32 v219, v255, v254, s54
    v_perm_b32 v220, v249, v248, s55
    v_perm_b32 v221, v251, v250, s55
    v_perm_b32 v222, v253, v252, s55
    v_perm_b32 v223, v255, v254, s55
    s_lshl_b32 s58, s52, 2
    s_add_u32 s58, s58, s3
    s_lshl_b32 s59, s58, 6
    s_add_u32 s59, s59, 3145728
    s_lshl_b32 s58, s58, 13
    s_add_u32 s58, s58, 2097152
    s_add_u32 s60, s58, 4096
    v_mov_b32 v7, 0
    s_mov_b32 s98, 0xffff0000
    s_cmp_lg_u32 s3, 0
    s_cbranch_scc1 L_polled_6
    v_mov_b32 v5, 192
L_poll_5:
    global_load_dword v6, v5, s[28:29] sc1
    s_waitcnt vmcnt(0)
    v_cmp_le_u32 vcc, 32, v6
    s_cbranch_vccnz L_polled_6
    s_sleep 2
    s_sub_u32 s101, s101, 1
    s_cbranch_scc0 L_poll_5
    s_mov_b32 s101, 0
L_polled_6:
    s_barrier
    buffer_load_dwordx4 v[48:51], v7, s[44:47], s59 offen offset:0 sc1
    buffer_load_dwordx4 v[52:55], v7, s[44:47], s59 offen offset:16 sc1
    buffer_load_dwordx4 v[56:59], v7, s[44:47], s59 offen offset:32 sc1
    buffer_load_dwordx4 v[60:63], v7, s[44:47], s59 offen offset:48 sc1
    buffer_load_dwordx4 v[16:19], v2, s[44:47], s58 offen offset:0 sc1
    buffer_load_dwordx4 v[20:23], v2, s[44:47], s58 offen offset:1024 sc1
    buffer_load_dwordx4 v[24:27], v2, s[44:47], s58 offen offset:2048 sc1
    buffer_load_dwordx4 v[28:31], v2, s[44:47], s58 offen offset:3072 sc1
    buffer_load_dwordx4 v[32:35], v2, s[44:47], s60 offen offset:0 sc1
    buffer_load_dwordx4 v[36:39], v2, s[44:47], s60 offen offset:1024 sc1
    buffer_load_dwordx4 v[40:43], v2, s[44:47], s60 offen offset:2048 sc1
    buffer_load_dwordx4 v[44:47], v2, s[44:47], s60 offen offset:3072 sc1
    s_waitcnt vmcnt(8)
    v_max3_f32 v224, v48, v50, v52
    v_max3_f32 v225, v54, v56, v58
    v_max3_f32 v224, v224, v60, v62
    v_max_f32 v224, v224, v225
    v_sub_f32 v232, v48, v224
    v_sub_f32 v233, v50, v224
    v_sub_f32 v234, v52, v224
    v_sub_f32 v235, v54, v224
    v_sub_f32 v236, v56, v224
    v_sub_f32 v237, v58, v224
    v_sub_f32 v238, v60, v224
    v_sub_f32 v239, v62, v224
    v_exp_f32 v232, v232
    v_exp_f32 v233, v233
    v_exp_f32 v234, v234
    v_exp_f32 v235, v235
    v_exp_f32 v236, v236
    v_exp_f32 v237, v237
    v_exp_f32 v238, v238
    v_exp_f32 v239, v239
    v_mul_f32 v232, v232, v49
    v_mul_f32 v233, v233, v51
    v_mul_f32 v234, v234, v53
    v_mul_f32 v235, v235, v55
    v_mul_f32 v236, v236, v57
    v_mul_f32 v237, v237, v59
    v_mul_f32 v238, v238, v61
    v_mul_f32 v239, v239, v63
    v_add_f32 v224, v232, v233
    v_add_f32 v225, v234, v235
    v_add_f32 v226, v236, v237
    v_add_f32 v227, v238, v239
    v_add_f32 v224, v224, v225
    v_add_f32 v226, v226, v227
    v_add_f32 v224, v224, v226
    v_rcp_f32 v224, v224
    s_nop 0
    v_mul_f32 v232, v232, v224
    v_mul_f32 v233, v233, v224
    v_mul_f32 v234, v234, v224
    v_mul_f32 v235, v235, v224
    v_mul_f32 v236, v236, v224
    v_mul_f32 v237, v237, v224
    v_mul_f32 v238, v238, v224
    v_mul_f32 v239, v239, v224
    s_waitcnt vmcnt(7)
    v_lshlrev_b32 v240, 16, v16
    v_and_b32 v241, s98, v16
    v_mul_f32 v224, v240, v232
    v_mul_f32 v225, v241, v232
    v_lshlrev_b32 v242, 16, v17
    v_and_b32 v243, s98, v17
    v_mul_f32 v226, v242, v232
    v_mul_f32 v227, v243, v232
    v_lshlrev_b32 v240, 16, v18
    v_and_b32 v241, s98, v18
    v_mul_f32 v228, v240, v232
    v_mul_f32 v229, v241, v232
    v_lshlrev_b32 v242, 16, v19
    v_and_b32 v243, s98, v19
    v_mul_f32 v230, v242, v232
    v_mul_f32 v231, v243, v232
    s_waitcnt vmcnt(6)
    v_lshlrev_b32 v240, 16, v20
    v_and_b32 v241, s98, v20
    v_fmac_f32 v224, v240, v233
    v_fmac_f32 v225, v241, v233
    v_lshlrev_b32 v242, 16, v21
    v_and_b32 v243, s98, v21
    v_fmac_f32 v226, v242, v233
    v_fmac_f32 v227, v243, v233
    v_lshlrev_b32 v240, 16, v22
    v_and_b32 v241, s98, v22
    v_fmac_f32 v228, v240, v233
    v_fmac_f32 v229, v241, v233
    v_lshlrev_b32 v242, 16, v23
    v_and_b32 v243, s98, v23
    v_fmac_f32 v230, v242, v233
    v_fmac_f32 v231, v243, v233
    s_waitcnt vmcnt(5)
    v_lshlrev_b32 v240, 16, v24
    v_and_b32 v241, s98, v24
    v_fmac_f32 v224, v240, v234
    v_fmac_f32 v225, v241, v234
    v_lshlrev_b32 v242, 16, v25
    v_and_b32 v243, s98, v25
    v_fmac_f32 v226, v242, v234
    v_fmac_f32 v227, v243, v234
    v_lshlrev_b32 v240, 16, v26
    v_and_b32 v241, s98, v26
    v_fmac_f32 v228, v240, v234
    v_fmac_f32 v229, v241, v234
    v_lshlrev_b32 v242, 16, v27
    v_and_b32 v243, s98, v27
    v_fmac_f32 v230, v242, v234
    v_fmac_f32 v231, v243, v234
    s_waitcnt vmcnt(4)
    v_lshlrev_b32 v240, 16, v28
    v_and_b32 v241, s98, v28
    v_fmac_f32 v224, v240, v235
    v_fmac_f32 v225, v241, v235
    v_lshlrev_b32 v242, 16, v29
    v_and_b32 v243, s98, v29
    v_fmac_f32 v226, v242, v235
    v_fmac_f32 v227, v243, v235
    v_lshlrev_b32 v240, 16, v30
    v_and_b32 v241, s98, v30
    v_fmac_f32 v228, v240, v235
    v_fmac_f32 v229, v241, v235
    v_lshlrev_b32 v242, 16, v31
    v_and_b32 v243, s98, v31
    v_fmac_f32 v230, v242, v235
    v_fmac_f32 v231, v243, v235
    s_waitcnt vmcnt(3)
    v_lshlrev_b32 v240, 16, v32
    v_and_b32 v241, s98, v32
    v_fmac_f32 v224, v240, v236
    v_fmac_f32 v225, v241, v236
    v_lshlrev_b32 v242, 16, v33
    v_and_b32 v243, s98, v33
    v_fmac_f32 v226, v242, v236
    v_fmac_f32 v227, v243, v236
    v_lshlrev_b32 v240, 16, v34
    v_and_b32 v241, s98, v34
    v_fmac_f32 v228, v240, v236
    v_fmac_f32 v229, v241, v236
    v_lshlrev_b32 v242, 16, v35
    v_and_b32 v243, s98, v35
    v_fmac_f32 v230, v242, v236
    v_fmac_f32 v231, v243, v236
    s_waitcnt vmcnt(2)
    v_lshlrev_b32 v240, 16, v36
    v_and_b32 v241, s98, v36
    v_fmac_f32 v224, v240, v237
    v_fmac_f32 v225, v241, v237
    v_lshlrev_b32 v242, 16, v37
    v_and_b32 v243, s98, v37
    v_fmac_f32 v226, v242, v237
    v_fmac_f32 v227, v243, v237
    v_lshlrev_b32 v240, 16, v38
    v_and_b32 v241, s98, v38
    v_fmac_f32 v228, v240, v237
    v_fmac_f32 v229, v241, v237
    v_lshlrev_b32 v242, 16, v39
    v_and_b32 v243, s98, v39
    v_fmac_f32 v230, v242, v237
    v_fmac_f32 v231, v243, v237
    s_waitcnt vmcnt(1)
    v_lshlrev_b32 v240, 16, v40
    v_and_b32 v241, s98, v40
    v_fmac_f32 v224, v240, v238
    v_fmac_f32 v225, v241, v238
    v_lshlrev_b32 v242, 16, v41
    v_and_b32 v243, s98, v41
    v_fmac_f32 v226, v242, v238
    v_fmac_f32 v227, v243, v238
    v_lshlrev_b32 v240, 16, v42
    v_and_b32 v241, s98, v42
    v_fmac_f32 v228, v240, v238
    v_fmac_f32 v229, v241, v238
    v_lshlrev_b32 v242, 16, v43
    v_and_b32 v243, s98, v43
    v_fmac_f32 v230, v242, v238
    v_fmac_f32 v231, v243, v238
    s_waitcnt vmcnt(0)
    v_lshlrev_b32 v240, 16, v44
    v_and_b32 v241, s98, v44
    v_fmac_f32 v224, v240, v239
    v_fmac_f32 v225, v241, v239
    v_lshlrev_b32 v242, 16, v45
    v_and_b32 v243, s98, v45
    v_fmac_f32 v226, v242, v239
    v_fmac_f32 v227, v243, v239
    v_lshlrev_b32 v240, 16, v46
    v_and_b32 v241, s98, v46
    v_fmac_f32 v228, v240, v239
    v_fmac_f32 v229, v241, v239
    v_lshlrev_b32 v242, 16, v47
    v_and_b32 v243, s98, v47
    v_fmac_f32 v230, v242, v239
    v_fmac_f32 v231, v243, v239
    v_cvt_pk_bf16_f32 v244, v224, v225
    v_cvt_pk_bf16_f32 v245, v226, v227
    v_cvt_pk_bf16_f32 v246, v228, v229
    v_cvt_pk_bf16_f32 v247, v230, v231
    s_lshl_b32 s54, s3, 10
    v_add_u32 v5, s54, v2
    ds_write_b128 v5, v[244:247]
    v_lshrrev_b32 v5, 3, v3
    v_lshlrev_b32 v5, 10, v5
    v_lshl_add_u32 v5, v4, 6, v5
    s_lshl_b32 s54, s3, 8
    v_add_u32 v5, s54, v5
    s_waitcnt lgkmcnt(0)
    s_barrier
    ds_read_b128 v[16:19], v5 offset:0
    ds_read_b128 v[20:23], v5 offset:16
    ds_read_b128 v[24:27], v5 offset:32
    ds_read_b128 v[28:31], v5 offset:48
    ds_read_b128 v[32:35], v5 offset:2048
    ds_read_b128 v[36:39], v5 offset:2064
    ds_read_b128 v[40:43], v5 offset:2080
    ds_read_b128 v[44:47], v5 offset:2096
    s_waitcnt lgkmcnt(0)
    v_perm_b32 v48, v16, v16, v8
    v_perm_b32 v49, v16, v16, v10
    v_perm_b32 v50, v16, v16, v12
    v_perm_b32 v51, v16, v16, v14
    s_nop 1
    v_mfma_f32_16x16x32_bf16 v[224:227], v[48:51], a[0:3], 0
    v_perm_b32 v52, v32, v32, v8
    v_perm_b32 v53, v32, v32, v10
    v_perm_b32 v54, v32, v32, v12
    v_perm_b32 v55, v32, v32, v14
    s_nop 1
    v_mfma_f32_16x16x32_bf16 v[228:231], v[52:55], a[0:3], 0
    v_perm_b32 v56, v16, v16, v9
    v_perm_b32 v57, v16, v16, v11
    v_perm_b32 v58, v16, v16, v13
    v_perm_b32 v59, v16, v16, v15
    s_nop 1
    v_mfma_f32_16x16x32_bf16 v[224:227], v[56:59], a[4:7], v[224:227]
    v_perm_b32 v60, v32, v32, v9
    v_perm_b32 v61, v32, v32, v11
    v_perm_b32 v62, v32, v32, v13
    v_perm_b32 v63, v32, v32, v15
    s_nop 1
    v_mfma_f32_16x16x32_bf16 v[228:231], v[60:63], a[4:7], v[228:231]
    v_perm_b32 v48, v17, v17, v8
    v_perm_b32 v49, v17, v17, v10
    v_perm_b32 v50, v17, v17, v12
    v_perm_b32 v51, v17, v17, v14
    s_nop 1
    v_mfma_f32_16x16x32_bf16 v[224:227], v[48:51], a[8:11], v[224:227]
    v_perm_b32 v52, v33, v33, v8
    v_perm_b32 v53, v33, v33, v10
    v_perm_b32 v54, v33, v33, v12
    v_perm_b32 v55, v33, v33, v14
    s_nop 1
    v_mfma_f32_16x16x32_bf16 v[228:231], v[52:55], a[8:11], v[228:231]
    v_perm_b32 v56, v17, v17, v9
    v_perm_b32 v57, v17, v17, v11
    v_perm_b32 v58, v17, v17, v13
    v_perm_b32 v59, v17, v17, v15
    s_nop 1
    v_mfma_f32_16x16x32_bf16 v[224:227], v[56:59], a[12:15], v[224:227]
    v_perm_b32 v60, v33, v33, v9
    v_perm_b32 v61, v33, v33, v11
    v_perm_b32 v62, v33, v33, v13
    v_perm_b32 v63, v33, v33, v15
    s_nop 1
    v_mfma_f32_16x16x32_bf16 v[228:231], v[60:63], a[12:15], v[228:231]
    v_perm_b32 v48, v18, v18, v8
    v_perm_b32 v49, v18, v18, v10
    v_perm_b32 v50, v18, v18, v12
    v_perm_b32 v51, v18, v18, v14
    s_nop 1
    v_mfma_f32_16x16x32_bf16 v[224:227], v[48:51], a[16:19], v[224:227]
    v_perm_b32 v52, v34, v34, v8
    v_perm_b32 v53, v34, v34, v10
    v_perm_b32 v54, v34, v34, v12
    v_perm_b32 v55, v34, v34, v14
    s_nop 1
    v_mfma_f32_16x16x32_bf16 v[228:231], v[52:55], a[16:19], v[228:231]
    v_perm_b32 v56, v18, v18, v9
    v_perm_b32 v57, v18, v18, v11
    v_perm_b32 v58, v18, v18, v13
    v_perm_b32 v59, v18, v18, v15
    s_nop 1
    v_mfma_f32_16x16x32_bf16 v[224:227], v[56:59], a[20:23], v[224:227]
    v_perm_b32 v60, v34, v34, v9
    v_perm_b32 v61, v34, v34, v11
    v_perm_b32 v62, v34, v34, v13
    v_perm_b32 v63, v34, v34, v15
    s_nop 1
    v_mfma_f32_16x16x32_bf16 v[228:231], v[60:63], a[20:23], v[228:231]
    v_perm_b32 v48, v19, v19, v8
    v_perm_b32 v49, v19, v19, v10
    v_perm_b32 v50, v19, v19, v12
    v_perm_b32 v51, v19, v19, v14
    s_nop 1
    v_mfma_f32_16x16x32_bf16 v[224:227], v[48:51], a[24:27], v[224:227]
    v_perm_b32 v52, v35, v35, v8
    v_perm_b32 v53, v35, v35, v10
    v_perm_b32 v54, v35, v35, v12
    v_perm_b32 v55, v35, v35, v14
    s_nop 1
    v_mfma_f32_16x16x32_bf16 v[228:231], v[52:55], a[24:27], v[228:231]
    v_perm_b32 v56, v19, v19, v9
    v_perm_b32 v57, v19, v19, v11
    v_perm_b32 v58, v19, v19, v13
    v_perm_b32 v59, v19, v19, v15
    s_nop 1
    v_mfma_f32_16x16x32_bf16 v[224:227], v[56:59], a[28:31], v[224:227]
    v_perm_b32 v60, v35, v35, v9
    v_perm_b32 v61, v35, v35, v11
    v_perm_b32 v62, v35, v35, v13
    v_perm_b32 v63, v35, v35, v15
    s_nop 1
    v_mfma_f32_16x16x32_bf16 v[228:231], v[60:63], a[28:31], v[228:231]
    v_perm_b32 v48, v20, v20, v8
    v_perm_b32 v49, v20, v20, v10
    v_perm_b32 v50, v20, v20, v12
    v_perm_b32 v51, v20, v20, v14
    s_nop 1
    v_mfma_f32_16x16x32_bf16 v[224:227], v[48:51], a[32:35], v[224:227]
    v_perm_b32 v52, v36, v36, v8
    v_perm_b32 v53, v36, v36, v10
    v_perm_b32 v54, v36, v36, v12
    v_perm_b32 v55, v36, v36, v14
    s_nop 1
    v_mfma_f32_16x16x32_bf16 v[228:231], v[52:55], a[32:35], v[228:231]
    v_perm_b32 v56, v20, v20, v9
    v_perm_b32 v57, v20, v20, v11
    v_perm_b32 v58, v20, v20, v13
    v_perm_b32 v59, v20, v20, v15
    s_nop 1
    v_mfma_f32_16x16x32_bf16 v[224:227], v[56:59], a[36:39], v[224:227]
    v_perm_b32 v60, v36, v36, v9
    v_perm_b32 v61, v36, v36, v11
    v_perm_b32 v62, v36, v36, v13
    v_perm_b32 v63, v36, v36, v15
    s_nop 1
    v_mfma_f32_16x16x32_bf16 v[228:231], v[60:63], a[36:39], v[228:231]
    v_perm_b32 v48, v21, v21, v8
    v_perm_b32 v49, v21, v21, v10
    v_perm_b32 v50, v21, v21, v12
    v_perm_b32 v51, v21, v21, v14
    s_nop 1
    v_mfma_f32_16x16x32_bf16 v[224:227], v[48:51], a[40:43], v[224:227]
    v_perm_b32 v52, v37, v37, v8
    v_perm_b32 v53, v37, v37, v10
    v_perm_b32 v54, v37, v37, v12
    v_perm_b32 v55, v37, v37, v14
    s_nop 1
    v_mfma_f32_16x16x32_bf16 v[228:231], v[52:55], a[40:43], v[228:231]
    v_perm_b32 v56, v21, v21, v9
    v_perm_b32 v57, v21, v21, v11
    v_perm_b32 v58, v21, v21, v13
    v_perm_b32 v59, v21, v21, v15
    s_nop 1
    v_mfma_f32_16x16x32_bf16 v[224:227], v[56:59], a[44:47], v[224:227]
    v_perm_b32 v60, v37, v37, v9
    v_perm_b32 v61, v37, v37, v11
    v_perm_b32 v62, v37, v37, v13
    v_perm_b32 v63, v37, v37, v15
    s_nop 1
    v_mfma_f32_16x16x32_bf16 v[228:231], v[60:63], a[44:47], v[228:231]
    v_perm_b32 v48, v22, v22, v8
    v_perm_b32 v49, v22, v22, v10
    v_perm_b32 v50, v22, v22, v12
    v_perm_b32 v51, v22, v22, v14
    s_nop 1
    v_mfma_f32_16x16x32_bf16 v[224:227], v[48:51], a[48:51], v[224:227]
    v_perm_b32 v52, v38, v38, v8
    v_perm_b32 v53, v38, v38, v10
    v_perm_b32 v54, v38, v38, v12
    v_perm_b32 v55, v38, v38, v14
    s_nop 1
    v_mfma_f32_16x16x32_bf16 v[228:231], v[52:55], a[48:51], v[228:231]
    v_perm_b32 v56, v22, v22, v9
    v_perm_b32 v57, v22, v22, v11
    v_perm_b32 v58, v22, v22, v13
    v_perm_b32 v59, v22, v22, v15
    s_nop 1
    v_mfma_f32_16x16x32_bf16 v[224:227], v[56:59], a[52:55], v[224:227]
    v_perm_b32 v60, v38, v38, v9
    v_perm_b32 v61, v38, v38, v11
    v_perm_b32 v62, v38, v38, v13
    v_perm_b32 v63, v38, v38, v15
    s_nop 1
    v_mfma_f32_16x16x32_bf16 v[228:231], v[60:63], a[52:55], v[228:231]
    v_perm_b32 v48, v23, v23, v8
    v_perm_b32 v49, v23, v23, v10
    v_perm_b32 v50, v23, v23, v12
    v_perm_b32 v51, v23, v23, v14
    s_nop 1
    v_mfma_f32_16x16x32_bf16 v[224:227], v[48:51], a[56:59], v[224:227]
    v_perm_b32 v52, v39, v39, v8
    v_perm_b32 v53, v39, v39, v10
    v_perm_b32 v54, v39, v39, v12
    v_perm_b32 v55, v39, v39, v14
    s_nop 1
    v_mfma_f32_16x16x32_bf16 v[228:231], v[52:55], a[56:59], v[228:231]
    v_perm_b32 v56, v23, v23, v9
    v_perm_b32 v57, v23, v23, v11
    v_perm_b32 v58, v23, v23, v13
    v_perm_b32 v59, v23, v23, v15
    s_nop 1
    v_mfma_f32_16x16x32_bf16 v[224:227], v[56:59], a[60:63], v[224:227]
    v_perm_b32 v60, v39, v39, v9
    v_perm_b32 v61, v39, v39, v11
    v_perm_b32 v62, v39, v39, v13
    v_perm_b32 v63, v39, v39, v15
    s_nop 1
    v_mfma_f32_16x16x32_bf16 v[228:231], v[60:63], a[60:63], v[228:231]
    v_perm_b32 v48, v24, v24, v8
    v_perm_b32 v49, v24, v24, v10
    v_perm_b32 v50, v24, v24, v12
    v_perm_b32 v51, v24, v24, v14
    s_nop 1
    v_mfma_f32_16x16x32_bf16 v[224:227], v[48:51], a[64:67], v[224:227]
    v_perm_b32 v52, v40, v40, v8
    v_perm_b32 v53, v40, v40, v10
    v_perm_b32 v54, v40, v40, v12
    v_perm_b32 v55, v40, v40, v14
    s_nop 1
    v_mfma_f32_16x16x32_bf16 v[228:231], v[52:55], a[64:67], v[228:231]
    v_perm_b32 v56, v24, v24, v9
    v_perm_b32 v57, v24, v24, v11
    v_perm_b32 v58, v24, v24, v13
    v_perm_b32 v59, v24, v24, v15
    s_nop 1
    v_mfma_f32_16x16x32_bf16 v[224:227], v[56:59], a[68:71], v[224:227]
    v_perm_b32 v60, v40, v40, v9
    v_perm_b32 v61, v40, v40, v11
    v_perm_b32 v62, v40, v40, v13
    v_perm_b32 v63, v40, v40, v15
    s_nop 1
    v_mfma_f32_16x16x32_bf16 v[228:231], v[60:63], a[68:71], v[228:231]
    v_perm_b32 v48, v25, v25, v8
    v_perm_b32 v49, v25, v25, v10
    v_perm_b32 v50, v25, v25, v12
    v_perm_b32 v51, v25, v25, v14
    s_nop 1
    v_mfma_f32_16x16x32_bf16 v[224:227], v[48:51], a[72:75], v[224:227]
    v_perm_b32 v52, v41, v41, v8
    v_perm_b32 v53, v41, v41, v10
    v_perm_b32 v54, v41, v41, v12
    v_perm_b32 v55, v41, v41, v14
    s_nop 1
    v_mfma_f32_16x16x32_bf16 v[228:231], v[52:55], a[72:75], v[228:231]
    v_perm_b32 v56, v25, v25, v9
    v_perm_b32 v57, v25, v25, v11
    v_perm_b32 v58, v25, v25, v13
    v_perm_b32 v59, v25, v25, v15
    s_nop 1
    v_mfma_f32_16x16x32_bf16 v[224:227], v[56:59], a[76:79], v[224:227]
    v_perm_b32 v60, v41, v41, v9
    v_perm_b32 v61, v41, v41, v11
    v_perm_b32 v62, v41, v41, v13
    v_perm_b32 v63, v41, v41, v15
    s_nop 1
    v_mfma_f32_16x16x32_bf16 v[228:231], v[60:63], a[76:79], v[228:231]
    v_perm_b32 v48, v26, v26, v8
    v_perm_b32 v49, v26, v26, v10
    v_perm_b32 v50, v26, v26, v12
    v_perm_b32 v51, v26, v26, v14
    s_nop 1
    v_mfma_f32_16x16x32_bf16 v[224:227], v[48:51], a[80:83], v[224:227]
    v_perm_b32 v52, v42, v42, v8
    v_perm_b32 v53, v42, v42, v10
    v_perm_b32 v54, v42, v42, v12
    v_perm_b32 v55, v42, v42, v14
    s_nop 1
    v_mfma_f32_16x16x32_bf16 v[228:231], v[52:55], a[80:83], v[228:231]
    v_perm_b32 v56, v26, v26, v9
    v_perm_b32 v57, v26, v26, v11
    v_perm_b32 v58, v26, v26, v13
    v_perm_b32 v59, v26, v26, v15
    s_nop 1
    v_mfma_f32_16x16x32_bf16 v[224:227], v[56:59], a[84:87], v[224:227]
    v_perm_b32 v60, v42, v42, v9
    v_perm_b32 v61, v42, v42, v11
    v_perm_b32 v62, v42, v42, v13
    v_perm_b32 v63, v42, v42, v15
    s_nop 1
    v_mfma_f32_16x16x32_bf16 v[228:231], v[60:63], a[84:87], v[228:231]
    v_perm_b32 v48, v27, v27, v8
    v_perm_b32 v49, v27, v27, v10
    v_perm_b32 v50, v27, v27, v12
    v_perm_b32 v51, v27, v27, v14
    s_nop 1
    v_mfma_f32_16x16x32_bf16 v[224:227], v[48:51], a[88:91], v[224:227]
    v_perm_b32 v52, v43, v43, v8
    v_perm_b32 v53, v43, v43, v10
    v_perm_b32 v54, v43, v43, v12
    v_perm_b32 v55, v43, v43, v14
    s_nop 1
    v_mfma_f32_16x16x32_bf16 v[228:231], v[52:55], a[88:91], v[228:231]
    v_perm_b32 v56, v27, v27, v9
    v_perm_b32 v57, v27, v27, v11
    v_perm_b32 v58, v27, v27, v13
    v_perm_b32 v59, v27, v27, v15
    s_nop 1
    v_mfma_f32_16x16x32_bf16 v[224:227], v[56:59], a[92:95], v[224:227]
    v_perm_b32 v60, v43, v43, v9
    v_perm_b32 v61, v43, v43, v11
    v_perm_b32 v62, v43, v43, v13
    v_perm_b32 v63, v43, v43, v15
    s_nop 1
    v_mfma_f32_16x16x32_bf16 v[228:231], v[60:63], a[92:95], v[228:231]
    v_perm_b32 v48, v28, v28, v8
    v_perm_b32 v49, v28, v28, v10
    v_perm_b32 v50, v28, v28, v12
    v_perm_b32 v51, v28, v28, v14
    s_nop 1
    v_mfma_f32_16x16x32_bf16 v[224:227], v[48:51], a[96:99], v[224:227]
    v_perm_b32 v52, v44, v44, v8
    v_perm_b32 v53, v44, v44, v10
    v_perm_b32 v54, v44, v44, v12
    v_perm_b32 v55, v44, v44, v14
    s_nop 1
    v_mfma_f32_16x16x32_bf16 v[228:231], v[52:55], a[96:99], v[228:231]
    v_perm_b32 v56, v28, v28, v9
    v_perm_b32 v57, v28, v28, v11
    v_perm_b32 v58, v28, v28, v13
    v_perm_b32 v59, v28, v28, v15
    s_nop 1
    v_mfma_f32_16x16x32_bf16 v[224:227], v[56:59], a[100:103], v[224:227]
    v_perm_b32 v60, v44, v44, v9
    v_perm_b32 v61, v44, v44, v11
    v_perm_b32 v62, v44, v44, v13
    v_perm_b32 v63, v44, v44, v15
    s_nop 1
    v_mfma_f32_16x16x32_bf16 v[228:231], v[60:63], a[100:103], v[228:231]
    v_perm_b32 v48, v29, v29, v8
    v_perm_b32 v49, v29, v29, v10
    v_perm_b32 v50, v29, v29, v12
    v_perm_b32 v51, v29, v29, v14
    s_nop 1
    v_mfma_f32_16x16x32_bf16 v[224:227], v[48:51], a[104:107], v[224:227]
    v_perm_b32 v52, v45, v45, v8
    v_perm_b32 v53, v45, v45, v10
    v_perm_b32 v54, v45, v45, v12
    v_perm_b32 v55, v45, v45, v14
    s_nop 1
    v_mfma_f32_16x16x32_bf16 v[228:231], v[52:55], a[104:107], v[228:231]
    v_perm_b32 v56, v29, v29, v9
    v_perm_b32 v57, v29, v29, v11
    v_perm_b32 v58, v29, v29, v13
    v_perm_b32 v59, v29, v29, v15
    s_nop 1
    v_mfma_f32_16x16x32_bf16 v[224:227], v[56:59], a[108:111], v[224:227]
    v_perm_b32 v60, v45, v45, v9
    v_perm_b32 v61, v45, v45, v11
    v_perm_b32 v62, v45, v45, v13
    v_perm_b32 v63, v45, v45, v15
    s_nop 1
    v_mfma_f32_16x16x32_bf16 v[228:231], v[60:63], a[108:111], v[228:231]
    v_perm_b32 v48, v30, v30, v8
    v_perm_b32 v49, v30, v30, v10
    v_perm_b32 v50, v30, v30, v12
    v_perm_b32 v51, v30, v30, v14
    s_nop 1
    v_mfma_f32_16x16x32_bf16 v[224:227], v[48:51], a[112:115], v[224:227]
    v_perm_b32 v52, v46, v46, v8
    v_perm_b32 v53, v46, v46, v10
    v_perm_b32 v54, v46, v46, v12
    v_perm_b32 v55, v46, v46, v14
    s_nop 1
    v_mfma_f32_16x16x32_bf16 v[228:231], v[52:55], a[112:115], v[228:231]
    v_perm_b32 v56, v30, v30, v9
    v_perm_b32 v57, v30, v30, v11
    v_perm_b32 v58, v30, v30, v13
    v_perm_b32 v59, v30, v30, v15
    s_nop 1
    v_mfma_f32_16x16x32_bf16 v[224:227], v[56:59], a[116:119], v[224:227]
    v_perm_b32 v60, v46, v46, v9
    v_perm_b32 v61, v46, v46, v11
    v_perm_b32 v62, v46, v46, v13
    v_perm_b32 v63, v46, v46, v15
    s_nop 1
    v_mfma_f32_16x16x32_bf16 v[228:231], v[60:63], a[116:119], v[228:231]
    v_perm_b32 v48, v31, v31, v8
    v_perm_b32 v49, v31, v31, v10
    v_perm_b32 v50, v31, v31, v12
    v_perm_b32 v51, v31, v31, v14
    s_nop 1
    v_mfma_f32_16x16x32_bf16 v[224:227], v[48:51], a[120:123], v[224:227]
    v_perm_b32 v52, v47, v47, v8
    v_perm_b32 v53, v47, v47, v10
    v_perm_b32 v54, v47, v47, v12
    v_perm_b32 v55, v47, v47, v14
    s_nop 1
    v_mfma_f32_16x16x32_bf16 v[228:231], v[52:55], a[120:123], v[228:231]
    v_perm_b32 v56, v31, v31, v9
    v_perm_b32 v57, v31, v31, v11
    v_perm_b32 v58, v31, v31, v13
    v_perm_b32 v59, v31, v31, v15
    s_nop 1
    v_mfma_f32_16x16x32_bf16 v[224:227], v[56:59], a[124:127], v[224:227]
    v_perm_b32 v60, v47, v47, v9
    v_perm_b32 v61, v47, v47, v11
    v_perm_b32 v62, v47, v47, v13
    v_perm_b32 v63, v47, v47, v15
    s_nop 1
    v_mfma_f32_16x16x32_bf16 v[228:231], v[60:63], a[124:127], v[228:231]
    v_lshrrev_b32 v5, 1, v4
    v_lshlrev_b32 v5, 9, v5
    v_lshl_add_u32 v5, v3, 5, v5
    v_and_b32 v6, 1, v4
    v_lshl_add_u32 v5, v6, 4, v5
    s_lshl_b32 s54, s3, 11
    s_add_u32 s54, s54, 131072
    v_add_u32 v5, s54, v5
    ds_write_b128 v5, v[224:227]
    ds_write_b128 v5, v[228:231] offset:1024
    s_waitcnt lgkmcnt(0)
    s_barrier
    v_lshrrev_b32 v5, 2, v3
    v_lshlrev_b32 v5, 9, v5
    v_lshl_add_u32 v5, v4, 5, v5
    v_add_u32 v5, 131072, v5
    ds_read_b128 v[16:19], v5 offset:0
    ds_read_b128 v[20:23], v5 offset:16
    ds_read_b128 v[24:27], v5 offset:2048
    ds_read_b128 v[28:31], v5 offset:2064
    ds_read_b128 v[32:35], v5 offset:4096
    ds_read_b128 v[36:39], v5 offset:4112
    ds_read_b128 v[40:43], v5 offset:6144
    ds_read_b128 v[44:47], v5 offset:6160
    s_waitcnt lgkmcnt(0)
    v_add_f32 v16, v16, v24
    v_add_f32 v32, v32, v40
    v_add_f32 v17, v17, v25
    v_add_f32 v33, v33, v41
    v_add_f32 v18, v18, v26
    v_add_f32 v34, v34, v42
    v_add_f32 v19, v19, v27
    v_add_f32 v35, v35, v43
    v_add_f32 v20, v20, v28
    v_add_f32 v36, v36, v44
    v_add_f32 v21, v21, v29
    v_add_f32 v37, v37, v45
    v_add_f32 v22, v22, v30
    v_add_f32 v38, v38, v46
    v_add_f32 v23, v23, v31
    v_add_f32 v39, v39, v47
    v_add_f32 v16, v16, v32
    v_add_f32 v17, v17, v33
    v_add_f32 v18, v18, v34
    v_add_f32 v19, v19, v35
    v_add_f32 v20, v20, v36
    v_add_f32 v21, v21, v37
    v_add_f32 v22, v22, v38
    v_add_f32 v23, v23, v39
    v_cvt_pk_bf16_f32 v48, v16, v17
    v_cvt_pk_bf16_f32 v49, v18, v19
    v_cvt_pk_bf16_f32 v50, v20, v21
    v_cvt_pk_bf16_f32 v51, v22, v23
    ds_read_b128 v[16:19], v5 offset:128
    ds_read_b128 v[20:23], v5 offset:144
    ds_read_b128 v[24:27], v5 offset:2176
    ds_read_b128 v[28:31], v5 offset:2192
    ds_read_b128 v[32:35], v5 offset:4224
    ds_read_b128 v[36:39], v5 offset:4240
    ds_read_b128 v[40:43], v5 offset:6272
    ds_read_b128 v[44:47], v5 offset:6288
    s_waitcnt lgkmcnt(0)
    v_add_f32 v16, v16, v24
    v_add_f32 v32, v32, v40
    v_add_f32 v17, v17, v25
    v_add_f32 v33, v33, v41
    v_add_f32 v18, v18, v26
    v_add_f32 v34, v34, v42
    v_add_f32 v19, v19, v27
    v_add_f32 v35, v35, v43
    v_add_f32 v20, v20, v28
    v_add_f32 v36, v36, v44
    v_add_f32 v21, v21, v29
    v_add_f32 v37, v37, v45
    v_add_f32 v22, v22, v30
    v_add_f32 v38, v38, v46
    v_add_f32 v23, v23, v31
    v_add_f32 v39, v39, v47
    v_add_f32 v16, v16, v32
    v_add_f32 v17, v17, v33
    v_add_f32 v18, v18, v34
    v_add_f32 v19, v19, v35
    v_add_f32 v20, v20, v36
    v_add_f32 v21, v21, v37
    v_add_f32 v22, v22, v38
    v_add_f32 v23, v23, v39
    v_cvt_pk_bf16_f32 v52, v16, v17
    v_cvt_pk_bf16_f32 v53, v18, v19
    v_cvt_pk_bf16_f32 v54, v20, v21
    v_cvt_pk_bf16_f32 v55, v22, v23
    ds_read_b128 v[16:19], v5 offset:256
    ds_read_b128 v[20:23], v5 offset:272
    ds_read_b128 v[24:27], v5 offset:2304
    ds_read_b128 v[28:31], v5 offset:2320
    ds_read_b128 v[32:35], v5 offset:4352
    ds_read_b128 v[36:39], v5 offset:4368
    ds_read_b128 v[40:43], v5 offset:6400
    ds_read_b128 v[44:47], v5 offset:6416
    s_waitcnt lgkmcnt(0)
    v_add_f32 v16, v16, v24
    v_add_f32 v32, v32, v40
    v_add_f32 v17, v17, v25
    v_add_f32 v33, v33, v41
    v_add_f32 v18, v18, v26
    v_add_f32 v34, v34, v42
    v_add_f32 v19, v19, v27
    v_add_f32 v35, v35, v43
    v_add_f32 v20, v20, v28
    v_add_f32 v36, v36, v44
    v_add_f32 v21, v21, v29
    v_add_f32 v37, v37, v45
    v_add_f32 v22, v22, v30
    v_add_f32 v38, v38, v46
    v_add_f32 v23, v23, v31
    v_add_f32 v39, v39, v47
    v_add_f32 v16, v16, v32
    v_add_f32 v17, v17, v33
    v_add_f32 v18, v18, v34
    v_add_f32 v19, v19, v35
    v_add_f32 v20, v20, v36
    v_add_f32 v21, v21, v37
    v_add_f32 v22, v22, v38
    v_add_f32 v23, v23, v39
    v_cvt_pk_bf16_f32 v56, v16, v17
    v_cvt_pk_bf16_f32 v57, v18, v19
    v_cvt_pk_bf16_f32 v58, v20, v21
    v_cvt_pk_bf16_f32 v59, v22, v23
    ds_read_b128 v[16:19], v5 offset:384
    ds_read_b128 v[20:23], v5 offset:400
    ds_read_b128 v[24:27], v5 offset:2432
    ds_read_b128 v[28:31], v5 offset:2448
    ds_read_b128 v[32:35], v5 offset:4480
    ds_read_b128 v[36:39], v5 offset:4496
    ds_read_b128 v[40:43], v5 offset:6528
    ds_read_b128 v[44:47], v5 offset:6544
    s_waitcnt lgkmcnt(0)
    v_add_f32 v16, v16, v24
    v_add_f32 v32, v32, v40
    v_add_f32 v17, v17, v25
    v_add_f32 v33, v33, v41
    v_add_f32 v18, v18, v26
    v_add_f32 v34, v34, v42
    v_add_f32 v19, v19, v27
    v_add_f32 v35, v35, v43
    v_add_f32 v20, v20, v28
    v_add_f32 v36, v36, v44
    v_add_f32 v21, v21, v29
    v_add_f32 v37, v37, v45
    v_add_f32 v22, v22, v30
    v_add_f32 v38, v38, v46
    v_add_f32 v23, v23, v31
    v_add_f32 v39, v39, v47
    v_add_f32 v16, v16, v32
    v_add_f32 v17, v17, v33
    v_add_f32 v18, v18, v34
    v_add_f32 v19, v19, v35
    v_add_f32 v20, v20, v36
    v_add_f32 v21, v21, v37
    v_add_f32 v22, v22, v38
    v_add_f32 v23, v23, v39
    v_cvt_pk_bf16_f32 v60, v16, v17
    v_cvt_pk_bf16_f32 v61, v18, v19
    v_cvt_pk_bf16_f32 v62, v20, v21
    v_cvt_pk_bf16_f32 v63, v22, v23
    v_mfma_f32_16x16x32_bf16 v[224:227], v[48:51], v[64:67], 0
    v_mfma_f32_16x16x32_bf16 v[228:231], v[48:51], v[68:71], 0
    v_mfma_f32_16x16x32_bf16 v[232:235], v[48:51], v[72:75], 0
    v_mfma_f32_16x16x32_bf16 v[236:239], v[48:51], v[76:79], 0
    v_mfma_f32_16x16x32_bf16 v[240:243], v[48:51], v[80:83], 0
    v_mfma_f32_16x16x32_bf16 v[244:247], v[48:51], v[84:87], 0
    v_mfma_f32_16x16x32_bf16 v[248:251], v[48:51], v[88:91], 0
    v_mfma_f32_16x16x32_bf16 v[252:255], v[48:51], v[92:95], 0
    v_mfma_f32_16x16x32_bf16 v[40:43], v[48:51], v[192:195], 0
    v_mfma_f32_16x16x32_bf16 v[44:47], v[48:51], v[196:199], 0
    v_mfma_f32_16x16x32_bf16 v[224:227], v[52:55], v[96:99], v[224:227]
    v_mfma_f32_16x16x32_bf16 v[228:231], v[52:55], v[100:103], v[228:231]
    v_mfma_f32_16x16x32_bf16 v[232:235], v[52:55], v[104:107], v[232:235]
    v_mfma_f32_16x16x32_bf16 v[236:239], v[52:55], v[108:111], v[236:239]
    v_mfma_f32_16x16x32_bf16 v[240:243], v[52:55], v[112:115], v[240:243]
    v_mfma_f32_16x16x32_bf16 v[244:247], v[52:55], v[116:119], v[244:247]
    v_mfma_f32_16x16x32_bf16 v[248:251], v[52:55], v[120:123], v[248:251]
    v_mfma_f32_16x16x32_bf16 v[252:255], v[52:55], v[124:127], v[252:255]
    v_mfma_f32_16x16x32_bf16 v[40:43], v[52:55], v[200:203], v[40:43]
    v_mfma_f32_16x16x32_bf16 v[44:47], v[52:55], v[204:207], v[44:47]
    v_mfma_f32_16x16x32_bf16 v[224:227], v[56:59], v[128:131], v[224:227]
    v_mfma_f32_16x16x32_bf16 v[228:231], v[56:59], v[132:135], v[228:231]
    v_mfma_f32_16x16x32_bf16 v[232:235], v[56:59], v[136:139], v[232:235]
    v_mfma_f32_16x16x32_bf16 v[236:239], v[56:59], v[140:143], v[236:239]
    v_mfma_f32_16x16x32_bf16 v[240:243], v[56:59], v[144:147], v[240:243]
    v_mfma_f32_16x16x32_bf16 v[244:247], v[56:59], v[148:151], v[244:247]
    v_mfma_f32_16x16x32_bf16 v[248:251], v[56:59], v[152:155], v[248:251]
    v_mfma_f32_16x16x32_bf16 v[252:255], v[56:59], v[156:159], v[252:255]
    v_mfma_f32_16x16x32_bf16 v[40:43], v[56:59], v[208:211], v[40:43]
    v_mfma_f32_16x16x32_bf16 v[44:47], v[56:59], v[212:215], v[44:47]
    v_mfma_f32_16x16x32_bf16 v[224:227], v[60:63], v[160:163], v[224:227]
    v_mfma_f32_16x16x32_bf16 v[228:231], v[60:63], v[164:167], v[228:231]
    v_mfma_f32_16x16x32_bf16 v[232:235], v[60:63], v[168:171], v[232:235]
    v_mfma_f32_16x16x32_bf16 v[236:239], v[60:63], v[172:175], v[236:239]
    v_mfma_f32_16x16x32_bf16 v[240:243], v[60:63], v[176:179], v[240:243]
    v_mfma_f32_16x16x32_bf16 v[244:247], v[60:63], v[180:183], v[244:247]
    v_mfma_f32_16x16x32_bf16 v[248:251], v[60:63], v[184:187], v[248:251]
    v_mfma_f32_16x16x32_bf16 v[252:255], v[60:63], v[188:191], v[252:255]
    v_mfma_f32_16x16x32_bf16 v[40:43], v[60:63], v[216:219], v[40:43]
    v_mfma_f32_16x16x32_bf16 v[44:47], v[60:63], v[220:223], v[44:47]
    v_mul_u32_u24 v7, 73728, v4
    v_lshrrev_b32 v5, 3, v3
    v_lshl_add_u32 v6, v5, 13, v7
    v_and_b32 v5, 7, v3
    v_lshl_add_u32 v6, v5, 4, v6
    v_lshl_add_u32 v7, v3, 3, v7
    v_add_u32 v7, 65536, v7
    s_lshl_b32 s56, s52, 7
    s_add_u32 s56, s56, 4718592
    s_lshl_b32 s54, s3, 14
    s_add_u32 s54, s54, s56
    s_add_u32 s55, s54, 4096
    s_and_b32 s57, s3, 1
    s_lshl_b32 s57, s57, 12
    s_add_u32 s56, s56, s57
    v_min_u32 v16, -2, v224
    v_min_u32 v17, -2, v228
    v_min_u32 v18, -2, v232
    v_min_u32 v19, -2, v236
    v_min_u32 v20, -2, v240
    v_min_u32 v21, -2, v244
    v_min_u32 v22, -2, v248
    v_min_u32 v23, -2, v252
    v_min_u32 v24, -2, v40
    v_min_u32 v25, -2, v44
    buffer_store_dwordx4 v[16:19], v6, s[44:47], s54 offen sc1
    buffer_store_dwordx4 v[20:23], v6, s[44:47], s55 offen sc1
    buffer_store_dwordx2 v[24:25], v7, s[44:47], s56 offen sc1
    s_lshl_b32 s54, s3, 5
    s_add_u32 s54, s54, s53
    s_cmp_ge_u32 s54, 72
    s_cbranch_scc1 L_nored_7
    s_lshl_b32 s55, s54, 12
    s_add_u32 s55, s55, 4718592
    s_mul_hi_u32 s56, s54, 238609295
    s_mul_i32 s57, s56, 18
    s_sub_u32 s57, s54, s57
    s_mul_i32 s56, s56, 2304
    s_add_u32 s56, s56, 1152
    s_lshr_b32 s58, s57, 1
    s_lshl_b32 s58, s58, 7
    s_and_b32 s59, s57, 1
    s_cmp_lt_u32 s57, 16
    s_cselect_b32 s60, 3, 6
    s_cselect_b32 s61, 4, 3
    s_lshl_b32 s59, s59, s60
    s_add_u32 s56, s56, s58
    s_add_u32 s56, s56, s59
    v_lshlrev_b32 v5, s61, v1
    s_mov_b32 s48, s26
    s_mov_b32 s49, s27
    s_mov_b32 s50, 9216
    s_mov_b32 s51, 0x20000
L_redpoll_8:
    buffer_load_dwordx4 v[16:19], v2, s[44:47], s55 offen offset:0 sc1
    buffer_load_dwordx4 v[20:23], v2, s[44:47], s55 offen offset:1024 sc1
    buffer_load_dwordx4 v[24:27], v2, s[44:47], s55 offen offset:2048 sc1
    buffer_load_dwordx4 v[28:31], v2, s[44:47], s55 offen offset:3072 sc1
    s_waitcnt vmcnt(0)
    v_max3_u32 v32, v16, v17, v18
    v_max3_u32 v33, v19, v20, v21
    v_max3_u32 v34, v22, v23, v24
    v_max3_u32 v35, v25, v26, v27
    v_max3_u32 v32, v32, v28, v29
    v_max3_u32 v33, v33, v30, v31
    v_max3_u32 v32, v32, v33, v34
    v_max_u32 v32, v32, v35
    v_cmp_eq_u32 vcc, -1, v32
    s_cbranch_vccz L_redok_9
    s_sub_u32 s101, s101, 1
    s_cbranch_scc0 L_redpoll_8
    s_mov_b32 s101, 0
L_redok_9:
    v_add_f32 v16, v16, v20
    v_add_f32 v24, v24, v28
    v_add_f32 v17, v17, v21
    v_add_f32 v25, v25, v29
    v_add_f32 v18, v18, v22
    v_add_f32 v26, v26, v30
    v_add_f32 v19, v19, v23
    v_add_f32 v27, v27, v31
    v_add_f32 v16, v16, v24
    v_add_f32 v17, v17, v25
    v_add_f32 v18, v18, v26
    v_add_f32 v19, v19, v27
    v_add_f32_dpp v16, v16, v16 row_ror:8 row_mask:0xf bank_mask:0xf
    v_add_f32_dpp v17, v17, v17 row_ror:8 row_mask:0xf bank_mask:0xf
    v_add_f32_dpp v18, v18, v18 row_ror:8 row_mask:0xf bank_mask:0xf
    v_add_f32_dpp v19, v19, v19 row_ror:8 row_mask:0xf bank_mask:0xf
    v_mov_b32 v20, v16
    v_mov_b32 v21, v17
    v_mov_b32 v22, v18
    v_mov_b32 v23, v19
    v_permlane16_swap_b32 v16, v20
    v_permlane16_swap_b32 v17, v21
    v_permlane16_swap_b32 v18, v22
    v_permlane16_swap_b32 v19, v23
    v_add_f32 v16, v16, v20
    v_add_f32 v17, v17, v21
    v_add_f32 v18, v18, v22
    v_add_f32 v19, v19, v23
    v_mov_b32 v20, v16
    v_mov_b32 v21, v17
    v_mov_b32 v22, v18
    v_mov_b32 v23, v19
    v_permlane32_swap_b32 v16, v20
    v_permlane32_swap_b32 v17, v21
    v_permlane32_swap_b32 v18, v22
    v_permlane32_swap_b32 v19, v23
    v_add_f32 v16, v16, v20
    v_add_f32 v17, v17, v21
    v_add_f32 v18, v18, v22
    v_add_f32 v19, v19, v23
    v_cvt_pk_bf16_f32 v16, v16, v17
    v_cvt_pk_bf16_f32 v17, v18, v19
    s_mov_b64 exec, 0xff
    buffer_store_dwordx2 v[16:17], v5, s[48:51], s56 offen
    s_mov_b64 exec, -1
L_nored_7:
    s_endpgm
L_roleH_end:
L_roleC:
    s_mov_b32 s101, 100000
    s_getpc_b64 s[56:57]
L_pc_10:
    s_sub_u32 s56, s56, L_pc_10-L_roleC
    s_subb_u32 s57, s57, 0
    v_lshlrev_b32 v5, 7, v0
    v_min_u32 v6, L_roleC_end-L_roleC-4, v5
    global_load_dword v122, v6, s[56:57]
    v_mov_b32 v20, -1
    v_mov_b32 v21, -1
    v_mov_b32 v22, -1
    v_mov_b32 v23, -1
    v_mul_u32_u24 v7, 73728, v4
    v_lshrrev_b32 v5, 3, v3
    v_lshl_add_u32 v6, v5, 13, v7
    v_and_b32 v5, 7, v3
    v_lshl_add_u32 v6, v5, 4, v6
    v_lshl_add_u32 v7, v3, 3, v7
    v_add_u32 v7, 65536, v7
    s_lshl_b32 s56, s52, 7
    s_add_u32 s56, s56, 4194304
    s_lshl_b32 s54, s3, 14
    s_add_u32 s54, s54, s56
    s_add_u32 s55, s54, 4096
    s_and_b32 s57, s3, 1
    s_lshl_b32 s57, s57, 12
    s_add_u32 s56, s56, s57
    s_waitcnt lgkmcnt(0)
    s_mov_b32 s44, s30
    s_mov_b32 s45, s31
    s_mov_b32 s46, 536870912
    s_mov_b32 s47, 0x20000
    buffer_store_dwordx4 v[20:23], v6, s[44:47], s54 offen sc1
    buffer_store_dwordx4 v[20:23], v6, s[44:47], s55 offen sc1
    buffer_store_dwordx2 v[20:21], v7, s[44:47], s56 offen sc1
    v_mov_b32 v7, 536870912
    v_cmp_gt_u32 vcc, 32, v1
    s_nop 1
    v_cndmask_b32 v123, v7, v2, vcc
    s_lshl_b32 s98, s52, 12
    s_lshl_b32 s54, s3, 9
    s_add_u32 s98, s98, s54
    s_add_u32 s98, s98, 5244928
    buffer_store_dwordx4 v[20:23], v123, s[44:47], s98 offen sc1
    s_lshl_b32 s55, s52, 15
    s_lshl_b32 s54, s3, 10
    s_add_u32 s55, s55, s54
    buffer_store_dwordx4 v[20:23], v2, s[44:47], s55 offen sc1
    s_add_u32 s55, s55, 4096
    buffer_store_dwordx4 v[20:23], v2, s[44:47], s55 offen sc1
    s_add_u32 s55, s55, 4096
    buffer_store_dwordx4 v[20:23], v2, s[44:47], s55 offen sc1
    s_add_u32 s55, s55, 4096
    buffer_store_dwordx4 v[20:23], v2, s[44:47], s55 offen sc1
    s_add_u32 s55, s55, 4096
    buffer_store_dwordx4 v[20:23], v2, s[44:47], s55 offen sc1
    s_add_u32 s55, s55, 4096
    buffer_store_dwordx4 v[20:23], v2, s[44:47], s55 offen sc1
    s_add_u32 s55, s55, 4096
    s_lshl_b32 s55, s52, 2
    s_add_u32 s55, s55, s3
    s_lshl_b32 s55, s55, 7
    s_add_u32 s55, s55, 5373952
    v_mov_b32 v5, 0
    buffer_store_dword v5, v5, s[44:47], s55 offen sc1
    s_mov_b32 s40, s10
    s_mov_b32 s41, s11
    s_mov_b32 s42, 4718592
    s_mov_b32 s43, 0x20000
    s_mov_b32 s48, s4
    s_mov_b32 s49, s5
    s_mov_b32 s50, 4608
    s_mov_b32 s51, 0x20000
    s_mov_b32 s32, s16
    s_mov_b32 s33, s17
    s_mov_b32 s34, 16777216
    s_mov_b32 s35, 0x20000
    v_lshrrev_b32 v5, 3, v3
    v_mul_u32_u24 v5, 1152, v5
    v_mul_u32_u24 v6, 36, v4
    v_add_u32 v5, v5, v6
    s_mul_i32 s54, s3, 144
    s_add_u32 s54, s54, 576
    buffer_load_dwordx4 v[48:51], v5, s[48:51], s54 offen offset:0
    buffer_load_dwordx4 v[52:55], v5, s[48:51], s54 offen offset:16
    buffer_load_dword v56, v5, s[48:51], s54 offen offset:32
    buffer_load_dwordx4 v[60:63], v5, s[48:51], s54 offen offset:2304
    buffer_load_dwordx4 v[64:67], v5, s[48:51], s54 offen offset:2320
    buffer_load_dword v68, v5, s[48:51], s54 offen offset:2336
    v_mul_u32_u24 v120, 147456, v4
    v_lshl_add_u32 v120, v3, 4, v120
    s_mul_i32 s61, s3, 589824
    s_lshl_b32 s54, s52, 8
    s_add_u32 s61, s61, s54
    s_add_u32 s61, s61, 2359296
    buffer_load_dwordx4 a[0:3], v120, s[40:43], s61 offen nt
    s_add_u32 s61, s61, 8192
    buffer_load_dwordx4 a[4:7], v120, s[40:43], s61 offen nt
    s_add_u32 s61, s61, 8192
    buffer_load_dwordx4 a[8:11], v120, s[40:43], s61 offen nt
    s_add_u32 s61, s61, 8192
    buffer_load_dwordx4 a[12:15], v120, s[40:43], s61 offen nt
    s_add_u32 s61, s61, 8192
    buffer_load_dwordx4 a[16:19], v120, s[40:43], s61 offen nt
    s_add_u32 s61, s61, 8192
    buffer_load_dwordx4 a[20:23], v120, s[40:43], s61 offen nt
    s_add_u32 s61, s61, 8192
    buffer_load_dwordx4 a[24:27], v120, s[40:43], s61 offen nt
    s_add_u32 s61, s61, 8192
    buffer_load_dwordx4 a[28:31], v120, s[40:43], s61 offen nt
    s_add_u32 s61, s61, 8192
    buffer_load_dwordx4 a[32:35], v120, s[40:43], s61 offen nt
    s_add_u32 s61, s61, 8192
    buffer_load_dwordx4 a[36:39], v120, s[40:43], s61 offen nt
    s_add_u32 s61, s61, 8192
    buffer_load_dwordx4 a[40:43], v120, s[40:43], s61 offen nt
    s_add_u32 s61, s61, 8192
    buffer_load_dwordx4 a[44:47], v120, s[40:43], s61 offen nt
    s_add_u32 s61, s61, 8192
    buffer_load_dwordx4 a[48:51], v120, s[40:43], s61 offen nt
    s_add_u32 s61, s61, 8192
    buffer_load_dwordx4 a[52:55], v120, s[40:43], s61 offen nt
    s_add_u32 s61, s61, 8192
    buffer_load_dwordx4 a[56:59], v120, s[40:43], s61 offen nt
    s_add_u32 s61, s61, 8192
    buffer_load_dwordx4 a[60:63], v120, s[40:43], s61 offen nt
    s_add_u32 s61, s61, 8192
    buffer_load_dwordx4 a[64:67], v120, s[40:43], s61 offen nt
    s_add_u32 s61, s61, 8192
    buffer_load_dwordx4 a[68:71], v120, s[40:43], s61 offen nt
    s_add_u32 s61, s61, 8192
    v_and_b32 v5, 1, v3
    v_cmp_eq_u32 vcc, 1, v5
    v_mov_b32 v5, 0x0c0c0100
    v_mov_b32 v6, 0x01000c0c
    v_cndmask_b32 v5, v5, v6, vcc
    v_mov_b32 v6, 0x0c0c0302
    v_mov_b32 v7, 0x03020c0c
    v_cndmask_b32 v6, v6, v7, vcc
    v_bfe_u32 v7, v3, 1, 2
    v_mov_b32 v16, 0x0c0c0c0c
    v_cmp_eq_u32 vcc, 0, v7
    s_nop 1
    v_cndmask_b32 v8, v16, v5, vcc
    v_cndmask_b32 v9, v16, v6, vcc
    v_cmp_eq_u32 vcc, 1, v7
    s_nop 1
    v_cndmask_b32 v10, v16, v5, vcc
    v_cndmask_b32 v11, v16, v6, vcc
    v_cmp_eq_u32 vcc, 2, v7
    s_nop 1
    v_cndmask_b32 v12, v16, v5, vcc
    v_cndmask_b32 v13, v16, v6, vcc
    v_cmp_eq_u32 vcc, 3, v7
    s_nop 1
    v_cndmask_b32 v14, v16, v5, vcc
    v_cndmask_b32 v15, v16, v6, vcc
    s_waitcnt vmcnt(24)
    s_barrier
    s_cmp_lg_u32 s3, 0
    s_cbranch_scc1 L_nosig_11
    s_lshl_b32 s54, s52, 2
    v_mov_b32 v5, s54
    v_mov_b32 v6, 1
    s_mov_b64 exec, 1
    global_atomic_add v5, v6, s[28:29]
    s_mov_b64 exec, -1
L_nosig_11:
    v_lshlrev_b32 v5, 2, v4
    v_xor_b32 v5, v5, v3
    v_lshlrev_b32 v6, 10, v4
    v_xor_b32 v7, 0, v5
    v_lshl_add_u32 v20, v7, 4, v6
    v_xor_b32 v7, 1, v5
    v_lshl_add_u32 v21, v7, 4, v6
    v_xor_b32 v7, 2, v5
    v_lshl_add_u32 v22, v7, 4, v6
    v_xor_b32 v7, 3, v5
    v_lshl_add_u32 v23, v7, 4, v6
    s_lshl_b32 s58, s53, 19
    s_lshl_b32 s54, s3, 8
    s_add_u32 s58, s58, s54
    s_add_u32 s60, s58, 524288
    s_lshl_b32 s63, s3, 15
    s_mov_b32 s59, s63
    s_add_u32 m0, s59, 0
    s_add_u32 s54, s58, 0
    buffer_load_dwordx4 v20, s[32:35], s54 offen nt lds
    s_add_u32 m0, s59, 1024
    s_add_u32 s54, s58, 4096
    buffer_load_dwordx4 v21, s[32:35], s54 offen nt lds
    s_add_u32 m0, s59, 2048
    s_add_u32 s54, s58, 8192
    buffer_load_dwordx4 v22, s[32:35], s54 offen nt lds
    s_add_u32 m0, s59, 3072
    s_add_u32 s54, s58, 12288
    buffer_load_dwordx4 v23, s[32:35], s54 offen nt lds
    s_add_u32 m0, s59, 4096
    s_add_u32 s54, s58, 16384
    buffer_load_dwordx4 v20, s[32:35], s54 offen nt lds
    s_add_u32 m0, s59, 5120
    s_add_u32 s54, s58, 20480
    buffer_load_dwordx4 v21, s[32:35], s54 offen nt lds
    s_add_u32 m0, s59, 6144
    s_add_u32 s54, s58, 24576
    buffer_load_dwordx4 v22, s[32:35], s54 offen nt lds
    s_add_u32 m0, s59, 7168
    s_add_u32 s54, s58, 28672
    buffer_load_dwordx4 v23, s[32:35], s54 offen nt lds
    s_add_u32 s58, s58, 32768
    s_add_u32 s59, s59, 8192
    s_and_b32 s59, s59, 0x7fff
    s_or_b32 s59, s59, s63
    s_cmp_lt_u32 s58, s60
    s_cselect_b32 s58, s58, 0x1000000
    s_waitcnt vmcnt(17)
    v_perm_b32 v96, v48, v48, v8
    v_perm_b32 v97, v48, v48, v10
    v_perm_b32 v98, v48, v48, v12
    v_perm_b32 v99, v48, v48, v14
    s_nop 1
    v_mfma_f32_16x16x32_bf16 v[112:115], v[96:99], a[0:3], 0
    v_perm_b32 v100, v60, v60, v8
    v_perm_b32 v101, v60, v60, v10
    v_perm_b32 v102, v60, v60, v12
    v_perm_b32 v103, v60, v60, v14
    s_nop 1
    v_mfma_f32_16x16x32_bf16 v[116:119], v[100:103], a[0:3], 0
    v_perm_b32 v104, v48, v48, v9
    v_perm_b32 v105, v48, v48, v11
    v_perm_b32 v106, v48, v48, v13
    v_perm_b32 v107, v48, v48, v15
    s_nop 1
    v_mfma_f32_16x16x32_bf16 v[112:115], v[104:107], a[4:7], v[112:115]
    v_perm_b32 v108, v60, v60, v9
    v_perm_b32 v109, v60, v60, v11
    v_perm_b32 v110, v60, v60, v13
    v_perm_b32 v111, v60, v60, v15
    s_nop 1
    v_mfma_f32_16x16x32_bf16 v[116:119], v[108:111], a[4:7], v[116:119]
    v_perm_b32 v96, v49, v49, v8
    v_perm_b32 v97, v49, v49, v10
    v_perm_b32 v98, v49, v49, v12
    v_perm_b32 v99, v49, v49, v14
    s_nop 1
    v_mfma_f32_16x16x32_bf16 v[112:115], v[96:99], a[8:11], v[112:115]
    v_perm_b32 v100, v61, v61, v8
    v_perm_b32 v101, v61, v61, v10
    v_perm_b32 v102, v61, v61, v12
    v_perm_b32 v103, v61, v61, v14
    s_nop 1
    v_mfma_f32_16x16x32_bf16 v[116:119], v[100:103], a[8:11], v[116:119]
    v_perm_b32 v104, v49, v49, v9
    v_perm_b32 v105, v49, v49, v11
    v_perm_b32 v106, v49, v49, v13
    v_perm_b32 v107, v49, v49, v15
    s_nop 1
    v_mfma_f32_16x16x32_bf16 v[112:115], v[104:107], a[12:15], v[112:115]
    v_perm_b32 v108, v61, v61, v9
    v_perm_b32 v109, v61, v61, v11
    v_perm_b32 v110, v61, v61, v13
    v_perm_b32 v111, v61, v61, v15
    s_nop 1
    v_mfma_f32_16x16x32_bf16 v[116:119], v[108:111], a[12:15], v[116:119]
    v_perm_b32 v96, v50, v50, v8
    v_perm_b32 v97, v50, v50, v10
    v_perm_b32 v98, v50, v50, v12
    v_perm_b32 v99, v50, v50, v14
    s_nop 1
    v_mfma_f32_16x16x32_bf16 v[112:115], v[96:99], a[16:19], v[112:115]
    v_perm_b32 v100, v62, v62, v8
    v_perm_b32 v101, v62, v62, v10
    v_perm_b32 v102, v62, v62, v12
    v_perm_b32 v103, v62, v62, v14
    s_nop 1
    v_mfma_f32_16x16x32_bf16 v[116:119], v[100:103], a[16:19], v[116:119]
    v_perm_b32 v104, v50, v50, v9
    v_perm_b32 v105, v50, v50, v11
    v_perm_b32 v106, v50, v50, v13
    v_perm_b32 v107, v50, v50, v15
    s_nop 1
    v_mfma_f32_16x16x32_bf16 v[112:115], v[104:107], a[20:23], v[112:115]
    v_perm_b32 v108, v62, v62, v9
    v_perm_b32 v109, v62, v62, v11
    v_perm_b32 v110, v62, v62, v13
    v_perm_b32 v111, v62, v62, v15
    s_nop 1
    v_mfma_f32_16x16x32_bf16 v[116:119], v[108:111], a[20:23], v[116:119]
    v_perm_b32 v96, v51, v51, v8
    v_perm_b32 v97, v51, v51, v10
    v_perm_b32 v98, v51, v51, v12
    v_perm_b32 v99, v51, v51, v14
    s_nop 1
    v_mfma_f32_16x16x32_bf16 v[112:115], v[96:99], a[24:27], v[112:115]
    v_perm_b32 v100, v63, v63, v8
    v_perm_b32 v101, v63, v63, v10
    v_perm_b32 v102, v63, v63, v12
    v_perm_b32 v103, v63, v63, v14
    s_nop 1
    v_mfma_f32_16x16x32_bf16 v[116:119], v[100:103], a[24:27], v[116:119]
    v_perm_b32 v104, v51, v51, v9
    v_perm_b32 v105, v51, v51, v11
    v_perm_b32 v106, v51, v51, v13
    v_perm_b32 v107, v51, v51, v15
    s_nop 1
    v_mfma_f32_16x16x32_bf16 v[112:115], v[104:107], a[28:31], v[112:115]
    v_perm_b32 v108, v63, v63, v9
    v_perm_b32 v109, v63, v63, v11
    v_perm_b32 v110, v63, v63, v13
    v_perm_b32 v111, v63, v63, v15
    s_nop 1
    v_mfma_f32_16x16x32_bf16 v[116:119], v[108:111], a[28:31], v[116:119]
    v_perm_b32 v96, v52, v52, v8
    v_perm_b32 v97, v52, v52, v10
    v_perm_b32 v98, v52, v52, v12
    v_perm_b32 v99, v52, v52, v14
    s_nop 1
    v_mfma_f32_16x16x32_bf16 v[112:115], v[96:99], a[32:35], v[112:115]
    v_perm_b32 v100, v64, v64, v8
    v_perm_b32 v101, v64, v64, v10
    v_perm_b32 v102, v64, v64, v12
    v_perm_b32 v103, v64, v64, v14
    s_nop 1
    v_mfma_f32_16x16x32_bf16 v[116:119], v[100:103], a[32:35], v[116:119]
    s_waitcnt vmcnt(8)
    v_perm_b32 v104, v52, v52, v9
    v_perm_b32 v105, v52, v52, v11
    v_perm_b32 v106, v52, v52, v13
    v_perm_b32 v107, v52, v52, v15
    s_nop 1
    v_mfma_f32_16x16x32_bf16 v[112:115], v[104:107], a[36:39], v[112:115]
    v_perm_b32 v108, v64, v64, v9
    v_perm_b32 v109, v64, v64, v11
    v_perm_b32 v110, v64, v64, v13
    v_perm_b32 v111, v64, v64, v15
    s_nop 1
    v_mfma_f32_16x16x32_bf16 v[116:119], v[108:111], a[36:39], v[116:119]
    v_perm_b32 v96, v53, v53, v8
    v_perm_b32 v97, v53, v53, v10
    v_perm_b32 v98, v53, v53, v12
    v_perm_b32 v99, v53, v53, v14
    s_nop 1
    v_mfma_f32_16x16x32_bf16 v[112:115], v[96:99], a[40:43], v[112:115]
    v_perm_b32 v100, v65, v65, v8
    v_perm_b32 v101, v65, v65, v10
    v_perm_b32 v102, v65, v65, v12
    v_perm_b32 v103, v65, v65, v14
    s_nop 1
    v_mfma_f32_16x16x32_bf16 v[116:119], v[100:103], a[40:43], v[116:119]
    v_perm_b32 v104, v53, v53, v9
    v_perm_b32 v105, v53, v53, v11
    v_perm_b32 v106, v53, v53, v13
    v_perm_b32 v107, v53, v53, v15
    s_nop 1
    v_mfma_f32_16x16x32_bf16 v[112:115], v[104:107], a[44:47], v[112:115]
    v_perm_b32 v108, v65, v65, v9
    v_perm_b32 v109, v65, v65, v11
    v_perm_b32 v110, v65, v65, v13
    v_perm_b32 v111, v65, v65, v15
    s_nop 1
    v_mfma_f32_16x16x32_bf16 v[116:119], v[108:111], a[44:47], v[116:119]
    v_perm_b32 v96, v54, v54, v8
    v_perm_b32 v97, v54, v54, v10
    v_perm_b32 v98, v54, v54, v12
    v_perm_b32 v99, v54, v54, v14
    s_nop 1
    v_mfma_f32_16x16x32_bf16 v[112:115], v[96:99], a[48:51], v[112:115]
    v_perm_b32 v100, v66, v66, v8
    v_perm_b32 v101, v66, v66, v10
    v_perm_b32 v102, v66, v66, v12
    v_perm_b32 v103, v66, v66, v14
    s_nop 1
    v_mfma_f32_16x16x32_bf16 v[116:119], v[100:103], a[48:51], v[116:119]
    v_perm_b32 v104, v54, v54, v9
    v_perm_b32 v105, v54, v54, v11
    v_perm_b32 v106, v54, v54, v13
    v_perm_b32 v107, v54, v54, v15
    s_nop 1
    v_mfma_f32_16x16x32_bf16 v[112:115], v[104:107], a[52:55], v[112:115]
    v_perm_b32 v108, v66, v66, v9
    v_perm_b32 v109, v66, v66, v11
    v_perm_b32 v110, v66, v66, v13
    v_perm_b32 v111, v66, v66, v15
    s_nop 1
    v_mfma_f32_16x16x32_bf16 v[116:119], v[108:111], a[52:55], v[116:119]
    v_perm_b32 v96, v55, v55, v8
    v_perm_b32 v97, v55, v55, v10
    v_perm_b32 v98, v55, v55, v12
    v_perm_b32 v99, v55, v55, v14
    s_nop 1
    v_mfma_f32_16x16x32_bf16 v[112:115], v[96:99], a[56:59], v[112:115]
    v_perm_b32 v100, v67, v67, v8
    v_perm_b32 v101, v67, v67, v10
    v_perm_b32 v102, v67, v67, v12
    v_perm_b32 v103, v67, v67, v14
    s_nop 1
    v_mfma_f32_16x16x32_bf16 v[116:119], v[100:103], a[56:59], v[116:119]
    v_perm_b32 v104, v55, v55, v9
    v_perm_b32 v105, v55, v55, v11
    v_perm_b32 v106, v55, v55, v13
    v_perm_b32 v107, v55, v55, v15
    s_nop 1
    v_mfma_f32_16x16x32_bf16 v[112:115], v[104:107], a[60:63], v[112:115]
    v_perm_b32 v108, v67, v67, v9
    v_perm_b32 v109, v67, v67, v11
    v_perm_b32 v110, v67, v67, v13
    v_perm_b32 v111, v67, v67, v15
    s_nop 1
    v_mfma_f32_16x16x32_bf16 v[116:119], v[108:111], a[60:63], v[116:119]
    v_perm_b32 v96, v56, v56, v8
    v_perm_b32 v97, v56, v56, v10
    v_perm_b32 v98, v56, v56, v12
    v_perm_b32 v99, v56, v56, v14
    s_nop 1
    v_mfma_f32_16x16x32_bf16 v[112:115], v[96:99], a[64:67], v[112:115]
    v_perm_b32 v100, v68, v68, v8
    v_perm_b32 v101, v68, v68, v10
    v_perm_b32 v102, v68, v68, v12
    v_perm_b32 v103, v68, v68, v14
    s_nop 1
    v_mfma_f32_16x16x32_bf16 v[116:119], v[100:103], a[64:67], v[116:119]
    v_perm_b32 v104, v56, v56, v9
    v_perm_b32 v105, v56, v56, v11
    v_perm_b32 v106, v56, v56, v13
    v_perm_b32 v107, v56, v56, v15
    s_nop 1
    v_mfma_f32_16x16x32_bf16 v[112:115], v[104:107], a[68:71], v[112:115]
    v_perm_b32 v108, v68, v68, v9
    v_perm_b32 v109, v68, v68, v11
    v_perm_b32 v110, v68, v68, v13
    v_perm_b32 v111, v68, v68, v15
    s_nop 1
    v_mfma_f32_16x16x32_bf16 v[116:119], v[108:111], a[68:71], v[116:119]
    v_lshrrev_b32 v5, 1, v4
    v_lshlrev_b32 v5, 9, v5
    v_lshl_add_u32 v5, v3, 5, v5
    v_and_b32 v6, 1, v4
    v_lshl_add_u32 v5, v6, 4, v5
    s_lshl_b32 s54, s3, 11
    s_add_u32 s54, s54, 139264
    v_add_u32 v5, s54, v5
    ds_write_b128 v5, v[112:115]
    ds_write_b128 v5, v[116:119] offset:1024
    s_waitcnt lgkmcnt(0)
    s_barrier
    s_lshl_b32 s54, s3, 9
    s_add_u32 s54, s54, 139264
    v_add_u32 v5, s54, v2
    ds_read_b128 v[96:99], v5 offset:0
    ds_read_b128 v[100:103], v5 offset:2048
    ds_read_b128 v[104:107], v5 offset:4096
    ds_read_b128 v[108:111], v5 offset:6144
    s_waitcnt lgkmcnt(0)
    v_add_f32 v96, v96, v100
    v_add_f32 v104, v104, v108
    v_add_f32 v97, v97, v101
    v_add_f32 v105, v105, v109
    v_add_f32 v98, v98, v102
    v_add_f32 v106, v106, v110
    v_add_f32 v99, v99, v103
    v_add_f32 v107, v107, v111
    v_add_f32 v96, v96, v104
    v_add_f32 v97, v97, v105
    v_add_f32 v98, v98, v106
    v_add_f32 v99, v99, v107
    v_min_u32 v124, -2, v96
    v_min_u32 v125, -2, v97
    v_min_u32 v126, -2, v98
    v_min_u32 v127, -2, v99
    buffer_store_dwordx4 v[124:127], v123, s[44:47], s98 offen sc1
    s_add_u32 m0, s59, 0
    s_add_u32 s54, s58, 0
    buffer_load_dwordx4 v20, s[32:35], s54 offen nt lds
    s_add_u32 m0, s59, 1024
    s_add_u32 s54, s58, 4096
    buffer_load_dwordx4 v21, s[32:35], s54 offen nt lds
    s_add_u32 m0, s59, 2048
    s_add_u32 s54, s58, 8192
    buffer_load_dwordx4 v22, s[32:35], s54 offen nt lds
    s_add_u32 m0, s59, 3072
    s_add_u32 s54, s58, 12288
    buffer_load_dwordx4 v23, s[32:35], s54 offen nt lds
    s_add_u32 m0, s59, 4096
    s_add_u32 s54, s58, 16384
    buffer_load_dwordx4 v20, s[32:35], s54 offen nt lds
    s_add_u32 m0, s59, 5120
    s_add_u32 s54, s58, 20480
    buffer_load_dwordx4 v21, s[32:35], s54 offen nt lds
    s_add_u32 m0, s59, 6144
    s_add_u32 s54, s58, 24576
    buffer_load_dwordx4 v22, s[32:35], s54 offen nt lds
    s_add_u32 m0, s59, 7168
    s_add_u32 s54, s58, 28672
    buffer_load_dwordx4 v23, s[32:35], s54 offen nt lds
    s_add_u32 s58, s58, 32768
    s_add_u32 s59, s59, 8192
    s_and_b32 s59, s59, 0x7fff
    s_or_b32 s59, s59, s63
    s_cmp_lt_u32 s58, s60
    s_cselect_b32 s58, s58, 0x1000000
    s_add_u32 m0, s59, 0
    s_add_u32 s54, s58, 0
    buffer_load_dwordx4 v20, s[32:35], s54 offen nt lds
    s_add_u32 m0, s59, 1024
    s_add_u32 s54, s58, 4096
    buffer_load_dwordx4 v21, s[32:35], s54 offen nt lds
    s_add_u32 m0, s59, 2048
    s_add_u32 s54, s58, 8192
    buffer_load_dwordx4 v22, s[32:35], s54 offen nt lds
    s_add_u32 m0, s59, 3072
    s_add_u32 s54, s58, 12288
    buffer_load_dwordx4 v23, s[32:35], s54 offen nt lds
    s_add_u32 m0, s59, 4096
    s_add_u32 s54, s58, 16384
    buffer_load_dwordx4 v20, s[32:35], s54 offen nt lds
    s_add_u32 m0, s59, 5120
    s_add_u32 s54, s58, 20480
    buffer_load_dwordx4 v21, s[32:35], s54 offen nt lds
    s_add_u32 m0, s59, 6144
    s_add_u32 s54, s58, 24576
    buffer_load_dwordx4 v22, s[32:35], s54 offen nt lds
    s_add_u32 m0, s59, 7168
    s_add_u32 s54, s58, 28672
    buffer_load_dwordx4 v23, s[32:35], s54 offen nt lds
    s_add_u32 s58, s58, 32768
    s_add_u32 s59, s59, 8192
    s_and_b32 s59, s59, 0x7fff
    s_or_b32 s59, s59, s63
    s_cmp_lt_u32 s58, s60
    s_cselect_b32 s58, s58, 0x1000000
    s_add_u32 m0, s59, 0
    s_add_u32 s54, s58, 0
    buffer_load_dwordx4 v20, s[32:35], s54 offen nt lds
    s_add_u32 m0, s59, 1024
    s_add_u32 s54, s58, 4096
    buffer_load_dwordx4 v21, s[32:35], s54 offen nt lds
    s_add_u32 m0, s59, 2048
    s_add_u32 s54, s58, 8192
    buffer_load_dwordx4 v22, s[32:35], s54 offen nt lds
    s_add_u32 m0, s59, 3072
    s_add_u32 s54, s58, 12288
    buffer_load_dwordx4 v23, s[32:35], s54 offen nt lds
    s_add_u32 m0, s59, 4096
    s_add_u32 s54, s58, 16384
    buffer_load_dwordx4 v20, s[32:35], s54 offen nt lds
    s_add_u32 m0, s59, 5120
    s_add_u32 s54, s58, 20480
    buffer_load_dwordx4 v21, s[32:35], s54 offen nt lds
    s_add_u32 m0, s59, 6144
    s_add_u32 s54, s58, 24576
    buffer_load_dwordx4 v22, s[32:35], s54 offen nt lds
    s_add_u32 m0, s59, 7168
    s_add_u32 s54, s58, 28672
    buffer_load_dwordx4 v23, s[32:35], s54 offen nt lds
    s_add_u32 s58, s58, 32768
    s_add_u32 s59, s59, 8192
    s_and_b32 s59, s59, 0x7fff
    s_or_b32 s59, s59, s63
    s_cmp_lt_u32 s58, s60
    s_cselect_b32 s58, s58, 0x1000000
    s_mov_b32 s36, s12
    s_mov_b32 s37, s13
    s_mov_b32 s38, 4718592
    s_mov_b32 s39, 0x20000
    v_mul_u32_u24 v81, 9216, v4
    v_lshl_add_u32 v80, v3, 4, v81
    v_lshl_add_u32 v81, v3, 2, v81
    s_mul_i32 s100, s52, 147456
    s_lshl_b32 s54, s3, 8
    s_add_u32 s99, s100, s54
    s_and_b32 s54, s3, 1
    s_lshl_b32 s54, s54, 6
    s_add_u32 s100, s100, s54
    s_add_u32 s100, s100, 1024
    s_waitcnt vmcnt(40)
    s_add_u32 s54, s99, 0
    s_add_u32 s55, s100, 0
    buffer_load_dwordx4 a[96:99], v80, s[36:39], s54 offen offset:0 nt
    buffer_load_dwordx4 a[100:103], v80, s[36:39], s54 offen offset:1152 nt
    buffer_load_dwordx4 a[104:107], v80, s[36:39], s54 offen offset:2304 nt
    buffer_load_dwordx4 a[108:111], v80, s[36:39], s54 offen offset:3456 nt
    buffer_load_dword a224, v81, s[36:39], s55 offen offset:0 nt
    buffer_load_dword a225, v81, s[36:39], s55 offen offset:1152 nt
    buffer_load_dword a226, v81, s[36:39], s55 offen offset:2304 nt
    buffer_load_dword a227, v81, s[36:39], s55 offen offset:3456 nt
    s_add_u32 s54, s99, 4608
    s_add_u32 s55, s100, 4608
    buffer_load_dwordx4 a[112:115], v80, s[36:39], s54 offen offset:0 nt
    buffer_load_dwordx4 a[116:119], v80, s[36:39], s54 offen offset:1152 nt
    buffer_load_dwordx4 a[120:123], v80, s[36:39], s54 offen offset:2304 nt
    buffer_load_dwordx4 a[124:127], v80, s[36:39], s54 offen offset:3456 nt
    buffer_load_dword a228, v81, s[36:39], s55 offen offset:0 nt
    buffer_load_dword a229, v81, s[36:39], s55 offen offset:1152 nt
    buffer_load_dword a230, v81, s[36:39], s55 offen offset:2304 nt
    buffer_load_dword a231, v81, s[36:39], s55 offen offset:3456 nt
    s_waitcnt vmcnt(40)
    s_add_u32 s54, s99, 36864
    s_add_u32 s55, s100, 36864
    buffer_load_dwordx4 a[128:131], v80, s[36:39], s54 offen offset:0 nt
    buffer_load_dwordx4 a[132:135], v80, s[36:39], s54 offen offset:1152 nt
    buffer_load_dwordx4 a[136:139], v80, s[36:39], s54 offen offset:2304 nt
    buffer_load_dwordx4 a[140:143], v80, s[36:39], s54 offen offset:3456 nt
    buffer_load_dword a232, v81, s[36:39], s55 offen offset:0 nt
    buffer_load_dword a233, v81, s[36:39], s55 offen offset:1152 nt
    buffer_load_dword a234, v81, s[36:39], s55 offen offset:2304 nt
    buffer_load_dword a235, v81, s[36:39], s55 offen offset:3456 nt
    s_add_u32 s54, s99, 41472
    s_add_u32 s55, s100, 41472
    buffer_load_dwordx4 a[144:147], v80, s[36:39], s54 offen offset:0 nt
    buffer_load_dwordx4 a[148:151], v80, s[36:39], s54 offen offset:1152 nt
    buffer_load_dwordx4 a[152:155], v80, s[36:39], s54 offen offset:2304 nt
    buffer_load_dwordx4 a[156:159], v80, s[36:39], s54 offen offset:3456 nt
    buffer_load_dword a236, v81, s[36:39], s55 offen offset:0 nt
    buffer_load_dword a237, v81, s[36:39], s55 offen offset:1152 nt
    buffer_load_dword a238, v81, s[36:39], s55 offen offset:2304 nt
    buffer_load_dword a239, v81, s[36:39], s55 offen offset:3456 nt
    s_waitcnt vmcnt(40)
    s_add_u32 s54, s99, 73728
    s_add_u32 s55, s100, 73728
    buffer_load_dwordx4 a[160:163], v80, s[36:39], s54 offen offset:0 nt
    buffer_load_dwordx4 a[164:167], v80, s[36:39], s54 offen offset:1152 nt
    buffer_load_dwordx4 a[168:171], v80, s[36:39], s54 offen offset:2304 nt
    buffer_load_dwordx4 a[172:175], v80, s[36:39], s54 offen offset:3456 nt
    buffer_load_dword a240, v81, s[36:39], s55 offen offset:0 nt
    buffer_load_dword a241, v81, s[36:39], s55 offen offset:1152 nt
    buffer_load_dword a242, v81, s[36:39], s55 offen offset:2304 nt
    buffer_load_dword a243, v81, s[36:39], s55 offen offset:3456 nt
    s_add_u32 s54, s99, 78336
    s_add_u32 s55, s100, 78336
    buffer_load_dwordx4 a[176:179], v80, s[36:39], s54 offen offset:0 nt
    buffer_load_dwordx4 a[180:183], v80, s[36:39], s54 offen offset:1152 nt
    buffer_load_dwordx4 a[184:187], v80, s[36:39], s54 offen offset:2304 nt
    buffer_load_dwordx4 a[188:191], v80, s[36:39], s54 offen offset:3456 nt
    buffer_load_dword a244, v81, s[36:39], s55 offen offset:0 nt
    buffer_load_dword a245, v81, s[36:39], s55 offen offset:1152 nt
    buffer_load_dword a246, v81, s[36:39], s55 offen offset:2304 nt
    buffer_load_dword a247, v81, s[36:39], s55 offen offset:3456 nt
    s_waitcnt vmcnt(40)
    s_add_u32 s54, s99, 110592
    s_add_u32 s55, s100, 110592
    buffer_load_dwordx4 a[192:195], v80, s[36:39], s54 offen offset:0 nt
    buffer_load_dwordx4 a[196:199], v80, s[36:39], s54 offen offset:1152 nt
    buffer_load_dwordx4 a[200:203], v80, s[36:39], s54 offen offset:2304 nt
    buffer_load_dwordx4 a[204:207], v80, s[36:39], s54 offen offset:3456 nt
    buffer_load_dword a248, v81, s[36:39], s55 offen offset:0 nt
    buffer_load_dword a249, v81, s[36:39], s55 offen offset:1152 nt
    buffer_load_dword a250, v81, s[36:39], s55 offen offset:2304 nt
    buffer_load_dword a251, v81, s[36:39], s55 offen offset:3456 nt
    s_add_u32 s54, s99, 115200
    s_add_u32 s55, s100, 115200
    buffer_load_dwordx4 a[208:211], v80, s[36:39], s54 offen offset:0 nt
    buffer_load_dwordx4 a[212:215], v80, s[36:39], s54 offen offset:1152 nt
    buffer_load_dwordx4 a[216:219], v80, s[36:39], s54 offen offset:2304 nt
    buffer_load_dwordx4 a[220:223], v80, s[36:39], s54 offen offset:3456 nt
    buffer_load_dword a252, v81, s[36:39], s55 offen offset:0 nt
    buffer_load_dword a253, v81, s[36:39], s55 offen offset:1152 nt
    buffer_load_dword a254, v81, s[36:39], s55 offen offset:2304 nt
    buffer_load_dword a255, v81, s[36:39], s55 offen offset:3456 nt
    v_and_b32 v24, 31, v1
    v_lshrrev_b32 v25, 5, v1
    v_lshlrev_b32 v19, 10, v24
    v_lshl_add_u32 v19, v25, 4, v19
    s_lshr_b32 s96, s53, 3
    s_lshl_b32 s96, s96, 15
    s_lshl_b32 s55, s3, 8
    s_add_u32 s96, s96, s55
    s_add_u32 s96, s96, 1048576
    v_and_b32 v5, 3, v24
    v_lshlrev_b32 v5, 2, v5
    v_bfe_u32 v6, v24, 2, 2
    v_or_b32 v5, v5, v6
    v_xor_b32 v5, v5, v25
    v_lshlrev_b32 v32, 8, v24
    v_lshl_add_u32 v32, v5, 4, v32
    v_add_u32 v32, s63, v32
    v_bfe_u32 v5, v1, 2, 2
    v_lshl_add_u32 v6, v25, 2, v5
    v_lshlrev_b32 v40, 8, v6
    v_and_b32 v6, 1, v1
    v_lshl_add_u32 v40, v6, 3, v40
    v_bfe_u32 v6, v1, 4, 1
    v_lshlrev_b32 v6, 1, v6
    v_bfe_u32 v7, v1, 1, 1
    v_or_b32 v6, v6, v7
    v_xor_b32 v6, v6, v25
    v_lshl_or_b32 v6, v5, 2, v6
    v_lshl_add_u32 v40, v6, 4, v40
    v_add_u32 v40, s63, v40
    v_xor_b32 v33, 32, v32
    v_xor_b32 v41, 32, v40
    v_xor_b32 v34, 64, v32
    v_xor_b32 v42, 64, v40
    v_xor_b32 v35, 96, v32
    v_xor_b32 v43, 96, v40
    v_xor_b32 v36, 128, v32
    v_xor_b32 v44, 128, v40
    v_xor_b32 v37, 160, v32
    v_xor_b32 v45, 160, v40
    v_xor_b32 v38, 192, v32
    v_xor_b32 v46, 192, v40
    v_xor_b32 v39, 224, v32
    v_xor_b32 v47, 224, v40
    s_lshl_b32 s54, s3, 12
    s_add_u32 s54, s54, 131072
    v_add_u32 v28, s54, v2
    v_xor_b32 v29, 4096, v28
    v_xor_b32 v30, 8192, v28
    v_xor_b32 v31, 12288, v28
    v_mov_b32 v64, 0
    v_mov_b32 v65, 0
    v_mov_b32 v66, 0
    v_mov_b32 v67, 0
    v_mov_b32 v68, 0
    v_mov_b32 v69, 0
    v_mov_b32 v70, 0
    v_mov_b32 v71, 0
    v_mov_b32 v72, 0
    v_mov_b32 v73, 0
    v_mov_b32 v74, 0
    v_mov_b32 v75, 0
    v_mov_b32 v76, 0
    v_mov_b32 v77, 0
    v_mov_b32 v78, 0
    v_mov_b32 v79, 0
    v_mov_b32 v80, 0
    v_mov_b32 v81, 0
    v_mov_b32 v82, 0
    v_mov_b32 v83, 0
    v_mov_b32 v84, 0
    v_mov_b32 v85, 0
    v_mov_b32 v86, 0
    v_mov_b32 v87, 0
    v_mov_b32 v88, 0
    v_mov_b32 v89, 0
    v_mov_b32 v90, 0
    v_mov_b32 v91, 0
    v_mov_b32 v92, 0
    v_mov_b32 v93, 0
    v_mov_b32 v94, 0
    v_mov_b32 v95, 0
    v_mov_b32 v96, 0
    v_mov_b32 v97, 0
    v_mov_b32 v98, 0
    v_mov_b32 v99, 0
    v_mov_b32 v100, 0
    v_mov_b32 v101, 0
    v_mov_b32 v102, 0
    v_mov_b32 v103, 0
    v_mov_b32 v104, 0
    v_mov_b32 v105, 0
    v_mov_b32 v106, 0
    v_mov_b32 v107, 0
    v_mov_b32 v108, 0
    v_mov_b32 v109, 0
    v_mov_b32 v110, 0
    v_mov_b32 v111, 0
    v_mov_b32 v112, 0
    v_mov_b32 v113, 0
    v_mov_b32 v114, 0
    v_mov_b32 v115, 0
    v_mov_b32 v116, 0
    v_mov_b32 v117, 0
    v_mov_b32 v118, 0
    v_mov_b32 v119, 0
    v_mov_b32 v120, 0
    v_mov_b32 v121, 0
    v_mov_b32 v122, 0
    v_mov_b32 v123, 0
    v_mov_b32 v124, 0
    v_mov_b32 v125, 0
    v_mov_b32 v126, 0
    v_mov_b32 v127, 0
    v_mov_b32 v216, 0xff800000
    v_mov_b32 v217, 0
    s_mov_b32 s62, 4
    s_waitcnt vmcnt(0)
    s_cmp_lg_u32 s3, 0
    s_cbranch_scc1 L_polled_13
    v_mov_b32 v5, 128
L_poll_12:
    global_load_dword v6, v5, s[28:29] sc1
    s_waitcnt vmcnt(0)
    v_cmp_le_u32 vcc, 32, v6
    s_cbranch_vccnz L_polled_13
    s_sleep 2
    s_sub_u32 s101, s101, 1
    s_cbranch_scc0 L_poll_12
    s_mov_b32 s101, 0
L_polled_13:
    s_barrier
    buffer_load_dwordx4 a[0:3], v19, s[44:47], s96 offen offset:0 sc1
    buffer_load_dwordx4 a[4:7], v19, s[44:47], s96 offen offset:32 sc1
    buffer_load_dwordx4 a[8:11], v19, s[44:47], s96 offen offset:64 sc1
    buffer_load_dwordx4 a[12:15], v19, s[44:47], s96 offen offset:96 sc1
    buffer_load_dwordx4 a[16:19], v19, s[44:47], s96 offen offset:128 sc1
    buffer_load_dwordx4 a[20:23], v19, s[44:47], s96 offen offset:160 sc1
    buffer_load_dwordx4 a[24:27], v19, s[44:47], s96 offen offset:192 sc1
    buffer_load_dwordx4 a[28:31], v19, s[44:47], s96 offen offset:224 sc1
    ds_read_b128 a[32:35], v32 offset:0
    ds_read_b128 a[36:39], v33 offset:0
    ds_read_b128 a[40:43], v34 offset:0
    ds_read_b128 a[44:47], v35 offset:0
    ds_read_b128 a[48:51], v36 offset:0
    ds_read_b128 a[52:55], v37 offset:0
    ds_read_b128 a[56:59], v38 offset:0
    ds_read_b128 a[60:63], v39 offset:0
    s_waitcnt vmcnt(0) lgkmcnt(0)
    v_mfma_f32_32x32x16_bf16 v[128:143], a[32:35], a[0:3], 0
    v_mfma_f32_32x32x16_bf16 v[128:143], a[36:39], a[4:7], v[128:143]
    v_mfma_f32_32x32x16_bf16 v[128:143], a[40:43], a[8:11], v[128:143]
    v_mfma_f32_32x32x16_bf16 v[128:143], a[44:47], a[12:15], v[128:143]
    v_mfma_f32_32x32x16_bf16 v[128:143], a[48:51], a[16:19], v[128:143]
    v_mfma_f32_32x32x16_bf16 v[128:143], a[52:55], a[20:23], v[128:143]
    v_mfma_f32_32x32x16_bf16 v[128:143], a[56:59], a[24:27], v[128:143]
    v_mfma_f32_32x32x16_bf16 v[128:143], a[60:63], a[28:31], v[128:143]
    s_nop 11
    ds_write_b128 v28, v[128:131] offset:0
    ds_write_b128 v28, v[132:135] offset:1024
    ds_write_b128 v28, v[136:139] offset:2048
    ds_write_b128 v28, v[140:143] offset:3072
    s_waitcnt lgkmcnt(0)
    s_barrier
    ds_read_b128 v[144:147], v29 offset:0
    ds_read_b128 v[148:151], v29 offset:1024
    ds_read_b128 v[152:155], v29 offset:2048
    ds_read_b128 v[156:159], v29 offset:3072
    ds_read_b128 v[160:163], v30 offset:0
    ds_read_b128 v[164:167], v30 offset:1024
    ds_read_b128 v[168:171], v30 offset:2048
    ds_read_b128 v[172:175], v30 offset:3072
    ds_read_b128 v[176:179], v31 offset:0
    ds_read_b128 v[180:183], v31 offset:1024
    ds_read_b128 v[184:187], v31 offset:2048
    ds_read_b128 v[188:191], v31 offset:3072
L_bloop:
    s_waitcnt vmcnt(16)
    ds_read_b128 a[32:35], v32 offset:8192
    ds_read_b128 a[36:39], v33 offset:8192
    ds_read_b128 a[40:43], v34 offset:8192
    ds_read_b128 a[44:47], v35 offset:8192
    ds_read_b128 a[48:51], v36 offset:8192
    ds_read_b128 a[52:55], v37 offset:8192
    ds_read_b128 a[56:59], v38 offset:8192
    ds_read_b128 a[60:63], v39 offset:8192
    s_waitcnt lgkmcnt(8)
    v_add_f32 v144, v144, v128
    v_add_f32 v145, v145, v129
    v_add_f32 v146, v146, v130
    v_add_f32 v147, v147, v131
    v_add_f32 v148, v148, v132
    v_add_f32 v149, v149, v133
    v_add_f32 v150, v150, v134
    v_add_f32 v151, v151, v135
    v_add_f32 v152, v152, v136
    v_add_f32 v153, v153, v137
    v_add_f32 v154, v154, v138
    v_add_f32 v155, v155, v139
    v_add_f32 v156, v156, v140
    v_add_f32 v157, v157, v141
    v_add_f32 v158, v158, v142
    v_add_f32 v159, v159, v143
    s_waitcnt lgkmcnt(0)
    v_mfma_f32_32x32x16_bf16 v[128:143], a[32:35], a[0:3], 0
    ds_read_b64_tr_b16 a[64:65], v40 offset:0
    ds_read_b64_tr_b16 a[66:67], v41 offset:2048
    v_add_f32 v160, v160, v176
    v_add_f32 v161, v161, v177
    v_add_f32 v162, v162, v178
    v_add_f32 v163, v163, v179
    v_add_f32 v164, v164, v180
    v_mfma_f32_32x32x16_bf16 v[128:143], a[36:39], a[4:7], v[128:143]
    ds_read_b64_tr_b16 a[72:73], v42 offset:0
    ds_read_b64_tr_b16 a[74:75], v43 offset:2048
    v_add_f32 v165, v165, v181
    v_add_f32 v166, v166, v182
    v_add_f32 v167, v167, v183
    v_add_f32 v168, v168, v184
    v_add_f32 v169, v169, v185
    v_mfma_f32_32x32x16_bf16 v[128:143], a[40:43], a[8:11], v[128:143]
    ds_read_b64_tr_b16 a[80:81], v44 offset:0
    ds_read_b64_tr_b16 a[82:83], v45 offset:2048
    v_add_f32 v170, v170, v186
    v_add_f32 v171, v171, v187
    v_add_f32 v172, v172, v188
    v_add_f32 v173, v173, v189
    v_add_f32 v174, v174, v190
    v_mfma_f32_32x32x16_bf16 v[128:143], a[44:47], a[12:15], v[128:143]
    ds_read_b64_tr_b16 a[88:89], v46 offset:0
    ds_read_b64_tr_b16 a[90:91], v47 offset:2048
    v_add_f32 v175, v175, v191
    v_add_f32 v144, v144, v160
    v_add_f32 v145, v145, v161
    v_add_f32 v146, v146, v162
    v_add_f32 v147, v147, v163
    v_mfma_f32_32x32x16_bf16 v[128:143], a[48:51], a[16:19], v[128:143]
    ds_read_b64_tr_b16 a[68:69], v40 offset:4096
    ds_read_b64_tr_b16 a[70:71], v41 offset:6144
    v_add_f32 v148, v148, v164
    v_add_f32 v149, v149, v165
    v_add_f32 v150, v150, v166
    v_add_f32 v151, v151, v167
    v_add_f32 v152, v152, v168
    v_mfma_f32_32x32x16_bf16 v[128:143], a[52:55], a[20:23], v[128:143]
    ds_read_b64_tr_b16 a[76:77], v42 offset:4096
    ds_read_b64_tr_b16 a[78:79], v43 offset:6144
    v_add_f32 v153, v153, v169
    v_add_f32 v154, v154, v170
    v_add_f32 v155, v155, v171
    v_add_f32 v156, v156, v172
    v_add_f32 v157, v157, v173
    v_mfma_f32_32x32x16_bf16 v[128:143], a[56:59], a[24:27], v[128:143]
    ds_read_b64_tr_b16 a[84:85], v44 offset:4096
    ds_read_b64_tr_b16 a[86:87], v45 offset:6144
    v_add_f32 v158, v158, v174
    v_add_f32 v159, v159, v175
    v_max3_f32 v218, v144, v145, v146
    v_max3_f32 v219, v147, v148, v149
    v_max3_f32 v220, v150, v151, v152
    v_mfma_f32_32x32x16_bf16 v[128:143], a[60:63], a[28:31], v[128:143]
    ds_read_b64_tr_b16 a[92:93], v46 offset:4096
    ds_read_b64_tr_b16 a[94:95], v47 offset:6144
    v_max3_f32 v221, v153, v154, v155
    v_max3_f32 v218, v218, v156, v157
    v_max3_f32 v219, v219, v158, v159
    v_max3_f32 v218, v218, v219, v220
    v_max_f32 v218, v218, v221
    v_mov_b32 v219, v218
    s_nop 1
    v_permlane32_swap_b32 v218, v219
    v_max3_f32 v218, v218, v219, v216
    v_sub_f32 v220, v216, v218
    v_mov_b32 v216, v218
    v_exp_f32 v220, v220
    v_sub_f32 v192, v144, v218
    v_sub_f32 v193, v145, v218
    v_sub_f32 v194, v146, v218
    v_sub_f32 v195, v147, v218
    v_sub_f32 v196, v148, v218
    v_sub_f32 v197, v149, v218
    v_sub_f32 v198, v150, v218
    v_sub_f32 v199, v151, v218
    v_sub_f32 v200, v152, v218
    v_sub_f32 v201, v153, v218
    v_sub_f32 v202, v154, v218
    v_sub_f32 v203, v155, v218
    v_sub_f32 v204, v156, v218
    v_sub_f32 v205, v157, v218
    v_sub_f32 v206, v158, v218
    v_sub_f32 v207, v159, v218
    ds_write_b128 v28, v[128:131] offset:16384
    v_exp_f32 v192, v192
    v_exp_f32 v193, v193
    v_exp_f32 v194, v194
    v_exp_f32 v195, v195
    ds_write_b128 v28, v[132:135] offset:17408
    v_exp_f32 v196, v196
    v_exp_f32 v197, v197
    v_exp_f32 v198, v198
    v_exp_f32 v199, v199
    ds_write_b128 v28, v[136:139] offset:18432
    v_exp_f32 v200, v200
    v_exp_f32 v201, v201
    v_exp_f32 v202, v202
    v_exp_f32 v203, v203
    ds_write_b128 v28, v[140:143] offset:19456
    v_exp_f32 v204, v204
    v_exp_f32 v205, v205
    v_exp_f32 v206, v206
    v_exp_f32 v207, v207
    v_mul_f32 v217, v217, v220
    v_cvt_pk_bf16_f32 v208, v192, v193
    v_cvt_pk_bf16_f32 v209, v194, v195
    v_cvt_pk_bf16_f32 v210, v196, v197
    v_cvt_pk_bf16_f32 v211, v198, v199
    v_cvt_pk_bf16_f32 v212, v200, v201
    v_cvt_pk_bf16_f32 v213, v202, v203
    v_cvt_pk_bf16_f32 v214, v204, v205
    v_cvt_pk_bf16_f32 v215, v206, v207
    v_mul_f32 v64, v64, v220
    v_mul_f32 v65, v65, v220
    v_mul_f32 v66, v66, v220
    v_mul_f32 v67, v67, v220
    v_mul_f32 v68, v68, v220
    v_mul_f32 v69, v69, v220
    v_mul_f32 v70, v70, v220
    v_mul_f32 v71, v71, v220
    v_mul_f32 v72, v72, v220
    v_mul_f32 v73, v73, v220
    v_mul_f32 v74, v74, v220
    v_mul_f32 v75, v75, v220
    v_mul_f32 v76, v76, v220
    v_mul_f32 v77, v77, v220
    v_mul_f32 v78, v78, v220
    v_mul_f32 v79, v79, v220
    s_waitcnt lgkmcnt(0)
    s_barrier
    v_mfma_f32_32x32x16_bf16 v[64:79], a[64:67], v[208:211], v[64:79]
    ds_read_b128 v[144:147], v29 offset:16384
    v_mul_f32 v80, v80, v220
    v_mul_f32 v81, v81, v220
    ds_read_b128 v[148:151], v29 offset:17408
    s_add_u32 m0, s63, 0
    s_add_u32 s54, s58, 0
    buffer_load_dwordx4 v20, s[32:35], s54 offen nt lds
    v_mul_f32 v82, v82, v220
    v_mul_f32 v83, v83, v220
    ds_read_b128 v[152:155], v29 offset:18432
    v_mul_f32 v84, v84, v220
    v_mfma_f32_32x32x16_bf16 v[64:79], a[68:71], v[212:215], v[64:79]
    v_mul_f32 v85, v85, v220
    ds_read_b128 v[156:159], v29 offset:19456
    v_mul_f32 v86, v86, v220
    s_add_u32 m0, s63, 1024
    s_add_u32 s54, s58, 4096
    buffer_load_dwordx4 v21, s[32:35], s54 offen nt lds
    v_mul_f32 v87, v87, v220
    v_mul_f32 v88, v88, v220
    v_mul_f32 v89, v89, v220
    v_mul_f32 v90, v90, v220
    v_mul_f32 v91, v91, v220
    v_mul_f32 v92, v92, v220
    v_mul_f32 v93, v93, v220
    v_mul_f32 v94, v94, v220
    v_mul_f32 v95, v95, v220
    s_nop 1
    v_mfma_f32_32x32x16_bf16 v[80:95], a[72:75], v[208:211], v[80:95]
    ds_read_b128 v[160:163], v30 offset:16384
    v_mul_f32 v96, v96, v220
    v_mul_f32 v97, v97, v220
    ds_read_b128 v[164:167], v30 offset:17408
    s_add_u32 m0, s63, 2048
    s_add_u32 s54, s58, 8192
    buffer_load_dwordx4 v22, s[32:35], s54 offen nt lds
    v_mul_f32 v98, v98, v220
    v_mul_f32 v99, v99, v220
    ds_read_b128 v[168:171], v30 offset:18432
    v_mul_f32 v100, v100, v220
    v_mfma_f32_32x32x16_bf16 v[80:95], a[76:79], v[212:215], v[80:95]
    v_mul_f32 v101, v101, v220
    ds_read_b128 v[172:175], v30 offset:19456
    v_mul_f32 v102, v102, v220
    s_add_u32 m0, s63, 3072
    s_add_u32 s54, s58, 12288
    buffer_load_dwordx4 v23, s[32:35], s54 offen nt lds
    v_mul_f32 v103, v103, v220
    v_mul_f32 v104, v104, v220
    v_mul_f32 v105, v105, v220
    v_mul_f32 v106, v106, v220
    v_mul_f32 v107, v107, v220
    v_mul_f32 v108, v108, v220
    v_mul_f32 v109, v109, v220
    v_mul_f32 v110, v110, v220
    v_mul_f32 v111, v111, v220
    s_nop 1
    v_mfma_f32_32x32x16_bf16 v[96:111], a[80:83], v[208:211], v[96:111]
    ds_read_b128 v[176:179], v31 offset:16384
    v_mul_f32 v112, v112, v220
    v_mul_f32 v113, v113, v220
    ds_read_b128 v[180:183], v31 offset:17408
    s_add_u32 m0, s63, 4096
    s_add_u32 s54, s58, 16384
    buffer_load_dwordx4 v20, s[32:35], s54 offen nt lds
    v_mul_f32 v114, v114, v220
    v_mul_f32 v115, v115, v220
    ds_read_b128 v[184:187], v31 offset:18432
    v_mul_f32 v116, v116, v220
    v_mfma_f32_32x32x16_bf16 v[96:111], a[84:87], v[212:215], v[96:111]
    v_mul_f32 v117, v117, v220
    ds_read_b128 v[188:191], v31 offset:19456
    v_mul_f32 v118, v118, v220
    s_add_u32 m0, s63, 5120
    s_add_u32 s54, s58, 20480
    buffer_load_dwordx4 v21, s[32:35], s54 offen nt lds
    v_mul_f32 v119, v119, v220
    v_mul_f32 v120, v120, v220
    v_mul_f32 v121, v121, v220
    v_mul_f32 v122, v122, v220
    v_mul_f32 v123, v123, v220
    v_mul_f32 v124, v124, v220
    v_mul_f32 v125, v125, v220
    v_mul_f32 v126, v126, v220
    v_mul_f32 v127, v127, v220
    s_nop 1
    v_mfma_f32_32x32x16_bf16 v[112:127], a[88:91], v[208:211], v[112:127]
    v_add_f32 v192, v192, v200
    v_add_f32 v193, v193, v201
    v_add_f32 v194, v194, v202
    v_add_f32 v195, v195, v203
    s_add_u32 m0, s63, 6144
    s_add_u32 s54, s58, 24576
    buffer_load_dwordx4 v22, s[32:35], s54 offen nt lds
    v_add_f32 v196, v196, v204
    v_add_f32 v197, v197, v205
    v_add_f32 v198, v198, v206
    v_add_f32 v199, v199, v207
    v_mfma_f32_32x32x16_bf16 v[112:127], a[92:95], v[212:215], v[112:127]
    v_add_f32 v192, v192, v196
    v_add_f32 v193, v193, v197
    v_add_f32 v194, v194, v198
    s_add_u32 m0, s63, 7168
    s_add_u32 s54, s58, 28672
    buffer_load_dwordx4 v23, s[32:35], s54 offen nt lds
    v_add_f32 v195, v195, v199
    v_add_f32 v192, v192, v193
    v_add_f32 v194, v194, v195
    v_add_f32 v192, v192, v194
    v_add_f32 v217, v217, v192
    s_add_u32 s58, s58, 32768
    s_cmp_lt_u32 s58, s60
    s_cselect_b32 s58, s58, 0x1000000
    s_waitcnt vmcnt(16)
    ds_read_b128 a[32:35], v32 offset:16384
    ds_read_b128 a[36:39], v33 offset:16384
    ds_read_b128 a[40:43], v34 offset:16384
    ds_read_b128 a[44:47], v35 offset:16384
    ds_read_b128 a[48:51], v36 offset:16384
    ds_read_b128 a[52:55], v37 offset:16384
    ds_read_b128 a[56:59], v38 offset:16384
    ds_read_b128 a[60:63], v39 offset:16384
    s_waitcnt lgkmcnt(8)
    v_add_f32 v144, v144, v128
    v_add_f32 v145, v145, v129
    v_add_f32 v146, v146, v130
    v_add_f32 v147, v147, v131
    v_add_f32 v148, v148, v132
    v_add_f32 v149, v149, v133
    v_add_f32 v150, v150, v134
    v_add_f32 v151, v151, v135
    v_add_f32 v152, v152, v136
    v_add_f32 v153, v153, v137
    v_add_f32 v154, v154, v138
    v_add_f32 v155, v155, v139
    v_add_f32 v156, v156, v140
    v_add_f32 v157, v157, v141
    v_add_f32 v158, v158, v142
    v_add_f32 v159, v159, v143
    s_waitcnt lgkmcnt(0)
    v_mfma_f32_32x32x16_bf16 v[128:143], a[32:35], a[0:3], 0
    ds_read_b64_tr_b16 a[64:65], v40 offset:8192
    ds_read_b64_tr_b16 a[66:67], v41 offset:10240
    v_add_f32 v160, v160, v176
    v_add_f32 v161, v161, v177
    v_add_f32 v162, v162, v178
    v_add_f32 v163, v163, v179
    v_add_f32 v164, v164, v180
    v_mfma_f32_32x32x16_bf16 v[128:143], a[36:39], a[4:7], v[128:143]
    ds_read_b64_tr_b16 a[72:73], v42 offset:8192
    ds_read_b64_tr_b16 a[74:75], v43 offset:10240
    v_add_f32 v165, v165, v181
    v_add_f32 v166, v166, v182
    v_add_f32 v167, v167, v183
    v_add_f32 v168, v168, v184
    v_add_f32 v169, v169, v185
    v_mfma_f32_32x32x16_bf16 v[128:143], a[40:43], a[8:11], v[128:143]
    ds_read_b64_tr_b16 a[80:81], v44 offset:8192
    ds_read_b64_tr_b16 a[82:83], v45 offset:10240
    v_add_f32 v170, v170, v186
    v_add_f32 v171, v171, v187
    v_add_f32 v172, v172, v188
    v_add_f32 v173, v173, v189
    v_add_f32 v174, v174, v190
    v_mfma_f32_32x32x16_bf16 v[128:143], a[44:47], a[12:15], v[128:143]
    ds_read_b64_tr_b16 a[88:89], v46 offset:8192
    ds_read_b64_tr_b16 a[90:91], v47 offset:10240
    v_add_f32 v175, v175, v191
    v_add_f32 v144, v144, v160
    v_add_f32 v145, v145, v161
    v_add_f32 v146, v146, v162
    v_add_f32 v147, v147, v163
    v_mfma_f32_32x32x16_bf16 v[128:143], a[48:51], a[16:19], v[128:143]
    ds_read_b64_tr_b16 a[68:69], v40 offset:12288
    ds_read_b64_tr_b16 a[70:71], v41 offset:14336
    v_add_f32 v148, v148, v164
    v_add_f32 v149, v149, v165
    v_add_f32 v150, v150, v166
    v_add_f32 v151, v151, v167
    v_add_f32 v152, v152, v168
    v_mfma_f32_32x32x16_bf16 v[128:143], a[52:55], a[20:23], v[128:143]
    ds_read_b64_tr_b16 a[76:77], v42 offset:12288
    ds_read_b64_tr_b16 a[78:79], v43 offset:14336
    v_add_f32 v153, v153, v169
    v_add_f32 v154, v154, v170
    v_add_f32 v155, v155, v171
    v_add_f32 v156, v156, v172
    v_add_f32 v157, v157, v173
    v_mfma_f32_32x32x16_bf16 v[128:143], a[56:59], a[24:27], v[128:143]
    ds_read_b64_tr_b16 a[84:85], v44 offset:12288
    ds_read_b64_tr_b16 a[86:87], v45 offset:14336
    v_add_f32 v158, v158, v174
    v_add_f32 v159, v159, v175
    v_max3_f32 v218, v144, v145, v146
    v_max3_f32 v219, v147, v148, v149
    v_max3_f32 v220, v150, v151, v152
    v_mfma_f32_32x32x16_bf16 v[128:143], a[60:63], a[28:31], v[128:143]
    ds_read_b64_tr_b16 a[92:93], v46 offset:12288
    ds_read_b64_tr_b16 a[94:95], v47 offset:14336
    v_max3_f32 v221, v153, v154, v155
    v_max3_f32 v218, v218, v156, v157
    v_max3_f32 v219, v219, v158, v159
    v_max3_f32 v218, v218, v219, v220
    v_max_f32 v218, v218, v221
    v_mov_b32 v219, v218
    s_nop 1
    v_permlane32_swap_b32 v218, v219
    v_max3_f32 v218, v218, v219, v216
    v_sub_f32 v220, v216, v218
    v_mov_b32 v216, v218
    v_exp_f32 v220, v220
    v_sub_f32 v192, v144, v218
    v_sub_f32 v193, v145, v218
    v_sub_f32 v194, v146, v218
    v_sub_f32 v195, v147, v218
    v_sub_f32 v196, v148, v218
    v_sub_f32 v197, v149, v218
    v_sub_f32 v198, v150, v218
    v_sub_f32 v199, v151, v218
    v_sub_f32 v200, v152, v218
    v_sub_f32 v201, v153, v218
    v_sub_f32 v202, v154, v218
    v_sub_f32 v203, v155, v218
    v_sub_f32 v204, v156, v218
    v_sub_f32 v205, v157, v218
    v_sub_f32 v206, v158, v218
    v_sub_f32 v207, v159, v218
    ds_write_b128 v28, v[128:131] offset:0
    v_exp_f32 v192, v192
    v_exp_f32 v193, v193
    v_exp_f32 v194, v194
    v_exp_f32 v195, v195
    ds_write_b128 v28, v[132:135] offset:1024
    v_exp_f32 v196, v196
    v_exp_f32 v197, v197
    v_exp_f32 v198, v198
    v_exp_f32 v199, v199
    ds_write_b128 v28, v[136:139] offset:2048
    v_exp_f32 v200, v200
    v_exp_f32 v201, v201
    v_exp_f32 v202, v202
    v_exp_f32 v203, v203
    ds_write_b128 v28, v[140:143] offset:3072
    v_exp_f32 v204, v204
    v_exp_f32 v205, v205
    v_exp_f32 v206, v206
    v_exp_f32 v207, v207
    v_mul_f32 v217, v217, v220
    v_cvt_pk_bf16_f32 v208, v192, v193
    v_cvt_pk_bf16_f32 v209, v194, v195
    v_cvt_pk_bf16_f32 v210, v196, v197
    v_cvt_pk_bf16_f32 v211, v198, v199
    v_cvt_pk_bf16_f32 v212, v200, v201
    v_cvt_pk_bf16_f32 v213, v202, v203
    v_cvt_pk_bf16_f32 v214, v204, v205
    v_cvt_pk_bf16_f32 v215, v206, v207
    v_mul_f32 v64, v64, v220
    v_mul_f32 v65, v65, v220
    v_mul_f32 v66, v66, v220
    v_mul_f32 v67, v67, v220
    v_mul_f32 v68, v68, v220
    v_mul_f32 v69, v69, v220
    v_mul_f32 v70, v70, v220
    v_mul_f32 v71, v71, v220
    v_mul_f32 v72, v72, v220
    v_mul_f32 v73, v73, v220
    v_mul_f32 v74, v74, v220
    v_mul_f32 v75, v75, v220
    v_mul_f32 v76, v76, v220
    v_mul_f32 v77, v77, v220
    v_mul_f32 v78, v78, v220
    v_mul_f32 v79, v79, v220
    s_waitcnt lgkmcnt(0)
    s_barrier
    v_mfma_f32_32x32x16_bf16 v[64:79], a[64:67], v[208:211], v[64:79]
    ds_read_b128 v[144:147], v29 offset:0
    v_mul_f32 v80, v80, v220
    v_mul_f32 v81, v81, v220
    ds_read_b128 v[148:151], v29 offset:1024
    s_add_u32 m0, s63, 8192
    s_add_u32 s54, s58, 0
    buffer_load_dwordx4 v20, s[32:35], s54 offen nt lds
    v_mul_f32 v82, v82, v220
    v_mul_f32 v83, v83, v220
    ds_read_b128 v[152:155], v29 offset:2048
    v_mul_f32 v84, v84, v220
    v_mfma_f32_32x32x16_bf16 v[64:79], a[68:71], v[212:215], v[64:79]
    v_mul_f32 v85, v85, v220
    ds_read_b128 v[156:159], v29 offset:3072
    v_mul_f32 v86, v86, v220
    s_add_u32 m0, s63, 9216
    s_add_u32 s54, s58, 4096
    buffer_load_dwordx4 v21, s[32:35], s54 offen nt lds
    v_mul_f32 v87, v87, v220
    v_mul_f32 v88, v88, v220
    v_mul_f32 v89, v89, v220
    v_mul_f32 v90, v90, v220
    v_mul_f32 v91, v91, v220
    v_mul_f32 v92, v92, v220
    v_mul_f32 v93, v93, v220
    v_mul_f32 v94, v94, v220
    v_mul_f32 v95, v95, v220
    s_nop 1
    v_mfma_f32_32x32x16_bf16 v[80:95], a[72:75], v[208:211], v[80:95]
    ds_read_b128 v[160:163], v30 offset:0
    v_mul_f32 v96, v96, v220
    v_mul_f32 v97, v97, v220
    ds_read_b128 v[164:167], v30 offset:1024
    s_add_u32 m0, s63, 10240
    s_add_u32 s54, s58, 8192
    buffer_load_dwordx4 v22, s[32:35], s54 offen nt lds
    v_mul_f32 v98, v98, v220
    v_mul_f32 v99, v99, v220
    ds_read_b128 v[168:171], v30 offset:2048
    v_mul_f32 v100, v100, v220
    v_mfma_f32_32x32x16_bf16 v[80:95], a[76:79], v[212:215], v[80:95]
    v_mul_f32 v101, v101, v220
    ds_read_b128 v[172:175], v30 offset:3072
    v_mul_f32 v102, v102, v220
    s_add_u32 m0, s63, 11264
    s_add_u32 s54, s58, 12288
    buffer_load_dwordx4 v23, s[32:35], s54 offen nt lds
    v_mul_f32 v103, v103, v220
    v_mul_f32 v104, v104, v220
    v_mul_f32 v105, v105, v220
    v_mul_f32 v106, v106, v220
    v_mul_f32 v107, v107, v220
    v_mul_f32 v108, v108, v220
    v_mul_f32 v109, v109, v220
    v_mul_f32 v110, v110, v220
    v_mul_f32 v111, v111, v220
    s_nop 1
    v_mfma_f32_32x32x16_bf16 v[96:111], a[80:83], v[208:211], v[96:111]
    ds_read_b128 v[176:179], v31 offset:0
    v_mul_f32 v112, v112, v220
    v_mul_f32 v113, v113, v220
    ds_read_b128 v[180:183], v31 offset:1024
    s_add_u32 m0, s63, 12288
    s_add_u32 s54, s58, 16384
    buffer_load_dwordx4 v20, s[32:35], s54 offen nt lds
    v_mul_f32 v114, v114, v220
    v_mul_f32 v115, v115, v220
    ds_read_b128 v[184:187], v31 offset:2048
    v_mul_f32 v116, v116, v220
    v_mfma_f32_32x32x16_bf16 v[96:111], a[84:87], v[212:215], v[96:111]
    v_mul_f32 v117, v117, v220
    ds_read_b128 v[188:191], v31 offset:3072
    v_mul_f32 v118, v118, v220
    s_add_u32 m0, s63, 13312
    s_add_u32 s54, s58, 20480
    buffer_load_dwordx4 v21, s[32:35], s54 offen nt lds
    v_mul_f32 v119, v119, v220
    v_mul_f32 v120, v120, v220
    v_mul_f32 v121, v121, v220
    v_mul_f32 v122, v122, v220
    v_mul_f32 v123, v123, v220
    v_mul_f32 v124, v124, v220
    v_mul_f32 v125, v125, v220
    v_mul_f32 v126, v126, v220
    v_mul_f32 v127, v127, v220
    s_nop 1
    v_mfma_f32_32x32x16_bf16 v[112:127], a[88:91], v[208:211], v[112:127]
    v_add_f32 v192, v192, v200
    v_add_f32 v193, v193, v201
    v_add_f32 v194, v194, v202
    v_add_f32 v195, v195, v203
    s_add_u32 m0, s63, 14336
    s_add_u32 s54, s58, 24576
    buffer_load_dwordx4 v22, s[32:35], s54 offen nt lds
    v_add_f32 v196, v196, v204
    v_add_f32 v197, v197, v205
    v_add_f32 v198, v198, v206
    v_add_f32 v199, v199, v207
    v_mfma_f32_32x32x16_bf16 v[112:127], a[92:95], v[212:215], v[112:127]
    v_add_f32 v192, v192, v196
    v_add_f32 v193, v193, v197
    v_add_f32 v194, v194, v198
    s_add_u32 m0, s63, 15360
    s_add_u32 s54, s58, 28672
    buffer_load_dwordx4 v23, s[32:35], s54 offen nt lds
    v_add_f32 v195, v195, v199
    v_add_f32 v192, v192, v193
    v_add_f32 v194, v194, v195
    v_add_f32 v192, v192, v194
    v_add_f32 v217, v217, v192
    s_add_u32 s58, s58, 32768
    s_cmp_lt_u32 s58, s60
    s_cselect_b32 s58, s58, 0x1000000
    s_waitcnt vmcnt(16)
    ds_read_b128 a[32:35], v32 offset:24576
    ds_read_b128 a[36:39], v33 offset:24576
    ds_read_b128 a[40:43], v34 offset:24576
    ds_read_b128 a[44:47], v35 offset:24576
    ds_read_b128 a[48:51], v36 offset:24576
    ds_read_b128 a[52:55], v37 offset:24576
    ds_read_b128 a[56:59], v38 offset:24576
    ds_read_b128 a[60:63], v39 offset:24576
    s_waitcnt lgkmcnt(8)
    v_add_f32 v144, v144, v128
    v_add_f32 v145, v145, v129
    v_add_f32 v146, v146, v130
    v_add_f32 v147, v147, v131
    v_add_f32 v148, v148, v132
    v_add_f32 v149, v149, v133
    v_add_f32 v150, v150, v134
    v_add_f32 v151, v151, v135
    v_add_f32 v152, v152, v136
    v_add_f32 v153, v153, v137
    v_add_f32 v154, v154, v138
    v_add_f32 v155, v155, v139
    v_add_f32 v156, v156, v140
    v_add_f32 v157, v157, v141
    v_add_f32 v158, v158, v142
    v_add_f32 v159, v159, v143
    s_waitcnt lgkmcnt(0)
    v_mfma_f32_32x32x16_bf16 v[128:143], a[32:35], a[0:3], 0
    ds_read_b64_tr_b16 a[64:65], v40 offset:16384
    ds_read_b64_tr_b16 a[66:67], v41 offset:18432
    v_add_f32 v160, v160, v176
    v_add_f32 v161, v161, v177
    v_add_f32 v162, v162, v178
    v_add_f32 v163, v163, v179
    v_add_f32 v164, v164, v180
    v_mfma_f32_32x32x16_bf16 v[128:143], a[36:39], a[4:7], v[128:143]
    ds_read_b64_tr_b16 a[72:73], v42 offset:16384
    ds_read_b64_tr_b16 a[74:75], v43 offset:18432
    v_add_f32 v165, v165, v181
    v_add_f32 v166, v166, v182
    v_add_f32 v167, v167, v183
    v_add_f32 v168, v168, v184
    v_add_f32 v169, v169, v185
    v_mfma_f32_32x32x16_bf16 v[128:143], a[40:43], a[8:11], v[128:143]
    ds_read_b64_tr_b16 a[80:81], v44 offset:16384
    ds_read_b64_tr_b16 a[82:83], v45 offset:18432
    v_add_f32 v170, v170, v186
    v_add_f32 v171, v171, v187
    v_add_f32 v172, v172, v188
    v_add_f32 v173, v173, v189
    v_add_f32 v174, v174, v190
    v_mfma_f32_32x32x16_bf16 v[128:143], a[44:47], a[12:15], v[128:143]
    ds_read_b64_tr_b16 a[88:89], v46 offset:16384
    ds_read_b64_tr_b16 a[90:91], v47 offset:18432
    v_add_f32 v175, v175, v191
    v_add_f32 v144, v144, v160
    v_add_f32 v145, v145, v161
    v_add_f32 v146, v146, v162
    v_add_f32 v147, v147, v163
    v_mfma_f32_32x32x16_bf16 v[128:143], a[48:51], a[16:19], v[128:143]
    ds_read_b64_tr_b16 a[68:69], v40 offset:20480
    ds_read_b64_tr_b16 a[70:71], v41 offset:22528
    v_add_f32 v148, v148, v164
    v_add_f32 v149, v149, v165
    v_add_f32 v150, v150, v166
    v_add_f32 v151, v151, v167
    v_add_f32 v152, v152, v168
    v_mfma_f32_32x32x16_bf16 v[128:143], a[52:55], a[20:23], v[128:143]
    ds_read_b64_tr_b16 a[76:77], v42 offset:20480
    ds_read_b64_tr_b16 a[78:79], v43 offset:22528
    v_add_f32 v153, v153, v169
    v_add_f32 v154, v154, v170
    v_add_f32 v155, v155, v171
    v_add_f32 v156, v156, v172
    v_add_f32 v157, v157, v173
    v_mfma_f32_32x32x16_bf16 v[128:143], a[56:59], a[24:27], v[128:143]
    ds_read_b64_tr_b16 a[84:85], v44 offset:20480
    ds_read_b64_tr_b16 a[86:87], v45 offset:22528
    v_add_f32 v158, v158, v174
    v_add_f32 v159, v159, v175
    v_max3_f32 v218, v144, v145, v146
    v_max3_f32 v219, v147, v148, v149
    v_max3_f32 v220, v150, v151, v152
    v_mfma_f32_32x32x16_bf16 v[128:143], a[60:63], a[28:31], v[128:143]
    ds_read_b64_tr_b16 a[92:93], v46 offset:20480
    ds_read_b64_tr_b16 a[94:95], v47 offset:22528
    v_max3_f32 v221, v153, v154, v155
    v_max3_f32 v218, v218, v156, v157
    v_max3_f32 v219, v219, v158, v159
    v_max3_f32 v218, v218, v219, v220
    v_max_f32 v218, v218, v221
    v_mov_b32 v219, v218
    s_nop 1
    v_permlane32_swap_b32 v218, v219
    v_max3_f32 v218, v218, v219, v216
    v_sub_f32 v220, v216, v218
    v_mov_b32 v216, v218
    v_exp_f32 v220, v220
    v_sub_f32 v192, v144, v218
    v_sub_f32 v193, v145, v218
    v_sub_f32 v194, v146, v218
    v_sub_f32 v195, v147, v218
    v_sub_f32 v196, v148, v218
    v_sub_f32 v197, v149, v218
    v_sub_f32 v198, v150, v218
    v_sub_f32 v199, v151, v218
    v_sub_f32 v200, v152, v218
    v_sub_f32 v201, v153, v218
    v_sub_f32 v202, v154, v218
    v_sub_f32 v203, v155, v218
    v_sub_f32 v204, v156, v218
    v_sub_f32 v205, v157, v218
    v_sub_f32 v206, v158, v218
    v_sub_f32 v207, v159, v218
    ds_write_b128 v28, v[128:131] offset:16384
    v_exp_f32 v192, v192
    v_exp_f32 v193, v193
    v_exp_f32 v194, v194
    v_exp_f32 v195, v195
    ds_write_b128 v28, v[132:135] offset:17408
    v_exp_f32 v196, v196
    v_exp_f32 v197, v197
    v_exp_f32 v198, v198
    v_exp_f32 v199, v199
    ds_write_b128 v28, v[136:139] offset:18432
    v_exp_f32 v200, v200
    v_exp_f32 v201, v201
    v_exp_f32 v202, v202
    v_exp_f32 v203, v203
    ds_write_b128 v28, v[140:143] offset:19456
    v_exp_f32 v204, v204
    v_exp_f32 v205, v205
    v_exp_f32 v206, v206
    v_exp_f32 v207, v207
    v_mul_f32 v217, v217, v220
    v_cvt_pk_bf16_f32 v208, v192, v193
    v_cvt_pk_bf16_f32 v209, v194, v195
    v_cvt_pk_bf16_f32 v210, v196, v197
    v_cvt_pk_bf16_f32 v211, v198, v199
    v_cvt_pk_bf16_f32 v212, v200, v201
    v_cvt_pk_bf16_f32 v213, v202, v203
    v_cvt_pk_bf16_f32 v214, v204, v205
    v_cvt_pk_bf16_f32 v215, v206, v207
    v_mul_f32 v64, v64, v220
    v_mul_f32 v65, v65, v220
    v_mul_f32 v66, v66, v220
    v_mul_f32 v67, v67, v220
    v_mul_f32 v68, v68, v220
    v_mul_f32 v69, v69, v220
    v_mul_f32 v70, v70, v220
    v_mul_f32 v71, v71, v220
    v_mul_f32 v72, v72, v220
    v_mul_f32 v73, v73, v220
    v_mul_f32 v74, v74, v220
    v_mul_f32 v75, v75, v220
    v_mul_f32 v76, v76, v220
    v_mul_f32 v77, v77, v220
    v_mul_f32 v78, v78, v220
    v_mul_f32 v79, v79, v220
    s_waitcnt lgkmcnt(0)
    s_barrier
    v_mfma_f32_32x32x16_bf16 v[64:79], a[64:67], v[208:211], v[64:79]
    ds_read_b128 v[144:147], v29 offset:16384
    v_mul_f32 v80, v80, v220
    v_mul_f32 v81, v81, v220
    ds_read_b128 v[148:151], v29 offset:17408
    s_add_u32 m0, s63, 16384
    s_add_u32 s54, s58, 0
    buffer_load_dwordx4 v20, s[32:35], s54 offen nt lds
    v_mul_f32 v82, v82, v220
    v_mul_f32 v83, v83, v220
    ds_read_b128 v[152:155], v29 offset:18432
    v_mul_f32 v84, v84, v220
    v_mfma_f32_32x32x16_bf16 v[64:79], a[68:71], v[212:215], v[64:79]
    v_mul_f32 v85, v85, v220
    ds_read_b128 v[156:159], v29 offset:19456
    v_mul_f32 v86, v86, v220
    s_add_u32 m0, s63, 17408
    s_add_u32 s54, s58, 4096
    buffer_load_dwordx4 v21, s[32:35], s54 offen nt lds
    v_mul_f32 v87, v87, v220
    v_mul_f32 v88, v88, v220
    v_mul_f32 v89, v89, v220
    v_mul_f32 v90, v90, v220
    v_mul_f32 v91, v91, v220
    v_mul_f32 v92, v92, v220
    v_mul_f32 v93, v93, v220
    v_mul_f32 v94, v94, v220
    v_mul_f32 v95, v95, v220
    s_nop 1
    v_mfma_f32_32x32x16_bf16 v[80:95], a[72:75], v[208:211], v[80:95]
    ds_read_b128 v[160:163], v30 offset:16384
    v_mul_f32 v96, v96, v220
    v_mul_f32 v97, v97, v220
    ds_read_b128 v[164:167], v30 offset:17408
    s_add_u32 m0, s63, 18432
    s_add_u32 s54, s58, 8192
    buffer_load_dwordx4 v22, s[32:35], s54 offen nt lds
    v_mul_f32 v98, v98, v220
    v_mul_f32 v99, v99, v220
    ds_read_b128 v[168:171], v30 offset:18432
    v_mul_f32 v100, v100, v220
    v_mfma_f32_32x32x16_bf16 v[80:95], a[76:79], v[212:215], v[80:95]
    v_mul_f32 v101, v101, v220
    ds_read_b128 v[172:175], v30 offset:19456
    v_mul_f32 v102, v102, v220
    s_add_u32 m0, s63, 19456
    s_add_u32 s54, s58, 12288
    buffer_load_dwordx4 v23, s[32:35], s54 offen nt lds
    v_mul_f32 v103, v103, v220
    v_mul_f32 v104, v104, v220
    v_mul_f32 v105, v105, v220
    v_mul_f32 v106, v106, v220
    v_mul_f32 v107, v107, v220
    v_mul_f32 v108, v108, v220
    v_mul_f32 v109, v109, v220
    v_mul_f32 v110, v110, v220
    v_mul_f32 v111, v111, v220
    s_nop 1
    v_mfma_f32_32x32x16_bf16 v[96:111], a[80:83], v[208:211], v[96:111]
    ds_read_b128 v[176:179], v31 offset:16384
    v_mul_f32 v112, v112, v220
    v_mul_f32 v113, v113, v220
    ds_read_b128 v[180:183], v31 offset:17408
    s_add_u32 m0, s63, 20480
    s_add_u32 s54, s58, 16384
    buffer_load_dwordx4 v20, s[32:35], s54 offen nt lds
    v_mul_f32 v114, v114, v220
    v_mul_f32 v115, v115, v220
    ds_read_b128 v[184:187], v31 offset:18432
    v_mul_f32 v116, v116, v220
    v_mfma_f32_32x32x16_bf16 v[96:111], a[84:87], v[212:215], v[96:111]
    v_mul_f32 v117, v117, v220
    ds_read_b128 v[188:191], v31 offset:19456
    v_mul_f32 v118, v118, v220
    s_add_u32 m0, s63, 21504
    s_add_u32 s54, s58, 20480
    buffer_load_dwordx4 v21, s[32:35], s54 offen nt lds
    v_mul_f32 v119, v119, v220
    v_mul_f32 v120, v120, v220
    v_mul_f32 v121, v121, v220
    v_mul_f32 v122, v122, v220
    v_mul_f32 v123, v123, v220
    v_mul_f32 v124, v124, v220
    v_mul_f32 v125, v125, v220
    v_mul_f32 v126, v126, v220
    v_mul_f32 v127, v127, v220
    s_nop 1
    v_mfma_f32_32x32x16_bf16 v[112:127], a[88:91], v[208:211], v[112:127]
    v_add_f32 v192, v192, v200
    v_add_f32 v193, v193, v201
    v_add_f32 v194, v194, v202
    v_add_f32 v195, v195, v203
    s_add_u32 m0, s63, 22528
    s_add_u32 s54, s58, 24576
    buffer_load_dwordx4 v22, s[32:35], s54 offen nt lds
    v_add_f32 v196, v196, v204
    v_add_f32 v197, v197, v205
    v_add_f32 v198, v198, v206
    v_add_f32 v199, v199, v207
    v_mfma_f32_32x32x16_bf16 v[112:127], a[92:95], v[212:215], v[112:127]
    v_add_f32 v192, v192, v196
    v_add_f32 v193, v193, v197
    v_add_f32 v194, v194, v198
    s_add_u32 m0, s63, 23552
    s_add_u32 s54, s58, 28672
    buffer_load_dwordx4 v23, s[32:35], s54 offen nt lds
    v_add_f32 v195, v195, v199
    v_add_f32 v192, v192, v193
    v_add_f32 v194, v194, v195
    v_add_f32 v192, v192, v194
    v_add_f32 v217, v217, v192
    s_add_u32 s58, s58, 32768
    s_cmp_lt_u32 s58, s60
    s_cselect_b32 s58, s58, 0x1000000
    s_waitcnt vmcnt(16)
    ds_read_b128 a[32:35], v32 offset:0
    ds_read_b128 a[36:39], v33 offset:0
    ds_read_b128 a[40:43], v34 offset:0
    ds_read_b128 a[44:47], v35 offset:0
    ds_read_b128 a[48:51], v36 offset:0
    ds_read_b128 a[52:55], v37 offset:0
    ds_read_b128 a[56:59], v38 offset:0
    ds_read_b128 a[60:63], v39 offset:0
    s_waitcnt lgkmcnt(8)
    v_add_f32 v144, v144, v128
    v_add_f32 v145, v145, v129
    v_add_f32 v146, v146, v130
    v_add_f32 v147, v147, v131
    v_add_f32 v148, v148, v132
    v_add_f32 v149, v149, v133
    v_add_f32 v150, v150, v134
    v_add_f32 v151, v151, v135
    v_add_f32 v152, v152, v136
    v_add_f32 v153, v153, v137
    v_add_f32 v154, v154, v138
    v_add_f32 v155, v155, v139
    v_add_f32 v156, v156, v140
    v_add_f32 v157, v157, v141
    v_add_f32 v158, v158, v142
    v_add_f32 v159, v159, v143
    s_waitcnt lgkmcnt(0)
    v_mfma_f32_32x32x16_bf16 v[128:143], a[32:35], a[0:3], 0
    ds_read_b64_tr_b16 a[64:65], v40 offset:24576
    ds_read_b64_tr_b16 a[66:67], v41 offset:26624
    v_add_f32 v160, v160, v176
    v_add_f32 v161, v161, v177
    v_add_f32 v162, v162, v178
    v_add_f32 v163, v163, v179
    v_add_f32 v164, v164, v180
    v_mfma_f32_32x32x16_bf16 v[128:143], a[36:39], a[4:7], v[128:143]
    ds_read_b64_tr_b16 a[72:73], v42 offset:24576
    ds_read_b64_tr_b16 a[74:75], v43 offset:26624
    v_add_f32 v165, v165, v181
    v_add_f32 v166, v166, v182
    v_add_f32 v167, v167, v183
    v_add_f32 v168, v168, v184
    v_add_f32 v169, v169, v185
    v_mfma_f32_32x32x16_bf16 v[128:143], a[40:43], a[8:11], v[128:143]
    ds_read_b64_tr_b16 a[80:81], v44 offset:24576
    ds_read_b64_tr_b16 a[82:83], v45 offset:26624
    v_add_f32 v170, v170, v186
    v_add_f32 v171, v171, v187
    v_add_f32 v172, v172, v188
    v_add_f32 v173, v173, v189
    v_add_f32 v174, v174, v190
    v_mfma_f32_32x32x16_bf16 v[128:143], a[44:47], a[12:15], v[128:143]
    ds_read_b64_tr_b16 a[88:89], v46 offset:24576
    ds_read_b64_tr_b16 a[90:91], v47 offset:26624
    v_add_f32 v175, v175, v191
    v_add_f32 v144, v144, v160
    v_add_f32 v145, v145, v161
    v_add_f32 v146, v146, v162
    v_add_f32 v147, v147, v163
    v_mfma_f32_32x32x16_bf16 v[128:143], a[48:51], a[16:19], v[128:143]
    ds_read_b64_tr_b16 a[68:69], v40 offset:28672
    ds_read_b64_tr_b16 a[70:71], v41 offset:30720
    v_add_f32 v148, v148, v164
    v_add_f32 v149, v149, v165
    v_add_f32 v150, v150, v166
    v_add_f32 v151, v151, v167
    v_add_f32 v152, v152, v168
    v_mfma_f32_32x32x16_bf16 v[128:143], a[52:55], a[20:23], v[128:143]
    ds_read_b64_tr_b16 a[76:77], v42 offset:28672
    ds_read_b64_tr_b16 a[78:79], v43 offset:30720
    v_add_f32 v153, v153, v169
    v_add_f32 v154, v154, v170
    v_add_f32 v155, v155, v171
    v_add_f32 v156, v156, v172
    v_add_f32 v157, v157, v173
    v_mfma_f32_32x32x16_bf16 v[128:143], a[56:59], a[24:27], v[128:143]
    ds_read_b64_tr_b16 a[84:85], v44 offset:28672
    ds_read_b64_tr_b16 a[86:87], v45 offset:30720
    v_add_f32 v158, v158, v174
    v_add_f32 v159, v159, v175
    v_max3_f32 v218, v144, v145, v146
    v_max3_f32 v219, v147, v148, v149
    v_max3_f32 v220, v150, v151, v152
    v_mfma_f32_32x32x16_bf16 v[128:143], a[60:63], a[28:31], v[128:143]
    ds_read_b64_tr_b16 a[92:93], v46 offset:28672
    ds_read_b64_tr_b16 a[94:95], v47 offset:30720
    v_max3_f32 v221, v153, v154, v155
    v_max3_f32 v218, v218, v156, v157
    v_max3_f32 v219, v219, v158, v159
    v_max3_f32 v218, v218, v219, v220
    v_max_f32 v218, v218, v221
    v_mov_b32 v219, v218
    s_nop 1
    v_permlane32_swap_b32 v218, v219
    v_max3_f32 v218, v218, v219, v216
    v_sub_f32 v220, v216, v218
    v_mov_b32 v216, v218
    v_exp_f32 v220, v220
    v_sub_f32 v192, v144, v218
    v_sub_f32 v193, v145, v218
    v_sub_f32 v194, v146, v218
    v_sub_f32 v195, v147, v218
    v_sub_f32 v196, v148, v218
    v_sub_f32 v197, v149, v218
    v_sub_f32 v198, v150, v218
    v_sub_f32 v199, v151, v218
    v_sub_f32 v200, v152, v218
    v_sub_f32 v201, v153, v218
    v_sub_f32 v202, v154, v218
    v_sub_f32 v203, v155, v218
    v_sub_f32 v204, v156, v218
    v_sub_f32 v205, v157, v218
    v_sub_f32 v206, v158, v218
    v_sub_f32 v207, v159, v218
    ds_write_b128 v28, v[128:131] offset:0
    v_exp_f32 v192, v192
    v_exp_f32 v193, v193
    v_exp_f32 v194, v194
    v_exp_f32 v195, v195
    ds_write_b128 v28, v[132:135] offset:1024
    v_exp_f32 v196, v196
    v_exp_f32 v197, v197
    v_exp_f32 v198, v198
    v_exp_f32 v199, v199
    ds_write_b128 v28, v[136:139] offset:2048
    v_exp_f32 v200, v200
    v_exp_f32 v201, v201
    v_exp_f32 v202, v202
    v_exp_f32 v203, v203
    ds_write_b128 v28, v[140:143] offset:3072
    v_exp_f32 v204, v204
    v_exp_f32 v205, v205
    v_exp_f32 v206, v206
    v_exp_f32 v207, v207
    v_mul_f32 v217, v217, v220
    v_cvt_pk_bf16_f32 v208, v192, v193
    v_cvt_pk_bf16_f32 v209, v194, v195
    v_cvt_pk_bf16_f32 v210, v196, v197
    v_cvt_pk_bf16_f32 v211, v198, v199
    v_cvt_pk_bf16_f32 v212, v200, v201
    v_cvt_pk_bf16_f32 v213, v202, v203
    v_cvt_pk_bf16_f32 v214, v204, v205
    v_cvt_pk_bf16_f32 v215, v206, v207
    v_mul_f32 v64, v64, v220
    v_mul_f32 v65, v65, v220
    v_mul_f32 v66, v66, v220
    v_mul_f32 v67, v67, v220
    v_mul_f32 v68, v68, v220
    v_mul_f32 v69, v69, v220
    v_mul_f32 v70, v70, v220
    v_mul_f32 v71, v71, v220
    v_mul_f32 v72, v72, v220
    v_mul_f32 v73, v73, v220
    v_mul_f32 v74, v74, v220
    v_mul_f32 v75, v75, v220
    v_mul_f32 v76, v76, v220
    v_mul_f32 v77, v77, v220
    v_mul_f32 v78, v78, v220
    v_mul_f32 v79, v79, v220
    s_waitcnt lgkmcnt(0)
    s_barrier
    v_mfma_f32_32x32x16_bf16 v[64:79], a[64:67], v[208:211], v[64:79]
    ds_read_b128 v[144:147], v29 offset:0
    v_mul_f32 v80, v80, v220
    v_mul_f32 v81, v81, v220
    ds_read_b128 v[148:151], v29 offset:1024
    s_add_u32 m0, s63, 24576
    s_add_u32 s54, s58, 0
    buffer_load_dwordx4 v20, s[32:35], s54 offen nt lds
    v_mul_f32 v82, v82, v220
    v_mul_f32 v83, v83, v220
    ds_read_b128 v[152:155], v29 offset:2048
    v_mul_f32 v84, v84, v220
    v_mfma_f32_32x32x16_bf16 v[64:79], a[68:71], v[212:215], v[64:79]
    v_mul_f32 v85, v85, v220
    ds_read_b128 v[156:159], v29 offset:3072
    v_mul_f32 v86, v86, v220
    s_add_u32 m0, s63, 25600
    s_add_u32 s54, s58, 4096
    buffer_load_dwordx4 v21, s[32:35], s54 offen nt lds
    v_mul_f32 v87, v87, v220
    v_mul_f32 v88, v88, v220
    v_mul_f32 v89, v89, v220
    v_mul_f32 v90, v90, v220
    v_mul_f32 v91, v91, v220
    v_mul_f32 v92, v92, v220
    v_mul_f32 v93, v93, v220
    v_mul_f32 v94, v94, v220
    v_mul_f32 v95, v95, v220
    s_nop 1
    v_mfma_f32_32x32x16_bf16 v[80:95], a[72:75], v[208:211], v[80:95]
    ds_read_b128 v[160:163], v30 offset:0
    v_mul_f32 v96, v96, v220
    v_mul_f32 v97, v97, v220
    ds_read_b128 v[164:167], v30 offset:1024
    s_add_u32 m0, s63, 26624
    s_add_u32 s54, s58, 8192
    buffer_load_dwordx4 v22, s[32:35], s54 offen nt lds
    v_mul_f32 v98, v98, v220
    v_mul_f32 v99, v99, v220
    ds_read_b128 v[168:171], v30 offset:2048
    v_mul_f32 v100, v100, v220
    v_mfma_f32_32x32x16_bf16 v[80:95], a[76:79], v[212:215], v[80:95]
    v_mul_f32 v101, v101, v220
    ds_read_b128 v[172:175], v30 offset:3072
    v_mul_f32 v102, v102, v220
    s_add_u32 m0, s63, 27648
    s_add_u32 s54, s58, 12288
    buffer_load_dwordx4 v23, s[32:35], s54 offen nt lds
    v_mul_f32 v103, v103, v220
    v_mul_f32 v104, v104, v220
    v_mul_f32 v105, v105, v220
    v_mul_f32 v106, v106, v220
    v_mul_f32 v107, v107, v220
    v_mul_f32 v108, v108, v220
    v_mul_f32 v109, v109, v220
    v_mul_f32 v110, v110, v220
    v_mul_f32 v111, v111, v220
    s_nop 1
    v_mfma_f32_32x32x16_bf16 v[96:111], a[80:83], v[208:211], v[96:111]
    ds_read_b128 v[176:179], v31 offset:0
    v_mul_f32 v112, v112, v220
    v_mul_f32 v113, v113, v220
    ds_read_b128 v[180:183], v31 offset:1024
    s_add_u32 m0, s63, 28672
    s_add_u32 s54, s58, 16384
    buffer_load_dwordx4 v20, s[32:35], s54 offen nt lds
    v_mul_f32 v114, v114, v220
    v_mul_f32 v115, v115, v220
    ds_read_b128 v[184:187], v31 offset:2048
    v_mul_f32 v116, v116, v220
    v_mfma_f32_32x32x16_bf16 v[96:111], a[84:87], v[212:215], v[96:111]
    v_mul_f32 v117, v117, v220
    ds_read_b128 v[188:191], v31 offset:3072
    v_mul_f32 v118, v118, v220
    s_add_u32 m0, s63, 29696
    s_add_u32 s54, s58, 20480
    buffer_load_dwordx4 v21, s[32:35], s54 offen nt lds
    v_mul_f32 v119, v119, v220
    v_mul_f32 v120, v120, v220
    v_mul_f32 v121, v121, v220
    v_mul_f32 v122, v122, v220
    v_mul_f32 v123, v123, v220
    v_mul_f32 v124, v124, v220
    v_mul_f32 v125, v125, v220
    v_mul_f32 v126, v126, v220
    v_mul_f32 v127, v127, v220
    s_nop 1
    v_mfma_f32_32x32x16_bf16 v[112:127], a[88:91], v[208:211], v[112:127]
    v_add_f32 v192, v192, v200
    v_add_f32 v193, v193, v201
    v_add_f32 v194, v194, v202
    v_add_f32 v195, v195, v203
    s_add_u32 m0, s63, 30720
    s_add_u32 s54, s58, 24576
    buffer_load_dwordx4 v22, s[32:35], s54 offen nt lds
    v_add_f32 v196, v196, v204
    v_add_f32 v197, v197, v205
    v_add_f32 v198, v198, v206
    v_add_f32 v199, v199, v207
    v_mfma_f32_32x32x16_bf16 v[112:127], a[92:95], v[212:215], v[112:127]
    v_add_f32 v192, v192, v196
    v_add_f32 v193, v193, v197
    v_add_f32 v194, v194, v198
    s_add_u32 m0, s63, 31744
    s_add_u32 s54, s58, 28672
    buffer_load_dwordx4 v23, s[32:35], s54 offen nt lds
    v_add_f32 v195, v195, v199
    v_add_f32 v192, v192, v193
    v_add_f32 v194, v194, v195
    v_add_f32 v192, v192, v194
    v_add_f32 v217, v217, v192
    s_add_u32 s58, s58, 32768
    s_cmp_lt_u32 s58, s60
    s_cselect_b32 s58, s58, 0x1000000
    s_sub_u32 s62, s62, 1
    s_cmp_lg_u32 s62, 0
    s_cbranch_scc1 L_bloop
    s_waitcnt lgkmcnt(0)
    s_waitcnt vmcnt(0)
    v_mov_b32 v219, v217
    s_nop 1
    v_permlane32_swap_b32 v217, v219
    v_add_f32 v217, v217, v219
    v_rcp_f32 v220, v217
    v_mul_u32_u24 v5, 272, v24
    v_lshl_add_u32 v5, v25, 3, v5
    v_add_u32 v5, s63, v5
    v_mul_f32 v64, v64, v220
    v_mul_f32 v65, v65, v220
    v_mul_f32 v66, v66, v220
    v_mul_f32 v67, v67, v220
    v_mul_f32 v68, v68, v220
    v_mul_f32 v69, v69, v220
    v_mul_f32 v70, v70, v220
    v_mul_f32 v71, v71, v220
    v_mul_f32 v72, v72, v220
    v_mul_f32 v73, v73, v220
    v_mul_f32 v74, v74, v220
    v_mul_f32 v75, v75, v220
    v_mul_f32 v76, v76, v220
    v_mul_f32 v77, v77, v220
    v_mul_f32 v78, v78, v220
    v_mul_f32 v79, v79, v220
    v_mul_f32 v80, v80, v220
    v_mul_f32 v81, v81, v220
    v_mul_f32 v82, v82, v220
    v_mul_f32 v83, v83, v220
    v_mul_f32 v84, v84, v220
    v_mul_f32 v85, v85, v220
    v_mul_f32 v86, v86, v220
    v_mul_f32 v87, v87, v220
    v_mul_f32 v88, v88, v220
    v_mul_f32 v89, v89, v220
    v_mul_f32 v90, v90, v220
    v_mul_f32 v91, v91, v220
    v_mul_f32 v92, v92, v220
    v_mul_f32 v93, v93, v220
    v_mul_f32 v94, v94, v220
    v_mul_f32 v95, v95, v220
    v_mul_f32 v96, v96, v220
    v_mul_f32 v97, v97, v220
    v_mul_f32 v98, v98, v220
    v_mul_f32 v99, v99, v220
    v_mul_f32 v100, v100, v220
    v_mul_f32 v101, v101, v220
    v_mul_f32 v102, v102, v220
    v_mul_f32 v103, v103, v220
    v_mul_f32 v104, v104, v220
    v_mul_f32 v105, v105, v220
    v_mul_f32 v106, v106, v220
    v_mul_f32 v107, v107, v220
    v_mul_f32 v108, v108, v220
    v_mul_f32 v109, v109, v220
    v_mul_f32 v110, v110, v220
    v_mul_f32 v111, v111, v220
    v_mul_f32 v112, v112, v220
    v_mul_f32 v113, v113, v220
    v_mul_f32 v114, v114, v220
    v_mul_f32 v115, v115, v220
    v_mul_f32 v116, v116, v220
    v_mul_f32 v117, v117, v220
    v_mul_f32 v118, v118, v220
    v_mul_f32 v119, v119, v220
    v_mul_f32 v120, v120, v220
    v_mul_f32 v121, v121, v220
    v_mul_f32 v122, v122, v220
    v_mul_f32 v123, v123, v220
    v_mul_f32 v124, v124, v220
    v_mul_f32 v125, v125, v220
    v_mul_f32 v126, v126, v220
    v_mul_f32 v127, v127, v220
    v_cvt_pk_bf16_f32 v128, v64, v65
    v_cvt_pk_bf16_f32 v129, v66, v67
    v_cvt_pk_bf16_f32 v130, v68, v69
    v_cvt_pk_bf16_f32 v131, v70, v71
    v_cvt_pk_bf16_f32 v132, v72, v73
    v_cvt_pk_bf16_f32 v133, v74, v75
    v_cvt_pk_bf16_f32 v134, v76, v77
    v_cvt_pk_bf16_f32 v135, v78, v79
    v_cvt_pk_bf16_f32 v136, v80, v81
    v_cvt_pk_bf16_f32 v137, v82, v83
    v_cvt_pk_bf16_f32 v138, v84, v85
    v_cvt_pk_bf16_f32 v139, v86, v87
    v_cvt_pk_bf16_f32 v140, v88, v89
    v_cvt_pk_bf16_f32 v141, v90, v91
    v_cvt_pk_bf16_f32 v142, v92, v93
    v_cvt_pk_bf16_f32 v143, v94, v95
    v_cvt_pk_bf16_f32 v144, v96, v97
    v_cvt_pk_bf16_f32 v145, v98, v99
    v_cvt_pk_bf16_f32 v146, v100, v101
    v_cvt_pk_bf16_f32 v147, v102, v103
    v_cvt_pk_bf16_f32 v148, v104, v105
    v_cvt_pk_bf16_f32 v149, v106, v107
    v_cvt_pk_bf16_f32 v150, v108, v109
    v_cvt_pk_bf16_f32 v151, v110, v111
    v_cvt_pk_bf16_f32 v152, v112, v113
    v_cvt_pk_bf16_f32 v153, v114, v115
    v_cvt_pk_bf16_f32 v154, v116, v117
    v_cvt_pk_bf16_f32 v155, v118, v119
    v_cvt_pk_bf16_f32 v156, v120, v121
    v_cvt_pk_bf16_f32 v157, v122, v123
    v_cvt_pk_bf16_f32 v158, v124, v125
    v_cvt_pk_bf16_f32 v159, v126, v127
    ds_write_b64 v5, v[128:129] offset:0
    ds_write_b64 v5, v[130:131] offset:16
    ds_write_b64 v5, v[132:133] offset:32
    ds_write_b64 v5, v[134:135] offset:48
    ds_write_b64 v5, v[136:137] offset:64
    ds_write_b64 v5, v[138:139] offset:80
    ds_write_b64 v5, v[140:141] offset:96
    ds_write_b64 v5, v[142:143] offset:112
    ds_write_b64 v5, v[144:145] offset:128
    ds_write_b64 v5, v[146:147] offset:144
    ds_write_b64 v5, v[148:149] offset:160
    ds_write_b64 v5, v[150:151] offset:176
    ds_write_b64 v5, v[152:153] offset:192
    ds_write_b64 v5, v[154:155] offset:208
    ds_write_b64 v5, v[156:157] offset:224
    ds_write_b64 v5, v[158:159] offset:240
    v_mul_u32_u24 v6, 272, v4
    v_lshl_add_u32 v6, v3, 4, v6
    v_add_u32 v6, s63, v6
    s_waitcnt lgkmcnt(0)
    ds_read_b128 v[64:67], v6 offset:0
    ds_read_b128 v[68:71], v6 offset:1088
    ds_read_b128 v[72:75], v6 offset:2176
    ds_read_b128 v[76:79], v6 offset:3264
    ds_read_b128 v[80:83], v6 offset:4352
    ds_read_b128 v[84:87], v6 offset:5440
    ds_read_b128 v[88:91], v6 offset:6528
    ds_read_b128 v[92:95], v6 offset:7616
    v_lshlrev_b32 v7, 15, v4
    v_lshl_add_u32 v7, v3, 4, v7
    s_lshl_b32 s54, s53, 10
    s_lshl_b32 s55, s3, 8
    s_add_u32 s54, s54, s55
    s_add_u32 s54, s54, 2097152
    s_waitcnt lgkmcnt(7)
    buffer_store_dwordx4 v[64:67], v7, s[44:47], s54 offen sc1
    s_add_u32 s54, s54, 131072
    s_waitcnt lgkmcnt(6)
    buffer_store_dwordx4 v[68:71], v7, s[44:47], s54 offen sc1
    s_add_u32 s54, s54, 131072
    s_waitcnt lgkmcnt(5)
    buffer_store_dwordx4 v[72:75], v7, s[44:47], s54 offen sc1
    s_add_u32 s54, s54, 131072
    s_waitcnt lgkmcnt(4)
    buffer_store_dwordx4 v[76:79], v7, s[44:47], s54 offen sc1
    s_add_u32 s54, s54, 131072
    s_waitcnt lgkmcnt(3)
    buffer_store_dwordx4 v[80:83], v7, s[44:47], s54 offen sc1
    s_add_u32 s54, s54, 131072
    s_waitcnt lgkmcnt(2)
    buffer_store_dwordx4 v[84:87], v7, s[44:47], s54 offen sc1
    s_add_u32 s54, s54, 131072
    s_waitcnt lgkmcnt(1)
    buffer_store_dwordx4 v[88:91], v7, s[44:47], s54 offen sc1
    s_add_u32 s54, s54, 131072
    s_waitcnt lgkmcnt(0)
    buffer_store_dwordx4 v[92:95], v7, s[44:47], s54 offen sc1
    s_add_u32 s54, s54, 131072
    v_lshlrev_b32 v5, 8, v24
    s_lshl_b32 s54, s53, 3
    s_add_u32 s54, s54, 3145728
    buffer_store_dwordx2 v[216:217], v5, s[44:47], s54 offen sc1
    s_waitcnt vmcnt(0)
    s_barrier
    s_cmp_lg_u32 s3, 0
    s_cbranch_scc1 L_nosig_14
    v_mov_b32 v5, 192
    v_mov_b32 v6, 1
    s_mov_b64 exec, 1
    global_atomic_add v5, v6, s[28:29]
    s_mov_b64 exec, -1
L_nosig_14:
    v_accvgpr_read_b32 v96, a96
    v_accvgpr_read_b32 v97, a97
    v_accvgpr_read_b32 v98, a98
    v_accvgpr_read_b32 v99, a99
    v_accvgpr_read_b32 v100, a100
    v_accvgpr_read_b32 v101, a101
    v_accvgpr_read_b32 v102, a102
    v_accvgpr_read_b32 v103, a103
    v_accvgpr_read_b32 v104, a104
    v_accvgpr_read_b32 v105, a105
    v_accvgpr_read_b32 v106, a106
    v_accvgpr_read_b32 v107, a107
    v_accvgpr_read_b32 v108, a108
    v_accvgpr_read_b32 v109, a109
    v_accvgpr_read_b32 v110, a110
    v_accvgpr_read_b32 v111, a111
    v_accvgpr_read_b32 v112, a112
    v_accvgpr_read_b32 v113, a113
    v_accvgpr_read_b32 v114, a114
    v_accvgpr_read_b32 v115, a115
    v_accvgpr_read_b32 v116, a116
    v_accvgpr_read_b32 v117, a117
    v_accvgpr_read_b32 v118, a118
    v_accvgpr_read_b32 v119, a119
    v_accvgpr_read_b32 v120, a120
    v_accvgpr_read_b32 v121, a121
    v_accvgpr_read_b32 v122, a122
    v_accvgpr_read_b32 v123, a123
    v_accvgpr_read_b32 v124, a124
    v_accvgpr_read_b32 v125, a125
    v_accvgpr_read_b32 v126, a126
    v_accvgpr_read_b32 v127, a127
    v_accvgpr_read_b32 v128, a128
    v_accvgpr_read_b32 v129, a129
    v_accvgpr_read_b32 v130, a130
    v_accvgpr_read_b32 v131, a131
    v_accvgpr_read_b32 v132, a132
    v_accvgpr_read_b32 v133, a133
    v_accvgpr_read_b32 v134, a134
    v_accvgpr_read_b32 v135, a135
    v_accvgpr_read_b32 v136, a136
    v_accvgpr_read_b32 v137, a137
    v_accvgpr_read_b32 v138, a138
    v_accvgpr_read_b32 v139, a139
    v_accvgpr_read_b32 v140, a140
    v_accvgpr_read_b32 v141, a141
    v_accvgpr_read_b32 v142, a142
    v_accvgpr_read_b32 v143, a143
    v_accvgpr_read_b32 v144, a144
    v_accvgpr_read_b32 v145, a145
    v_accvgpr_read_b32 v146, a146
    v_accvgpr_read_b32 v147, a147
    v_accvgpr_read_b32 v148, a148
    v_accvgpr_read_b32 v149, a149
    v_accvgpr_read_b32 v150, a150
    v_accvgpr_read_b32 v151, a151
    v_accvgpr_read_b32 v152, a152
    v_accvgpr_read_b32 v153, a153
    v_accvgpr_read_b32 v154, a154
    v_accvgpr_read_b32 v155, a155
    v_accvgpr_read_b32 v156, a156
    v_accvgpr_read_b32 v157, a157
    v_accvgpr_read_b32 v158, a158
    v_accvgpr_read_b32 v159, a159
    v_accvgpr_read_b32 v160, a160
    v_accvgpr_read_b32 v161, a161
    v_accvgpr_read_b32 v162, a162
    v_accvgpr_read_b32 v163, a163
    v_accvgpr_read_b32 v164, a164
    v_accvgpr_read_b32 v165, a165
    v_accvgpr_read_b32 v166, a166
    v_accvgpr_read_b32 v167, a167
    v_accvgpr_read_b32 v168, a168
    v_accvgpr_read_b32 v169, a169
    v_accvgpr_read_b32 v170, a170
    v_accvgpr_read_b32 v171, a171
    v_accvgpr_read_b32 v172, a172
    v_accvgpr_read_b32 v173, a173
    v_accvgpr_read_b32 v174, a174
    v_accvgpr_read_b32 v175, a175
    v_accvgpr_read_b32 v176, a176
    v_accvgpr_read_b32 v177, a177
    v_accvgpr_read_b32 v178, a178
    v_accvgpr_read_b32 v179, a179
    v_accvgpr_read_b32 v180, a180
    v_accvgpr_read_b32 v181, a181
    v_accvgpr_read_b32 v182, a182
    v_accvgpr_read_b32 v183, a183
    v_accvgpr_read_b32 v184, a184
    v_accvgpr_read_b32 v185, a185
    v_accvgpr_read_b32 v186, a186
    v_accvgpr_read_b32 v187, a187
    v_accvgpr_read_b32 v188, a188
    v_accvgpr_read_b32 v189, a189
    v_accvgpr_read_b32 v190, a190
    v_accvgpr_read_b32 v191, a191
    v_accvgpr_read_b32 v192, a192
    v_accvgpr_read_b32 v193, a193
    v_accvgpr_read_b32 v194, a194
    v_accvgpr_read_b32 v195, a195
    v_accvgpr_read_b32 v196, a196
    v_accvgpr_read_b32 v197, a197
    v_accvgpr_read_b32 v198, a198
    v_accvgpr_read_b32 v199, a199
    v_accvgpr_read_b32 v200, a200
    v_accvgpr_read_b32 v201, a201
    v_accvgpr_read_b32 v202, a202
    v_accvgpr_read_b32 v203, a203
    v_accvgpr_read_b32 v204, a204
    v_accvgpr_read_b32 v205, a205
    v_accvgpr_read_b32 v206, a206
    v_accvgpr_read_b32 v207, a207
    v_accvgpr_read_b32 v208, a208
    v_accvgpr_read_b32 v209, a209
    v_accvgpr_read_b32 v210, a210
    v_accvgpr_read_b32 v211, a211
    v_accvgpr_read_b32 v212, a212
    v_accvgpr_read_b32 v213, a213
    v_accvgpr_read_b32 v214, a214
    v_accvgpr_read_b32 v215, a215
    v_accvgpr_read_b32 v216, a216
    v_accvgpr_read_b32 v217, a217
    v_accvgpr_read_b32 v218, a218
    v_accvgpr_read_b32 v219, a219
    v_accvgpr_read_b32 v220, a220
    v_accvgpr_read_b32 v221, a221
    v_accvgpr_read_b32 v222, a222
    v_accvgpr_read_b32 v223, a223
    v_accvgpr_read_b32 v224, a224
    v_accvgpr_read_b32 v225, a225
    v_accvgpr_read_b32 v226, a226
    v_accvgpr_read_b32 v227, a227
    v_accvgpr_read_b32 v228, a228
    v_accvgpr_read_b32 v229, a229
    v_accvgpr_read_b32 v230, a230
    v_accvgpr_read_b32 v231, a231
    v_accvgpr_read_b32 v232, a232
    v_accvgpr_read_b32 v233, a233
    v_accvgpr_read_b32 v234, a234
    v_accvgpr_read_b32 v235, a235
    v_accvgpr_read_b32 v236, a236
    v_accvgpr_read_b32 v237, a237
    v_accvgpr_read_b32 v238, a238
    v_accvgpr_read_b32 v239, a239
    v_accvgpr_read_b32 v240, a240
    v_accvgpr_read_b32 v241, a241
    v_accvgpr_read_b32 v242, a242
    v_accvgpr_read_b32 v243, a243
    v_accvgpr_read_b32 v244, a244
    v_accvgpr_read_b32 v245, a245
    v_accvgpr_read_b32 v246, a246
    v_accvgpr_read_b32 v247, a247
    v_accvgpr_read_b32 v248, a248
    v_accvgpr_read_b32 v249, a249
    v_accvgpr_read_b32 v250, a250
    v_accvgpr_read_b32 v251, a251
    v_accvgpr_read_b32 v252, a252
    v_accvgpr_read_b32 v253, a253
    v_accvgpr_read_b32 v254, a254
    v_accvgpr_read_b32 v255, a255
    s_mov_b32 s54, 0x05040100
    s_mov_b32 s55, 0x07060302
    v_perm_b32 v64, v100, v96, s54
    v_perm_b32 v65, v108, v104, s54
    v_perm_b32 v66, v116, v112, s54
    v_perm_b32 v67, v124, v120, s54
    v_perm_b32 v68, v100, v96, s55
    v_perm_b32 v69, v108, v104, s55
    v_perm_b32 v70, v116, v112, s55
    v_perm_b32 v71, v124, v120, s55
    v_perm_b32 v72, v101, v97, s54
    v_perm_b32 v73, v109, v105, s54
    v_perm_b32 v74, v117, v113, s54
    v_perm_b32 v75, v125, v121, s54
    v_perm_b32 v76, v101, v97, s55
    v_perm_b32 v77, v109, v105, s55
    v_perm_b32 v78, v117, v113, s55
    v_perm_b32 v79, v125, v121, s55
    v_perm_b32 v80, v102, v98, s54
    v_perm_b32 v81, v110, v106, s54
    v_perm_b32 v82, v118, v114, s54
    v_perm_b32 v83, v126, v122, s54
    v_perm_b32 v84, v102, v98, s55
    v_perm_b32 v85, v110, v106, s55
    v_perm_b32 v86, v118, v114, s55
    v_perm_b32 v87, v126, v122, s55
    v_perm_b32 v88, v103, v99, s54
    v_perm_b32 v89, v111, v107, s54
    v_perm_b32 v90, v119, v115, s54
    v_perm_b32 v91, v127, v123, s54
    v_perm_b32 v92, v103, v99, s55
    v_perm_b32 v93, v111, v107, s55
    v_perm_b32 v94, v119, v115, s55
    v_perm_b32 v95, v127, v123, s55
    v_perm_b32 v96, v132, v128, s54
    v_perm_b32 v97, v140, v136, s54
    v_perm_b32 v98, v148, v144, s54
    v_perm_b32 v99, v156, v152, s54
    v_perm_b32 v100, v132, v128, s55
    v_perm_b32 v101, v140, v136, s55
    v_perm_b32 v102, v148, v144, s55
    v_perm_b32 v103, v156, v152, s55
    v_perm_b32 v104, v133, v129, s54
    v_perm_b32 v105, v141, v137, s54
    v_perm_b32 v106, v149, v145, s54
    v_perm_b32 v107, v157, v153, s54
    v_perm_b32 v108, v133, v129, s55
    v_perm_b32 v109, v141, v137, s55
    v_perm_b32 v110, v149, v145, s55
    v_perm_b32 v111, v157, v153, s55
    v_perm_b32 v112, v134, v130, s54
    v_perm_b32 v113, v142, v138, s54
    v_perm_b32 v114, v150, v146, s54
    v_perm_b32 v115, v158, v154, s54
    v_perm_b32 v116, v134, v130, s55
    v_perm_b32 v117, v142, v138, s55
    v_perm_b32 v118, v150, v146, s55
    v_perm_b32 v119, v158, v154, s55
    v_perm_b32 v120, v135, v131, s54
    v_perm_b32 v121, v143, v139, s54
    v_perm_b32 v122, v151, v147, s54
    v_perm_b32 v123, v159, v155, s54
    v_perm_b32 v124, v135, v131, s55
    v_perm_b32 v125, v143, v139, s55
    v_perm_b32 v126, v151, v147, s55
    v_perm_b32 v127, v159, v155, s55
    v_perm_b32 v128, v164, v160, s54
    v_perm_b32 v129, v172, v168, s54
    v_perm_b32 v130, v180, v176, s54
    v_perm_b32 v131, v188, v184, s54
    v_perm_b32 v132, v164, v160, s55
    v_perm_b32 v133, v172, v168, s55
    v_perm_b32 v134, v180, v176, s55
    v_perm_b32 v135, v188, v184, s55
    v_perm_b32 v136, v165, v161, s54
    v_perm_b32 v137, v173, v169, s54
    v_perm_b32 v138, v181, v177, s54
    v_perm_b32 v139, v189, v185, s54
    v_perm_b32 v140, v165, v161, s55
    v_perm_b32 v141, v173, v169, s55
    v_perm_b32 v142, v181, v177, s55
    v_perm_b32 v143, v189, v185, s55
    v_perm_b32 v144, v166, v162, s54
    v_perm_b32 v145, v174, v170, s54
    v_perm_b32 v146, v182, v178, s54
    v_perm_b32 v147, v190, v186, s54
    v_perm_b32 v148, v166, v162, s55
    v_perm_b32 v149, v174, v170, s55
    v_perm_b32 v150, v182, v178, s55
    v_perm_b32 v151, v190, v186, s55
    v_perm_b32 v152, v167, v163, s54
    v_perm_b32 v153, v175, v171, s54
    v_perm_b32 v154, v183, v179, s54
    v_perm_b32 v155, v191, v187, s54
    v_perm_b32 v156, v167, v163, s55
    v_perm_b32 v157, v175, v171, s55
    v_perm_b32 v158, v183, v179, s55
    v_perm_b32 v159, v191, v187, s55
    v_perm_b32 v160, v196, v192, s54
    v_perm_b32 v161, v204, v200, s54
    v_perm_b32 v162, v212, v208, s54
    v_perm_b32 v163, v220, v216, s54
    v_perm_b32 v164, v196, v192, s55
    v_perm_b32 v165, v204, v200, s55
    v_perm_b32 v166, v212, v208, s55
    v_perm_b32 v167, v220, v216, s55
    v_perm_b32 v168, v197, v193, s54
    v_perm_b32 v169, v205, v201, s54
    v_perm_b32 v170, v213, v209, s54
    v_perm_b32 v171, v221, v217, s54
    v_perm_b32 v172, v197, v193, s55
    v_perm_b32 v173, v205, v201, s55
    v_perm_b32 v174, v213, v209, s55
    v_perm_b32 v175, v221, v217, s55
    v_perm_b32 v176, v198, v194, s54
    v_perm_b32 v177, v206, v202, s54
    v_perm_b32 v178, v214, v210, s54
    v_perm_b32 v179, v222, v218, s54
    v_perm_b32 v180, v198, v194, s55
    v_perm_b32 v181, v206, v202, s55
    v_perm_b32 v182, v214, v210, s55
    v_perm_b32 v183, v222, v218, s55
    v_perm_b32 v184, v199, v195, s54
    v_perm_b32 v185, v207, v203, s54
    v_perm_b32 v186, v215, v211, s54
    v_perm_b32 v187, v223, v219, s54
    v_perm_b32 v188, v199, v195, s55
    v_perm_b32 v189, v207, v203, s55
    v_perm_b32 v190, v215, v211, s55
    v_perm_b32 v191, v223, v219, s55
    v_perm_b32 v192, v225, v224, s54
    v_perm_b32 v193, v227, v226, s54
    v_perm_b32 v194, v229, v228, s54
    v_perm_b32 v195, v231, v230, s54
    v_perm_b32 v196, v225, v224, s55
    v_perm_b32 v197, v227, v226, s55
    v_perm_b32 v198, v229, v228, s55
    v_perm_b32 v199, v231, v230, s55
    v_perm_b32 v200, v233, v232, s54
    v_perm_b32 v201, v235, v234, s54
    v_perm_b32 v202, v237, v236, s54
    v_perm_b32 v203, v239, v238, s54
    v_perm_b32 v204, v233, v232, s55
    v_perm_b32 v205, v235, v234, s55
    v_perm_b32 v206, v237, v236, s55
    v_perm_b32 v207, v239, v238, s55
    v_perm_b32 v208, v241, v240, s54
    v_perm_b32 v209, v243, v242, s54
    v_perm_b32 v210, v245, v244, s54
    v_perm_b32 v211, v247, v246, s54
    v_perm_b32 v212, v241, v240, s55
    v_perm_b32 v213, v243, v242, s55
    v_perm_b32 v214, v245, v244, s55
    v_perm_b32 v215, v247, v246, s55
    v_perm_b32 v216, v249, v248, s54
    v_perm_b32 v217, v251, v250, s54
    v_perm_b32 v218, v253, v252, s54
    v_perm_b32 v219, v255, v254, s54
    v_perm_b32 v220, v249, v248, s55
    v_perm_b32 v221, v251, v250, s55
    v_perm_b32 v222, v253, v252, s55
    v_perm_b32 v223, v255, v254, s55
    s_cmp_lg_u32 s3, 0
    s_cbranch_scc1 L_polled_16
    v_mov_b32 v5, 192
L_poll_15:
    global_load_dword v6, v5, s[28:29] sc1
    s_waitcnt vmcnt(0)
    v_cmp_le_u32 vcc, 32, v6
    s_cbranch_vccnz L_polled_16
    s_sleep 2
    s_sub_u32 s101, s101, 1
    s_cbranch_scc0 L_poll_15
    s_mov_b32 s101, 0
L_polled_16:
    s_barrier
    s_lshl_b32 s58, s52, 15
    s_lshl_b32 s54, s3, 10
    s_add_u32 s58, s58, s54
    v_min_u32 v5, 5, v1
    v_lshlrev_b32 v5, 12, v5
    s_mov_b32 s97, 1069066811
L_light_17:
    buffer_load_dword v6, v5, s[44:47], s58 offen offset:512 sc1
    s_waitcnt vmcnt(0)
    v_cmp_ne_u32 vcc, -1, v6
    s_cbranch_vccnz L_heavy_18
    s_sleep 4
    s_sub_u32 s101, s101, 1
    s_cbranch_scc0 L_light_17
    s_mov_b32 s101, 0
L_heavy_18:
    s_add_u32 s54, s58, 0
    buffer_load_dwordx4 v[16:19], v2, s[44:47], s54 offen sc1
    s_add_u32 s54, s58, 4096
    buffer_load_dwordx4 v[20:23], v2, s[44:47], s54 offen sc1
    s_add_u32 s54, s58, 8192
    buffer_load_dwordx4 v[24:27], v2, s[44:47], s54 offen sc1
    s_add_u32 s54, s58, 12288
    buffer_load_dwordx4 v[28:31], v2, s[44:47], s54 offen sc1
    s_add_u32 s54, s58, 16384
    buffer_load_dwordx4 v[32:35], v2, s[44:47], s54 offen sc1
    s_add_u32 s54, s58, 20480
    buffer_load_dwordx4 v[36:39], v2, s[44:47], s54 offen sc1
    s_waitcnt vmcnt(0)
    v_max3_u32 v224, v16, v17, v18
    v_max3_u32 v225, v28, v29, v30
    v_max3_u32 v224, v224, v19, v20
    v_max3_u32 v225, v225, v31, v32
    v_max3_u32 v224, v224, v21, v22
    v_max3_u32 v225, v225, v33, v34
    v_max3_u32 v224, v224, v23, v24
    v_max3_u32 v225, v225, v35, v36
    v_max3_u32 v224, v224, v25, v26
    v_max3_u32 v225, v225, v37, v38
    v_max3_u32 v224, v224, v27, v39
    v_max_u32 v224, v224, v225
    v_cmp_eq_u32 vcc, -1, v224
    s_cbranch_vccz L_heavyok_19
    s_sub_u32 s101, s101, 1
    s_cbranch_scc0 L_heavy_18
    s_mov_b32 s101, 0
L_heavyok_19:
    v_max3_f32 v224, v16, v20, v24
    v_max3_f32 v225, v28, v32, v36
    v_max_f32 v224, v224, v225
    v_sub_f32 v232, v16, v224
    v_sub_f32 v233, v20, v224
    v_sub_f32 v234, v24, v224
    v_sub_f32 v235, v28, v224
    v_sub_f32 v236, v32, v224
    v_sub_f32 v237, v36, v224
    v_mul_f32 v232, s97, v232
    v_mul_f32 v233, s97, v233
    v_mul_f32 v234, s97, v234
    v_mul_f32 v235, s97, v235
    v_mul_f32 v236, s97, v236
    v_mul_f32 v237, s97, v237
    v_exp_f32 v232, v232
    v_exp_f32 v233, v233
    v_exp_f32 v234, v234
    v_exp_f32 v235, v235
    v_exp_f32 v236, v236
    v_exp_f32 v237, v237
    v_mul_f32 v224, v232, v17
    v_mul_f32 v225, v233, v21
    v_fmac_f32 v224, v234, v25
    v_fmac_f32 v225, v235, v29
    v_fmac_f32 v224, v236, v33
    v_fmac_f32 v225, v237, v37
    v_add_f32 v224, v224, v225
    v_rcp_f32 v224, v224
    s_nop 0
    v_mul_f32 v232, v232, v224
    v_mul_f32 v233, v233, v224
    v_mul_f32 v234, v234, v224
    v_mul_f32 v235, v235, v224
    v_mul_f32 v236, v236, v224
    v_mul_f32 v237, v237, v224
    v_permlane32_swap_b32 v232, v240
    v_permlane32_swap_b32 v233, v241
    v_permlane32_swap_b32 v234, v242
    v_permlane32_swap_b32 v235, v243
    v_permlane32_swap_b32 v236, v244
    v_permlane32_swap_b32 v237, v245
    v_mul_f32 v224, v16, v240
    v_mul_f32 v225, v17, v240
    v_mul_f32 v226, v18, v240
    v_mul_f32 v227, v19, v240
    v_fmac_f32 v224, v20, v241
    v_fmac_f32 v225, v21, v241
    v_fmac_f32 v226, v22, v241
    v_fmac_f32 v227, v23, v241
    v_fmac_f32 v224, v24, v242
    v_fmac_f32 v225, v25, v242
    v_fmac_f32 v226, v26, v242
    v_fmac_f32 v227, v27, v242
    v_fmac_f32 v224, v28, v243
    v_fmac_f32 v225, v29, v243
    v_fmac_f32 v226, v30, v243
    v_fmac_f32 v227, v31, v243
    v_fmac_f32 v224, v32, v244
    v_fmac_f32 v225, v33, v244
    v_fmac_f32 v226, v34, v244
    v_fmac_f32 v227, v35, v244
    v_fmac_f32 v224, v36, v245
    v_fmac_f32 v225, v37, v245
    v_fmac_f32 v226, v38, v245
    v_fmac_f32 v227, v39, v245
    v_cvt_pk_bf16_f32 v224, v224, v225
    v_cvt_pk_bf16_f32 v225, v226, v227
    s_lshl_b32 s54, s3, 9
    v_lshl_add_u32 v5, v1, 3, s54
    ds_write_b64 v5, v[224:225]
    v_lshrrev_b32 v5, 2, v3
    v_lshlrev_b32 v5, 9, v5
    v_lshl_add_u32 v5, v4, 4, v5
    s_waitcnt lgkmcnt(0)
    s_barrier
    ds_read_b128 v[48:51], v5 offset:0
    ds_read_b128 v[52:55], v5 offset:64
    ds_read_b128 v[56:59], v5 offset:128
    ds_read_b128 v[60:63], v5 offset:192
    s_waitcnt lgkmcnt(0)
    v_mfma_f32_16x16x32_bf16 v[224:227], v[48:51], v[64:67], 0
    v_mfma_f32_16x16x32_bf16 v[228:231], v[48:51], v[68:71], 0
    v_mfma_f32_16x16x32_bf16 v[232:235], v[48:51], v[72:75], 0
    v_mfma_f32_16x16x32_bf16 v[236:239], v[48:51], v[76:79], 0
    v_mfma_f32_16x16x32_bf16 v[240:243], v[48:51], v[80:83], 0
    v_mfma_f32_16x16x32_bf16 v[244:247], v[48:51], v[84:87], 0
    v_mfma_f32_16x16x32_bf16 v[248:251], v[48:51], v[88:91], 0
    v_mfma_f32_16x16x32_bf16 v[252:255], v[48:51], v[92:95], 0
    v_mfma_f32_16x16x32_bf16 v[40:43], v[48:51], v[192:195], 0
    v_mfma_f32_16x16x32_bf16 v[44:47], v[48:51], v[196:199], 0
    v_mfma_f32_16x16x32_bf16 v[224:227], v[52:55], v[96:99], v[224:227]
    v_mfma_f32_16x16x32_bf16 v[228:231], v[52:55], v[100:103], v[228:231]
    v_mfma_f32_16x16x32_bf16 v[232:235], v[52:55], v[104:107], v[232:235]
    v_mfma_f32_16x16x32_bf16 v[236:239], v[52:55], v[108:111], v[236:239]
    v_mfma_f32_16x16x32_bf16 v[240:243], v[52:55], v[112:115], v[240:243]
    v_mfma_f32_16x16x32_bf16 v[244:247], v[52:55], v[116:119], v[244:247]
    v_mfma_f32_16x16x32_bf16 v[248:251], v[52:55], v[120:123], v[248:251]
    v_mfma_f32_16x16x32_bf16 v[252:255], v[52:55], v[124:127], v[252:255]
    v_mfma_f32_16x16x32_bf16 v[40:43], v[52:55], v[200:203], v[40:43]
    v_mfma_f32_16x16x32_bf16 v[44:47], v[52:55], v[204:207], v[44:47]
    v_mfma_f32_16x16x32_bf16 v[224:227], v[56:59], v[128:131], v[224:227]
    v_mfma_f32_16x16x32_bf16 v[228:231], v[56:59], v[132:135], v[228:231]
    v_mfma_f32_16x16x32_bf16 v[232:235], v[56:59], v[136:139], v[232:235]
    v_mfma_f32_16x16x32_bf16 v[236:239], v[56:59], v[140:143], v[236:239]
    v_mfma_f32_16x16x32_bf16 v[240:243], v[56:59], v[144:147], v[240:243]
    v_mfma_f32_16x16x32_bf16 v[244:247], v[56:59], v[148:151], v[244:247]
    v_mfma_f32_16x16x32_bf16 v[248:251], v[56:59], v[152:155], v[248:251]
    v_mfma_f32_16x16x32_bf16 v[252:255], v[56:59], v[156:159], v[252:255]
    v_mfma_f32_16x16x32_bf16 v[40:43], v[56:59], v[208:211], v[40:43]
    v_mfma_f32_16x16x32_bf16 v[44:47], v[56:59], v[212:215], v[44:47]
    v_mfma_f32_16x16x32_bf16 v[224:227], v[60:63], v[160:163], v[224:227]
    v_mfma_f32_16x16x32_bf16 v[228:231], v[60:63], v[164:167], v[228:231]
    v_mfma_f32_16x16x32_bf16 v[232:235], v[60:63], v[168:171], v[232:235]
    v_mfma_f32_16x16x32_bf16 v[236:239], v[60:63], v[172:175], v[236:239]
    v_mfma_f32_16x16x32_bf16 v[240:243], v[60:63], v[176:179], v[240:243]
    v_mfma_f32_16x16x32_bf16 v[244:247], v[60:63], v[180:183], v[244:247]
    v_mfma_f32_16x16x32_bf16 v[248:251], v[60:63], v[184:187], v[248:251]
    v_mfma_f32_16x16x32_bf16 v[252:255], v[60:63], v[188:191], v[252:255]
    v_mfma_f32_16x16x32_bf16 v[40:43], v[60:63], v[216:219], v[40:43]
    v_mfma_f32_16x16x32_bf16 v[44:47], v[60:63], v[220:223], v[44:47]
    v_mul_u32_u24 v7, 73728, v4
    v_lshrrev_b32 v5, 3, v3
    v_lshl_add_u32 v6, v5, 13, v7
    v_and_b32 v5, 7, v3
    v_lshl_add_u32 v6, v5, 4, v6
    v_lshl_add_u32 v7, v3, 3, v7
    v_add_u32 v7, 65536, v7
    s_lshl_b32 s56, s52, 7
    s_add_u32 s56, s56, 4194304
    s_lshl_b32 s54, s3, 14
    s_add_u32 s54, s54, s56
    s_add_u32 s55, s54, 4096
    s_and_b32 s57, s3, 1
    s_lshl_b32 s57, s57, 12
    s_add_u32 s56, s56, s57
    v_min_u32 v16, -2, v224
    v_min_u32 v17, -2, v228
    v_min_u32 v18, -2, v232
    v_min_u32 v19, -2, v236
    v_min_u32 v20, -2, v240
    v_min_u32 v21, -2, v244
    v_min_u32 v22, -2, v248
    v_min_u32 v23, -2, v252
    v_min_u32 v24, -2, v40
    v_min_u32 v25, -2, v44
    buffer_store_dwordx4 v[16:19], v6, s[44:47], s54 offen sc1
    buffer_store_dwordx4 v[20:23], v6, s[44:47], s55 offen sc1
    buffer_store_dwordx2 v[24:25], v7, s[44:47], s56 offen sc1
    s_lshl_b32 s54, s3, 5
    s_add_u32 s54, s54, s53
    s_cmp_ge_u32 s54, 72
    s_cbranch_scc1 L_nored_20
    s_lshl_b32 s55, s54, 12
    s_add_u32 s55, s55, 4194304
    s_mul_hi_u32 s56, s54, 238609295
    s_mul_i32 s57, s56, 18
    s_sub_u32 s57, s54, s57
    s_mul_i32 s56, s56, 2304
    s_add_u32 s56, s56, 0
    s_lshr_b32 s58, s57, 1
    s_lshl_b32 s58, s58, 7
    s_and_b32 s59, s57, 1
    s_cmp_lt_u32 s57, 16
    s_cselect_b32 s60, 3, 6
    s_cselect_b32 s61, 4, 3
    s_lshl_b32 s59, s59, s60
    s_add_u32 s56, s56, s58
    s_add_u32 s56, s56, s59
    v_lshlrev_b32 v5, s61, v1
    s_mov_b32 s48, s26
    s_mov_b32 s49, s27
    s_mov_b32 s50, 9216
    s_mov_b32 s51, 0x20000
L_redpoll_21:
    buffer_load_dwordx4 v[16:19], v2, s[44:47], s55 offen offset:0 sc1
    buffer_load_dwordx4 v[20:23], v2, s[44:47], s55 offen offset:1024 sc1
    buffer_load_dwordx4 v[24:27], v2, s[44:47], s55 offen offset:2048 sc1
    buffer_load_dwordx4 v[28:31], v2, s[44:47], s55 offen offset:3072 sc1
    s_waitcnt vmcnt(0)
    v_max3_u32 v32, v16, v17, v18
    v_max3_u32 v33, v19, v20, v21
    v_max3_u32 v34, v22, v23, v24
    v_max3_u32 v35, v25, v26, v27
    v_max3_u32 v32, v32, v28, v29
    v_max3_u32 v33, v33, v30, v31
    v_max3_u32 v32, v32, v33, v34
    v_max_u32 v32, v32, v35
    v_cmp_eq_u32 vcc, -1, v32
    s_cbranch_vccz L_redok_22
    s_sub_u32 s101, s101, 1
    s_cbranch_scc0 L_redpoll_21
    s_mov_b32 s101, 0
L_redok_22:
    v_add_f32 v16, v16, v20
    v_add_f32 v24, v24, v28
    v_add_f32 v17, v17, v21
    v_add_f32 v25, v25, v29
    v_add_f32 v18, v18, v22
    v_add_f32 v26, v26, v30
    v_add_f32 v19, v19, v23
    v_add_f32 v27, v27, v31
    v_add_f32 v16, v16, v24
    v_add_f32 v17, v17, v25
    v_add_f32 v18, v18, v26
    v_add_f32 v19, v19, v27
    v_add_f32_dpp v16, v16, v16 row_ror:8 row_mask:0xf bank_mask:0xf
    v_add_f32_dpp v17, v17, v17 row_ror:8 row_mask:0xf bank_mask:0xf
    v_add_f32_dpp v18, v18, v18 row_ror:8 row_mask:0xf bank_mask:0xf
    v_add_f32_dpp v19, v19, v19 row_ror:8 row_mask:0xf bank_mask:0xf
    v_mov_b32 v20, v16
    v_mov_b32 v21, v17
    v_mov_b32 v22, v18
    v_mov_b32 v23, v19
    v_permlane16_swap_b32 v16, v20
    v_permlane16_swap_b32 v17, v21
    v_permlane16_swap_b32 v18, v22
    v_permlane16_swap_b32 v19, v23
    v_add_f32 v16, v16, v20
    v_add_f32 v17, v17, v21
    v_add_f32 v18, v18, v22
    v_add_f32 v19, v19, v23
    v_mov_b32 v20, v16
    v_mov_b32 v21, v17
    v_mov_b32 v22, v18
    v_mov_b32 v23, v19
    v_permlane32_swap_b32 v16, v20
    v_permlane32_swap_b32 v17, v21
    v_permlane32_swap_b32 v18, v22
    v_permlane32_swap_b32 v19, v23
    v_add_f32 v16, v16, v20
    v_add_f32 v17, v17, v21
    v_add_f32 v18, v18, v22
    v_add_f32 v19, v19, v23
    v_cvt_pk_bf16_f32 v16, v16, v17
    v_cvt_pk_bf16_f32 v17, v18, v19
    s_mov_b64 exec, 0xff
    buffer_store_dwordx2 v[16:17], v5, s[48:51], s56 offen
    s_mov_b64 exec, -1
L_nored_20:
    s_endpgm
L_roleC_end:
L_exit:
    s_endpgm
.section .rodata,"a"
.p2align 6
.amdhsa_kernel concat_heads__mha_block_cached__compressed_kv_cla__decode_kernel
  .amdhsa_next_free_vgpr 512
  .amdhsa_next_free_sgpr 102
  .amdhsa_accum_offset 256
  .amdhsa_group_segment_fixed_size 0
  .amdhsa_kernarg_size 112
  .amdhsa_user_sgpr_count 2
  .amdhsa_user_sgpr_kernarg_segment_ptr 1
  .amdhsa_system_sgpr_workgroup_id_x 1
.end_amdhsa_kernel
```

```asm
; @launch grid=(256,1,1) block=(256,1,1) lds=163840
.amdgcn_target "amdgcn-amd-amdhsa--gfx950"
.text
.globl concat_heads__mha_block_cached__compressed_kv_cla__decode_kernel
.p2align 8
.type concat_heads__mha_block_cached__compressed_kv_cla__decode_kernel,@function
concat_heads__mha_block_cached__compressed_kv_cla__decode_kernel:
    s_cmp_ge_u32 s2, 256
    s_cbranch_scc1 L_exit
    s_load_dwordx16 s[4:19], s[0:1], 0
    s_load_dwordx8 s[20:27], s[0:1], 64
    s_load_dwordx4 s[28:31], s[0:1], 96
    v_lshrrev_b32 v2, 6, v0
    v_and_b32 v1, 63, v0
    v_readfirstlane_b32 s3, v2
    v_and_b32 v3, 15, v0
    v_bfe_u32 v4, v0, 4, 2
    v_lshlrev_b32 v2, 4, v1
    s_and_b32 s52, s2, 31
    s_mov_b32 s53, s52
    s_cmp_lt_u32 s2, 32
    s_cbranch_scc1 L_roleH
    s_cmp_lt_u32 s2, 64
    s_cbranch_scc1 L_roleC
L_roleA:
    s_sub_u32 s54, s2, 64
    s_mul_hi_u32 s96, s54, 178956971
    s_mul_i32 s56, s96, 24
    s_sub_u32 s97, s54, s56
    s_add_u32 s56, s96, s3
    s_and_b32 s56, s56, 3
    s_lshr_b32 s55, s97, 3
    s_and_b32 s53, s97, 7
    s_lshl_b32 s96, s96, 2
    s_add_u32 s55, s55, s56
    s_add_u32 s55, s55, 1
    s_and_b32 s55, s55, 3
    s_add_u32 s52, s96, s55
    s_add_u32 s96, s96, s56
    s_lshl_b32 s100, s3, 25
    s_lshl_b32 s55, s52, 20
    s_add_u32 s100, s100, s55
    s_lshl_b32 s55, s53, 12
    s_add_u32 s100, s100, s55
    s_lshl_b32 s58, s52, 2
    s_add_u32 s58, s58, s3
    s_mul_i32 s58, s58, 163840
    s_add_u32 s59, s58, 1048576
    s_sub_u32 s61, s59, 65536
    s_and_b32 s99, s96, 28
    s_add_u32 s99, s99, s3
    s_mul_i32 s99, s99, 151552
    s_mov_b32 s63, s53
    s_getpc_b64 s[56:57]
L_pc_1:
    s_sub_u32 s56, s56, L_pc_1-L_roleA
    s_subb_u32 s57, s57, 0
    v_lshlrev_b32 v5, 7, v0
    v_min_u32 v6, L_roleA_end-L_roleA-4, v5
    global_load_dword v56, v6, s[56:57]
    s_mov_b32 s53, 536870912
    v_mov_b32 v18, s53
    v_cmp_eq_u32 vcc, 0, v1
    s_nop 1
    v_cndmask_b32 v18, v18, v1, vcc
    s_waitcnt lgkmcnt(0)
    s_mov_b32 s32, s6
    s_mov_b32 s33, s7
    s_mov_b32 s34, 134217728
    s_mov_b32 s35, 0x20000
    s_mov_b32 s36, s8
    s_mov_b32 s37, s9
    s_mov_b32 s38, 134217728
    s_mov_b32 s39, 0x20000
    s_mov_b32 s44, s30
    s_mov_b32 s45, s31
    s_mov_b32 s46, 536870912
    s_mov_b32 s47, 0x20000
    s_and_b32 s60, s58, 1015808
    s_or_b32 s60, s60, s100
    s_add_u32 s58, s58, 32768
    buffer_load_dwordx4 v[96:99], v2, s[32:35], s60 offen offset:0 nt
    buffer_load_dwordx4 v[100:103], v2, s[32:35], s60 offen offset:1024 nt
    buffer_load_dwordx4 v[104:107], v2, s[32:35], s60 offen offset:2048 nt
    buffer_load_dwordx4 v[108:111], v2, s[32:35], s60 offen offset:3072 nt
    buffer_load_dwordx4 a[32:35], v2, s[36:39], s60 offen offset:0 nt
    buffer_load_dwordx4 a[36:39], v2, s[36:39], s60 offen offset:1024 nt
    buffer_load_dwordx4 a[40:43], v2, s[36:39], s60 offen offset:2048 nt
    buffer_load_dwordx4 a[44:47], v2, s[36:39], s60 offen offset:3072 nt
    s_and_b32 s60, s58, 1015808
    s_or_b32 s60, s60, s100
    s_add_u32 s58, s58, 32768
    buffer_load_dwordx4 v[112:115], v2, s[32:35], s60 offen offset:0 nt
    buffer_load_dwordx4 v[116:119], v2, s[32:35], s60 offen offset:1024 nt
    buffer_load_dwordx4 v[120:123], v2, s[32:35], s60 offen offset:2048 nt
    buffer_load_dwordx4 v[124:127], v2, s[32:35], s60 offen offset:3072 nt
    buffer_load_dwordx4 a[48:51], v2, s[36:39], s60 offen offset:0 nt
    buffer_load_dwordx4 a[52:55], v2, s[36:39], s60 offen offset:1024 nt
    buffer_load_dwordx4 a[56:59], v2, s[36:39], s60 offen offset:2048 nt
    buffer_load_dwordx4 a[60:63], v2, s[36:39], s60 offen offset:3072 nt
    s_and_b32 s60, s58, 1015808
    s_or_b32 s60, s60, s100
    s_add_u32 s58, s58, 32768
    buffer_load_dwordx4 v[128:131], v2, s[32:35], s60 offen offset:0 nt
    buffer_load_dwordx4 v[132:135], v2, s[32:35], s60 offen offset:1024 nt
    buffer_load_dwordx4 v[136:139], v2, s[32:35], s60 offen offset:2048 nt
    buffer_load_dwordx4 v[140:143], v2, s[32:35], s60 offen offset:3072 nt
    buffer_load_dwordx4 a[64:67], v2, s[36:39], s60 offen offset:0 nt
    buffer_load_dwordx4 a[68:71], v2, s[36:39], s60 offen offset:1024 nt
    buffer_load_dwordx4 a[72:75], v2, s[36:39], s60 offen offset:2048 nt
    buffer_load_dwordx4 a[76:79], v2, s[36:39], s60 offen offset:3072 nt
    s_and_b32 s60, s58, 1015808
    s_or_b32 s60, s60, s100
    s_add_u32 s58, s58, 32768
    buffer_load_dwordx4 v[144:147], v2, s[32:35], s60 offen offset:0 nt
    buffer_load_dwordx4 v[148:151], v2, s[32:35], s60 offen offset:1024 nt
    buffer_load_dwordx4 v[152:155], v2, s[32:35], s60 offen offset:2048 nt
    buffer_load_dwordx4 v[156:159], v2, s[32:35], s60 offen offset:3072 nt
    buffer_load_dwordx4 a[80:83], v2, s[36:39], s60 offen offset:0 nt
    buffer_load_dwordx4 a[84:87], v2, s[36:39], s60 offen offset:1024 nt
    buffer_load_dwordx4 a[88:91], v2, s[36:39], s60 offen offset:2048 nt
    buffer_load_dwordx4 a[92:95], v2, s[36:39], s60 offen offset:3072 nt
    s_and_b32 s60, s58, 1015808
    s_or_b32 s60, s60, s100
    s_add_u32 s58, s58, 32768
    buffer_load_dwordx4 v[160:163], v2, s[32:35], s60 offen offset:0 nt
    buffer_load_dwordx4 v[164:167], v2, s[32:35], s60 offen offset:1024 nt
    buffer_load_dwordx4 v[168:171], v2, s[32:35], s60 offen offset:2048 nt
    buffer_load_dwordx4 v[172:175], v2, s[32:35], s60 offen offset:3072 nt
    buffer_load_dwordx4 a[96:99], v2, s[36:39], s60 offen offset:0 nt
    buffer_load_dwordx4 a[100:103], v2, s[36:39], s60 offen offset:1024 nt
    buffer_load_dwordx4 a[104:107], v2, s[36:39], s60 offen offset:2048 nt
    buffer_load_dwordx4 a[108:111], v2, s[36:39], s60 offen offset:3072 nt
    s_and_b32 s60, s58, 1015808
    s_or_b32 s60, s60, s100
    s_add_u32 s58, s58, 32768
    buffer_load_dwordx4 v[176:179], v2, s[32:35], s60 offen offset:0 nt
    buffer_load_dwordx4 v[180:183], v2, s[32:35], s60 offen offset:1024 nt
    buffer_load_dwordx4 v[184:187], v2, s[32:35], s60 offen offset:2048 nt
    buffer_load_dwordx4 v[188:191], v2, s[32:35], s60 offen offset:3072 nt
    buffer_load_dwordx4 a[112:115], v2, s[36:39], s60 offen offset:0 nt
    buffer_load_dwordx4 a[116:119], v2, s[36:39], s60 offen offset:1024 nt
    buffer_load_dwordx4 a[120:123], v2, s[36:39], s60 offen offset:2048 nt
    buffer_load_dwordx4 a[124:127], v2, s[36:39], s60 offen offset:3072 nt
    s_lshl_b32 s54, s52, 2
    s_lshl_b32 s55, s96, 2
    v_mov_b32 v58, s54
    v_mov_b32 v57, s55
    v_cndmask_b32 v58, v58, v57, vcc
    s_load_dword s18, s[28:29], s54
    s_load_dword s19, s[28:29], s55
    s_and_b32 s60, s58, 1015808
    s_or_b32 s60, s60, s100
    s_add_u32 s58, s58, 32768
    buffer_load_dwordx4 v[192:195], v2, s[32:35], s60 offen offset:0 nt
    buffer_load_dwordx4 v[196:199], v2, s[32:35], s60 offen offset:1024 nt
    buffer_load_dwordx4 v[200:203], v2, s[32:35], s60 offen offset:2048 nt
    buffer_load_dwordx4 v[204:207], v2, s[32:35], s60 offen offset:3072 nt
    buffer_load_dwordx4 a[128:131], v2, s[36:39], s60 offen offset:0 nt
    buffer_load_dwordx4 a[132:135], v2, s[36:39], s60 offen offset:1024 nt
    buffer_load_dwordx4 a[136:139], v2, s[36:39], s60 offen offset:2048 nt
    buffer_load_dwordx4 a[140:143], v2, s[36:39], s60 offen offset:3072 nt
    s_waitcnt vmcnt(48)
    s_and_b32 s60, s58, 1015808
    s_or_b32 s60, s60, s100
    s_add_u32 s58, s58, 32768
    buffer_load_dwordx4 v[208:211], v2, s[32:35], s60 offen offset:0 nt
    buffer_load_dwordx4 v[212:215], v2, s[32:35], s60 offen offset:1024 nt
    buffer_load_dwordx4 v[216:219], v2, s[32:35], s60 offen offset:2048 nt
    buffer_load_dwordx4 v[220:223], v2, s[32:35], s60 offen offset:3072 nt
    buffer_load_dwordx4 a[144:147], v2, s[36:39], s60 offen offset:0 nt
    buffer_load_dwordx4 a[148:151], v2, s[36:39], s60 offen offset:1024 nt
    buffer_load_dwordx4 a[152:155], v2, s[36:39], s60 offen offset:2048 nt
    buffer_load_dwordx4 a[156:159], v2, s[36:39], s60 offen offset:3072 nt
    s_waitcnt vmcnt(48)
    s_and_b32 s60, s58, 1015808
    s_or_b32 s60, s60, s100
    s_add_u32 s58, s58, 32768
    buffer_load_dwordx4 v[224:227], v2, s[32:35], s60 offen offset:0 nt
    buffer_load_dwordx4 v[228:231], v2, s[32:35], s60 offen offset:1024 nt
    buffer_load_dwordx4 v[232:235], v2, s[32:35], s60 offen offset:2048 nt
    buffer_load_dwordx4 v[236:239], v2, s[32:35], s60 offen offset:3072 nt
    buffer_load_dwordx4 a[160:163], v2, s[36:39], s60 offen offset:0 nt
    buffer_load_dwordx4 a[164:167], v2, s[36:39], s60 offen offset:1024 nt
    buffer_load_dwordx4 a[168:171], v2, s[36:39], s60 offen offset:2048 nt
    buffer_load_dwordx4 a[172:175], v2, s[36:39], s60 offen offset:3072 nt
    v_and_b32 v5, 1, v3
    v_cmp_eq_u32 vcc, 1, v5
    v_mov_b32 v5, 0xffff
    v_mov_b32 v6, 0xffff0000
    v_cndmask_b32 v5, v5, v6, vcc
    v_lshrrev_b32 v6, 1, v3
    v_cmp_eq_u32 vcc, 0, v6
    s_nop 1
    v_cndmask_b32 v8, 0, v5, vcc
    v_cmp_eq_u32 vcc, 1, v6
    s_nop 1
    v_cndmask_b32 v9, 0, v5, vcc
    v_cmp_eq_u32 vcc, 2, v6
    s_nop 1
    v_cndmask_b32 v10, 0, v5, vcc
    v_cmp_eq_u32 vcc, 3, v6
    s_nop 1
    v_cndmask_b32 v11, 0, v5, vcc
    v_mov_b32 v12, 0
    v_mov_b32 v13, 0
    v_mov_b32 v14, 0
    v_mov_b32 v15, 0
    v_mov_b32 v16, 0xff800000
    v_mov_b32 v17, 0
    v_lshrrev_b32 v5, 1, v4
    v_lshlrev_b32 v59, 5, v3
    v_lshl_add_u32 v59, v5, 4, v59
    v_and_b32 v5, 1, v4
    v_lshl_add_u32 v59, v5, 11, v59
    s_lshl_b32 s54, s52, 2
    s_add_u32 s54, s54, s3
    s_lshl_b32 s54, s54, 13
    s_lshl_b32 s55, s96, 2
    s_add_u32 s55, s55, s3
    s_lshl_b32 s55, s55, 13
    v_cmp_eq_u32 vcc, 1, v5
    v_mov_b32 v6, s54
    v_mov_b32 v7, s55
    v_cndmask_b32 v6, v6, v7, vcc
    v_mov_b32 v20, s63
    v_mov_b32 v7, s97
    v_cndmask_b32 v7, v20, v7, vcc
    v_lshl_add_u32 v20, v7, 4, v3
    v_lshl_add_u32 v20, v20, 4, v6
    v_lshl_add_u32 v21, v7, 4, v6
    v_add_u32 v21, 6144, v21
    v_mov_b32 v7, s53
    v_cmp_eq_u32 vcc, 0, v3
    s_nop 1
    v_cndmask_b32 v21, v7, v21, vcc
    v_cmp_gt_u32 vcc, 32, v1
    s_nop 1
    v_cndmask_b32 v3, v21, v20, vcc
    s_mov_b32 s8, 1015808
    s_mov_b32 s9, s100
    s_mov_b32 s10, 0xff000
    s_lshl_b32 s11, s3, 25
    s_lshl_b32 s54, s96, 20
    s_add_u32 s11, s11, s54
    s_lshl_b32 s57, s96, 2
    s_add_u32 s57, s57, s3
    s_lshl_b32 s57, s57, 7
    s_add_u32 s57, s57, 5373952
    s_lshl_b32 s54, s3, 9
    s_add_u32 s54, s54, 5242880
    s_lshl_b32 s56, s52, 12
    s_add_u32 s56, s56, s54
    s_lshl_b32 s12, s96, 12
    s_add_u32 s12, s12, s54
    s_mov_b32 s13, 0
    s_add_u32 s15, s59, 65536
    s_sub_u32 s14, s15, 131072
    s_mov_b32 s96, 1035273459
    s_mov_b32 s97, 1069066811
    s_mov_b32 s98, 0xffff0000
    s_mov_b32 s62, 2
    s_mov_b32 s101, 100000
    s_waitcnt lgkmcnt(0)
    s_min_u32 s18, s18, s19
    s_cmp_lt_u32 s18, 2
    s_cbranch_scc1 L_aflag
L_aflag_ok:
    buffer_load_dwordx4 v[60:63], v59, s[44:47], s56 offen sc1
    s_waitcnt vmcnt(49)
    s_and_b32 s60, s58, 1015808
    s_or_b32 s60, s60, s100
    s_add_u32 s58, s58, 32768
    buffer_load_dwordx4 v[240:243], v2, s[32:35], s60 offen offset:0 nt
    buffer_load_dwordx4 v[244:247], v2, s[32:35], s60 offen offset:1024 nt
    buffer_load_dwordx4 v[248:251], v2, s[32:35], s60 offen offset:2048 nt
    buffer_load_dwordx4 v[252:255], v2, s[32:35], s60 offen offset:3072 nt
    buffer_load_dwordx4 a[176:179], v2, s[36:39], s60 offen offset:0 nt
    buffer_load_dwordx4 a[180:183], v2, s[36:39], s60 offen offset:1024 nt
    buffer_load_dwordx4 a[184:187], v2, s[36:39], s60 offen offset:2048 nt
    buffer_load_dwordx4 a[188:191], v2, s[36:39], s60 offen offset:3072 nt
    s_waitcnt vmcnt(49)
    buffer_atomic_add v48, v18, s[44:47], s53 offen sc0
    s_and_b32 s60, s58, 1015808
    s_or_b32 s60, s60, s100
    s_add_u32 s58, s58, 32768
    buffer_load_dwordx4 v[64:67], v2, s[32:35], s60 offen offset:0 nt
    buffer_load_dwordx4 v[68:71], v2, s[32:35], s60 offen offset:1024 nt
    buffer_load_dwordx4 v[72:75], v2, s[32:35], s60 offen offset:2048 nt
    buffer_load_dwordx4 v[76:79], v2, s[32:35], s60 offen offset:3072 nt
    buffer_load_dwordx4 a[0:3], v2, s[36:39], s60 offen offset:0 nt
    buffer_load_dwordx4 a[4:7], v2, s[36:39], s60 offen offset:1024 nt
    buffer_load_dwordx4 a[8:11], v2, s[36:39], s60 offen offset:2048 nt
    buffer_load_dwordx4 a[12:15], v2, s[36:39], s60 offen offset:3072 nt
    s_waitcnt vmcnt(50)
    buffer_atomic_add v49, v18, s[44:47], s53 offen sc0
    s_and_b32 s60, s58, 1015808
    s_or_b32 s60, s60, s100
    s_add_u32 s58, s58, 32768
    buffer_load_dwordx4 v[80:83], v2, s[32:35], s60 offen offset:0 nt
    buffer_load_dwordx4 v[84:87], v2, s[32:35], s60 offen offset:1024 nt
    buffer_load_dwordx4 v[88:91], v2, s[32:35], s60 offen offset:2048 nt
    buffer_load_dwordx4 v[92:95], v2, s[32:35], s60 offen offset:3072 nt
    buffer_load_dwordx4 a[16:19], v2, s[36:39], s60 offen offset:0 nt
    buffer_load_dwordx4 a[20:23], v2, s[36:39], s60 offen offset:1024 nt
    buffer_load_dwordx4 a[24:27], v2, s[36:39], s60 offen offset:2048 nt
    buffer_load_dwordx4 a[28:31], v2, s[36:39], s60 offen offset:3072 nt
    s_waitcnt vmcnt(26)
L_aq1:
    v_max3_u32 v20, v60, v61, v62
    v_max_u32 v20, v20, v63
    v_cmp_eq_u32 vcc, -1, v20
    s_cbranch_vccz L_aq1_ok
    buffer_load_dwordx4 v[60:63], v59, s[44:47], s56 offen sc1
    s_waitcnt vmcnt(0)
    s_sub_u32 s101, s101, 1
    s_cbranch_scc0 L_aq1
    s_mov_b32 s101, 0
L_aq1_ok:
    v_mov_b32 v20, v60
    v_mov_b32 v21, v61
    v_mov_b32 v22, v62
    v_mov_b32 v23, v63
    v_permlane16_swap_b32 v60, v20
    v_permlane16_swap_b32 v61, v21
    v_permlane16_swap_b32 v62, v22
    v_permlane16_swap_b32 v63, v23
    v_add_f32 v60, v60, v20
    v_add_f32 v61, v61, v21
    v_add_f32 v62, v62, v22
    v_add_f32 v63, v63, v23
    v_cvt_pk_bf16_f32 v4, v60, v61
    v_cvt_pk_bf16_f32 v5, v62, v63
    v_mov_b32 v6, v4
    v_mov_b32 v7, v5
    s_nop 0
    v_permlane32_swap_b32 v4, v6
    v_permlane32_swap_b32 v5, v7
    s_mov_b32 s56, 1
L_aloop:
    s_waitcnt vmcnt(13)
    v_dot2_f32_bf16 v20, v64, v4, 0
    v_dot2_f32_bf16 v21, v68, v4, 0
    v_dot2_f32_bf16 v22, v72, v4, 0
    v_dot2_f32_bf16 v23, v76, v4, 0
    v_dot2_f32_bf16 v20, v65, v5, v20
    v_dot2_f32_bf16 v21, v69, v5, v21
    v_dot2_f32_bf16 v22, v73, v5, v22
    v_dot2_f32_bf16 v23, v77, v5, v23
    v_dot2_f32_bf16 v20, v66, v6, v20
    v_dot2_f32_bf16 v21, v70, v6, v21
    v_dot2_f32_bf16 v22, v74, v6, v22
    v_dot2_f32_bf16 v23, v78, v6, v23
    v_dot2_f32_bf16 v20, v67, v7, v20
    v_dot2_f32_bf16 v21, v71, v7, v21
    v_dot2_f32_bf16 v22, v75, v7, v22
    v_dot2_f32_bf16 v23, v79, v7, v23
    v_readfirstlane_b32 s54, v48
    v_mov_b32 v48, 1
    s_cmp_ge_u32 s58, s61
    s_cselect_b32 s55, s57, s53
    s_lshl_b32 s54, s54, 12
    s_add_u32 s60, s54, s99
    s_cmp_lt_u32 s58, s59
    s_cselect_b32 s60, s58, s60
    s_cselect_b32 s54, 0, s54
    s_cselect_b64 s[6:7], s[8:9], s[10:11]
    s_add_u32 s58, s58, 32768
    s_and_b32 s60, s60, s6
    s_or_b32 s60, s60, s7
    s_cmp_lt_u32 s54, 0x100000
    s_cselect_b32 s60, s60, 0x8000000
    s_cselect_b32 s55, s55, s53
    s_addc_u32 s62, s62, -1
    buffer_atomic_add v48, v18, s[44:47], s55 offen sc0
    buffer_load_dwordx4 v[64:67], v2, s[32:35], s60 offen offset:0 nt
    buffer_load_dwordx4 v[68:71], v2, s[32:35], s60 offen offset:1024 nt
    buffer_load_dwordx4 v[72:75], v2, s[32:35], s60 offen offset:2048 nt
    buffer_load_dwordx4 v[76:79], v2, s[32:35], s60 offen offset:3072 nt
    v_add_f32_dpp v24, v20, v20 row_ror:8 row_mask:0xf bank_mask:0x3
    v_add_f32_dpp v25, v22, v22 row_ror:8 row_mask:0xf bank_mask:0x3
    v_add_f32_dpp v24, v21, v21 row_ror:8 row_mask:0xf bank_mask:0xc
    v_add_f32_dpp v25, v23, v23 row_ror:8 row_mask:0xf bank_mask:0xc
    s_nop 0
    v_add_f32_dpp v26, v24, v24 row_shl:4 row_mask:0xf bank_mask:0x5
    v_add_f32_dpp v26, v25, v25 row_shr:4 row_mask:0xf bank_mask:0xa
    s_nop 1
    v_add_f32_dpp v26, v26, v26 quad_perm:[1,0,3,2] row_mask:0xf bank_mask:0xf
    s_nop 1
    v_add_f32_dpp v26, v26, v26 quad_perm:[2,3,0,1] row_mask:0xf bank_mask:0xf
    v_cvt_pk_bf16_f32 v26, v26, v26
    v_and_b32 v26, s98, v26
    v_mul_f32 v26, s96, v26
    v_cvt_pk_bf16_f32 v26, v26, v26
    v_and_b32 v26, s98, v26
    s_nop 1
    v_max_f32_dpp v27, v26, v26 row_ror:4 row_mask:0xf bank_mask:0xf
    s_nop 1
    v_max_f32_dpp v27, v27, v27 row_ror:8 row_mask:0xf bank_mask:0xf
    v_mov_b32 v28, v27
    s_nop 1
    v_permlane16_swap_b32 v27, v28
    v_max_f32 v27, v27, v28
    v_mov_b32 v28, v27
    s_nop 1
    v_permlane32_swap_b32 v27, v28
    v_max3_f32 v27, v27, v28, v16
    v_sub_f32 v28, v16, v27
    v_sub_f32 v29, v26, v27
    v_mul_f32 v28, s97, v28
    v_mul_f32 v29, s97, v29
    v_exp_f32 v28, v28
    v_exp_f32 v29, v29
    v_mov_b32 v16, v27
    v_fma_f32 v17, v17, v28, v29
    v_cvt_pk_bf16_f32 v29, v29, v29
    v_mul_f32 v12, v12, v28
    v_mul_f32 v13, v13, v28
    v_mul_f32 v14, v14, v28
    v_mul_f32 v15, v15, v28
    s_waitcnt vmcnt(14)
    v_and_b32_dpp v32, v29, v8 row_newbcast:0 row_mask:0xf bank_mask:0xf
    v_and_b32_dpp v33, v29, v9 row_newbcast:0 row_mask:0xf bank_mask:0xf
    v_and_b32_dpp v34, v29, v10 row_newbcast:0 row_mask:0xf bank_mask:0xf
    v_and_b32_dpp v35, v29, v11 row_newbcast:0 row_mask:0xf bank_mask:0xf
    v_and_b32_dpp v36, v29, v8 row_newbcast:8 row_mask:0xf bank_mask:0xf
    v_and_b32_dpp v37, v29, v9 row_newbcast:8 row_mask:0xf bank_mask:0xf
    v_and_b32_dpp v38, v29, v10 row_newbcast:8 row_mask:0xf bank_mask:0xf
    v_and_b32_dpp v39, v29, v11 row_newbcast:8 row_mask:0xf bank_mask:0xf
    v_and_b32_dpp v40, v29, v8 row_newbcast:4 row_mask:0xf bank_mask:0xf
    v_and_b32_dpp v41, v29, v9 row_newbcast:4 row_mask:0xf bank_mask:0xf
    v_and_b32_dpp v42, v29, v10 row_newbcast:4 row_mask:0xf bank_mask:0xf
    v_and_b32_dpp v43, v29, v11 row_newbcast:4 row_mask:0xf bank_mask:0xf
    v_and_b32_dpp v44, v29, v8 row_newbcast:12 row_mask:0xf bank_mask:0xf
    v_and_b32_dpp v45, v29, v9 row_newbcast:12 row_mask:0xf bank_mask:0xf
    v_and_b32_dpp v46, v29, v10 row_newbcast:12 row_mask:0xf bank_mask:0xf
    v_and_b32_dpp v47, v29, v11 row_newbcast:12 row_mask:0xf bank_mask:0xf
    v_mfma_f32_16x16x32_bf16 v[12:15], v[32:35], a[0:3], v[12:15]
    v_mfma_f32_16x16x32_bf16 v[12:15], v[36:39], a[4:7], v[12:15]
    v_mfma_f32_16x16x32_bf16 v[12:15], v[40:43], a[8:11], v[12:15]
    v_mfma_f32_16x16x32_bf16 v[12:15], v[44:47], a[12:15], v[12:15]
    buffer_load_dwordx4 a[0:3], v2, s[36:39], s60 offen offset:0 nt
    buffer_load_dwordx4 a[4:7], v2, s[36:39], s60 offen offset:1024 nt
    buffer_load_dwordx4 a[8:11], v2, s[36:39], s60 offen offset:2048 nt
    buffer_load_dwordx4 a[12:15], v2, s[36:39], s60 offen offset:3072 nt
    s_cmp_eq_u32 s62, 0
    s_cbranch_scc1 L_adone
    s_cmp_lg_u32 s56, 0
    s_cbranch_scc1 L_aext0
L_aback0:
    s_waitcnt vmcnt(13)
    v_dot2_f32_bf16 v20, v80, v4, 0
    v_dot2_f32_bf16 v21, v84, v4, 0
    v_dot2_f32_bf16 v22, v88, v4, 0
    v_dot2_f32_bf16 v23, v92, v4, 0
    v_dot2_f32_bf16 v20, v81, v5, v20
    v_dot2_f32_bf16 v21, v85, v5, v21
    v_dot2_f32_bf16 v22, v89, v5, v22
    v_dot2_f32_bf16 v23, v93, v5, v23
    v_dot2_f32_bf16 v20, v82, v6, v20
    v_dot2_f32_bf16 v21, v86, v6, v21
    v_dot2_f32_bf16 v22, v90, v6, v22
    v_dot2_f32_bf16 v23, v94, v6, v23
    v_dot2_f32_bf16 v20, v83, v7, v20
    v_dot2_f32_bf16 v21, v87, v7, v21
    v_dot2_f32_bf16 v22, v91, v7, v22
    v_dot2_f32_bf16 v23, v95, v7, v23
    v_readfirstlane_b32 s54, v49
    v_mov_b32 v49, 1
    s_cmp_ge_u32 s58, s61
    s_cselect_b32 s55, s57, s53
    s_lshl_b32 s54, s54, 12
    s_add_u32 s60, s54, s99
    s_cmp_lt_u32 s58, s59
    s_cselect_b32 s60, s58, s60
    s_cselect_b32 s54, 0, s54
    s_cselect_b64 s[6:7], s[8:9], s[10:11]
    s_add_u32 s58, s58, 32768
    s_and_b32 s60, s60, s6
    s_or_b32 s60, s60, s7
    s_cmp_lt_u32 s54, 0x100000
    s_cselect_b32 s60, s60, 0x8000000
    s_cselect_b32 s55, s55, s53
    s_addc_u32 s62, s62, -1
    buffer_atomic_add v49, v18, s[44:47], s55 offen sc0
    buffer_load_dwordx4 v[80:83], v2, s[32:35], s60 offen offset:0 nt
    buffer_load_dwordx4 v[84:87], v2, s[32:35], s60 offen offset:1024 nt
    buffer_load_dwordx4 v[88:91], v2, s[32:35], s60 offen offset:2048 nt
    buffer_load_dwordx4 v[92:95], v2, s[32:35], s60 offen offset:3072 nt
    v_add_f32_dpp v24, v20, v20 row_ror:8 row_mask:0xf bank_mask:0x3
    v_add_f32_dpp v25, v22, v22 row_ror:8 row_mask:0xf bank_mask:0x3
    v_add_f32_dpp v24, v21, v21 row_ror:8 row_mask:0xf bank_mask:0xc
    v_add_f32_dpp v25, v23, v23 row_ror:8 row_mask:0xf bank_mask:0xc
    s_nop 0
    v_add_f32_dpp v26, v24, v24 row_shl:4 row_mask:0xf bank_mask:0x5
    v_add_f32_dpp v26, v25, v25 row_shr:4 row_mask:0xf bank_mask:0xa
    s_nop 1
    v_add_f32_dpp v26, v26, v26 quad_perm:[1,0,3,2] row_mask:0xf bank_mask:0xf
    s_nop 1
    v_add_f32_dpp v26, v26, v26 quad_perm:[2,3,0,1] row_mask:0xf bank_mask:0xf
    v_cvt_pk_bf16_f32 v26, v26, v26
    v_and_b32 v26, s98, v26
    v_mul_f32 v26, s96, v26
    v_cvt_pk_bf16_f32 v26, v26, v26
    v_and_b32 v26, s98, v26
    s_nop 1
    v_max_f32_dpp v27, v26, v26 row_ror:4 row_mask:0xf bank_mask:0xf
    s_nop 1
    v_max_f32_dpp v27, v27, v27 row_ror:8 row_mask:0xf bank_mask:0xf
    v_mov_b32 v28, v27
    s_nop 1
    v_permlane16_swap_b32 v27, v28
    v_max_f32 v27, v27, v28
    v_mov_b32 v28, v27
    s_nop 1
    v_permlane32_swap_b32 v27, v28
    v_max3_f32 v27, v27, v28, v16
    v_sub_f32 v28, v16, v27
    v_sub_f32 v29, v26, v27
    v_mul_f32 v28, s97, v28
    v_mul_f32 v29, s97, v29
    v_exp_f32 v28, v28
    v_exp_f32 v29, v29
    v_mov_b32 v16, v27
    v_fma_f32 v17, v17, v28, v29
    v_cvt_pk_bf16_f32 v29, v29, v29
    v_mul_f32 v12, v12, v28
    v_mul_f32 v13, v13, v28
    v_mul_f32 v14, v14, v28
    v_mul_f32 v15, v15, v28
    s_waitcnt vmcnt(14)
    v_and_b32_dpp v32, v29, v8 row_newbcast:0 row_mask:0xf bank_mask:0xf
    v_and_b32_dpp v33, v29, v9 row_newbcast:0 row_mask:0xf bank_mask:0xf
    v_and_b32_dpp v34, v29, v10 row_newbcast:0 row_mask:0xf bank_mask:0xf
    v_and_b32_dpp v35, v29, v11 row_newbcast:0 row_mask:0xf bank_mask:0xf
    v_and_b32_dpp v36, v29, v8 row_newbcast:8 row_mask:0xf bank_mask:0xf
    v_and_b32_dpp v37, v29, v9 row_newbcast:8 row_mask:0xf bank_mask:0xf
    v_and_b32_dpp v38, v29, v10 row_newbcast:8 row_mask:0xf bank_mask:0xf
    v_and_b32_dpp v39, v29, v11 row_newbcast:8 row_mask:0xf bank_mask:0xf
    v_and_b32_dpp v40, v29, v8 row_newbcast:4 row_mask:0xf bank_mask:0xf
    v_and_b32_dpp v41, v29, v9 row_newbcast:4 row_mask:0xf bank_mask:0xf
    v_and_b32_dpp v42, v29, v10 row_newbcast:4 row_mask:0xf bank_mask:0xf
    v_and_b32_dpp v43, v29, v11 row_newbcast:4 row_mask:0xf bank_mask:0xf
    v_and_b32_dpp v44, v29, v8 row_newbcast:12 row_mask:0xf bank_mask:0xf
    v_and_b32_dpp v45, v29, v9 row_newbcast:12 row_mask:0xf bank_mask:0xf
    v_and_b32_dpp v46, v29, v10 row_newbcast:12 row_mask:0xf bank_mask:0xf
    v_and_b32_dpp v47, v29, v11 row_newbcast:12 row_mask:0xf bank_mask:0xf
    v_mfma_f32_16x16x32_bf16 v[12:15], v[32:35], a[16:19], v[12:15]
    v_mfma_f32_16x16x32_bf16 v[12:15], v[36:39], a[20:23], v[12:15]
    v_mfma_f32_16x16x32_bf16 v[12:15], v[40:43], a[24:27], v[12:15]
    v_mfma_f32_16x16x32_bf16 v[12:15], v[44:47], a[28:31], v[12:15]
    buffer_load_dwordx4 a[16:19], v2, s[36:39], s60 offen offset:0 nt
    buffer_load_dwordx4 a[20:23], v2, s[36:39], s60 offen offset:1024 nt
    buffer_load_dwordx4 a[24:27], v2, s[36:39], s60 offen offset:2048 nt
    buffer_load_dwordx4 a[28:31], v2, s[36:39], s60 offen offset:3072 nt
    s_cmp_eq_u32 s62, 0
    s_cbranch_scc1 L_adone
    s_cmp_lg_u32 s56, 0
    s_cbranch_scc1 L_aext1
L_aback1:
    s_cmp_lg_u32 s58, s14
    s_cbranch_scc1 L_aloop
    s_cmp_eq_u32 s14, s15
    s_cbranch_scc1 L_aswitch
    buffer_load_dwordx4 v[60:63], v59, s[44:47], s12 offen sc1
    s_mov_b32 s14, s15
    s_branch L_aloop
L_aswitch:
    s_nop 11
    v_add_f32_dpp v17, v17, v17 row_ror:4 row_mask:0xf bank_mask:0xf
    s_nop 1
    v_add_f32_dpp v17, v17, v17 row_ror:8 row_mask:0xf bank_mask:0xf
    v_mov_b32 v28, v17
    s_nop 1
    v_permlane16_swap_b32 v17, v28
    v_add_f32 v17, v17, v28
    v_mov_b32 v28, v17
    s_nop 1
    v_permlane32_swap_b32 v17, v28
    v_add_f32 v51, v17, v28
    v_mov_b32 v50, v16
    v_cvt_pk_bf16_f32 v52, v12, v13
    v_cvt_pk_bf16_f32 v53, v14, v15
    v_mov_b32 v12, 0
    v_mov_b32 v13, 0
    v_mov_b32 v14, 0
    v_mov_b32 v15, 0
    v_mov_b32 v16, 0xff800000
    v_mov_b32 v17, 0
    s_mov_b32 s13, 1
    s_cmp_eq_u32 s62, 0
    s_cbranch_scc1 L_adone
L_aq2:
    v_max3_u32 v20, v60, v61, v62
    v_max_u32 v20, v20, v63
    v_cmp_eq_u32 vcc, -1, v20
    s_cbranch_vccz L_aq2_ok
    buffer_load_dwordx4 v[60:63], v59, s[44:47], s12 offen sc1
    s_waitcnt vmcnt(0)
    s_sub_u32 s101, s101, 1
    s_cbranch_scc0 L_aq2
    s_mov_b32 s101, 0
L_aq2_ok:
    v_mov_b32 v20, v60
    v_mov_b32 v21, v61
    v_mov_b32 v22, v62
    v_mov_b32 v23, v63
    v_permlane16_swap_b32 v60, v20
    v_permlane16_swap_b32 v61, v21
    v_permlane16_swap_b32 v62, v22
    v_permlane16_swap_b32 v63, v23
    v_add_f32 v60, v60, v20
    v_add_f32 v61, v61, v21
    v_add_f32 v62, v62, v22
    v_add_f32 v63, v63, v23
    v_cvt_pk_bf16_f32 v4, v60, v61
    v_cvt_pk_bf16_f32 v5, v62, v63
    v_mov_b32 v6, v4
    v_mov_b32 v7, v5
    s_nop 0
    v_permlane32_swap_b32 v4, v6
    v_permlane32_swap_b32 v5, v7
    s_branch L_aloop
L_aext0:
    v_dot2_f32_bf16 v20, v96, v4, 0
    v_dot2_f32_bf16 v21, v100, v4, 0
    v_dot2_f32_bf16 v22, v104, v4, 0
    v_dot2_f32_bf16 v23, v108, v4, 0
    v_dot2_f32_bf16 v20, v97, v5, v20
    v_dot2_f32_bf16 v21, v101, v5, v21
    v_dot2_f32_bf16 v22, v105, v5, v22
    v_dot2_f32_bf16 v23, v109, v5, v23
    v_dot2_f32_bf16 v20, v98, v6, v20
    v_dot2_f32_bf16 v21, v102, v6, v21
    v_dot2_f32_bf16 v22, v106, v6, v22
    v_dot2_f32_bf16 v23, v110, v6, v23
    v_dot2_f32_bf16 v20, v99, v7, v20
    v_dot2_f32_bf16 v21, v103, v7, v21
    v_dot2_f32_bf16 v22, v107, v7, v22
    v_dot2_f32_bf16 v23, v111, v7, v23
    v_add_f32_dpp v24, v20, v20 row_ror:8 row_mask:0xf bank_mask:0x3
    s_nop 0
    v_add_f32_dpp v25, v22, v22 row_ror:8 row_mask:0xf bank_mask:0x3
    v_add_f32_dpp v24, v21, v21 row_ror:8 row_mask:0xf bank_mask:0xc
    v_add_f32_dpp v25, v23, v23 row_ror:8 row_mask:0xf bank_mask:0xc
    s_nop 0
    v_add_f32_dpp v26, v24, v24 row_shl:4 row_mask:0xf bank_mask:0x5
    v_add_f32_dpp v26, v25, v25 row_shr:4 row_mask:0xf bank_mask:0xa
    s_nop 1
    v_add_f32_dpp v26, v26, v26 quad_perm:[1,0,3,2] row_mask:0xf bank_mask:0xf
    s_nop 1
    v_add_f32_dpp v26, v26, v26 quad_perm:[2,3,0,1] row_mask:0xf bank_mask:0xf
    v_cvt_pk_bf16_f32 v26, v26, v26
    v_and_b32 v26, s98, v26
    v_mul_f32 v26, s96, v26
    v_cvt_pk_bf16_f32 v26, v26, v26
    v_and_b32 v26, s98, v26
    s_nop 1
    v_max_f32_dpp v27, v26, v26 row_ror:4 row_mask:0xf bank_mask:0xf
    s_nop 1
    v_max_f32_dpp v27, v27, v27 row_ror:8 row_mask:0xf bank_mask:0xf
    v_mov_b32 v28, v27
    s_nop 1
    v_permlane16_swap_b32 v27, v28
    v_max_f32 v27, v27, v28
    v_mov_b32 v28, v27
    s_nop 1
    v_permlane32_swap_b32 v27, v28
    v_max3_f32 v27, v27, v28, v16
    v_sub_f32 v28, v16, v27
    v_sub_f32 v29, v26, v27
    v_mul_f32 v28, s97, v28
    v_mul_f32 v29, s97, v29
    v_exp_f32 v28, v28
    v_exp_f32 v29, v29
    v_mov_b32 v16, v27
    v_fma_f32 v17, v17, v28, v29
    v_cvt_pk_bf16_f32 v29, v29, v29
    v_mul_f32 v12, v12, v28
    v_mul_f32 v13, v13, v28
    v_mul_f32 v14, v14, v28
    v_mul_f32 v15, v15, v28
    v_and_b32_dpp v32, v29, v8 row_newbcast:0 row_mask:0xf bank_mask:0xf
    v_and_b32_dpp v33, v29, v9 row_newbcast:0 row_mask:0xf bank_mask:0xf
    v_and_b32_dpp v34, v29, v10 row_newbcast:0 row_mask:0xf bank_mask:0xf
    v_and_b32_dpp v35, v29, v11 row_newbcast:0 row_mask:0xf bank_mask:0xf
    v_and_b32_dpp v36, v29, v8 row_newbcast:8 row_mask:0xf bank_mask:0xf
    v_and_b32_dpp v37, v29, v9 row_newbcast:8 row_mask:0xf bank_mask:0xf
    v_and_b32_dpp v38, v29, v10 row_newbcast:8 row_mask:0xf bank_mask:0xf
    v_and_b32_dpp v39, v29, v11 row_newbcast:8 row_mask:0xf bank_mask:0xf
    v_and_b32_dpp v40, v29, v8 row_newbcast:4 row_mask:0xf bank_mask:0xf
    v_and_b32_dpp v41, v29, v9 row_newbcast:4 row_mask:0xf bank_mask:0xf
    v_and_b32_dpp v42, v29, v10 row_newbcast:4 row_mask:0xf bank_mask:0xf
    v_and_b32_dpp v43, v29, v11 row_newbcast:4 row_mask:0xf bank_mask:0xf
    v_and_b32_dpp v44, v29, v8 row_newbcast:12 row_mask:0xf bank_mask:0xf
    v_and_b32_dpp v45, v29, v9 row_newbcast:12 row_mask:0xf bank_mask:0xf
    v_and_b32_dpp v46, v29, v10 row_newbcast:12 row_mask:0xf bank_mask:0xf
    v_and_b32_dpp v47, v29, v11 row_newbcast:12 row_mask:0xf bank_mask:0xf
    v_mfma_f32_16x16x32_bf16 v[12:15], v[32:35], a[32:35], v[12:15]
    v_mfma_f32_16x16x32_bf16 v[12:15], v[36:39], a[36:39], v[12:15]
    v_mfma_f32_16x16x32_bf16 v[12:15], v[40:43], a[40:43], v[12:15]
    v_mfma_f32_16x16x32_bf16 v[12:15], v[44:47], a[44:47], v[12:15]
    v_dot2_f32_bf16 v20, v112, v4, 0
    v_dot2_f32_bf16 v21, v116, v4, 0
    v_dot2_f32_bf16 v22, v120, v4, 0
    v_dot2_f32_bf16 v23, v124, v4, 0
    v_dot2_f32_bf16 v20, v113, v5, v20
    v_dot2_f32_bf16 v21, v117, v5, v21
    v_dot2_f32_bf16 v22, v121, v5, v22
    v_dot2_f32_bf16 v23, v125, v5, v23
    v_dot2_f32_bf16 v20, v114, v6, v20
    v_dot2_f32_bf16 v21, v118, v6, v21
    v_dot2_f32_bf16 v22, v122, v6, v22
    v_dot2_f32_bf16 v23, v126, v6, v23
    v_dot2_f32_bf16 v20, v115, v7, v20
    v_dot2_f32_bf16 v21, v119, v7, v21
    v_dot2_f32_bf16 v22, v123, v7, v22
    v_dot2_f32_bf16 v23, v127, v7, v23
    v_add_f32_dpp v24, v20, v20 row_ror:8 row_mask:0xf bank_mask:0x3
    s_nop 0
    v_add_f32_dpp v25, v22, v22 row_ror:8 row_mask:0xf bank_mask:0x3
    v_add_f32_dpp v24, v21, v21 row_ror:8 row_mask:0xf bank_mask:0xc
    v_add_f32_dpp v25, v23, v23 row_ror:8 row_mask:0xf bank_mask:0xc
    s_nop 0
    v_add_f32_dpp v26, v24, v24 row_shl:4 row_mask:0xf bank_mask:0x5
    v_add_f32_dpp v26, v25, v25 row_shr:4 row_mask:0xf bank_mask:0xa
    s_nop 1
    v_add_f32_dpp v26, v26, v26 quad_perm:[1,0,3,2] row_mask:0xf bank_mask:0xf
    s_nop 1
    v_add_f32_dpp v26, v26, v26 quad_perm:[2,3,0,1] row_mask:0xf bank_mask:0xf
    v_cvt_pk_bf16_f32 v26, v26, v26
    v_and_b32 v26, s98, v26
    v_mul_f32 v26, s96, v26
    v_cvt_pk_bf16_f32 v26, v26, v26
    v_and_b32 v26, s98, v26
    s_nop 1
    v_max_f32_dpp v27, v26, v26 row_ror:4 row_mask:0xf bank_mask:0xf
    s_nop 1
    v_max_f32_dpp v27, v27, v27 row_ror:8 row_mask:0xf bank_mask:0xf
    v_mov_b32 v28, v27
    s_nop 1
    v_permlane16_swap_b32 v27, v28
    v_max_f32 v27, v27, v28
    v_mov_b32 v28, v27
    s_nop 1
    v_permlane32_swap_b32 v27, v28
    v_max3_f32 v27, v27, v28, v16
    v_sub_f32 v28, v16, v27
    v_sub_f32 v29, v26, v27
    v_mul_f32 v28, s97, v28
    v_mul_f32 v29, s97, v29
    v_exp_f32 v28, v28
    v_exp_f32 v29, v29
    v_mov_b32 v16, v27
    v_fma_f32 v17, v17, v28, v29
    v_cvt_pk_bf16_f32 v29, v29, v29
    v_mul_f32 v12, v12, v28
    v_mul_f32 v13, v13, v28
    v_mul_f32 v14, v14, v28
    v_mul_f32 v15, v15, v28
    v_and_b32_dpp v32, v29, v8 row_newbcast:0 row_mask:0xf bank_mask:0xf
    v_and_b32_dpp v33, v29, v9 row_newbcast:0 row_mask:0xf bank_mask:0xf
    v_and_b32_dpp v34, v29, v10 row_newbcast:0 row_mask:0xf bank_mask:0xf
    v_and_b32_dpp v35, v29, v11 row_newbcast:0 row_mask:0xf bank_mask:0xf
    v_and_b32_dpp v36, v29, v8 row_newbcast:8 row_mask:0xf bank_mask:0xf
    v_and_b32_dpp v37, v29, v9 row_newbcast:8 row_mask:0xf bank_mask:0xf
    v_and_b32_dpp v38, v29, v10 row_newbcast:8 row_mask:0xf bank_mask:0xf
    v_and_b32_dpp v39, v29, v11 row_newbcast:8 row_mask:0xf bank_mask:0xf
    v_and_b32_dpp v40, v29, v8 row_newbcast:4 row_mask:0xf bank_mask:0xf
    v_and_b32_dpp v41, v29, v9 row_newbcast:4 row_mask:0xf bank_mask:0xf
    v_and_b32_dpp v42, v29, v10 row_newbcast:4 row_mask:0xf bank_mask:0xf
    v_and_b32_dpp v43, v29, v11 row_newbcast:4 row_mask:0xf bank_mask:0xf
    v_and_b32_dpp v44, v29, v8 row_newbcast:12 row_mask:0xf bank_mask:0xf
    v_and_b32_dpp v45, v29, v9 row_newbcast:12 row_mask:0xf bank_mask:0xf
    v_and_b32_dpp v46, v29, v10 row_newbcast:12 row_mask:0xf bank_mask:0xf
    v_and_b32_dpp v47, v29, v11 row_newbcast:12 row_mask:0xf bank_mask:0xf
    v_mfma_f32_16x16x32_bf16 v[12:15], v[32:35], a[48:51], v[12:15]
    v_mfma_f32_16x16x32_bf16 v[12:15], v[36:39], a[52:55], v[12:15]
    v_mfma_f32_16x16x32_bf16 v[12:15], v[40:43], a[56:59], v[12:15]
    v_mfma_f32_16x16x32_bf16 v[12:15], v[44:47], a[60:63], v[12:15]
    v_dot2_f32_bf16 v20, v128, v4, 0
    v_dot2_f32_bf16 v21, v132, v4, 0
    v_dot2_f32_bf16 v22, v136, v4, 0
    v_dot2_f32_bf16 v23, v140, v4, 0
    v_dot2_f32_bf16 v20, v129, v5, v20
    v_dot2_f32_bf16 v21, v133, v5, v21
    v_dot2_f32_bf16 v22, v137, v5, v22
    v_dot2_f32_bf16 v23, v141, v5, v23
    v_dot2_f32_bf16 v20, v130, v6, v20
    v_dot2_f32_bf16 v21, v134, v6, v21
    v_dot2_f32_bf16 v22, v138, v6, v22
    v_dot2_f32_bf16 v23, v142, v6, v23
    v_dot2_f32_bf16 v20, v131, v7, v20
    v_dot2_f32_bf16 v21, v135, v7, v21
    v_dot2_f32_bf16 v22, v139, v7, v22
    v_dot2_f32_bf16 v23, v143, v7, v23
    v_add_f32_dpp v24, v20, v20 row_ror:8 row_mask:0xf bank_mask:0x3
    s_nop 0
    v_add_f32_dpp v25, v22, v22 row_ror:8 row_mask:0xf bank_mask:0x3
    v_add_f32_dpp v24, v21, v21 row_ror:8 row_mask:0xf bank_mask:0xc
    v_add_f32_dpp v25, v23, v23 row_ror:8 row_mask:0xf bank_mask:0xc
    s_nop 0
    v_add_f32_dpp v26, v24, v24 row_shl:4 row_mask:0xf bank_mask:0x5
    v_add_f32_dpp v26, v25, v25 row_shr:4 row_mask:0xf bank_mask:0xa
    s_nop 1
    v_add_f32_dpp v26, v26, v26 quad_perm:[1,0,3,2] row_mask:0xf bank_mask:0xf
    s_nop 1
    v_add_f32_dpp v26, v26, v26 quad_perm:[2,3,0,1] row_mask:0xf bank_mask:0xf
    v_cvt_pk_bf16_f32 v26, v26, v26
    v_and_b32 v26, s98, v26
    v_mul_f32 v26, s96, v26
    v_cvt_pk_bf16_f32 v26, v26, v26
    v_and_b32 v26, s98, v26
    s_nop 1
    v_max_f32_dpp v27, v26, v26 row_ror:4 row_mask:0xf bank_mask:0xf
    s_nop 1
    v_max_f32_dpp v27, v27, v27 row_ror:8 row_mask:0xf bank_mask:0xf
    v_mov_b32 v28, v27
    s_nop 1
    v_permlane16_swap_b32 v27, v28
    v_max_f32 v27, v27, v28
    v_mov_b32 v28, v27
    s_nop 1
    v_permlane32_swap_b32 v27, v28
    v_max3_f32 v27, v27, v28, v16
    v_sub_f32 v28, v16, v27
    v_sub_f32 v29, v26, v27
    v_mul_f32 v28, s97, v28
    v_mul_f32 v29, s97, v29
    v_exp_f32 v28, v28
    v_exp_f32 v29, v29
    v_mov_b32 v16, v27
    v_fma_f32 v17, v17, v28, v29
    v_cvt_pk_bf16_f32 v29, v29, v29
    v_mul_f32 v12, v12, v28
    v_mul_f32 v13, v13, v28
    v_mul_f32 v14, v14, v28
    v_mul_f32 v15, v15, v28
    v_and_b32_dpp v32, v29, v8 row_newbcast:0 row_mask:0xf bank_mask:0xf
    v_and_b32_dpp v33, v29, v9 row_newbcast:0 row_mask:0xf bank_mask:0xf
    v_and_b32_dpp v34, v29, v10 row_newbcast:0 row_mask:0xf bank_mask:0xf
    v_and_b32_dpp v35, v29, v11 row_newbcast:0 row_mask:0xf bank_mask:0xf
    v_and_b32_dpp v36, v29, v8 row_newbcast:8 row_mask:0xf bank_mask:0xf
    v_and_b32_dpp v37, v29, v9 row_newbcast:8 row_mask:0xf bank_mask:0xf
    v_and_b32_dpp v38, v29, v10 row_newbcast:8 row_mask:0xf bank_mask:0xf
    v_and_b32_dpp v39, v29, v11 row_newbcast:8 row_mask:0xf bank_mask:0xf
    v_and_b32_dpp v40, v29, v8 row_newbcast:4 row_mask:0xf bank_mask:0xf
    v_and_b32_dpp v41, v29, v9 row_newbcast:4 row_mask:0xf bank_mask:0xf
    v_and_b32_dpp v42, v29, v10 row_newbcast:4 row_mask:0xf bank_mask:0xf
    v_and_b32_dpp v43, v29, v11 row_newbcast:4 row_mask:0xf bank_mask:0xf
    v_and_b32_dpp v44, v29, v8 row_newbcast:12 row_mask:0xf bank_mask:0xf
    v_and_b32_dpp v45, v29, v9 row_newbcast:12 row_mask:0xf bank_mask:0xf
    v_and_b32_dpp v46, v29, v10 row_newbcast:12 row_mask:0xf bank_mask:0xf
    v_and_b32_dpp v47, v29, v11 row_newbcast:12 row_mask:0xf bank_mask:0xf
    v_mfma_f32_16x16x32_bf16 v[12:15], v[32:35], a[64:67], v[12:15]
    v_mfma_f32_16x16x32_bf16 v[12:15], v[36:39], a[68:71], v[12:15]
    v_mfma_f32_16x16x32_bf16 v[12:15], v[40:43], a[72:75], v[12:15]
    v_mfma_f32_16x16x32_bf16 v[12:15], v[44:47], a[76:79], v[12:15]
    v_dot2_f32_bf16 v20, v144, v4, 0
    v_dot2_f32_bf16 v21, v148, v4, 0
    v_dot2_f32_bf16 v22, v152, v4, 0
    v_dot2_f32_bf16 v23, v156, v4, 0
    v_dot2_f32_bf16 v20, v145, v5, v20
    v_dot2_f32_bf16 v21, v149, v5, v21
    v_dot2_f32_bf16 v22, v153, v5, v22
    v_dot2_f32_bf16 v23, v157, v5, v23
    v_dot2_f32_bf16 v20, v146, v6, v20
    v_dot2_f32_bf16 v21, v150, v6, v21
    v_dot2_f32_bf16 v22, v154, v6, v22
    v_dot2_f32_bf16 v23, v158, v6, v23
    v_dot2_f32_bf16 v20, v147, v7, v20
    v_dot2_f32_bf16 v21, v151, v7, v21
    v_dot2_f32_bf16 v22, v155, v7, v22
    v_dot2_f32_bf16 v23, v159, v7, v23
    v_add_f32_dpp v24, v20, v20 row_ror:8 row_mask:0xf bank_mask:0x3
    s_nop 0
    v_add_f32_dpp v25, v22, v22 row_ror:8 row_mask:0xf bank_mask:0x3
    v_add_f32_dpp v24, v21, v21 row_ror:8 row_mask:0xf bank_mask:0xc
    v_add_f32_dpp v25, v23, v23 row_ror:8 row_mask:0xf bank_mask:0xc
    s_nop 0
    v_add_f32_dpp v26, v24, v24 row_shl:4 row_mask:0xf bank_mask:0x5
    v_add_f32_dpp v26, v25, v25 row_shr:4 row_mask:0xf bank_mask:0xa
    s_nop 1
    v_add_f32_dpp v26, v26, v26 quad_perm:[1,0,3,2] row_mask:0xf bank_mask:0xf
    s_nop 1
    v_add_f32_dpp v26, v26, v26 quad_perm:[2,3,0,1] row_mask:0xf bank_mask:0xf
    v_cvt_pk_bf16_f32 v26, v26, v26
    v_and_b32 v26, s98, v26
    v_mul_f32 v26, s96, v26
    v_cvt_pk_bf16_f32 v26, v26, v26
    v_and_b32 v26, s98, v26
    s_nop 1
    v_max_f32_dpp v27, v26, v26 row_ror:4 row_mask:0xf bank_mask:0xf
    s_nop 1
    v_max_f32_dpp v27, v27, v27 row_ror:8 row_mask:0xf bank_mask:0xf
    v_mov_b32 v28, v27
    s_nop 1
    v_permlane16_swap_b32 v27, v28
    v_max_f32 v27, v27, v28
    v_mov_b32 v28, v27
    s_nop 1
    v_permlane32_swap_b32 v27, v28
    v_max3_f32 v27, v27, v28, v16
    v_sub_f32 v28, v16, v27
    v_sub_f32 v29, v26, v27
    v_mul_f32 v28, s97, v28
    v_mul_f32 v29, s97, v29
    v_exp_f32 v28, v28
    v_exp_f32 v29, v29
    v_mov_b32 v16, v27
    v_fma_f32 v17, v17, v28, v29
    v_cvt_pk_bf16_f32 v29, v29, v29
    v_mul_f32 v12, v12, v28
    v_mul_f32 v13, v13, v28
    v_mul_f32 v14, v14, v28
    v_mul_f32 v15, v15, v28
    v_and_b32_dpp v32, v29, v8 row_newbcast:0 row_mask:0xf bank_mask:0xf
    v_and_b32_dpp v33, v29, v9 row_newbcast:0 row_mask:0xf bank_mask:0xf
    v_and_b32_dpp v34, v29, v10 row_newbcast:0 row_mask:0xf bank_mask:0xf
    v_and_b32_dpp v35, v29, v11 row_newbcast:0 row_mask:0xf bank_mask:0xf
    v_and_b32_dpp v36, v29, v8 row_newbcast:8 row_mask:0xf bank_mask:0xf
    v_and_b32_dpp v37, v29, v9 row_newbcast:8 row_mask:0xf bank_mask:0xf
    v_and_b32_dpp v38, v29, v10 row_newbcast:8 row_mask:0xf bank_mask:0xf
    v_and_b32_dpp v39, v29, v11 row_newbcast:8 row_mask:0xf bank_mask:0xf
    v_and_b32_dpp v40, v29, v8 row_newbcast:4 row_mask:0xf bank_mask:0xf
    v_and_b32_dpp v41, v29, v9 row_newbcast:4 row_mask:0xf bank_mask:0xf
    v_and_b32_dpp v42, v29, v10 row_newbcast:4 row_mask:0xf bank_mask:0xf
    v_and_b32_dpp v43, v29, v11 row_newbcast:4 row_mask:0xf bank_mask:0xf
    v_and_b32_dpp v44, v29, v8 row_newbcast:12 row_mask:0xf bank_mask:0xf
    v_and_b32_dpp v45, v29, v9 row_newbcast:12 row_mask:0xf bank_mask:0xf
    v_and_b32_dpp v46, v29, v10 row_newbcast:12 row_mask:0xf bank_mask:0xf
    v_and_b32_dpp v47, v29, v11 row_newbcast:12 row_mask:0xf bank_mask:0xf
    v_mfma_f32_16x16x32_bf16 v[12:15], v[32:35], a[80:83], v[12:15]
    v_mfma_f32_16x16x32_bf16 v[12:15], v[36:39], a[84:87], v[12:15]
    v_mfma_f32_16x16x32_bf16 v[12:15], v[40:43], a[88:91], v[12:15]
    v_mfma_f32_16x16x32_bf16 v[12:15], v[44:47], a[92:95], v[12:15]
    v_dot2_f32_bf16 v20, v160, v4, 0
    v_dot2_f32_bf16 v21, v164, v4, 0
    v_dot2_f32_bf16 v22, v168, v4, 0
    v_dot2_f32_bf16 v23, v172, v4, 0
    v_dot2_f32_bf16 v20, v161, v5, v20
    v_dot2_f32_bf16 v21, v165, v5, v21
    v_dot2_f32_bf16 v22, v169, v5, v22
    v_dot2_f32_bf16 v23, v173, v5, v23
    v_dot2_f32_bf16 v20, v162, v6, v20
    v_dot2_f32_bf16 v21, v166, v6, v21
    v_dot2_f32_bf16 v22, v170, v6, v22
    v_dot2_f32_bf16 v23, v174, v6, v23
    v_dot2_f32_bf16 v20, v163, v7, v20
    v_dot2_f32_bf16 v21, v167, v7, v21
    v_dot2_f32_bf16 v22, v171, v7, v22
    v_dot2_f32_bf16 v23, v175, v7, v23
    v_add_f32_dpp v24, v20, v20 row_ror:8 row_mask:0xf bank_mask:0x3
    s_nop 0
    v_add_f32_dpp v25, v22, v22 row_ror:8 row_mask:0xf bank_mask:0x3
    v_add_f32_dpp v24, v21, v21 row_ror:8 row_mask:0xf bank_mask:0xc
    v_add_f32_dpp v25, v23, v23 row_ror:8 row_mask:0xf bank_mask:0xc
    s_nop 0
    v_add_f32_dpp v26, v24, v24 row_shl:4 row_mask:0xf bank_mask:0x5
    v_add_f32_dpp v26, v25, v25 row_shr:4 row_mask:0xf bank_mask:0xa
    s_nop 1
    v_add_f32_dpp v26, v26, v26 quad_perm:[1,0,3,2] row_mask:0xf bank_mask:0xf
    s_nop 1
    v_add_f32_dpp v26, v26, v26 quad_perm:[2,3,0,1] row_mask:0xf bank_mask:0xf
    v_cvt_pk_bf16_f32 v26, v26, v26
    v_and_b32 v26, s98, v26
    v_mul_f32 v26, s96, v26
    v_cvt_pk_bf16_f32 v26, v26, v26
    v_and_b32 v26, s98, v26
    s_nop 1
    v_max_f32_dpp v27, v26, v26 row_ror:4 row_mask:0xf bank_mask:0xf
    s_nop 1
    v_max_f32_dpp v27, v27, v27 row_ror:8 row_mask:0xf bank_mask:0xf
    v_mov_b32 v28, v27
    s_nop 1
    v_permlane16_swap_b32 v27, v28
    v_max_f32 v27, v27, v28
    v_mov_b32 v28, v27
    s_nop 1
    v_permlane32_swap_b32 v27, v28
    v_max3_f32 v27, v27, v28, v16
    v_sub_f32 v28, v16, v27
    v_sub_f32 v29, v26, v27
    v_mul_f32 v28, s97, v28
    v_mul_f32 v29, s97, v29
    v_exp_f32 v28, v28
    v_exp_f32 v29, v29
    v_mov_b32 v16, v27
    v_fma_f32 v17, v17, v28, v29
    v_cvt_pk_bf16_f32 v29, v29, v29
    v_mul_f32 v12, v12, v28
    v_mul_f32 v13, v13, v28
    v_mul_f32 v14, v14, v28
    v_mul_f32 v15, v15, v28
    v_and_b32_dpp v32, v29, v8 row_newbcast:0 row_mask:0xf bank_mask:0xf
    v_and_b32_dpp v33, v29, v9 row_newbcast:0 row_mask:0xf bank_mask:0xf
    v_and_b32_dpp v34, v29, v10 row_newbcast:0 row_mask:0xf bank_mask:0xf
    v_and_b32_dpp v35, v29, v11 row_newbcast:0 row_mask:0xf bank_mask:0xf
    v_and_b32_dpp v36, v29, v8 row_newbcast:8 row_mask:0xf bank_mask:0xf
    v_and_b32_dpp v37, v29, v9 row_newbcast:8 row_mask:0xf bank_mask:0xf
    v_and_b32_dpp v38, v29, v10 row_newbcast:8 row_mask:0xf bank_mask:0xf
    v_and_b32_dpp v39, v29, v11 row_newbcast:8 row_mask:0xf bank_mask:0xf
    v_and_b32_dpp v40, v29, v8 row_newbcast:4 row_mask:0xf bank_mask:0xf
    v_and_b32_dpp v41, v29, v9 row_newbcast:4 row_mask:0xf bank_mask:0xf
    v_and_b32_dpp v42, v29, v10 row_newbcast:4 row_mask:0xf bank_mask:0xf
    v_and_b32_dpp v43, v29, v11 row_newbcast:4 row_mask:0xf bank_mask:0xf
    v_and_b32_dpp v44, v29, v8 row_newbcast:12 row_mask:0xf bank_mask:0xf
    v_and_b32_dpp v45, v29, v9 row_newbcast:12 row_mask:0xf bank_mask:0xf
    v_and_b32_dpp v46, v29, v10 row_newbcast:12 row_mask:0xf bank_mask:0xf
    v_and_b32_dpp v47, v29, v11 row_newbcast:12 row_mask:0xf bank_mask:0xf
    v_mfma_f32_16x16x32_bf16 v[12:15], v[32:35], a[96:99], v[12:15]
    v_mfma_f32_16x16x32_bf16 v[12:15], v[36:39], a[100:103], v[12:15]
    v_mfma_f32_16x16x32_bf16 v[12:15], v[40:43], a[104:107], v[12:15]
    v_mfma_f32_16x16x32_bf16 v[12:15], v[44:47], a[108:111], v[12:15]
    s_branch L_aback0
L_aext1:
    v_dot2_f32_bf16 v20, v176, v4, 0
    v_dot2_f32_bf16 v21, v180, v4, 0
    v_dot2_f32_bf16 v22, v184, v4, 0
    v_dot2_f32_bf16 v23, v188, v4, 0
    v_dot2_f32_bf16 v20, v177, v5, v20
    v_dot2_f32_bf16 v21, v181, v5, v21
    v_dot2_f32_bf16 v22, v185, v5, v22
    v_dot2_f32_bf16 v23, v189, v5, v23
    v_dot2_f32_bf16 v20, v178, v6, v20
    v_dot2_f32_bf16 v21, v182, v6, v21
    v_dot2_f32_bf16 v22, v186, v6, v22
    v_dot2_f32_bf16 v23, v190, v6, v23
    v_dot2_f32_bf16 v20, v179, v7, v20
    v_dot2_f32_bf16 v21, v183, v7, v21
    v_dot2_f32_bf16 v22, v187, v7, v22
    v_dot2_f32_bf16 v23, v191, v7, v23
    v_add_f32_dpp v24, v20, v20 row_ror:8 row_mask:0xf bank_mask:0x3
    s_nop 0
    v_add_f32_dpp v25, v22, v22 row_ror:8 row_mask:0xf bank_mask:0x3
    v_add_f32_dpp v24, v21, v21 row_ror:8 row_mask:0xf bank_mask:0xc
    v_add_f32_dpp v25, v23, v23 row_ror:8 row_mask:0xf bank_mask:0xc
    s_nop 0
    v_add_f32_dpp v26, v24, v24 row_shl:4 row_mask:0xf bank_mask:0x5
    v_add_f32_dpp v26, v25, v25 row_shr:4 row_mask:0xf bank_mask:0xa
    s_nop 1
    v_add_f32_dpp v26, v26, v26 quad_perm:[1,0,3,2] row_mask:0xf bank_mask:0xf
    s_nop 1
    v_add_f32_dpp v26, v26, v26 quad_perm:[2,3,0,1] row_mask:0xf bank_mask:0xf
    v_cvt_pk_bf16_f32 v26, v26, v26
    v_and_b32 v26, s98, v26
    v_mul_f32 v26, s96, v26
    v_cvt_pk_bf16_f32 v26, v26, v26
    v_and_b32 v26, s98, v26
    s_nop 1
    v_max_f32_dpp v27, v26, v26 row_ror:4 row_mask:0xf bank_mask:0xf
    s_nop 1
    v_max_f32_dpp v27, v27, v27 row_ror:8 row_mask:0xf bank_mask:0xf
    v_mov_b32 v28, v27
    s_nop 1
    v_permlane16_swap_b32 v27, v28
    v_max_f32 v27, v27, v28
    v_mov_b32 v28, v27
    s_nop 1
    v_permlane32_swap_b32 v27, v28
    v_max3_f32 v27, v27, v28, v16
    v_sub_f32 v28, v16, v27
    v_sub_f32 v29, v26, v27
    v_mul_f32 v28, s97, v28
    v_mul_f32 v29, s97, v29
    v_exp_f32 v28, v28
    v_exp_f32 v29, v29
    v_mov_b32 v16, v27
    v_fma_f32 v17, v17, v28, v29
    v_cvt_pk_bf16_f32 v29, v29, v29
    v_mul_f32 v12, v12, v28
    v_mul_f32 v13, v13, v28
    v_mul_f32 v14, v14, v28
    v_mul_f32 v15, v15, v28
    v_and_b32_dpp v32, v29, v8 row_newbcast:0 row_mask:0xf bank_mask:0xf
    v_and_b32_dpp v33, v29, v9 row_newbcast:0 row_mask:0xf bank_mask:0xf
    v_and_b32_dpp v34, v29, v10 row_newbcast:0 row_mask:0xf bank_mask:0xf
    v_and_b32_dpp v35, v29, v11 row_newbcast:0 row_mask:0xf bank_mask:0xf
    v_and_b32_dpp v36, v29, v8 row_newbcast:8 row_mask:0xf bank_mask:0xf
    v_and_b32_dpp v37, v29, v9 row_newbcast:8 row_mask:0xf bank_mask:0xf
    v_and_b32_dpp v38, v29, v10 row_newbcast:8 row_mask:0xf bank_mask:0xf
    v_and_b32_dpp v39, v29, v11 row_newbcast:8 row_mask:0xf bank_mask:0xf
    v_and_b32_dpp v40, v29, v8 row_newbcast:4 row_mask:0xf bank_mask:0xf
    v_and_b32_dpp v41, v29, v9 row_newbcast:4 row_mask:0xf bank_mask:0xf
    v_and_b32_dpp v42, v29, v10 row_newbcast:4 row_mask:0xf bank_mask:0xf
    v_and_b32_dpp v43, v29, v11 row_newbcast:4 row_mask:0xf bank_mask:0xf
    v_and_b32_dpp v44, v29, v8 row_newbcast:12 row_mask:0xf bank_mask:0xf
    v_and_b32_dpp v45, v29, v9 row_newbcast:12 row_mask:0xf bank_mask:0xf
    v_and_b32_dpp v46, v29, v10 row_newbcast:12 row_mask:0xf bank_mask:0xf
    v_and_b32_dpp v47, v29, v11 row_newbcast:12 row_mask:0xf bank_mask:0xf
    v_mfma_f32_16x16x32_bf16 v[12:15], v[32:35], a[112:115], v[12:15]
    v_mfma_f32_16x16x32_bf16 v[12:15], v[36:39], a[116:119], v[12:15]
    v_mfma_f32_16x16x32_bf16 v[12:15], v[40:43], a[120:123], v[12:15]
    v_mfma_f32_16x16x32_bf16 v[12:15], v[44:47], a[124:127], v[12:15]
    v_dot2_f32_bf16 v20, v192, v4, 0
    v_dot2_f32_bf16 v21, v196, v4, 0
    v_dot2_f32_bf16 v22, v200, v4, 0
    v_dot2_f32_bf16 v23, v204, v4, 0
    v_dot2_f32_bf16 v20, v193, v5, v20
    v_dot2_f32_bf16 v21, v197, v5, v21
    v_dot2_f32_bf16 v22, v201, v5, v22
    v_dot2_f32_bf16 v23, v205, v5, v23
    v_dot2_f32_bf16 v20, v194, v6, v20
    v_dot2_f32_bf16 v21, v198, v6, v21
    v_dot2_f32_bf16 v22, v202, v6, v22
    v_dot2_f32_bf16 v23, v206, v6, v23
    v_dot2_f32_bf16 v20, v195, v7, v20
    v_dot2_f32_bf16 v21, v199, v7, v21
    v_dot2_f32_bf16 v22, v203, v7, v22
    v_dot2_f32_bf16 v23, v207, v7, v23
    v_add_f32_dpp v24, v20, v20 row_ror:8 row_mask:0xf bank_mask:0x3
    s_nop 0
    v_add_f32_dpp v25, v22, v22 row_ror:8 row_mask:0xf bank_mask:0x3
    v_add_f32_dpp v24, v21, v21 row_ror:8 row_mask:0xf bank_mask:0xc
    v_add_f32_dpp v25, v23, v23 row_ror:8 row_mask:0xf bank_mask:0xc
    s_nop 0
    v_add_f32_dpp v26, v24, v24 row_shl:4 row_mask:0xf bank_mask:0x5
    v_add_f32_dpp v26, v25, v25 row_shr:4 row_mask:0xf bank_mask:0xa
    s_nop 1
    v_add_f32_dpp v26, v26, v26 quad_perm:[1,0,3,2] row_mask:0xf bank_mask:0xf
    s_nop 1
    v_add_f32_dpp v26, v26, v26 quad_perm:[2,3,0,1] row_mask:0xf bank_mask:0xf
    v_cvt_pk_bf16_f32 v26, v26, v26
    v_and_b32 v26, s98, v26
    v_mul_f32 v26, s96, v26
    v_cvt_pk_bf16_f32 v26, v26, v26
    v_and_b32 v26, s98, v26
    s_nop 1
    v_max_f32_dpp v27, v26, v26 row_ror:4 row_mask:0xf bank_mask:0xf
    s_nop 1
    v_max_f32_dpp v27, v27, v27 row_ror:8 row_mask:0xf bank_mask:0xf
    v_mov_b32 v28, v27
    s_nop 1
    v_permlane16_swap_b32 v27, v28
    v_max_f32 v27, v27, v28
    v_mov_b32 v28, v27
    s_nop 1
    v_permlane32_swap_b32 v27, v28
    v_max3_f32 v27, v27, v28, v16
    v_sub_f32 v28, v16, v27
    v_sub_f32 v29, v26, v27
    v_mul_f32 v28, s97, v28
    v_mul_f32 v29, s97, v29
    v_exp_f32 v28, v28
    v_exp_f32 v29, v29
    v_mov_b32 v16, v27
    v_fma_f32 v17, v17, v28, v29
    v_cvt_pk_bf16_f32 v29, v29, v29
    v_mul_f32 v12, v12, v28
    v_mul_f32 v13, v13, v28
    v_mul_f32 v14, v14, v28
    v_mul_f32 v15, v15, v28
    v_and_b32_dpp v32, v29, v8 row_newbcast:0 row_mask:0xf bank_mask:0xf
    v_and_b32_dpp v33, v29, v9 row_newbcast:0 row_mask:0xf bank_mask:0xf
    v_and_b32_dpp v34, v29, v10 row_newbcast:0 row_mask:0xf bank_mask:0xf
    v_and_b32_dpp v35, v29, v11 row_newbcast:0 row_mask:0xf bank_mask:0xf
    v_and_b32_dpp v36, v29, v8 row_newbcast:8 row_mask:0xf bank_mask:0xf
    v_and_b32_dpp v37, v29, v9 row_newbcast:8 row_mask:0xf bank_mask:0xf
    v_and_b32_dpp v38, v29, v10 row_newbcast:8 row_mask:0xf bank_mask:0xf
    v_and_b32_dpp v39, v29, v11 row_newbcast:8 row_mask:0xf bank_mask:0xf
    v_and_b32_dpp v40, v29, v8 row_newbcast:4 row_mask:0xf bank_mask:0xf
    v_and_b32_dpp v41, v29, v9 row_newbcast:4 row_mask:0xf bank_mask:0xf
    v_and_b32_dpp v42, v29, v10 row_newbcast:4 row_mask:0xf bank_mask:0xf
    v_and_b32_dpp v43, v29, v11 row_newbcast:4 row_mask:0xf bank_mask:0xf
    v_and_b32_dpp v44, v29, v8 row_newbcast:12 row_mask:0xf bank_mask:0xf
    v_and_b32_dpp v45, v29, v9 row_newbcast:12 row_mask:0xf bank_mask:0xf
    v_and_b32_dpp v46, v29, v10 row_newbcast:12 row_mask:0xf bank_mask:0xf
    v_and_b32_dpp v47, v29, v11 row_newbcast:12 row_mask:0xf bank_mask:0xf
    v_mfma_f32_16x16x32_bf16 v[12:15], v[32:35], a[128:131], v[12:15]
    v_mfma_f32_16x16x32_bf16 v[12:15], v[36:39], a[132:135], v[12:15]
    v_mfma_f32_16x16x32_bf16 v[12:15], v[40:43], a[136:139], v[12:15]
    v_mfma_f32_16x16x32_bf16 v[12:15], v[44:47], a[140:143], v[12:15]
    v_dot2_f32_bf16 v20, v208, v4, 0
    v_dot2_f32_bf16 v21, v212, v4, 0
    v_dot2_f32_bf16 v22, v216, v4, 0
    v_dot2_f32_bf16 v23, v220, v4, 0
    v_dot2_f32_bf16 v20, v209, v5, v20
    v_dot2_f32_bf16 v21, v213, v5, v21
    v_dot2_f32_bf16 v22, v217, v5, v22
    v_dot2_f32_bf16 v23, v221, v5, v23
    v_dot2_f32_bf16 v20, v210, v6, v20
    v_dot2_f32_bf16 v21, v214, v6, v21
    v_dot2_f32_bf16 v22, v218, v6, v22
    v_dot2_f32_bf16 v23, v222, v6, v23
    v_dot2_f32_bf16 v20, v211, v7, v20
    v_dot2_f32_bf16 v21, v215, v7, v21
    v_dot2_f32_bf16 v22, v219, v7, v22
    v_dot2_f32_bf16 v23, v223, v7, v23
    v_add_f32_dpp v24, v20, v20 row_ror:8 row_mask:0xf bank_mask:0x3
    s_nop 0
    v_add_f32_dpp v25, v22, v22 row_ror:8 row_mask:0xf bank_mask:0x3
    v_add_f32_dpp v24, v21, v21 row_ror:8 row_mask:0xf bank_mask:0xc
    v_add_f32_dpp v25, v23, v23 row_ror:8 row_mask:0xf bank_mask:0xc
    s_nop 0
    v_add_f32_dpp v26, v24, v24 row_shl:4 row_mask:0xf bank_mask:0x5
    v_add_f32_dpp v26, v25, v25 row_shr:4 row_mask:0xf bank_mask:0xa
    s_nop 1
    v_add_f32_dpp v26, v26, v26 quad_perm:[1,0,3,2] row_mask:0xf bank_mask:0xf
    s_nop 1
    v_add_f32_dpp v26, v26, v26 quad_perm:[2,3,0,1] row_mask:0xf bank_mask:0xf
    v_cvt_pk_bf16_f32 v26, v26, v26
    v_and_b32 v26, s98, v26
    v_mul_f32 v26, s96, v26
    v_cvt_pk_bf16_f32 v26, v26, v26
    v_and_b32 v26, s98, v26
    s_nop 1
    v_max_f32_dpp v27, v26, v26 row_ror:4 row_mask:0xf bank_mask:0xf
    s_nop 1
    v_max_f32_dpp v27, v27, v27 row_ror:8 row_mask:0xf bank_mask:0xf
    v_mov_b32 v28, v27
    s_nop 1
    v_permlane16_swap_b32 v27, v28
    v_max_f32 v27, v27, v28
    v_mov_b32 v28, v27
    s_nop 1
    v_permlane32_swap_b32 v27, v28
    v_max3_f32 v27, v27, v28, v16
    v_sub_f32 v28, v16, v27
    v_sub_f32 v29, v26, v27
    v_mul_f32 v28, s97, v28
    v_mul_f32 v29, s97, v29
    v_exp_f32 v28, v28
    v_exp_f32 v29, v29
    v_mov_b32 v16, v27
    v_fma_f32 v17, v17, v28, v29
    v_cvt_pk_bf16_f32 v29, v29, v29
    v_mul_f32 v12, v12, v28
    v_mul_f32 v13, v13, v28
    v_mul_f32 v14, v14, v28
    v_mul_f32 v15, v15, v28
    v_and_b32_dpp v32, v29, v8 row_newbcast:0 row_mask:0xf bank_mask:0xf
    v_and_b32_dpp v33, v29, v9 row_newbcast:0 row_mask:0xf bank_mask:0xf
    v_and_b32_dpp v34, v29, v10 row_newbcast:0 row_mask:0xf bank_mask:0xf
    v_and_b32_dpp v35, v29, v11 row_newbcast:0 row_mask:0xf bank_mask:0xf
    v_and_b32_dpp v36, v29, v8 row_newbcast:8 row_mask:0xf bank_mask:0xf
    v_and_b32_dpp v37, v29, v9 row_newbcast:8 row_mask:0xf bank_mask:0xf
    v_and_b32_dpp v38, v29, v10 row_newbcast:8 row_mask:0xf bank_mask:0xf
    v_and_b32_dpp v39, v29, v11 row_newbcast:8 row_mask:0xf bank_mask:0xf
    v_and_b32_dpp v40, v29, v8 row_newbcast:4 row_mask:0xf bank_mask:0xf
    v_and_b32_dpp v41, v29, v9 row_newbcast:4 row_mask:0xf bank_mask:0xf
    v_and_b32_dpp v42, v29, v10 row_newbcast:4 row_mask:0xf bank_mask:0xf
    v_and_b32_dpp v43, v29, v11 row_newbcast:4 row_mask:0xf bank_mask:0xf
    v_and_b32_dpp v44, v29, v8 row_newbcast:12 row_mask:0xf bank_mask:0xf
    v_and_b32_dpp v45, v29, v9 row_newbcast:12 row_mask:0xf bank_mask:0xf
    v_and_b32_dpp v46, v29, v10 row_newbcast:12 row_mask:0xf bank_mask:0xf
    v_and_b32_dpp v47, v29, v11 row_newbcast:12 row_mask:0xf bank_mask:0xf
    v_mfma_f32_16x16x32_bf16 v[12:15], v[32:35], a[144:147], v[12:15]
    v_mfma_f32_16x16x32_bf16 v[12:15], v[36:39], a[148:151], v[12:15]
    v_mfma_f32_16x16x32_bf16 v[12:15], v[40:43], a[152:155], v[12:15]
    v_mfma_f32_16x16x32_bf16 v[12:15], v[44:47], a[156:159], v[12:15]
    v_dot2_f32_bf16 v20, v224, v4, 0
    v_dot2_f32_bf16 v21, v228, v4, 0
    v_dot2_f32_bf16 v22, v232, v4, 0
    v_dot2_f32_bf16 v23, v236, v4, 0
    v_dot2_f32_bf16 v20, v225, v5, v20
    v_dot2_f32_bf16 v21, v229, v5, v21
    v_dot2_f32_bf16 v22, v233, v5, v22
    v_dot2_f32_bf16 v23, v237, v5, v23
    v_dot2_f32_bf16 v20, v226, v6, v20
    v_dot2_f32_bf16 v21, v230, v6, v21
    v_dot2_f32_bf16 v22, v234, v6, v22
    v_dot2_f32_bf16 v23, v238, v6, v23
    v_dot2_f32_bf16 v20, v227, v7, v20
    v_dot2_f32_bf16 v21, v231, v7, v21
    v_dot2_f32_bf16 v22, v235, v7, v22
    v_dot2_f32_bf16 v23, v239, v7, v23
    v_add_f32_dpp v24, v20, v20 row_ror:8 row_mask:0xf bank_mask:0x3
    s_nop 0
    v_add_f32_dpp v25, v22, v22 row_ror:8 row_mask:0xf bank_mask:0x3
    v_add_f32_dpp v24, v21, v21 row_ror:8 row_mask:0xf bank_mask:0xc
    v_add_f32_dpp v25, v23, v23 row_ror:8 row_mask:0xf bank_mask:0xc
    s_nop 0
    v_add_f32_dpp v26, v24, v24 row_shl:4 row_mask:0xf bank_mask:0x5
    v_add_f32_dpp v26, v25, v25 row_shr:4 row_mask:0xf bank_mask:0xa
    s_nop 1
    v_add_f32_dpp v26, v26, v26 quad_perm:[1,0,3,2] row_mask:0xf bank_mask:0xf
    s_nop 1
    v_add_f32_dpp v26, v26, v26 quad_perm:[2,3,0,1] row_mask:0xf bank_mask:0xf
    v_cvt_pk_bf16_f32 v26, v26, v26
    v_and_b32 v26, s98, v26
    v_mul_f32 v26, s96, v26
    v_cvt_pk_bf16_f32 v26, v26, v26
    v_and_b32 v26, s98, v26
    s_nop 1
    v_max_f32_dpp v27, v26, v26 row_ror:4 row_mask:0xf bank_mask:0xf
    s_nop 1
    v_max_f32_dpp v27, v27, v27 row_ror:8 row_mask:0xf bank_mask:0xf
    v_mov_b32 v28, v27
    s_nop 1
    v_permlane16_swap_b32 v27, v28
    v_max_f32 v27, v27, v28
    v_mov_b32 v28, v27
    s_nop 1
    v_permlane32_swap_b32 v27, v28
    v_max3_f32 v27, v27, v28, v16
    v_sub_f32 v28, v16, v27
    v_sub_f32 v29, v26, v27
    v_mul_f32 v28, s97, v28
    v_mul_f32 v29, s97, v29
    v_exp_f32 v28, v28
    v_exp_f32 v29, v29
    v_mov_b32 v16, v27
    v_fma_f32 v17, v17, v28, v29
    v_cvt_pk_bf16_f32 v29, v29, v29
    v_mul_f32 v12, v12, v28
    v_mul_f32 v13, v13, v28
    v_mul_f32 v14, v14, v28
    v_mul_f32 v15, v15, v28
    v_and_b32_dpp v32, v29, v8 row_newbcast:0 row_mask:0xf bank_mask:0xf
    v_and_b32_dpp v33, v29, v9 row_newbcast:0 row_mask:0xf bank_mask:0xf
    v_and_b32_dpp v34, v29, v10 row_newbcast:0 row_mask:0xf bank_mask:0xf
    v_and_b32_dpp v35, v29, v11 row_newbcast:0 row_mask:0xf bank_mask:0xf
    v_and_b32_dpp v36, v29, v8 row_newbcast:8 row_mask:0xf bank_mask:0xf
    v_and_b32_dpp v37, v29, v9 row_newbcast:8 row_mask:0xf bank_mask:0xf
    v_and_b32_dpp v38, v29, v10 row_newbcast:8 row_mask:0xf bank_mask:0xf
    v_and_b32_dpp v39, v29, v11 row_newbcast:8 row_mask:0xf bank_mask:0xf
    v_and_b32_dpp v40, v29, v8 row_newbcast:4 row_mask:0xf bank_mask:0xf
    v_and_b32_dpp v41, v29, v9 row_newbcast:4 row_mask:0xf bank_mask:0xf
    v_and_b32_dpp v42, v29, v10 row_newbcast:4 row_mask:0xf bank_mask:0xf
    v_and_b32_dpp v43, v29, v11 row_newbcast:4 row_mask:0xf bank_mask:0xf
    v_and_b32_dpp v44, v29, v8 row_newbcast:12 row_mask:0xf bank_mask:0xf
    v_and_b32_dpp v45, v29, v9 row_newbcast:12 row_mask:0xf bank_mask:0xf
    v_and_b32_dpp v46, v29, v10 row_newbcast:12 row_mask:0xf bank_mask:0xf
    v_and_b32_dpp v47, v29, v11 row_newbcast:12 row_mask:0xf bank_mask:0xf
    v_mfma_f32_16x16x32_bf16 v[12:15], v[32:35], a[160:163], v[12:15]
    v_mfma_f32_16x16x32_bf16 v[12:15], v[36:39], a[164:167], v[12:15]
    v_mfma_f32_16x16x32_bf16 v[12:15], v[40:43], a[168:171], v[12:15]
    v_mfma_f32_16x16x32_bf16 v[12:15], v[44:47], a[172:175], v[12:15]
    v_dot2_f32_bf16 v20, v240, v4, 0
    v_dot2_f32_bf16 v21, v244, v4, 0
    v_dot2_f32_bf16 v22, v248, v4, 0
    v_dot2_f32_bf16 v23, v252, v4, 0
    v_dot2_f32_bf16 v20, v241, v5, v20
    v_dot2_f32_bf16 v21, v245, v5, v21
    v_dot2_f32_bf16 v22, v249, v5, v22
    v_dot2_f32_bf16 v23, v253, v5, v23
    v_dot2_f32_bf16 v20, v242, v6, v20
    v_dot2_f32_bf16 v21, v246, v6, v21
    v_dot2_f32_bf16 v22, v250, v6, v22
    v_dot2_f32_bf16 v23, v254, v6, v23
    v_dot2_f32_bf16 v20, v243, v7, v20
    v_dot2_f32_bf16 v21, v247, v7, v21
    v_dot2_f32_bf16 v22, v251, v7, v22
    v_dot2_f32_bf16 v23, v255, v7, v23
    v_add_f32_dpp v24, v20, v20 row_ror:8 row_mask:0xf bank_mask:0x3
    s_nop 0
    v_add_f32_dpp v25, v22, v22 row_ror:8 row_mask:0xf bank_mask:0x3
    v_add_f32_dpp v24, v21, v21 row_ror:8 row_mask:0xf bank_mask:0xc
    v_add_f32_dpp v25, v23, v23 row_ror:8 row_mask:0xf bank_mask:0xc
    s_nop 0
    v_add_f32_dpp v26, v24, v24 row_shl:4 row_mask:0xf bank_mask:0x5
    v_add_f32_dpp v26, v25, v25 row_shr:4 row_mask:0xf bank_mask:0xa
    s_nop 1
    v_add_f32_dpp v26, v26, v26 quad_perm:[1,0,3,2] row_mask:0xf bank_mask:0xf
    s_nop 1
    v_add_f32_dpp v26, v26, v26 quad_perm:[2,3,0,1] row_mask:0xf bank_mask:0xf
    v_cvt_pk_bf16_f32 v26, v26, v26
    v_and_b32 v26, s98, v26
    v_mul_f32 v26, s96, v26
    v_cvt_pk_bf16_f32 v26, v26, v26
    v_and_b32 v26, s98, v26
    s_nop 1
    v_max_f32_dpp v27, v26, v26 row_ror:4 row_mask:0xf bank_mask:0xf
    s_nop 1
    v_max_f32_dpp v27, v27, v27 row_ror:8 row_mask:0xf bank_mask:0xf
    v_mov_b32 v28, v27
    s_nop 1
    v_permlane16_swap_b32 v27, v28
    v_max_f32 v27, v27, v28
    v_mov_b32 v28, v27
    s_nop 1
    v_permlane32_swap_b32 v27, v28
    v_max3_f32 v27, v27, v28, v16
    v_sub_f32 v28, v16, v27
    v_sub_f32 v29, v26, v27
    v_mul_f32 v28, s97, v28
    v_mul_f32 v29, s97, v29
    v_exp_f32 v28, v28
    v_exp_f32 v29, v29
    v_mov_b32 v16, v27
    v_fma_f32 v17, v17, v28, v29
    v_cvt_pk_bf16_f32 v29, v29, v29
    v_mul_f32 v12, v12, v28
    v_mul_f32 v13, v13, v28
    v_mul_f32 v14, v14, v28
    v_mul_f32 v15, v15, v28
    v_and_b32_dpp v32, v29, v8 row_newbcast:0 row_mask:0xf bank_mask:0xf
    v_and_b32_dpp v33, v29, v9 row_newbcast:0 row_mask:0xf bank_mask:0xf
    v_and_b32_dpp v34, v29, v10 row_newbcast:0 row_mask:0xf bank_mask:0xf
    v_and_b32_dpp v35, v29, v11 row_newbcast:0 row_mask:0xf bank_mask:0xf
    v_and_b32_dpp v36, v29, v8 row_newbcast:8 row_mask:0xf bank_mask:0xf
    v_and_b32_dpp v37, v29, v9 row_newbcast:8 row_mask:0xf bank_mask:0xf
    v_and_b32_dpp v38, v29, v10 row_newbcast:8 row_mask:0xf bank_mask:0xf
    v_and_b32_dpp v39, v29, v11 row_newbcast:8 row_mask:0xf bank_mask:0xf
    v_and_b32_dpp v40, v29, v8 row_newbcast:4 row_mask:0xf bank_mask:0xf
    v_and_b32_dpp v41, v29, v9 row_newbcast:4 row_mask:0xf bank_mask:0xf
    v_and_b32_dpp v42, v29, v10 row_newbcast:4 row_mask:0xf bank_mask:0xf
    v_and_b32_dpp v43, v29, v11 row_newbcast:4 row_mask:0xf bank_mask:0xf
    v_and_b32_dpp v44, v29, v8 row_newbcast:12 row_mask:0xf bank_mask:0xf
    v_and_b32_dpp v45, v29, v9 row_newbcast:12 row_mask:0xf bank_mask:0xf
    v_and_b32_dpp v46, v29, v10 row_newbcast:12 row_mask:0xf bank_mask:0xf
    v_and_b32_dpp v47, v29, v11 row_newbcast:12 row_mask:0xf bank_mask:0xf
    v_mfma_f32_16x16x32_bf16 v[12:15], v[32:35], a[176:179], v[12:15]
    v_mfma_f32_16x16x32_bf16 v[12:15], v[36:39], a[180:183], v[12:15]
    v_mfma_f32_16x16x32_bf16 v[12:15], v[40:43], a[184:187], v[12:15]
    v_mfma_f32_16x16x32_bf16 v[12:15], v[44:47], a[188:191], v[12:15]
    s_mov_b32 s56, 0
    s_branch L_aback1
L_aflag:
    s_sleep 2
    global_load_dword v57, v58, s[28:29] sc1
    s_waitcnt vmcnt(0)
    v_cmp_gt_u32 vcc, 2, v57
    s_cbranch_vccz L_aflag_ok
    s_sub_u32 s101, s101, 1
    s_cbranch_scc0 L_aflag
    s_mov_b32 s101, 0
    s_branch L_aflag_ok
L_adone:
    s_cmp_eq_u32 s13, 0
    s_cbranch_scc1 L_aswitch
    v_add_f32_dpp v17, v17, v17 row_ror:4 row_mask:0xf bank_mask:0xf
    s_nop 1
    v_add_f32_dpp v17, v17, v17 row_ror:8 row_mask:0xf bank_mask:0xf
    v_mov_b32 v28, v17
    s_nop 1
    v_permlane16_swap_b32 v17, v28
    v_add_f32 v17, v17, v28
    v_mov_b32 v28, v17
    s_nop 1
    v_permlane32_swap_b32 v17, v28
    v_add_f32 v17, v17, v28
    v_cvt_pk_bf16_f32 v54, v12, v13
    v_cvt_pk_bf16_f32 v55, v14, v15
    v_cmp_gt_u32 vcc, 48, v1
    s_nop 1
    v_cndmask_b32 v16, v16, v50, vcc
    v_cndmask_b32 v17, v17, v51, vcc
    v_permlane16_swap_b32 v52, v54
    v_permlane16_swap_b32 v53, v55
    v_cmp_gt_u32 vcc, 32, v1
    s_nop 1
    v_cndmask_b32 v52, v16, v52, vcc
    v_cndmask_b32 v53, v17, v53, vcc
    v_cndmask_b32 v54, v16, v54, vcc
    v_cndmask_b32 v55, v17, v55, vcc
    v_min_u32 v52, -2, v52
    v_min_u32 v53, -2, v53
    v_min_u32 v54, -2, v54
    v_min_u32 v55, -2, v55
    s_mov_b32 s54, 8388608
    buffer_store_dwordx4 v[52:55], v3, s[44:47], s54 offen sc1
    s_endpgm
L_roleA_end:
L_roleH:
    s_mov_b32 s101, 100000
    s_getpc_b64 s[56:57]
L_pc_2:
    s_sub_u32 s56, s56, L_pc_2-L_roleH
    s_subb_u32 s57, s57, 0
    v_lshlrev_b32 v5, 7, v0
    v_min_u32 v6, L_roleH_end-L_roleH-4, v5
    global_load_dword v122, v6, s[56:57]
    v_mov_b32 v20, -1
    v_mov_b32 v21, -1
    v_mov_b32 v22, -1
    v_mov_b32 v23, -1
    v_mul_u32_u24 v7, 73728, v4
    v_lshrrev_b32 v5, 3, v3
    v_lshl_add_u32 v6, v5, 13, v7
    v_and_b32 v5, 7, v3
    v_lshl_add_u32 v6, v5, 4, v6
    v_lshl_add_u32 v7, v3, 3, v7
    v_add_u32 v7, 65536, v7
    s_lshl_b32 s56, s52, 7
    s_add_u32 s56, s56, 4718592
    s_lshl_b32 s54, s3, 14
    s_add_u32 s54, s54, s56
    s_add_u32 s55, s54, 4096
    s_and_b32 s57, s3, 1
    s_lshl_b32 s57, s57, 12
    s_add_u32 s56, s56, s57
    s_waitcnt lgkmcnt(0)
    s_mov_b32 s44, s30
    s_mov_b32 s45, s31
    s_mov_b32 s46, 536870912
    s_mov_b32 s47, 0x20000
    buffer_store_dwordx4 v[20:23], v6, s[44:47], s54 offen sc1
    buffer_store_dwordx4 v[20:23], v6, s[44:47], s55 offen sc1
    buffer_store_dwordx2 v[20:21], v7, s[44:47], s56 offen sc1
    v_lshrrev_b32 v5, 2, v3
    v_lshlrev_b32 v5, 15, v5
    v_lshl_add_u32 v5, v4, 4, v5
    v_and_b32 v6, 3, v3
    v_lshl_add_u32 v5, v6, 6, v5
    s_lshl_b32 s54, s52, 10
    s_lshl_b32 s55, s3, 8
    s_add_u32 s54, s54, s55
    s_add_u32 s54, s54, 1048576
    buffer_store_dwordx4 v[20:23], v5, s[44:47], s54 offen sc1
    v_mov_b32 v7, 536870912
    v_cmp_gt_u32 vcc, 32, v1
    s_nop 1
    v_cndmask_b32 v123, v7, v2, vcc
    s_lshl_b32 s98, s52, 12
    s_lshl_b32 s54, s3, 9
    s_add_u32 s98, s98, s54
    s_add_u32 s98, s98, 5242880
    buffer_store_dwordx4 v[20:23], v123, s[44:47], s98 offen sc1
    s_mov_b32 s40, s10
    s_mov_b32 s41, s11
    s_mov_b32 s42, 4718592
    s_mov_b32 s43, 0x20000
    s_mov_b32 s48, s4
    s_mov_b32 s49, s5
    s_mov_b32 s50, 4608
    s_mov_b32 s51, 0x20000
    v_lshrrev_b32 v5, 3, v3
    v_mul_u32_u24 v5, 1152, v5
    v_mul_u32_u24 v6, 36, v4
    v_add_u32 v5, v5, v6
    s_mul_i32 s54, s3, 144
    buffer_load_dwordx4 v[24:27], v5, s[48:51], s54 offen offset:0
    buffer_load_dwordx4 v[28:31], v5, s[48:51], s54 offen offset:16
    buffer_load_dword v32, v5, s[48:51], s54 offen offset:32
    buffer_load_dwordx4 v[36:39], v5, s[48:51], s54 offen offset:2304
    buffer_load_dwordx4 v[40:43], v5, s[48:51], s54 offen offset:2320
    buffer_load_dword v44, v5, s[48:51], s54 offen offset:2336
    v_mul_u32_u24 v120, 147456, v4
    v_lshl_add_u32 v120, v3, 4, v120
    s_mul_i32 s61, s3, 589824
    s_lshl_b32 s54, s52, 8
    s_add_u32 s61, s61, s54
    buffer_load_dwordx4 a[0:3], v120, s[40:43], s61 offen nt
    s_add_u32 s61, s61, 8192
    buffer_load_dwordx4 a[4:7], v120, s[40:43], s61 offen nt
    s_add_u32 s61, s61, 8192
    buffer_load_dwordx4 a[8:11], v120, s[40:43], s61 offen nt
    s_add_u32 s61, s61, 8192
    buffer_load_dwordx4 a[12:15], v120, s[40:43], s61 offen nt
    s_add_u32 s61, s61, 8192
    buffer_load_dwordx4 a[16:19], v120, s[40:43], s61 offen nt
    s_add_u32 s61, s61, 8192
    buffer_load_dwordx4 a[20:23], v120, s[40:43], s61 offen nt
    s_add_u32 s61, s61, 8192
    buffer_load_dwordx4 a[24:27], v120, s[40:43], s61 offen nt
    s_add_u32 s61, s61, 8192
    buffer_load_dwordx4 a[28:31], v120, s[40:43], s61 offen nt
    s_add_u32 s61, s61, 8192
    buffer_load_dwordx4 a[32:35], v120, s[40:43], s61 offen nt
    s_add_u32 s61, s61, 8192
    buffer_load_dwordx4 a[36:39], v120, s[40:43], s61 offen nt
    s_add_u32 s61, s61, 8192
    buffer_load_dwordx4 a[40:43], v120, s[40:43], s61 offen nt
    s_add_u32 s61, s61, 8192
    buffer_load_dwordx4 a[44:47], v120, s[40:43], s61 offen nt
    s_add_u32 s61, s61, 8192
    buffer_load_dwordx4 a[48:51], v120, s[40:43], s61 offen nt
    s_add_u32 s61, s61, 8192
    buffer_load_dwordx4 a[52:55], v120, s[40:43], s61 offen nt
    s_add_u32 s61, s61, 8192
    buffer_load_dwordx4 a[56:59], v120, s[40:43], s61 offen nt
    s_add_u32 s61, s61, 8192
    buffer_load_dwordx4 a[60:63], v120, s[40:43], s61 offen nt
    s_add_u32 s61, s61, 8192
    buffer_load_dwordx4 a[64:67], v120, s[40:43], s61 offen nt
    s_add_u32 s61, s61, 8192
    buffer_load_dwordx4 a[68:71], v120, s[40:43], s61 offen nt
    s_add_u32 s61, s61, 8192
    s_mov_b32 s32, s18
    s_mov_b32 s33, s19
    s_mov_b32 s34, 4718592
    s_mov_b32 s35, 0x20000
    s_mov_b32 s36, s14
    s_mov_b32 s37, s15
    s_mov_b32 s38, 4608
    s_mov_b32 s39, 0x20000
    v_lshrrev_b32 v5, 3, v3
    v_mul_u32_u24 v5, 1152, v5
    v_mul_u32_u24 v6, 72, v4
    v_add_u32 v5, v5, v6
    s_mul_i32 s54, s3, 288
    buffer_load_dwordx4 v[48:51], v5, s[36:39], s54 offen offset:0
    buffer_load_dwordx4 v[52:55], v5, s[36:39], s54 offen offset:16
    buffer_load_dwordx4 v[56:59], v5, s[36:39], s54 offen offset:32
    buffer_load_dwordx4 v[60:63], v5, s[36:39], s54 offen offset:48
    buffer_load_dwordx2 v[64:65], v5, s[36:39], s54 offen offset:64
    buffer_load_dwordx4 v[68:71], v5, s[36:39], s54 offen offset:2304
    buffer_load_dwordx4 v[72:75], v5, s[36:39], s54 offen offset:2320
    buffer_load_dwordx4 v[76:79], v5, s[36:39], s54 offen offset:2336
    buffer_load_dwordx4 v[80:83], v5, s[36:39], s54 offen offset:2352
    buffer_load_dwordx2 v[84:85], v5, s[36:39], s54 offen offset:2368
    v_mul_u32_u24 v120, 294912, v4
    v_lshl_add_u32 v120, v3, 4, v120
    s_mul_i32 s61, s3, 1179648
    s_lshl_b32 s54, s52, 8
    s_add_u32 s61, s61, s54
    buffer_load_dwordx4 a[112:115], v120, s[32:35], s61 offen nt
    s_add_u32 s61, s61, 8192
    buffer_load_dwordx4 a[116:119], v120, s[32:35], s61 offen nt
    s_add_u32 s61, s61, 8192
    buffer_load_dwordx4 a[120:123], v120, s[32:35], s61 offen nt
    s_add_u32 s61, s61, 8192
    buffer_load_dwordx4 a[124:127], v120, s[32:35], s61 offen nt
    s_add_u32 s61, s61, 8192
    buffer_load_dwordx4 a[128:131], v120, s[32:35], s61 offen nt
    s_add_u32 s61, s61, 8192
    buffer_load_dwordx4 a[132:135], v120, s[32:35], s61 offen nt
    s_add_u32 s61, s61, 8192
    buffer_load_dwordx4 a[136:139], v120, s[32:35], s61 offen nt
    s_add_u32 s61, s61, 8192
    buffer_load_dwordx4 a[140:143], v120, s[32:35], s61 offen nt
    s_add_u32 s61, s61, 8192
    buffer_load_dwordx4 a[144:147], v120, s[32:35], s61 offen nt
    s_add_u32 s61, s61, 8192
    s_mov_b32 s36, s20
    s_mov_b32 s37, s21
    s_mov_b32 s38, 4194304
    s_mov_b32 s39, 0x20000
    s_mov_b32 s40, s22
    s_mov_b32 s41, s23
    s_mov_b32 s42, 4194304
    s_mov_b32 s43, 0x20000
    v_lshlrev_b32 v5, 2, v4
    v_xor_b32 v5, v5, v3
    v_lshlrev_b32 v6, 13, v4
    v_xor_b32 v7, 0, v5
    v_lshl_add_u32 v88, v7, 4, v6
    v_xor_b32 v7, 1, v5
    v_lshl_add_u32 v89, v7, 4, v6
    v_xor_b32 v7, 2, v5
    v_lshl_add_u32 v90, v7, 4, v6
    v_xor_b32 v7, 3, v5
    v_lshl_add_u32 v91, v7, 4, v6
    s_lshl_b32 s62, s3, 20
    s_lshl_b32 s54, s52, 8
    s_add_u32 s62, s62, s54
    s_mov_b32 s60, s62
    s_lshl_b32 s63, s3, 15
    v_lshlrev_b32 v121, 18, v4
    v_lshl_add_u32 v121, v3, 4, v121
    v_lshrrev_b32 v5, 2, v3
    v_and_b32 v6, 3, v3
    v_lshl_add_u32 v7, v5, 3, v6
    v_lshlrev_b32 v92, 8, v7
    v_lshl_or_b32 v5, v6, 2, v5
    v_xor_b32 v5, v5, v4
    v_lshl_add_u32 v92, v5, 4, v92
    v_add_u32 v92, s63, v92
    v_xor_b32 v93, 64, v92
    v_xor_b32 v94, 128, v92
    v_xor_b32 v95, 192, v92
    v_and_b32 v5, 1, v3
    v_cmp_eq_u32 vcc, 1, v5
    v_mov_b32 v5, 0x0c0c0100
    v_mov_b32 v6, 0x01000c0c
    v_cndmask_b32 v5, v5, v6, vcc
    v_mov_b32 v6, 0x0c0c0302
    v_mov_b32 v7, 0x03020c0c
    v_cndmask_b32 v6, v6, v7, vcc
    v_bfe_u32 v7, v3, 1, 2
    v_mov_b32 v16, 0x0c0c0c0c
    v_cmp_eq_u32 vcc, 0, v7
    s_nop 1
    v_cndmask_b32 v8, v16, v5, vcc
    v_cndmask_b32 v9, v16, v6, vcc
    v_cmp_eq_u32 vcc, 1, v7
    s_nop 1
    v_cndmask_b32 v10, v16, v5, vcc
    v_cndmask_b32 v11, v16, v6, vcc
    v_cmp_eq_u32 vcc, 2, v7
    s_nop 1
    v_cndmask_b32 v12, v16, v5, vcc
    v_cndmask_b32 v13, v16, v6, vcc
    v_cmp_eq_u32 vcc, 3, v7
    s_nop 1
    v_cndmask_b32 v14, v16, v5, vcc
    v_cndmask_b32 v15, v16, v6, vcc
    s_waitcnt vmcnt(43)
    s_barrier
    s_cmp_lg_u32 s3, 0
    s_cbranch_scc1 L_nosig_3
    s_lshl_b32 s54, s52, 2
    v_mov_b32 v5, s54
    v_mov_b32 v6, 1
    s_mov_b64 exec, 1
    global_atomic_add v5, v6, s[28:29]
    s_mov_b64 exec, -1
L_nosig_3:
    s_waitcnt vmcnt(28)
    buffer_load_dwordx4 a[148:151], v120, s[32:35], s61 offen nt
    s_add_u32 s61, s61, 8192
    buffer_load_dwordx4 a[152:155], v120, s[32:35], s61 offen nt
    s_add_u32 s61, s61, 8192
    buffer_load_dwordx4 a[156:159], v120, s[32:35], s61 offen nt
    s_add_u32 s61, s61, 8192
    buffer_load_dwordx4 a[160:163], v120, s[32:35], s61 offen nt
    s_add_u32 s61, s61, 8192
    buffer_load_dwordx4 a[164:167], v120, s[32:35], s61 offen nt
    s_add_u32 s61, s61, 8192
    buffer_load_dwordx4 a[168:171], v120, s[32:35], s61 offen nt
    s_add_u32 s61, s61, 8192
    buffer_load_dwordx4 a[172:175], v120, s[32:35], s61 offen nt
    s_add_u32 s61, s61, 8192
    buffer_load_dwordx4 a[176:179], v120, s[32:35], s61 offen nt
    s_add_u32 s61, s61, 8192
    buffer_load_dwordx4 a[180:183], v120, s[32:35], s61 offen nt
    s_add_u32 s61, s61, 8192
    buffer_load_dwordx4 a[184:187], v120, s[32:35], s61 offen nt
    s_add_u32 s61, s61, 8192
    v_perm_b32 v96, v24, v24, v8
    v_perm_b32 v97, v24, v24, v10
    v_perm_b32 v98, v24, v24, v12
    v_perm_b32 v99, v24, v24, v14
    s_nop 1
    v_mfma_f32_16x16x32_bf16 v[112:115], v[96:99], a[0:3], 0
    v_perm_b32 v100, v36, v36, v8
    v_perm_b32 v101, v36, v36, v10
    v_perm_b32 v102, v36, v36, v12
    v_perm_b32 v103, v36, v36, v14
    s_nop 1
    v_mfma_f32_16x16x32_bf16 v[116:119], v[100:103], a[0:3], 0
    v_perm_b32 v104, v24, v24, v9
    v_perm_b32 v105, v24, v24, v11
    v_perm_b32 v106, v24, v24, v13
    v_perm_b32 v107, v24, v24, v15
    s_nop 1
    v_mfma_f32_16x16x32_bf16 v[112:115], v[104:107], a[4:7], v[112:115]
    v_perm_b32 v108, v36, v36, v9
    v_perm_b32 v109, v36, v36, v11
    v_perm_b32 v110, v36, v36, v13
    v_perm_b32 v111, v36, v36, v15
    s_nop 1
    v_mfma_f32_16x16x32_bf16 v[116:119], v[108:111], a[4:7], v[116:119]
    v_perm_b32 v96, v25, v25, v8
    v_perm_b32 v97, v25, v25, v10
    v_perm_b32 v98, v25, v25, v12
    v_perm_b32 v99, v25, v25, v14
    s_nop 1
    v_mfma_f32_16x16x32_bf16 v[112:115], v[96:99], a[8:11], v[112:115]
    v_perm_b32 v100, v37, v37, v8
    v_perm_b32 v101, v37, v37, v10
    v_perm_b32 v102, v37, v37, v12
    v_perm_b32 v103, v37, v37, v14
    s_nop 1
    v_mfma_f32_16x16x32_bf16 v[116:119], v[100:103], a[8:11], v[116:119]
    v_perm_b32 v104, v25, v25, v9
    v_perm_b32 v105, v25, v25, v11
    v_perm_b32 v106, v25, v25, v13
    v_perm_b32 v107, v25, v25, v15
    s_nop 1
    v_mfma_f32_16x16x32_bf16 v[112:115], v[104:107], a[12:15], v[112:115]
    v_perm_b32 v108, v37, v37, v9
    v_perm_b32 v109, v37, v37, v11
    v_perm_b32 v110, v37, v37, v13
    v_perm_b32 v111, v37, v37, v15
    s_nop 1
    v_mfma_f32_16x16x32_bf16 v[116:119], v[108:111], a[12:15], v[116:119]
    v_perm_b32 v96, v26, v26, v8
    v_perm_b32 v97, v26, v26, v10
    v_perm_b32 v98, v26, v26, v12
    v_perm_b32 v99, v26, v26, v14
    s_nop 1
    v_mfma_f32_16x16x32_bf16 v[112:115], v[96:99], a[16:19], v[112:115]
    v_perm_b32 v100, v38, v38, v8
    v_perm_b32 v101, v38, v38, v10
    v_perm_b32 v102, v38, v38, v12
    v_perm_b32 v103, v38, v38, v14
    s_nop 1
    v_mfma_f32_16x16x32_bf16 v[116:119], v[100:103], a[16:19], v[116:119]
    v_perm_b32 v104, v26, v26, v9
    v_perm_b32 v105, v26, v26, v11
    v_perm_b32 v106, v26, v26, v13
    v_perm_b32 v107, v26, v26, v15
    s_nop 1
    v_mfma_f32_16x16x32_bf16 v[112:115], v[104:107], a[20:23], v[112:115]
    v_perm_b32 v108, v38, v38, v9
    v_perm_b32 v109, v38, v38, v11
    v_perm_b32 v110, v38, v38, v13
    v_perm_b32 v111, v38, v38, v15
    s_nop 1
    v_mfma_f32_16x16x32_bf16 v[116:119], v[108:111], a[20:23], v[116:119]
    v_perm_b32 v96, v27, v27, v8
    v_perm_b32 v97, v27, v27, v10
    v_perm_b32 v98, v27, v27, v12
    v_perm_b32 v99, v27, v27, v14
    s_nop 1
    v_mfma_f32_16x16x32_bf16 v[112:115], v[96:99], a[24:27], v[112:115]
    v_perm_b32 v100, v39, v39, v8
    v_perm_b32 v101, v39, v39, v10
    v_perm_b32 v102, v39, v39, v12
    v_perm_b32 v103, v39, v39, v14
    s_nop 1
    v_mfma_f32_16x16x32_bf16 v[116:119], v[100:103], a[24:27], v[116:119]
    v_perm_b32 v104, v27, v27, v9
    v_perm_b32 v105, v27, v27, v11
    v_perm_b32 v106, v27, v27, v13
    v_perm_b32 v107, v27, v27, v15
    s_nop 1
    v_mfma_f32_16x16x32_bf16 v[112:115], v[104:107], a[28:31], v[112:115]
    v_perm_b32 v108, v39, v39, v9
    v_perm_b32 v109, v39, v39, v11
    v_perm_b32 v110, v39, v39, v13
    v_perm_b32 v111, v39, v39, v15
    s_nop 1
    v_mfma_f32_16x16x32_bf16 v[116:119], v[108:111], a[28:31], v[116:119]
    v_perm_b32 v96, v28, v28, v8
    v_perm_b32 v97, v28, v28, v10
    v_perm_b32 v98, v28, v28, v12
    v_perm_b32 v99, v28, v28, v14
    s_nop 1
    v_mfma_f32_16x16x32_bf16 v[112:115], v[96:99], a[32:35], v[112:115]
    v_perm_b32 v100, v40, v40, v8
    v_perm_b32 v101, v40, v40, v10
    v_perm_b32 v102, v40, v40, v12
    v_perm_b32 v103, v40, v40, v14
    s_nop 1
    v_mfma_f32_16x16x32_bf16 v[116:119], v[100:103], a[32:35], v[116:119]
    s_waitcnt vmcnt(29)
    buffer_load_dwordx4 a[188:191], v120, s[32:35], s61 offen nt
    s_add_u32 s61, s61, 8192
    buffer_load_dwordx4 a[192:195], v120, s[32:35], s61 offen nt
    s_add_u32 s61, s61, 8192
    buffer_load_dwordx4 a[196:199], v120, s[32:35], s61 offen nt
    s_add_u32 s61, s61, 8192
    buffer_load_dwordx4 a[200:203], v120, s[32:35], s61 offen nt
    s_add_u32 s61, s61, 8192
    buffer_load_dwordx4 a[204:207], v120, s[32:35], s61 offen nt
    s_add_u32 s61, s61, 8192
    buffer_load_dwordx4 a[208:211], v120, s[32:35], s61 offen nt
    s_add_u32 s61, s61, 8192
    buffer_load_dwordx4 a[212:215], v120, s[32:35], s61 offen nt
    s_add_u32 s61, s61, 8192
    buffer_load_dwordx4 a[216:219], v120, s[32:35], s61 offen nt
    s_add_u32 s61, s61, 8192
    buffer_load_dwordx4 a[220:223], v120, s[32:35], s61 offen nt
    s_add_u32 s61, s61, 8192
    v_perm_b32 v104, v28, v28, v9
    v_perm_b32 v105, v28, v28, v11
    v_perm_b32 v106, v28, v28, v13
    v_perm_b32 v107, v28, v28, v15
    s_nop 1
    v_mfma_f32_16x16x32_bf16 v[112:115], v[104:107], a[36:39], v[112:115]
    v_perm_b32 v108, v40, v40, v9
    v_perm_b32 v109, v40, v40, v11
    v_perm_b32 v110, v40, v40, v13
    v_perm_b32 v111, v40, v40, v15
    s_nop 1
    v_mfma_f32_16x16x32_bf16 v[116:119], v[108:111], a[36:39], v[116:119]
    v_perm_b32 v96, v29, v29, v8
    v_perm_b32 v97, v29, v29, v10
    v_perm_b32 v98, v29, v29, v12
    v_perm_b32 v99, v29, v29, v14
    s_nop 1
    v_mfma_f32_16x16x32_bf16 v[112:115], v[96:99], a[40:43], v[112:115]
    v_perm_b32 v100, v41, v41, v8
    v_perm_b32 v101, v41, v41, v10
    v_perm_b32 v102, v41, v41, v12
    v_perm_b32 v103, v41, v41, v14
    s_nop 1
    v_mfma_f32_16x16x32_bf16 v[116:119], v[100:103], a[40:43], v[116:119]
    v_perm_b32 v104, v29, v29, v9
    v_perm_b32 v105, v29, v29, v11
    v_perm_b32 v106, v29, v29, v13
    v_perm_b32 v107, v29, v29, v15
    s_nop 1
    v_mfma_f32_16x16x32_bf16 v[112:115], v[104:107], a[44:47], v[112:115]
    v_perm_b32 v108, v41, v41, v9
    v_perm_b32 v109, v41, v41, v11
    v_perm_b32 v110, v41, v41, v13
    v_perm_b32 v111, v41, v41, v15
    s_nop 1
    v_mfma_f32_16x16x32_bf16 v[116:119], v[108:111], a[44:47], v[116:119]
    v_perm_b32 v96, v30, v30, v8
    v_perm_b32 v97, v30, v30, v10
    v_perm_b32 v98, v30, v30, v12
    v_perm_b32 v99, v30, v30, v14
    s_nop 1
    v_mfma_f32_16x16x32_bf16 v[112:115], v[96:99], a[48:51], v[112:115]
    v_perm_b32 v100, v42, v42, v8
    v_perm_b32 v101, v42, v42, v10
    v_perm_b32 v102, v42, v42, v12
    v_perm_b32 v103, v42, v42, v14
    s_nop 1
    v_mfma_f32_16x16x32_bf16 v[116:119], v[100:103], a[48:51], v[116:119]
    v_perm_b32 v104, v30, v30, v9
    v_perm_b32 v105, v30, v30, v11
    v_perm_b32 v106, v30, v30, v13
    v_perm_b32 v107, v30, v30, v15
    s_nop 1
    v_mfma_f32_16x16x32_bf16 v[112:115], v[104:107], a[52:55], v[112:115]
    v_perm_b32 v108, v42, v42, v9
    v_perm_b32 v109, v42, v42, v11
    v_perm_b32 v110, v42, v42, v13
    v_perm_b32 v111, v42, v42, v15
    s_nop 1
    v_mfma_f32_16x16x32_bf16 v[116:119], v[108:111], a[52:55], v[116:119]
    v_perm_b32 v96, v31, v31, v8
    v_perm_b32 v97, v31, v31, v10
    v_perm_b32 v98, v31, v31, v12
    v_perm_b32 v99, v31, v31, v14
    s_nop 1
    v_mfma_f32_16x16x32_bf16 v[112:115], v[96:99], a[56:59], v[112:115]
    v_perm_b32 v100, v43, v43, v8
    v_perm_b32 v101, v43, v43, v10
    v_perm_b32 v102, v43, v43, v12
    v_perm_b32 v103, v43, v43, v14
    s_nop 1
    v_mfma_f32_16x16x32_bf16 v[116:119], v[100:103], a[56:59], v[116:119]
    v_perm_b32 v104, v31, v31, v9
    v_perm_b32 v105, v31, v31, v11
    v_perm_b32 v106, v31, v31, v13
    v_perm_b32 v107, v31, v31, v15
    s_nop 1
    v_mfma_f32_16x16x32_bf16 v[112:115], v[104:107], a[60:63], v[112:115]
    v_perm_b32 v108, v43, v43, v9
    v_perm_b32 v109, v43, v43, v11
    v_perm_b32 v110, v43, v43, v13
    v_perm_b32 v111, v43, v43, v15
    s_nop 1
    v_mfma_f32_16x16x32_bf16 v[116:119], v[108:111], a[60:63], v[116:119]
    v_perm_b32 v96, v32, v32, v8
    v_perm_b32 v97, v32, v32, v10
    v_perm_b32 v98, v32, v32, v12
    v_perm_b32 v99, v32, v32, v14
    s_nop 1
    v_mfma_f32_16x16x32_bf16 v[112:115], v[96:99], a[64:67], v[112:115]
    v_perm_b32 v100, v44, v44, v8
    v_perm_b32 v101, v44, v44, v10
    v_perm_b32 v102, v44, v44, v12
    v_perm_b32 v103, v44, v44, v14
    s_nop 1
    v_mfma_f32_16x16x32_bf16 v[116:119], v[100:103], a[64:67], v[116:119]
    v_perm_b32 v104, v32, v32, v9
    v_perm_b32 v105, v32, v32, v11
    v_perm_b32 v106, v32, v32, v13
    v_perm_b32 v107, v32, v32, v15
    s_nop 1
    v_mfma_f32_16x16x32_bf16 v[112:115], v[104:107], a[68:71], v[112:115]
    v_perm_b32 v108, v44, v44, v9
    v_perm_b32 v109, v44, v44, v11
    v_perm_b32 v110, v44, v44, v13
    v_perm_b32 v111, v44, v44, v15
    s_nop 1
    v_mfma_f32_16x16x32_bf16 v[116:119], v[108:111], a[68:71], v[116:119]
    v_lshrrev_b32 v5, 1, v4
    v_lshlrev_b32 v5, 9, v5
    v_lshl_add_u32 v5, v3, 5, v5
    v_and_b32 v6, 1, v4
    v_lshl_add_u32 v5, v6, 4, v5
    s_lshl_b32 s54, s3, 11
    s_add_u32 s54, s54, 139264
    v_add_u32 v5, s54, v5
    ds_write_b128 v5, v[112:115]
    ds_write_b128 v5, v[116:119] offset:1024
    s_waitcnt lgkmcnt(0)
    s_barrier
    s_lshl_b32 s54, s3, 9
    s_add_u32 s54, s54, 139264
    v_add_u32 v5, s54, v2
    ds_read_b128 v[96:99], v5 offset:0
    ds_read_b128 v[100:103], v5 offset:2048
    ds_read_b128 v[104:107], v5 offset:4096
    ds_read_b128 v[108:111], v5 offset:6144
    s_waitcnt lgkmcnt(0)
    v_add_f32 v96, v96, v100
    v_add_f32 v104, v104, v108
    v_add_f32 v97, v97, v101
    v_add_f32 v105, v105, v109
    v_add_f32 v98, v98, v102
    v_add_f32 v106, v106, v110
    v_add_f32 v99, v99, v103
    v_add_f32 v107, v107, v111
    v_add_f32 v96, v96, v104
    v_add_f32 v97, v97, v105
    v_add_f32 v98, v98, v106
    v_add_f32 v99, v99, v107
    v_min_u32 v124, -2, v96
    v_min_u32 v125, -2, v97
    v_min_u32 v126, -2, v98
    v_min_u32 v127, -2, v99
    buffer_store_dwordx4 v[124:127], v123, s[44:47], s98 offen sc1
    s_waitcnt vmcnt(20)
    buffer_load_dwordx4 a[224:227], v120, s[32:35], s61 offen nt
    s_add_u32 s61, s61, 8192
    buffer_load_dwordx4 a[228:231], v120, s[32:35], s61 offen nt
    s_add_u32 s61, s61, 8192
    buffer_load_dwordx4 a[232:235], v120, s[32:35], s61 offen nt
    s_add_u32 s61, s61, 8192
    buffer_load_dwordx4 a[236:239], v120, s[32:35], s61 offen nt
    s_add_u32 s61, s61, 8192
    buffer_load_dwordx4 a[240:243], v120, s[32:35], s61 offen nt
    s_add_u32 s61, s61, 8192
    buffer_load_dwordx4 a[244:247], v120, s[32:35], s61 offen nt
    s_add_u32 s61, s61, 8192
    buffer_load_dwordx4 a[248:251], v120, s[32:35], s61 offen nt
    s_add_u32 s61, s61, 8192
    buffer_load_dwordx4 a[252:255], v120, s[32:35], s61 offen nt
    s_add_u32 s61, s61, 8192
    s_add_u32 m0, s63, 0
    s_nop 0
    buffer_load_dwordx4 v88, s[36:39], s60 offen nt lds
    s_add_u32 s60, s60, 32768
    v_perm_b32 v96, v48, v48, v8
    v_perm_b32 v97, v48, v48, v10
    v_perm_b32 v98, v48, v48, v12
    v_perm_b32 v99, v48, v48, v14
    s_nop 1
    v_mfma_f32_16x16x32_bf16 v[112:115], v[96:99], a[112:115], 0
    v_perm_b32 v100, v68, v68, v8
    v_perm_b32 v101, v68, v68, v10
    v_perm_b32 v102, v68, v68, v12
    v_perm_b32 v103, v68, v68, v14
    s_nop 1
    v_mfma_f32_16x16x32_bf16 v[116:119], v[100:103], a[112:115], 0
    v_perm_b32 v104, v48, v48, v9
    v_perm_b32 v105, v48, v48, v11
    v_perm_b32 v106, v48, v48, v13
    v_perm_b32 v107, v48, v48, v15
    s_nop 1
    v_mfma_f32_16x16x32_bf16 v[112:115], v[104:107], a[116:119], v[112:115]
    v_perm_b32 v108, v68, v68, v9
    v_perm_b32 v109, v68, v68, v11
    v_perm_b32 v110, v68, v68, v13
    v_perm_b32 v111, v68, v68, v15
    s_nop 1
    v_mfma_f32_16x16x32_bf16 v[116:119], v[108:111], a[116:119], v[116:119]
    v_perm_b32 v96, v49, v49, v8
    v_perm_b32 v97, v49, v49, v10
    v_perm_b32 v98, v49, v49, v12
    v_perm_b32 v99, v49, v49, v14
    s_nop 1
    v_mfma_f32_16x16x32_bf16 v[112:115], v[96:99], a[120:123], v[112:115]
    v_perm_b32 v100, v69, v69, v8
    v_perm_b32 v101, v69, v69, v10
    v_perm_b32 v102, v69, v69, v12
    v_perm_b32 v103, v69, v69, v14
    s_nop 1
    v_mfma_f32_16x16x32_bf16 v[116:119], v[100:103], a[120:123], v[116:119]
    v_perm_b32 v104, v49, v49, v9
    v_perm_b32 v105, v49, v49, v11
    v_perm_b32 v106, v49, v49, v13
    v_perm_b32 v107, v49, v49, v15
    s_nop 1
    v_mfma_f32_16x16x32_bf16 v[112:115], v[104:107], a[124:127], v[112:115]
    v_perm_b32 v108, v69, v69, v9
    v_perm_b32 v109, v69, v69, v11
    v_perm_b32 v110, v69, v69, v13
    v_perm_b32 v111, v69, v69, v15
    s_nop 1
    v_mfma_f32_16x16x32_bf16 v[116:119], v[108:111], a[124:127], v[116:119]
    v_perm_b32 v96, v50, v50, v8
    v_perm_b32 v97, v50, v50, v10
    v_perm_b32 v98, v50, v50, v12
    v_perm_b32 v99, v50, v50, v14
    s_nop 1
    v_mfma_f32_16x16x32_bf16 v[112:115], v[96:99], a[128:131], v[112:115]
    v_perm_b32 v100, v70, v70, v8
    v_perm_b32 v101, v70, v70, v10
    v_perm_b32 v102, v70, v70, v12
    v_perm_b32 v103, v70, v70, v14
    s_nop 1
    v_mfma_f32_16x16x32_bf16 v[116:119], v[100:103], a[128:131], v[116:119]
    v_perm_b32 v104, v50, v50, v9
    v_perm_b32 v105, v50, v50, v11
    v_perm_b32 v106, v50, v50, v13
    v_perm_b32 v107, v50, v50, v15
    s_nop 1
    v_mfma_f32_16x16x32_bf16 v[112:115], v[104:107], a[132:135], v[112:115]
    v_perm_b32 v108, v70, v70, v9
    v_perm_b32 v109, v70, v70, v11
    v_perm_b32 v110, v70, v70, v13
    v_perm_b32 v111, v70, v70, v15
    s_nop 1
    v_mfma_f32_16x16x32_bf16 v[116:119], v[108:111], a[132:135], v[116:119]
    v_perm_b32 v96, v51, v51, v8
    v_perm_b32 v97, v51, v51, v10
    v_perm_b32 v98, v51, v51, v12
    v_perm_b32 v99, v51, v51, v14
    s_nop 1
    v_mfma_f32_16x16x32_bf16 v[112:115], v[96:99], a[136:139], v[112:115]
    v_perm_b32 v100, v71, v71, v8
    v_perm_b32 v101, v71, v71, v10
    v_perm_b32 v102, v71, v71, v12
    v_perm_b32 v103, v71, v71, v14
    s_nop 1
    v_mfma_f32_16x16x32_bf16 v[116:119], v[100:103], a[136:139], v[116:119]
    v_perm_b32 v104, v51, v51, v9
    v_perm_b32 v105, v51, v51, v11
    v_perm_b32 v106, v51, v51, v13
    v_perm_b32 v107, v51, v51, v15
    s_nop 1
    v_mfma_f32_16x16x32_bf16 v[112:115], v[104:107], a[140:143], v[112:115]
    v_perm_b32 v108, v71, v71, v9
    v_perm_b32 v109, v71, v71, v11
    v_perm_b32 v110, v71, v71, v13
    v_perm_b32 v111, v71, v71, v15
    s_nop 1
    v_mfma_f32_16x16x32_bf16 v[116:119], v[108:111], a[140:143], v[116:119]
    v_perm_b32 v96, v52, v52, v8
    v_perm_b32 v97, v52, v52, v10
    v_perm_b32 v98, v52, v52, v12
    v_perm_b32 v99, v52, v52, v14
    s_nop 1
    v_mfma_f32_16x16x32_bf16 v[112:115], v[96:99], a[144:147], v[112:115]
    v_perm_b32 v100, v72, v72, v8
    v_perm_b32 v101, v72, v72, v10
    v_perm_b32 v102, v72, v72, v12
    v_perm_b32 v103, v72, v72, v14
    s_nop 1
    v_mfma_f32_16x16x32_bf16 v[116:119], v[100:103], a[144:147], v[116:119]
    s_waitcnt vmcnt(20)
    s_add_u32 m0, s63, 1024
    s_nop 0
    buffer_load_dwordx4 v88, s[36:39], s60 offen nt lds
    s_add_u32 s60, s60, 32768
    s_add_u32 m0, s63, 2048
    s_nop 0
    buffer_load_dwordx4 v89, s[36:39], s60 offen nt lds
    s_add_u32 s60, s60, 32768
    s_add_u32 m0, s63, 3072
    s_nop 0
    buffer_load_dwordx4 v89, s[36:39], s60 offen nt lds
    s_add_u32 s60, s60, 32768
    s_add_u32 m0, s63, 4096
    s_nop 0
    buffer_load_dwordx4 v90, s[36:39], s60 offen nt lds
    s_add_u32 s60, s60, 32768
    s_add_u32 m0, s63, 5120
    s_nop 0
    buffer_load_dwordx4 v90, s[36:39], s60 offen nt lds
    s_add_u32 s60, s60, 32768
    s_add_u32 m0, s63, 6144
    s_nop 0
    buffer_load_dwordx4 v91, s[36:39], s60 offen nt lds
    s_add_u32 s60, s60, 32768
    s_add_u32 m0, s63, 7168
    s_nop 0
    buffer_load_dwordx4 v91, s[36:39], s60 offen nt lds
    s_add_u32 s60, s60, 32768
    s_add_u32 m0, s63, 8192
    s_nop 0
    buffer_load_dwordx4 v88, s[36:39], s60 offen nt lds
    s_add_u32 s60, s60, 32768
    s_add_u32 m0, s63, 9216
    s_nop 0
    buffer_load_dwordx4 v88, s[36:39], s60 offen nt lds
    s_add_u32 s60, s60, 32768
    v_perm_b32 v104, v52, v52, v9
    v_perm_b32 v105, v52, v52, v11
    v_perm_b32 v106, v52, v52, v13
    v_perm_b32 v107, v52, v52, v15
    s_nop 1
    v_mfma_f32_16x16x32_bf16 v[112:115], v[104:107], a[148:151], v[112:115]
    v_perm_b32 v108, v72, v72, v9
    v_perm_b32 v109, v72, v72, v11
    v_perm_b32 v110, v72, v72, v13
    v_perm_b32 v111, v72, v72, v15
    s_nop 1
    v_mfma_f32_16x16x32_bf16 v[116:119], v[108:111], a[148:151], v[116:119]
    v_perm_b32 v96, v53, v53, v8
    v_perm_b32 v97, v53, v53, v10
    v_perm_b32 v98, v53, v53, v12
    v_perm_b32 v99, v53, v53, v14
    s_nop 1
    v_mfma_f32_16x16x32_bf16 v[112:115], v[96:99], a[152:155], v[112:115]
    v_perm_b32 v100, v73, v73, v8
    v_perm_b32 v101, v73, v73, v10
    v_perm_b32 v102, v73, v73, v12
    v_perm_b32 v103, v73, v73, v14
    s_nop 1
    v_mfma_f32_16x16x32_bf16 v[116:119], v[100:103], a[152:155], v[116:119]
    v_perm_b32 v104, v53, v53, v9
    v_perm_b32 v105, v53, v53, v11
    v_perm_b32 v106, v53, v53, v13
    v_perm_b32 v107, v53, v53, v15
    s_nop 1
    v_mfma_f32_16x16x32_bf16 v[112:115], v[104:107], a[156:159], v[112:115]
    v_perm_b32 v108, v73, v73, v9
    v_perm_b32 v109, v73, v73, v11
    v_perm_b32 v110, v73, v73, v13
    v_perm_b32 v111, v73, v73, v15
    s_nop 1
    v_mfma_f32_16x16x32_bf16 v[116:119], v[108:111], a[156:159], v[116:119]
    v_perm_b32 v96, v54, v54, v8
    v_perm_b32 v97, v54, v54, v10
    v_perm_b32 v98, v54, v54, v12
    v_perm_b32 v99, v54, v54, v14
    s_nop 1
    v_mfma_f32_16x16x32_bf16 v[112:115], v[96:99], a[160:163], v[112:115]
    v_perm_b32 v100, v74, v74, v8
    v_perm_b32 v101, v74, v74, v10
    v_perm_b32 v102, v74, v74, v12
    v_perm_b32 v103, v74, v74, v14
    s_nop 1
    v_mfma_f32_16x16x32_bf16 v[116:119], v[100:103], a[160:163], v[116:119]
    v_perm_b32 v104, v54, v54, v9
    v_perm_b32 v105, v54, v54, v11
    v_perm_b32 v106, v54, v54, v13
    v_perm_b32 v107, v54, v54, v15
    s_nop 1
    v_mfma_f32_16x16x32_bf16 v[112:115], v[104:107], a[164:167], v[112:115]
    v_perm_b32 v108, v74, v74, v9
    v_perm_b32 v109, v74, v74, v11
    v_perm_b32 v110, v74, v74, v13
    v_perm_b32 v111, v74, v74, v15
    s_nop 1
    v_mfma_f32_16x16x32_bf16 v[116:119], v[108:111], a[164:167], v[116:119]
    v_perm_b32 v96, v55, v55, v8
    v_perm_b32 v97, v55, v55, v10
    v_perm_b32 v98, v55, v55, v12
    v_perm_b32 v99, v55, v55, v14
    s_nop 1
    v_mfma_f32_16x16x32_bf16 v[112:115], v[96:99], a[168:171], v[112:115]
    v_perm_b32 v100, v75, v75, v8
    v_perm_b32 v101, v75, v75, v10
    v_perm_b32 v102, v75, v75, v12
    v_perm_b32 v103, v75, v75, v14
    s_nop 1
    v_mfma_f32_16x16x32_bf16 v[116:119], v[100:103], a[168:171], v[116:119]
    v_perm_b32 v104, v55, v55, v9
    v_perm_b32 v105, v55, v55, v11
    v_perm_b32 v106, v55, v55, v13
    v_perm_b32 v107, v55, v55, v15
    s_nop 1
    v_mfma_f32_16x16x32_bf16 v[112:115], v[104:107], a[172:175], v[112:115]
    v_perm_b32 v108, v75, v75, v9
    v_perm_b32 v109, v75, v75, v11
    v_perm_b32 v110, v75, v75, v13
    v_perm_b32 v111, v75, v75, v15
    s_nop 1
    v_mfma_f32_16x16x32_bf16 v[116:119], v[108:111], a[172:175], v[116:119]
    v_perm_b32 v96, v56, v56, v8
    v_perm_b32 v97, v56, v56, v10
    v_perm_b32 v98, v56, v56, v12
    v_perm_b32 v99, v56, v56, v14
    s_nop 1
    v_mfma_f32_16x16x32_bf16 v[112:115], v[96:99], a[176:179], v[112:115]
    v_perm_b32 v100, v76, v76, v8
    v_perm_b32 v101, v76, v76, v10
    v_perm_b32 v102, v76, v76, v12
    v_perm_b32 v103, v76, v76, v14
    s_nop 1
    v_mfma_f32_16x16x32_bf16 v[116:119], v[100:103], a[176:179], v[116:119]
    v_perm_b32 v104, v56, v56, v9
    v_perm_b32 v105, v56, v56, v11
    v_perm_b32 v106, v56, v56, v13
    v_perm_b32 v107, v56, v56, v15
    s_nop 1
    v_mfma_f32_16x16x32_bf16 v[112:115], v[104:107], a[180:183], v[112:115]
    v_perm_b32 v108, v76, v76, v9
    v_perm_b32 v109, v76, v76, v11
    v_perm_b32 v110, v76, v76, v13
    v_perm_b32 v111, v76, v76, v15
    s_nop 1
    v_mfma_f32_16x16x32_bf16 v[116:119], v[108:111], a[180:183], v[116:119]
    s_waitcnt vmcnt(20)
    s_add_u32 m0, s63, 10240
    s_nop 0
    buffer_load_dwordx4 v89, s[36:39], s60 offen nt lds
    s_add_u32 s60, s60, 32768
    s_add_u32 m0, s63, 11264
    s_nop 0
    buffer_load_dwordx4 v89, s[36:39], s60 offen nt lds
    s_add_u32 s60, s60, 32768
    s_add_u32 m0, s63, 12288
    s_nop 0
    buffer_load_dwordx4 v90, s[36:39], s60 offen nt lds
    s_add_u32 s60, s60, 32768
    s_add_u32 m0, s63, 13312
    s_nop 0
    buffer_load_dwordx4 v90, s[36:39], s60 offen nt lds
    s_add_u32 s60, s60, 32768
    s_add_u32 m0, s63, 14336
    s_nop 0
    buffer_load_dwordx4 v91, s[36:39], s60 offen nt lds
    s_add_u32 s60, s60, 32768
    s_add_u32 m0, s63, 15360
    s_nop 0
    buffer_load_dwordx4 v91, s[36:39], s60 offen nt lds
    s_add_u32 s60, s60, 32768
    s_add_u32 m0, s63, 16384
    s_nop 0
    buffer_load_dwordx4 v88, s[36:39], s60 offen nt lds
    s_add_u32 s60, s60, 32768
    s_add_u32 m0, s63, 17408
    s_nop 0
    buffer_load_dwordx4 v88, s[36:39], s60 offen nt lds
    s_add_u32 s60, s60, 32768
    s_add_u32 m0, s63, 18432
    s_nop 0
    buffer_load_dwordx4 v89, s[36:39], s60 offen nt lds
    s_add_u32 s60, s60, 32768
    v_perm_b32 v96, v57, v57, v8
    v_perm_b32 v97, v57, v57, v10
    v_perm_b32 v98, v57, v57, v12
    v_perm_b32 v99, v57, v57, v14
    s_nop 1
    v_mfma_f32_16x16x32_bf16 v[112:115], v[96:99], a[184:187], v[112:115]
    v_perm_b32 v100, v77, v77, v8
    v_perm_b32 v101, v77, v77, v10
    v_perm_b32 v102, v77, v77, v12
    v_perm_b32 v103, v77, v77, v14
    s_nop 1
    v_mfma_f32_16x16x32_bf16 v[116:119], v[100:103], a[184:187], v[116:119]
    v_perm_b32 v104, v57, v57, v9
    v_perm_b32 v105, v57, v57, v11
    v_perm_b32 v106, v57, v57, v13
    v_perm_b32 v107, v57, v57, v15
    s_nop 1
    v_mfma_f32_16x16x32_bf16 v[112:115], v[104:107], a[188:191], v[112:115]
    v_perm_b32 v108, v77, v77, v9
    v_perm_b32 v109, v77, v77, v11
    v_perm_b32 v110, v77, v77, v13
    v_perm_b32 v111, v77, v77, v15
    s_nop 1
    v_mfma_f32_16x16x32_bf16 v[116:119], v[108:111], a[188:191], v[116:119]
    v_perm_b32 v96, v58, v58, v8
    v_perm_b32 v97, v58, v58, v10
    v_perm_b32 v98, v58, v58, v12
    v_perm_b32 v99, v58, v58, v14
    s_nop 1
    v_mfma_f32_16x16x32_bf16 v[112:115], v[96:99], a[192:195], v[112:115]
    v_perm_b32 v100, v78, v78, v8
    v_perm_b32 v101, v78, v78, v10
    v_perm_b32 v102, v78, v78, v12
    v_perm_b32 v103, v78, v78, v14
    s_nop 1
    v_mfma_f32_16x16x32_bf16 v[116:119], v[100:103], a[192:195], v[116:119]
    v_perm_b32 v104, v58, v58, v9
    v_perm_b32 v105, v58, v58, v11
    v_perm_b32 v106, v58, v58, v13
    v_perm_b32 v107, v58, v58, v15
    s_nop 1
    v_mfma_f32_16x16x32_bf16 v[112:115], v[104:107], a[196:199], v[112:115]
    v_perm_b32 v108, v78, v78, v9
    v_perm_b32 v109, v78, v78, v11
    v_perm_b32 v110, v78, v78, v13
    v_perm_b32 v111, v78, v78, v15
    s_nop 1
    v_mfma_f32_16x16x32_bf16 v[116:119], v[108:111], a[196:199], v[116:119]
    v_perm_b32 v96, v59, v59, v8
    v_perm_b32 v97, v59, v59, v10
    v_perm_b32 v98, v59, v59, v12
    v_perm_b32 v99, v59, v59, v14
    s_nop 1
    v_mfma_f32_16x16x32_bf16 v[112:115], v[96:99], a[200:203], v[112:115]
    v_perm_b32 v100, v79, v79, v8
    v_perm_b32 v101, v79, v79, v10
    v_perm_b32 v102, v79, v79, v12
    v_perm_b32 v103, v79, v79, v14
    s_nop 1
    v_mfma_f32_16x16x32_bf16 v[116:119], v[100:103], a[200:203], v[116:119]
    v_perm_b32 v104, v59, v59, v9
    v_perm_b32 v105, v59, v59, v11
    v_perm_b32 v106, v59, v59, v13
    v_perm_b32 v107, v59, v59, v15
    s_nop 1
    v_mfma_f32_16x16x32_bf16 v[112:115], v[104:107], a[204:207], v[112:115]
    v_perm_b32 v108, v79, v79, v9
    v_perm_b32 v109, v79, v79, v11
    v_perm_b32 v110, v79, v79, v13
    v_perm_b32 v111, v79, v79, v15
    s_nop 1
    v_mfma_f32_16x16x32_bf16 v[116:119], v[108:111], a[204:207], v[116:119]
    v_perm_b32 v96, v60, v60, v8
    v_perm_b32 v97, v60, v60, v10
    v_perm_b32 v98, v60, v60, v12
    v_perm_b32 v99, v60, v60, v14
    s_nop 1
    v_mfma_f32_16x16x32_bf16 v[112:115], v[96:99], a[208:211], v[112:115]
    v_perm_b32 v100, v80, v80, v8
    v_perm_b32 v101, v80, v80, v10
    v_perm_b32 v102, v80, v80, v12
    v_perm_b32 v103, v80, v80, v14
    s_nop 1
    v_mfma_f32_16x16x32_bf16 v[116:119], v[100:103], a[208:211], v[116:119]
    v_perm_b32 v104, v60, v60, v9
    v_perm_b32 v105, v60, v60, v11
    v_perm_b32 v106, v60, v60, v13
    v_perm_b32 v107, v60, v60, v15
    s_nop 1
    v_mfma_f32_16x16x32_bf16 v[112:115], v[104:107], a[212:215], v[112:115]
    v_perm_b32 v108, v80, v80, v9
    v_perm_b32 v109, v80, v80, v11
    v_perm_b32 v110, v80, v80, v13
    v_perm_b32 v111, v80, v80, v15
    s_nop 1
    v_mfma_f32_16x16x32_bf16 v[116:119], v[108:111], a[212:215], v[116:119]
    v_perm_b32 v96, v61, v61, v8
    v_perm_b32 v97, v61, v61, v10
    v_perm_b32 v98, v61, v61, v12
    v_perm_b32 v99, v61, v61, v14
    s_nop 1
    v_mfma_f32_16x16x32_bf16 v[112:115], v[96:99], a[216:219], v[112:115]
    v_perm_b32 v100, v81, v81, v8
    v_perm_b32 v101, v81, v81, v10
    v_perm_b32 v102, v81, v81, v12
    v_perm_b32 v103, v81, v81, v14
    s_nop 1
    v_mfma_f32_16x16x32_bf16 v[116:119], v[100:103], a[216:219], v[116:119]
    s_waitcnt vmcnt(19)
    s_add_u32 m0, s63, 19456
    s_nop 0
    buffer_load_dwordx4 v89, s[36:39], s60 offen nt lds
    s_add_u32 s60, s60, 32768
    s_add_u32 m0, s63, 20480
    s_nop 0
    buffer_load_dwordx4 v90, s[36:39], s60 offen nt lds
    s_add_u32 s60, s60, 32768
    s_add_u32 m0, s63, 21504
    s_nop 0
    buffer_load_dwordx4 v90, s[36:39], s60 offen nt lds
    s_add_u32 s60, s60, 32768
    s_add_u32 m0, s63, 22528
    s_nop 0
    buffer_load_dwordx4 v91, s[36:39], s60 offen nt lds
    s_add_u32 s60, s60, 32768
    s_add_u32 m0, s63, 23552
    s_nop 0
    buffer_load_dwordx4 v91, s[36:39], s60 offen nt lds
    s_add_u32 s60, s60, 32768
    s_add_u32 m0, s63, 24576
    s_nop 0
    buffer_load_dwordx4 v88, s[36:39], s60 offen nt lds
    s_add_u32 s60, s60, 32768
    s_add_u32 m0, s63, 25600
    s_nop 0
    buffer_load_dwordx4 v88, s[36:39], s60 offen nt lds
    s_add_u32 s60, s60, 32768
    s_add_u32 m0, s63, 26624
    s_nop 0
    buffer_load_dwordx4 v89, s[36:39], s60 offen nt lds
    s_add_u32 s60, s60, 32768
    s_add_u32 m0, s63, 27648
    s_nop 0
    buffer_load_dwordx4 v89, s[36:39], s60 offen nt lds
    s_add_u32 s60, s60, 32768
    v_perm_b32 v104, v61, v61, v9
    v_perm_b32 v105, v61, v61, v11
    v_perm_b32 v106, v61, v61, v13
    v_perm_b32 v107, v61, v61, v15
    s_nop 1
    v_mfma_f32_16x16x32_bf16 v[112:115], v[104:107], a[220:223], v[112:115]
    v_perm_b32 v108, v81, v81, v9
    v_perm_b32 v109, v81, v81, v11
    v_perm_b32 v110, v81, v81, v13
    v_perm_b32 v111, v81, v81, v15
    s_nop 1
    v_mfma_f32_16x16x32_bf16 v[116:119], v[108:111], a[220:223], v[116:119]
    v_perm_b32 v96, v62, v62, v8
    v_perm_b32 v97, v62, v62, v10
    v_perm_b32 v98, v62, v62, v12
    v_perm_b32 v99, v62, v62, v14
    s_nop 1
    v_mfma_f32_16x16x32_bf16 v[112:115], v[96:99], a[224:227], v[112:115]
    v_perm_b32 v100, v82, v82, v8
    v_perm_b32 v101, v82, v82, v10
    v_perm_b32 v102, v82, v82, v12
    v_perm_b32 v103, v82, v82, v14
    s_nop 1
    v_mfma_f32_16x16x32_bf16 v[116:119], v[100:103], a[224:227], v[116:119]
    v_perm_b32 v104, v62, v62, v9
    v_perm_b32 v105, v62, v62, v11
    v_perm_b32 v106, v62, v62, v13
    v_perm_b32 v107, v62, v62, v15
    s_nop 1
    v_mfma_f32_16x16x32_bf16 v[112:115], v[104:107], a[228:231], v[112:115]
    v_perm_b32 v108, v82, v82, v9
    v_perm_b32 v109, v82, v82, v11
    v_perm_b32 v110, v82, v82, v13
    v_perm_b32 v111, v82, v82, v15
    s_nop 1
    v_mfma_f32_16x16x32_bf16 v[116:119], v[108:111], a[228:231], v[116:119]
    v_perm_b32 v96, v63, v63, v8
    v_perm_b32 v97, v63, v63, v10
    v_perm_b32 v98, v63, v63, v12
    v_perm_b32 v99, v63, v63, v14
    s_nop 1
    v_mfma_f32_16x16x32_bf16 v[112:115], v[96:99], a[232:235], v[112:115]
    v_perm_b32 v100, v83, v83, v8
    v_perm_b32 v101, v83, v83, v10
    v_perm_b32 v102, v83, v83, v12
    v_perm_b32 v103, v83, v83, v14
    s_nop 1
    v_mfma_f32_16x16x32_bf16 v[116:119], v[100:103], a[232:235], v[116:119]
    v_perm_b32 v104, v63, v63, v9
    v_perm_b32 v105, v63, v63, v11
    v_perm_b32 v106, v63, v63, v13
    v_perm_b32 v107, v63, v63, v15
    s_nop 1
    v_mfma_f32_16x16x32_bf16 v[112:115], v[104:107], a[236:239], v[112:115]
    v_perm_b32 v108, v83, v83, v9
    v_perm_b32 v109, v83, v83, v11
    v_perm_b32 v110, v83, v83, v13
    v_perm_b32 v111, v83, v83, v15
    s_nop 1
    v_mfma_f32_16x16x32_bf16 v[116:119], v[108:111], a[236:239], v[116:119]
    v_perm_b32 v96, v64, v64, v8
    v_perm_b32 v97, v64, v64, v10
    v_perm_b32 v98, v64, v64, v12
    v_perm_b32 v99, v64, v64, v14
    s_nop 1
    v_mfma_f32_16x16x32_bf16 v[112:115], v[96:99], a[240:243], v[112:115]
    v_perm_b32 v100, v84, v84, v8
    v_perm_b32 v101, v84, v84, v10
    v_perm_b32 v102, v84, v84, v12
    v_perm_b32 v103, v84, v84, v14
    s_nop 1
    v_mfma_f32_16x16x32_bf16 v[116:119], v[100:103], a[240:243], v[116:119]
    v_perm_b32 v104, v64, v64, v9
    v_perm_b32 v105, v64, v64, v11
    v_perm_b32 v106, v64, v64, v13
    v_perm_b32 v107, v64, v64, v15
    s_nop 1
    v_mfma_f32_16x16x32_bf16 v[112:115], v[104:107], a[244:247], v[112:115]
    v_perm_b32 v108, v84, v84, v9
    v_perm_b32 v109, v84, v84, v11
    v_perm_b32 v110, v84, v84, v13
    v_perm_b32 v111, v84, v84, v15
    s_nop 1
    v_mfma_f32_16x16x32_bf16 v[116:119], v[108:111], a[244:247], v[116:119]
    v_perm_b32 v96, v65, v65, v8
    v_perm_b32 v97, v65, v65, v10
    v_perm_b32 v98, v65, v65, v12
    v_perm_b32 v99, v65, v65, v14
    s_nop 1
    v_mfma_f32_16x16x32_bf16 v[112:115], v[96:99], a[248:251], v[112:115]
    v_perm_b32 v100, v85, v85, v8
    v_perm_b32 v101, v85, v85, v10
    v_perm_b32 v102, v85, v85, v12
    v_perm_b32 v103, v85, v85, v14
    s_nop 1
    v_mfma_f32_16x16x32_bf16 v[116:119], v[100:103], a[248:251], v[116:119]
    v_perm_b32 v104, v65, v65, v9
    v_perm_b32 v105, v65, v65, v11
    v_perm_b32 v106, v65, v65, v13
    v_perm_b32 v107, v65, v65, v15
    s_nop 1
    v_mfma_f32_16x16x32_bf16 v[112:115], v[104:107], a[252:255], v[112:115]
    v_perm_b32 v108, v85, v85, v9
    v_perm_b32 v109, v85, v85, v11
    v_perm_b32 v110, v85, v85, v13
    v_perm_b32 v111, v85, v85, v15
    s_nop 1
    v_mfma_f32_16x16x32_bf16 v[116:119], v[108:111], a[252:255], v[116:119]
    v_lshrrev_b32 v5, 1, v4
    v_lshlrev_b32 v5, 9, v5
    v_lshl_add_u32 v5, v3, 5, v5
    v_and_b32 v6, 1, v4
    v_lshl_add_u32 v5, v6, 4, v5
    s_lshl_b32 s54, s3, 11
    s_add_u32 s54, s54, 131072
    v_add_u32 v5, s54, v5
    ds_write_b128 v5, v[112:115]
    ds_write_b128 v5, v[116:119] offset:1024
    s_waitcnt lgkmcnt(0)
    s_barrier
    s_add_u32 m0, s63, 28672
    s_nop 0
    buffer_load_dwordx4 v90, s[36:39], s60 offen nt lds
    s_add_u32 s60, s60, 32768
    s_add_u32 m0, s63, 29696
    s_nop 0
    buffer_load_dwordx4 v90, s[36:39], s60 offen nt lds
    s_add_u32 s60, s60, 32768
    s_add_u32 m0, s63, 30720
    s_nop 0
    buffer_load_dwordx4 v91, s[36:39], s60 offen nt lds
    s_add_u32 s60, s60, 32768
    s_add_u32 m0, s63, 31744
    s_nop 0
    buffer_load_dwordx4 v91, s[36:39], s60 offen nt lds
    s_add_u32 s60, s60, 32768
    v_lshrrev_b32 v5, 2, v3
    v_lshlrev_b32 v5, 9, v5
    v_lshl_add_u32 v5, v4, 5, v5
    v_add_u32 v5, 131072, v5
    ds_read_b128 v[48:51], v5 offset:0
    ds_read_b128 v[52:55], v5 offset:16
    ds_read_b128 v[56:59], v5 offset:2048
    ds_read_b128 v[60:63], v5 offset:2064
    ds_read_b128 v[64:67], v5 offset:4096
    ds_read_b128 v[68:71], v5 offset:4112
    ds_read_b128 v[72:75], v5 offset:6144
    ds_read_b128 v[76:79], v5 offset:6160
    s_waitcnt lgkmcnt(0)
    v_add_f32 v48, v48, v56
    v_add_f32 v64, v64, v72
    v_add_f32 v49, v49, v57
    v_add_f32 v65, v65, v73
    v_add_f32 v50, v50, v58
    v_add_f32 v66, v66, v74
    v_add_f32 v51, v51, v59
    v_add_f32 v67, v67, v75
    v_add_f32 v52, v52, v60
    v_add_f32 v68, v68, v76
    v_add_f32 v53, v53, v61
    v_add_f32 v69, v69, v77
    v_add_f32 v54, v54, v62
    v_add_f32 v70, v70, v78
    v_add_f32 v55, v55, v63
    v_add_f32 v71, v71, v79
    v_add_f32 v48, v48, v64
    v_add_f32 v49, v49, v65
    v_add_f32 v50, v50, v66
    v_add_f32 v51, v51, v67
    v_add_f32 v52, v52, v68
    v_add_f32 v53, v53, v69
    v_add_f32 v54, v54, v70
    v_add_f32 v55, v55, v71
    v_cvt_pk_bf16_f32 v96, v48, v49
    v_cvt_pk_bf16_f32 v97, v50, v51
    v_cvt_pk_bf16_f32 v98, v52, v53
    v_cvt_pk_bf16_f32 v99, v54, v55
    ds_read_b128 v[48:51], v5 offset:128
    ds_read_b128 v[52:55], v5 offset:144
    ds_read_b128 v[56:59], v5 offset:2176
    ds_read_b128 v[60:63], v5 offset:2192
    ds_read_b128 v[64:67], v5 offset:4224
    ds_read_b128 v[68:71], v5 offset:4240
    ds_read_b128 v[72:75], v5 offset:6272
    ds_read_b128 v[76:79], v5 offset:6288
    s_waitcnt lgkmcnt(0)
    v_add_f32 v48, v48, v56
    v_add_f32 v64, v64, v72
    v_add_f32 v49, v49, v57
    v_add_f32 v65, v65, v73
    v_add_f32 v50, v50, v58
    v_add_f32 v66, v66, v74
    v_add_f32 v51, v51, v59
    v_add_f32 v67, v67, v75
    v_add_f32 v52, v52, v60
    v_add_f32 v68, v68, v76
    v_add_f32 v53, v53, v61
    v_add_f32 v69, v69, v77
    v_add_f32 v54, v54, v62
    v_add_f32 v70, v70, v78
    v_add_f32 v55, v55, v63
    v_add_f32 v71, v71, v79
    v_add_f32 v48, v48, v64
    v_add_f32 v49, v49, v65
    v_add_f32 v50, v50, v66
    v_add_f32 v51, v51, v67
    v_add_f32 v52, v52, v68
    v_add_f32 v53, v53, v69
    v_add_f32 v54, v54, v70
    v_add_f32 v55, v55, v71
    v_cvt_pk_bf16_f32 v100, v48, v49
    v_cvt_pk_bf16_f32 v101, v50, v51
    v_cvt_pk_bf16_f32 v102, v52, v53
    v_cvt_pk_bf16_f32 v103, v54, v55
    ds_read_b128 v[48:51], v5 offset:256
    ds_read_b128 v[52:55], v5 offset:272
    ds_read_b128 v[56:59], v5 offset:2304
    ds_read_b128 v[60:63], v5 offset:2320
    ds_read_b128 v[64:67], v5 offset:4352
    ds_read_b128 v[68:71], v5 offset:4368
    ds_read_b128 v[72:75], v5 offset:6400
    ds_read_b128 v[76:79], v5 offset:6416
    s_waitcnt lgkmcnt(0)
    v_add_f32 v48, v48, v56
    v_add_f32 v64, v64, v72
    v_add_f32 v49, v49, v57
    v_add_f32 v65, v65, v73
    v_add_f32 v50, v50, v58
    v_add_f32 v66, v66, v74
    v_add_f32 v51, v51, v59
    v_add_f32 v67, v67, v75
    v_add_f32 v52, v52, v60
    v_add_f32 v68, v68, v76
    v_add_f32 v53, v53, v61
    v_add_f32 v69, v69, v77
    v_add_f32 v54, v54, v62
    v_add_f32 v70, v70, v78
    v_add_f32 v55, v55, v63
    v_add_f32 v71, v71, v79
    v_add_f32 v48, v48, v64
    v_add_f32 v49, v49, v65
    v_add_f32 v50, v50, v66
    v_add_f32 v51, v51, v67
    v_add_f32 v52, v52, v68
    v_add_f32 v53, v53, v69
    v_add_f32 v54, v54, v70
    v_add_f32 v55, v55, v71
    v_cvt_pk_bf16_f32 v104, v48, v49
    v_cvt_pk_bf16_f32 v105, v50, v51
    v_cvt_pk_bf16_f32 v106, v52, v53
    v_cvt_pk_bf16_f32 v107, v54, v55
    ds_read_b128 v[48:51], v5 offset:384
    ds_read_b128 v[52:55], v5 offset:400
    ds_read_b128 v[56:59], v5 offset:2432
    ds_read_b128 v[60:63], v5 offset:2448
    ds_read_b128 v[64:67], v5 offset:4480
    ds_read_b128 v[68:71], v5 offset:4496
    ds_read_b128 v[72:75], v5 offset:6528
    ds_read_b128 v[76:79], v5 offset:6544
    s_waitcnt lgkmcnt(0)
    v_add_f32 v48, v48, v56
    v_add_f32 v64, v64, v72
    v_add_f32 v49, v49, v57
    v_add_f32 v65, v65, v73
    v_add_f32 v50, v50, v58
    v_add_f32 v66, v66, v74
    v_add_f32 v51, v51, v59
    v_add_f32 v67, v67, v75
    v_add_f32 v52, v52, v60
    v_add_f32 v68, v68, v76
    v_add_f32 v53, v53, v61
    v_add_f32 v69, v69, v77
    v_add_f32 v54, v54, v62
    v_add_f32 v70, v70, v78
    v_add_f32 v55, v55, v63
    v_add_f32 v71, v71, v79
    v_add_f32 v48, v48, v64
    v_add_f32 v49, v49, v65
    v_add_f32 v50, v50, v66
    v_add_f32 v51, v51, v67
    v_add_f32 v52, v52, v68
    v_add_f32 v53, v53, v69
    v_add_f32 v54, v54, v70
    v_add_f32 v55, v55, v71
    v_cvt_pk_bf16_f32 v108, v48, v49
    v_cvt_pk_bf16_f32 v109, v50, v51
    v_cvt_pk_bf16_f32 v110, v52, v53
    v_cvt_pk_bf16_f32 v111, v54, v55
    s_waitcnt vmcnt(24)
    ds_read_b128 v[128:131], v92 offset:0
    ds_read_b128 v[132:135], v93 offset:0
    ds_read_b128 v[136:139], v94 offset:0
    ds_read_b128 v[140:143], v95 offset:0
    ds_read_b128 v[144:147], v92 offset:1024
    ds_read_b128 v[148:151], v93 offset:1024
    ds_read_b128 v[152:155], v94 offset:1024
    ds_read_b128 v[156:159], v95 offset:1024
    s_waitcnt lgkmcnt(7)
    v_mfma_f32_16x16x32_bf16 v[48:51], v[128:131], v[96:99], 0
    s_waitcnt lgkmcnt(6)
    v_mfma_f32_16x16x32_bf16 v[48:51], v[132:135], v[100:103], v[48:51]
    s_waitcnt lgkmcnt(5)
    v_mfma_f32_16x16x32_bf16 v[48:51], v[136:139], v[104:107], v[48:51]
    s_waitcnt lgkmcnt(4)
    v_mfma_f32_16x16x32_bf16 v[48:51], v[140:143], v[108:111], v[48:51]
    s_waitcnt lgkmcnt(3)
    v_mfma_f32_16x16x32_bf16 v[52:55], v[144:147], v[96:99], 0
    s_waitcnt lgkmcnt(2)
    v_mfma_f32_16x16x32_bf16 v[52:55], v[148:151], v[100:103], v[52:55]
    s_waitcnt lgkmcnt(1)
    v_mfma_f32_16x16x32_bf16 v[52:55], v[152:155], v[104:107], v[52:55]
    s_waitcnt lgkmcnt(0)
    v_mfma_f32_16x16x32_bf16 v[52:55], v[156:159], v[108:111], v[52:55]
    s_waitcnt vmcnt(16)
    ds_read_b128 v[160:163], v92 offset:8192
    ds_read_b128 v[164:167], v93 offset:8192
    ds_read_b128 v[168:171], v94 offset:8192
    ds_read_b128 v[172:175], v95 offset:8192
    ds_read_b128 v[176:179], v92 offset:9216
    ds_read_b128 v[180:183], v93 offset:9216
    ds_read_b128 v[184:187], v94 offset:9216
    ds_read_b128 v[188:191], v95 offset:9216
    s_waitcnt lgkmcnt(7)
    v_mfma_f32_16x16x32_bf16 v[56:59], v[160:163], v[96:99], 0
    s_waitcnt lgkmcnt(6)
    v_mfma_f32_16x16x32_bf16 v[56:59], v[164:167], v[100:103], v[56:59]
    s_waitcnt lgkmcnt(5)
    v_mfma_f32_16x16x32_bf16 v[56:59], v[168:171], v[104:107], v[56:59]
    s_waitcnt lgkmcnt(4)
    v_mfma_f32_16x16x32_bf16 v[56:59], v[172:175], v[108:111], v[56:59]
    s_waitcnt lgkmcnt(3)
    v_mfma_f32_16x16x32_bf16 v[60:63], v[176:179], v[96:99], 0
    s_waitcnt lgkmcnt(2)
    v_mfma_f32_16x16x32_bf16 v[60:63], v[180:183], v[100:103], v[60:63]
    s_waitcnt lgkmcnt(1)
    v_mfma_f32_16x16x32_bf16 v[60:63], v[184:187], v[104:107], v[60:63]
    s_waitcnt lgkmcnt(0)
    v_mfma_f32_16x16x32_bf16 v[60:63], v[188:191], v[108:111], v[60:63]
    s_waitcnt vmcnt(8)
    ds_read_b128 v[128:131], v92 offset:16384
    ds_read_b128 v[132:135], v93 offset:16384
    ds_read_b128 v[136:139], v94 offset:16384
    ds_read_b128 v[140:143], v95 offset:16384
    ds_read_b128 v[144:147], v92 offset:17408
    ds_read_b128 v[148:151], v93 offset:17408
    ds_read_b128 v[152:155], v94 offset:17408
    ds_read_b128 v[156:159], v95 offset:17408
    s_waitcnt lgkmcnt(7)
    v_mfma_f32_16x16x32_bf16 v[64:67], v[128:131], v[96:99], 0
    s_waitcnt lgkmcnt(6)
    v_mfma_f32_16x16x32_bf16 v[64:67], v[132:135], v[100:103], v[64:67]
    s_waitcnt lgkmcnt(5)
    v_mfma_f32_16x16x32_bf16 v[64:67], v[136:139], v[104:107], v[64:67]
    s_waitcnt lgkmcnt(4)
    v_mfma_f32_16x16x32_bf16 v[64:67], v[140:143], v[108:111], v[64:67]
    s_waitcnt lgkmcnt(3)
    v_mfma_f32_16x16x32_bf16 v[68:71], v[144:147], v[96:99], 0
    s_waitcnt lgkmcnt(2)
    v_mfma_f32_16x16x32_bf16 v[68:71], v[148:151], v[100:103], v[68:71]
    s_waitcnt lgkmcnt(1)
    v_mfma_f32_16x16x32_bf16 v[68:71], v[152:155], v[104:107], v[68:71]
    s_waitcnt lgkmcnt(0)
    v_mfma_f32_16x16x32_bf16 v[68:71], v[156:159], v[108:111], v[68:71]
    s_waitcnt vmcnt(0)
    ds_read_b128 v[160:163], v92 offset:24576
    ds_read_b128 v[164:167], v93 offset:24576
    ds_read_b128 v[168:171], v94 offset:24576
    ds_read_b128 v[172:175], v95 offset:24576
    ds_read_b128 v[176:179], v92 offset:25600
    ds_read_b128 v[180:183], v93 offset:25600
    ds_read_b128 v[184:187], v94 offset:25600
    ds_read_b128 v[188:191], v95 offset:25600
    s_waitcnt lgkmcnt(7)
    v_mfma_f32_16x16x32_bf16 v[72:75], v[160:163], v[96:99], 0
    s_waitcnt lgkmcnt(6)
    v_mfma_f32_16x16x32_bf16 v[72:75], v[164:167], v[100:103], v[72:75]
    s_waitcnt lgkmcnt(5)
    v_mfma_f32_16x16x32_bf16 v[72:75], v[168:171], v[104:107], v[72:75]
    s_waitcnt lgkmcnt(4)
    v_mfma_f32_16x16x32_bf16 v[72:75], v[172:175], v[108:111], v[72:75]
    s_waitcnt lgkmcnt(3)
    v_mfma_f32_16x16x32_bf16 v[76:79], v[176:179], v[96:99], 0
    s_waitcnt lgkmcnt(2)
    v_mfma_f32_16x16x32_bf16 v[76:79], v[180:183], v[100:103], v[76:79]
    s_waitcnt lgkmcnt(1)
    v_mfma_f32_16x16x32_bf16 v[76:79], v[184:187], v[104:107], v[76:79]
    s_waitcnt lgkmcnt(0)
    v_mfma_f32_16x16x32_bf16 v[76:79], v[188:191], v[108:111], v[76:79]
    s_mov_b32 s96, 1040356334
    v_and_b32 v6, 3, v3
    v_cmp_eq_u32 vcc, 1, v6
    s_nop 1
    v_cndmask_b32 v48, v48, v56, vcc
    v_cndmask_b32 v49, v49, v57, vcc
    v_cndmask_b32 v50, v50, v58, vcc
    v_cndmask_b32 v51, v51, v59, vcc
    v_cndmask_b32 v52, v52, v60, vcc
    v_cndmask_b32 v53, v53, v61, vcc
    v_cndmask_b32 v54, v54, v62, vcc
    v_cndmask_b32 v55, v55, v63, vcc
    v_cmp_eq_u32 vcc, 2, v6
    s_nop 1
    v_cndmask_b32 v48, v48, v64, vcc
    v_cndmask_b32 v49, v49, v65, vcc
    v_cndmask_b32 v50, v50, v66, vcc
    v_cndmask_b32 v51, v51, v67, vcc
    v_cndmask_b32 v52, v52, v68, vcc
    v_cndmask_b32 v53, v53, v69, vcc
    v_cndmask_b32 v54, v54, v70, vcc
    v_cndmask_b32 v55, v55, v71, vcc
    v_cmp_eq_u32 vcc, 3, v6
    s_nop 1
    v_cndmask_b32 v48, v48, v72, vcc
    v_cndmask_b32 v49, v49, v73, vcc
    v_cndmask_b32 v50, v50, v74, vcc
    v_cndmask_b32 v51, v51, v75, vcc
    v_cndmask_b32 v52, v52, v76, vcc
    v_cndmask_b32 v53, v53, v77, vcc
    v_cndmask_b32 v54, v54, v78, vcc
    v_cndmask_b32 v55, v55, v79, vcc
    v_mul_f32 v48, s96, v48
    v_mul_f32 v49, s96, v49
    v_mul_f32 v50, s96, v50
    v_mul_f32 v51, s96, v51
    v_mul_f32 v52, s96, v52
    v_mul_f32 v53, s96, v53
    v_mul_f32 v54, s96, v54
    v_mul_f32 v55, s96, v55
    v_cvt_pk_bf16_f32 v24, v48, v49
    v_cvt_pk_bf16_f32 v25, v50, v51
    v_cvt_pk_bf16_f32 v26, v52, v53
    v_cvt_pk_bf16_f32 v27, v54, v55
    v_min_u32 v24, -2, v24
    v_min_u32 v25, -2, v25
    v_min_u32 v26, -2, v26
    v_min_u32 v27, -2, v27
    v_lshrrev_b32 v5, 2, v3
    v_lshlrev_b32 v5, 15, v5
    v_lshl_add_u32 v5, v4, 4, v5
    v_and_b32 v6, 3, v3
    v_lshl_add_u32 v5, v6, 6, v5
    s_lshl_b32 s54, s52, 10
    s_lshl_b32 s55, s3, 8
    s_add_u32 s54, s54, s55
    s_add_u32 s54, s54, 1048576
    buffer_store_dwordx4 v[24:27], v5, s[44:47], s54 offen sc1
    buffer_load_dwordx4 a[0:3], v121, s[40:43], s62 offen nt
    s_add_u32 s62, s62, 8192
    buffer_load_dwordx4 a[4:7], v121, s[40:43], s62 offen nt
    s_add_u32 s62, s62, 8192
    buffer_load_dwordx4 a[8:11], v121, s[40:43], s62 offen nt
    s_add_u32 s62, s62, 8192
    buffer_load_dwordx4 a[12:15], v121, s[40:43], s62 offen nt
    s_add_u32 s62, s62, 8192
    buffer_load_dwordx4 a[16:19], v121, s[40:43], s62 offen nt
    s_add_u32 s62, s62, 8192
    buffer_load_dwordx4 a[20:23], v121, s[40:43], s62 offen nt
    s_add_u32 s62, s62, 8192
    buffer_load_dwordx4 a[24:27], v121, s[40:43], s62 offen nt
    s_add_u32 s62, s62, 8192
    buffer_load_dwordx4 a[28:31], v121, s[40:43], s62 offen nt
    s_add_u32 s62, s62, 8192
    buffer_load_dwordx4 a[32:35], v121, s[40:43], s62 offen nt
    s_add_u32 s62, s62, 8192
    buffer_load_dwordx4 a[36:39], v121, s[40:43], s62 offen nt
    s_add_u32 s62, s62, 8192
    buffer_load_dwordx4 a[40:43], v121, s[40:43], s62 offen nt
    s_add_u32 s62, s62, 8192
    buffer_load_dwordx4 a[44:47], v121, s[40:43], s62 offen nt
    s_add_u32 s62, s62, 8192
    buffer_load_dwordx4 a[48:51], v121, s[40:43], s62 offen nt
    s_add_u32 s62, s62, 8192
    buffer_load_dwordx4 a[52:55], v121, s[40:43], s62 offen nt
    s_add_u32 s62, s62, 8192
    buffer_load_dwordx4 a[56:59], v121, s[40:43], s62 offen nt
    s_add_u32 s62, s62, 8192
    buffer_load_dwordx4 a[60:63], v121, s[40:43], s62 offen nt
    s_add_u32 s62, s62, 8192
    buffer_load_dwordx4 a[64:67], v121, s[40:43], s62 offen nt
    s_add_u32 s62, s62, 8192
    buffer_load_dwordx4 a[68:71], v121, s[40:43], s62 offen nt
    s_add_u32 s62, s62, 8192
    buffer_load_dwordx4 a[72:75], v121, s[40:43], s62 offen nt
    s_add_u32 s62, s62, 8192
    buffer_load_dwordx4 a[76:79], v121, s[40:43], s62 offen nt
    s_add_u32 s62, s62, 8192
    buffer_load_dwordx4 a[80:83], v121, s[40:43], s62 offen nt
    s_add_u32 s62, s62, 8192
    buffer_load_dwordx4 a[84:87], v121, s[40:43], s62 offen nt
    s_add_u32 s62, s62, 8192
    buffer_load_dwordx4 a[88:91], v121, s[40:43], s62 offen nt
    s_add_u32 s62, s62, 8192
    buffer_load_dwordx4 a[92:95], v121, s[40:43], s62 offen nt
    s_add_u32 s62, s62, 8192
    buffer_load_dwordx4 a[96:99], v121, s[40:43], s62 offen nt
    s_add_u32 s62, s62, 8192
    buffer_load_dwordx4 a[100:103], v121, s[40:43], s62 offen nt
    s_add_u32 s62, s62, 8192
    buffer_load_dwordx4 a[104:107], v121, s[40:43], s62 offen nt
    s_add_u32 s62, s62, 8192
    buffer_load_dwordx4 a[108:111], v121, s[40:43], s62 offen nt
    s_add_u32 s62, s62, 8192
    buffer_load_dwordx4 a[112:115], v121, s[40:43], s62 offen nt
    s_add_u32 s62, s62, 8192
    buffer_load_dwordx4 a[116:119], v121, s[40:43], s62 offen nt
    s_add_u32 s62, s62, 8192
    buffer_load_dwordx4 a[120:123], v121, s[40:43], s62 offen nt
    s_add_u32 s62, s62, 8192
    buffer_load_dwordx4 a[124:127], v121, s[40:43], s62 offen nt
    s_add_u32 s62, s62, 8192
    s_mov_b32 s36, s24
    s_mov_b32 s37, s25
    s_mov_b32 s38, 4718592
    s_mov_b32 s39, 0x20000
    v_mul_u32_u24 v81, 9216, v4
    v_lshl_add_u32 v80, v3, 4, v81
    v_lshl_add_u32 v81, v3, 2, v81
    s_mul_i32 s100, s52, 147456
    s_lshl_b32 s54, s3, 8
    s_add_u32 s99, s100, s54
    s_and_b32 s54, s3, 1
    s_lshl_b32 s54, s54, 6
    s_add_u32 s100, s100, s54
    s_add_u32 s100, s100, 1024
    buffer_load_dwordx4 v[96:99], v80, s[36:39], s99 offen offset:0 nt
    buffer_load_dwordx4 v[100:103], v80, s[36:39], s99 offen offset:1152 nt
    buffer_load_dwordx4 v[104:107], v80, s[36:39], s99 offen offset:2304 nt
    buffer_load_dwordx4 v[108:111], v80, s[36:39], s99 offen offset:3456 nt
    s_add_u32 s99, s99, 4608
    buffer_load_dwordx4 v[112:115], v80, s[36:39], s99 offen offset:0 nt
    buffer_load_dwordx4 v[116:119], v80, s[36:39], s99 offen offset:1152 nt
    buffer_load_dwordx4 v[120:123], v80, s[36:39], s99 offen offset:2304 nt
    buffer_load_dwordx4 v[124:127], v80, s[36:39], s99 offen offset:3456 nt
    s_add_u32 s99, s99, 32256
    buffer_load_dwordx4 v[128:131], v80, s[36:39], s99 offen offset:0 nt
    buffer_load_dwordx4 v[132:135], v80, s[36:39], s99 offen offset:1152 nt
    buffer_load_dwordx4 v[136:139], v80, s[36:39], s99 offen offset:2304 nt
    buffer_load_dwordx4 v[140:143], v80, s[36:39], s99 offen offset:3456 nt
    s_add_u32 s99, s99, 4608
    buffer_load_dwordx4 v[144:147], v80, s[36:39], s99 offen offset:0 nt
    buffer_load_dwordx4 v[148:151], v80, s[36:39], s99 offen offset:1152 nt
    buffer_load_dwordx4 v[152:155], v80, s[36:39], s99 offen offset:2304 nt
    buffer_load_dwordx4 v[156:159], v80, s[36:39], s99 offen offset:3456 nt
    s_add_u32 s99, s99, 32256
    buffer_load_dwordx4 v[160:163], v80, s[36:39], s99 offen offset:0 nt
    buffer_load_dwordx4 v[164:167], v80, s[36:39], s99 offen offset:1152 nt
    buffer_load_dwordx4 v[168:171], v80, s[36:39], s99 offen offset:2304 nt
    buffer_load_dwordx4 v[172:175], v80, s[36:39], s99 offen offset:3456 nt
    s_add_u32 s99, s99, 4608
    buffer_load_dwordx4 v[176:179], v80, s[36:39], s99 offen offset:0 nt
    buffer_load_dwordx4 v[180:183], v80, s[36:39], s99 offen offset:1152 nt
    buffer_load_dwordx4 v[184:187], v80, s[36:39], s99 offen offset:2304 nt
    buffer_load_dwordx4 v[188:191], v80, s[36:39], s99 offen offset:3456 nt
    s_add_u32 s99, s99, 32256
    buffer_load_dwordx4 v[192:195], v80, s[36:39], s99 offen offset:0 nt
    buffer_load_dwordx4 v[196:199], v80, s[36:39], s99 offen offset:1152 nt
    buffer_load_dwordx4 v[200:203], v80, s[36:39], s99 offen offset:2304 nt
    buffer_load_dwordx4 v[204:207], v80, s[36:39], s99 offen offset:3456 nt
    s_add_u32 s99, s99, 4608
    s_waitcnt vmcnt(40)
    buffer_load_dwordx4 v[208:211], v80, s[36:39], s99 offen offset:0 nt
    buffer_load_dwordx4 v[212:215], v80, s[36:39], s99 offen offset:1152 nt
    buffer_load_dwordx4 v[216:219], v80, s[36:39], s99 offen offset:2304 nt
    buffer_load_dwordx4 v[220:223], v80, s[36:39], s99 offen offset:3456 nt
    s_add_u32 s99, s99, 32256
    v_and_b32 v16, 31, v1
    v_lshlrev_b32 v16, 2, v16
    global_load_dword v17, v16, s[28:29] sc1
    buffer_load_dword v224, v81, s[36:39], s100 offen offset:0 nt
    buffer_load_dword v225, v81, s[36:39], s100 offen offset:1152 nt
    buffer_load_dword v226, v81, s[36:39], s100 offen offset:2304 nt
    buffer_load_dword v227, v81, s[36:39], s100 offen offset:3456 nt
    s_add_u32 s100, s100, 4608
    buffer_load_dword v228, v81, s[36:39], s100 offen offset:0 nt
    buffer_load_dword v229, v81, s[36:39], s100 offen offset:1152 nt
    buffer_load_dword v230, v81, s[36:39], s100 offen offset:2304 nt
    buffer_load_dword v231, v81, s[36:39], s100 offen offset:3456 nt
    s_add_u32 s100, s100, 32256
    buffer_load_dword v232, v81, s[36:39], s100 offen offset:0 nt
    buffer_load_dword v233, v81, s[36:39], s100 offen offset:1152 nt
    buffer_load_dword v234, v81, s[36:39], s100 offen offset:2304 nt
    buffer_load_dword v235, v81, s[36:39], s100 offen offset:3456 nt
    s_add_u32 s100, s100, 4608
    buffer_load_dword v236, v81, s[36:39], s100 offen offset:0 nt
    buffer_load_dword v237, v81, s[36:39], s100 offen offset:1152 nt
    buffer_load_dword v238, v81, s[36:39], s100 offen offset:2304 nt
    buffer_load_dword v239, v81, s[36:39], s100 offen offset:3456 nt
    s_add_u32 s100, s100, 32256
    s_waitcnt vmcnt(40)
    buffer_load_dword v240, v81, s[36:39], s100 offen offset:0 nt
    buffer_load_dword v241, v81, s[36:39], s100 offen offset:1152 nt
    buffer_load_dword v242, v81, s[36:39], s100 offen offset:2304 nt
    buffer_load_dword v243, v81, s[36:39], s100 offen offset:3456 nt
    s_add_u32 s100, s100, 4608
    buffer_load_dword v244, v81, s[36:39], s100 offen offset:0 nt
    buffer_load_dword v245, v81, s[36:39], s100 offen offset:1152 nt
    buffer_load_dword v246, v81, s[36:39], s100 offen offset:2304 nt
    buffer_load_dword v247, v81, s[36:39], s100 offen offset:3456 nt
    s_add_u32 s100, s100, 32256
    buffer_load_dword v248, v81, s[36:39], s100 offen offset:0 nt
    buffer_load_dword v249, v81, s[36:39], s100 offen offset:1152 nt
    buffer_load_dword v250, v81, s[36:39], s100 offen offset:2304 nt
    buffer_load_dword v251, v81, s[36:39], s100 offen offset:3456 nt
    s_add_u32 s100, s100, 4608
    buffer_load_dword v252, v81, s[36:39], s100 offen offset:0 nt
    buffer_load_dword v253, v81, s[36:39], s100 offen offset:1152 nt
    buffer_load_dword v254, v81, s[36:39], s100 offen offset:2304 nt
    buffer_load_dword v255, v81, s[36:39], s100 offen offset:3456 nt
    s_add_u32 s100, s100, 32256
    s_waitcnt vmcnt(0)
    s_mov_b32 s54, 0x05040100
    s_mov_b32 s55, 0x07060302
    v_perm_b32 v64, v100, v96, s54
    v_perm_b32 v65, v108, v104, s54
    v_perm_b32 v66, v116, v112, s54
    v_perm_b32 v67, v124, v120, s54
    v_perm_b32 v68, v100, v96, s55
    v_perm_b32 v69, v108, v104, s55
    v_perm_b32 v70, v116, v112, s55
    v_perm_b32 v71, v124, v120, s55
    v_perm_b32 v72, v101, v97, s54
    v_perm_b32 v73, v109, v105, s54
    v_perm_b32 v74, v117, v113, s54
    v_perm_b32 v75, v125, v121, s54
    v_perm_b32 v76, v101, v97, s55
    v_perm_b32 v77, v109, v105, s55
    v_perm_b32 v78, v117, v113, s55
    v_perm_b32 v79, v125, v121, s55
    v_perm_b32 v80, v102, v98, s54
    v_perm_b32 v81, v110, v106, s54
    v_perm_b32 v82, v118, v114, s54
    v_perm_b32 v83, v126, v122, s54
    v_perm_b32 v84, v102, v98, s55
    v_perm_b32 v85, v110, v106, s55
    v_perm_b32 v86, v118, v114, s55
    v_perm_b32 v87, v126, v122, s55
    v_perm_b32 v88, v103, v99, s54
    v_perm_b32 v89, v111, v107, s54
    v_perm_b32 v90, v119, v115, s54
    v_perm_b32 v91, v127, v123, s54
    v_perm_b32 v92, v103, v99, s55
    v_perm_b32 v93, v111, v107, s55
    v_perm_b32 v94, v119, v115, s55
    v_perm_b32 v95, v127, v123, s55
    v_perm_b32 v96, v132, v128, s54
    v_perm_b32 v97, v140, v136, s54
    v_perm_b32 v98, v148, v144, s54
    v_perm_b32 v99, v156, v152, s54
    v_perm_b32 v100, v132, v128, s55
    v_perm_b32 v101, v140, v136, s55
    v_perm_b32 v102, v148, v144, s55
    v_perm_b32 v103, v156, v152, s55
    v_perm_b32 v104, v133, v129, s54
    v_perm_b32 v105, v141, v137, s54
    v_perm_b32 v106, v149, v145, s54
    v_perm_b32 v107, v157, v153, s54
    v_perm_b32 v108, v133, v129, s55
    v_perm_b32 v109, v141, v137, s55
    v_perm_b32 v110, v149, v145, s55
    v_perm_b32 v111, v157, v153, s55
    v_perm_b32 v112, v134, v130, s54
    v_perm_b32 v113, v142, v138, s54
    v_perm_b32 v114, v150, v146, s54
    v_perm_b32 v115, v158, v154, s54
    v_perm_b32 v116, v134, v130, s55
    v_perm_b32 v117, v142, v138, s55
    v_perm_b32 v118, v150, v146, s55
    v_perm_b32 v119, v158, v154, s55
    v_perm_b32 v120, v135, v131, s54
    v_perm_b32 v121, v143, v139, s54
    v_perm_b32 v122, v151, v147, s54
    v_perm_b32 v123, v159, v155, s54
    v_perm_b32 v124, v135, v131, s55
    v_perm_b32 v125, v143, v139, s55
    v_perm_b32 v126, v151, v147, s55
    v_perm_b32 v127, v159, v155, s55
    v_perm_b32 v128, v164, v160, s54
    v_perm_b32 v129, v172, v168, s54
    v_perm_b32 v130, v180, v176, s54
    v_perm_b32 v131, v188, v184, s54
    v_perm_b32 v132, v164, v160, s55
    v_perm_b32 v133, v172, v168, s55
    v_perm_b32 v134, v180, v176, s55
    v_perm_b32 v135, v188, v184, s55
    v_perm_b32 v136, v165, v161, s54
    v_perm_b32 v137, v173, v169, s54
    v_perm_b32 v138, v181, v177, s54
    v_perm_b32 v139, v189, v185, s54
    v_perm_b32 v140, v165, v161, s55
    v_perm_b32 v141, v173, v169, s55
    v_perm_b32 v142, v181, v177, s55
    v_perm_b32 v143, v189, v185, s55
    v_perm_b32 v144, v166, v162, s54
    v_perm_b32 v145, v174, v170, s54
    v_perm_b32 v146, v182, v178, s54
    v_perm_b32 v147, v190, v186, s54
    v_perm_b32 v148, v166, v162, s55
    v_perm_b32 v149, v174, v170, s55
    v_perm_b32 v150, v182, v178, s55
    v_perm_b32 v151, v190, v186, s55
    v_perm_b32 v152, v167, v163, s54
    v_perm_b32 v153, v175, v171, s54
    v_perm_b32 v154, v183, v179, s54
    v_perm_b32 v155, v191, v187, s54
    v_perm_b32 v156, v167, v163, s55
    v_perm_b32 v157, v175, v171, s55
    v_perm_b32 v158, v183, v179, s55
    v_perm_b32 v159, v191, v187, s55
    v_perm_b32 v160, v196, v192, s54
    v_perm_b32 v161, v204, v200, s54
    v_perm_b32 v162, v212, v208, s54
    v_perm_b32 v163, v220, v216, s54
    v_perm_b32 v164, v196, v192, s55
    v_perm_b32 v165, v204, v200, s55
    v_perm_b32 v166, v212, v208, s55
    v_perm_b32 v167, v220, v216, s55
    v_perm_b32 v168, v197, v193, s54
    v_perm_b32 v169, v205, v201, s54
    v_perm_b32 v170, v213, v209, s54
    v_perm_b32 v171, v221, v217, s54
    v_perm_b32 v172, v197, v193, s55
    v_perm_b32 v173, v205, v201, s55
    v_perm_b32 v174, v213, v209, s55
    v_perm_b32 v175, v221, v217, s55
    v_perm_b32 v176, v198, v194, s54
    v_perm_b32 v177, v206, v202, s54
    v_perm_b32 v178, v214, v210, s54
    v_perm_b32 v179, v222, v218, s54
    v_perm_b32 v180, v198, v194, s55
    v_perm_b32 v181, v206, v202, s55
    v_perm_b32 v182, v214, v210, s55
    v_perm_b32 v183, v222, v218, s55
    v_perm_b32 v184, v199, v195, s54
    v_perm_b32 v185, v207, v203, s54
    v_perm_b32 v186, v215, v211, s54
    v_perm_b32 v187, v223, v219, s54
    v_perm_b32 v188, v199, v195, s55
    v_perm_b32 v189, v207, v203, s55
    v_perm_b32 v190, v215, v211, s55
    v_perm_b32 v191, v223, v219, s55
    v_perm_b32 v192, v225, v224, s54
    v_perm_b32 v193, v227, v226, s54
    v_perm_b32 v194, v229, v228, s54
    v_perm_b32 v195, v231, v230, s54
    v_perm_b32 v196, v225, v224, s55
    v_perm_b32 v197, v227, v226, s55
    v_perm_b32 v198, v229, v228, s55
    v_perm_b32 v199, v231, v230, s55
    v_perm_b32 v200, v233, v232, s54
    v_perm_b32 v201, v235, v234, s54
    v_perm_b32 v202, v237, v236, s54
    v_perm_b32 v203, v239, v238, s54
    v_perm_b32 v204, v233, v232, s55
    v_perm_b32 v205, v235, v234, s55
    v_perm_b32 v206, v237, v236, s55
    v_perm_b32 v207, v239, v238, s55
    v_perm_b32 v208, v241, v240, s54
    v_perm_b32 v209, v243, v242, s54
    v_perm_b32 v210, v245, v244, s54
    v_perm_b32 v211, v247, v246, s54
    v_perm_b32 v212, v241, v240, s55
    v_perm_b32 v213, v243, v242, s55
    v_perm_b32 v214, v245, v244, s55
    v_perm_b32 v215, v247, v246, s55
    v_perm_b32 v216, v249, v248, s54
    v_perm_b32 v217, v251, v250, s54
    v_perm_b32 v218, v253, v252, s54
    v_perm_b32 v219, v255, v254, s54
    v_perm_b32 v220, v249, v248, s55
    v_perm_b32 v221, v251, v250, s55
    v_perm_b32 v222, v253, v252, s55
    v_perm_b32 v223, v255, v254, s55
    s_barrier
L_flags_4:
    v_cmp_gt_u32 vcc, 2, v17
    s_cbranch_vccz L_flagsok_5
    s_sleep 2
    global_load_dword v17, v16, s[28:29] sc1
    s_waitcnt vmcnt(0)
    s_sub_u32 s101, s101, 1
    s_cbranch_scc0 L_flags_4
    s_mov_b32 s101, 0
L_flagsok_5:
    s_lshl_b32 s58, s3, 18
    s_lshl_b32 s54, s52, 10
    s_add_u32 s58, s58, s54
    s_add_u32 s58, s58, 2097152
    s_lshl_b32 s59, s3, 11
    s_lshl_b32 s54, s52, 3
    s_add_u32 s59, s59, s54
    s_add_u32 s59, s59, 3145728
    s_mov_b32 s98, 0xffff0000
    v_and_b32 v5, 7, v1
    v_lshlrev_b32 v5, 8, v5
L_blight_6:
    buffer_load_dwordx2 v[232:233], v5, s[44:47], s59 offen sc1
    s_waitcnt vmcnt(0)
    v_max_u32 v6, v232, v233
    v_cmp_eq_u32 vcc, -1, v6
    s_cbranch_vccz L_bheavy_7
    s_sleep 2
    s_sub_u32 s101, s101, 1
    s_cbranch_scc0 L_blight_6
    s_mov_b32 s101, 0
L_bheavy_7:
    buffer_load_dwordx4 v[16:19], v2, s[44:47], s58 offen sc1 nt
    s_add_u32 s58, s58, 32768
    buffer_load_dwordx4 v[20:23], v2, s[44:47], s58 offen sc1 nt
    s_add_u32 s58, s58, 32768
    buffer_load_dwordx4 v[24:27], v2, s[44:47], s58 offen sc1 nt
    s_add_u32 s58, s58, 32768
    buffer_load_dwordx4 v[28:31], v2, s[44:47], s58 offen sc1 nt
    s_add_u32 s58, s58, 32768
    buffer_load_dwordx4 v[32:35], v2, s[44:47], s58 offen sc1 nt
    s_add_u32 s58, s58, 32768
    buffer_load_dwordx4 v[36:39], v2, s[44:47], s58 offen sc1 nt
    s_add_u32 s58, s58, 32768
    buffer_load_dwordx4 v[40:43], v2, s[44:47], s58 offen sc1 nt
    s_add_u32 s58, s58, 32768
    buffer_load_dwordx4 v[44:47], v2, s[44:47], s58 offen sc1 nt
    s_add_u32 s58, s58, 32768
    v_max_f32_dpp v234, v232, v232 row_ror:1 row_mask:0xf bank_mask:0xf
    s_nop 1
    v_max_f32_dpp v234, v234, v234 row_ror:2 row_mask:0xf bank_mask:0xf
    s_nop 1
    v_max_f32_dpp v234, v234, v234 row_ror:4 row_mask:0xf bank_mask:0xf
    v_sub_f32 v232, v232, v234
    v_exp_f32 v232, v232
    s_nop 0
    v_mul_f32 v232, v232, v233
    s_nop 1
    v_add_f32_dpp v234, v232, v232 row_ror:1 row_mask:0xf bank_mask:0xf
    s_nop 1
    v_add_f32_dpp v234, v234, v234 row_ror:2 row_mask:0xf bank_mask:0xf
    s_nop 1
    v_add_f32_dpp v234, v234, v234 row_ror:4 row_mask:0xf bank_mask:0xf
    v_rcp_f32 v234, v234
    s_nop 0
    v_mul_f32 v232, v232, v234
    s_waitcnt vmcnt(7)
    v_lshlrev_b32 v240, 16, v16
    v_and_b32 v16, s98, v16
    v_lshlrev_b32 v241, 16, v17
    v_and_b32 v17, s98, v17
    v_lshlrev_b32 v242, 16, v18
    v_and_b32 v18, s98, v18
    v_lshlrev_b32 v243, 16, v19
    v_and_b32 v19, s98, v19
    v_mul_f32_dpp v224, v232, v240 row_newbcast:0 row_mask:0xf bank_mask:0xf
    v_mul_f32_dpp v225, v232, v16 row_newbcast:0 row_mask:0xf bank_mask:0xf
    v_mul_f32_dpp v226, v232, v241 row_newbcast:0 row_mask:0xf bank_mask:0xf
    v_mul_f32_dpp v227, v232, v17 row_newbcast:0 row_mask:0xf bank_mask:0xf
    v_mul_f32_dpp v228, v232, v242 row_newbcast:0 row_mask:0xf bank_mask:0xf
    v_mul_f32_dpp v229, v232, v18 row_newbcast:0 row_mask:0xf bank_mask:0xf
    v_mul_f32_dpp v230, v232, v243 row_newbcast:0 row_mask:0xf bank_mask:0xf
    v_mul_f32_dpp v231, v232, v19 row_newbcast:0 row_mask:0xf bank_mask:0xf
    s_waitcnt vmcnt(6)
    v_lshlrev_b32 v240, 16, v20
    v_and_b32 v20, s98, v20
    v_lshlrev_b32 v241, 16, v21
    v_and_b32 v21, s98, v21
    v_lshlrev_b32 v242, 16, v22
    v_and_b32 v22, s98, v22
    v_lshlrev_b32 v243, 16, v23
    v_and_b32 v23, s98, v23
    v_fmac_f32_dpp v224, v232, v240 row_newbcast:1 row_mask:0xf bank_mask:0xf
    v_fmac_f32_dpp v225, v232, v20 row_newbcast:1 row_mask:0xf bank_mask:0xf
    v_fmac_f32_dpp v226, v232, v241 row_newbcast:1 row_mask:0xf bank_mask:0xf
    v_fmac_f32_dpp v227, v232, v21 row_newbcast:1 row_mask:0xf bank_mask:0xf
    v_fmac_f32_dpp v228, v232, v242 row_newbcast:1 row_mask:0xf bank_mask:0xf
    v_fmac_f32_dpp v229, v232, v22 row_newbcast:1 row_mask:0xf bank_mask:0xf
    v_fmac_f32_dpp v230, v232, v243 row_newbcast:1 row_mask:0xf bank_mask:0xf
    v_fmac_f32_dpp v231, v232, v23 row_newbcast:1 row_mask:0xf bank_mask:0xf
    s_waitcnt vmcnt(5)
    v_lshlrev_b32 v240, 16, v24
    v_and_b32 v24, s98, v24
    v_lshlrev_b32 v241, 16, v25
    v_and_b32 v25, s98, v25
    v_lshlrev_b32 v242, 16, v26
    v_and_b32 v26, s98, v26
    v_lshlrev_b32 v243, 16, v27
    v_and_b32 v27, s98, v27
    v_fmac_f32_dpp v224, v232, v240 row_newbcast:2 row_mask:0xf bank_mask:0xf
    v_fmac_f32_dpp v225, v232, v24 row_newbcast:2 row_mask:0xf bank_mask:0xf
    v_fmac_f32_dpp v226, v232, v241 row_newbcast:2 row_mask:0xf bank_mask:0xf
    v_fmac_f32_dpp v227, v232, v25 row_newbcast:2 row_mask:0xf bank_mask:0xf
    v_fmac_f32_dpp v228, v232, v242 row_newbcast:2 row_mask:0xf bank_mask:0xf
    v_fmac_f32_dpp v229, v232, v26 row_newbcast:2 row_mask:0xf bank_mask:0xf
    v_fmac_f32_dpp v230, v232, v243 row_newbcast:2 row_mask:0xf bank_mask:0xf
    v_fmac_f32_dpp v231, v232, v27 row_newbcast:2 row_mask:0xf bank_mask:0xf
    s_waitcnt vmcnt(4)
    v_lshlrev_b32 v240, 16, v28
    v_and_b32 v28, s98, v28
    v_lshlrev_b32 v241, 16, v29
    v_and_b32 v29, s98, v29
    v_lshlrev_b32 v242, 16, v30
    v_and_b32 v30, s98, v30
    v_lshlrev_b32 v243, 16, v31
    v_and_b32 v31, s98, v31
    v_fmac_f32_dpp v224, v232, v240 row_newbcast:3 row_mask:0xf bank_mask:0xf
    v_fmac_f32_dpp v225, v232, v28 row_newbcast:3 row_mask:0xf bank_mask:0xf
    v_fmac_f32_dpp v226, v232, v241 row_newbcast:3 row_mask:0xf bank_mask:0xf
    v_fmac_f32_dpp v227, v232, v29 row_newbcast:3 row_mask:0xf bank_mask:0xf
    v_fmac_f32_dpp v228, v232, v242 row_newbcast:3 row_mask:0xf bank_mask:0xf
    v_fmac_f32_dpp v229, v232, v30 row_newbcast:3 row_mask:0xf bank_mask:0xf
    v_fmac_f32_dpp v230, v232, v243 row_newbcast:3 row_mask:0xf bank_mask:0xf
    v_fmac_f32_dpp v231, v232, v31 row_newbcast:3 row_mask:0xf bank_mask:0xf
    s_waitcnt vmcnt(3)
    v_lshlrev_b32 v240, 16, v32
    v_and_b32 v32, s98, v32
    v_lshlrev_b32 v241, 16, v33
    v_and_b32 v33, s98, v33
    v_lshlrev_b32 v242, 16, v34
    v_and_b32 v34, s98, v34
    v_lshlrev_b32 v243, 16, v35
    v_and_b32 v35, s98, v35
    v_fmac_f32_dpp v224, v232, v240 row_newbcast:4 row_mask:0xf bank_mask:0xf
    v_fmac_f32_dpp v225, v232, v32 row_newbcast:4 row_mask:0xf bank_mask:0xf
    v_fmac_f32_dpp v226, v232, v241 row_newbcast:4 row_mask:0xf bank_mask:0xf
    v_fmac_f32_dpp v227, v232, v33 row_newbcast:4 row_mask:0xf bank_mask:0xf
    v_fmac_f32_dpp v228, v232, v242 row_newbcast:4 row_mask:0xf bank_mask:0xf
    v_fmac_f32_dpp v229, v232, v34 row_newbcast:4 row_mask:0xf bank_mask:0xf
    v_fmac_f32_dpp v230, v232, v243 row_newbcast:4 row_mask:0xf bank_mask:0xf
    v_fmac_f32_dpp v231, v232, v35 row_newbcast:4 row_mask:0xf bank_mask:0xf
    s_waitcnt vmcnt(2)
    v_lshlrev_b32 v240, 16, v36
    v_and_b32 v36, s98, v36
    v_lshlrev_b32 v241, 16, v37
    v_and_b32 v37, s98, v37
    v_lshlrev_b32 v242, 16, v38
    v_and_b32 v38, s98, v38
    v_lshlrev_b32 v243, 16, v39
    v_and_b32 v39, s98, v39
    v_fmac_f32_dpp v224, v232, v240 row_newbcast:5 row_mask:0xf bank_mask:0xf
    v_fmac_f32_dpp v225, v232, v36 row_newbcast:5 row_mask:0xf bank_mask:0xf
    v_fmac_f32_dpp v226, v232, v241 row_newbcast:5 row_mask:0xf bank_mask:0xf
    v_fmac_f32_dpp v227, v232, v37 row_newbcast:5 row_mask:0xf bank_mask:0xf
    v_fmac_f32_dpp v228, v232, v242 row_newbcast:5 row_mask:0xf bank_mask:0xf
    v_fmac_f32_dpp v229, v232, v38 row_newbcast:5 row_mask:0xf bank_mask:0xf
    v_fmac_f32_dpp v230, v232, v243 row_newbcast:5 row_mask:0xf bank_mask:0xf
    v_fmac_f32_dpp v231, v232, v39 row_newbcast:5 row_mask:0xf bank_mask:0xf
    s_waitcnt vmcnt(1)
    v_lshlrev_b32 v240, 16, v40
    v_and_b32 v40, s98, v40
    v_lshlrev_b32 v241, 16, v41
    v_and_b32 v41, s98, v41
    v_lshlrev_b32 v242, 16, v42
    v_and_b32 v42, s98, v42
    v_lshlrev_b32 v243, 16, v43
    v_and_b32 v43, s98, v43
    v_fmac_f32_dpp v224, v232, v240 row_newbcast:6 row_mask:0xf bank_mask:0xf
    v_fmac_f32_dpp v225, v232, v40 row_newbcast:6 row_mask:0xf bank_mask:0xf
    v_fmac_f32_dpp v226, v232, v241 row_newbcast:6 row_mask:0xf bank_mask:0xf
    v_fmac_f32_dpp v227, v232, v41 row_newbcast:6 row_mask:0xf bank_mask:0xf
    v_fmac_f32_dpp v228, v232, v242 row_newbcast:6 row_mask:0xf bank_mask:0xf
    v_fmac_f32_dpp v229, v232, v42 row_newbcast:6 row_mask:0xf bank_mask:0xf
    v_fmac_f32_dpp v230, v232, v243 row_newbcast:6 row_mask:0xf bank_mask:0xf
    v_fmac_f32_dpp v231, v232, v43 row_newbcast:6 row_mask:0xf bank_mask:0xf
    s_waitcnt vmcnt(0)
    v_lshlrev_b32 v240, 16, v44
    v_and_b32 v44, s98, v44
    v_lshlrev_b32 v241, 16, v45
    v_and_b32 v45, s98, v45
    v_lshlrev_b32 v242, 16, v46
    v_and_b32 v46, s98, v46
    v_lshlrev_b32 v243, 16, v47
    v_and_b32 v47, s98, v47
    v_fmac_f32_dpp v224, v232, v240 row_newbcast:7 row_mask:0xf bank_mask:0xf
    v_fmac_f32_dpp v225, v232, v44 row_newbcast:7 row_mask:0xf bank_mask:0xf
    v_fmac_f32_dpp v226, v232, v241 row_newbcast:7 row_mask:0xf bank_mask:0xf
    v_fmac_f32_dpp v227, v232, v45 row_newbcast:7 row_mask:0xf bank_mask:0xf
    v_fmac_f32_dpp v228, v232, v242 row_newbcast:7 row_mask:0xf bank_mask:0xf
    v_fmac_f32_dpp v229, v232, v46 row_newbcast:7 row_mask:0xf bank_mask:0xf
    v_fmac_f32_dpp v230, v232, v243 row_newbcast:7 row_mask:0xf bank_mask:0xf
    v_fmac_f32_dpp v231, v232, v47 row_newbcast:7 row_mask:0xf bank_mask:0xf
    v_cvt_pk_bf16_f32 v244, v224, v225
    v_cvt_pk_bf16_f32 v245, v226, v227
    v_cvt_pk_bf16_f32 v246, v228, v229
    v_cvt_pk_bf16_f32 v247, v230, v231
    s_lshl_b32 s54, s3, 10
    v_add_u32 v5, s54, v2
    ds_write_b128 v5, v[244:247]
    v_lshrrev_b32 v5, 3, v3
    v_lshlrev_b32 v5, 10, v5
    v_lshl_add_u32 v5, v4, 6, v5
    s_lshl_b32 s54, s3, 8
    v_add_u32 v5, s54, v5
    s_waitcnt lgkmcnt(0)
    s_barrier
    ds_read_b128 v[16:19], v5 offset:0
    ds_read_b128 v[20:23], v5 offset:16
    ds_read_b128 v[24:27], v5 offset:32
    ds_read_b128 v[28:31], v5 offset:48
    ds_read_b128 v[32:35], v5 offset:2048
    ds_read_b128 v[36:39], v5 offset:2064
    ds_read_b128 v[40:43], v5 offset:2080
    ds_read_b128 v[44:47], v5 offset:2096
    s_waitcnt lgkmcnt(0)
    v_perm_b32 v48, v16, v16, v8
    v_perm_b32 v49, v16, v16, v10
    v_perm_b32 v50, v16, v16, v12
    v_perm_b32 v51, v16, v16, v14
    s_nop 1
    v_mfma_f32_16x16x32_bf16 v[224:227], v[48:51], a[0:3], 0
    v_perm_b32 v52, v32, v32, v8
    v_perm_b32 v53, v32, v32, v10
    v_perm_b32 v54, v32, v32, v12
    v_perm_b32 v55, v32, v32, v14
    s_nop 1
    v_mfma_f32_16x16x32_bf16 v[228:231], v[52:55], a[0:3], 0
    v_perm_b32 v56, v16, v16, v9
    v_perm_b32 v57, v16, v16, v11
    v_perm_b32 v58, v16, v16, v13
    v_perm_b32 v59, v16, v16, v15
    s_nop 1
    v_mfma_f32_16x16x32_bf16 v[224:227], v[56:59], a[4:7], v[224:227]
    v_perm_b32 v60, v32, v32, v9
    v_perm_b32 v61, v32, v32, v11
    v_perm_b32 v62, v32, v32, v13
    v_perm_b32 v63, v32, v32, v15
    s_nop 1
    v_mfma_f32_16x16x32_bf16 v[228:231], v[60:63], a[4:7], v[228:231]
    v_perm_b32 v48, v17, v17, v8
    v_perm_b32 v49, v17, v17, v10
    v_perm_b32 v50, v17, v17, v12
    v_perm_b32 v51, v17, v17, v14
    s_nop 1
    v_mfma_f32_16x16x32_bf16 v[224:227], v[48:51], a[8:11], v[224:227]
    v_perm_b32 v52, v33, v33, v8
    v_perm_b32 v53, v33, v33, v10
    v_perm_b32 v54, v33, v33, v12
    v_perm_b32 v55, v33, v33, v14
    s_nop 1
    v_mfma_f32_16x16x32_bf16 v[228:231], v[52:55], a[8:11], v[228:231]
    v_perm_b32 v56, v17, v17, v9
    v_perm_b32 v57, v17, v17, v11
    v_perm_b32 v58, v17, v17, v13
    v_perm_b32 v59, v17, v17, v15
    s_nop 1
    v_mfma_f32_16x16x32_bf16 v[224:227], v[56:59], a[12:15], v[224:227]
    v_perm_b32 v60, v33, v33, v9
    v_perm_b32 v61, v33, v33, v11
    v_perm_b32 v62, v33, v33, v13
    v_perm_b32 v63, v33, v33, v15
    s_nop 1
    v_mfma_f32_16x16x32_bf16 v[228:231], v[60:63], a[12:15], v[228:231]
    v_perm_b32 v48, v18, v18, v8
    v_perm_b32 v49, v18, v18, v10
    v_perm_b32 v50, v18, v18, v12
    v_perm_b32 v51, v18, v18, v14
    s_nop 1
    v_mfma_f32_16x16x32_bf16 v[224:227], v[48:51], a[16:19], v[224:227]
    v_perm_b32 v52, v34, v34, v8
    v_perm_b32 v53, v34, v34, v10
    v_perm_b32 v54, v34, v34, v12
    v_perm_b32 v55, v34, v34, v14
    s_nop 1
    v_mfma_f32_16x16x32_bf16 v[228:231], v[52:55], a[16:19], v[228:231]
    v_perm_b32 v56, v18, v18, v9
    v_perm_b32 v57, v18, v18, v11
    v_perm_b32 v58, v18, v18, v13
    v_perm_b32 v59, v18, v18, v15
    s_nop 1
    v_mfma_f32_16x16x32_bf16 v[224:227], v[56:59], a[20:23], v[224:227]
    v_perm_b32 v60, v34, v34, v9
    v_perm_b32 v61, v34, v34, v11
    v_perm_b32 v62, v34, v34, v13
    v_perm_b32 v63, v34, v34, v15
    s_nop 1
    v_mfma_f32_16x16x32_bf16 v[228:231], v[60:63], a[20:23], v[228:231]
    v_perm_b32 v48, v19, v19, v8
    v_perm_b32 v49, v19, v19, v10
    v_perm_b32 v50, v19, v19, v12
    v_perm_b32 v51, v19, v19, v14
    s_nop 1
    v_mfma_f32_16x16x32_bf16 v[224:227], v[48:51], a[24:27], v[224:227]
    v_perm_b32 v52, v35, v35, v8
    v_perm_b32 v53, v35, v35, v10
    v_perm_b32 v54, v35, v35, v12
    v_perm_b32 v55, v35, v35, v14
    s_nop 1
    v_mfma_f32_16x16x32_bf16 v[228:231], v[52:55], a[24:27], v[228:231]
    v_perm_b32 v56, v19, v19, v9
    v_perm_b32 v57, v19, v19, v11
    v_perm_b32 v58, v19, v19, v13
    v_perm_b32 v59, v19, v19, v15
    s_nop 1
    v_mfma_f32_16x16x32_bf16 v[224:227], v[56:59], a[28:31], v[224:227]
    v_perm_b32 v60, v35, v35, v9
    v_perm_b32 v61, v35, v35, v11
    v_perm_b32 v62, v35, v35, v13
    v_perm_b32 v63, v35, v35, v15
    s_nop 1
    v_mfma_f32_16x16x32_bf16 v[228:231], v[60:63], a[28:31], v[228:231]
    v_perm_b32 v48, v20, v20, v8
    v_perm_b32 v49, v20, v20, v10
    v_perm_b32 v50, v20, v20, v12
    v_perm_b32 v51, v20, v20, v14
    s_nop 1
    v_mfma_f32_16x16x32_bf16 v[224:227], v[48:51], a[32:35], v[224:227]
    v_perm_b32 v52, v36, v36, v8
    v_perm_b32 v53, v36, v36, v10
    v_perm_b32 v54, v36, v36, v12
    v_perm_b32 v55, v36, v36, v14
    s_nop 1
    v_mfma_f32_16x16x32_bf16 v[228:231], v[52:55], a[32:35], v[228:231]
    v_perm_b32 v56, v20, v20, v9
    v_perm_b32 v57, v20, v20, v11
    v_perm_b32 v58, v20, v20, v13
    v_perm_b32 v59, v20, v20, v15
    s_nop 1
    v_mfma_f32_16x16x32_bf16 v[224:227], v[56:59], a[36:39], v[224:227]
    v_perm_b32 v60, v36, v36, v9
    v_perm_b32 v61, v36, v36, v11
    v_perm_b32 v62, v36, v36, v13
    v_perm_b32 v63, v36, v36, v15
    s_nop 1
    v_mfma_f32_16x16x32_bf16 v[228:231], v[60:63], a[36:39], v[228:231]
    v_perm_b32 v48, v21, v21, v8
    v_perm_b32 v49, v21, v21, v10
    v_perm_b32 v50, v21, v21, v12
    v_perm_b32 v51, v21, v21, v14
    s_nop 1
    v_mfma_f32_16x16x32_bf16 v[224:227], v[48:51], a[40:43], v[224:227]
    v_perm_b32 v52, v37, v37, v8
    v_perm_b32 v53, v37, v37, v10
    v_perm_b32 v54, v37, v37, v12
    v_perm_b32 v55, v37, v37, v14
    s_nop 1
    v_mfma_f32_16x16x32_bf16 v[228:231], v[52:55], a[40:43], v[228:231]
    v_perm_b32 v56, v21, v21, v9
    v_perm_b32 v57, v21, v21, v11
    v_perm_b32 v58, v21, v21, v13
    v_perm_b32 v59, v21, v21, v15
    s_nop 1
    v_mfma_f32_16x16x32_bf16 v[224:227], v[56:59], a[44:47], v[224:227]
    v_perm_b32 v60, v37, v37, v9
    v_perm_b32 v61, v37, v37, v11
    v_perm_b32 v62, v37, v37, v13
    v_perm_b32 v63, v37, v37, v15
    s_nop 1
    v_mfma_f32_16x16x32_bf16 v[228:231], v[60:63], a[44:47], v[228:231]
    v_perm_b32 v48, v22, v22, v8
    v_perm_b32 v49, v22, v22, v10
    v_perm_b32 v50, v22, v22, v12
    v_perm_b32 v51, v22, v22, v14
    s_nop 1
    v_mfma_f32_16x16x32_bf16 v[224:227], v[48:51], a[48:51], v[224:227]
    v_perm_b32 v52, v38, v38, v8
    v_perm_b32 v53, v38, v38, v10
    v_perm_b32 v54, v38, v38, v12
    v_perm_b32 v55, v38, v38, v14
    s_nop 1
    v_mfma_f32_16x16x32_bf16 v[228:231], v[52:55], a[48:51], v[228:231]
    v_perm_b32 v56, v22, v22, v9
    v_perm_b32 v57, v22, v22, v11
    v_perm_b32 v58, v22, v22, v13
    v_perm_b32 v59, v22, v22, v15
    s_nop 1
    v_mfma_f32_16x16x32_bf16 v[224:227], v[56:59], a[52:55], v[224:227]
    v_perm_b32 v60, v38, v38, v9
    v_perm_b32 v61, v38, v38, v11
    v_perm_b32 v62, v38, v38, v13
    v_perm_b32 v63, v38, v38, v15
    s_nop 1
    v_mfma_f32_16x16x32_bf16 v[228:231], v[60:63], a[52:55], v[228:231]
    v_perm_b32 v48, v23, v23, v8
    v_perm_b32 v49, v23, v23, v10
    v_perm_b32 v50, v23, v23, v12
    v_perm_b32 v51, v23, v23, v14
    s_nop 1
    v_mfma_f32_16x16x32_bf16 v[224:227], v[48:51], a[56:59], v[224:227]
    v_perm_b32 v52, v39, v39, v8
    v_perm_b32 v53, v39, v39, v10
    v_perm_b32 v54, v39, v39, v12
    v_perm_b32 v55, v39, v39, v14
    s_nop 1
    v_mfma_f32_16x16x32_bf16 v[228:231], v[52:55], a[56:59], v[228:231]
    v_perm_b32 v56, v23, v23, v9
    v_perm_b32 v57, v23, v23, v11
    v_perm_b32 v58, v23, v23, v13
    v_perm_b32 v59, v23, v23, v15
    s_nop 1
    v_mfma_f32_16x16x32_bf16 v[224:227], v[56:59], a[60:63], v[224:227]
    v_perm_b32 v60, v39, v39, v9
    v_perm_b32 v61, v39, v39, v11
    v_perm_b32 v62, v39, v39, v13
    v_perm_b32 v63, v39, v39, v15
    s_nop 1
    v_mfma_f32_16x16x32_bf16 v[228:231], v[60:63], a[60:63], v[228:231]
    v_perm_b32 v48, v24, v24, v8
    v_perm_b32 v49, v24, v24, v10
    v_perm_b32 v50, v24, v24, v12
    v_perm_b32 v51, v24, v24, v14
    s_nop 1
    v_mfma_f32_16x16x32_bf16 v[224:227], v[48:51], a[64:67], v[224:227]
    v_perm_b32 v52, v40, v40, v8
    v_perm_b32 v53, v40, v40, v10
    v_perm_b32 v54, v40, v40, v12
    v_perm_b32 v55, v40, v40, v14
    s_nop 1
    v_mfma_f32_16x16x32_bf16 v[228:231], v[52:55], a[64:67], v[228:231]
    v_perm_b32 v56, v24, v24, v9
    v_perm_b32 v57, v24, v24, v11
    v_perm_b32 v58, v24, v24, v13
    v_perm_b32 v59, v24, v24, v15
    s_nop 1
    v_mfma_f32_16x16x32_bf16 v[224:227], v[56:59], a[68:71], v[224:227]
    v_perm_b32 v60, v40, v40, v9
    v_perm_b32 v61, v40, v40, v11
    v_perm_b32 v62, v40, v40, v13
    v_perm_b32 v63, v40, v40, v15
    s_nop 1
    v_mfma_f32_16x16x32_bf16 v[228:231], v[60:63], a[68:71], v[228:231]
    v_perm_b32 v48, v25, v25, v8
    v_perm_b32 v49, v25, v25, v10
    v_perm_b32 v50, v25, v25, v12
    v_perm_b32 v51, v25, v25, v14
    s_nop 1
    v_mfma_f32_16x16x32_bf16 v[224:227], v[48:51], a[72:75], v[224:227]
    v_perm_b32 v52, v41, v41, v8
    v_perm_b32 v53, v41, v41, v10
    v_perm_b32 v54, v41, v41, v12
    v_perm_b32 v55, v41, v41, v14
    s_nop 1
    v_mfma_f32_16x16x32_bf16 v[228:231], v[52:55], a[72:75], v[228:231]
    v_perm_b32 v56, v25, v25, v9
    v_perm_b32 v57, v25, v25, v11
    v_perm_b32 v58, v25, v25, v13
    v_perm_b32 v59, v25, v25, v15
    s_nop 1
    v_mfma_f32_16x16x32_bf16 v[224:227], v[56:59], a[76:79], v[224:227]
    v_perm_b32 v60, v41, v41, v9
    v_perm_b32 v61, v41, v41, v11
    v_perm_b32 v62, v41, v41, v13
    v_perm_b32 v63, v41, v41, v15
    s_nop 1
    v_mfma_f32_16x16x32_bf16 v[228:231], v[60:63], a[76:79], v[228:231]
    v_perm_b32 v48, v26, v26, v8
    v_perm_b32 v49, v26, v26, v10
    v_perm_b32 v50, v26, v26, v12
    v_perm_b32 v51, v26, v26, v14
    s_nop 1
    v_mfma_f32_16x16x32_bf16 v[224:227], v[48:51], a[80:83], v[224:227]
    v_perm_b32 v52, v42, v42, v8
    v_perm_b32 v53, v42, v42, v10
    v_perm_b32 v54, v42, v42, v12
    v_perm_b32 v55, v42, v42, v14
    s_nop 1
    v_mfma_f32_16x16x32_bf16 v[228:231], v[52:55], a[80:83], v[228:231]
    v_perm_b32 v56, v26, v26, v9
    v_perm_b32 v57, v26, v26, v11
    v_perm_b32 v58, v26, v26, v13
    v_perm_b32 v59, v26, v26, v15
    s_nop 1
    v_mfma_f32_16x16x32_bf16 v[224:227], v[56:59], a[84:87], v[224:227]
    v_perm_b32 v60, v42, v42, v9
    v_perm_b32 v61, v42, v42, v11
    v_perm_b32 v62, v42, v42, v13
    v_perm_b32 v63, v42, v42, v15
    s_nop 1
    v_mfma_f32_16x16x32_bf16 v[228:231], v[60:63], a[84:87], v[228:231]
    v_perm_b32 v48, v27, v27, v8
    v_perm_b32 v49, v27, v27, v10
    v_perm_b32 v50, v27, v27, v12
    v_perm_b32 v51, v27, v27, v14
    s_nop 1
    v_mfma_f32_16x16x32_bf16 v[224:227], v[48:51], a[88:91], v[224:227]
    v_perm_b32 v52, v43, v43, v8
    v_perm_b32 v53, v43, v43, v10
    v_perm_b32 v54, v43, v43, v12
    v_perm_b32 v55, v43, v43, v14
    s_nop 1
    v_mfma_f32_16x16x32_bf16 v[228:231], v[52:55], a[88:91], v[228:231]
    v_perm_b32 v56, v27, v27, v9
    v_perm_b32 v57, v27, v27, v11
    v_perm_b32 v58, v27, v27, v13
    v_perm_b32 v59, v27, v27, v15
    s_nop 1
    v_mfma_f32_16x16x32_bf16 v[224:227], v[56:59], a[92:95], v[224:227]
    v_perm_b32 v60, v43, v43, v9
    v_perm_b32 v61, v43, v43, v11
    v_perm_b32 v62, v43, v43, v13
    v_perm_b32 v63, v43, v43, v15
    s_nop 1
    v_mfma_f32_16x16x32_bf16 v[228:231], v[60:63], a[92:95], v[228:231]
    v_perm_b32 v48, v28, v28, v8
    v_perm_b32 v49, v28, v28, v10
    v_perm_b32 v50, v28, v28, v12
    v_perm_b32 v51, v28, v28, v14
    s_nop 1
    v_mfma_f32_16x16x32_bf16 v[224:227], v[48:51], a[96:99], v[224:227]
    v_perm_b32 v52, v44, v44, v8
    v_perm_b32 v53, v44, v44, v10
    v_perm_b32 v54, v44, v44, v12
    v_perm_b32 v55, v44, v44, v14
    s_nop 1
    v_mfma_f32_16x16x32_bf16 v[228:231], v[52:55], a[96:99], v[228:231]
    v_perm_b32 v56, v28, v28, v9
    v_perm_b32 v57, v28, v28, v11
    v_perm_b32 v58, v28, v28, v13
    v_perm_b32 v59, v28, v28, v15
    s_nop 1
    v_mfma_f32_16x16x32_bf16 v[224:227], v[56:59], a[100:103], v[224:227]
    v_perm_b32 v60, v44, v44, v9
    v_perm_b32 v61, v44, v44, v11
    v_perm_b32 v62, v44, v44, v13
    v_perm_b32 v63, v44, v44, v15
    s_nop 1
    v_mfma_f32_16x16x32_bf16 v[228:231], v[60:63], a[100:103], v[228:231]
    v_perm_b32 v48, v29, v29, v8
    v_perm_b32 v49, v29, v29, v10
    v_perm_b32 v50, v29, v29, v12
    v_perm_b32 v51, v29, v29, v14
    s_nop 1
    v_mfma_f32_16x16x32_bf16 v[224:227], v[48:51], a[104:107], v[224:227]
    v_perm_b32 v52, v45, v45, v8
    v_perm_b32 v53, v45, v45, v10
    v_perm_b32 v54, v45, v45, v12
    v_perm_b32 v55, v45, v45, v14
    s_nop 1
    v_mfma_f32_16x16x32_bf16 v[228:231], v[52:55], a[104:107], v[228:231]
    v_perm_b32 v56, v29, v29, v9
    v_perm_b32 v57, v29, v29, v11
    v_perm_b32 v58, v29, v29, v13
    v_perm_b32 v59, v29, v29, v15
    s_nop 1
    v_mfma_f32_16x16x32_bf16 v[224:227], v[56:59], a[108:111], v[224:227]
    v_perm_b32 v60, v45, v45, v9
    v_perm_b32 v61, v45, v45, v11
    v_perm_b32 v62, v45, v45, v13
    v_perm_b32 v63, v45, v45, v15
    s_nop 1
    v_mfma_f32_16x16x32_bf16 v[228:231], v[60:63], a[108:111], v[228:231]
    v_perm_b32 v48, v30, v30, v8
    v_perm_b32 v49, v30, v30, v10
    v_perm_b32 v50, v30, v30, v12
    v_perm_b32 v51, v30, v30, v14
    s_nop 1
    v_mfma_f32_16x16x32_bf16 v[224:227], v[48:51], a[112:115], v[224:227]
    v_perm_b32 v52, v46, v46, v8
    v_perm_b32 v53, v46, v46, v10
    v_perm_b32 v54, v46, v46, v12
    v_perm_b32 v55, v46, v46, v14
    s_nop 1
    v_mfma_f32_16x16x32_bf16 v[228:231], v[52:55], a[112:115], v[228:231]
    v_perm_b32 v56, v30, v30, v9
    v_perm_b32 v57, v30, v30, v11
    v_perm_b32 v58, v30, v30, v13
    v_perm_b32 v59, v30, v30, v15
    s_nop 1
    v_mfma_f32_16x16x32_bf16 v[224:227], v[56:59], a[116:119], v[224:227]
    v_perm_b32 v60, v46, v46, v9
    v_perm_b32 v61, v46, v46, v11
    v_perm_b32 v62, v46, v46, v13
    v_perm_b32 v63, v46, v46, v15
    s_nop 1
    v_mfma_f32_16x16x32_bf16 v[228:231], v[60:63], a[116:119], v[228:231]
    v_perm_b32 v48, v31, v31, v8
    v_perm_b32 v49, v31, v31, v10
    v_perm_b32 v50, v31, v31, v12
    v_perm_b32 v51, v31, v31, v14
    s_nop 1
    v_mfma_f32_16x16x32_bf16 v[224:227], v[48:51], a[120:123], v[224:227]
    v_perm_b32 v52, v47, v47, v8
    v_perm_b32 v53, v47, v47, v10
    v_perm_b32 v54, v47, v47, v12
    v_perm_b32 v55, v47, v47, v14
    s_nop 1
    v_mfma_f32_16x16x32_bf16 v[228:231], v[52:55], a[120:123], v[228:231]
    v_perm_b32 v56, v31, v31, v9
    v_perm_b32 v57, v31, v31, v11
    v_perm_b32 v58, v31, v31, v13
    v_perm_b32 v59, v31, v31, v15
    s_nop 1
    v_mfma_f32_16x16x32_bf16 v[224:227], v[56:59], a[124:127], v[224:227]
    v_perm_b32 v60, v47, v47, v9
    v_perm_b32 v61, v47, v47, v11
    v_perm_b32 v62, v47, v47, v13
    v_perm_b32 v63, v47, v47, v15
    s_nop 1
    v_mfma_f32_16x16x32_bf16 v[228:231], v[60:63], a[124:127], v[228:231]
    v_lshrrev_b32 v5, 1, v4
    v_lshlrev_b32 v5, 9, v5
    v_lshl_add_u32 v5, v3, 5, v5
    v_and_b32 v6, 1, v4
    v_lshl_add_u32 v5, v6, 4, v5
    s_lshl_b32 s54, s3, 11
    s_add_u32 s54, s54, 131072
    v_add_u32 v5, s54, v5
    ds_write_b128 v5, v[224:227]
    ds_write_b128 v5, v[228:231] offset:1024
    s_waitcnt lgkmcnt(0)
    s_barrier
    v_lshrrev_b32 v5, 2, v3
    v_lshlrev_b32 v5, 9, v5
    v_lshl_add_u32 v5, v4, 5, v5
    v_add_u32 v5, 131072, v5
    ds_read_b128 v[16:19], v5 offset:0
    ds_read_b128 v[20:23], v5 offset:16
    ds_read_b128 v[24:27], v5 offset:2048
    ds_read_b128 v[28:31], v5 offset:2064
    ds_read_b128 v[32:35], v5 offset:4096
    ds_read_b128 v[36:39], v5 offset:4112
    ds_read_b128 v[40:43], v5 offset:6144
    ds_read_b128 v[44:47], v5 offset:6160
    s_waitcnt lgkmcnt(0)
    v_add_f32 v16, v16, v24
    v_add_f32 v32, v32, v40
    v_add_f32 v17, v17, v25
    v_add_f32 v33, v33, v41
    v_add_f32 v18, v18, v26
    v_add_f32 v34, v34, v42
    v_add_f32 v19, v19, v27
    v_add_f32 v35, v35, v43
    v_add_f32 v20, v20, v28
    v_add_f32 v36, v36, v44
    v_add_f32 v21, v21, v29
    v_add_f32 v37, v37, v45
    v_add_f32 v22, v22, v30
    v_add_f32 v38, v38, v46
    v_add_f32 v23, v23, v31
    v_add_f32 v39, v39, v47
    v_add_f32 v16, v16, v32
    v_add_f32 v17, v17, v33
    v_add_f32 v18, v18, v34
    v_add_f32 v19, v19, v35
    v_add_f32 v20, v20, v36
    v_add_f32 v21, v21, v37
    v_add_f32 v22, v22, v38
    v_add_f32 v23, v23, v39
    v_cvt_pk_bf16_f32 v48, v16, v17
    v_cvt_pk_bf16_f32 v49, v18, v19
    v_cvt_pk_bf16_f32 v50, v20, v21
    v_cvt_pk_bf16_f32 v51, v22, v23
    ds_read_b128 v[16:19], v5 offset:128
    ds_read_b128 v[20:23], v5 offset:144
    ds_read_b128 v[24:27], v5 offset:2176
    ds_read_b128 v[28:31], v5 offset:2192
    ds_read_b128 v[32:35], v5 offset:4224
    ds_read_b128 v[36:39], v5 offset:4240
    ds_read_b128 v[40:43], v5 offset:6272
    ds_read_b128 v[44:47], v5 offset:6288
    s_waitcnt lgkmcnt(0)
    v_add_f32 v16, v16, v24
    v_add_f32 v32, v32, v40
    v_add_f32 v17, v17, v25
    v_add_f32 v33, v33, v41
    v_add_f32 v18, v18, v26
    v_add_f32 v34, v34, v42
    v_add_f32 v19, v19, v27
    v_add_f32 v35, v35, v43
    v_add_f32 v20, v20, v28
    v_add_f32 v36, v36, v44
    v_add_f32 v21, v21, v29
    v_add_f32 v37, v37, v45
    v_add_f32 v22, v22, v30
    v_add_f32 v38, v38, v46
    v_add_f32 v23, v23, v31
    v_add_f32 v39, v39, v47
    v_add_f32 v16, v16, v32
    v_add_f32 v17, v17, v33
    v_add_f32 v18, v18, v34
    v_add_f32 v19, v19, v35
    v_add_f32 v20, v20, v36
    v_add_f32 v21, v21, v37
    v_add_f32 v22, v22, v38
    v_add_f32 v23, v23, v39
    v_cvt_pk_bf16_f32 v52, v16, v17
    v_cvt_pk_bf16_f32 v53, v18, v19
    v_cvt_pk_bf16_f32 v54, v20, v21
    v_cvt_pk_bf16_f32 v55, v22, v23
    ds_read_b128 v[16:19], v5 offset:256
    ds_read_b128 v[20:23], v5 offset:272
    ds_read_b128 v[24:27], v5 offset:2304
    ds_read_b128 v[28:31], v5 offset:2320
    ds_read_b128 v[32:35], v5 offset:4352
    ds_read_b128 v[36:39], v5 offset:4368
    ds_read_b128 v[40:43], v5 offset:6400
    ds_read_b128 v[44:47], v5 offset:6416
    s_waitcnt lgkmcnt(0)
    v_add_f32 v16, v16, v24
    v_add_f32 v32, v32, v40
    v_add_f32 v17, v17, v25
    v_add_f32 v33, v33, v41
    v_add_f32 v18, v18, v26
    v_add_f32 v34, v34, v42
    v_add_f32 v19, v19, v27
    v_add_f32 v35, v35, v43
    v_add_f32 v20, v20, v28
    v_add_f32 v36, v36, v44
    v_add_f32 v21, v21, v29
    v_add_f32 v37, v37, v45
    v_add_f32 v22, v22, v30
    v_add_f32 v38, v38, v46
    v_add_f32 v23, v23, v31
    v_add_f32 v39, v39, v47
    v_add_f32 v16, v16, v32
    v_add_f32 v17, v17, v33
    v_add_f32 v18, v18, v34
    v_add_f32 v19, v19, v35
    v_add_f32 v20, v20, v36
    v_add_f32 v21, v21, v37
    v_add_f32 v22, v22, v38
    v_add_f32 v23, v23, v39
    v_cvt_pk_bf16_f32 v56, v16, v17
    v_cvt_pk_bf16_f32 v57, v18, v19
    v_cvt_pk_bf16_f32 v58, v20, v21
    v_cvt_pk_bf16_f32 v59, v22, v23
    ds_read_b128 v[16:19], v5 offset:384
    ds_read_b128 v[20:23], v5 offset:400
    ds_read_b128 v[24:27], v5 offset:2432
    ds_read_b128 v[28:31], v5 offset:2448
    ds_read_b128 v[32:35], v5 offset:4480
    ds_read_b128 v[36:39], v5 offset:4496
    ds_read_b128 v[40:43], v5 offset:6528
    ds_read_b128 v[44:47], v5 offset:6544
    s_waitcnt lgkmcnt(0)
    v_add_f32 v16, v16, v24
    v_add_f32 v32, v32, v40
    v_add_f32 v17, v17, v25
    v_add_f32 v33, v33, v41
    v_add_f32 v18, v18, v26
    v_add_f32 v34, v34, v42
    v_add_f32 v19, v19, v27
    v_add_f32 v35, v35, v43
    v_add_f32 v20, v20, v28
    v_add_f32 v36, v36, v44
    v_add_f32 v21, v21, v29
    v_add_f32 v37, v37, v45
    v_add_f32 v22, v22, v30
    v_add_f32 v38, v38, v46
    v_add_f32 v23, v23, v31
    v_add_f32 v39, v39, v47
    v_add_f32 v16, v16, v32
    v_add_f32 v17, v17, v33
    v_add_f32 v18, v18, v34
    v_add_f32 v19, v19, v35
    v_add_f32 v20, v20, v36
    v_add_f32 v21, v21, v37
    v_add_f32 v22, v22, v38
    v_add_f32 v23, v23, v39
    v_cvt_pk_bf16_f32 v60, v16, v17
    v_cvt_pk_bf16_f32 v61, v18, v19
    v_cvt_pk_bf16_f32 v62, v20, v21
    v_cvt_pk_bf16_f32 v63, v22, v23
    v_mfma_f32_16x16x32_bf16 v[224:227], v[48:51], v[64:67], 0
    v_mfma_f32_16x16x32_bf16 v[228:231], v[48:51], v[68:71], 0
    v_mfma_f32_16x16x32_bf16 v[232:235], v[48:51], v[72:75], 0
    v_mfma_f32_16x16x32_bf16 v[236:239], v[48:51], v[76:79], 0
    v_mfma_f32_16x16x32_bf16 v[240:243], v[48:51], v[80:83], 0
    v_mfma_f32_16x16x32_bf16 v[244:247], v[48:51], v[84:87], 0
    v_mfma_f32_16x16x32_bf16 v[248:251], v[48:51], v[88:91], 0
    v_mfma_f32_16x16x32_bf16 v[252:255], v[48:51], v[92:95], 0
    v_mfma_f32_16x16x32_bf16 v[40:43], v[48:51], v[192:195], 0
    v_mfma_f32_16x16x32_bf16 v[44:47], v[48:51], v[196:199], 0
    v_mfma_f32_16x16x32_bf16 v[224:227], v[52:55], v[96:99], v[224:227]
    v_mfma_f32_16x16x32_bf16 v[228:231], v[52:55], v[100:103], v[228:231]
    v_mfma_f32_16x16x32_bf16 v[232:235], v[52:55], v[104:107], v[232:235]
    v_mfma_f32_16x16x32_bf16 v[236:239], v[52:55], v[108:111], v[236:239]
    v_mfma_f32_16x16x32_bf16 v[240:243], v[52:55], v[112:115], v[240:243]
    v_mfma_f32_16x16x32_bf16 v[244:247], v[52:55], v[116:119], v[244:247]
    v_mfma_f32_16x16x32_bf16 v[248:251], v[52:55], v[120:123], v[248:251]
    v_mfma_f32_16x16x32_bf16 v[252:255], v[52:55], v[124:127], v[252:255]
    v_mfma_f32_16x16x32_bf16 v[40:43], v[52:55], v[200:203], v[40:43]
    v_mfma_f32_16x16x32_bf16 v[44:47], v[52:55], v[204:207], v[44:47]
    v_mfma_f32_16x16x32_bf16 v[224:227], v[56:59], v[128:131], v[224:227]
    v_mfma_f32_16x16x32_bf16 v[228:231], v[56:59], v[132:135], v[228:231]
    v_mfma_f32_16x16x32_bf16 v[232:235], v[56:59], v[136:139], v[232:235]
    v_mfma_f32_16x16x32_bf16 v[236:239], v[56:59], v[140:143], v[236:239]
    v_mfma_f32_16x16x32_bf16 v[240:243], v[56:59], v[144:147], v[240:243]
    v_mfma_f32_16x16x32_bf16 v[244:247], v[56:59], v[148:151], v[244:247]
    v_mfma_f32_16x16x32_bf16 v[248:251], v[56:59], v[152:155], v[248:251]
    v_mfma_f32_16x16x32_bf16 v[252:255], v[56:59], v[156:159], v[252:255]
    v_mfma_f32_16x16x32_bf16 v[40:43], v[56:59], v[208:211], v[40:43]
    v_mfma_f32_16x16x32_bf16 v[44:47], v[56:59], v[212:215], v[44:47]
    v_mfma_f32_16x16x32_bf16 v[224:227], v[60:63], v[160:163], v[224:227]
    v_mfma_f32_16x16x32_bf16 v[228:231], v[60:63], v[164:167], v[228:231]
    v_mfma_f32_16x16x32_bf16 v[232:235], v[60:63], v[168:171], v[232:235]
    v_mfma_f32_16x16x32_bf16 v[236:239], v[60:63], v[172:175], v[236:239]
    v_mfma_f32_16x16x32_bf16 v[240:243], v[60:63], v[176:179], v[240:243]
    v_mfma_f32_16x16x32_bf16 v[244:247], v[60:63], v[180:183], v[244:247]
    v_mfma_f32_16x16x32_bf16 v[248:251], v[60:63], v[184:187], v[248:251]
    v_mfma_f32_16x16x32_bf16 v[252:255], v[60:63], v[188:191], v[252:255]
    v_mfma_f32_16x16x32_bf16 v[40:43], v[60:63], v[216:219], v[40:43]
    v_mfma_f32_16x16x32_bf16 v[44:47], v[60:63], v[220:223], v[44:47]
    v_mul_u32_u24 v7, 73728, v4
    v_lshrrev_b32 v5, 3, v3
    v_lshl_add_u32 v6, v5, 13, v7
    v_and_b32 v5, 7, v3
    v_lshl_add_u32 v6, v5, 4, v6
    v_lshl_add_u32 v7, v3, 3, v7
    v_add_u32 v7, 65536, v7
    s_lshl_b32 s56, s52, 7
    s_add_u32 s56, s56, 4718592
    s_lshl_b32 s54, s3, 14
    s_add_u32 s54, s54, s56
    s_add_u32 s55, s54, 4096
    s_and_b32 s57, s3, 1
    s_lshl_b32 s57, s57, 12
    s_add_u32 s56, s56, s57
    v_min_u32 v16, -2, v224
    v_min_u32 v17, -2, v228
    v_min_u32 v18, -2, v232
    v_min_u32 v19, -2, v236
    v_min_u32 v20, -2, v240
    v_min_u32 v21, -2, v244
    v_min_u32 v22, -2, v248
    v_min_u32 v23, -2, v252
    v_min_u32 v24, -2, v40
    v_min_u32 v25, -2, v44
    buffer_store_dwordx4 v[16:19], v6, s[44:47], s54 offen sc1
    buffer_store_dwordx4 v[20:23], v6, s[44:47], s55 offen sc1
    buffer_store_dwordx2 v[24:25], v7, s[44:47], s56 offen sc1
    s_lshl_b32 s54, s3, 5
    s_add_u32 s54, s54, s53
    s_cmp_ge_u32 s54, 72
    s_cbranch_scc1 L_nored_8
    s_lshl_b32 s55, s54, 12
    s_add_u32 s55, s55, 4718592
    s_mul_hi_u32 s56, s54, 238609295
    s_mul_i32 s57, s56, 18
    s_sub_u32 s57, s54, s57
    s_mul_i32 s56, s56, 2304
    s_add_u32 s56, s56, 1152
    s_lshr_b32 s58, s57, 1
    s_lshl_b32 s58, s58, 7
    s_and_b32 s59, s57, 1
    s_cmp_lt_u32 s57, 16
    s_cselect_b32 s60, 3, 6
    s_cselect_b32 s61, 4, 3
    s_lshl_b32 s59, s59, s60
    s_add_u32 s56, s56, s58
    s_add_u32 s56, s56, s59
    v_lshlrev_b32 v5, s61, v1
    s_mov_b32 s48, s26
    s_mov_b32 s49, s27
    s_mov_b32 s50, 9216
    s_mov_b32 s51, 0x20000
    s_mov_b64 s[4:5], -1
    s_mov_b64 s[6:7], -1
    s_mov_b64 s[8:9], -1
    s_mov_b64 s[10:11], -1
L_mpoll_9:
    s_mov_b64 exec, s[4:5]
    buffer_load_dwordx4 v[16:19], v2, s[44:47], s55 offen offset:0 sc1
    s_mov_b64 exec, s[6:7]
    buffer_load_dwordx4 v[20:23], v2, s[44:47], s55 offen offset:1024 sc1
    s_mov_b64 exec, s[8:9]
    buffer_load_dwordx4 v[24:27], v2, s[44:47], s55 offen offset:2048 sc1
    s_mov_b64 exec, s[10:11]
    buffer_load_dwordx4 v[28:31], v2, s[44:47], s55 offen offset:3072 sc1
    s_mov_b64 exec, -1
    s_waitcnt vmcnt(0)
    v_max3_u32 v32, v16, v17, v18
    v_max3_u32 v33, v20, v21, v22
    v_max3_u32 v34, v24, v25, v26
    v_max3_u32 v35, v28, v29, v30
    v_max_u32 v32, v32, v19
    v_max_u32 v33, v33, v23
    v_max_u32 v34, v34, v27
    v_max_u32 v35, v35, v31
    v_cmp_eq_u32 s[4:5], -1, v32
    v_cmp_eq_u32 s[6:7], -1, v33
    v_cmp_eq_u32 s[8:9], -1, v34
    v_cmp_eq_u32 s[10:11], -1, v35
    s_or_b64 vcc, s[4:5], s[6:7]
    s_or_b64 vcc, vcc, s[8:9]
    s_or_b64 vcc, vcc, s[10:11]
    s_cbranch_scc0 L_mpollok_10
    s_sub_u32 s101, s101, 1
    s_cbranch_scc0 L_mpoll_9
    s_mov_b32 s101, 0
L_mpollok_10:
    v_add_f32 v16, v16, v20
    v_add_f32 v24, v24, v28
    v_add_f32 v17, v17, v21
    v_add_f32 v25, v25, v29
    v_add_f32 v18, v18, v22
    v_add_f32 v26, v26, v30
    v_add_f32 v19, v19, v23
    v_add_f32 v27, v27, v31
    v_add_f32 v16, v16, v24
    v_add_f32 v17, v17, v25
    v_add_f32 v18, v18, v26
    v_add_f32 v19, v19, v27
    v_add_f32_dpp v16, v16, v16 row_ror:8 row_mask:0xf bank_mask:0xf
    v_add_f32_dpp v17, v17, v17 row_ror:8 row_mask:0xf bank_mask:0xf
    v_add_f32_dpp v18, v18, v18 row_ror:8 row_mask:0xf bank_mask:0xf
    v_add_f32_dpp v19, v19, v19 row_ror:8 row_mask:0xf bank_mask:0xf
    v_mov_b32 v20, v16
    v_mov_b32 v21, v17
    v_mov_b32 v22, v18
    v_mov_b32 v23, v19
    v_permlane16_swap_b32 v16, v20
    v_permlane16_swap_b32 v17, v21
    v_permlane16_swap_b32 v18, v22
    v_permlane16_swap_b32 v19, v23
    v_add_f32 v16, v16, v20
    v_add_f32 v17, v17, v21
    v_add_f32 v18, v18, v22
    v_add_f32 v19, v19, v23
    v_mov_b32 v20, v16
    v_mov_b32 v21, v17
    v_mov_b32 v22, v18
    v_mov_b32 v23, v19
    v_permlane32_swap_b32 v16, v20
    v_permlane32_swap_b32 v17, v21
    v_permlane32_swap_b32 v18, v22
    v_permlane32_swap_b32 v19, v23
    v_add_f32 v16, v16, v20
    v_add_f32 v17, v17, v21
    v_add_f32 v18, v18, v22
    v_add_f32 v19, v19, v23
    v_cvt_pk_bf16_f32 v16, v16, v17
    v_cvt_pk_bf16_f32 v17, v18, v19
    s_mov_b64 exec, 0xff
    buffer_store_dwordx2 v[16:17], v5, s[48:51], s56 offen
    s_mov_b64 exec, -1
L_nored_8:
    s_endpgm
L_roleH_end:
L_roleC:
    s_mov_b32 s101, 100000
    s_getpc_b64 s[56:57]
L_pc_11:
    s_sub_u32 s56, s56, L_pc_11-L_roleC
    s_subb_u32 s57, s57, 0
    v_lshlrev_b32 v5, 7, v0
    v_min_u32 v6, L_roleC_end-L_roleC-4, v5
    global_load_dword v122, v6, s[56:57]
    v_add_u32 v5, 32768, v5
    v_min_u32 v6, L_roleC_end-L_roleC-4, v5
    global_load_dword v122, v6, s[56:57]
    v_mov_b32 v20, -1
    v_mov_b32 v21, -1
    v_mov_b32 v22, -1
    v_mov_b32 v23, -1
    v_mul_u32_u24 v7, 73728, v4
    v_lshrrev_b32 v5, 3, v3
    v_lshl_add_u32 v6, v5, 13, v7
    v_and_b32 v5, 7, v3
    v_lshl_add_u32 v6, v5, 4, v6
    v_lshl_add_u32 v7, v3, 3, v7
    v_add_u32 v7, 65536, v7
    s_lshl_b32 s56, s52, 7
    s_add_u32 s56, s56, 4194304
    s_lshl_b32 s54, s3, 14
    s_add_u32 s54, s54, s56
    s_add_u32 s55, s54, 4096
    s_and_b32 s57, s3, 1
    s_lshl_b32 s57, s57, 12
    s_add_u32 s56, s56, s57
    s_waitcnt lgkmcnt(0)
    s_mov_b32 s44, s30
    s_mov_b32 s45, s31
    s_mov_b32 s46, 536870912
    s_mov_b32 s47, 0x20000
    buffer_store_dwordx4 v[20:23], v6, s[44:47], s54 offen sc1
    buffer_store_dwordx4 v[20:23], v6, s[44:47], s55 offen sc1
    buffer_store_dwordx2 v[20:21], v7, s[44:47], s56 offen sc1
    v_mov_b32 v7, 536870912
    v_cmp_gt_u32 vcc, 32, v1
    s_nop 1
    v_cndmask_b32 v123, v7, v2, vcc
    s_lshl_b32 s98, s52, 12
    s_lshl_b32 s54, s3, 9
    s_add_u32 s98, s98, s54
    s_add_u32 s98, s98, 5244928
    buffer_store_dwordx4 v[20:23], v123, s[44:47], s98 offen sc1
    s_lshl_b32 s58, s52, 2
    s_add_u32 s58, s58, s3
    s_lshl_b32 s58, s58, 13
    s_add_u32 s58, s58, 8388608
    s_add_u32 s59, s58, 4096
    v_min_u32 v6, 1, v3
    v_lshl_add_u32 v6, v6, 2, v4
    v_lshlrev_b32 v6, 4, v6
    s_lshr_b32 s55, s52, 2
    s_add_u32 s55, s55, s3
    s_and_b32 s55, s55, 3
    s_and_b32 s54, s52, 3
    s_cmp_eq_u32 s54, s55
    s_mov_b32 s56, 255
    s_cselect_b32 s56, 16777215, s56
    s_mov_b32 s57, 0
    s_cbranch_scc0 L_cclr
    buffer_store_dwordx4 v[20:23], v2, s[44:47], s58 offen offset:2048 sc1
    buffer_store_dwordx4 v[20:23], v2, s[44:47], s58 offen offset:3072 sc1
    buffer_store_dwordx4 v[20:23], v2, s[44:47], s59 offen offset:0 sc1
    buffer_store_dwordx4 v[20:23], v2, s[44:47], s59 offen offset:1024 sc1
    s_lshl_b32 s55, s52, 2
    s_add_u32 s55, s55, s3
    s_lshl_b32 s55, s55, 7
    s_add_u32 s55, s55, 5373952
    v_mov_b32 v5, 0
    s_mov_b64 exec, 1
    buffer_store_dword v5, v5, s[44:47], s55 offen sc1
    s_lshl_b32 s55, s53, 8
    s_add_u32 s55, s55, 3145728
    s_mov_b64 exec, 0xffff
    buffer_store_dwordx4 v[20:23], v2, s[44:47], s55 offen sc1
    s_mov_b64 exec, -1
L_cclr:
    buffer_store_dwordx4 v[20:23], v2, s[44:47], s58 offen offset:0 sc1
    buffer_store_dwordx4 v[20:23], v2, s[44:47], s58 offen offset:1024 sc1
    s_mov_b64 exec, s[56:57]
    buffer_store_dwordx4 v[20:23], v2, s[44:47], s59 offen offset:2048 sc1
    s_mov_b64 exec, -1
    s_mov_b32 s40, s10
    s_mov_b32 s41, s11
    s_mov_b32 s42, 4718592
    s_mov_b32 s43, 0x20000
    s_mov_b32 s48, s4
    s_mov_b32 s49, s5
    s_mov_b32 s50, 4608
    s_mov_b32 s51, 0x20000
    s_mov_b32 s32, s16
    s_mov_b32 s33, s17
    s_mov_b32 s34, 16777216
    s_mov_b32 s35, 0x20000
    v_lshrrev_b32 v5, 3, v3
    v_mul_u32_u24 v5, 1152, v5
    v_mul_u32_u24 v6, 36, v4
    v_add_u32 v5, v5, v6
    s_mul_i32 s54, s3, 144
    s_add_u32 s54, s54, 576
    buffer_load_dwordx4 v[48:51], v5, s[48:51], s54 offen offset:0
    buffer_load_dwordx4 v[52:55], v5, s[48:51], s54 offen offset:16
    buffer_load_dword v56, v5, s[48:51], s54 offen offset:32
    buffer_load_dwordx4 v[60:63], v5, s[48:51], s54 offen offset:2304
    buffer_load_dwordx4 v[64:67], v5, s[48:51], s54 offen offset:2320
    buffer_load_dword v68, v5, s[48:51], s54 offen offset:2336
    v_mul_u32_u24 v120, 147456, v4
    v_lshl_add_u32 v120, v3, 4, v120
    s_mul_i32 s61, s3, 589824
    s_lshl_b32 s54, s52, 8
    s_add_u32 s61, s61, s54
    s_add_u32 s61, s61, 2359296
    buffer_load_dwordx4 a[0:3], v120, s[40:43], s61 offen nt
    s_add_u32 s61, s61, 8192
    buffer_load_dwordx4 a[4:7], v120, s[40:43], s61 offen nt
    s_add_u32 s61, s61, 8192
    buffer_load_dwordx4 a[8:11], v120, s[40:43], s61 offen nt
    s_add_u32 s61, s61, 8192
    buffer_load_dwordx4 a[12:15], v120, s[40:43], s61 offen nt
    s_add_u32 s61, s61, 8192
    buffer_load_dwordx4 a[16:19], v120, s[40:43], s61 offen nt
    s_add_u32 s61, s61, 8192
    buffer_load_dwordx4 a[20:23], v120, s[40:43], s61 offen nt
    s_add_u32 s61, s61, 8192
    buffer_load_dwordx4 a[24:27], v120, s[40:43], s61 offen nt
    s_add_u32 s61, s61, 8192
    buffer_load_dwordx4 a[28:31], v120, s[40:43], s61 offen nt
    s_add_u32 s61, s61, 8192
    buffer_load_dwordx4 a[32:35], v120, s[40:43], s61 offen nt
    s_add_u32 s61, s61, 8192
    buffer_load_dwordx4 a[36:39], v120, s[40:43], s61 offen nt
    s_add_u32 s61, s61, 8192
    buffer_load_dwordx4 a[40:43], v120, s[40:43], s61 offen nt
    s_add_u32 s61, s61, 8192
    buffer_load_dwordx4 a[44:47], v120, s[40:43], s61 offen nt
    s_add_u32 s61, s61, 8192
    buffer_load_dwordx4 a[48:51], v120, s[40:43], s61 offen nt
    s_add_u32 s61, s61, 8192
    buffer_load_dwordx4 a[52:55], v120, s[40:43], s61 offen nt
    s_add_u32 s61, s61, 8192
    buffer_load_dwordx4 a[56:59], v120, s[40:43], s61 offen nt
    s_add_u32 s61, s61, 8192
    buffer_load_dwordx4 a[60:63], v120, s[40:43], s61 offen nt
    s_add_u32 s61, s61, 8192
    buffer_load_dwordx4 a[64:67], v120, s[40:43], s61 offen nt
    s_add_u32 s61, s61, 8192
    buffer_load_dwordx4 a[68:71], v120, s[40:43], s61 offen nt
    s_add_u32 s61, s61, 8192
    v_and_b32 v5, 1, v3
    v_cmp_eq_u32 vcc, 1, v5
    v_mov_b32 v5, 0x0c0c0100
    v_mov_b32 v6, 0x01000c0c
    v_cndmask_b32 v5, v5, v6, vcc
    v_mov_b32 v6, 0x0c0c0302
    v_mov_b32 v7, 0x03020c0c
    v_cndmask_b32 v6, v6, v7, vcc
    v_bfe_u32 v7, v3, 1, 2
    v_mov_b32 v16, 0x0c0c0c0c
    v_cmp_eq_u32 vcc, 0, v7
    s_nop 1
    v_cndmask_b32 v8, v16, v5, vcc
    v_cndmask_b32 v9, v16, v6, vcc
    v_cmp_eq_u32 vcc, 1, v7
    s_nop 1
    v_cndmask_b32 v10, v16, v5, vcc
    v_cndmask_b32 v11, v16, v6, vcc
    v_cmp_eq_u32 vcc, 2, v7
    s_nop 1
    v_cndmask_b32 v12, v16, v5, vcc
    v_cndmask_b32 v13, v16, v6, vcc
    v_cmp_eq_u32 vcc, 3, v7
    s_nop 1
    v_cndmask_b32 v14, v16, v5, vcc
    v_cndmask_b32 v15, v16, v6, vcc
    s_waitcnt vmcnt(24)
    s_barrier
    s_cmp_lg_u32 s3, 0
    s_cbranch_scc1 L_nosig_12
    s_lshl_b32 s54, s52, 2
    v_mov_b32 v5, s54
    v_mov_b32 v6, 1
    s_mov_b64 exec, 1
    global_atomic_add v5, v6, s[28:29]
    s_mov_b64 exec, -1
L_nosig_12:
    v_lshlrev_b32 v5, 2, v4
    v_xor_b32 v5, v5, v3
    v_lshlrev_b32 v6, 10, v4
    v_xor_b32 v7, 0, v5
    v_lshl_add_u32 v20, v7, 4, v6
    v_xor_b32 v7, 1, v5
    v_lshl_add_u32 v21, v7, 4, v6
    v_add_u32 v21, 4096, v21
    v_xor_b32 v7, 2, v5
    v_lshl_add_u32 v22, v7, 4, v6
    v_add_u32 v22, 8192, v22
    v_xor_b32 v7, 3, v5
    v_lshl_add_u32 v23, v7, 4, v6
    v_add_u32 v23, 12288, v23
    s_lshl_b32 s58, s53, 19
    s_lshl_b32 s54, s3, 8
    s_add_u32 s58, s58, s54
    s_lshl_b32 s63, s3, 15
    s_mov_b32 s59, s63
    s_add_u32 m0, s59, 0
    s_add_u32 s54, s58, 0
    buffer_load_dwordx4 v20, s[32:35], s54 offen nt lds
    s_add_u32 m0, s59, 1024
    s_add_u32 s54, s58, 0
    buffer_load_dwordx4 v21, s[32:35], s54 offen nt lds
    s_add_u32 m0, s59, 2048
    s_add_u32 s54, s58, 0
    buffer_load_dwordx4 v22, s[32:35], s54 offen nt lds
    s_add_u32 m0, s59, 3072
    s_add_u32 s54, s58, 0
    buffer_load_dwordx4 v23, s[32:35], s54 offen nt lds
    s_add_u32 m0, s59, 4096
    s_add_u32 s54, s58, 16384
    buffer_load_dwordx4 v20, s[32:35], s54 offen nt lds
    s_add_u32 m0, s59, 5120
    s_add_u32 s54, s58, 16384
    buffer_load_dwordx4 v21, s[32:35], s54 offen nt lds
    s_add_u32 m0, s59, 6144
    s_add_u32 s54, s58, 16384
    buffer_load_dwordx4 v22, s[32:35], s54 offen nt lds
    s_add_u32 m0, s59, 7168
    s_add_u32 s54, s58, 16384
    buffer_load_dwordx4 v23, s[32:35], s54 offen nt lds
    s_add_u32 s58, s58, 32768
    s_add_u32 s59, s59, 8192
    s_waitcnt vmcnt(17)
    v_perm_b32 v96, v48, v48, v8
    v_perm_b32 v97, v48, v48, v10
    v_perm_b32 v98, v48, v48, v12
    v_perm_b32 v99, v48, v48, v14
    s_nop 1
    v_mfma_f32_16x16x32_bf16 v[112:115], v[96:99], a[0:3], 0
    v_perm_b32 v100, v60, v60, v8
    v_perm_b32 v101, v60, v60, v10
    v_perm_b32 v102, v60, v60, v12
    v_perm_b32 v103, v60, v60, v14
    s_nop 1
    v_mfma_f32_16x16x32_bf16 v[116:119], v[100:103], a[0:3], 0
    v_perm_b32 v104, v48, v48, v9
    v_perm_b32 v105, v48, v48, v11
    v_perm_b32 v106, v48, v48, v13
    v_perm_b32 v107, v48, v48, v15
    s_nop 1
    v_mfma_f32_16x16x32_bf16 v[112:115], v[104:107], a[4:7], v[112:115]
    v_perm_b32 v108, v60, v60, v9
    v_perm_b32 v109, v60, v60, v11
    v_perm_b32 v110, v60, v60, v13
    v_perm_b32 v111, v60, v60, v15
    s_nop 1
    v_mfma_f32_16x16x32_bf16 v[116:119], v[108:111], a[4:7], v[116:119]
    v_perm_b32 v96, v49, v49, v8
    v_perm_b32 v97, v49, v49, v10
    v_perm_b32 v98, v49, v49, v12
    v_perm_b32 v99, v49, v49, v14
    s_nop 1
    v_mfma_f32_16x16x32_bf16 v[112:115], v[96:99], a[8:11], v[112:115]
    v_perm_b32 v100, v61, v61, v8
    v_perm_b32 v101, v61, v61, v10
    v_perm_b32 v102, v61, v61, v12
    v_perm_b32 v103, v61, v61, v14
    s_nop 1
    v_mfma_f32_16x16x32_bf16 v[116:119], v[100:103], a[8:11], v[116:119]
    v_perm_b32 v104, v49, v49, v9
    v_perm_b32 v105, v49, v49, v11
    v_perm_b32 v106, v49, v49, v13
    v_perm_b32 v107, v49, v49, v15
    s_nop 1
    v_mfma_f32_16x16x32_bf16 v[112:115], v[104:107], a[12:15], v[112:115]
    v_perm_b32 v108, v61, v61, v9
    v_perm_b32 v109, v61, v61, v11
    v_perm_b32 v110, v61, v61, v13
    v_perm_b32 v111, v61, v61, v15
    s_nop 1
    v_mfma_f32_16x16x32_bf16 v[116:119], v[108:111], a[12:15], v[116:119]
    v_perm_b32 v96, v50, v50, v8
    v_perm_b32 v97, v50, v50, v10
    v_perm_b32 v98, v50, v50, v12
    v_perm_b32 v99, v50, v50, v14
    s_nop 1
    v_mfma_f32_16x16x32_bf16 v[112:115], v[96:99], a[16:19], v[112:115]
    v_perm_b32 v100, v62, v62, v8
    v_perm_b32 v101, v62, v62, v10
    v_perm_b32 v102, v62, v62, v12
    v_perm_b32 v103, v62, v62, v14
    s_nop 1
    v_mfma_f32_16x16x32_bf16 v[116:119], v[100:103], a[16:19], v[116:119]
    v_perm_b32 v104, v50, v50, v9
    v_perm_b32 v105, v50, v50, v11
    v_perm_b32 v106, v50, v50, v13
    v_perm_b32 v107, v50, v50, v15
    s_nop 1
    v_mfma_f32_16x16x32_bf16 v[112:115], v[104:107], a[20:23], v[112:115]
    v_perm_b32 v108, v62, v62, v9
    v_perm_b32 v109, v62, v62, v11
    v_perm_b32 v110, v62, v62, v13
    v_perm_b32 v111, v62, v62, v15
    s_nop 1
    v_mfma_f32_16x16x32_bf16 v[116:119], v[108:111], a[20:23], v[116:119]
    v_perm_b32 v96, v51, v51, v8
    v_perm_b32 v97, v51, v51, v10
    v_perm_b32 v98, v51, v51, v12
    v_perm_b32 v99, v51, v51, v14
    s_nop 1
    v_mfma_f32_16x16x32_bf16 v[112:115], v[96:99], a[24:27], v[112:115]
    v_perm_b32 v100, v63, v63, v8
    v_perm_b32 v101, v63, v63, v10
    v_perm_b32 v102, v63, v63, v12
    v_perm_b32 v103, v63, v63, v14
    s_nop 1
    v_mfma_f32_16x16x32_bf16 v[116:119], v[100:103], a[24:27], v[116:119]
    v_perm_b32 v104, v51, v51, v9
    v_perm_b32 v105, v51, v51, v11
    v_perm_b32 v106, v51, v51, v13
    v_perm_b32 v107, v51, v51, v15
    s_nop 1
    v_mfma_f32_16x16x32_bf16 v[112:115], v[104:107], a[28:31], v[112:115]
    v_perm_b32 v108, v63, v63, v9
    v_perm_b32 v109, v63, v63, v11
    v_perm_b32 v110, v63, v63, v13
    v_perm_b32 v111, v63, v63, v15
    s_nop 1
    v_mfma_f32_16x16x32_bf16 v[116:119], v[108:111], a[28:31], v[116:119]
    v_perm_b32 v96, v52, v52, v8
    v_perm_b32 v97, v52, v52, v10
    v_perm_b32 v98, v52, v52, v12
    v_perm_b32 v99, v52, v52, v14
    s_nop 1
    v_mfma_f32_16x16x32_bf16 v[112:115], v[96:99], a[32:35], v[112:115]
    v_perm_b32 v100, v64, v64, v8
    v_perm_b32 v101, v64, v64, v10
    v_perm_b32 v102, v64, v64, v12
    v_perm_b32 v103, v64, v64, v14
    s_nop 1
    v_mfma_f32_16x16x32_bf16 v[116:119], v[100:103], a[32:35], v[116:119]
    s_waitcnt vmcnt(8)
    v_perm_b32 v104, v52, v52, v9
    v_perm_b32 v105, v52, v52, v11
    v_perm_b32 v106, v52, v52, v13
    v_perm_b32 v107, v52, v52, v15
    s_nop 1
    v_mfma_f32_16x16x32_bf16 v[112:115], v[104:107], a[36:39], v[112:115]
    v_perm_b32 v108, v64, v64, v9
    v_perm_b32 v109, v64, v64, v11
    v_perm_b32 v110, v64, v64, v13
    v_perm_b32 v111, v64, v64, v15
    s_nop 1
    v_mfma_f32_16x16x32_bf16 v[116:119], v[108:111], a[36:39], v[116:119]
    v_perm_b32 v96, v53, v53, v8
    v_perm_b32 v97, v53, v53, v10
    v_perm_b32 v98, v53, v53, v12
    v_perm_b32 v99, v53, v53, v14
    s_nop 1
    v_mfma_f32_16x16x32_bf16 v[112:115], v[96:99], a[40:43], v[112:115]
    v_perm_b32 v100, v65, v65, v8
    v_perm_b32 v101, v65, v65, v10
    v_perm_b32 v102, v65, v65, v12
    v_perm_b32 v103, v65, v65, v14
    s_nop 1
    v_mfma_f32_16x16x32_bf16 v[116:119], v[100:103], a[40:43], v[116:119]
    v_perm_b32 v104, v53, v53, v9
    v_perm_b32 v105, v53, v53, v11
    v_perm_b32 v106, v53, v53, v13
    v_perm_b32 v107, v53, v53, v15
    s_nop 1
    v_mfma_f32_16x16x32_bf16 v[112:115], v[104:107], a[44:47], v[112:115]
    v_perm_b32 v108, v65, v65, v9
    v_perm_b32 v109, v65, v65, v11
    v_perm_b32 v110, v65, v65, v13
    v_perm_b32 v111, v65, v65, v15
    s_nop 1
    v_mfma_f32_16x16x32_bf16 v[116:119], v[108:111], a[44:47], v[116:119]
    v_perm_b32 v96, v54, v54, v8
    v_perm_b32 v97, v54, v54, v10
    v_perm_b32 v98, v54, v54, v12
    v_perm_b32 v99, v54, v54, v14
    s_nop 1
    v_mfma_f32_16x16x32_bf16 v[112:115], v[96:99], a[48:51], v[112:115]
    v_perm_b32 v100, v66, v66, v8
    v_perm_b32 v101, v66, v66, v10
    v_perm_b32 v102, v66, v66, v12
    v_perm_b32 v103, v66, v66, v14
    s_nop 1
    v_mfma_f32_16x16x32_bf16 v[116:119], v[100:103], a[48:51], v[116:119]
    v_perm_b32 v104, v54, v54, v9
    v_perm_b32 v105, v54, v54, v11
    v_perm_b32 v106, v54, v54, v13
    v_perm_b32 v107, v54, v54, v15
    s_nop 1
    v_mfma_f32_16x16x32_bf16 v[112:115], v[104:107], a[52:55], v[112:115]
    v_perm_b32 v108, v66, v66, v9
    v_perm_b32 v109, v66, v66, v11
    v_perm_b32 v110, v66, v66, v13
    v_perm_b32 v111, v66, v66, v15
    s_nop 1
    v_mfma_f32_16x16x32_bf16 v[116:119], v[108:111], a[52:55], v[116:119]
    v_perm_b32 v96, v55, v55, v8
    v_perm_b32 v97, v55, v55, v10
    v_perm_b32 v98, v55, v55, v12
    v_perm_b32 v99, v55, v55, v14
    s_nop 1
    v_mfma_f32_16x16x32_bf16 v[112:115], v[96:99], a[56:59], v[112:115]
    v_perm_b32 v100, v67, v67, v8
    v_perm_b32 v101, v67, v67, v10
    v_perm_b32 v102, v67, v67, v12
    v_perm_b32 v103, v67, v67, v14
    s_nop 1
    v_mfma_f32_16x16x32_bf16 v[116:119], v[100:103], a[56:59], v[116:119]
    v_perm_b32 v104, v55, v55, v9
    v_perm_b32 v105, v55, v55, v11
    v_perm_b32 v106, v55, v55, v13
    v_perm_b32 v107, v55, v55, v15
    s_nop 1
    v_mfma_f32_16x16x32_bf16 v[112:115], v[104:107], a[60:63], v[112:115]
    v_perm_b32 v108, v67, v67, v9
    v_perm_b32 v109, v67, v67, v11
    v_perm_b32 v110, v67, v67, v13
    v_perm_b32 v111, v67, v67, v15
    s_nop 1
    v_mfma_f32_16x16x32_bf16 v[116:119], v[108:111], a[60:63], v[116:119]
    v_perm_b32 v96, v56, v56, v8
    v_perm_b32 v97, v56, v56, v10
    v_perm_b32 v98, v56, v56, v12
    v_perm_b32 v99, v56, v56, v14
    s_nop 1
    v_mfma_f32_16x16x32_bf16 v[112:115], v[96:99], a[64:67], v[112:115]
    v_perm_b32 v100, v68, v68, v8
    v_perm_b32 v101, v68, v68, v10
    v_perm_b32 v102, v68, v68, v12
    v_perm_b32 v103, v68, v68, v14
    s_nop 1
    v_mfma_f32_16x16x32_bf16 v[116:119], v[100:103], a[64:67], v[116:119]
    v_perm_b32 v104, v56, v56, v9
    v_perm_b32 v105, v56, v56, v11
    v_perm_b32 v106, v56, v56, v13
    v_perm_b32 v107, v56, v56, v15
    s_nop 1
    v_mfma_f32_16x16x32_bf16 v[112:115], v[104:107], a[68:71], v[112:115]
    v_perm_b32 v108, v68, v68, v9
    v_perm_b32 v109, v68, v68, v11
    v_perm_b32 v110, v68, v68, v13
    v_perm_b32 v111, v68, v68, v15
    s_nop 1
    v_mfma_f32_16x16x32_bf16 v[116:119], v[108:111], a[68:71], v[116:119]
    v_lshrrev_b32 v5, 1, v4
    v_lshlrev_b32 v5, 9, v5
    v_lshl_add_u32 v5, v3, 5, v5
    v_and_b32 v6, 1, v4
    v_lshl_add_u32 v5, v6, 4, v5
    s_lshl_b32 s54, s3, 11
    s_add_u32 s54, s54, 139264
    v_add_u32 v5, s54, v5
    ds_write_b128 v5, v[112:115]
    ds_write_b128 v5, v[116:119] offset:1024
    s_waitcnt lgkmcnt(0)
    s_barrier
    s_lshl_b32 s54, s3, 9
    s_add_u32 s54, s54, 139264
    v_add_u32 v5, s54, v2
    ds_read_b128 v[96:99], v5 offset:0
    ds_read_b128 v[100:103], v5 offset:2048
    ds_read_b128 v[104:107], v5 offset:4096
    ds_read_b128 v[108:111], v5 offset:6144
    s_waitcnt lgkmcnt(0)
    v_add_f32 v96, v96, v100
    v_add_f32 v104, v104, v108
    v_add_f32 v97, v97, v101
    v_add_f32 v105, v105, v109
    v_add_f32 v98, v98, v102
    v_add_f32 v106, v106, v110
    v_add_f32 v99, v99, v103
    v_add_f32 v107, v107, v111
    v_add_f32 v96, v96, v104
    v_add_f32 v97, v97, v105
    v_add_f32 v98, v98, v106
    v_add_f32 v99, v99, v107
    v_min_u32 v124, -2, v96
    v_min_u32 v125, -2, v97
    v_min_u32 v126, -2, v98
    v_min_u32 v127, -2, v99
    buffer_store_dwordx4 v[124:127], v123, s[44:47], s98 offen sc1
    s_add_u32 m0, s59, 0
    s_add_u32 s54, s58, 0
    buffer_load_dwordx4 v20, s[32:35], s54 offen nt lds
    s_add_u32 m0, s59, 1024
    s_add_u32 s54, s58, 0
    buffer_load_dwordx4 v21, s[32:35], s54 offen nt lds
    s_add_u32 m0, s59, 2048
    s_add_u32 s54, s58, 0
    buffer_load_dwordx4 v22, s[32:35], s54 offen nt lds
    s_add_u32 m0, s59, 3072
    s_add_u32 s54, s58, 0
    buffer_load_dwordx4 v23, s[32:35], s54 offen nt lds
    s_add_u32 m0, s59, 4096
    s_add_u32 s54, s58, 16384
    buffer_load_dwordx4 v20, s[32:35], s54 offen nt lds
    s_add_u32 m0, s59, 5120
    s_add_u32 s54, s58, 16384
    buffer_load_dwordx4 v21, s[32:35], s54 offen nt lds
    s_add_u32 m0, s59, 6144
    s_add_u32 s54, s58, 16384
    buffer_load_dwordx4 v22, s[32:35], s54 offen nt lds
    s_add_u32 m0, s59, 7168
    s_add_u32 s54, s58, 16384
    buffer_load_dwordx4 v23, s[32:35], s54 offen nt lds
    s_add_u32 s58, s58, 32768
    s_add_u32 s59, s59, 8192
    s_add_u32 m0, s59, 0
    s_add_u32 s54, s58, 0
    buffer_load_dwordx4 v20, s[32:35], s54 offen nt lds
    s_add_u32 m0, s59, 1024
    s_add_u32 s54, s58, 0
    buffer_load_dwordx4 v21, s[32:35], s54 offen nt lds
    s_add_u32 m0, s59, 2048
    s_add_u32 s54, s58, 0
    buffer_load_dwordx4 v22, s[32:35], s54 offen nt lds
    s_add_u32 m0, s59, 3072
    s_add_u32 s54, s58, 0
    buffer_load_dwordx4 v23, s[32:35], s54 offen nt lds
    s_add_u32 m0, s59, 4096
    s_add_u32 s54, s58, 16384
    buffer_load_dwordx4 v20, s[32:35], s54 offen nt lds
    s_add_u32 m0, s59, 5120
    s_add_u32 s54, s58, 16384
    buffer_load_dwordx4 v21, s[32:35], s54 offen nt lds
    s_add_u32 m0, s59, 6144
    s_add_u32 s54, s58, 16384
    buffer_load_dwordx4 v22, s[32:35], s54 offen nt lds
    s_add_u32 m0, s59, 7168
    s_add_u32 s54, s58, 16384
    buffer_load_dwordx4 v23, s[32:35], s54 offen nt lds
    s_add_u32 s58, s58, 32768
    s_add_u32 s59, s59, 8192
    s_add_u32 m0, s59, 0
    s_add_u32 s54, s58, 0
    buffer_load_dwordx4 v20, s[32:35], s54 offen nt lds
    s_add_u32 m0, s59, 1024
    s_add_u32 s54, s58, 0
    buffer_load_dwordx4 v21, s[32:35], s54 offen nt lds
    s_add_u32 m0, s59, 2048
    s_add_u32 s54, s58, 0
    buffer_load_dwordx4 v22, s[32:35], s54 offen nt lds
    s_add_u32 m0, s59, 3072
    s_add_u32 s54, s58, 0
    buffer_load_dwordx4 v23, s[32:35], s54 offen nt lds
    s_add_u32 m0, s59, 4096
    s_add_u32 s54, s58, 16384
    buffer_load_dwordx4 v20, s[32:35], s54 offen nt lds
    s_add_u32 m0, s59, 5120
    s_add_u32 s54, s58, 16384
    buffer_load_dwordx4 v21, s[32:35], s54 offen nt lds
    s_add_u32 m0, s59, 6144
    s_add_u32 s54, s58, 16384
    buffer_load_dwordx4 v22, s[32:35], s54 offen nt lds
    s_add_u32 m0, s59, 7168
    s_add_u32 s54, s58, 16384
    buffer_load_dwordx4 v23, s[32:35], s54 offen nt lds
    s_add_u32 s58, s58, 32768
    s_add_u32 s59, s59, 8192
    s_waitcnt vmcnt(40)
    buffer_load_dwordx4 a[96:99], v20, s[32:35], s58 offen nt
    buffer_load_dwordx4 a[100:103], v21, s[32:35], s58 offen nt
    buffer_load_dwordx4 a[104:107], v22, s[32:35], s58 offen nt
    buffer_load_dwordx4 a[108:111], v23, s[32:35], s58 offen nt
    s_add_u32 s58, s58, 16384
    buffer_load_dwordx4 a[112:115], v20, s[32:35], s58 offen nt
    buffer_load_dwordx4 a[116:119], v21, s[32:35], s58 offen nt
    buffer_load_dwordx4 a[120:123], v22, s[32:35], s58 offen nt
    buffer_load_dwordx4 a[124:127], v23, s[32:35], s58 offen nt
    s_add_u32 s58, s58, 16384
    s_waitcnt vmcnt(40)
    buffer_load_dwordx4 a[128:131], v20, s[32:35], s58 offen nt
    buffer_load_dwordx4 a[132:135], v21, s[32:35], s58 offen nt
    buffer_load_dwordx4 a[136:139], v22, s[32:35], s58 offen nt
    buffer_load_dwordx4 a[140:143], v23, s[32:35], s58 offen nt
    s_add_u32 s58, s58, 16384
    buffer_load_dwordx4 a[144:147], v20, s[32:35], s58 offen nt
    buffer_load_dwordx4 a[148:151], v21, s[32:35], s58 offen nt
    buffer_load_dwordx4 a[152:155], v22, s[32:35], s58 offen nt
    buffer_load_dwordx4 a[156:159], v23, s[32:35], s58 offen nt
    s_add_u32 s58, s58, 16384
    s_waitcnt vmcnt(40)
    buffer_load_dwordx4 a[160:163], v20, s[32:35], s58 offen nt
    buffer_load_dwordx4 a[164:167], v21, s[32:35], s58 offen nt
    buffer_load_dwordx4 a[168:171], v22, s[32:35], s58 offen nt
    buffer_load_dwordx4 a[172:175], v23, s[32:35], s58 offen nt
    s_add_u32 s58, s58, 16384
    buffer_load_dwordx4 a[176:179], v20, s[32:35], s58 offen nt
    buffer_load_dwordx4 a[180:183], v21, s[32:35], s58 offen nt
    buffer_load_dwordx4 a[184:187], v22, s[32:35], s58 offen nt
    buffer_load_dwordx4 a[188:191], v23, s[32:35], s58 offen nt
    s_add_u32 s58, s58, 16384
    s_waitcnt vmcnt(40)
    buffer_load_dwordx4 a[192:195], v20, s[32:35], s58 offen nt
    buffer_load_dwordx4 a[196:199], v21, s[32:35], s58 offen nt
    buffer_load_dwordx4 a[200:203], v22, s[32:35], s58 offen nt
    buffer_load_dwordx4 a[204:207], v23, s[32:35], s58 offen nt
    s_add_u32 s58, s58, 16384
    buffer_load_dwordx4 a[208:211], v20, s[32:35], s58 offen nt
    buffer_load_dwordx4 a[212:215], v21, s[32:35], s58 offen nt
    buffer_load_dwordx4 a[216:219], v22, s[32:35], s58 offen nt
    buffer_load_dwordx4 a[220:223], v23, s[32:35], s58 offen nt
    s_add_u32 s58, s58, 16384
    s_waitcnt vmcnt(40)
    v_and_b32 v27, 31, v1
    v_lshlrev_b32 v27, 2, v27
    global_load_dword v18, v27, s[28:29] sc1
    buffer_load_dwordx4 a[224:227], v20, s[32:35], s58 offen nt
    buffer_load_dwordx4 a[228:231], v21, s[32:35], s58 offen nt
    buffer_load_dwordx4 a[232:235], v22, s[32:35], s58 offen nt
    buffer_load_dwordx4 a[236:239], v23, s[32:35], s58 offen nt
    s_add_u32 s58, s58, 16384
    buffer_load_dwordx4 a[240:243], v20, s[32:35], s58 offen nt
    buffer_load_dwordx4 a[244:247], v21, s[32:35], s58 offen nt
    buffer_load_dwordx4 a[248:251], v22, s[32:35], s58 offen nt
    buffer_load_dwordx4 a[252:255], v23, s[32:35], s58 offen nt
    s_add_u32 s58, s58, 16384
    s_waitcnt vmcnt(40)
    buffer_load_dwordx4 v[224:227], v20, s[32:35], s58 offen nt
    buffer_load_dwordx4 v[228:231], v21, s[32:35], s58 offen nt
    buffer_load_dwordx4 v[232:235], v22, s[32:35], s58 offen nt
    buffer_load_dwordx4 v[236:239], v23, s[32:35], s58 offen nt
    s_add_u32 s58, s58, 16384
    buffer_load_dwordx4 v[240:243], v20, s[32:35], s58 offen nt
    buffer_load_dwordx4 v[244:247], v21, s[32:35], s58 offen nt
    buffer_load_dwordx4 v[248:251], v22, s[32:35], s58 offen nt
    buffer_load_dwordx4 v[252:255], v23, s[32:35], s58 offen nt
    s_add_u32 s58, s58, 16384
    s_mov_b32 s36, s12
    s_mov_b32 s37, s13
    s_mov_b32 s38, 4718592
    s_mov_b32 s39, 0x20000
    v_mul_u32_u24 v49, 9216, v4
    v_lshl_add_u32 v48, v3, 4, v49
    v_lshl_add_u32 v49, v3, 2, v49
    s_mul_i32 s100, s52, 147456
    s_lshl_b32 s54, s3, 8
    s_add_u32 s99, s100, s54
    s_and_b32 s54, s3, 1
    s_lshl_b32 s54, s54, 6
    s_add_u32 s100, s100, s54
    s_add_u32 s100, s100, 1024
    v_add_u32 v26, s63, v2
    v_and_b32 v24, 31, v1
    v_lshrrev_b32 v25, 5, v1
    v_lshlrev_b32 v19, 10, v24
    v_lshl_add_u32 v19, v25, 4, v19
    s_lshr_b32 s96, s53, 3
    s_lshl_b32 s96, s96, 15
    s_lshl_b32 s55, s3, 8
    s_add_u32 s96, s96, s55
    s_add_u32 s96, s96, 1048576
    v_and_b32 v5, 3, v24
    v_lshlrev_b32 v5, 2, v5
    v_bfe_u32 v6, v24, 2, 2
    v_or_b32 v5, v5, v6
    v_xor_b32 v5, v5, v25
    v_lshlrev_b32 v32, 8, v24
    v_lshl_add_u32 v32, v5, 4, v32
    v_add_u32 v32, s63, v32
    v_bfe_u32 v5, v1, 2, 2
    v_lshl_add_u32 v6, v25, 2, v5
    v_lshlrev_b32 v40, 8, v6
    v_and_b32 v6, 1, v1
    v_lshl_add_u32 v40, v6, 3, v40
    v_bfe_u32 v6, v1, 4, 1
    v_lshlrev_b32 v6, 1, v6
    v_bfe_u32 v7, v1, 1, 1
    v_or_b32 v6, v6, v7
    v_xor_b32 v6, v6, v25
    v_lshl_or_b32 v6, v5, 2, v6
    v_lshl_add_u32 v40, v6, 4, v40
    v_add_u32 v40, s63, v40
    v_xor_b32 v33, 32, v32
    v_xor_b32 v41, 32, v40
    v_xor_b32 v34, 64, v32
    v_xor_b32 v42, 64, v40
    v_xor_b32 v35, 96, v32
    v_xor_b32 v43, 96, v40
    v_xor_b32 v36, 128, v32
    v_xor_b32 v44, 128, v40
    v_xor_b32 v37, 160, v32
    v_xor_b32 v45, 160, v40
    v_xor_b32 v38, 192, v32
    v_xor_b32 v46, 192, v40
    v_xor_b32 v39, 224, v32
    v_xor_b32 v47, 224, v40
    s_lshl_b32 s54, s3, 12
    s_add_u32 s54, s54, 131072
    v_add_u32 v28, s54, v2
    v_xor_b32 v29, 4096, v28
    v_xor_b32 v30, 8192, v28
    v_xor_b32 v31, 12288, v28
    v_mov_b32 v64, 0
    v_mov_b32 v65, 0
    v_mov_b32 v66, 0
    v_mov_b32 v67, 0
    v_mov_b32 v68, 0
    v_mov_b32 v69, 0
    v_mov_b32 v70, 0
    v_mov_b32 v71, 0
    v_mov_b32 v72, 0
    v_mov_b32 v73, 0
    v_mov_b32 v74, 0
    v_mov_b32 v75, 0
    v_mov_b32 v76, 0
    v_mov_b32 v77, 0
    v_mov_b32 v78, 0
    v_mov_b32 v79, 0
    v_mov_b32 v80, 0
    v_mov_b32 v81, 0
    v_mov_b32 v82, 0
    v_mov_b32 v83, 0
    v_mov_b32 v84, 0
    v_mov_b32 v85, 0
    v_mov_b32 v86, 0
    v_mov_b32 v87, 0
    v_mov_b32 v88, 0
    v_mov_b32 v89, 0
    v_mov_b32 v90, 0
    v_mov_b32 v91, 0
    v_mov_b32 v92, 0
    v_mov_b32 v93, 0
    v_mov_b32 v94, 0
    v_mov_b32 v95, 0
    v_mov_b32 v96, 0
    v_mov_b32 v97, 0
    v_mov_b32 v98, 0
    v_mov_b32 v99, 0
    v_mov_b32 v100, 0
    v_mov_b32 v101, 0
    v_mov_b32 v102, 0
    v_mov_b32 v103, 0
    v_mov_b32 v104, 0
    v_mov_b32 v105, 0
    v_mov_b32 v106, 0
    v_mov_b32 v107, 0
    v_mov_b32 v108, 0
    v_mov_b32 v109, 0
    v_mov_b32 v110, 0
    v_mov_b32 v111, 0
    v_mov_b32 v112, 0
    v_mov_b32 v113, 0
    v_mov_b32 v114, 0
    v_mov_b32 v115, 0
    v_mov_b32 v116, 0
    v_mov_b32 v117, 0
    v_mov_b32 v118, 0
    v_mov_b32 v119, 0
    v_mov_b32 v120, 0
    v_mov_b32 v121, 0
    v_mov_b32 v122, 0
    v_mov_b32 v123, 0
    v_mov_b32 v124, 0
    v_mov_b32 v125, 0
    v_mov_b32 v126, 0
    v_mov_b32 v127, 0
    v_mov_b32 v216, 0xff800000
    v_mov_b32 v217, 0
    s_waitcnt vmcnt(0)
L_flags_13:
    v_cmp_gt_u32 vcc, 2, v18
    s_cbranch_vccz L_flagsok_14
    s_sleep 2
    global_load_dword v18, v27, s[28:29] sc1
    s_waitcnt vmcnt(0)
    s_sub_u32 s101, s101, 1
    s_cbranch_scc0 L_flags_13
    s_mov_b32 s101, 0
L_flagsok_14:
    s_barrier
    ds_read_b128 a[32:35], v32 offset:0
    ds_read_b128 a[36:39], v33 offset:0
    ds_read_b128 a[40:43], v34 offset:0
    ds_read_b128 a[44:47], v35 offset:0
    ds_read_b128 a[48:51], v36 offset:0
    ds_read_b128 a[52:55], v37 offset:0
    ds_read_b128 a[56:59], v38 offset:0
    ds_read_b128 a[60:63], v39 offset:0
L_qpoll_15:
    buffer_load_dwordx4 v[128:131], v19, s[44:47], s96 offen offset:0 sc1
    buffer_load_dwordx4 v[132:135], v19, s[44:47], s96 offen offset:32 sc1
    buffer_load_dwordx4 v[136:139], v19, s[44:47], s96 offen offset:64 sc1
    buffer_load_dwordx4 v[140:143], v19, s[44:47], s96 offen offset:96 sc1
    buffer_load_dwordx4 v[144:147], v19, s[44:47], s96 offen offset:128 sc1
    buffer_load_dwordx4 v[148:151], v19, s[44:47], s96 offen offset:160 sc1
    buffer_load_dwordx4 v[152:155], v19, s[44:47], s96 offen offset:192 sc1
    buffer_load_dwordx4 v[156:159], v19, s[44:47], s96 offen offset:224 sc1
    s_waitcnt vmcnt(0)
    v_max3_u32 v5, v128, v129, v130
    v_max3_u32 v6, v144, v145, v146
    v_max3_u32 v5, v5, v131, v132
    v_max3_u32 v6, v6, v147, v148
    v_max3_u32 v5, v5, v133, v134
    v_max3_u32 v6, v6, v149, v150
    v_max3_u32 v5, v5, v135, v136
    v_max3_u32 v6, v6, v151, v152
    v_max3_u32 v5, v5, v137, v138
    v_max3_u32 v6, v6, v153, v154
    v_max3_u32 v5, v5, v139, v140
    v_max3_u32 v6, v6, v155, v156
    v_max3_u32 v5, v5, v141, v142
    v_max3_u32 v6, v6, v157, v158
    v_max3_u32 v5, v5, v143, v159
    v_max_u32 v5, v5, v6
    v_cmp_eq_u32 vcc, -1, v5
    s_nop 0
    s_mov_b64 exec, vcc
    s_cbranch_execz L_qok_16
    s_sub_u32 s101, s101, 1
    s_cbranch_scc0 L_qpoll_15
    s_mov_b32 s101, 0
L_qok_16:
    s_mov_b64 exec, -1
    v_accvgpr_write_b32 a0, v128
    v_accvgpr_write_b32 a1, v129
    v_accvgpr_write_b32 a2, v130
    v_accvgpr_write_b32 a3, v131
    v_accvgpr_write_b32 a4, v132
    v_accvgpr_write_b32 a5, v133
    v_accvgpr_write_b32 a6, v134
    v_accvgpr_write_b32 a7, v135
    v_accvgpr_write_b32 a8, v136
    v_accvgpr_write_b32 a9, v137
    v_accvgpr_write_b32 a10, v138
    v_accvgpr_write_b32 a11, v139
    v_accvgpr_write_b32 a12, v140
    v_accvgpr_write_b32 a13, v141
    v_accvgpr_write_b32 a14, v142
    v_accvgpr_write_b32 a15, v143
    v_accvgpr_write_b32 a16, v144
    v_accvgpr_write_b32 a17, v145
    v_accvgpr_write_b32 a18, v146
    v_accvgpr_write_b32 a19, v147
    v_accvgpr_write_b32 a20, v148
    v_accvgpr_write_b32 a21, v149
    v_accvgpr_write_b32 a22, v150
    v_accvgpr_write_b32 a23, v151
    v_accvgpr_write_b32 a24, v152
    v_accvgpr_write_b32 a25, v153
    v_accvgpr_write_b32 a26, v154
    v_accvgpr_write_b32 a27, v155
    v_accvgpr_write_b32 a28, v156
    v_accvgpr_write_b32 a29, v157
    v_accvgpr_write_b32 a30, v158
    v_accvgpr_write_b32 a31, v159
    s_waitcnt lgkmcnt(0)
    v_mfma_f32_32x32x16_bf16 v[128:143], a[32:35], a[0:3], 0
    v_mfma_f32_32x32x16_bf16 v[128:143], a[36:39], a[4:7], v[128:143]
    v_mfma_f32_32x32x16_bf16 v[128:143], a[40:43], a[8:11], v[128:143]
    v_mfma_f32_32x32x16_bf16 v[128:143], a[44:47], a[12:15], v[128:143]
    v_mfma_f32_32x32x16_bf16 v[128:143], a[48:51], a[16:19], v[128:143]
    v_mfma_f32_32x32x16_bf16 v[128:143], a[52:55], a[20:23], v[128:143]
    v_mfma_f32_32x32x16_bf16 v[128:143], a[56:59], a[24:27], v[128:143]
    v_mfma_f32_32x32x16_bf16 v[128:143], a[60:63], a[28:31], v[128:143]
    s_nop 11
    ds_write_b128 v28, v[128:131] offset:0
    ds_write_b128 v28, v[132:135] offset:1024
    ds_write_b128 v28, v[136:139] offset:2048
    ds_write_b128 v28, v[140:143] offset:3072
    s_waitcnt lgkmcnt(0)
    s_barrier
    ds_read_b128 v[144:147], v29 offset:0
    ds_read_b128 v[148:151], v29 offset:1024
    ds_read_b128 v[152:155], v29 offset:2048
    ds_read_b128 v[156:159], v29 offset:3072
    ds_read_b128 v[160:163], v30 offset:0
    ds_read_b128 v[164:167], v30 offset:1024
    ds_read_b128 v[168:171], v30 offset:2048
    ds_read_b128 v[172:175], v30 offset:3072
    ds_read_b128 v[176:179], v31 offset:0
    ds_read_b128 v[180:183], v31 offset:1024
    ds_read_b128 v[184:187], v31 offset:2048
    ds_read_b128 v[188:191], v31 offset:3072
    ds_read_b128 a[32:35], v32 offset:8192
    ds_read_b128 a[36:39], v33 offset:8192
    ds_read_b128 a[40:43], v34 offset:8192
    ds_read_b128 a[44:47], v35 offset:8192
    ds_read_b128 a[48:51], v36 offset:8192
    ds_read_b128 a[52:55], v37 offset:8192
    ds_read_b128 a[56:59], v38 offset:8192
    ds_read_b128 a[60:63], v39 offset:8192
    s_waitcnt lgkmcnt(8)
    v_add_f32 v144, v144, v128
    v_add_f32 v145, v145, v129
    v_add_f32 v146, v146, v130
    v_add_f32 v147, v147, v131
    v_add_f32 v148, v148, v132
    v_add_f32 v149, v149, v133
    v_add_f32 v150, v150, v134
    v_add_f32 v151, v151, v135
    v_add_f32 v152, v152, v136
    v_add_f32 v153, v153, v137
    v_add_f32 v154, v154, v138
    v_add_f32 v155, v155, v139
    v_add_f32 v156, v156, v140
    v_add_f32 v157, v157, v141
    v_add_f32 v158, v158, v142
    v_add_f32 v159, v159, v143
    s_waitcnt lgkmcnt(0)
    v_mfma_f32_32x32x16_bf16 v[128:143], a[32:35], a[0:3], 0
    ds_read_b64_tr_b16 a[64:65], v40 offset:0
    ds_read_b64_tr_b16 a[66:67], v41 offset:2048
    v_add_f32 v160, v160, v176
    v_add_f32 v161, v161, v177
    v_add_f32 v162, v162, v178
    v_add_f32 v163, v163, v179
    v_add_f32 v164, v164, v180
    v_mfma_f32_32x32x16_bf16 v[128:143], a[36:39], a[4:7], v[128:143]
    ds_read_b64_tr_b16 a[72:73], v42 offset:0
    ds_read_b64_tr_b16 a[74:75], v43 offset:2048
    v_add_f32 v165, v165, v181
    v_add_f32 v166, v166, v182
    v_add_f32 v167, v167, v183
    v_add_f32 v168, v168, v184
    v_add_f32 v169, v169, v185
    v_mfma_f32_32x32x16_bf16 v[128:143], a[40:43], a[8:11], v[128:143]
    ds_read_b64_tr_b16 a[80:81], v44 offset:0
    ds_read_b64_tr_b16 a[82:83], v45 offset:2048
    v_add_f32 v170, v170, v186
    v_add_f32 v171, v171, v187
    v_add_f32 v172, v172, v188
    v_add_f32 v173, v173, v189
    v_add_f32 v174, v174, v190
    v_mfma_f32_32x32x16_bf16 v[128:143], a[44:47], a[12:15], v[128:143]
    ds_read_b64_tr_b16 a[88:89], v46 offset:0
    ds_read_b64_tr_b16 a[90:91], v47 offset:2048
    v_add_f32 v175, v175, v191
    v_add_f32 v144, v144, v160
    v_add_f32 v145, v145, v161
    v_add_f32 v146, v146, v162
    v_add_f32 v147, v147, v163
    v_mfma_f32_32x32x16_bf16 v[128:143], a[48:51], a[16:19], v[128:143]
    ds_read_b64_tr_b16 a[68:69], v40 offset:4096
    ds_read_b64_tr_b16 a[70:71], v41 offset:6144
    v_add_f32 v148, v148, v164
    v_add_f32 v149, v149, v165
    v_add_f32 v150, v150, v166
    v_add_f32 v151, v151, v167
    v_add_f32 v152, v152, v168
    v_mfma_f32_32x32x16_bf16 v[128:143], a[52:55], a[20:23], v[128:143]
    ds_read_b64_tr_b16 a[76:77], v42 offset:4096
    ds_read_b64_tr_b16 a[78:79], v43 offset:6144
    v_add_f32 v153, v153, v169
    v_add_f32 v154, v154, v170
    v_add_f32 v155, v155, v171
    v_add_f32 v156, v156, v172
    v_add_f32 v157, v157, v173
    v_mfma_f32_32x32x16_bf16 v[128:143], a[56:59], a[24:27], v[128:143]
    ds_read_b64_tr_b16 a[84:85], v44 offset:4096
    ds_read_b64_tr_b16 a[86:87], v45 offset:6144
    v_add_f32 v158, v158, v174
    v_add_f32 v159, v159, v175
    v_max3_f32 v218, v144, v145, v146
    v_max3_f32 v219, v147, v148, v149
    v_max3_f32 v220, v150, v151, v152
    v_mfma_f32_32x32x16_bf16 v[128:143], a[60:63], a[28:31], v[128:143]
    ds_read_b64_tr_b16 a[92:93], v46 offset:4096
    ds_read_b64_tr_b16 a[94:95], v47 offset:6144
    v_max3_f32 v221, v153, v154, v155
    v_max3_f32 v218, v218, v156, v157
    v_max3_f32 v219, v219, v158, v159
    v_max3_f32 v218, v218, v219, v220
    v_max_f32 v218, v218, v221
    v_mov_b32 v219, v218
    s_nop 1
    v_permlane32_swap_b32 v218, v219
    v_max3_f32 v218, v218, v219, v216
    v_sub_f32 v220, v216, v218
    v_mov_b32 v216, v218
    v_exp_f32 v220, v220
    v_sub_f32 v192, v144, v218
    v_sub_f32 v193, v145, v218
    v_sub_f32 v194, v146, v218
    v_sub_f32 v195, v147, v218
    v_sub_f32 v196, v148, v218
    v_sub_f32 v197, v149, v218
    v_sub_f32 v198, v150, v218
    v_sub_f32 v199, v151, v218
    v_sub_f32 v200, v152, v218
    v_sub_f32 v201, v153, v218
    v_sub_f32 v202, v154, v218
    v_sub_f32 v203, v155, v218
    v_sub_f32 v204, v156, v218
    v_sub_f32 v205, v157, v218
    v_sub_f32 v206, v158, v218
    v_sub_f32 v207, v159, v218
    ds_write_b128 v28, v[128:131] offset:16384
    v_exp_f32 v192, v192
    v_exp_f32 v193, v193
    v_exp_f32 v194, v194
    v_exp_f32 v195, v195
    ds_write_b128 v28, v[132:135] offset:17408
    v_exp_f32 v196, v196
    v_exp_f32 v197, v197
    v_exp_f32 v198, v198
    v_exp_f32 v199, v199
    ds_write_b128 v28, v[136:139] offset:18432
    v_exp_f32 v200, v200
    v_exp_f32 v201, v201
    v_exp_f32 v202, v202
    v_exp_f32 v203, v203
    ds_write_b128 v28, v[140:143] offset:19456
    v_exp_f32 v204, v204
    v_exp_f32 v205, v205
    v_exp_f32 v206, v206
    v_exp_f32 v207, v207
    v_mul_f32 v217, v217, v220
    v_cvt_pk_bf16_f32 v208, v192, v193
    v_cvt_pk_bf16_f32 v209, v194, v195
    v_cvt_pk_bf16_f32 v210, v196, v197
    v_cvt_pk_bf16_f32 v211, v198, v199
    v_cvt_pk_bf16_f32 v212, v200, v201
    v_cvt_pk_bf16_f32 v213, v202, v203
    v_cvt_pk_bf16_f32 v214, v204, v205
    v_cvt_pk_bf16_f32 v215, v206, v207
    v_mul_f32 v64, v64, v220
    v_mul_f32 v65, v65, v220
    v_mul_f32 v66, v66, v220
    v_mul_f32 v67, v67, v220
    v_mul_f32 v68, v68, v220
    v_mul_f32 v69, v69, v220
    v_mul_f32 v70, v70, v220
    v_mul_f32 v71, v71, v220
    v_mul_f32 v72, v72, v220
    v_mul_f32 v73, v73, v220
    v_mul_f32 v74, v74, v220
    v_mul_f32 v75, v75, v220
    v_mul_f32 v76, v76, v220
    v_mul_f32 v77, v77, v220
    v_mul_f32 v78, v78, v220
    v_mul_f32 v79, v79, v220
    s_waitcnt lgkmcnt(0)
    s_barrier
    v_mfma_f32_32x32x16_bf16 v[64:79], a[64:67], v[208:211], v[64:79]
    ds_read_b128 v[144:147], v29 offset:16384
    v_mul_f32 v80, v80, v220
    v_mul_f32 v81, v81, v220
    ds_read_b128 v[148:151], v29 offset:17408
    ds_write_b128 v26, a[96:99] offset:0
    buffer_load_dwordx4 a[96:99], v20, s[32:35], s58 offen nt
    v_mul_f32 v82, v82, v220
    v_mul_f32 v83, v83, v220
    ds_read_b128 v[152:155], v29 offset:18432
    v_mul_f32 v84, v84, v220
    v_mfma_f32_32x32x16_bf16 v[64:79], a[68:71], v[212:215], v[64:79]
    v_mul_f32 v85, v85, v220
    ds_read_b128 v[156:159], v29 offset:19456
    v_mul_f32 v86, v86, v220
    ds_write_b128 v26, a[100:103] offset:1024
    buffer_load_dwordx4 a[100:103], v21, s[32:35], s58 offen nt
    v_mul_f32 v87, v87, v220
    v_mul_f32 v88, v88, v220
    v_mul_f32 v89, v89, v220
    v_mul_f32 v90, v90, v220
    v_mul_f32 v91, v91, v220
    v_mul_f32 v92, v92, v220
    v_mul_f32 v93, v93, v220
    v_mul_f32 v94, v94, v220
    v_mul_f32 v95, v95, v220
    s_nop 1
    v_mfma_f32_32x32x16_bf16 v[80:95], a[72:75], v[208:211], v[80:95]
    ds_read_b128 v[160:163], v30 offset:16384
    v_mul_f32 v96, v96, v220
    v_mul_f32 v97, v97, v220
    ds_read_b128 v[164:167], v30 offset:17408
    ds_write_b128 v26, a[104:107] offset:2048
    buffer_load_dwordx4 a[104:107], v22, s[32:35], s58 offen nt
    v_mul_f32 v98, v98, v220
    v_mul_f32 v99, v99, v220
    ds_read_b128 v[168:171], v30 offset:18432
    v_mul_f32 v100, v100, v220
    v_mfma_f32_32x32x16_bf16 v[80:95], a[76:79], v[212:215], v[80:95]
    v_mul_f32 v101, v101, v220
    ds_read_b128 v[172:175], v30 offset:19456
    v_mul_f32 v102, v102, v220
    ds_write_b128 v26, a[108:111] offset:3072
    buffer_load_dwordx4 a[108:111], v23, s[32:35], s58 offen nt
    s_add_u32 s58, s58, 16384
    v_mul_f32 v103, v103, v220
    v_mul_f32 v104, v104, v220
    v_mul_f32 v105, v105, v220
    v_mul_f32 v106, v106, v220
    v_mul_f32 v107, v107, v220
    v_mul_f32 v108, v108, v220
    v_mul_f32 v109, v109, v220
    v_mul_f32 v110, v110, v220
    v_mul_f32 v111, v111, v220
    s_nop 1
    v_mfma_f32_32x32x16_bf16 v[96:111], a[80:83], v[208:211], v[96:111]
    ds_read_b128 v[176:179], v31 offset:16384
    v_mul_f32 v112, v112, v220
    v_mul_f32 v113, v113, v220
    ds_read_b128 v[180:183], v31 offset:17408
    ds_write_b128 v26, a[112:115] offset:4096
    buffer_load_dwordx4 a[112:115], v20, s[32:35], s58 offen nt
    v_mul_f32 v114, v114, v220
    v_mul_f32 v115, v115, v220
    ds_read_b128 v[184:187], v31 offset:18432
    v_mul_f32 v116, v116, v220
    v_mfma_f32_32x32x16_bf16 v[96:111], a[84:87], v[212:215], v[96:111]
    v_mul_f32 v117, v117, v220
    ds_read_b128 v[188:191], v31 offset:19456
    v_mul_f32 v118, v118, v220
    ds_write_b128 v26, a[116:119] offset:5120
    buffer_load_dwordx4 a[116:119], v21, s[32:35], s58 offen nt
    v_mul_f32 v119, v119, v220
    v_mul_f32 v120, v120, v220
    v_mul_f32 v121, v121, v220
    v_mul_f32 v122, v122, v220
    v_mul_f32 v123, v123, v220
    v_mul_f32 v124, v124, v220
    v_mul_f32 v125, v125, v220
    v_mul_f32 v126, v126, v220
    v_mul_f32 v127, v127, v220
    s_nop 1
    v_mfma_f32_32x32x16_bf16 v[112:127], a[88:91], v[208:211], v[112:127]
    v_add_f32 v192, v192, v200
    v_add_f32 v193, v193, v201
    v_add_f32 v194, v194, v202
    v_add_f32 v195, v195, v203
    ds_write_b128 v26, a[120:123] offset:6144
    buffer_load_dwordx4 a[120:123], v22, s[32:35], s58 offen nt
    v_add_f32 v196, v196, v204
    v_add_f32 v197, v197, v205
    v_add_f32 v198, v198, v206
    v_add_f32 v199, v199, v207
    v_mfma_f32_32x32x16_bf16 v[112:127], a[92:95], v[212:215], v[112:127]
    v_add_f32 v192, v192, v196
    v_add_f32 v193, v193, v197
    v_add_f32 v194, v194, v198
    ds_write_b128 v26, a[124:127] offset:7168
    buffer_load_dwordx4 a[124:127], v23, s[32:35], s58 offen nt
    s_add_u32 s58, s58, 16384
    v_add_f32 v195, v195, v199
    v_add_f32 v192, v192, v193
    v_add_f32 v194, v194, v195
    v_add_f32 v192, v192, v194
    v_add_f32 v217, v217, v192
    ds_read_b128 a[32:35], v32 offset:16384
    ds_read_b128 a[36:39], v33 offset:16384
    ds_read_b128 a[40:43], v34 offset:16384
    ds_read_b128 a[44:47], v35 offset:16384
    ds_read_b128 a[48:51], v36 offset:16384
    ds_read_b128 a[52:55], v37 offset:16384
    ds_read_b128 a[56:59], v38 offset:16384
    ds_read_b128 a[60:63], v39 offset:16384
    s_waitcnt lgkmcnt(8)
    v_add_f32 v144, v144, v128
    v_add_f32 v145, v145, v129
    v_add_f32 v146, v146, v130
    v_add_f32 v147, v147, v131
    v_add_f32 v148, v148, v132
    v_add_f32 v149, v149, v133
    v_add_f32 v150, v150, v134
    v_add_f32 v151, v151, v135
    v_add_f32 v152, v152, v136
    v_add_f32 v153, v153, v137
    v_add_f32 v154, v154, v138
    v_add_f32 v155, v155, v139
    v_add_f32 v156, v156, v140
    v_add_f32 v157, v157, v141
    v_add_f32 v158, v158, v142
    v_add_f32 v159, v159, v143
    s_waitcnt lgkmcnt(0)
    v_mfma_f32_32x32x16_bf16 v[128:143], a[32:35], a[0:3], 0
    ds_read_b64_tr_b16 a[64:65], v40 offset:8192
    ds_read_b64_tr_b16 a[66:67], v41 offset:10240
    v_add_f32 v160, v160, v176
    v_add_f32 v161, v161, v177
    v_add_f32 v162, v162, v178
    v_add_f32 v163, v163, v179
    v_add_f32 v164, v164, v180
    v_mfma_f32_32x32x16_bf16 v[128:143], a[36:39], a[4:7], v[128:143]
    ds_read_b64_tr_b16 a[72:73], v42 offset:8192
    ds_read_b64_tr_b16 a[74:75], v43 offset:10240
    v_add_f32 v165, v165, v181
    v_add_f32 v166, v166, v182
    v_add_f32 v167, v167, v183
    v_add_f32 v168, v168, v184
    v_add_f32 v169, v169, v185
    v_mfma_f32_32x32x16_bf16 v[128:143], a[40:43], a[8:11], v[128:143]
    ds_read_b64_tr_b16 a[80:81], v44 offset:8192
    ds_read_b64_tr_b16 a[82:83], v45 offset:10240
    v_add_f32 v170, v170, v186
    v_add_f32 v171, v171, v187
    v_add_f32 v172, v172, v188
    v_add_f32 v173, v173, v189
    v_add_f32 v174, v174, v190
    v_mfma_f32_32x32x16_bf16 v[128:143], a[44:47], a[12:15], v[128:143]
    ds_read_b64_tr_b16 a[88:89], v46 offset:8192
    ds_read_b64_tr_b16 a[90:91], v47 offset:10240
    v_add_f32 v175, v175, v191
    v_add_f32 v144, v144, v160
    v_add_f32 v145, v145, v161
    v_add_f32 v146, v146, v162
    v_add_f32 v147, v147, v163
    v_mfma_f32_32x32x16_bf16 v[128:143], a[48:51], a[16:19], v[128:143]
    ds_read_b64_tr_b16 a[68:69], v40 offset:12288
    ds_read_b64_tr_b16 a[70:71], v41 offset:14336
    v_add_f32 v148, v148, v164
    v_add_f32 v149, v149, v165
    v_add_f32 v150, v150, v166
    v_add_f32 v151, v151, v167
    v_add_f32 v152, v152, v168
    v_mfma_f32_32x32x16_bf16 v[128:143], a[52:55], a[20:23], v[128:143]
    ds_read_b64_tr_b16 a[76:77], v42 offset:12288
    ds_read_b64_tr_b16 a[78:79], v43 offset:14336
    v_add_f32 v153, v153, v169
    v_add_f32 v154, v154, v170
    v_add_f32 v155, v155, v171
    v_add_f32 v156, v156, v172
    v_add_f32 v157, v157, v173
    v_mfma_f32_32x32x16_bf16 v[128:143], a[56:59], a[24:27], v[128:143]
    ds_read_b64_tr_b16 a[84:85], v44 offset:12288
    ds_read_b64_tr_b16 a[86:87], v45 offset:14336
    v_add_f32 v158, v158, v174
    v_add_f32 v159, v159, v175
    v_max3_f32 v218, v144, v145, v146
    v_max3_f32 v219, v147, v148, v149
    v_max3_f32 v220, v150, v151, v152
    v_mfma_f32_32x32x16_bf16 v[128:143], a[60:63], a[28:31], v[128:143]
    ds_read_b64_tr_b16 a[92:93], v46 offset:12288
    ds_read_b64_tr_b16 a[94:95], v47 offset:14336
    v_max3_f32 v221, v153, v154, v155
    v_max3_f32 v218, v218, v156, v157
    v_max3_f32 v219, v219, v158, v159
    v_max3_f32 v218, v218, v219, v220
    v_max_f32 v218, v218, v221
    v_mov_b32 v219, v218
    s_nop 1
    v_permlane32_swap_b32 v218, v219
    v_max3_f32 v218, v218, v219, v216
    v_sub_f32 v220, v216, v218
    v_mov_b32 v216, v218
    v_exp_f32 v220, v220
    v_sub_f32 v192, v144, v218
    v_sub_f32 v193, v145, v218
    v_sub_f32 v194, v146, v218
    v_sub_f32 v195, v147, v218
    v_sub_f32 v196, v148, v218
    v_sub_f32 v197, v149, v218
    v_sub_f32 v198, v150, v218
    v_sub_f32 v199, v151, v218
    v_sub_f32 v200, v152, v218
    v_sub_f32 v201, v153, v218
    v_sub_f32 v202, v154, v218
    v_sub_f32 v203, v155, v218
    v_sub_f32 v204, v156, v218
    v_sub_f32 v205, v157, v218
    v_sub_f32 v206, v158, v218
    v_sub_f32 v207, v159, v218
    ds_write_b128 v28, v[128:131] offset:0
    v_exp_f32 v192, v192
    v_exp_f32 v193, v193
    v_exp_f32 v194, v194
    v_exp_f32 v195, v195
    ds_write_b128 v28, v[132:135] offset:1024
    v_exp_f32 v196, v196
    v_exp_f32 v197, v197
    v_exp_f32 v198, v198
    v_exp_f32 v199, v199
    ds_write_b128 v28, v[136:139] offset:2048
    v_exp_f32 v200, v200
    v_exp_f32 v201, v201
    v_exp_f32 v202, v202
    v_exp_f32 v203, v203
    ds_write_b128 v28, v[140:143] offset:3072
    v_exp_f32 v204, v204
    v_exp_f32 v205, v205
    v_exp_f32 v206, v206
    v_exp_f32 v207, v207
    v_mul_f32 v217, v217, v220
    v_cvt_pk_bf16_f32 v208, v192, v193
    v_cvt_pk_bf16_f32 v209, v194, v195
    v_cvt_pk_bf16_f32 v210, v196, v197
    v_cvt_pk_bf16_f32 v211, v198, v199
    v_cvt_pk_bf16_f32 v212, v200, v201
    v_cvt_pk_bf16_f32 v213, v202, v203
    v_cvt_pk_bf16_f32 v214, v204, v205
    v_cvt_pk_bf16_f32 v215, v206, v207
    v_mul_f32 v64, v64, v220
    v_mul_f32 v65, v65, v220
    v_mul_f32 v66, v66, v220
    v_mul_f32 v67, v67, v220
    v_mul_f32 v68, v68, v220
    v_mul_f32 v69, v69, v220
    v_mul_f32 v70, v70, v220
    v_mul_f32 v71, v71, v220
    v_mul_f32 v72, v72, v220
    v_mul_f32 v73, v73, v220
    v_mul_f32 v74, v74, v220
    v_mul_f32 v75, v75, v220
    v_mul_f32 v76, v76, v220
    v_mul_f32 v77, v77, v220
    v_mul_f32 v78, v78, v220
    v_mul_f32 v79, v79, v220
    s_waitcnt lgkmcnt(0)
    s_barrier
    v_mfma_f32_32x32x16_bf16 v[64:79], a[64:67], v[208:211], v[64:79]
    ds_read_b128 v[144:147], v29 offset:0
    v_mul_f32 v80, v80, v220
    v_mul_f32 v81, v81, v220
    ds_read_b128 v[148:151], v29 offset:1024
    ds_write_b128 v26, a[128:131] offset:8192
    buffer_load_dwordx4 a[128:131], v20, s[32:35], s58 offen nt
    v_mul_f32 v82, v82, v220
    v_mul_f32 v83, v83, v220
    ds_read_b128 v[152:155], v29 offset:2048
    v_mul_f32 v84, v84, v220
    v_mfma_f32_32x32x16_bf16 v[64:79], a[68:71], v[212:215], v[64:79]
    v_mul_f32 v85, v85, v220
    ds_read_b128 v[156:159], v29 offset:3072
    v_mul_f32 v86, v86, v220
    ds_write_b128 v26, a[132:135] offset:9216
    buffer_load_dwordx4 a[132:135], v21, s[32:35], s58 offen nt
    v_mul_f32 v87, v87, v220
    v_mul_f32 v88, v88, v220
    v_mul_f32 v89, v89, v220
    v_mul_f32 v90, v90, v220
    v_mul_f32 v91, v91, v220
    v_mul_f32 v92, v92, v220
    v_mul_f32 v93, v93, v220
    v_mul_f32 v94, v94, v220
    v_mul_f32 v95, v95, v220
    s_nop 1
    v_mfma_f32_32x32x16_bf16 v[80:95], a[72:75], v[208:211], v[80:95]
    ds_read_b128 v[160:163], v30 offset:0
    v_mul_f32 v96, v96, v220
    v_mul_f32 v97, v97, v220
    ds_read_b128 v[164:167], v30 offset:1024
    ds_write_b128 v26, a[136:139] offset:10240
    buffer_load_dwordx4 a[136:139], v22, s[32:35], s58 offen nt
    v_mul_f32 v98, v98, v220
    v_mul_f32 v99, v99, v220
    ds_read_b128 v[168:171], v30 offset:2048
    v_mul_f32 v100, v100, v220
    v_mfma_f32_32x32x16_bf16 v[80:95], a[76:79], v[212:215], v[80:95]
    v_mul_f32 v101, v101, v220
    ds_read_b128 v[172:175], v30 offset:3072
    v_mul_f32 v102, v102, v220
    ds_write_b128 v26, a[140:143] offset:11264
    buffer_load_dwordx4 a[140:143], v23, s[32:35], s58 offen nt
    s_add_u32 s58, s58, 16384
    v_mul_f32 v103, v103, v220
    v_mul_f32 v104, v104, v220
    v_mul_f32 v105, v105, v220
    v_mul_f32 v106, v106, v220
    v_mul_f32 v107, v107, v220
    v_mul_f32 v108, v108, v220
    v_mul_f32 v109, v109, v220
    v_mul_f32 v110, v110, v220
    v_mul_f32 v111, v111, v220
    s_nop 1
    v_mfma_f32_32x32x16_bf16 v[96:111], a[80:83], v[208:211], v[96:111]
    ds_read_b128 v[176:179], v31 offset:0
    v_mul_f32 v112, v112, v220
    v_mul_f32 v113, v113, v220
    ds_read_b128 v[180:183], v31 offset:1024
    ds_write_b128 v26, a[144:147] offset:12288
    buffer_load_dwordx4 a[144:147], v20, s[32:35], s58 offen nt
    v_mul_f32 v114, v114, v220
    v_mul_f32 v115, v115, v220
    ds_read_b128 v[184:187], v31 offset:2048
    v_mul_f32 v116, v116, v220
    v_mfma_f32_32x32x16_bf16 v[96:111], a[84:87], v[212:215], v[96:111]
    v_mul_f32 v117, v117, v220
    ds_read_b128 v[188:191], v31 offset:3072
    v_mul_f32 v118, v118, v220
    ds_write_b128 v26, a[148:151] offset:13312
    buffer_load_dwordx4 a[148:151], v21, s[32:35], s58 offen nt
    v_mul_f32 v119, v119, v220
    v_mul_f32 v120, v120, v220
    v_mul_f32 v121, v121, v220
    v_mul_f32 v122, v122, v220
    v_mul_f32 v123, v123, v220
    v_mul_f32 v124, v124, v220
    v_mul_f32 v125, v125, v220
    v_mul_f32 v126, v126, v220
    v_mul_f32 v127, v127, v220
    s_nop 1
    v_mfma_f32_32x32x16_bf16 v[112:127], a[88:91], v[208:211], v[112:127]
    v_add_f32 v192, v192, v200
    v_add_f32 v193, v193, v201
    v_add_f32 v194, v194, v202
    v_add_f32 v195, v195, v203
    ds_write_b128 v26, a[152:155] offset:14336
    buffer_load_dwordx4 a[152:155], v22, s[32:35], s58 offen nt
    v_add_f32 v196, v196, v204
    v_add_f32 v197, v197, v205
    v_add_f32 v198, v198, v206
    v_add_f32 v199, v199, v207
    v_mfma_f32_32x32x16_bf16 v[112:127], a[92:95], v[212:215], v[112:127]
    v_add_f32 v192, v192, v196
    v_add_f32 v193, v193, v197
    v_add_f32 v194, v194, v198
    ds_write_b128 v26, a[156:159] offset:15360
    buffer_load_dwordx4 a[156:159], v23, s[32:35], s58 offen nt
    s_add_u32 s58, s58, 16384
    v_add_f32 v195, v195, v199
    v_add_f32 v192, v192, v193
    v_add_f32 v194, v194, v195
    v_add_f32 v192, v192, v194
    v_add_f32 v217, v217, v192
    ds_read_b128 a[32:35], v32 offset:24576
    ds_read_b128 a[36:39], v33 offset:24576
    ds_read_b128 a[40:43], v34 offset:24576
    ds_read_b128 a[44:47], v35 offset:24576
    ds_read_b128 a[48:51], v36 offset:24576
    ds_read_b128 a[52:55], v37 offset:24576
    ds_read_b128 a[56:59], v38 offset:24576
    ds_read_b128 a[60:63], v39 offset:24576
    s_waitcnt lgkmcnt(8)
    v_add_f32 v144, v144, v128
    v_add_f32 v145, v145, v129
    v_add_f32 v146, v146, v130
    v_add_f32 v147, v147, v131
    v_add_f32 v148, v148, v132
    v_add_f32 v149, v149, v133
    v_add_f32 v150, v150, v134
    v_add_f32 v151, v151, v135
    v_add_f32 v152, v152, v136
    v_add_f32 v153, v153, v137
    v_add_f32 v154, v154, v138
    v_add_f32 v155, v155, v139
    v_add_f32 v156, v156, v140
    v_add_f32 v157, v157, v141
    v_add_f32 v158, v158, v142
    v_add_f32 v159, v159, v143
    s_waitcnt lgkmcnt(0)
    v_mfma_f32_32x32x16_bf16 v[128:143], a[32:35], a[0:3], 0
    ds_read_b64_tr_b16 a[64:65], v40 offset:16384
    ds_read_b64_tr_b16 a[66:67], v41 offset:18432
    v_add_f32 v160, v160, v176
    v_add_f32 v161, v161, v177
    v_add_f32 v162, v162, v178
    v_add_f32 v163, v163, v179
    v_add_f32 v164, v164, v180
    v_mfma_f32_32x32x16_bf16 v[128:143], a[36:39], a[4:7], v[128:143]
    ds_read_b64_tr_b16 a[72:73], v42 offset:16384
    ds_read_b64_tr_b16 a[74:75], v43 offset:18432
    v_add_f32 v165, v165, v181
    v_add_f32 v166, v166, v182
    v_add_f32 v167, v167, v183
    v_add_f32 v168, v168, v184
    v_add_f32 v169, v169, v185
    v_mfma_f32_32x32x16_bf16 v[128:143], a[40:43], a[8:11], v[128:143]
    ds_read_b64_tr_b16 a[80:81], v44 offset:16384
    ds_read_b64_tr_b16 a[82:83], v45 offset:18432
    v_add_f32 v170, v170, v186
    v_add_f32 v171, v171, v187
    v_add_f32 v172, v172, v188
    v_add_f32 v173, v173, v189
    v_add_f32 v174, v174, v190
    v_mfma_f32_32x32x16_bf16 v[128:143], a[44:47], a[12:15], v[128:143]
    ds_read_b64_tr_b16 a[88:89], v46 offset:16384
    ds_read_b64_tr_b16 a[90:91], v47 offset:18432
    v_add_f32 v175, v175, v191
    v_add_f32 v144, v144, v160
    v_add_f32 v145, v145, v161
    v_add_f32 v146, v146, v162
    v_add_f32 v147, v147, v163
    v_mfma_f32_32x32x16_bf16 v[128:143], a[48:51], a[16:19], v[128:143]
    ds_read_b64_tr_b16 a[68:69], v40 offset:20480
    ds_read_b64_tr_b16 a[70:71], v41 offset:22528
    v_add_f32 v148, v148, v164
    v_add_f32 v149, v149, v165
    v_add_f32 v150, v150, v166
    v_add_f32 v151, v151, v167
    v_add_f32 v152, v152, v168
    v_mfma_f32_32x32x16_bf16 v[128:143], a[52:55], a[20:23], v[128:143]
    ds_read_b64_tr_b16 a[76:77], v42 offset:20480
    ds_read_b64_tr_b16 a[78:79], v43 offset:22528
    v_add_f32 v153, v153, v169
    v_add_f32 v154, v154, v170
    v_add_f32 v155, v155, v171
    v_add_f32 v156, v156, v172
    v_add_f32 v157, v157, v173
    v_mfma_f32_32x32x16_bf16 v[128:143], a[56:59], a[24:27], v[128:143]
    ds_read_b64_tr_b16 a[84:85], v44 offset:20480
    ds_read_b64_tr_b16 a[86:87], v45 offset:22528
    v_add_f32 v158, v158, v174
    v_add_f32 v159, v159, v175
    v_max3_f32 v218, v144, v145, v146
    v_max3_f32 v219, v147, v148, v149
    v_max3_f32 v220, v150, v151, v152
    v_mfma_f32_32x32x16_bf16 v[128:143], a[60:63], a[28:31], v[128:143]
    ds_read_b64_tr_b16 a[92:93], v46 offset:20480
    ds_read_b64_tr_b16 a[94:95], v47 offset:22528
    v_max3_f32 v221, v153, v154, v155
    v_max3_f32 v218, v218, v156, v157
    v_max3_f32 v219, v219, v158, v159
    v_max3_f32 v218, v218, v219, v220
    v_max_f32 v218, v218, v221
    v_mov_b32 v219, v218
    s_nop 1
    v_permlane32_swap_b32 v218, v219
    v_max3_f32 v218, v218, v219, v216
    v_sub_f32 v220, v216, v218
    v_mov_b32 v216, v218
    v_exp_f32 v220, v220
    v_sub_f32 v192, v144, v218
    v_sub_f32 v193, v145, v218
    v_sub_f32 v194, v146, v218
    v_sub_f32 v195, v147, v218
    v_sub_f32 v196, v148, v218
    v_sub_f32 v197, v149, v218
    v_sub_f32 v198, v150, v218
    v_sub_f32 v199, v151, v218
    v_sub_f32 v200, v152, v218
    v_sub_f32 v201, v153, v218
    v_sub_f32 v202, v154, v218
    v_sub_f32 v203, v155, v218
    v_sub_f32 v204, v156, v218
    v_sub_f32 v205, v157, v218
    v_sub_f32 v206, v158, v218
    v_sub_f32 v207, v159, v218
    ds_write_b128 v28, v[128:131] offset:16384
    v_exp_f32 v192, v192
    v_exp_f32 v193, v193
    v_exp_f32 v194, v194
    v_exp_f32 v195, v195
    ds_write_b128 v28, v[132:135] offset:17408
    v_exp_f32 v196, v196
    v_exp_f32 v197, v197
    v_exp_f32 v198, v198
    v_exp_f32 v199, v199
    ds_write_b128 v28, v[136:139] offset:18432
    v_exp_f32 v200, v200
    v_exp_f32 v201, v201
    v_exp_f32 v202, v202
    v_exp_f32 v203, v203
    ds_write_b128 v28, v[140:143] offset:19456
    v_exp_f32 v204, v204
    v_exp_f32 v205, v205
    v_exp_f32 v206, v206
    v_exp_f32 v207, v207
    v_mul_f32 v217, v217, v220
    v_cvt_pk_bf16_f32 v208, v192, v193
    v_cvt_pk_bf16_f32 v209, v194, v195
    v_cvt_pk_bf16_f32 v210, v196, v197
    v_cvt_pk_bf16_f32 v211, v198, v199
    v_cvt_pk_bf16_f32 v212, v200, v201
    v_cvt_pk_bf16_f32 v213, v202, v203
    v_cvt_pk_bf16_f32 v214, v204, v205
    v_cvt_pk_bf16_f32 v215, v206, v207
    v_mul_f32 v64, v64, v220
    v_mul_f32 v65, v65, v220
    v_mul_f32 v66, v66, v220
    v_mul_f32 v67, v67, v220
    v_mul_f32 v68, v68, v220
    v_mul_f32 v69, v69, v220
    v_mul_f32 v70, v70, v220
    v_mul_f32 v71, v71, v220
    v_mul_f32 v72, v72, v220
    v_mul_f32 v73, v73, v220
    v_mul_f32 v74, v74, v220
    v_mul_f32 v75, v75, v220
    v_mul_f32 v76, v76, v220
    v_mul_f32 v77, v77, v220
    v_mul_f32 v78, v78, v220
    v_mul_f32 v79, v79, v220
    s_waitcnt lgkmcnt(0)
    s_barrier
    v_mfma_f32_32x32x16_bf16 v[64:79], a[64:67], v[208:211], v[64:79]
    ds_read_b128 v[144:147], v29 offset:16384
    v_mul_f32 v80, v80, v220
    v_mul_f32 v81, v81, v220
    ds_read_b128 v[148:151], v29 offset:17408
    ds_write_b128 v26, a[160:163] offset:16384
    buffer_load_dwordx4 a[160:163], v20, s[32:35], s58 offen nt
    v_mul_f32 v82, v82, v220
    v_mul_f32 v83, v83, v220
    ds_read_b128 v[152:155], v29 offset:18432
    v_mul_f32 v84, v84, v220
    v_mfma_f32_32x32x16_bf16 v[64:79], a[68:71], v[212:215], v[64:79]
    v_mul_f32 v85, v85, v220
    ds_read_b128 v[156:159], v29 offset:19456
    v_mul_f32 v86, v86, v220
    ds_write_b128 v26, a[164:167] offset:17408
    buffer_load_dwordx4 a[164:167], v21, s[32:35], s58 offen nt
    v_mul_f32 v87, v87, v220
    v_mul_f32 v88, v88, v220
    v_mul_f32 v89, v89, v220
    v_mul_f32 v90, v90, v220
    v_mul_f32 v91, v91, v220
    v_mul_f32 v92, v92, v220
    v_mul_f32 v93, v93, v220
    v_mul_f32 v94, v94, v220
    v_mul_f32 v95, v95, v220
    s_nop 1
    v_mfma_f32_32x32x16_bf16 v[80:95], a[72:75], v[208:211], v[80:95]
    ds_read_b128 v[160:163], v30 offset:16384
    v_mul_f32 v96, v96, v220
    v_mul_f32 v97, v97, v220
    ds_read_b128 v[164:167], v30 offset:17408
    ds_write_b128 v26, a[168:171] offset:18432
    buffer_load_dwordx4 a[168:171], v22, s[32:35], s58 offen nt
    v_mul_f32 v98, v98, v220
    v_mul_f32 v99, v99, v220
    ds_read_b128 v[168:171], v30 offset:18432
    v_mul_f32 v100, v100, v220
    v_mfma_f32_32x32x16_bf16 v[80:95], a[76:79], v[212:215], v[80:95]
    v_mul_f32 v101, v101, v220
    ds_read_b128 v[172:175], v30 offset:19456
    v_mul_f32 v102, v102, v220
    ds_write_b128 v26, a[172:175] offset:19456
    v_mul_f32 v103, v103, v220
    v_mul_f32 v104, v104, v220
    v_mul_f32 v105, v105, v220
    v_mul_f32 v106, v106, v220
    v_mul_f32 v107, v107, v220
    v_mul_f32 v108, v108, v220
    v_mul_f32 v109, v109, v220
    v_mul_f32 v110, v110, v220
    v_mul_f32 v111, v111, v220
    s_nop 1
    v_mfma_f32_32x32x16_bf16 v[96:111], a[80:83], v[208:211], v[96:111]
    ds_read_b128 v[176:179], v31 offset:16384
    v_mul_f32 v112, v112, v220
    v_mul_f32 v113, v113, v220
    ds_read_b128 v[180:183], v31 offset:17408
    ds_write_b128 v26, a[176:179] offset:20480
    buffer_load_dwordx4 a[172:175], v23, s[32:35], s58 offen nt
    s_add_u32 s58, s58, 16384
    v_mul_f32 v114, v114, v220
    v_mul_f32 v115, v115, v220
    ds_read_b128 v[184:187], v31 offset:18432
    v_mul_f32 v116, v116, v220
    v_mfma_f32_32x32x16_bf16 v[96:111], a[84:87], v[212:215], v[96:111]
    v_mul_f32 v117, v117, v220
    ds_read_b128 v[188:191], v31 offset:19456
    v_mul_f32 v118, v118, v220
    ds_write_b128 v26, a[180:183] offset:21504
    buffer_load_dwordx4 a[176:179], v20, s[32:35], s58 offen nt
    v_mul_f32 v119, v119, v220
    v_mul_f32 v120, v120, v220
    v_mul_f32 v121, v121, v220
    v_mul_f32 v122, v122, v220
    v_mul_f32 v123, v123, v220
    v_mul_f32 v124, v124, v220
    v_mul_f32 v125, v125, v220
    v_mul_f32 v126, v126, v220
    v_mul_f32 v127, v127, v220
    s_nop 1
    v_mfma_f32_32x32x16_bf16 v[112:127], a[88:91], v[208:211], v[112:127]
    v_add_f32 v192, v192, v200
    v_add_f32 v193, v193, v201
    v_add_f32 v194, v194, v202
    v_add_f32 v195, v195, v203
    ds_write_b128 v26, a[184:187] offset:22528
    buffer_load_dwordx4 a[180:183], v21, s[32:35], s58 offen nt
    v_add_f32 v196, v196, v204
    v_add_f32 v197, v197, v205
    v_add_f32 v198, v198, v206
    v_add_f32 v199, v199, v207
    v_mfma_f32_32x32x16_bf16 v[112:127], a[92:95], v[212:215], v[112:127]
    v_add_f32 v192, v192, v196
    v_add_f32 v193, v193, v197
    v_add_f32 v194, v194, v198
    ds_write_b128 v26, a[188:191] offset:23552
    v_add_f32 v195, v195, v199
    v_add_f32 v192, v192, v193
    v_add_f32 v194, v194, v195
    v_add_f32 v192, v192, v194
    v_add_f32 v217, v217, v192
    ds_read_b128 a[32:35], v32 offset:0
    ds_read_b128 a[36:39], v33 offset:0
    ds_read_b128 a[40:43], v34 offset:0
    ds_read_b128 a[44:47], v35 offset:0
    ds_read_b128 a[48:51], v36 offset:0
    ds_read_b128 a[52:55], v37 offset:0
    ds_read_b128 a[56:59], v38 offset:0
    ds_read_b128 a[60:63], v39 offset:0
    s_waitcnt lgkmcnt(8)
    v_add_f32 v144, v144, v128
    v_add_f32 v145, v145, v129
    v_add_f32 v146, v146, v130
    v_add_f32 v147, v147, v131
    buffer_load_dwordx4 a[184:187], v22, s[32:35], s58 offen nt
    v_add_f32 v148, v148, v132
    v_add_f32 v149, v149, v133
    v_add_f32 v150, v150, v134
    v_add_f32 v151, v151, v135
    v_add_f32 v152, v152, v136
    v_add_f32 v153, v153, v137
    v_add_f32 v154, v154, v138
    v_add_f32 v155, v155, v139
    v_add_f32 v156, v156, v140
    v_add_f32 v157, v157, v141
    v_add_f32 v158, v158, v142
    v_add_f32 v159, v159, v143
    s_waitcnt lgkmcnt(0)
    v_mfma_f32_32x32x16_bf16 v[128:143], a[32:35], a[0:3], 0
    ds_read_b64_tr_b16 a[64:65], v40 offset:24576
    ds_read_b64_tr_b16 a[66:67], v41 offset:26624
    v_add_f32 v160, v160, v176
    v_add_f32 v161, v161, v177
    v_add_f32 v162, v162, v178
    v_add_f32 v163, v163, v179
    v_add_f32 v164, v164, v180
    v_mfma_f32_32x32x16_bf16 v[128:143], a[36:39], a[4:7], v[128:143]
    ds_read_b64_tr_b16 a[72:73], v42 offset:24576
    ds_read_b64_tr_b16 a[74:75], v43 offset:26624
    v_add_f32 v165, v165, v181
    v_add_f32 v166, v166, v182
    v_add_f32 v167, v167, v183
    v_add_f32 v168, v168, v184
    v_add_f32 v169, v169, v185
    v_mfma_f32_32x32x16_bf16 v[128:143], a[40:43], a[8:11], v[128:143]
    ds_read_b64_tr_b16 a[80:81], v44 offset:24576
    ds_read_b64_tr_b16 a[82:83], v45 offset:26624
    v_add_f32 v170, v170, v186
    v_add_f32 v171, v171, v187
    v_add_f32 v172, v172, v188
    v_add_f32 v173, v173, v189
    v_add_f32 v174, v174, v190
    v_mfma_f32_32x32x16_bf16 v[128:143], a[44:47], a[12:15], v[128:143]
    ds_read_b64_tr_b16 a[88:89], v46 offset:24576
    ds_read_b64_tr_b16 a[90:91], v47 offset:26624
    v_add_f32 v175, v175, v191
    v_add_f32 v144, v144, v160
    v_add_f32 v145, v145, v161
    v_add_f32 v146, v146, v162
    v_add_f32 v147, v147, v163
    v_mfma_f32_32x32x16_bf16 v[128:143], a[48:51], a[16:19], v[128:143]
    ds_read_b64_tr_b16 a[68:69], v40 offset:28672
    ds_read_b64_tr_b16 a[70:71], v41 offset:30720
    v_add_f32 v148, v148, v164
    v_add_f32 v149, v149, v165
    v_add_f32 v150, v150, v166
    v_add_f32 v151, v151, v167
    v_add_f32 v152, v152, v168
    v_mfma_f32_32x32x16_bf16 v[128:143], a[52:55], a[20:23], v[128:143]
    ds_read_b64_tr_b16 a[76:77], v42 offset:28672
    ds_read_b64_tr_b16 a[78:79], v43 offset:30720
    v_add_f32 v153, v153, v169
    v_add_f32 v154, v154, v170
    v_add_f32 v155, v155, v171
    v_add_f32 v156, v156, v172
    v_add_f32 v157, v157, v173
    v_mfma_f32_32x32x16_bf16 v[128:143], a[56:59], a[24:27], v[128:143]
    ds_read_b64_tr_b16 a[84:85], v44 offset:28672
    ds_read_b64_tr_b16 a[86:87], v45 offset:30720
    v_add_f32 v158, v158, v174
    v_add_f32 v159, v159, v175
    v_max3_f32 v218, v144, v145, v146
    v_max3_f32 v219, v147, v148, v149
    v_max3_f32 v220, v150, v151, v152
    v_mfma_f32_32x32x16_bf16 v[128:143], a[60:63], a[28:31], v[128:143]
    ds_read_b64_tr_b16 a[92:93], v46 offset:28672
    ds_read_b64_tr_b16 a[94:95], v47 offset:30720
    v_max3_f32 v221, v153, v154, v155
    v_max3_f32 v218, v218, v156, v157
    v_max3_f32 v219, v219, v158, v159
    v_max3_f32 v218, v218, v219, v220
    v_max_f32 v218, v218, v221
    v_mov_b32 v219, v218
    s_nop 1
    v_permlane32_swap_b32 v218, v219
    v_max3_f32 v218, v218, v219, v216
    v_sub_f32 v220, v216, v218
    v_mov_b32 v216, v218
    v_exp_f32 v220, v220
    v_sub_f32 v192, v144, v218
    v_sub_f32 v193, v145, v218
    buffer_load_dwordx4 a[188:191], v23, s[32:35], s58 offen nt
    s_add_u32 s58, s58, 16384
    v_sub_f32 v194, v146, v218
    v_sub_f32 v195, v147, v218
    v_sub_f32 v196, v148, v218
    v_sub_f32 v197, v149, v218
    v_sub_f32 v198, v150, v218
    v_sub_f32 v199, v151, v218
    v_sub_f32 v200, v152, v218
    v_sub_f32 v201, v153, v218
    v_sub_f32 v202, v154, v218
    v_sub_f32 v203, v155, v218
    v_sub_f32 v204, v156, v218
    v_sub_f32 v205, v157, v218
    v_sub_f32 v206, v158, v218
    v_sub_f32 v207, v159, v218
    ds_write_b128 v28, v[128:131] offset:0
    v_exp_f32 v192, v192
    v_exp_f32 v193, v193
    v_exp_f32 v194, v194
    v_exp_f32 v195, v195
    ds_write_b128 v28, v[132:135] offset:1024
    v_exp_f32 v196, v196
    v_exp_f32 v197, v197
    v_exp_f32 v198, v198
    v_exp_f32 v199, v199
    ds_write_b128 v28, v[136:139] offset:2048
    v_exp_f32 v200, v200
    v_exp_f32 v201, v201
    v_exp_f32 v202, v202
    v_exp_f32 v203, v203
    ds_write_b128 v28, v[140:143] offset:3072
    v_exp_f32 v204, v204
    v_exp_f32 v205, v205
    v_exp_f32 v206, v206
    v_exp_f32 v207, v207
    v_mul_f32 v217, v217, v220
    v_cvt_pk_bf16_f32 v208, v192, v193
    v_cvt_pk_bf16_f32 v209, v194, v195
    v_cvt_pk_bf16_f32 v210, v196, v197
    v_cvt_pk_bf16_f32 v211, v198, v199
    v_cvt_pk_bf16_f32 v212, v200, v201
    v_cvt_pk_bf16_f32 v213, v202, v203
    v_cvt_pk_bf16_f32 v214, v204, v205
    v_cvt_pk_bf16_f32 v215, v206, v207
    v_mul_f32 v64, v64, v220
    v_mul_f32 v65, v65, v220
    v_mul_f32 v66, v66, v220
    v_mul_f32 v67, v67, v220
    v_mul_f32 v68, v68, v220
    v_mul_f32 v69, v69, v220
    v_mul_f32 v70, v70, v220
    v_mul_f32 v71, v71, v220
    v_mul_f32 v72, v72, v220
    v_mul_f32 v73, v73, v220
    v_mul_f32 v74, v74, v220
    v_mul_f32 v75, v75, v220
    v_mul_f32 v76, v76, v220
    v_mul_f32 v77, v77, v220
    v_mul_f32 v78, v78, v220
    v_mul_f32 v79, v79, v220
    s_waitcnt lgkmcnt(0)
    s_barrier
    v_mfma_f32_32x32x16_bf16 v[64:79], a[64:67], v[208:211], v[64:79]
    ds_read_b128 v[144:147], v29 offset:0
    v_mul_f32 v80, v80, v220
    v_mul_f32 v81, v81, v220
    ds_read_b128 v[148:151], v29 offset:1024
    ds_write_b128 v26, a[192:195] offset:24576
    buffer_load_dwordx4 a[192:195], v20, s[32:35], s58 offen nt
    v_mul_f32 v82, v82, v220
    v_mul_f32 v83, v83, v220
    ds_read_b128 v[152:155], v29 offset:2048
    v_mul_f32 v84, v84, v220
    v_mfma_f32_32x32x16_bf16 v[64:79], a[68:71], v[212:215], v[64:79]
    v_mul_f32 v85, v85, v220
    ds_read_b128 v[156:159], v29 offset:3072
    v_mul_f32 v86, v86, v220
    ds_write_b128 v26, a[196:199] offset:25600
    v_mul_f32 v87, v87, v220
    v_mul_f32 v88, v88, v220
    v_mul_f32 v89, v89, v220
    v_mul_f32 v90, v90, v220
    v_mul_f32 v91, v91, v220
    v_mul_f32 v92, v92, v220
    v_mul_f32 v93, v93, v220
    v_mul_f32 v94, v94, v220
    v_mul_f32 v95, v95, v220
    s_nop 1
    v_mfma_f32_32x32x16_bf16 v[80:95], a[72:75], v[208:211], v[80:95]
    ds_read_b128 v[160:163], v30 offset:0
    v_mul_f32 v96, v96, v220
    v_mul_f32 v97, v97, v220
    ds_read_b128 v[164:167], v30 offset:1024
    ds_write_b128 v26, a[200:203] offset:26624
    buffer_load_dwordx4 a[196:199], v21, s[32:35], s58 offen nt
    v_mul_f32 v98, v98, v220
    v_mul_f32 v99, v99, v220
    ds_read_b128 v[168:171], v30 offset:2048
    v_mul_f32 v100, v100, v220
    v_mfma_f32_32x32x16_bf16 v[80:95], a[76:79], v[212:215], v[80:95]
    v_mul_f32 v101, v101, v220
    ds_read_b128 v[172:175], v30 offset:3072
    v_mul_f32 v102, v102, v220
    ds_write_b128 v26, a[204:207] offset:27648
    v_mul_f32 v103, v103, v220
    v_mul_f32 v104, v104, v220
    v_mul_f32 v105, v105, v220
    v_mul_f32 v106, v106, v220
    v_mul_f32 v107, v107, v220
    v_mul_f32 v108, v108, v220
    v_mul_f32 v109, v109, v220
    v_mul_f32 v110, v110, v220
    v_mul_f32 v111, v111, v220
    s_nop 1
    v_mfma_f32_32x32x16_bf16 v[96:111], a[80:83], v[208:211], v[96:111]
    ds_read_b128 v[176:179], v31 offset:0
    v_mul_f32 v112, v112, v220
    v_mul_f32 v113, v113, v220
    ds_read_b128 v[180:183], v31 offset:1024
    ds_write_b128 v26, a[208:211] offset:28672
    buffer_load_dwordx4 a[200:203], v22, s[32:35], s58 offen nt
    v_mul_f32 v114, v114, v220
    v_mul_f32 v115, v115, v220
    ds_read_b128 v[184:187], v31 offset:2048
    v_mul_f32 v116, v116, v220
    v_mfma_f32_32x32x16_bf16 v[96:111], a[84:87], v[212:215], v[96:111]
    v_mul_f32 v117, v117, v220
    ds_read_b128 v[188:191], v31 offset:3072
    v_mul_f32 v118, v118, v220
    ds_write_b128 v26, a[212:215] offset:29696
    v_mul_f32 v119, v119, v220
    v_mul_f32 v120, v120, v220
    v_mul_f32 v121, v121, v220
    v_mul_f32 v122, v122, v220
    v_mul_f32 v123, v123, v220
    v_mul_f32 v124, v124, v220
    v_mul_f32 v125, v125, v220
    v_mul_f32 v126, v126, v220
    v_mul_f32 v127, v127, v220
    s_nop 1
    v_mfma_f32_32x32x16_bf16 v[112:127], a[88:91], v[208:211], v[112:127]
    v_add_f32 v192, v192, v200
    v_add_f32 v193, v193, v201
    v_add_f32 v194, v194, v202
    v_add_f32 v195, v195, v203
    ds_write_b128 v26, a[216:219] offset:30720
    buffer_load_dwordx4 a[204:207], v23, s[32:35], s58 offen nt
    s_add_u32 s58, s58, 16384
    v_add_f32 v196, v196, v204
    v_add_f32 v197, v197, v205
    v_add_f32 v198, v198, v206
    v_add_f32 v199, v199, v207
    v_mfma_f32_32x32x16_bf16 v[112:127], a[92:95], v[212:215], v[112:127]
    v_add_f32 v192, v192, v196
    v_add_f32 v193, v193, v197
    v_add_f32 v194, v194, v198
    ds_write_b128 v26, a[220:223] offset:31744
    v_add_f32 v195, v195, v199
    v_add_f32 v192, v192, v193
    v_add_f32 v194, v194, v195
    v_add_f32 v192, v192, v194
    v_add_f32 v217, v217, v192
    ds_read_b128 a[32:35], v32 offset:8192
    ds_read_b128 a[36:39], v33 offset:8192
    ds_read_b128 a[40:43], v34 offset:8192
    ds_read_b128 a[44:47], v35 offset:8192
    ds_read_b128 a[48:51], v36 offset:8192
    ds_read_b128 a[52:55], v37 offset:8192
    ds_read_b128 a[56:59], v38 offset:8192
    ds_read_b128 a[60:63], v39 offset:8192
    s_waitcnt lgkmcnt(8)
    v_add_f32 v144, v144, v128
    v_add_f32 v145, v145, v129
    v_add_f32 v146, v146, v130
    v_add_f32 v147, v147, v131
    buffer_load_dwordx4 a[208:211], v20, s[32:35], s58 offen nt
    v_add_f32 v148, v148, v132
    v_add_f32 v149, v149, v133
    v_add_f32 v150, v150, v134
    v_add_f32 v151, v151, v135
    v_add_f32 v152, v152, v136
    v_add_f32 v153, v153, v137
    v_add_f32 v154, v154, v138
    v_add_f32 v155, v155, v139
    v_add_f32 v156, v156, v140
    v_add_f32 v157, v157, v141
    v_add_f32 v158, v158, v142
    v_add_f32 v159, v159, v143
    s_waitcnt lgkmcnt(0)
    v_mfma_f32_32x32x16_bf16 v[128:143], a[32:35], a[0:3], 0
    ds_read_b64_tr_b16 a[64:65], v40 offset:0
    ds_read_b64_tr_b16 a[66:67], v41 offset:2048
    v_add_f32 v160, v160, v176
    v_add_f32 v161, v161, v177
    v_add_f32 v162, v162, v178
    v_add_f32 v163, v163, v179
    v_add_f32 v164, v164, v180
    v_mfma_f32_32x32x16_bf16 v[128:143], a[36:39], a[4:7], v[128:143]
    ds_read_b64_tr_b16 a[72:73], v42 offset:0
    ds_read_b64_tr_b16 a[74:75], v43 offset:2048
    v_add_f32 v165, v165, v181
    v_add_f32 v166, v166, v182
    v_add_f32 v167, v167, v183
    v_add_f32 v168, v168, v184
    v_add_f32 v169, v169, v185
    v_mfma_f32_32x32x16_bf16 v[128:143], a[40:43], a[8:11], v[128:143]
    ds_read_b64_tr_b16 a[80:81], v44 offset:0
    ds_read_b64_tr_b16 a[82:83], v45 offset:2048
    v_add_f32 v170, v170, v186
    v_add_f32 v171, v171, v187
    v_add_f32 v172, v172, v188
    v_add_f32 v173, v173, v189
    v_add_f32 v174, v174, v190
    v_mfma_f32_32x32x16_bf16 v[128:143], a[44:47], a[12:15], v[128:143]
    ds_read_b64_tr_b16 a[88:89], v46 offset:0
    ds_read_b64_tr_b16 a[90:91], v47 offset:2048
    v_add_f32 v175, v175, v191
    v_add_f32 v144, v144, v160
    v_add_f32 v145, v145, v161
    v_add_f32 v146, v146, v162
    v_add_f32 v147, v147, v163
    v_mfma_f32_32x32x16_bf16 v[128:143], a[48:51], a[16:19], v[128:143]
    ds_read_b64_tr_b16 a[68:69], v40 offset:4096
    ds_read_b64_tr_b16 a[70:71], v41 offset:6144
    v_add_f32 v148, v148, v164
    v_add_f32 v149, v149, v165
    v_add_f32 v150, v150, v166
    v_add_f32 v151, v151, v167
    v_add_f32 v152, v152, v168
    v_mfma_f32_32x32x16_bf16 v[128:143], a[52:55], a[20:23], v[128:143]
    ds_read_b64_tr_b16 a[76:77], v42 offset:4096
    ds_read_b64_tr_b16 a[78:79], v43 offset:6144
    v_add_f32 v153, v153, v169
    v_add_f32 v154, v154, v170
    v_add_f32 v155, v155, v171
    v_add_f32 v156, v156, v172
    v_add_f32 v157, v157, v173
    v_mfma_f32_32x32x16_bf16 v[128:143], a[56:59], a[24:27], v[128:143]
    ds_read_b64_tr_b16 a[84:85], v44 offset:4096
    ds_read_b64_tr_b16 a[86:87], v45 offset:6144
    v_add_f32 v158, v158, v174
    v_add_f32 v159, v159, v175
    v_max3_f32 v218, v144, v145, v146
    v_max3_f32 v219, v147, v148, v149
    v_max3_f32 v220, v150, v151, v152
    v_mfma_f32_32x32x16_bf16 v[128:143], a[60:63], a[28:31], v[128:143]
    ds_read_b64_tr_b16 a[92:93], v46 offset:4096
    ds_read_b64_tr_b16 a[94:95], v47 offset:6144
    v_max3_f32 v221, v153, v154, v155
    v_max3_f32 v218, v218, v156, v157
    v_max3_f32 v219, v219, v158, v159
    v_max3_f32 v218, v218, v219, v220
    v_max_f32 v218, v218, v221
    v_mov_b32 v219, v218
    s_nop 1
    v_permlane32_swap_b32 v218, v219
    v_max3_f32 v218, v218, v219, v216
    v_sub_f32 v220, v216, v218
    v_mov_b32 v216, v218
    v_exp_f32 v220, v220
    v_sub_f32 v192, v144, v218
    v_sub_f32 v193, v145, v218
    buffer_load_dwordx4 a[212:215], v21, s[32:35], s58 offen nt
    v_sub_f32 v194, v146, v218
    v_sub_f32 v195, v147, v218
    v_sub_f32 v196, v148, v218
    v_sub_f32 v197, v149, v218
    v_sub_f32 v198, v150, v218
    buffer_load_dwordx4 a[216:219], v22, s[32:35], s58 offen nt
    v_sub_f32 v199, v151, v218
    v_sub_f32 v200, v152, v218
    v_sub_f32 v201, v153, v218
    v_sub_f32 v202, v154, v218
    v_sub_f32 v203, v155, v218
    v_sub_f32 v204, v156, v218
    v_sub_f32 v205, v157, v218
    v_sub_f32 v206, v158, v218
    v_sub_f32 v207, v159, v218
    ds_write_b128 v28, v[128:131] offset:16384
    v_exp_f32 v192, v192
    v_exp_f32 v193, v193
    v_exp_f32 v194, v194
    v_exp_f32 v195, v195
    ds_write_b128 v28, v[132:135] offset:17408
    v_exp_f32 v196, v196
    v_exp_f32 v197, v197
    v_exp_f32 v198, v198
    v_exp_f32 v199, v199
    ds_write_b128 v28, v[136:139] offset:18432
    v_exp_f32 v200, v200
    v_exp_f32 v201, v201
    v_exp_f32 v202, v202
    v_exp_f32 v203, v203
    ds_write_b128 v28, v[140:143] offset:19456
    v_exp_f32 v204, v204
    v_exp_f32 v205, v205
    v_exp_f32 v206, v206
    v_exp_f32 v207, v207
    v_mul_f32 v217, v217, v220
    v_cvt_pk_bf16_f32 v208, v192, v193
    v_cvt_pk_bf16_f32 v209, v194, v195
    v_cvt_pk_bf16_f32 v210, v196, v197
    v_cvt_pk_bf16_f32 v211, v198, v199
    v_cvt_pk_bf16_f32 v212, v200, v201
    v_cvt_pk_bf16_f32 v213, v202, v203
    v_cvt_pk_bf16_f32 v214, v204, v205
    v_cvt_pk_bf16_f32 v215, v206, v207
    v_mul_f32 v64, v64, v220
    v_mul_f32 v65, v65, v220
    v_mul_f32 v66, v66, v220
    v_mul_f32 v67, v67, v220
    v_mul_f32 v68, v68, v220
    v_mul_f32 v69, v69, v220
    v_mul_f32 v70, v70, v220
    v_mul_f32 v71, v71, v220
    v_mul_f32 v72, v72, v220
    v_mul_f32 v73, v73, v220
    v_mul_f32 v74, v74, v220
    v_mul_f32 v75, v75, v220
    v_mul_f32 v76, v76, v220
    v_mul_f32 v77, v77, v220
    v_mul_f32 v78, v78, v220
    v_mul_f32 v79, v79, v220
    s_waitcnt lgkmcnt(0)
    s_barrier
    v_mfma_f32_32x32x16_bf16 v[64:79], a[64:67], v[208:211], v[64:79]
    ds_read_b128 v[144:147], v29 offset:16384
    v_mul_f32 v80, v80, v220
    v_mul_f32 v81, v81, v220
    ds_read_b128 v[148:151], v29 offset:17408
    ds_write_b128 v26, a[224:227] offset:0
    buffer_load_dwordx4 a[220:223], v23, s[32:35], s58 offen nt
    s_add_u32 s58, s58, 16384
    v_mul_f32 v82, v82, v220
    v_mul_f32 v83, v83, v220
    ds_read_b128 v[152:155], v29 offset:18432
    v_mul_f32 v84, v84, v220
    v_mfma_f32_32x32x16_bf16 v[64:79], a[68:71], v[212:215], v[64:79]
    v_mul_f32 v85, v85, v220
    ds_read_b128 v[156:159], v29 offset:19456
    v_mul_f32 v86, v86, v220
    ds_write_b128 v26, a[228:231] offset:1024
    v_mul_f32 v87, v87, v220
    v_mul_f32 v88, v88, v220
    v_mul_f32 v89, v89, v220
    v_mul_f32 v90, v90, v220
    v_mul_f32 v91, v91, v220
    v_mul_f32 v92, v92, v220
    v_mul_f32 v93, v93, v220
    v_mul_f32 v94, v94, v220
    v_mul_f32 v95, v95, v220
    s_nop 1
    v_mfma_f32_32x32x16_bf16 v[80:95], a[72:75], v[208:211], v[80:95]
    ds_read_b128 v[160:163], v30 offset:16384
    v_mul_f32 v96, v96, v220
    v_mul_f32 v97, v97, v220
    ds_read_b128 v[164:167], v30 offset:17408
    ds_write_b128 v26, a[232:235] offset:2048
    buffer_load_dwordx4 a[224:227], v20, s[32:35], s58 offen nt
    v_mul_f32 v98, v98, v220
    v_mul_f32 v99, v99, v220
    ds_read_b128 v[168:171], v30 offset:18432
    v_mul_f32 v100, v100, v220
    v_mfma_f32_32x32x16_bf16 v[80:95], a[76:79], v[212:215], v[80:95]
    v_mul_f32 v101, v101, v220
    ds_read_b128 v[172:175], v30 offset:19456
    v_mul_f32 v102, v102, v220
    ds_write_b128 v26, a[236:239] offset:3072
    v_mul_f32 v103, v103, v220
    v_mul_f32 v104, v104, v220
    v_mul_f32 v105, v105, v220
    v_mul_f32 v106, v106, v220
    v_mul_f32 v107, v107, v220
    v_mul_f32 v108, v108, v220
    v_mul_f32 v109, v109, v220
    v_mul_f32 v110, v110, v220
    v_mul_f32 v111, v111, v220
    s_nop 1
    v_mfma_f32_32x32x16_bf16 v[96:111], a[80:83], v[208:211], v[96:111]
    ds_read_b128 v[176:179], v31 offset:16384
    v_mul_f32 v112, v112, v220
    v_mul_f32 v113, v113, v220
    ds_read_b128 v[180:183], v31 offset:17408
    ds_write_b128 v26, a[240:243] offset:4096
    v_mul_f32 v114, v114, v220
    v_mul_f32 v115, v115, v220
    ds_read_b128 v[184:187], v31 offset:18432
    v_mul_f32 v116, v116, v220
    v_mfma_f32_32x32x16_bf16 v[96:111], a[84:87], v[212:215], v[96:111]
    v_mul_f32 v117, v117, v220
    ds_read_b128 v[188:191], v31 offset:19456
    v_mul_f32 v118, v118, v220
    ds_write_b128 v26, a[244:247] offset:5120
    buffer_load_dwordx4 a[228:231], v21, s[32:35], s58 offen nt
    v_mul_f32 v119, v119, v220
    v_mul_f32 v120, v120, v220
    v_mul_f32 v121, v121, v220
    v_mul_f32 v122, v122, v220
    v_mul_f32 v123, v123, v220
    v_mul_f32 v124, v124, v220
    v_mul_f32 v125, v125, v220
    v_mul_f32 v126, v126, v220
    v_mul_f32 v127, v127, v220
    s_nop 1
    v_mfma_f32_32x32x16_bf16 v[112:127], a[88:91], v[208:211], v[112:127]
    v_add_f32 v192, v192, v200
    v_add_f32 v193, v193, v201
    v_add_f32 v194, v194, v202
    v_add_f32 v195, v195, v203
    ds_write_b128 v26, a[248:251] offset:6144
    v_add_f32 v196, v196, v204
    v_add_f32 v197, v197, v205
    v_add_f32 v198, v198, v206
    v_add_f32 v199, v199, v207
    v_mfma_f32_32x32x16_bf16 v[112:127], a[92:95], v[212:215], v[112:127]
    v_add_f32 v192, v192, v196
    v_add_f32 v193, v193, v197
    v_add_f32 v194, v194, v198
    ds_write_b128 v26, a[252:255] offset:7168
    v_add_f32 v195, v195, v199
    v_add_f32 v192, v192, v193
    v_add_f32 v194, v194, v195
    v_add_f32 v192, v192, v194
    v_add_f32 v217, v217, v192
    ds_read_b128 a[32:35], v32 offset:16384
    ds_read_b128 a[36:39], v33 offset:16384
    ds_read_b128 a[40:43], v34 offset:16384
    ds_read_b128 a[44:47], v35 offset:16384
    ds_read_b128 a[48:51], v36 offset:16384
    ds_read_b128 a[52:55], v37 offset:16384
    ds_read_b128 a[56:59], v38 offset:16384
    ds_read_b128 a[60:63], v39 offset:16384
    s_waitcnt lgkmcnt(8)
    v_add_f32 v144, v144, v128
    v_add_f32 v145, v145, v129
    v_add_f32 v146, v146, v130
    v_add_f32 v147, v147, v131
    buffer_load_dwordx4 a[232:235], v22, s[32:35], s58 offen nt
    v_add_f32 v148, v148, v132
    v_add_f32 v149, v149, v133
    v_add_f32 v150, v150, v134
    v_add_f32 v151, v151, v135
    v_add_f32 v152, v152, v136
    v_add_f32 v153, v153, v137
    v_add_f32 v154, v154, v138
    v_add_f32 v155, v155, v139
    v_add_f32 v156, v156, v140
    v_add_f32 v157, v157, v141
    v_add_f32 v158, v158, v142
    v_add_f32 v159, v159, v143
    s_waitcnt lgkmcnt(0)
    v_mfma_f32_32x32x16_bf16 v[128:143], a[32:35], a[0:3], 0
    ds_read_b64_tr_b16 a[64:65], v40 offset:8192
    ds_read_b64_tr_b16 a[66:67], v41 offset:10240
    v_add_f32 v160, v160, v176
    v_add_f32 v161, v161, v177
    v_add_f32 v162, v162, v178
    v_add_f32 v163, v163, v179
    v_add_f32 v164, v164, v180
    v_mfma_f32_32x32x16_bf16 v[128:143], a[36:39], a[4:7], v[128:143]
    ds_read_b64_tr_b16 a[72:73], v42 offset:8192
    ds_read_b64_tr_b16 a[74:75], v43 offset:10240
    v_add_f32 v165, v165, v181
    v_add_f32 v166, v166, v182
    v_add_f32 v167, v167, v183
    v_add_f32 v168, v168, v184
    v_add_f32 v169, v169, v185
    v_mfma_f32_32x32x16_bf16 v[128:143], a[40:43], a[8:11], v[128:143]
    ds_read_b64_tr_b16 a[80:81], v44 offset:8192
    ds_read_b64_tr_b16 a[82:83], v45 offset:10240
    v_add_f32 v170, v170, v186
    v_add_f32 v171, v171, v187
    v_add_f32 v172, v172, v188
    v_add_f32 v173, v173, v189
    v_add_f32 v174, v174, v190
    v_mfma_f32_32x32x16_bf16 v[128:143], a[44:47], a[12:15], v[128:143]
    ds_read_b64_tr_b16 a[88:89], v46 offset:8192
    ds_read_b64_tr_b16 a[90:91], v47 offset:10240
    v_add_f32 v175, v175, v191
    v_add_f32 v144, v144, v160
    v_add_f32 v145, v145, v161
    v_add_f32 v146, v146, v162
    v_add_f32 v147, v147, v163
    v_mfma_f32_32x32x16_bf16 v[128:143], a[48:51], a[16:19], v[128:143]
    ds_read_b64_tr_b16 a[68:69], v40 offset:12288
    ds_read_b64_tr_b16 a[70:71], v41 offset:14336
    v_add_f32 v148, v148, v164
    v_add_f32 v149, v149, v165
    v_add_f32 v150, v150, v166
    v_add_f32 v151, v151, v167
    v_add_f32 v152, v152, v168
    v_mfma_f32_32x32x16_bf16 v[128:143], a[52:55], a[20:23], v[128:143]
    ds_read_b64_tr_b16 a[76:77], v42 offset:12288
    ds_read_b64_tr_b16 a[78:79], v43 offset:14336
    v_add_f32 v153, v153, v169
    v_add_f32 v154, v154, v170
    v_add_f32 v155, v155, v171
    v_add_f32 v156, v156, v172
    v_add_f32 v157, v157, v173
    v_mfma_f32_32x32x16_bf16 v[128:143], a[56:59], a[24:27], v[128:143]
    ds_read_b64_tr_b16 a[84:85], v44 offset:12288
    ds_read_b64_tr_b16 a[86:87], v45 offset:14336
    v_add_f32 v158, v158, v174
    v_add_f32 v159, v159, v175
    v_max3_f32 v218, v144, v145, v146
    v_max3_f32 v219, v147, v148, v149
    v_max3_f32 v220, v150, v151, v152
    v_mfma_f32_32x32x16_bf16 v[128:143], a[60:63], a[28:31], v[128:143]
    ds_read_b64_tr_b16 a[92:93], v46 offset:12288
    ds_read_b64_tr_b16 a[94:95], v47 offset:14336
    v_max3_f32 v221, v153, v154, v155
    v_max3_f32 v218, v218, v156, v157
    v_max3_f32 v219, v219, v158, v159
    v_max3_f32 v218, v218, v219, v220
    v_max_f32 v218, v218, v221
    v_mov_b32 v219, v218
    s_nop 1
    v_permlane32_swap_b32 v218, v219
    v_max3_f32 v218, v218, v219, v216
    v_sub_f32 v220, v216, v218
    v_mov_b32 v216, v218
    v_exp_f32 v220, v220
    v_sub_f32 v192, v144, v218
    v_sub_f32 v193, v145, v218
    buffer_load_dwordx4 a[236:239], v23, s[32:35], s58 offen nt
    s_add_u32 s58, s58, 16384
    v_sub_f32 v194, v146, v218
    v_sub_f32 v195, v147, v218
    v_sub_f32 v196, v148, v218
    v_sub_f32 v197, v149, v218
    v_sub_f32 v198, v150, v218
    buffer_load_dwordx4 a[240:243], v20, s[32:35], s58 offen nt
    v_sub_f32 v199, v151, v218
    v_sub_f32 v200, v152, v218
    v_sub_f32 v201, v153, v218
    v_sub_f32 v202, v154, v218
    v_sub_f32 v203, v155, v218
    v_sub_f32 v204, v156, v218
    v_sub_f32 v205, v157, v218
    v_sub_f32 v206, v158, v218
    v_sub_f32 v207, v159, v218
    ds_write_b128 v28, v[128:131] offset:0
    v_exp_f32 v192, v192
    v_exp_f32 v193, v193
    v_exp_f32 v194, v194
    v_exp_f32 v195, v195
    ds_write_b128 v28, v[132:135] offset:1024
    v_exp_f32 v196, v196
    v_exp_f32 v197, v197
    v_exp_f32 v198, v198
    v_exp_f32 v199, v199
    ds_write_b128 v28, v[136:139] offset:2048
    v_exp_f32 v200, v200
    v_exp_f32 v201, v201
    v_exp_f32 v202, v202
    v_exp_f32 v203, v203
    ds_write_b128 v28, v[140:143] offset:3072
    v_exp_f32 v204, v204
    v_exp_f32 v205, v205
    v_exp_f32 v206, v206
    v_exp_f32 v207, v207
    v_mul_f32 v217, v217, v220
    v_cvt_pk_bf16_f32 v208, v192, v193
    v_cvt_pk_bf16_f32 v209, v194, v195
    v_cvt_pk_bf16_f32 v210, v196, v197
    v_cvt_pk_bf16_f32 v211, v198, v199
    v_cvt_pk_bf16_f32 v212, v200, v201
    v_cvt_pk_bf16_f32 v213, v202, v203
    v_cvt_pk_bf16_f32 v214, v204, v205
    v_cvt_pk_bf16_f32 v215, v206, v207
    v_mul_f32 v64, v64, v220
    v_mul_f32 v65, v65, v220
    v_mul_f32 v66, v66, v220
    v_mul_f32 v67, v67, v220
    v_mul_f32 v68, v68, v220
    v_mul_f32 v69, v69, v220
    v_mul_f32 v70, v70, v220
    v_mul_f32 v71, v71, v220
    v_mul_f32 v72, v72, v220
    v_mul_f32 v73, v73, v220
    v_mul_f32 v74, v74, v220
    v_mul_f32 v75, v75, v220
    v_mul_f32 v76, v76, v220
    v_mul_f32 v77, v77, v220
    v_mul_f32 v78, v78, v220
    v_mul_f32 v79, v79, v220
    s_waitcnt lgkmcnt(0)
    s_barrier
    v_mfma_f32_32x32x16_bf16 v[64:79], a[64:67], v[208:211], v[64:79]
    ds_read_b128 v[144:147], v29 offset:0
    v_mul_f32 v80, v80, v220
    v_mul_f32 v81, v81, v220
    ds_read_b128 v[148:151], v29 offset:1024
    ds_write_b128 v26, v[224:227] offset:8192
    buffer_load_dwordx4 a[244:247], v21, s[32:35], s58 offen nt
    v_mul_f32 v82, v82, v220
    v_mul_f32 v83, v83, v220
    ds_read_b128 v[152:155], v29 offset:2048
    v_mul_f32 v84, v84, v220
    v_mfma_f32_32x32x16_bf16 v[64:79], a[68:71], v[212:215], v[64:79]
    v_mul_f32 v85, v85, v220
    ds_read_b128 v[156:159], v29 offset:3072
    v_mul_f32 v86, v86, v220
    ds_write_b128 v26, v[228:231] offset:9216
    v_mul_f32 v87, v87, v220
    v_mul_f32 v88, v88, v220
    v_mul_f32 v89, v89, v220
    v_mul_f32 v90, v90, v220
    v_mul_f32 v91, v91, v220
    v_mul_f32 v92, v92, v220
    v_mul_f32 v93, v93, v220
    v_mul_f32 v94, v94, v220
    v_mul_f32 v95, v95, v220
    s_nop 1
    v_mfma_f32_32x32x16_bf16 v[80:95], a[72:75], v[208:211], v[80:95]
    ds_read_b128 v[160:163], v30 offset:0
    v_mul_f32 v96, v96, v220
    v_mul_f32 v97, v97, v220
    ds_read_b128 v[164:167], v30 offset:1024
    ds_write_b128 v26, v[232:235] offset:10240
    buffer_load_dwordx4 a[248:251], v22, s[32:35], s58 offen nt
    v_mul_f32 v98, v98, v220
    v_mul_f32 v99, v99, v220
    ds_read_b128 v[168:171], v30 offset:2048
    v_mul_f32 v100, v100, v220
    v_mfma_f32_32x32x16_bf16 v[80:95], a[76:79], v[212:215], v[80:95]
    v_mul_f32 v101, v101, v220
    ds_read_b128 v[172:175], v30 offset:3072
    v_mul_f32 v102, v102, v220
    ds_write_b128 v26, v[236:239] offset:11264
    v_mul_f32 v103, v103, v220
    v_mul_f32 v104, v104, v220
    v_mul_f32 v105, v105, v220
    v_mul_f32 v106, v106, v220
    v_mul_f32 v107, v107, v220
    v_mul_f32 v108, v108, v220
    v_mul_f32 v109, v109, v220
    v_mul_f32 v110, v110, v220
    v_mul_f32 v111, v111, v220
    s_nop 1
    v_mfma_f32_32x32x16_bf16 v[96:111], a[80:83], v[208:211], v[96:111]
    ds_read_b128 v[176:179], v31 offset:0
    v_mul_f32 v112, v112, v220
    v_mul_f32 v113, v113, v220
    ds_read_b128 v[180:183], v31 offset:1024
    ds_write_b128 v26, v[240:243] offset:12288
    v_mul_f32 v114, v114, v220
    v_mul_f32 v115, v115, v220
    ds_read_b128 v[184:187], v31 offset:2048
    v_mul_f32 v116, v116, v220
    v_mfma_f32_32x32x16_bf16 v[96:111], a[84:87], v[212:215], v[96:111]
    v_mul_f32 v117, v117, v220
    ds_read_b128 v[188:191], v31 offset:3072
    v_mul_f32 v118, v118, v220
    ds_write_b128 v26, v[244:247] offset:13312
    buffer_load_dwordx4 a[252:255], v23, s[32:35], s58 offen nt
    s_add_u32 s58, s58, 16384
    v_mul_f32 v119, v119, v220
    v_mul_f32 v120, v120, v220
    v_mul_f32 v121, v121, v220
    v_mul_f32 v122, v122, v220
    v_mul_f32 v123, v123, v220
    v_mul_f32 v124, v124, v220
    v_mul_f32 v125, v125, v220
    v_mul_f32 v126, v126, v220
    v_mul_f32 v127, v127, v220
    s_nop 1
    v_mfma_f32_32x32x16_bf16 v[112:127], a[88:91], v[208:211], v[112:127]
    v_add_f32 v192, v192, v200
    v_add_f32 v193, v193, v201
    v_add_f32 v194, v194, v202
    v_add_f32 v195, v195, v203
    ds_write_b128 v26, v[248:251] offset:14336
    v_add_f32 v196, v196, v204
    v_add_f32 v197, v197, v205
    v_add_f32 v198, v198, v206
    v_add_f32 v199, v199, v207
    v_mfma_f32_32x32x16_bf16 v[112:127], a[92:95], v[212:215], v[112:127]
    v_add_f32 v192, v192, v196
    v_add_f32 v193, v193, v197
    v_add_f32 v194, v194, v198
    ds_write_b128 v26, v[252:255] offset:15360
    v_add_f32 v195, v195, v199
    v_add_f32 v192, v192, v193
    v_add_f32 v194, v194, v195
    v_add_f32 v192, v192, v194
    v_add_f32 v217, v217, v192
    ds_read_b128 a[32:35], v32 offset:24576
    ds_read_b128 a[36:39], v33 offset:24576
    ds_read_b128 a[40:43], v34 offset:24576
    ds_read_b128 a[44:47], v35 offset:24576
    ds_read_b128 a[48:51], v36 offset:24576
    ds_read_b128 a[52:55], v37 offset:24576
    ds_read_b128 a[56:59], v38 offset:24576
    ds_read_b128 a[60:63], v39 offset:24576
    s_waitcnt lgkmcnt(8)
    v_add_f32 v144, v144, v128
    v_add_f32 v145, v145, v129
    v_add_f32 v146, v146, v130
    v_add_f32 v147, v147, v131
    buffer_load_dwordx4 v[224:227], v20, s[32:35], s58 offen nt
    v_add_f32 v148, v148, v132
    v_add_f32 v149, v149, v133
    v_add_f32 v150, v150, v134
    v_add_f32 v151, v151, v135
    v_add_f32 v152, v152, v136
    v_add_f32 v153, v153, v137
    v_add_f32 v154, v154, v138
    v_add_f32 v155, v155, v139
    v_add_f32 v156, v156, v140
    v_add_f32 v157, v157, v141
    v_add_f32 v158, v158, v142
    v_add_f32 v159, v159, v143
    s_waitcnt lgkmcnt(0)
    v_mfma_f32_32x32x16_bf16 v[128:143], a[32:35], a[0:3], 0
    ds_read_b64_tr_b16 a[64:65], v40 offset:16384
    ds_read_b64_tr_b16 a[66:67], v41 offset:18432
    v_add_f32 v160, v160, v176
    v_add_f32 v161, v161, v177
    v_add_f32 v162, v162, v178
    v_add_f32 v163, v163, v179
    v_add_f32 v164, v164, v180
    v_mfma_f32_32x32x16_bf16 v[128:143], a[36:39], a[4:7], v[128:143]
    ds_read_b64_tr_b16 a[72:73], v42 offset:16384
    ds_read_b64_tr_b16 a[74:75], v43 offset:18432
    v_add_f32 v165, v165, v181
    v_add_f32 v166, v166, v182
    v_add_f32 v167, v167, v183
    v_add_f32 v168, v168, v184
    v_add_f32 v169, v169, v185
    v_mfma_f32_32x32x16_bf16 v[128:143], a[40:43], a[8:11], v[128:143]
    ds_read_b64_tr_b16 a[80:81], v44 offset:16384
    ds_read_b64_tr_b16 a[82:83], v45 offset:18432
    v_add_f32 v170, v170, v186
    v_add_f32 v171, v171, v187
    v_add_f32 v172, v172, v188
    v_add_f32 v173, v173, v189
    v_add_f32 v174, v174, v190
    v_mfma_f32_32x32x16_bf16 v[128:143], a[44:47], a[12:15], v[128:143]
    ds_read_b64_tr_b16 a[88:89], v46 offset:16384
    ds_read_b64_tr_b16 a[90:91], v47 offset:18432
    v_add_f32 v175, v175, v191
    v_add_f32 v144, v144, v160
    v_add_f32 v145, v145, v161
    v_add_f32 v146, v146, v162
    v_add_f32 v147, v147, v163
    v_mfma_f32_32x32x16_bf16 v[128:143], a[48:51], a[16:19], v[128:143]
    ds_read_b64_tr_b16 a[68:69], v40 offset:20480
    ds_read_b64_tr_b16 a[70:71], v41 offset:22528
    v_add_f32 v148, v148, v164
    v_add_f32 v149, v149, v165
    v_add_f32 v150, v150, v166
    v_add_f32 v151, v151, v167
    v_add_f32 v152, v152, v168
    v_mfma_f32_32x32x16_bf16 v[128:143], a[52:55], a[20:23], v[128:143]
    ds_read_b64_tr_b16 a[76:77], v42 offset:20480
    ds_read_b64_tr_b16 a[78:79], v43 offset:22528
    v_add_f32 v153, v153, v169
    v_add_f32 v154, v154, v170
    v_add_f32 v155, v155, v171
    v_add_f32 v156, v156, v172
    v_add_f32 v157, v157, v173
    v_mfma_f32_32x32x16_bf16 v[128:143], a[56:59], a[24:27], v[128:143]
    ds_read_b64_tr_b16 a[84:85], v44 offset:20480
    ds_read_b64_tr_b16 a[86:87], v45 offset:22528
    v_add_f32 v158, v158, v174
    v_add_f32 v159, v159, v175
    v_max3_f32 v218, v144, v145, v146
    v_max3_f32 v219, v147, v148, v149
    v_max3_f32 v220, v150, v151, v152
    v_mfma_f32_32x32x16_bf16 v[128:143], a[60:63], a[28:31], v[128:143]
    ds_read_b64_tr_b16 a[92:93], v46 offset:20480
    ds_read_b64_tr_b16 a[94:95], v47 offset:22528
    v_max3_f32 v221, v153, v154, v155
    v_max3_f32 v218, v218, v156, v157
    v_max3_f32 v219, v219, v158, v159
    v_max3_f32 v218, v218, v219, v220
    v_max_f32 v218, v218, v221
    v_mov_b32 v219, v218
    s_nop 1
    v_permlane32_swap_b32 v218, v219
    v_max3_f32 v218, v218, v219, v216
    v_sub_f32 v220, v216, v218
    v_mov_b32 v216, v218
    v_exp_f32 v220, v220
    v_sub_f32 v192, v144, v218
    v_sub_f32 v193, v145, v218
    buffer_load_dwordx4 v[228:231], v21, s[32:35], s58 offen nt
    v_sub_f32 v194, v146, v218
    v_sub_f32 v195, v147, v218
    v_sub_f32 v196, v148, v218
    v_sub_f32 v197, v149, v218
    v_sub_f32 v198, v150, v218
    buffer_load_dwordx4 v[232:235], v22, s[32:35], s58 offen nt
    v_sub_f32 v199, v151, v218
    v_sub_f32 v200, v152, v218
    v_sub_f32 v201, v153, v218
    v_sub_f32 v202, v154, v218
    v_sub_f32 v203, v155, v218
    v_sub_f32 v204, v156, v218
    v_sub_f32 v205, v157, v218
    v_sub_f32 v206, v158, v218
    v_sub_f32 v207, v159, v218
    ds_write_b128 v28, v[128:131] offset:16384
    v_exp_f32 v192, v192
    v_exp_f32 v193, v193
    v_exp_f32 v194, v194
    v_exp_f32 v195, v195
    ds_write_b128 v28, v[132:135] offset:17408
    v_exp_f32 v196, v196
    v_exp_f32 v197, v197
    v_exp_f32 v198, v198
    v_exp_f32 v199, v199
    ds_write_b128 v28, v[136:139] offset:18432
    v_exp_f32 v200, v200
    v_exp_f32 v201, v201
    v_exp_f32 v202, v202
    v_exp_f32 v203, v203
    ds_write_b128 v28, v[140:143] offset:19456
    v_exp_f32 v204, v204
    v_exp_f32 v205, v205
    v_exp_f32 v206, v206
    v_exp_f32 v207, v207
    v_mul_f32 v217, v217, v220
    v_cvt_pk_bf16_f32 v208, v192, v193
    v_cvt_pk_bf16_f32 v209, v194, v195
    v_cvt_pk_bf16_f32 v210, v196, v197
    v_cvt_pk_bf16_f32 v211, v198, v199
    v_cvt_pk_bf16_f32 v212, v200, v201
    v_cvt_pk_bf16_f32 v213, v202, v203
    v_cvt_pk_bf16_f32 v214, v204, v205
    v_cvt_pk_bf16_f32 v215, v206, v207
    v_mul_f32 v64, v64, v220
    v_mul_f32 v65, v65, v220
    v_mul_f32 v66, v66, v220
    v_mul_f32 v67, v67, v220
    v_mul_f32 v68, v68, v220
    v_mul_f32 v69, v69, v220
    v_mul_f32 v70, v70, v220
    v_mul_f32 v71, v71, v220
    v_mul_f32 v72, v72, v220
    v_mul_f32 v73, v73, v220
    v_mul_f32 v74, v74, v220
    v_mul_f32 v75, v75, v220
    v_mul_f32 v76, v76, v220
    v_mul_f32 v77, v77, v220
    v_mul_f32 v78, v78, v220
    v_mul_f32 v79, v79, v220
    s_waitcnt lgkmcnt(0)
    s_barrier
    v_mfma_f32_32x32x16_bf16 v[64:79], a[64:67], v[208:211], v[64:79]
    ds_read_b128 v[144:147], v29 offset:16384
    v_mul_f32 v80, v80, v220
    v_mul_f32 v81, v81, v220
    ds_read_b128 v[148:151], v29 offset:17408
    buffer_load_dwordx4 v[236:239], v23, s[32:35], s58 offen nt
    s_add_u32 s58, s58, 16384
    v_mul_f32 v82, v82, v220
    v_mul_f32 v83, v83, v220
    ds_read_b128 v[152:155], v29 offset:18432
    v_mul_f32 v84, v84, v220
    v_mfma_f32_32x32x16_bf16 v[64:79], a[68:71], v[212:215], v[64:79]
    v_mul_f32 v85, v85, v220
    ds_read_b128 v[156:159], v29 offset:19456
    v_mul_f32 v86, v86, v220
    v_mul_f32 v87, v87, v220
    v_mul_f32 v88, v88, v220
    v_mul_f32 v89, v89, v220
    v_mul_f32 v90, v90, v220
    v_mul_f32 v91, v91, v220
    v_mul_f32 v92, v92, v220
    v_mul_f32 v93, v93, v220
    v_mul_f32 v94, v94, v220
    v_mul_f32 v95, v95, v220
    s_nop 1
    v_mfma_f32_32x32x16_bf16 v[80:95], a[72:75], v[208:211], v[80:95]
    ds_read_b128 v[160:163], v30 offset:16384
    v_mul_f32 v96, v96, v220
    v_mul_f32 v97, v97, v220
    ds_read_b128 v[164:167], v30 offset:17408
    buffer_load_dwordx4 v[240:243], v20, s[32:35], s58 offen nt
    v_mul_f32 v98, v98, v220
    v_mul_f32 v99, v99, v220
    ds_read_b128 v[168:171], v30 offset:18432
    v_mul_f32 v100, v100, v220
    v_mfma_f32_32x32x16_bf16 v[80:95], a[76:79], v[212:215], v[80:95]
    v_mul_f32 v101, v101, v220
    ds_read_b128 v[172:175], v30 offset:19456
    v_mul_f32 v102, v102, v220
    v_mul_f32 v103, v103, v220
    v_mul_f32 v104, v104, v220
    v_mul_f32 v105, v105, v220
    v_mul_f32 v106, v106, v220
    v_mul_f32 v107, v107, v220
    v_mul_f32 v108, v108, v220
    v_mul_f32 v109, v109, v220
    v_mul_f32 v110, v110, v220
    v_mul_f32 v111, v111, v220
    s_nop 1
    v_mfma_f32_32x32x16_bf16 v[96:111], a[80:83], v[208:211], v[96:111]
    ds_read_b128 v[176:179], v31 offset:16384
    v_mul_f32 v112, v112, v220
    v_mul_f32 v113, v113, v220
    ds_read_b128 v[180:183], v31 offset:17408
    v_mul_f32 v114, v114, v220
    v_mul_f32 v115, v115, v220
    ds_read_b128 v[184:187], v31 offset:18432
    v_mul_f32 v116, v116, v220
    v_mfma_f32_32x32x16_bf16 v[96:111], a[84:87], v[212:215], v[96:111]
    v_mul_f32 v117, v117, v220
    ds_read_b128 v[188:191], v31 offset:19456
    v_mul_f32 v118, v118, v220
    buffer_load_dwordx4 v[244:247], v21, s[32:35], s58 offen nt
    v_mul_f32 v119, v119, v220
    v_mul_f32 v120, v120, v220
    v_mul_f32 v121, v121, v220
    v_mul_f32 v122, v122, v220
    v_mul_f32 v123, v123, v220
    v_mul_f32 v124, v124, v220
    v_mul_f32 v125, v125, v220
    v_mul_f32 v126, v126, v220
    v_mul_f32 v127, v127, v220
    s_nop 1
    v_mfma_f32_32x32x16_bf16 v[112:127], a[88:91], v[208:211], v[112:127]
    v_add_f32 v192, v192, v200
    v_add_f32 v193, v193, v201
    v_add_f32 v194, v194, v202
    v_add_f32 v195, v195, v203
    v_add_f32 v196, v196, v204
    v_add_f32 v197, v197, v205
    v_add_f32 v198, v198, v206
    v_add_f32 v199, v199, v207
    v_mfma_f32_32x32x16_bf16 v[112:127], a[92:95], v[212:215], v[112:127]
    v_add_f32 v192, v192, v196
    v_add_f32 v193, v193, v197
    v_add_f32 v194, v194, v198
    v_add_f32 v195, v195, v199
    v_add_f32 v192, v192, v193
    v_add_f32 v194, v194, v195
    v_add_f32 v192, v192, v194
    v_add_f32 v217, v217, v192
    ds_read_b128 a[32:35], v32 offset:0
    ds_read_b128 a[36:39], v33 offset:0
    ds_read_b128 a[40:43], v34 offset:0
    ds_read_b128 a[44:47], v35 offset:0
    ds_read_b128 a[48:51], v36 offset:0
    ds_read_b128 a[52:55], v37 offset:0
    ds_read_b128 a[56:59], v38 offset:0
    ds_read_b128 a[60:63], v39 offset:0
    s_waitcnt lgkmcnt(8)
    v_add_f32 v144, v144, v128
    v_add_f32 v145, v145, v129
    v_add_f32 v146, v146, v130
    v_add_f32 v147, v147, v131
    buffer_load_dwordx4 v[248:251], v22, s[32:35], s58 offen nt
    v_add_f32 v148, v148, v132
    v_add_f32 v149, v149, v133
    v_add_f32 v150, v150, v134
    v_add_f32 v151, v151, v135
    v_add_f32 v152, v152, v136
    v_add_f32 v153, v153, v137
    v_add_f32 v154, v154, v138
    v_add_f32 v155, v155, v139
    v_add_f32 v156, v156, v140
    v_add_f32 v157, v157, v141
    v_add_f32 v158, v158, v142
    v_add_f32 v159, v159, v143
    s_waitcnt lgkmcnt(0)
    v_mfma_f32_32x32x16_bf16 v[128:143], a[32:35], a[0:3], 0
    ds_read_b64_tr_b16 a[64:65], v40 offset:24576
    ds_read_b64_tr_b16 a[66:67], v41 offset:26624
    v_add_f32 v160, v160, v176
    v_add_f32 v161, v161, v177
    v_add_f32 v162, v162, v178
    v_add_f32 v163, v163, v179
    v_add_f32 v164, v164, v180
    v_mfma_f32_32x32x16_bf16 v[128:143], a[36:39], a[4:7], v[128:143]
    ds_read_b64_tr_b16 a[72:73], v42 offset:24576
    ds_read_b64_tr_b16 a[74:75], v43 offset:26624
    v_add_f32 v165, v165, v181
    v_add_f32 v166, v166, v182
    v_add_f32 v167, v167, v183
    v_add_f32 v168, v168, v184
    v_add_f32 v169, v169, v185
    v_mfma_f32_32x32x16_bf16 v[128:143], a[40:43], a[8:11], v[128:143]
    ds_read_b64_tr_b16 a[80:81], v44 offset:24576
    ds_read_b64_tr_b16 a[82:83], v45 offset:26624
    v_add_f32 v170, v170, v186
    v_add_f32 v171, v171, v187
    v_add_f32 v172, v172, v188
    v_add_f32 v173, v173, v189
    v_add_f32 v174, v174, v190
    v_mfma_f32_32x32x16_bf16 v[128:143], a[44:47], a[12:15], v[128:143]
    ds_read_b64_tr_b16 a[88:89], v46 offset:24576
    ds_read_b64_tr_b16 a[90:91], v47 offset:26624
    v_add_f32 v175, v175, v191
    v_add_f32 v144, v144, v160
    v_add_f32 v145, v145, v161
    v_add_f32 v146, v146, v162
    v_add_f32 v147, v147, v163
    v_mfma_f32_32x32x16_bf16 v[128:143], a[48:51], a[16:19], v[128:143]
    ds_read_b64_tr_b16 a[68:69], v40 offset:28672
    ds_read_b64_tr_b16 a[70:71], v41 offset:30720
    v_add_f32 v148, v148, v164
    v_add_f32 v149, v149, v165
    v_add_f32 v150, v150, v166
    v_add_f32 v151, v151, v167
    v_add_f32 v152, v152, v168
    v_mfma_f32_32x32x16_bf16 v[128:143], a[52:55], a[20:23], v[128:143]
    ds_read_b64_tr_b16 a[76:77], v42 offset:28672
    ds_read_b64_tr_b16 a[78:79], v43 offset:30720
    v_add_f32 v153, v153, v169
    v_add_f32 v154, v154, v170
    v_add_f32 v155, v155, v171
    v_add_f32 v156, v156, v172
    v_add_f32 v157, v157, v173
    v_mfma_f32_32x32x16_bf16 v[128:143], a[56:59], a[24:27], v[128:143]
    ds_read_b64_tr_b16 a[84:85], v44 offset:28672
    ds_read_b64_tr_b16 a[86:87], v45 offset:30720
    v_add_f32 v158, v158, v174
    v_add_f32 v159, v159, v175
    v_max3_f32 v218, v144, v145, v146
    v_max3_f32 v219, v147, v148, v149
    v_max3_f32 v220, v150, v151, v152
    v_mfma_f32_32x32x16_bf16 v[128:143], a[60:63], a[28:31], v[128:143]
    ds_read_b64_tr_b16 a[92:93], v46 offset:28672
    ds_read_b64_tr_b16 a[94:95], v47 offset:30720
    v_max3_f32 v221, v153, v154, v155
    v_max3_f32 v218, v218, v156, v157
    v_max3_f32 v219, v219, v158, v159
    v_max3_f32 v218, v218, v219, v220
    v_max_f32 v218, v218, v221
    v_mov_b32 v219, v218
    s_nop 1
    v_permlane32_swap_b32 v218, v219
    v_max3_f32 v218, v218, v219, v216
    v_sub_f32 v220, v216, v218
    v_mov_b32 v216, v218
    v_exp_f32 v220, v220
    v_sub_f32 v192, v144, v218
    v_sub_f32 v193, v145, v218
    buffer_load_dwordx4 v[252:255], v23, s[32:35], s58 offen nt
    s_add_u32 s58, s58, 16384
    v_sub_f32 v194, v146, v218
    v_sub_f32 v195, v147, v218
    v_sub_f32 v196, v148, v218
    v_sub_f32 v197, v149, v218
    v_sub_f32 v198, v150, v218
    v_sub_f32 v199, v151, v218
    v_sub_f32 v200, v152, v218
    v_sub_f32 v201, v153, v218
    v_sub_f32 v202, v154, v218
    v_sub_f32 v203, v155, v218
    v_sub_f32 v204, v156, v218
    v_sub_f32 v205, v157, v218
    v_sub_f32 v206, v158, v218
    v_sub_f32 v207, v159, v218
    ds_write_b128 v28, v[128:131] offset:0
    v_exp_f32 v192, v192
    v_exp_f32 v193, v193
    v_exp_f32 v194, v194
    v_exp_f32 v195, v195
    ds_write_b128 v28, v[132:135] offset:1024
    v_exp_f32 v196, v196
    v_exp_f32 v197, v197
    v_exp_f32 v198, v198
    v_exp_f32 v199, v199
    ds_write_b128 v28, v[136:139] offset:2048
    v_exp_f32 v200, v200
    v_exp_f32 v201, v201
    v_exp_f32 v202, v202
    v_exp_f32 v203, v203
    ds_write_b128 v28, v[140:143] offset:3072
    v_exp_f32 v204, v204
    v_exp_f32 v205, v205
    v_exp_f32 v206, v206
    v_exp_f32 v207, v207
    v_mul_f32 v217, v217, v220
    v_cvt_pk_bf16_f32 v208, v192, v193
    v_cvt_pk_bf16_f32 v209, v194, v195
    v_cvt_pk_bf16_f32 v210, v196, v197
    v_cvt_pk_bf16_f32 v211, v198, v199
    v_cvt_pk_bf16_f32 v212, v200, v201
    v_cvt_pk_bf16_f32 v213, v202, v203
    v_cvt_pk_bf16_f32 v214, v204, v205
    v_cvt_pk_bf16_f32 v215, v206, v207
    v_mul_f32 v64, v64, v220
    v_mul_f32 v65, v65, v220
    v_mul_f32 v66, v66, v220
    v_mul_f32 v67, v67, v220
    v_mul_f32 v68, v68, v220
    v_mul_f32 v69, v69, v220
    v_mul_f32 v70, v70, v220
    v_mul_f32 v71, v71, v220
    v_mul_f32 v72, v72, v220
    v_mul_f32 v73, v73, v220
    v_mul_f32 v74, v74, v220
    v_mul_f32 v75, v75, v220
    v_mul_f32 v76, v76, v220
    v_mul_f32 v77, v77, v220
    v_mul_f32 v78, v78, v220
    v_mul_f32 v79, v79, v220
    s_waitcnt lgkmcnt(0)
    s_barrier
    v_mfma_f32_32x32x16_bf16 v[64:79], a[64:67], v[208:211], v[64:79]
    ds_read_b128 v[144:147], v29 offset:0
    v_mul_f32 v80, v80, v220
    v_mul_f32 v81, v81, v220
    ds_read_b128 v[148:151], v29 offset:1024
    v_mul_f32 v82, v82, v220
    v_mul_f32 v83, v83, v220
    ds_read_b128 v[152:155], v29 offset:2048
    v_mul_f32 v84, v84, v220
    v_mfma_f32_32x32x16_bf16 v[64:79], a[68:71], v[212:215], v[64:79]
    v_mul_f32 v85, v85, v220
    ds_read_b128 v[156:159], v29 offset:3072
    v_mul_f32 v86, v86, v220
    v_mul_f32 v87, v87, v220
    v_mul_f32 v88, v88, v220
    v_mul_f32 v89, v89, v220
    v_mul_f32 v90, v90, v220
    v_mul_f32 v91, v91, v220
    v_mul_f32 v92, v92, v220
    v_mul_f32 v93, v93, v220
    v_mul_f32 v94, v94, v220
    v_mul_f32 v95, v95, v220
    s_nop 1
    v_mfma_f32_32x32x16_bf16 v[80:95], a[72:75], v[208:211], v[80:95]
    ds_read_b128 v[160:163], v30 offset:0
    v_mul_f32 v96, v96, v220
    v_mul_f32 v97, v97, v220
    ds_read_b128 v[164:167], v30 offset:1024
    v_mul_f32 v98, v98, v220
    v_mul_f32 v99, v99, v220
    ds_read_b128 v[168:171], v30 offset:2048
    v_mul_f32 v100, v100, v220
    v_mfma_f32_32x32x16_bf16 v[80:95], a[76:79], v[212:215], v[80:95]
    v_mul_f32 v101, v101, v220
    ds_read_b128 v[172:175], v30 offset:3072
    v_mul_f32 v102, v102, v220
    v_mul_f32 v103, v103, v220
    v_mul_f32 v104, v104, v220
    v_mul_f32 v105, v105, v220
    v_mul_f32 v106, v106, v220
    v_mul_f32 v107, v107, v220
    v_mul_f32 v108, v108, v220
    v_mul_f32 v109, v109, v220
    v_mul_f32 v110, v110, v220
    v_mul_f32 v111, v111, v220
    s_nop 1
    v_mfma_f32_32x32x16_bf16 v[96:111], a[80:83], v[208:211], v[96:111]
    ds_read_b128 v[176:179], v31 offset:0
    v_mul_f32 v112, v112, v220
    v_mul_f32 v113, v113, v220
    ds_read_b128 v[180:183], v31 offset:1024
    v_mul_f32 v114, v114, v220
    v_mul_f32 v115, v115, v220
    ds_read_b128 v[184:187], v31 offset:2048
    v_mul_f32 v116, v116, v220
    v_mfma_f32_32x32x16_bf16 v[96:111], a[84:87], v[212:215], v[96:111]
    v_mul_f32 v117, v117, v220
    ds_read_b128 v[188:191], v31 offset:3072
    v_mul_f32 v118, v118, v220
    v_mul_f32 v119, v119, v220
    v_mul_f32 v120, v120, v220
    v_mul_f32 v121, v121, v220
    v_mul_f32 v122, v122, v220
    v_mul_f32 v123, v123, v220
    v_mul_f32 v124, v124, v220
    v_mul_f32 v125, v125, v220
    v_mul_f32 v126, v126, v220
    v_mul_f32 v127, v127, v220
    s_nop 1
    v_mfma_f32_32x32x16_bf16 v[112:127], a[88:91], v[208:211], v[112:127]
    v_add_f32 v192, v192, v200
    v_add_f32 v193, v193, v201
    v_add_f32 v194, v194, v202
    v_add_f32 v195, v195, v203
    v_add_f32 v196, v196, v204
    v_add_f32 v197, v197, v205
    v_add_f32 v198, v198, v206
    v_add_f32 v199, v199, v207
    v_mfma_f32_32x32x16_bf16 v[112:127], a[92:95], v[212:215], v[112:127]
    v_add_f32 v192, v192, v196
    v_add_f32 v193, v193, v197
    v_add_f32 v194, v194, v198
    v_add_f32 v195, v195, v199
    v_add_f32 v192, v192, v193
    v_add_f32 v194, v194, v195
    v_add_f32 v192, v192, v194
    v_add_f32 v217, v217, v192
    ds_read_b128 a[32:35], v32 offset:8192
    ds_read_b128 a[36:39], v33 offset:8192
    ds_read_b128 a[40:43], v34 offset:8192
    ds_read_b128 a[44:47], v35 offset:8192
    ds_read_b128 a[48:51], v36 offset:8192
    ds_read_b128 a[52:55], v37 offset:8192
    ds_read_b128 a[56:59], v38 offset:8192
    ds_read_b128 a[60:63], v39 offset:8192
    s_waitcnt lgkmcnt(8)
    v_add_f32 v144, v144, v128
    v_add_f32 v145, v145, v129
    v_add_f32 v146, v146, v130
    v_add_f32 v147, v147, v131
    v_add_f32 v148, v148, v132
    v_add_f32 v149, v149, v133
    v_add_f32 v150, v150, v134
    v_add_f32 v151, v151, v135
    v_add_f32 v152, v152, v136
    v_add_f32 v153, v153, v137
    v_add_f32 v154, v154, v138
    v_add_f32 v155, v155, v139
    v_add_f32 v156, v156, v140
    v_add_f32 v157, v157, v141
    v_add_f32 v158, v158, v142
    v_add_f32 v159, v159, v143
    s_waitcnt lgkmcnt(0)
    v_mfma_f32_32x32x16_bf16 v[128:143], a[32:35], a[0:3], 0
    ds_read_b64_tr_b16 a[64:65], v40 offset:0
    ds_read_b64_tr_b16 a[66:67], v41 offset:2048
    v_add_f32 v160, v160, v176
    v_add_f32 v161, v161, v177
    v_add_f32 v162, v162, v178
    v_add_f32 v163, v163, v179
    v_add_f32 v164, v164, v180
    v_mfma_f32_32x32x16_bf16 v[128:143], a[36:39], a[4:7], v[128:143]
    ds_read_b64_tr_b16 a[72:73], v42 offset:0
    ds_read_b64_tr_b16 a[74:75], v43 offset:2048
    v_add_f32 v165, v165, v181
    v_add_f32 v166, v166, v182
    v_add_f32 v167, v167, v183
    v_add_f32 v168, v168, v184
    v_add_f32 v169, v169, v185
    v_mfma_f32_32x32x16_bf16 v[128:143], a[40:43], a[8:11], v[128:143]
    ds_read_b64_tr_b16 a[80:81], v44 offset:0
    ds_read_b64_tr_b16 a[82:83], v45 offset:2048
    v_add_f32 v170, v170, v186
    v_add_f32 v171, v171, v187
    v_add_f32 v172, v172, v188
    v_add_f32 v173, v173, v189
    v_add_f32 v174, v174, v190
    v_mfma_f32_32x32x16_bf16 v[128:143], a[44:47], a[12:15], v[128:143]
    ds_read_b64_tr_b16 a[88:89], v46 offset:0
    ds_read_b64_tr_b16 a[90:91], v47 offset:2048
    v_add_f32 v175, v175, v191
    v_add_f32 v144, v144, v160
    v_add_f32 v145, v145, v161
    v_add_f32 v146, v146, v162
    v_add_f32 v147, v147, v163
    v_mfma_f32_32x32x16_bf16 v[128:143], a[48:51], a[16:19], v[128:143]
    ds_read_b64_tr_b16 a[68:69], v40 offset:4096
    ds_read_b64_tr_b16 a[70:71], v41 offset:6144
    v_add_f32 v148, v148, v164
    v_add_f32 v149, v149, v165
    v_add_f32 v150, v150, v166
    v_add_f32 v151, v151, v167
    v_add_f32 v152, v152, v168
    v_mfma_f32_32x32x16_bf16 v[128:143], a[52:55], a[20:23], v[128:143]
    ds_read_b64_tr_b16 a[76:77], v42 offset:4096
    ds_read_b64_tr_b16 a[78:79], v43 offset:6144
    v_add_f32 v153, v153, v169
    v_add_f32 v154, v154, v170
    v_add_f32 v155, v155, v171
    v_add_f32 v156, v156, v172
    v_add_f32 v157, v157, v173
    v_mfma_f32_32x32x16_bf16 v[128:143], a[56:59], a[24:27], v[128:143]
    ds_read_b64_tr_b16 a[84:85], v44 offset:4096
    ds_read_b64_tr_b16 a[86:87], v45 offset:6144
    v_add_f32 v158, v158, v174
    v_add_f32 v159, v159, v175
    v_max3_f32 v218, v144, v145, v146
    v_max3_f32 v219, v147, v148, v149
    v_max3_f32 v220, v150, v151, v152
    v_mfma_f32_32x32x16_bf16 v[128:143], a[60:63], a[28:31], v[128:143]
    ds_read_b64_tr_b16 a[92:93], v46 offset:4096
    ds_read_b64_tr_b16 a[94:95], v47 offset:6144
    v_max3_f32 v221, v153, v154, v155
    v_max3_f32 v218, v218, v156, v157
    v_max3_f32 v219, v219, v158, v159
    v_max3_f32 v218, v218, v219, v220
    v_max_f32 v218, v218, v221
    v_mov_b32 v219, v218
    s_nop 1
    v_permlane32_swap_b32 v218, v219
    v_max3_f32 v218, v218, v219, v216
    v_sub_f32 v220, v216, v218
    v_mov_b32 v216, v218
    v_exp_f32 v220, v220
    v_sub_f32 v192, v144, v218
    v_sub_f32 v193, v145, v218
    v_sub_f32 v194, v146, v218
    v_sub_f32 v195, v147, v218
    v_sub_f32 v196, v148, v218
    v_sub_f32 v197, v149, v218
    v_sub_f32 v198, v150, v218
    v_sub_f32 v199, v151, v218
    v_sub_f32 v200, v152, v218
    v_sub_f32 v201, v153, v218
    v_sub_f32 v202, v154, v218
    v_sub_f32 v203, v155, v218
    v_sub_f32 v204, v156, v218
    v_sub_f32 v205, v157, v218
    v_sub_f32 v206, v158, v218
    v_sub_f32 v207, v159, v218
    ds_write_b128 v28, v[128:131] offset:16384
    v_exp_f32 v192, v192
    v_exp_f32 v193, v193
    v_exp_f32 v194, v194
    v_exp_f32 v195, v195
    ds_write_b128 v28, v[132:135] offset:17408
    v_exp_f32 v196, v196
    v_exp_f32 v197, v197
    v_exp_f32 v198, v198
    v_exp_f32 v199, v199
    ds_write_b128 v28, v[136:139] offset:18432
    v_exp_f32 v200, v200
    v_exp_f32 v201, v201
    v_exp_f32 v202, v202
    v_exp_f32 v203, v203
    ds_write_b128 v28, v[140:143] offset:19456
    v_exp_f32 v204, v204
    v_exp_f32 v205, v205
    v_exp_f32 v206, v206
    v_exp_f32 v207, v207
    v_mul_f32 v217, v217, v220
    v_cvt_pk_bf16_f32 v208, v192, v193
    v_cvt_pk_bf16_f32 v209, v194, v195
    v_cvt_pk_bf16_f32 v210, v196, v197
    v_cvt_pk_bf16_f32 v211, v198, v199
    v_cvt_pk_bf16_f32 v212, v200, v201
    v_cvt_pk_bf16_f32 v213, v202, v203
    v_cvt_pk_bf16_f32 v214, v204, v205
    v_cvt_pk_bf16_f32 v215, v206, v207
    v_mul_f32 v64, v64, v220
    v_mul_f32 v65, v65, v220
    v_mul_f32 v66, v66, v220
    v_mul_f32 v67, v67, v220
    v_mul_f32 v68, v68, v220
    v_mul_f32 v69, v69, v220
    v_mul_f32 v70, v70, v220
    v_mul_f32 v71, v71, v220
    v_mul_f32 v72, v72, v220
    v_mul_f32 v73, v73, v220
    v_mul_f32 v74, v74, v220
    v_mul_f32 v75, v75, v220
    v_mul_f32 v76, v76, v220
    v_mul_f32 v77, v77, v220
    v_mul_f32 v78, v78, v220
    v_mul_f32 v79, v79, v220
    s_waitcnt lgkmcnt(0)
    s_barrier
    v_mfma_f32_32x32x16_bf16 v[64:79], a[64:67], v[208:211], v[64:79]
    ds_read_b128 v[144:147], v29 offset:16384
    v_mul_f32 v80, v80, v220
    v_mul_f32 v81, v81, v220
    ds_read_b128 v[148:151], v29 offset:17408
    s_waitcnt vmcnt(47)
    ds_write_b128 v26, a[96:99] offset:16384
    buffer_load_dwordx4 a[96:99], v48, s[36:39], s99 offen offset:0 nt
    v_mul_f32 v82, v82, v220
    v_mul_f32 v83, v83, v220
    ds_read_b128 v[152:155], v29 offset:18432
    v_mul_f32 v84, v84, v220
    v_mfma_f32_32x32x16_bf16 v[64:79], a[68:71], v[212:215], v[64:79]
    v_mul_f32 v85, v85, v220
    ds_read_b128 v[156:159], v29 offset:19456
    v_mul_f32 v86, v86, v220
    s_waitcnt vmcnt(47)
    ds_write_b128 v26, a[100:103] offset:17408
    buffer_load_dwordx4 a[100:103], v48, s[36:39], s99 offen offset:1152 nt
    v_mul_f32 v87, v87, v220
    v_mul_f32 v88, v88, v220
    v_mul_f32 v89, v89, v220
    v_mul_f32 v90, v90, v220
    v_mul_f32 v91, v91, v220
    v_mul_f32 v92, v92, v220
    v_mul_f32 v93, v93, v220
    v_mul_f32 v94, v94, v220
    v_mul_f32 v95, v95, v220
    s_nop 1
    v_mfma_f32_32x32x16_bf16 v[80:95], a[72:75], v[208:211], v[80:95]
    ds_read_b128 v[160:163], v30 offset:16384
    v_mul_f32 v96, v96, v220
    v_mul_f32 v97, v97, v220
    ds_read_b128 v[164:167], v30 offset:17408
    s_waitcnt vmcnt(47)
    ds_write_b128 v26, a[104:107] offset:18432
    buffer_load_dwordx4 a[104:107], v48, s[36:39], s99 offen offset:2304 nt
    v_mul_f32 v98, v98, v220
    v_mul_f32 v99, v99, v220
    ds_read_b128 v[168:171], v30 offset:18432
    v_mul_f32 v100, v100, v220
    v_mfma_f32_32x32x16_bf16 v[80:95], a[76:79], v[212:215], v[80:95]
    v_mul_f32 v101, v101, v220
    ds_read_b128 v[172:175], v30 offset:19456
    v_mul_f32 v102, v102, v220
    s_waitcnt vmcnt(47)
    ds_write_b128 v26, a[108:111] offset:19456
    v_mul_f32 v103, v103, v220
    v_mul_f32 v104, v104, v220
    v_mul_f32 v105, v105, v220
    v_mul_f32 v106, v106, v220
    v_mul_f32 v107, v107, v220
    v_mul_f32 v108, v108, v220
    v_mul_f32 v109, v109, v220
    v_mul_f32 v110, v110, v220
    v_mul_f32 v111, v111, v220
    s_nop 1
    v_mfma_f32_32x32x16_bf16 v[96:111], a[80:83], v[208:211], v[96:111]
    ds_read_b128 v[176:179], v31 offset:16384
    v_mul_f32 v112, v112, v220
    v_mul_f32 v113, v113, v220
    ds_read_b128 v[180:183], v31 offset:17408
    s_waitcnt vmcnt(46)
    ds_write_b128 v26, a[112:115] offset:20480
    buffer_load_dwordx4 a[108:111], v48, s[36:39], s99 offen offset:3456 nt
    s_add_u32 s99, s99, 4608
    v_mul_f32 v114, v114, v220
    v_mul_f32 v115, v115, v220
    ds_read_b128 v[184:187], v31 offset:18432
    v_mul_f32 v116, v116, v220
    v_mfma_f32_32x32x16_bf16 v[96:111], a[84:87], v[212:215], v[96:111]
    v_mul_f32 v117, v117, v220
    ds_read_b128 v[188:191], v31 offset:19456
    v_mul_f32 v118, v118, v220
    s_waitcnt vmcnt(46)
    ds_write_b128 v26, a[116:119] offset:21504
    buffer_load_dwordx4 a[112:115], v48, s[36:39], s99 offen offset:0 nt
    v_mul_f32 v119, v119, v220
    v_mul_f32 v120, v120, v220
    v_mul_f32 v121, v121, v220
    v_mul_f32 v122, v122, v220
    v_mul_f32 v123, v123, v220
    v_mul_f32 v124, v124, v220
    v_mul_f32 v125, v125, v220
    v_mul_f32 v126, v126, v220
    v_mul_f32 v127, v127, v220
    s_nop 1
    v_mfma_f32_32x32x16_bf16 v[112:127], a[88:91], v[208:211], v[112:127]
    v_add_f32 v192, v192, v200
    v_add_f32 v193, v193, v201
    v_add_f32 v194, v194, v202
    v_add_f32 v195, v195, v203
    s_waitcnt vmcnt(46)
    ds_write_b128 v26, a[120:123] offset:22528
    buffer_load_dwordx4 a[116:119], v48, s[36:39], s99 offen offset:1152 nt
    v_add_f32 v196, v196, v204
    v_add_f32 v197, v197, v205
    v_add_f32 v198, v198, v206
    v_add_f32 v199, v199, v207
    v_mfma_f32_32x32x16_bf16 v[112:127], a[92:95], v[212:215], v[112:127]
    v_add_f32 v192, v192, v196
    v_add_f32 v193, v193, v197
    v_add_f32 v194, v194, v198
    s_waitcnt vmcnt(46)
    ds_write_b128 v26, a[124:127] offset:23552
    v_add_f32 v195, v195, v199
    v_add_f32 v192, v192, v193
    v_add_f32 v194, v194, v195
    v_add_f32 v192, v192, v194
    v_add_f32 v217, v217, v192
    ds_read_b128 a[32:35], v32 offset:16384
    ds_read_b128 a[36:39], v33 offset:16384
    ds_read_b128 a[40:43], v34 offset:16384
    ds_read_b128 a[44:47], v35 offset:16384
    ds_read_b128 a[48:51], v36 offset:16384
    ds_read_b128 a[52:55], v37 offset:16384
    ds_read_b128 a[56:59], v38 offset:16384
    ds_read_b128 a[60:63], v39 offset:16384
    s_waitcnt lgkmcnt(8)
    v_add_f32 v144, v144, v128
    v_add_f32 v145, v145, v129
    v_add_f32 v146, v146, v130
    v_add_f32 v147, v147, v131
    buffer_load_dwordx4 a[120:123], v48, s[36:39], s99 offen offset:2304 nt
    v_add_f32 v148, v148, v132
    v_add_f32 v149, v149, v133
    v_add_f32 v150, v150, v134
    v_add_f32 v151, v151, v135
    v_add_f32 v152, v152, v136
    v_add_f32 v153, v153, v137
    v_add_f32 v154, v154, v138
    v_add_f32 v155, v155, v139
    v_add_f32 v156, v156, v140
    v_add_f32 v157, v157, v141
    v_add_f32 v158, v158, v142
    v_add_f32 v159, v159, v143
    s_waitcnt lgkmcnt(0)
    v_mfma_f32_32x32x16_bf16 v[128:143], a[32:35], a[0:3], 0
    ds_read_b64_tr_b16 a[64:65], v40 offset:8192
    ds_read_b64_tr_b16 a[66:67], v41 offset:10240
    v_add_f32 v160, v160, v176
    v_add_f32 v161, v161, v177
    v_add_f32 v162, v162, v178
    v_add_f32 v163, v163, v179
    v_add_f32 v164, v164, v180
    v_mfma_f32_32x32x16_bf16 v[128:143], a[36:39], a[4:7], v[128:143]
    ds_read_b64_tr_b16 a[72:73], v42 offset:8192
    ds_read_b64_tr_b16 a[74:75], v43 offset:10240
    v_add_f32 v165, v165, v181
    v_add_f32 v166, v166, v182
    v_add_f32 v167, v167, v183
    v_add_f32 v168, v168, v184
    v_add_f32 v169, v169, v185
    v_mfma_f32_32x32x16_bf16 v[128:143], a[40:43], a[8:11], v[128:143]
    ds_read_b64_tr_b16 a[80:81], v44 offset:8192
    ds_read_b64_tr_b16 a[82:83], v45 offset:10240
    v_add_f32 v170, v170, v186
    v_add_f32 v171, v171, v187
    v_add_f32 v172, v172, v188
    v_add_f32 v173, v173, v189
    v_add_f32 v174, v174, v190
    v_mfma_f32_32x32x16_bf16 v[128:143], a[44:47], a[12:15], v[128:143]
    ds_read_b64_tr_b16 a[88:89], v46 offset:8192
    ds_read_b64_tr_b16 a[90:91], v47 offset:10240
    v_add_f32 v175, v175, v191
    v_add_f32 v144, v144, v160
    v_add_f32 v145, v145, v161
    v_add_f32 v146, v146, v162
    v_add_f32 v147, v147, v163
    v_mfma_f32_32x32x16_bf16 v[128:143], a[48:51], a[16:19], v[128:143]
    ds_read_b64_tr_b16 a[68:69], v40 offset:12288
    ds_read_b64_tr_b16 a[70:71], v41 offset:14336
    v_add_f32 v148, v148, v164
    v_add_f32 v149, v149, v165
    v_add_f32 v150, v150, v166
    v_add_f32 v151, v151, v167
    v_add_f32 v152, v152, v168
    v_mfma_f32_32x32x16_bf16 v[128:143], a[52:55], a[20:23], v[128:143]
    ds_read_b64_tr_b16 a[76:77], v42 offset:12288
    ds_read_b64_tr_b16 a[78:79], v43 offset:14336
    v_add_f32 v153, v153, v169
    v_add_f32 v154, v154, v170
    v_add_f32 v155, v155, v171
    v_add_f32 v156, v156, v172
    v_add_f32 v157, v157, v173
    v_mfma_f32_32x32x16_bf16 v[128:143], a[56:59], a[24:27], v[128:143]
    ds_read_b64_tr_b16 a[84:85], v44 offset:12288
    ds_read_b64_tr_b16 a[86:87], v45 offset:14336
    v_add_f32 v158, v158, v174
    v_add_f32 v159, v159, v175
    v_max3_f32 v218, v144, v145, v146
    v_max3_f32 v219, v147, v148, v149
    v_max3_f32 v220, v150, v151, v152
    v_mfma_f32_32x32x16_bf16 v[128:143], a[60:63], a[28:31], v[128:143]
    ds_read_b64_tr_b16 a[92:93], v46 offset:12288
    ds_read_b64_tr_b16 a[94:95], v47 offset:14336
    v_max3_f32 v221, v153, v154, v155
    v_max3_f32 v218, v218, v156, v157
    v_max3_f32 v219, v219, v158, v159
    v_max3_f32 v218, v218, v219, v220
    v_max_f32 v218, v218, v221
    v_mov_b32 v219, v218
    s_nop 1
    v_permlane32_swap_b32 v218, v219
    v_max3_f32 v218, v218, v219, v216
    v_sub_f32 v220, v216, v218
    v_mov_b32 v216, v218
    v_exp_f32 v220, v220
    v_sub_f32 v192, v144, v218
    v_sub_f32 v193, v145, v218
    buffer_load_dwordx4 a[124:127], v48, s[36:39], s99 offen offset:3456 nt
    s_add_u32 s99, s99, 32256
    v_sub_f32 v194, v146, v218
    v_sub_f32 v195, v147, v218
    v_sub_f32 v196, v148, v218
    v_sub_f32 v197, v149, v218
    v_sub_f32 v198, v150, v218
    v_sub_f32 v199, v151, v218
    v_sub_f32 v200, v152, v218
    v_sub_f32 v201, v153, v218
    v_sub_f32 v202, v154, v218
    v_sub_f32 v203, v155, v218
    v_sub_f32 v204, v156, v218
    v_sub_f32 v205, v157, v218
    v_sub_f32 v206, v158, v218
    v_sub_f32 v207, v159, v218
    ds_write_b128 v28, v[128:131] offset:0
    v_exp_f32 v192, v192
    v_exp_f32 v193, v193
    v_exp_f32 v194, v194
    v_exp_f32 v195, v195
    ds_write_b128 v28, v[132:135] offset:1024
    v_exp_f32 v196, v196
    v_exp_f32 v197, v197
    v_exp_f32 v198, v198
    v_exp_f32 v199, v199
    ds_write_b128 v28, v[136:139] offset:2048
    v_exp_f32 v200, v200
    v_exp_f32 v201, v201
    v_exp_f32 v202, v202
    v_exp_f32 v203, v203
    ds_write_b128 v28, v[140:143] offset:3072
    v_exp_f32 v204, v204
    v_exp_f32 v205, v205
    v_exp_f32 v206, v206
    v_exp_f32 v207, v207
    v_mul_f32 v217, v217, v220
    v_cvt_pk_bf16_f32 v208, v192, v193
    v_cvt_pk_bf16_f32 v209, v194, v195
    v_cvt_pk_bf16_f32 v210, v196, v197
    v_cvt_pk_bf16_f32 v211, v198, v199
    v_cvt_pk_bf16_f32 v212, v200, v201
    v_cvt_pk_bf16_f32 v213, v202, v203
    v_cvt_pk_bf16_f32 v214, v204, v205
    v_cvt_pk_bf16_f32 v215, v206, v207
    v_mul_f32 v64, v64, v220
    v_mul_f32 v65, v65, v220
    v_mul_f32 v66, v66, v220
    v_mul_f32 v67, v67, v220
    v_mul_f32 v68, v68, v220
    v_mul_f32 v69, v69, v220
    v_mul_f32 v70, v70, v220
    v_mul_f32 v71, v71, v220
    v_mul_f32 v72, v72, v220
    v_mul_f32 v73, v73, v220
    v_mul_f32 v74, v74, v220
    v_mul_f32 v75, v75, v220
    v_mul_f32 v76, v76, v220
    v_mul_f32 v77, v77, v220
    v_mul_f32 v78, v78, v220
    v_mul_f32 v79, v79, v220
    s_waitcnt lgkmcnt(0)
    s_barrier
    v_mfma_f32_32x32x16_bf16 v[64:79], a[64:67], v[208:211], v[64:79]
    ds_read_b128 v[144:147], v29 offset:0
    v_mul_f32 v80, v80, v220
    v_mul_f32 v81, v81, v220
    ds_read_b128 v[148:151], v29 offset:1024
    s_waitcnt vmcnt(47)
    ds_write_b128 v26, a[128:131] offset:24576
    buffer_load_dwordx4 a[128:131], v48, s[36:39], s99 offen offset:0 nt
    v_mul_f32 v82, v82, v220
    v_mul_f32 v83, v83, v220
    ds_read_b128 v[152:155], v29 offset:2048
    v_mul_f32 v84, v84, v220
    v_mfma_f32_32x32x16_bf16 v[64:79], a[68:71], v[212:215], v[64:79]
    v_mul_f32 v85, v85, v220
    ds_read_b128 v[156:159], v29 offset:3072
    v_mul_f32 v86, v86, v220
    s_waitcnt vmcnt(47)
    ds_write_b128 v26, a[132:135] offset:25600
    v_mul_f32 v87, v87, v220
    v_mul_f32 v88, v88, v220
    v_mul_f32 v89, v89, v220
    v_mul_f32 v90, v90, v220
    v_mul_f32 v91, v91, v220
    v_mul_f32 v92, v92, v220
    v_mul_f32 v93, v93, v220
    v_mul_f32 v94, v94, v220
    v_mul_f32 v95, v95, v220
    s_nop 1
    v_mfma_f32_32x32x16_bf16 v[80:95], a[72:75], v[208:211], v[80:95]
    ds_read_b128 v[160:163], v30 offset:0
    v_mul_f32 v96, v96, v220
    v_mul_f32 v97, v97, v220
    ds_read_b128 v[164:167], v30 offset:1024
    s_waitcnt vmcnt(46)
    ds_write_b128 v26, a[136:139] offset:26624
    buffer_load_dwordx4 a[132:135], v48, s[36:39], s99 offen offset:1152 nt
    v_mul_f32 v98, v98, v220
    v_mul_f32 v99, v99, v220
    ds_read_b128 v[168:171], v30 offset:2048
    v_mul_f32 v100, v100, v220
    v_mfma_f32_32x32x16_bf16 v[80:95], a[76:79], v[212:215], v[80:95]
    v_mul_f32 v101, v101, v220
    ds_read_b128 v[172:175], v30 offset:3072
    v_mul_f32 v102, v102, v220
    s_waitcnt vmcnt(46)
    ds_write_b128 v26, a[140:143] offset:27648
    v_mul_f32 v103, v103, v220
    v_mul_f32 v104, v104, v220
    v_mul_f32 v105, v105, v220
    v_mul_f32 v106, v106, v220
    v_mul_f32 v107, v107, v220
    v_mul_f32 v108, v108, v220
    v_mul_f32 v109, v109, v220
    v_mul_f32 v110, v110, v220
    v_mul_f32 v111, v111, v220
    s_nop 1
    v_mfma_f32_32x32x16_bf16 v[96:111], a[80:83], v[208:211], v[96:111]
    ds_read_b128 v[176:179], v31 offset:0
    v_mul_f32 v112, v112, v220
    v_mul_f32 v113, v113, v220
    ds_read_b128 v[180:183], v31 offset:1024
    s_waitcnt vmcnt(45)
    ds_write_b128 v26, a[144:147] offset:28672
    buffer_load_dwordx4 a[136:139], v48, s[36:39], s99 offen offset:2304 nt
    v_mul_f32 v114, v114, v220
    v_mul_f32 v115, v115, v220
    ds_read_b128 v[184:187], v31 offset:2048
    v_mul_f32 v116, v116, v220
    v_mfma_f32_32x32x16_bf16 v[96:111], a[84:87], v[212:215], v[96:111]
    v_mul_f32 v117, v117, v220
    ds_read_b128 v[188:191], v31 offset:3072
    v_mul_f32 v118, v118, v220
    s_waitcnt vmcnt(45)
    ds_write_b128 v26, a[148:151] offset:29696
    v_mul_f32 v119, v119, v220
    v_mul_f32 v120, v120, v220
    v_mul_f32 v121, v121, v220
    v_mul_f32 v122, v122, v220
    v_mul_f32 v123, v123, v220
    v_mul_f32 v124, v124, v220
    v_mul_f32 v125, v125, v220
    v_mul_f32 v126, v126, v220
    v_mul_f32 v127, v127, v220
    s_nop 1
    v_mfma_f32_32x32x16_bf16 v[112:127], a[88:91], v[208:211], v[112:127]
    v_add_f32 v192, v192, v200
    v_add_f32 v193, v193, v201
    v_add_f32 v194, v194, v202
    v_add_f32 v195, v195, v203
    s_waitcnt vmcnt(44)
    ds_write_b128 v26, a[152:155] offset:30720
    buffer_load_dwordx4 a[140:143], v48, s[36:39], s99 offen offset:3456 nt
    s_add_u32 s99, s99, 4608
    v_add_f32 v196, v196, v204
    v_add_f32 v197, v197, v205
    v_add_f32 v198, v198, v206
    v_add_f32 v199, v199, v207
    v_mfma_f32_32x32x16_bf16 v[112:127], a[92:95], v[212:215], v[112:127]
    v_add_f32 v192, v192, v196
    v_add_f32 v193, v193, v197
    v_add_f32 v194, v194, v198
    s_waitcnt vmcnt(44)
    ds_write_b128 v26, a[156:159] offset:31744
    v_add_f32 v195, v195, v199
    v_add_f32 v192, v192, v193
    v_add_f32 v194, v194, v195
    v_add_f32 v192, v192, v194
    v_add_f32 v217, v217, v192
    ds_read_b128 a[32:35], v32 offset:24576
    ds_read_b128 a[36:39], v33 offset:24576
    ds_read_b128 a[40:43], v34 offset:24576
    ds_read_b128 a[44:47], v35 offset:24576
    ds_read_b128 a[48:51], v36 offset:24576
    ds_read_b128 a[52:55], v37 offset:24576
    ds_read_b128 a[56:59], v38 offset:24576
    ds_read_b128 a[60:63], v39 offset:24576
    s_waitcnt lgkmcnt(8)
    v_add_f32 v144, v144, v128
    v_add_f32 v145, v145, v129
    v_add_f32 v146, v146, v130
    v_add_f32 v147, v147, v131
    buffer_load_dwordx4 a[144:147], v48, s[36:39], s99 offen offset:0 nt
    v_add_f32 v148, v148, v132
    v_add_f32 v149, v149, v133
    v_add_f32 v150, v150, v134
    v_add_f32 v151, v151, v135
    v_add_f32 v152, v152, v136
    v_add_f32 v153, v153, v137
    v_add_f32 v154, v154, v138
    v_add_f32 v155, v155, v139
    v_add_f32 v156, v156, v140
    v_add_f32 v157, v157, v141
    v_add_f32 v158, v158, v142
    v_add_f32 v159, v159, v143
    s_waitcnt lgkmcnt(0)
    v_mfma_f32_32x32x16_bf16 v[128:143], a[32:35], a[0:3], 0
    ds_read_b64_tr_b16 a[64:65], v40 offset:16384
    ds_read_b64_tr_b16 a[66:67], v41 offset:18432
    v_add_f32 v160, v160, v176
    v_add_f32 v161, v161, v177
    v_add_f32 v162, v162, v178
    v_add_f32 v163, v163, v179
    v_add_f32 v164, v164, v180
    v_mfma_f32_32x32x16_bf16 v[128:143], a[36:39], a[4:7], v[128:143]
    ds_read_b64_tr_b16 a[72:73], v42 offset:16384
    ds_read_b64_tr_b16 a[74:75], v43 offset:18432
    v_add_f32 v165, v165, v181
    v_add_f32 v166, v166, v182
    v_add_f32 v167, v167, v183
    v_add_f32 v168, v168, v184
    v_add_f32 v169, v169, v185
    v_mfma_f32_32x32x16_bf16 v[128:143], a[40:43], a[8:11], v[128:143]
    ds_read_b64_tr_b16 a[80:81], v44 offset:16384
    ds_read_b64_tr_b16 a[82:83], v45 offset:18432
    v_add_f32 v170, v170, v186
    v_add_f32 v171, v171, v187
    v_add_f32 v172, v172, v188
    v_add_f32 v173, v173, v189
    v_add_f32 v174, v174, v190
    v_mfma_f32_32x32x16_bf16 v[128:143], a[44:47], a[12:15], v[128:143]
    ds_read_b64_tr_b16 a[88:89], v46 offset:16384
    ds_read_b64_tr_b16 a[90:91], v47 offset:18432
    v_add_f32 v175, v175, v191
    v_add_f32 v144, v144, v160
    v_add_f32 v145, v145, v161
    v_add_f32 v146, v146, v162
    v_add_f32 v147, v147, v163
    v_mfma_f32_32x32x16_bf16 v[128:143], a[48:51], a[16:19], v[128:143]
    ds_read_b64_tr_b16 a[68:69], v40 offset:20480
    ds_read_b64_tr_b16 a[70:71], v41 offset:22528
    v_add_f32 v148, v148, v164
    v_add_f32 v149, v149, v165
    v_add_f32 v150, v150, v166
    v_add_f32 v151, v151, v167
    v_add_f32 v152, v152, v168
    v_mfma_f32_32x32x16_bf16 v[128:143], a[52:55], a[20:23], v[128:143]
    ds_read_b64_tr_b16 a[76:77], v42 offset:20480
    ds_read_b64_tr_b16 a[78:79], v43 offset:22528
    v_add_f32 v153, v153, v169
    v_add_f32 v154, v154, v170
    v_add_f32 v155, v155, v171
    v_add_f32 v156, v156, v172
    v_add_f32 v157, v157, v173
    v_mfma_f32_32x32x16_bf16 v[128:143], a[56:59], a[24:27], v[128:143]
    ds_read_b64_tr_b16 a[84:85], v44 offset:20480
    ds_read_b64_tr_b16 a[86:87], v45 offset:22528
    v_add_f32 v158, v158, v174
    v_add_f32 v159, v159, v175
    v_max3_f32 v218, v144, v145, v146
    v_max3_f32 v219, v147, v148, v149
    v_max3_f32 v220, v150, v151, v152
    v_mfma_f32_32x32x16_bf16 v[128:143], a[60:63], a[28:31], v[128:143]
    ds_read_b64_tr_b16 a[92:93], v46 offset:20480
    ds_read_b64_tr_b16 a[94:95], v47 offset:22528
    v_max3_f32 v221, v153, v154, v155
    v_max3_f32 v218, v218, v156, v157
    v_max3_f32 v219, v219, v158, v159
    v_max3_f32 v218, v218, v219, v220
    v_max_f32 v218, v218, v221
    v_mov_b32 v219, v218
    s_nop 1
    v_permlane32_swap_b32 v218, v219
    v_max3_f32 v218, v218, v219, v216
    v_sub_f32 v220, v216, v218
    v_mov_b32 v216, v218
    v_exp_f32 v220, v220
    v_sub_f32 v192, v144, v218
    v_sub_f32 v193, v145, v218
    buffer_load_dwordx4 a[148:151], v48, s[36:39], s99 offen offset:1152 nt
    v_sub_f32 v194, v146, v218
    v_sub_f32 v195, v147, v218
    v_sub_f32 v196, v148, v218
    v_sub_f32 v197, v149, v218
    v_sub_f32 v198, v150, v218
    buffer_load_dwordx4 a[152:155], v48, s[36:39], s99 offen offset:2304 nt
    v_sub_f32 v199, v151, v218
    v_sub_f32 v200, v152, v218
    v_sub_f32 v201, v153, v218
    v_sub_f32 v202, v154, v218
    v_sub_f32 v203, v155, v218
    v_sub_f32 v204, v156, v218
    v_sub_f32 v205, v157, v218
    v_sub_f32 v206, v158, v218
    v_sub_f32 v207, v159, v218
    ds_write_b128 v28, v[128:131] offset:16384
    v_exp_f32 v192, v192
    v_exp_f32 v193, v193
    v_exp_f32 v194, v194
    v_exp_f32 v195, v195
    ds_write_b128 v28, v[132:135] offset:17408
    v_exp_f32 v196, v196
    v_exp_f32 v197, v197
    v_exp_f32 v198, v198
    v_exp_f32 v199, v199
    ds_write_b128 v28, v[136:139] offset:18432
    v_exp_f32 v200, v200
    v_exp_f32 v201, v201
    v_exp_f32 v202, v202
    v_exp_f32 v203, v203
    ds_write_b128 v28, v[140:143] offset:19456
    v_exp_f32 v204, v204
    v_exp_f32 v205, v205
    v_exp_f32 v206, v206
    v_exp_f32 v207, v207
    v_mul_f32 v217, v217, v220
    v_cvt_pk_bf16_f32 v208, v192, v193
    v_cvt_pk_bf16_f32 v209, v194, v195
    v_cvt_pk_bf16_f32 v210, v196, v197
    v_cvt_pk_bf16_f32 v211, v198, v199
    v_cvt_pk_bf16_f32 v212, v200, v201
    v_cvt_pk_bf16_f32 v213, v202, v203
    v_cvt_pk_bf16_f32 v214, v204, v205
    v_cvt_pk_bf16_f32 v215, v206, v207
    v_mul_f32 v64, v64, v220
    v_mul_f32 v65, v65, v220
    v_mul_f32 v66, v66, v220
    v_mul_f32 v67, v67, v220
    v_mul_f32 v68, v68, v220
    v_mul_f32 v69, v69, v220
    v_mul_f32 v70, v70, v220
    v_mul_f32 v71, v71, v220
    v_mul_f32 v72, v72, v220
    v_mul_f32 v73, v73, v220
    v_mul_f32 v74, v74, v220
    v_mul_f32 v75, v75, v220
    v_mul_f32 v76, v76, v220
    v_mul_f32 v77, v77, v220
    v_mul_f32 v78, v78, v220
    v_mul_f32 v79, v79, v220
    s_waitcnt lgkmcnt(0)
    s_barrier
    v_mfma_f32_32x32x16_bf16 v[64:79], a[64:67], v[208:211], v[64:79]
    ds_read_b128 v[144:147], v29 offset:16384
    v_mul_f32 v80, v80, v220
    v_mul_f32 v81, v81, v220
    ds_read_b128 v[148:151], v29 offset:17408
    s_waitcnt vmcnt(46)
    ds_write_b128 v26, a[160:163] offset:0
    buffer_load_dwordx4 a[156:159], v48, s[36:39], s99 offen offset:3456 nt
    s_add_u32 s99, s99, 32256
    v_mul_f32 v82, v82, v220
    v_mul_f32 v83, v83, v220
    ds_read_b128 v[152:155], v29 offset:18432
    v_mul_f32 v84, v84, v220
    v_mfma_f32_32x32x16_bf16 v[64:79], a[68:71], v[212:215], v[64:79]
    v_mul_f32 v85, v85, v220
    ds_read_b128 v[156:159], v29 offset:19456
    v_mul_f32 v86, v86, v220
    s_waitcnt vmcnt(46)
    ds_write_b128 v26, a[164:167] offset:1024
    v_mul_f32 v87, v87, v220
    v_mul_f32 v88, v88, v220
    v_mul_f32 v89, v89, v220
    v_mul_f32 v90, v90, v220
    v_mul_f32 v91, v91, v220
    v_mul_f32 v92, v92, v220
    v_mul_f32 v93, v93, v220
    v_mul_f32 v94, v94, v220
    v_mul_f32 v95, v95, v220
    s_nop 1
    v_mfma_f32_32x32x16_bf16 v[80:95], a[72:75], v[208:211], v[80:95]
    ds_read_b128 v[160:163], v30 offset:16384
    v_mul_f32 v96, v96, v220
    v_mul_f32 v97, v97, v220
    ds_read_b128 v[164:167], v30 offset:17408
    s_waitcnt vmcnt(45)
    ds_write_b128 v26, a[168:171] offset:2048
    buffer_load_dwordx4 a[160:163], v48, s[36:39], s99 offen offset:0 nt
    v_mul_f32 v98, v98, v220
    v_mul_f32 v99, v99, v220
    ds_read_b128 v[168:171], v30 offset:18432
    v_mul_f32 v100, v100, v220
    v_mfma_f32_32x32x16_bf16 v[80:95], a[76:79], v[212:215], v[80:95]
    v_mul_f32 v101, v101, v220
    ds_read_b128 v[172:175], v30 offset:19456
    v_mul_f32 v102, v102, v220
    s_waitcnt vmcnt(45)
    ds_write_b128 v26, a[172:175] offset:3072
    v_mul_f32 v103, v103, v220
    v_mul_f32 v104, v104, v220
    v_mul_f32 v105, v105, v220
    v_mul_f32 v106, v106, v220
    v_mul_f32 v107, v107, v220
    v_mul_f32 v108, v108, v220
    v_mul_f32 v109, v109, v220
    v_mul_f32 v110, v110, v220
    v_mul_f32 v111, v111, v220
    s_nop 1
    v_mfma_f32_32x32x16_bf16 v[96:111], a[80:83], v[208:211], v[96:111]
    ds_read_b128 v[176:179], v31 offset:16384
    v_mul_f32 v112, v112, v220
    v_mul_f32 v113, v113, v220
    ds_read_b128 v[180:183], v31 offset:17408
    s_waitcnt vmcnt(44)
    ds_write_b128 v26, a[176:179] offset:4096
    v_mul_f32 v114, v114, v220
    v_mul_f32 v115, v115, v220
    ds_read_b128 v[184:187], v31 offset:18432
    v_mul_f32 v116, v116, v220
    v_mfma_f32_32x32x16_bf16 v[96:111], a[84:87], v[212:215], v[96:111]
    v_mul_f32 v117, v117, v220
    ds_read_b128 v[188:191], v31 offset:19456
    v_mul_f32 v118, v118, v220
    s_waitcnt vmcnt(43)
    ds_write_b128 v26, a[180:183] offset:5120
    buffer_load_dwordx4 a[164:167], v48, s[36:39], s99 offen offset:1152 nt
    v_mul_f32 v119, v119, v220
    v_mul_f32 v120, v120, v220
    v_mul_f32 v121, v121, v220
    v_mul_f32 v122, v122, v220
    v_mul_f32 v123, v123, v220
    v_mul_f32 v124, v124, v220
    v_mul_f32 v125, v125, v220
    v_mul_f32 v126, v126, v220
    v_mul_f32 v127, v127, v220
    s_nop 1
    v_mfma_f32_32x32x16_bf16 v[112:127], a[88:91], v[208:211], v[112:127]
    v_add_f32 v192, v192, v200
    v_add_f32 v193, v193, v201
    v_add_f32 v194, v194, v202
    v_add_f32 v195, v195, v203
    s_waitcnt vmcnt(43)
    ds_write_b128 v26, a[184:187] offset:6144
    v_add_f32 v196, v196, v204
    v_add_f32 v197, v197, v205
    v_add_f32 v198, v198, v206
    v_add_f32 v199, v199, v207
    v_mfma_f32_32x32x16_bf16 v[112:127], a[92:95], v[212:215], v[112:127]
    v_add_f32 v192, v192, v196
    v_add_f32 v193, v193, v197
    v_add_f32 v194, v194, v198
    s_waitcnt vmcnt(42)
    ds_write_b128 v26, a[188:191] offset:7168
    v_add_f32 v195, v195, v199
    v_add_f32 v192, v192, v193
    v_add_f32 v194, v194, v195
    v_add_f32 v192, v192, v194
    v_add_f32 v217, v217, v192
    ds_read_b128 a[32:35], v32 offset:0
    ds_read_b128 a[36:39], v33 offset:0
    ds_read_b128 a[40:43], v34 offset:0
    ds_read_b128 a[44:47], v35 offset:0
    ds_read_b128 a[48:51], v36 offset:0
    ds_read_b128 a[52:55], v37 offset:0
    ds_read_b128 a[56:59], v38 offset:0
    ds_read_b128 a[60:63], v39 offset:0
    s_waitcnt lgkmcnt(8)
    v_add_f32 v144, v144, v128
    v_add_f32 v145, v145, v129
    v_add_f32 v146, v146, v130
    v_add_f32 v147, v147, v131
    buffer_load_dwordx4 a[168:171], v48, s[36:39], s99 offen offset:2304 nt
    v_add_f32 v148, v148, v132
    v_add_f32 v149, v149, v133
    v_add_f32 v150, v150, v134
    v_add_f32 v151, v151, v135
    v_add_f32 v152, v152, v136
    v_add_f32 v153, v153, v137
    v_add_f32 v154, v154, v138
    v_add_f32 v155, v155, v139
    v_add_f32 v156, v156, v140
    v_add_f32 v157, v157, v141
    v_add_f32 v158, v158, v142
    v_add_f32 v159, v159, v143
    s_waitcnt lgkmcnt(0)
    v_mfma_f32_32x32x16_bf16 v[128:143], a[32:35], a[0:3], 0
    ds_read_b64_tr_b16 a[64:65], v40 offset:24576
    ds_read_b64_tr_b16 a[66:67], v41 offset:26624
    v_add_f32 v160, v160, v176
    v_add_f32 v161, v161, v177
    v_add_f32 v162, v162, v178
    v_add_f32 v163, v163, v179
    v_add_f32 v164, v164, v180
    v_mfma_f32_32x32x16_bf16 v[128:143], a[36:39], a[4:7], v[128:143]
    ds_read_b64_tr_b16 a[72:73], v42 offset:24576
    ds_read_b64_tr_b16 a[74:75], v43 offset:26624
    v_add_f32 v165, v165, v181
    v_add_f32 v166, v166, v182
    v_add_f32 v167, v167, v183
    v_add_f32 v168, v168, v184
    v_add_f32 v169, v169, v185
    v_mfma_f32_32x32x16_bf16 v[128:143], a[40:43], a[8:11], v[128:143]
    ds_read_b64_tr_b16 a[80:81], v44 offset:24576
    ds_read_b64_tr_b16 a[82:83], v45 offset:26624
    v_add_f32 v170, v170, v186
    v_add_f32 v171, v171, v187
    v_add_f32 v172, v172, v188
    v_add_f32 v173, v173, v189
    v_add_f32 v174, v174, v190
    v_mfma_f32_32x32x16_bf16 v[128:143], a[44:47], a[12:15], v[128:143]
    ds_read_b64_tr_b16 a[88:89], v46 offset:24576
    ds_read_b64_tr_b16 a[90:91], v47 offset:26624
    v_add_f32 v175, v175, v191
    v_add_f32 v144, v144, v160
    v_add_f32 v145, v145, v161
    v_add_f32 v146, v146, v162
    v_add_f32 v147, v147, v163
    v_mfma_f32_32x32x16_bf16 v[128:143], a[48:51], a[16:19], v[128:143]
    ds_read_b64_tr_b16 a[68:69], v40 offset:28672
    ds_read_b64_tr_b16 a[70:71], v41 offset:30720
    v_add_f32 v148, v148, v164
    v_add_f32 v149, v149, v165
    v_add_f32 v150, v150, v166
    v_add_f32 v151, v151, v167
    v_add_f32 v152, v152, v168
    v_mfma_f32_32x32x16_bf16 v[128:143], a[52:55], a[20:23], v[128:143]
    ds_read_b64_tr_b16 a[76:77], v42 offset:28672
    ds_read_b64_tr_b16 a[78:79], v43 offset:30720
    v_add_f32 v153, v153, v169
    v_add_f32 v154, v154, v170
    v_add_f32 v155, v155, v171
    v_add_f32 v156, v156, v172
    v_add_f32 v157, v157, v173
    v_mfma_f32_32x32x16_bf16 v[128:143], a[56:59], a[24:27], v[128:143]
    ds_read_b64_tr_b16 a[84:85], v44 offset:28672
    ds_read_b64_tr_b16 a[86:87], v45 offset:30720
    v_add_f32 v158, v158, v174
    v_add_f32 v159, v159, v175
    v_max3_f32 v218, v144, v145, v146
    v_max3_f32 v219, v147, v148, v149
    v_max3_f32 v220, v150, v151, v152
    v_mfma_f32_32x32x16_bf16 v[128:143], a[60:63], a[28:31], v[128:143]
    ds_read_b64_tr_b16 a[92:93], v46 offset:28672
    ds_read_b64_tr_b16 a[94:95], v47 offset:30720
    v_max3_f32 v221, v153, v154, v155
    v_max3_f32 v218, v218, v156, v157
    v_max3_f32 v219, v219, v158, v159
    v_max3_f32 v218, v218, v219, v220
    v_max_f32 v218, v218, v221
    v_mov_b32 v219, v218
    s_nop 1
    v_permlane32_swap_b32 v218, v219
    v_max3_f32 v218, v218, v219, v216
    v_sub_f32 v220, v216, v218
    v_mov_b32 v216, v218
    v_exp_f32 v220, v220
    v_sub_f32 v192, v144, v218
    v_sub_f32 v193, v145, v218
    buffer_load_dwordx4 a[172:175], v48, s[36:39], s99 offen offset:3456 nt
    s_add_u32 s99, s99, 4608
    v_sub_f32 v194, v146, v218
    v_sub_f32 v195, v147, v218
    v_sub_f32 v196, v148, v218
    v_sub_f32 v197, v149, v218
    v_sub_f32 v198, v150, v218
    buffer_load_dwordx4 a[176:179], v48, s[36:39], s99 offen offset:0 nt
    v_sub_f32 v199, v151, v218
    v_sub_f32 v200, v152, v218
    v_sub_f32 v201, v153, v218
    v_sub_f32 v202, v154, v218
    v_sub_f32 v203, v155, v218
    v_sub_f32 v204, v156, v218
    v_sub_f32 v205, v157, v218
    v_sub_f32 v206, v158, v218
    v_sub_f32 v207, v159, v218
    ds_write_b128 v28, v[128:131] offset:0
    v_exp_f32 v192, v192
    v_exp_f32 v193, v193
    v_exp_f32 v194, v194
    v_exp_f32 v195, v195
    ds_write_b128 v28, v[132:135] offset:1024
    v_exp_f32 v196, v196
    v_exp_f32 v197, v197
    v_exp_f32 v198, v198
    v_exp_f32 v199, v199
    ds_write_b128 v28, v[136:139] offset:2048
    v_exp_f32 v200, v200
    v_exp_f32 v201, v201
    v_exp_f32 v202, v202
    v_exp_f32 v203, v203
    ds_write_b128 v28, v[140:143] offset:3072
    v_exp_f32 v204, v204
    v_exp_f32 v205, v205
    v_exp_f32 v206, v206
    v_exp_f32 v207, v207
    v_mul_f32 v217, v217, v220
    v_cvt_pk_bf16_f32 v208, v192, v193
    v_cvt_pk_bf16_f32 v209, v194, v195
    v_cvt_pk_bf16_f32 v210, v196, v197
    v_cvt_pk_bf16_f32 v211, v198, v199
    v_cvt_pk_bf16_f32 v212, v200, v201
    v_cvt_pk_bf16_f32 v213, v202, v203
    v_cvt_pk_bf16_f32 v214, v204, v205
    v_cvt_pk_bf16_f32 v215, v206, v207
    v_mul_f32 v64, v64, v220
    v_mul_f32 v65, v65, v220
    v_mul_f32 v66, v66, v220
    v_mul_f32 v67, v67, v220
    v_mul_f32 v68, v68, v220
    v_mul_f32 v69, v69, v220
    v_mul_f32 v70, v70, v220
    v_mul_f32 v71, v71, v220
    v_mul_f32 v72, v72, v220
    v_mul_f32 v73, v73, v220
    v_mul_f32 v74, v74, v220
    v_mul_f32 v75, v75, v220
    v_mul_f32 v76, v76, v220
    v_mul_f32 v77, v77, v220
    v_mul_f32 v78, v78, v220
    v_mul_f32 v79, v79, v220
    s_waitcnt lgkmcnt(0)
    s_barrier
    v_mfma_f32_32x32x16_bf16 v[64:79], a[64:67], v[208:211], v[64:79]
    ds_read_b128 v[144:147], v29 offset:0
    v_mul_f32 v80, v80, v220
    v_mul_f32 v81, v81, v220
    ds_read_b128 v[148:151], v29 offset:1024
    s_waitcnt vmcnt(44)
    ds_write_b128 v26, a[192:195] offset:8192
    buffer_load_dwordx4 a[180:183], v48, s[36:39], s99 offen offset:1152 nt
    v_mul_f32 v82, v82, v220
    v_mul_f32 v83, v83, v220
    ds_read_b128 v[152:155], v29 offset:2048
    v_mul_f32 v84, v84, v220
    v_mfma_f32_32x32x16_bf16 v[64:79], a[68:71], v[212:215], v[64:79]
    v_mul_f32 v85, v85, v220
    ds_read_b128 v[156:159], v29 offset:3072
    v_mul_f32 v86, v86, v220
    s_waitcnt vmcnt(44)
    ds_write_b128 v26, a[196:199] offset:9216
    v_mul_f32 v87, v87, v220
    v_mul_f32 v88, v88, v220
    v_mul_f32 v89, v89, v220
    v_mul_f32 v90, v90, v220
    v_mul_f32 v91, v91, v220
    v_mul_f32 v92, v92, v220
    v_mul_f32 v93, v93, v220
    v_mul_f32 v94, v94, v220
    v_mul_f32 v95, v95, v220
    s_nop 1
    v_mfma_f32_32x32x16_bf16 v[80:95], a[72:75], v[208:211], v[80:95]
    ds_read_b128 v[160:163], v30 offset:0
    v_mul_f32 v96, v96, v220
    v_mul_f32 v97, v97, v220
    ds_read_b128 v[164:167], v30 offset:1024
    s_waitcnt vmcnt(43)
    ds_write_b128 v26, a[200:203] offset:10240
    buffer_load_dwordx4 a[184:187], v48, s[36:39], s99 offen offset:2304 nt
    v_mul_f32 v98, v98, v220
    v_mul_f32 v99, v99, v220
    ds_read_b128 v[168:171], v30 offset:2048
    v_mul_f32 v100, v100, v220
    v_mfma_f32_32x32x16_bf16 v[80:95], a[76:79], v[212:215], v[80:95]
    v_mul_f32 v101, v101, v220
    ds_read_b128 v[172:175], v30 offset:3072
    v_mul_f32 v102, v102, v220
    s_waitcnt vmcnt(43)
    ds_write_b128 v26, a[204:207] offset:11264
    v_mul_f32 v103, v103, v220
    v_mul_f32 v104, v104, v220
    v_mul_f32 v105, v105, v220
    v_mul_f32 v106, v106, v220
    v_mul_f32 v107, v107, v220
    v_mul_f32 v108, v108, v220
    v_mul_f32 v109, v109, v220
    v_mul_f32 v110, v110, v220
    v_mul_f32 v111, v111, v220
    s_nop 1
    v_mfma_f32_32x32x16_bf16 v[96:111], a[80:83], v[208:211], v[96:111]
    ds_read_b128 v[176:179], v31 offset:0
    v_mul_f32 v112, v112, v220
    v_mul_f32 v113, v113, v220
    ds_read_b128 v[180:183], v31 offset:1024
    s_waitcnt vmcnt(42)
    ds_write_b128 v26, a[208:211] offset:12288
    v_mul_f32 v114, v114, v220
    v_mul_f32 v115, v115, v220
    ds_read_b128 v[184:187], v31 offset:2048
    v_mul_f32 v116, v116, v220
    v_mfma_f32_32x32x16_bf16 v[96:111], a[84:87], v[212:215], v[96:111]
    v_mul_f32 v117, v117, v220
    ds_read_b128 v[188:191], v31 offset:3072
    v_mul_f32 v118, v118, v220
    s_waitcnt vmcnt(41)
    ds_write_b128 v26, a[212:215] offset:13312
    buffer_load_dwordx4 a[188:191], v48, s[36:39], s99 offen offset:3456 nt
    s_add_u32 s99, s99, 32256
    v_mul_f32 v119, v119, v220
    v_mul_f32 v120, v120, v220
    v_mul_f32 v121, v121, v220
    v_mul_f32 v122, v122, v220
    v_mul_f32 v123, v123, v220
    v_mul_f32 v124, v124, v220
    v_mul_f32 v125, v125, v220
    v_mul_f32 v126, v126, v220
    v_mul_f32 v127, v127, v220
    s_nop 1
    v_mfma_f32_32x32x16_bf16 v[112:127], a[88:91], v[208:211], v[112:127]
    v_add_f32 v192, v192, v200
    v_add_f32 v193, v193, v201
    v_add_f32 v194, v194, v202
    v_add_f32 v195, v195, v203
    s_waitcnt vmcnt(41)
    ds_write_b128 v26, a[216:219] offset:14336
    v_add_f32 v196, v196, v204
    v_add_f32 v197, v197, v205
    v_add_f32 v198, v198, v206
    v_add_f32 v199, v199, v207
    v_mfma_f32_32x32x16_bf16 v[112:127], a[92:95], v[212:215], v[112:127]
    v_add_f32 v192, v192, v196
    v_add_f32 v193, v193, v197
    v_add_f32 v194, v194, v198
    s_waitcnt vmcnt(40)
    ds_write_b128 v26, a[220:223] offset:15360
    v_add_f32 v195, v195, v199
    v_add_f32 v192, v192, v193
    v_add_f32 v194, v194, v195
    v_add_f32 v192, v192, v194
    v_add_f32 v217, v217, v192
    ds_read_b128 a[32:35], v32 offset:8192
    ds_read_b128 a[36:39], v33 offset:8192
    ds_read_b128 a[40:43], v34 offset:8192
    ds_read_b128 a[44:47], v35 offset:8192
    ds_read_b128 a[48:51], v36 offset:8192
    ds_read_b128 a[52:55], v37 offset:8192
    ds_read_b128 a[56:59], v38 offset:8192
    ds_read_b128 a[60:63], v39 offset:8192
    s_waitcnt lgkmcnt(8)
    v_add_f32 v144, v144, v128
    v_add_f32 v145, v145, v129
    v_add_f32 v146, v146, v130
    v_add_f32 v147, v147, v131
    buffer_load_dwordx4 a[192:195], v48, s[36:39], s99 offen offset:0 nt
    v_add_f32 v148, v148, v132
    v_add_f32 v149, v149, v133
    v_add_f32 v150, v150, v134
    v_add_f32 v151, v151, v135
    v_add_f32 v152, v152, v136
    v_add_f32 v153, v153, v137
    v_add_f32 v154, v154, v138
    v_add_f32 v155, v155, v139
    v_add_f32 v156, v156, v140
    v_add_f32 v157, v157, v141
    v_add_f32 v158, v158, v142
    v_add_f32 v159, v159, v143
    s_waitcnt lgkmcnt(0)
    v_mfma_f32_32x32x16_bf16 v[128:143], a[32:35], a[0:3], 0
    ds_read_b64_tr_b16 a[64:65], v40 offset:0
    ds_read_b64_tr_b16 a[66:67], v41 offset:2048
    v_add_f32 v160, v160, v176
    v_add_f32 v161, v161, v177
    v_add_f32 v162, v162, v178
    v_add_f32 v163, v163, v179
    v_add_f32 v164, v164, v180
    v_mfma_f32_32x32x16_bf16 v[128:143], a[36:39], a[4:7], v[128:143]
    ds_read_b64_tr_b16 a[72:73], v42 offset:0
    ds_read_b64_tr_b16 a[74:75], v43 offset:2048
    v_add_f32 v165, v165, v181
    v_add_f32 v166, v166, v182
    v_add_f32 v167, v167, v183
    v_add_f32 v168, v168, v184
    v_add_f32 v169, v169, v185
    v_mfma_f32_32x32x16_bf16 v[128:143], a[40:43], a[8:11], v[128:143]
    ds_read_b64_tr_b16 a[80:81], v44 offset:0
    ds_read_b64_tr_b16 a[82:83], v45 offset:2048
    v_add_f32 v170, v170, v186
    v_add_f32 v171, v171, v187
    v_add_f32 v172, v172, v188
    v_add_f32 v173, v173, v189
    v_add_f32 v174, v174, v190
    v_mfma_f32_32x32x16_bf16 v[128:143], a[44:47], a[12:15], v[128:143]
    ds_read_b64_tr_b16 a[88:89], v46 offset:0
    ds_read_b64_tr_b16 a[90:91], v47 offset:2048
    v_add_f32 v175, v175, v191
    v_add_f32 v144, v144, v160
    v_add_f32 v145, v145, v161
    v_add_f32 v146, v146, v162
    v_add_f32 v147, v147, v163
    v_mfma_f32_32x32x16_bf16 v[128:143], a[48:51], a[16:19], v[128:143]
    ds_read_b64_tr_b16 a[68:69], v40 offset:4096
    ds_read_b64_tr_b16 a[70:71], v41 offset:6144
    v_add_f32 v148, v148, v164
    v_add_f32 v149, v149, v165
    v_add_f32 v150, v150, v166
    v_add_f32 v151, v151, v167
    v_add_f32 v152, v152, v168
    v_mfma_f32_32x32x16_bf16 v[128:143], a[52:55], a[20:23], v[128:143]
    ds_read_b64_tr_b16 a[76:77], v42 offset:4096
    ds_read_b64_tr_b16 a[78:79], v43 offset:6144
    v_add_f32 v153, v153, v169
    v_add_f32 v154, v154, v170
    v_add_f32 v155, v155, v171
    v_add_f32 v156, v156, v172
    v_add_f32 v157, v157, v173
    v_mfma_f32_32x32x16_bf16 v[128:143], a[56:59], a[24:27], v[128:143]
    ds_read_b64_tr_b16 a[84:85], v44 offset:4096
    ds_read_b64_tr_b16 a[86:87], v45 offset:6144
    v_add_f32 v158, v158, v174
    v_add_f32 v159, v159, v175
    v_max3_f32 v218, v144, v145, v146
    v_max3_f32 v219, v147, v148, v149
    v_max3_f32 v220, v150, v151, v152
    v_mfma_f32_32x32x16_bf16 v[128:143], a[60:63], a[28:31], v[128:143]
    ds_read_b64_tr_b16 a[92:93], v46 offset:4096
    ds_read_b64_tr_b16 a[94:95], v47 offset:6144
    v_max3_f32 v221, v153, v154, v155
    v_max3_f32 v218, v218, v156, v157
    v_max3_f32 v219, v219, v158, v159
    v_max3_f32 v218, v218, v219, v220
    v_max_f32 v218, v218, v221
    v_mov_b32 v219, v218
    s_nop 1
    v_permlane32_swap_b32 v218, v219
    v_max3_f32 v218, v218, v219, v216
    v_sub_f32 v220, v216, v218
    v_mov_b32 v216, v218
    v_exp_f32 v220, v220
    v_sub_f32 v192, v144, v218
    v_sub_f32 v193, v145, v218
    buffer_load_dwordx4 a[196:199], v48, s[36:39], s99 offen offset:1152 nt
    v_sub_f32 v194, v146, v218
    v_sub_f32 v195, v147, v218
    v_sub_f32 v196, v148, v218
    v_sub_f32 v197, v149, v218
    v_sub_f32 v198, v150, v218
    buffer_load_dwordx4 a[200:203], v48, s[36:39], s99 offen offset:2304 nt
    v_sub_f32 v199, v151, v218
    v_sub_f32 v200, v152, v218
    v_sub_f32 v201, v153, v218
    v_sub_f32 v202, v154, v218
    v_sub_f32 v203, v155, v218
    v_sub_f32 v204, v156, v218
    v_sub_f32 v205, v157, v218
    v_sub_f32 v206, v158, v218
    v_sub_f32 v207, v159, v218
    ds_write_b128 v28, v[128:131] offset:16384
    v_exp_f32 v192, v192
    v_exp_f32 v193, v193
    v_exp_f32 v194, v194
    v_exp_f32 v195, v195
    ds_write_b128 v28, v[132:135] offset:17408
    v_exp_f32 v196, v196
    v_exp_f32 v197, v197
    v_exp_f32 v198, v198
    v_exp_f32 v199, v199
    ds_write_b128 v28, v[136:139] offset:18432
    v_exp_f32 v200, v200
    v_exp_f32 v201, v201
    v_exp_f32 v202, v202
    v_exp_f32 v203, v203
    ds_write_b128 v28, v[140:143] offset:19456
    v_exp_f32 v204, v204
    v_exp_f32 v205, v205
    v_exp_f32 v206, v206
    v_exp_f32 v207, v207
    v_mul_f32 v217, v217, v220
    v_cvt_pk_bf16_f32 v208, v192, v193
    v_cvt_pk_bf16_f32 v209, v194, v195
    v_cvt_pk_bf16_f32 v210, v196, v197
    v_cvt_pk_bf16_f32 v211, v198, v199
    v_cvt_pk_bf16_f32 v212, v200, v201
    v_cvt_pk_bf16_f32 v213, v202, v203
    v_cvt_pk_bf16_f32 v214, v204, v205
    v_cvt_pk_bf16_f32 v215, v206, v207
    v_mul_f32 v64, v64, v220
    v_mul_f32 v65, v65, v220
    v_mul_f32 v66, v66, v220
    v_mul_f32 v67, v67, v220
    v_mul_f32 v68, v68, v220
    v_mul_f32 v69, v69, v220
    v_mul_f32 v70, v70, v220
    v_mul_f32 v71, v71, v220
    v_mul_f32 v72, v72, v220
    v_mul_f32 v73, v73, v220
    v_mul_f32 v74, v74, v220
    v_mul_f32 v75, v75, v220
    v_mul_f32 v76, v76, v220
    v_mul_f32 v77, v77, v220
    v_mul_f32 v78, v78, v220
    v_mul_f32 v79, v79, v220
    s_waitcnt lgkmcnt(0)
    s_barrier
    v_mfma_f32_32x32x16_bf16 v[64:79], a[64:67], v[208:211], v[64:79]
    ds_read_b128 v[144:147], v29 offset:16384
    v_mul_f32 v80, v80, v220
    v_mul_f32 v81, v81, v220
    ds_read_b128 v[148:151], v29 offset:17408
    s_waitcnt vmcnt(42)
    ds_write_b128 v26, a[224:227] offset:16384
    buffer_load_dwordx4 a[204:207], v48, s[36:39], s99 offen offset:3456 nt
    s_add_u32 s99, s99, 4608
    v_mul_f32 v82, v82, v220
    v_mul_f32 v83, v83, v220
    ds_read_b128 v[152:155], v29 offset:18432
    v_mul_f32 v84, v84, v220
    v_mfma_f32_32x32x16_bf16 v[64:79], a[68:71], v[212:215], v[64:79]
    v_mul_f32 v85, v85, v220
    ds_read_b128 v[156:159], v29 offset:19456
    v_mul_f32 v86, v86, v220
    s_waitcnt vmcnt(42)
    ds_write_b128 v26, a[228:231] offset:17408
    v_mul_f32 v87, v87, v220
    v_mul_f32 v88, v88, v220
    v_mul_f32 v89, v89, v220
    v_mul_f32 v90, v90, v220
    v_mul_f32 v91, v91, v220
    v_mul_f32 v92, v92, v220
    v_mul_f32 v93, v93, v220
    v_mul_f32 v94, v94, v220
    v_mul_f32 v95, v95, v220
    s_nop 1
    v_mfma_f32_32x32x16_bf16 v[80:95], a[72:75], v[208:211], v[80:95]
    ds_read_b128 v[160:163], v30 offset:16384
    v_mul_f32 v96, v96, v220
    v_mul_f32 v97, v97, v220
    ds_read_b128 v[164:167], v30 offset:17408
    s_waitcnt vmcnt(41)
    ds_write_b128 v26, a[232:235] offset:18432
    buffer_load_dwordx4 a[208:211], v48, s[36:39], s99 offen offset:0 nt
    v_mul_f32 v98, v98, v220
    v_mul_f32 v99, v99, v220
    ds_read_b128 v[168:171], v30 offset:18432
    v_mul_f32 v100, v100, v220
    v_mfma_f32_32x32x16_bf16 v[80:95], a[76:79], v[212:215], v[80:95]
    v_mul_f32 v101, v101, v220
    ds_read_b128 v[172:175], v30 offset:19456
    v_mul_f32 v102, v102, v220
    s_waitcnt vmcnt(41)
    ds_write_b128 v26, a[236:239] offset:19456
    v_mul_f32 v103, v103, v220
    v_mul_f32 v104, v104, v220
    v_mul_f32 v105, v105, v220
    v_mul_f32 v106, v106, v220
    v_mul_f32 v107, v107, v220
    v_mul_f32 v108, v108, v220
    v_mul_f32 v109, v109, v220
    v_mul_f32 v110, v110, v220
    v_mul_f32 v111, v111, v220
    s_nop 1
    v_mfma_f32_32x32x16_bf16 v[96:111], a[80:83], v[208:211], v[96:111]
    ds_read_b128 v[176:179], v31 offset:16384
    v_mul_f32 v112, v112, v220
    v_mul_f32 v113, v113, v220
    ds_read_b128 v[180:183], v31 offset:17408
    s_waitcnt vmcnt(40)
    ds_write_b128 v26, a[240:243] offset:20480
    v_mul_f32 v114, v114, v220
    v_mul_f32 v115, v115, v220
    ds_read_b128 v[184:187], v31 offset:18432
    v_mul_f32 v116, v116, v220
    v_mfma_f32_32x32x16_bf16 v[96:111], a[84:87], v[212:215], v[96:111]
    v_mul_f32 v117, v117, v220
    ds_read_b128 v[188:191], v31 offset:19456
    v_mul_f32 v118, v118, v220
    s_waitcnt vmcnt(39)
    ds_write_b128 v26, a[244:247] offset:21504
    buffer_load_dwordx4 a[212:215], v48, s[36:39], s99 offen offset:1152 nt
    v_mul_f32 v119, v119, v220
    v_mul_f32 v120, v120, v220
    v_mul_f32 v121, v121, v220
    v_mul_f32 v122, v122, v220
    v_mul_f32 v123, v123, v220
    v_mul_f32 v124, v124, v220
    v_mul_f32 v125, v125, v220
    v_mul_f32 v126, v126, v220
    v_mul_f32 v127, v127, v220
    s_nop 1
    v_mfma_f32_32x32x16_bf16 v[112:127], a[88:91], v[208:211], v[112:127]
    v_add_f32 v192, v192, v200
    v_add_f32 v193, v193, v201
    v_add_f32 v194, v194, v202
    v_add_f32 v195, v195, v203
    s_waitcnt vmcnt(39)
    ds_write_b128 v26, a[248:251] offset:22528
    v_add_f32 v196, v196, v204
    v_add_f32 v197, v197, v205
    v_add_f32 v198, v198, v206
    v_add_f32 v199, v199, v207
    v_mfma_f32_32x32x16_bf16 v[112:127], a[92:95], v[212:215], v[112:127]
    v_add_f32 v192, v192, v196
    v_add_f32 v193, v193, v197
    v_add_f32 v194, v194, v198
    s_waitcnt vmcnt(38)
    ds_write_b128 v26, a[252:255] offset:23552
    v_add_f32 v195, v195, v199
    v_add_f32 v192, v192, v193
    v_add_f32 v194, v194, v195
    v_add_f32 v192, v192, v194
    v_add_f32 v217, v217, v192
    ds_read_b128 a[32:35], v32 offset:16384
    ds_read_b128 a[36:39], v33 offset:16384
    ds_read_b128 a[40:43], v34 offset:16384
    ds_read_b128 a[44:47], v35 offset:16384
    ds_read_b128 a[48:51], v36 offset:16384
    ds_read_b128 a[52:55], v37 offset:16384
    ds_read_b128 a[56:59], v38 offset:16384
    ds_read_b128 a[60:63], v39 offset:16384
    s_waitcnt lgkmcnt(8)
    v_add_f32 v144, v144, v128
    v_add_f32 v145, v145, v129
    v_add_f32 v146, v146, v130
    v_add_f32 v147, v147, v131
    buffer_load_dwordx4 a[216:219], v48, s[36:39], s99 offen offset:2304 nt
    v_add_f32 v148, v148, v132
    v_add_f32 v149, v149, v133
    v_add_f32 v150, v150, v134
    v_add_f32 v151, v151, v135
    v_add_f32 v152, v152, v136
    v_add_f32 v153, v153, v137
    v_add_f32 v154, v154, v138
    v_add_f32 v155, v155, v139
    v_add_f32 v156, v156, v140
    v_add_f32 v157, v157, v141
    v_add_f32 v158, v158, v142
    v_add_f32 v159, v159, v143
    s_waitcnt lgkmcnt(0)
    v_mfma_f32_32x32x16_bf16 v[128:143], a[32:35], a[0:3], 0
    ds_read_b64_tr_b16 a[64:65], v40 offset:8192
    ds_read_b64_tr_b16 a[66:67], v41 offset:10240
    v_add_f32 v160, v160, v176
    v_add_f32 v161, v161, v177
    v_add_f32 v162, v162, v178
    v_add_f32 v163, v163, v179
    v_add_f32 v164, v164, v180
    v_mfma_f32_32x32x16_bf16 v[128:143], a[36:39], a[4:7], v[128:143]
    ds_read_b64_tr_b16 a[72:73], v42 offset:8192
    ds_read_b64_tr_b16 a[74:75], v43 offset:10240
    v_add_f32 v165, v165, v181
    v_add_f32 v166, v166, v182
    v_add_f32 v167, v167, v183
    v_add_f32 v168, v168, v184
    v_add_f32 v169, v169, v185
    v_mfma_f32_32x32x16_bf16 v[128:143], a[40:43], a[8:11], v[128:143]
    ds_read_b64_tr_b16 a[80:81], v44 offset:8192
    ds_read_b64_tr_b16 a[82:83], v45 offset:10240
    v_add_f32 v170, v170, v186
    v_add_f32 v171, v171, v187
    v_add_f32 v172, v172, v188
    v_add_f32 v173, v173, v189
    v_add_f32 v174, v174, v190
    v_mfma_f32_32x32x16_bf16 v[128:143], a[44:47], a[12:15], v[128:143]
    ds_read_b64_tr_b16 a[88:89], v46 offset:8192
    ds_read_b64_tr_b16 a[90:91], v47 offset:10240
    v_add_f32 v175, v175, v191
    v_add_f32 v144, v144, v160
    v_add_f32 v145, v145, v161
    v_add_f32 v146, v146, v162
    v_add_f32 v147, v147, v163
    v_mfma_f32_32x32x16_bf16 v[128:143], a[48:51], a[16:19], v[128:143]
    ds_read_b64_tr_b16 a[68:69], v40 offset:12288
    ds_read_b64_tr_b16 a[70:71], v41 offset:14336
    v_add_f32 v148, v148, v164
    v_add_f32 v149, v149, v165
    v_add_f32 v150, v150, v166
    v_add_f32 v151, v151, v167
    v_add_f32 v152, v152, v168
    v_mfma_f32_32x32x16_bf16 v[128:143], a[52:55], a[20:23], v[128:143]
    ds_read_b64_tr_b16 a[76:77], v42 offset:12288
    ds_read_b64_tr_b16 a[78:79], v43 offset:14336
    v_add_f32 v153, v153, v169
    v_add_f32 v154, v154, v170
    v_add_f32 v155, v155, v171
    v_add_f32 v156, v156, v172
    v_add_f32 v157, v157, v173
    v_mfma_f32_32x32x16_bf16 v[128:143], a[56:59], a[24:27], v[128:143]
    ds_read_b64_tr_b16 a[84:85], v44 offset:12288
    ds_read_b64_tr_b16 a[86:87], v45 offset:14336
    v_add_f32 v158, v158, v174
    v_add_f32 v159, v159, v175
    v_max3_f32 v218, v144, v145, v146
    v_max3_f32 v219, v147, v148, v149
    v_max3_f32 v220, v150, v151, v152
    v_mfma_f32_32x32x16_bf16 v[128:143], a[60:63], a[28:31], v[128:143]
    ds_read_b64_tr_b16 a[92:93], v46 offset:12288
    ds_read_b64_tr_b16 a[94:95], v47 offset:14336
    v_max3_f32 v221, v153, v154, v155
    v_max3_f32 v218, v218, v156, v157
    v_max3_f32 v219, v219, v158, v159
    v_max3_f32 v218, v218, v219, v220
    v_max_f32 v218, v218, v221
    v_mov_b32 v219, v218
    s_nop 1
    v_permlane32_swap_b32 v218, v219
    v_max3_f32 v218, v218, v219, v216
    v_sub_f32 v220, v216, v218
    v_mov_b32 v216, v218
    v_exp_f32 v220, v220
    v_sub_f32 v192, v144, v218
    v_sub_f32 v193, v145, v218
    v_sub_f32 v194, v146, v218
    v_sub_f32 v195, v147, v218
    v_sub_f32 v196, v148, v218
    v_sub_f32 v197, v149, v218
    v_sub_f32 v198, v150, v218
    v_sub_f32 v199, v151, v218
    v_sub_f32 v200, v152, v218
    v_sub_f32 v201, v153, v218
    v_sub_f32 v202, v154, v218
    v_sub_f32 v203, v155, v218
    v_sub_f32 v204, v156, v218
    v_sub_f32 v205, v157, v218
    v_sub_f32 v206, v158, v218
    v_sub_f32 v207, v159, v218
    ds_write_b128 v28, v[128:131] offset:0
    v_exp_f32 v192, v192
    v_exp_f32 v193, v193
    v_exp_f32 v194, v194
    v_exp_f32 v195, v195
    ds_write_b128 v28, v[132:135] offset:1024
    v_exp_f32 v196, v196
    v_exp_f32 v197, v197
    v_exp_f32 v198, v198
    v_exp_f32 v199, v199
    ds_write_b128 v28, v[136:139] offset:2048
    v_exp_f32 v200, v200
    v_exp_f32 v201, v201
    v_exp_f32 v202, v202
    v_exp_f32 v203, v203
    ds_write_b128 v28, v[140:143] offset:3072
    v_exp_f32 v204, v204
    v_exp_f32 v205, v205
    v_exp_f32 v206, v206
    v_exp_f32 v207, v207
    v_mul_f32 v217, v217, v220
    v_cvt_pk_bf16_f32 v208, v192, v193
    v_cvt_pk_bf16_f32 v209, v194, v195
    v_cvt_pk_bf16_f32 v210, v196, v197
    v_cvt_pk_bf16_f32 v211, v198, v199
    v_cvt_pk_bf16_f32 v212, v200, v201
    v_cvt_pk_bf16_f32 v213, v202, v203
    v_cvt_pk_bf16_f32 v214, v204, v205
    v_cvt_pk_bf16_f32 v215, v206, v207
    v_mul_f32 v64, v64, v220
    v_mul_f32 v65, v65, v220
    v_mul_f32 v66, v66, v220
    v_mul_f32 v67, v67, v220
    v_mul_f32 v68, v68, v220
    v_mul_f32 v69, v69, v220
    v_mul_f32 v70, v70, v220
    v_mul_f32 v71, v71, v220
    v_mul_f32 v72, v72, v220
    v_mul_f32 v73, v73, v220
    v_mul_f32 v74, v74, v220
    v_mul_f32 v75, v75, v220
    v_mul_f32 v76, v76, v220
    v_mul_f32 v77, v77, v220
    v_mul_f32 v78, v78, v220
    v_mul_f32 v79, v79, v220
    s_waitcnt lgkmcnt(0)
    s_barrier
    v_mfma_f32_32x32x16_bf16 v[64:79], a[64:67], v[208:211], v[64:79]
    ds_read_b128 v[144:147], v29 offset:0
    v_mul_f32 v80, v80, v220
    v_mul_f32 v81, v81, v220
    ds_read_b128 v[148:151], v29 offset:1024
    s_waitcnt vmcnt(38)
    ds_write_b128 v26, v[224:227] offset:24576
    buffer_load_dwordx4 a[220:223], v48, s[36:39], s99 offen offset:3456 nt
    s_add_u32 s99, s99, 32256
    v_mul_f32 v82, v82, v220
    v_mul_f32 v83, v83, v220
    ds_read_b128 v[152:155], v29 offset:2048
    v_mul_f32 v84, v84, v220
    v_mfma_f32_32x32x16_bf16 v[64:79], a[68:71], v[212:215], v[64:79]
    v_mul_f32 v85, v85, v220
    ds_read_b128 v[156:159], v29 offset:3072
    v_mul_f32 v86, v86, v220
    s_waitcnt vmcnt(38)
    ds_write_b128 v26, v[228:231] offset:25600
    v_mul_f32 v87, v87, v220
    v_mul_f32 v88, v88, v220
    v_mul_f32 v89, v89, v220
    v_mul_f32 v90, v90, v220
    v_mul_f32 v91, v91, v220
    v_mul_f32 v92, v92, v220
    v_mul_f32 v93, v93, v220
    v_mul_f32 v94, v94, v220
    v_mul_f32 v95, v95, v220
    s_nop 1
    v_mfma_f32_32x32x16_bf16 v[80:95], a[72:75], v[208:211], v[80:95]
    ds_read_b128 v[160:163], v30 offset:0
    v_mul_f32 v96, v96, v220
    v_mul_f32 v97, v97, v220
    ds_read_b128 v[164:167], v30 offset:1024
    s_waitcnt vmcnt(37)
    ds_write_b128 v26, v[232:235] offset:26624
    v_mul_f32 v98, v98, v220
    v_mul_f32 v99, v99, v220
    ds_read_b128 v[168:171], v30 offset:2048
    v_mul_f32 v100, v100, v220
    v_mfma_f32_32x32x16_bf16 v[80:95], a[76:79], v[212:215], v[80:95]
    v_mul_f32 v101, v101, v220
    ds_read_b128 v[172:175], v30 offset:3072
    v_mul_f32 v102, v102, v220
    s_waitcnt vmcnt(36)
    ds_write_b128 v26, v[236:239] offset:27648
    v_mul_f32 v103, v103, v220
    v_mul_f32 v104, v104, v220
    v_mul_f32 v105, v105, v220
    v_mul_f32 v106, v106, v220
    v_mul_f32 v107, v107, v220
    v_mul_f32 v108, v108, v220
    v_mul_f32 v109, v109, v220
    v_mul_f32 v110, v110, v220
    v_mul_f32 v111, v111, v220
    s_nop 1
    v_mfma_f32_32x32x16_bf16 v[96:111], a[80:83], v[208:211], v[96:111]
    ds_read_b128 v[176:179], v31 offset:0
    v_mul_f32 v112, v112, v220
    v_mul_f32 v113, v113, v220
    ds_read_b128 v[180:183], v31 offset:1024
    s_waitcnt vmcnt(35)
    ds_write_b128 v26, v[240:243] offset:28672
    v_mul_f32 v114, v114, v220
    v_mul_f32 v115, v115, v220
    ds_read_b128 v[184:187], v31 offset:2048
    v_mul_f32 v116, v116, v220
    v_mfma_f32_32x32x16_bf16 v[96:111], a[84:87], v[212:215], v[96:111]
    v_mul_f32 v117, v117, v220
    ds_read_b128 v[188:191], v31 offset:3072
    v_mul_f32 v118, v118, v220
    s_waitcnt vmcnt(34)
    ds_write_b128 v26, v[244:247] offset:29696
    v_mul_f32 v119, v119, v220
    v_mul_f32 v120, v120, v220
    v_mul_f32 v121, v121, v220
    v_mul_f32 v122, v122, v220
    v_mul_f32 v123, v123, v220
    v_mul_f32 v124, v124, v220
    v_mul_f32 v125, v125, v220
    v_mul_f32 v126, v126, v220
    v_mul_f32 v127, v127, v220
    s_nop 1
    v_mfma_f32_32x32x16_bf16 v[112:127], a[88:91], v[208:211], v[112:127]
    v_add_f32 v192, v192, v200
    v_add_f32 v193, v193, v201
    v_add_f32 v194, v194, v202
    v_add_f32 v195, v195, v203
    s_waitcnt vmcnt(33)
    ds_write_b128 v26, v[248:251] offset:30720
    v_add_f32 v196, v196, v204
    v_add_f32 v197, v197, v205
    v_add_f32 v198, v198, v206
    v_add_f32 v199, v199, v207
    v_mfma_f32_32x32x16_bf16 v[112:127], a[92:95], v[212:215], v[112:127]
    v_add_f32 v192, v192, v196
    v_add_f32 v193, v193, v197
    v_add_f32 v194, v194, v198
    s_waitcnt vmcnt(32)
    ds_write_b128 v26, v[252:255] offset:31744
    v_add_f32 v195, v195, v199
    v_add_f32 v192, v192, v193
    v_add_f32 v194, v194, v195
    v_add_f32 v192, v192, v194
    v_add_f32 v217, v217, v192
    ds_read_b128 a[32:35], v32 offset:24576
    ds_read_b128 a[36:39], v33 offset:24576
    ds_read_b128 a[40:43], v34 offset:24576
    ds_read_b128 a[44:47], v35 offset:24576
    ds_read_b128 a[48:51], v36 offset:24576
    ds_read_b128 a[52:55], v37 offset:24576
    ds_read_b128 a[56:59], v38 offset:24576
    ds_read_b128 a[60:63], v39 offset:24576
    s_waitcnt lgkmcnt(8)
    v_add_f32 v144, v144, v128
    v_add_f32 v145, v145, v129
    v_add_f32 v146, v146, v130
    v_add_f32 v147, v147, v131
    v_add_f32 v148, v148, v132
    v_add_f32 v149, v149, v133
    v_add_f32 v150, v150, v134
    v_add_f32 v151, v151, v135
    v_add_f32 v152, v152, v136
    v_add_f32 v153, v153, v137
    v_add_f32 v154, v154, v138
    v_add_f32 v155, v155, v139
    v_add_f32 v156, v156, v140
    v_add_f32 v157, v157, v141
    v_add_f32 v158, v158, v142
    v_add_f32 v159, v159, v143
    s_waitcnt lgkmcnt(0)
    v_mfma_f32_32x32x16_bf16 v[128:143], a[32:35], a[0:3], 0
    ds_read_b64_tr_b16 a[64:65], v40 offset:16384
    ds_read_b64_tr_b16 a[66:67], v41 offset:18432
    v_add_f32 v160, v160, v176
    v_add_f32 v161, v161, v177
    v_add_f32 v162, v162, v178
    v_add_f32 v163, v163, v179
    v_add_f32 v164, v164, v180
    v_mfma_f32_32x32x16_bf16 v[128:143], a[36:39], a[4:7], v[128:143]
    ds_read_b64_tr_b16 a[72:73], v42 offset:16384
    ds_read_b64_tr_b16 a[74:75], v43 offset:18432
    v_add_f32 v165, v165, v181
    v_add_f32 v166, v166, v182
    v_add_f32 v167, v167, v183
    v_add_f32 v168, v168, v184
    v_add_f32 v169, v169, v185
    v_mfma_f32_32x32x16_bf16 v[128:143], a[40:43], a[8:11], v[128:143]
    ds_read_b64_tr_b16 a[80:81], v44 offset:16384
    ds_read_b64_tr_b16 a[82:83], v45 offset:18432
    v_add_f32 v170, v170, v186
    v_add_f32 v171, v171, v187
    v_add_f32 v172, v172, v188
    v_add_f32 v173, v173, v189
    v_add_f32 v174, v174, v190
    v_mfma_f32_32x32x16_bf16 v[128:143], a[44:47], a[12:15], v[128:143]
    ds_read_b64_tr_b16 a[88:89], v46 offset:16384
    ds_read_b64_tr_b16 a[90:91], v47 offset:18432
    v_add_f32 v175, v175, v191
    v_add_f32 v144, v144, v160
    v_add_f32 v145, v145, v161
    v_add_f32 v146, v146, v162
    v_add_f32 v147, v147, v163
    v_mfma_f32_32x32x16_bf16 v[128:143], a[48:51], a[16:19], v[128:143]
    ds_read_b64_tr_b16 a[68:69], v40 offset:20480
    ds_read_b64_tr_b16 a[70:71], v41 offset:22528
    v_add_f32 v148, v148, v164
    v_add_f32 v149, v149, v165
    v_add_f32 v150, v150, v166
    v_add_f32 v151, v151, v167
    v_add_f32 v152, v152, v168
    v_mfma_f32_32x32x16_bf16 v[128:143], a[52:55], a[20:23], v[128:143]
    ds_read_b64_tr_b16 a[76:77], v42 offset:20480
    ds_read_b64_tr_b16 a[78:79], v43 offset:22528
    v_add_f32 v153, v153, v169
    v_add_f32 v154, v154, v170
    v_add_f32 v155, v155, v171
    v_add_f32 v156, v156, v172
    v_add_f32 v157, v157, v173
    v_mfma_f32_32x32x16_bf16 v[128:143], a[56:59], a[24:27], v[128:143]
    ds_read_b64_tr_b16 a[84:85], v44 offset:20480
    ds_read_b64_tr_b16 a[86:87], v45 offset:22528
    v_add_f32 v158, v158, v174
    v_add_f32 v159, v159, v175
    v_max3_f32 v218, v144, v145, v146
    v_max3_f32 v219, v147, v148, v149
    v_max3_f32 v220, v150, v151, v152
    v_mfma_f32_32x32x16_bf16 v[128:143], a[60:63], a[28:31], v[128:143]
    ds_read_b64_tr_b16 a[92:93], v46 offset:20480
    ds_read_b64_tr_b16 a[94:95], v47 offset:22528
    v_max3_f32 v221, v153, v154, v155
    v_max3_f32 v218, v218, v156, v157
    v_max3_f32 v219, v219, v158, v159
    v_max3_f32 v218, v218, v219, v220
    v_max_f32 v218, v218, v221
    v_mov_b32 v219, v218
    s_nop 1
    v_permlane32_swap_b32 v218, v219
    v_max3_f32 v218, v218, v219, v216
    v_sub_f32 v220, v216, v218
    v_mov_b32 v216, v218
    v_exp_f32 v220, v220
    v_sub_f32 v192, v144, v218
    v_sub_f32 v193, v145, v218
    v_sub_f32 v194, v146, v218
    v_sub_f32 v195, v147, v218
    v_sub_f32 v196, v148, v218
    v_sub_f32 v197, v149, v218
    v_sub_f32 v198, v150, v218
    v_sub_f32 v199, v151, v218
    v_sub_f32 v200, v152, v218
    v_sub_f32 v201, v153, v218
    v_sub_f32 v202, v154, v218
    v_sub_f32 v203, v155, v218
    v_sub_f32 v204, v156, v218
    v_sub_f32 v205, v157, v218
    v_sub_f32 v206, v158, v218
    v_sub_f32 v207, v159, v218
    ds_write_b128 v28, v[128:131] offset:16384
    v_exp_f32 v192, v192
    v_exp_f32 v193, v193
    v_exp_f32 v194, v194
    v_exp_f32 v195, v195
    ds_write_b128 v28, v[132:135] offset:17408
    v_exp_f32 v196, v196
    v_exp_f32 v197, v197
    v_exp_f32 v198, v198
    v_exp_f32 v199, v199
    ds_write_b128 v28, v[136:139] offset:18432
    v_exp_f32 v200, v200
    v_exp_f32 v201, v201
    v_exp_f32 v202, v202
    v_exp_f32 v203, v203
    ds_write_b128 v28, v[140:143] offset:19456
    v_exp_f32 v204, v204
    v_exp_f32 v205, v205
    v_exp_f32 v206, v206
    v_exp_f32 v207, v207
    v_mul_f32 v217, v217, v220
    v_cvt_pk_bf16_f32 v208, v192, v193
    v_cvt_pk_bf16_f32 v209, v194, v195
    v_cvt_pk_bf16_f32 v210, v196, v197
    v_cvt_pk_bf16_f32 v211, v198, v199
    v_cvt_pk_bf16_f32 v212, v200, v201
    v_cvt_pk_bf16_f32 v213, v202, v203
    v_cvt_pk_bf16_f32 v214, v204, v205
    v_cvt_pk_bf16_f32 v215, v206, v207
    v_mul_f32 v64, v64, v220
    v_mul_f32 v65, v65, v220
    v_mul_f32 v66, v66, v220
    v_mul_f32 v67, v67, v220
    v_mul_f32 v68, v68, v220
    v_mul_f32 v69, v69, v220
    v_mul_f32 v70, v70, v220
    v_mul_f32 v71, v71, v220
    v_mul_f32 v72, v72, v220
    v_mul_f32 v73, v73, v220
    v_mul_f32 v74, v74, v220
    v_mul_f32 v75, v75, v220
    v_mul_f32 v76, v76, v220
    v_mul_f32 v77, v77, v220
    v_mul_f32 v78, v78, v220
    v_mul_f32 v79, v79, v220
    s_waitcnt lgkmcnt(0)
    s_barrier
    v_mfma_f32_32x32x16_bf16 v[64:79], a[64:67], v[208:211], v[64:79]
    ds_read_b128 v[144:147], v29 offset:16384
    v_mul_f32 v80, v80, v220
    v_mul_f32 v81, v81, v220
    ds_read_b128 v[148:151], v29 offset:17408
    v_mul_f32 v82, v82, v220
    v_mul_f32 v83, v83, v220
    ds_read_b128 v[152:155], v29 offset:18432
    v_mul_f32 v84, v84, v220
    v_mfma_f32_32x32x16_bf16 v[64:79], a[68:71], v[212:215], v[64:79]
    v_mul_f32 v85, v85, v220
    ds_read_b128 v[156:159], v29 offset:19456
    v_mul_f32 v86, v86, v220
    v_mul_f32 v87, v87, v220
    v_mul_f32 v88, v88, v220
    v_mul_f32 v89, v89, v220
    v_mul_f32 v90, v90, v220
    v_mul_f32 v91, v91, v220
    v_mul_f32 v92, v92, v220
    v_mul_f32 v93, v93, v220
    v_mul_f32 v94, v94, v220
    v_mul_f32 v95, v95, v220
    s_nop 1
    v_mfma_f32_32x32x16_bf16 v[80:95], a[72:75], v[208:211], v[80:95]
    ds_read_b128 v[160:163], v30 offset:16384
    v_mul_f32 v96, v96, v220
    v_mul_f32 v97, v97, v220
    ds_read_b128 v[164:167], v30 offset:17408
    v_mul_f32 v98, v98, v220
    v_mul_f32 v99, v99, v220
    ds_read_b128 v[168:171], v30 offset:18432
    v_mul_f32 v100, v100, v220
    v_mfma_f32_32x32x16_bf16 v[80:95], a[76:79], v[212:215], v[80:95]
    v_mul_f32 v101, v101, v220
    ds_read_b128 v[172:175], v30 offset:19456
    v_mul_f32 v102, v102, v220
    v_mul_f32 v103, v103, v220
    v_mul_f32 v104, v104, v220
    v_mul_f32 v105, v105, v220
    v_mul_f32 v106, v106, v220
    v_mul_f32 v107, v107, v220
    v_mul_f32 v108, v108, v220
    v_mul_f32 v109, v109, v220
    v_mul_f32 v110, v110, v220
    v_mul_f32 v111, v111, v220
    s_nop 1
    v_mfma_f32_32x32x16_bf16 v[96:111], a[80:83], v[208:211], v[96:111]
    ds_read_b128 v[176:179], v31 offset:16384
    v_mul_f32 v112, v112, v220
    v_mul_f32 v113, v113, v220
    ds_read_b128 v[180:183], v31 offset:17408
    v_mul_f32 v114, v114, v220
    v_mul_f32 v115, v115, v220
    ds_read_b128 v[184:187], v31 offset:18432
    v_mul_f32 v116, v116, v220
    v_mfma_f32_32x32x16_bf16 v[96:111], a[84:87], v[212:215], v[96:111]
    v_mul_f32 v117, v117, v220
    ds_read_b128 v[188:191], v31 offset:19456
    v_mul_f32 v118, v118, v220
    v_mul_f32 v119, v119, v220
    v_mul_f32 v120, v120, v220
    v_mul_f32 v121, v121, v220
    v_mul_f32 v122, v122, v220
    v_mul_f32 v123, v123, v220
    v_mul_f32 v124, v124, v220
    v_mul_f32 v125, v125, v220
    v_mul_f32 v126, v126, v220
    v_mul_f32 v127, v127, v220
    s_nop 1
    v_mfma_f32_32x32x16_bf16 v[112:127], a[88:91], v[208:211], v[112:127]
    v_add_f32 v192, v192, v200
    v_add_f32 v193, v193, v201
    v_add_f32 v194, v194, v202
    v_add_f32 v195, v195, v203
    v_add_f32 v196, v196, v204
    v_add_f32 v197, v197, v205
    v_add_f32 v198, v198, v206
    v_add_f32 v199, v199, v207
    v_mfma_f32_32x32x16_bf16 v[112:127], a[92:95], v[212:215], v[112:127]
    v_add_f32 v192, v192, v196
    v_add_f32 v193, v193, v197
    v_add_f32 v194, v194, v198
    v_add_f32 v195, v195, v199
    v_add_f32 v192, v192, v193
    v_add_f32 v194, v194, v195
    v_add_f32 v192, v192, v194
    v_add_f32 v217, v217, v192
    s_waitcnt lgkmcnt(0)
    v_add_f32 v144, v144, v128
    v_add_f32 v145, v145, v129
    v_add_f32 v146, v146, v130
    v_add_f32 v147, v147, v131
    v_add_f32 v148, v148, v132
    v_add_f32 v149, v149, v133
    v_add_f32 v150, v150, v134
    v_add_f32 v151, v151, v135
    v_add_f32 v152, v152, v136
    v_add_f32 v153, v153, v137
    v_add_f32 v154, v154, v138
    v_add_f32 v155, v155, v139
    v_add_f32 v156, v156, v140
    v_add_f32 v157, v157, v141
    v_add_f32 v158, v158, v142
    v_add_f32 v159, v159, v143
    s_waitcnt lgkmcnt(0)
    ds_read_b64_tr_b16 a[64:65], v40 offset:24576
    ds_read_b64_tr_b16 a[66:67], v41 offset:26624
    v_add_f32 v160, v160, v176
    v_add_f32 v161, v161, v177
    v_add_f32 v162, v162, v178
    v_add_f32 v163, v163, v179
    v_add_f32 v164, v164, v180
    ds_read_b64_tr_b16 a[72:73], v42 offset:24576
    ds_read_b64_tr_b16 a[74:75], v43 offset:26624
    v_add_f32 v165, v165, v181
    v_add_f32 v166, v166, v182
    v_add_f32 v167, v167, v183
    v_add_f32 v168, v168, v184
    v_add_f32 v169, v169, v185
    ds_read_b64_tr_b16 a[80:81], v44 offset:24576
    ds_read_b64_tr_b16 a[82:83], v45 offset:26624
    v_add_f32 v170, v170, v186
    v_add_f32 v171, v171, v187
    v_add_f32 v172, v172, v188
    v_add_f32 v173, v173, v189
    v_add_f32 v174, v174, v190
    ds_read_b64_tr_b16 a[88:89], v46 offset:24576
    ds_read_b64_tr_b16 a[90:91], v47 offset:26624
    v_add_f32 v175, v175, v191
    v_add_f32 v144, v144, v160
    v_add_f32 v145, v145, v161
    v_add_f32 v146, v146, v162
    v_add_f32 v147, v147, v163
    ds_read_b64_tr_b16 a[68:69], v40 offset:28672
    ds_read_b64_tr_b16 a[70:71], v41 offset:30720
    v_add_f32 v148, v148, v164
    v_add_f32 v149, v149, v165
    v_add_f32 v150, v150, v166
    v_add_f32 v151, v151, v167
    v_add_f32 v152, v152, v168
    ds_read_b64_tr_b16 a[76:77], v42 offset:28672
    ds_read_b64_tr_b16 a[78:79], v43 offset:30720
    v_add_f32 v153, v153, v169
    v_add_f32 v154, v154, v170
    v_add_f32 v155, v155, v171
    v_add_f32 v156, v156, v172
    v_add_f32 v157, v157, v173
    ds_read_b64_tr_b16 a[84:85], v44 offset:28672
    ds_read_b64_tr_b16 a[86:87], v45 offset:30720
    v_add_f32 v158, v158, v174
    v_add_f32 v159, v159, v175
    v_max3_f32 v218, v144, v145, v146
    v_max3_f32 v219, v147, v148, v149
    v_max3_f32 v220, v150, v151, v152
    ds_read_b64_tr_b16 a[92:93], v46 offset:28672
    ds_read_b64_tr_b16 a[94:95], v47 offset:30720
    v_max3_f32 v221, v153, v154, v155
    v_max3_f32 v218, v218, v156, v157
    v_max3_f32 v219, v219, v158, v159
    v_max3_f32 v218, v218, v219, v220
    v_max_f32 v218, v218, v221
    v_mov_b32 v219, v218
    s_nop 1
    v_permlane32_swap_b32 v218, v219
    v_max3_f32 v218, v218, v219, v216
    v_sub_f32 v220, v216, v218
    v_mov_b32 v216, v218
    v_exp_f32 v220, v220
    v_sub_f32 v192, v144, v218
    v_sub_f32 v193, v145, v218
    v_sub_f32 v194, v146, v218
    v_sub_f32 v195, v147, v218
    v_sub_f32 v196, v148, v218
    v_sub_f32 v197, v149, v218
    v_sub_f32 v198, v150, v218
    v_sub_f32 v199, v151, v218
    v_sub_f32 v200, v152, v218
    v_sub_f32 v201, v153, v218
    v_sub_f32 v202, v154, v218
    v_sub_f32 v203, v155, v218
    v_sub_f32 v204, v156, v218
    v_sub_f32 v205, v157, v218
    v_sub_f32 v206, v158, v218
    v_sub_f32 v207, v159, v218
    v_exp_f32 v192, v192
    v_exp_f32 v193, v193
    v_exp_f32 v194, v194
    v_exp_f32 v195, v195
    v_exp_f32 v196, v196
    v_exp_f32 v197, v197
    v_exp_f32 v198, v198
    v_exp_f32 v199, v199
    v_exp_f32 v200, v200
    v_exp_f32 v201, v201
    v_exp_f32 v202, v202
    v_exp_f32 v203, v203
    v_exp_f32 v204, v204
    v_exp_f32 v205, v205
    v_exp_f32 v206, v206
    v_exp_f32 v207, v207
    v_mul_f32 v217, v217, v220
    v_cvt_pk_bf16_f32 v208, v192, v193
    v_cvt_pk_bf16_f32 v209, v194, v195
    v_cvt_pk_bf16_f32 v210, v196, v197
    v_cvt_pk_bf16_f32 v211, v198, v199
    v_cvt_pk_bf16_f32 v212, v200, v201
    v_cvt_pk_bf16_f32 v213, v202, v203
    v_cvt_pk_bf16_f32 v214, v204, v205
    v_cvt_pk_bf16_f32 v215, v206, v207
    v_mul_f32 v64, v64, v220
    v_mul_f32 v65, v65, v220
    v_mul_f32 v66, v66, v220
    v_mul_f32 v67, v67, v220
    v_mul_f32 v68, v68, v220
    v_mul_f32 v69, v69, v220
    v_mul_f32 v70, v70, v220
    v_mul_f32 v71, v71, v220
    v_mul_f32 v72, v72, v220
    v_mul_f32 v73, v73, v220
    v_mul_f32 v74, v74, v220
    v_mul_f32 v75, v75, v220
    v_mul_f32 v76, v76, v220
    v_mul_f32 v77, v77, v220
    v_mul_f32 v78, v78, v220
    v_mul_f32 v79, v79, v220
    s_waitcnt lgkmcnt(0)
    s_nop 0
    v_mfma_f32_32x32x16_bf16 v[64:79], a[64:67], v[208:211], v[64:79]
    v_mul_f32 v80, v80, v220
    v_mul_f32 v81, v81, v220
    v_mul_f32 v82, v82, v220
    v_mul_f32 v83, v83, v220
    v_mul_f32 v84, v84, v220
    v_mul_f32 v85, v85, v220
    v_mul_f32 v86, v86, v220
    v_mul_f32 v87, v87, v220
    v_mfma_f32_32x32x16_bf16 v[64:79], a[68:71], v[212:215], v[64:79]
    v_mul_f32 v88, v88, v220
    v_mul_f32 v89, v89, v220
    v_mul_f32 v90, v90, v220
    v_mul_f32 v91, v91, v220
    v_mul_f32 v92, v92, v220
    v_mul_f32 v93, v93, v220
    v_mul_f32 v94, v94, v220
    v_mul_f32 v95, v95, v220
    s_nop 1
    v_mfma_f32_32x32x16_bf16 v[80:95], a[72:75], v[208:211], v[80:95]
    v_mul_f32 v96, v96, v220
    v_mul_f32 v97, v97, v220
    v_mul_f32 v98, v98, v220
    v_mul_f32 v99, v99, v220
    v_mul_f32 v100, v100, v220
    v_mul_f32 v101, v101, v220
    v_mul_f32 v102, v102, v220
    v_mul_f32 v103, v103, v220
    v_mfma_f32_32x32x16_bf16 v[80:95], a[76:79], v[212:215], v[80:95]
    v_mul_f32 v104, v104, v220
    v_mul_f32 v105, v105, v220
    v_mul_f32 v106, v106, v220
    v_mul_f32 v107, v107, v220
    v_mul_f32 v108, v108, v220
    v_mul_f32 v109, v109, v220
    v_mul_f32 v110, v110, v220
    v_mul_f32 v111, v111, v220
    s_nop 1
    v_mfma_f32_32x32x16_bf16 v[96:111], a[80:83], v[208:211], v[96:111]
    v_mul_f32 v112, v112, v220
    v_mul_f32 v113, v113, v220
    v_mul_f32 v114, v114, v220
    v_mul_f32 v115, v115, v220
    v_mul_f32 v116, v116, v220
    v_mul_f32 v117, v117, v220
    v_mul_f32 v118, v118, v220
    v_mul_f32 v119, v119, v220
    v_mfma_f32_32x32x16_bf16 v[96:111], a[84:87], v[212:215], v[96:111]
    v_mul_f32 v120, v120, v220
    v_mul_f32 v121, v121, v220
    v_mul_f32 v122, v122, v220
    v_mul_f32 v123, v123, v220
    v_mul_f32 v124, v124, v220
    v_mul_f32 v125, v125, v220
    v_mul_f32 v126, v126, v220
    v_mul_f32 v127, v127, v220
    s_nop 1
    v_mfma_f32_32x32x16_bf16 v[112:127], a[88:91], v[208:211], v[112:127]
    v_add_f32 v192, v192, v200
    v_add_f32 v193, v193, v201
    v_add_f32 v194, v194, v202
    v_add_f32 v195, v195, v203
    v_add_f32 v196, v196, v204
    v_add_f32 v197, v197, v205
    v_add_f32 v198, v198, v206
    v_add_f32 v199, v199, v207
    v_mfma_f32_32x32x16_bf16 v[112:127], a[92:95], v[212:215], v[112:127]
    v_add_f32 v192, v192, v196
    v_add_f32 v193, v193, v197
    v_add_f32 v194, v194, v198
    v_add_f32 v195, v195, v199
    v_add_f32 v192, v192, v193
    v_add_f32 v194, v194, v195
    v_add_f32 v192, v192, v194
    v_add_f32 v217, v217, v192
    s_waitcnt lgkmcnt(0)
    v_mov_b32 v219, v217
    s_nop 1
    v_permlane32_swap_b32 v217, v219
    v_add_f32 v217, v217, v219
    v_rcp_f32 v220, v217
    v_mul_u32_u24 v5, 272, v24
    v_lshl_add_u32 v5, v25, 3, v5
    v_add_u32 v5, s63, v5
    v_mul_f32 v64, v64, v220
    v_mul_f32 v65, v65, v220
    v_mul_f32 v66, v66, v220
    v_mul_f32 v67, v67, v220
    v_mul_f32 v68, v68, v220
    v_mul_f32 v69, v69, v220
    v_mul_f32 v70, v70, v220
    v_mul_f32 v71, v71, v220
    v_mul_f32 v72, v72, v220
    v_mul_f32 v73, v73, v220
    v_mul_f32 v74, v74, v220
    v_mul_f32 v75, v75, v220
    v_mul_f32 v76, v76, v220
    v_mul_f32 v77, v77, v220
    v_mul_f32 v78, v78, v220
    v_mul_f32 v79, v79, v220
    v_mul_f32 v80, v80, v220
    v_mul_f32 v81, v81, v220
    v_mul_f32 v82, v82, v220
    v_mul_f32 v83, v83, v220
    v_mul_f32 v84, v84, v220
    v_mul_f32 v85, v85, v220
    v_mul_f32 v86, v86, v220
    v_mul_f32 v87, v87, v220
    v_mul_f32 v88, v88, v220
    v_mul_f32 v89, v89, v220
    v_mul_f32 v90, v90, v220
    v_mul_f32 v91, v91, v220
    v_mul_f32 v92, v92, v220
    v_mul_f32 v93, v93, v220
    v_mul_f32 v94, v94, v220
    v_mul_f32 v95, v95, v220
    v_mul_f32 v96, v96, v220
    v_mul_f32 v97, v97, v220
    v_mul_f32 v98, v98, v220
    v_mul_f32 v99, v99, v220
    v_mul_f32 v100, v100, v220
    v_mul_f32 v101, v101, v220
    v_mul_f32 v102, v102, v220
    v_mul_f32 v103, v103, v220
    v_mul_f32 v104, v104, v220
    v_mul_f32 v105, v105, v220
    v_mul_f32 v106, v106, v220
    v_mul_f32 v107, v107, v220
    v_mul_f32 v108, v108, v220
    v_mul_f32 v109, v109, v220
    v_mul_f32 v110, v110, v220
    v_mul_f32 v111, v111, v220
    v_mul_f32 v112, v112, v220
    v_mul_f32 v113, v113, v220
    v_mul_f32 v114, v114, v220
    v_mul_f32 v115, v115, v220
    v_mul_f32 v116, v116, v220
    v_mul_f32 v117, v117, v220
    v_mul_f32 v118, v118, v220
    v_mul_f32 v119, v119, v220
    v_mul_f32 v120, v120, v220
    v_mul_f32 v121, v121, v220
    v_mul_f32 v122, v122, v220
    v_mul_f32 v123, v123, v220
    v_mul_f32 v124, v124, v220
    v_mul_f32 v125, v125, v220
    v_mul_f32 v126, v126, v220
    v_mul_f32 v127, v127, v220
    v_cvt_pk_bf16_f32 v128, v64, v65
    v_cvt_pk_bf16_f32 v129, v66, v67
    v_cvt_pk_bf16_f32 v130, v68, v69
    v_cvt_pk_bf16_f32 v131, v70, v71
    v_cvt_pk_bf16_f32 v132, v72, v73
    v_cvt_pk_bf16_f32 v133, v74, v75
    v_cvt_pk_bf16_f32 v134, v76, v77
    v_cvt_pk_bf16_f32 v135, v78, v79
    v_cvt_pk_bf16_f32 v136, v80, v81
    v_cvt_pk_bf16_f32 v137, v82, v83
    v_cvt_pk_bf16_f32 v138, v84, v85
    v_cvt_pk_bf16_f32 v139, v86, v87
    v_cvt_pk_bf16_f32 v140, v88, v89
    v_cvt_pk_bf16_f32 v141, v90, v91
    v_cvt_pk_bf16_f32 v142, v92, v93
    v_cvt_pk_bf16_f32 v143, v94, v95
    v_cvt_pk_bf16_f32 v144, v96, v97
    v_cvt_pk_bf16_f32 v145, v98, v99
    v_cvt_pk_bf16_f32 v146, v100, v101
    v_cvt_pk_bf16_f32 v147, v102, v103
    v_cvt_pk_bf16_f32 v148, v104, v105
    v_cvt_pk_bf16_f32 v149, v106, v107
    v_cvt_pk_bf16_f32 v150, v108, v109
    v_cvt_pk_bf16_f32 v151, v110, v111
    v_cvt_pk_bf16_f32 v152, v112, v113
    v_cvt_pk_bf16_f32 v153, v114, v115
    v_cvt_pk_bf16_f32 v154, v116, v117
    v_cvt_pk_bf16_f32 v155, v118, v119
    v_cvt_pk_bf16_f32 v156, v120, v121
    v_cvt_pk_bf16_f32 v157, v122, v123
    v_cvt_pk_bf16_f32 v158, v124, v125
    v_cvt_pk_bf16_f32 v159, v126, v127
    v_min_u32 v216, -2, v216
    v_min_u32 v217, -2, v217
    s_nop 0
    v_mov_b32_dpp v218, v216 quad_perm:[1,1,3,3] row_mask:0xf bank_mask:0xf
    v_mov_b32_dpp v219, v217 quad_perm:[1,1,3,3] row_mask:0xf bank_mask:0xf
    ds_write_b64 v5, v[128:129] offset:0
    ds_write_b64 v5, v[130:131] offset:16
    ds_write_b64 v5, v[132:133] offset:32
    ds_write_b64 v5, v[134:135] offset:48
    ds_write_b64 v5, v[136:137] offset:64
    ds_write_b64 v5, v[138:139] offset:80
    ds_write_b64 v5, v[140:141] offset:96
    ds_write_b64 v5, v[142:143] offset:112
    ds_write_b64 v5, v[144:145] offset:128
    ds_write_b64 v5, v[146:147] offset:144
    ds_write_b64 v5, v[148:149] offset:160
    ds_write_b64 v5, v[150:151] offset:176
    ds_write_b64 v5, v[152:153] offset:192
    ds_write_b64 v5, v[154:155] offset:208
    ds_write_b64 v5, v[156:157] offset:224
    ds_write_b64 v5, v[158:159] offset:240
    v_mul_u32_u24 v6, 272, v4
    v_lshl_add_u32 v6, v3, 4, v6
    v_add_u32 v6, s63, v6
    s_waitcnt lgkmcnt(0)
    ds_read_b128 v[64:67], v6 offset:0
    ds_read_b128 v[68:71], v6 offset:1088
    ds_read_b128 v[72:75], v6 offset:2176
    ds_read_b128 v[76:79], v6 offset:3264
    ds_read_b128 v[80:83], v6 offset:4352
    ds_read_b128 v[84:87], v6 offset:5440
    ds_read_b128 v[88:91], v6 offset:6528
    ds_read_b128 v[92:95], v6 offset:7616
    v_lshlrev_b32 v7, 10, v4
    v_lshl_add_u32 v7, v3, 4, v7
    s_lshl_b32 s54, s53, 15
    s_lshl_b32 s55, s3, 8
    s_add_u32 s54, s54, s55
    s_add_u32 s54, s54, 2097152
    s_waitcnt lgkmcnt(7)
    buffer_store_dwordx4 v[64:67], v7, s[44:47], s54 offen sc1
    s_add_u32 s54, s54, 4096
    s_waitcnt lgkmcnt(6)
    buffer_store_dwordx4 v[68:71], v7, s[44:47], s54 offen sc1
    s_add_u32 s54, s54, 4096
    s_waitcnt lgkmcnt(5)
    buffer_store_dwordx4 v[72:75], v7, s[44:47], s54 offen sc1
    s_add_u32 s54, s54, 4096
    s_waitcnt lgkmcnt(4)
    buffer_store_dwordx4 v[76:79], v7, s[44:47], s54 offen sc1
    s_add_u32 s54, s54, 4096
    s_waitcnt lgkmcnt(3)
    buffer_store_dwordx4 v[80:83], v7, s[44:47], s54 offen sc1
    s_add_u32 s54, s54, 4096
    s_waitcnt lgkmcnt(2)
    buffer_store_dwordx4 v[84:87], v7, s[44:47], s54 offen sc1
    s_add_u32 s54, s54, 4096
    s_waitcnt lgkmcnt(1)
    buffer_store_dwordx4 v[88:91], v7, s[44:47], s54 offen sc1
    s_add_u32 s54, s54, 4096
    s_waitcnt lgkmcnt(0)
    buffer_store_dwordx4 v[92:95], v7, s[44:47], s54 offen sc1
    s_add_u32 s54, s54, 4096
    buffer_load_dword a224, v49, s[36:39], s100 offen offset:0 nt
    buffer_load_dword a225, v49, s[36:39], s100 offen offset:1152 nt
    buffer_load_dword a226, v49, s[36:39], s100 offen offset:2304 nt
    buffer_load_dword a227, v49, s[36:39], s100 offen offset:3456 nt
    s_add_u32 s100, s100, 4608
    buffer_load_dword a228, v49, s[36:39], s100 offen offset:0 nt
    buffer_load_dword a229, v49, s[36:39], s100 offen offset:1152 nt
    buffer_load_dword a230, v49, s[36:39], s100 offen offset:2304 nt
    buffer_load_dword a231, v49, s[36:39], s100 offen offset:3456 nt
    s_add_u32 s100, s100, 32256
    v_lshlrev_b32 v5, 3, v1
    s_lshl_b32 s54, s53, 8
    s_add_u32 s54, s54, 3145728
    s_cmp_eq_u32 s3, 0
    s_cselect_b32 s56, 0x55555555, 0
    s_mov_b32 s57, 0
    s_waitcnt vmcnt(8)
    s_barrier
    s_mov_b64 exec, s[56:57]
    buffer_store_dwordx4 v[216:219], v5, s[44:47], s54 offen sc1
    s_mov_b64 exec, -1
    buffer_load_dword a232, v49, s[36:39], s100 offen offset:0 nt
    buffer_load_dword a233, v49, s[36:39], s100 offen offset:1152 nt
    buffer_load_dword a234, v49, s[36:39], s100 offen offset:2304 nt
    buffer_load_dword a235, v49, s[36:39], s100 offen offset:3456 nt
    s_add_u32 s100, s100, 4608
    buffer_load_dword a236, v49, s[36:39], s100 offen offset:0 nt
    buffer_load_dword a237, v49, s[36:39], s100 offen offset:1152 nt
    buffer_load_dword a238, v49, s[36:39], s100 offen offset:2304 nt
    buffer_load_dword a239, v49, s[36:39], s100 offen offset:3456 nt
    s_add_u32 s100, s100, 32256
    buffer_load_dword a240, v49, s[36:39], s100 offen offset:0 nt
    buffer_load_dword a241, v49, s[36:39], s100 offen offset:1152 nt
    buffer_load_dword a242, v49, s[36:39], s100 offen offset:2304 nt
    buffer_load_dword a243, v49, s[36:39], s100 offen offset:3456 nt
    s_add_u32 s100, s100, 4608
    buffer_load_dword a244, v49, s[36:39], s100 offen offset:0 nt
    buffer_load_dword a245, v49, s[36:39], s100 offen offset:1152 nt
    buffer_load_dword a246, v49, s[36:39], s100 offen offset:2304 nt
    buffer_load_dword a247, v49, s[36:39], s100 offen offset:3456 nt
    s_add_u32 s100, s100, 32256
    buffer_load_dword a248, v49, s[36:39], s100 offen offset:0 nt
    buffer_load_dword a249, v49, s[36:39], s100 offen offset:1152 nt
    buffer_load_dword a250, v49, s[36:39], s100 offen offset:2304 nt
    buffer_load_dword a251, v49, s[36:39], s100 offen offset:3456 nt
    s_add_u32 s100, s100, 4608
    buffer_load_dword a252, v49, s[36:39], s100 offen offset:0 nt
    buffer_load_dword a253, v49, s[36:39], s100 offen offset:1152 nt
    buffer_load_dword a254, v49, s[36:39], s100 offen offset:2304 nt
    buffer_load_dword a255, v49, s[36:39], s100 offen offset:3456 nt
    s_add_u32 s100, s100, 32256
    s_waitcnt vmcnt(0)
    v_accvgpr_read_b32 v96, a96
    v_accvgpr_read_b32 v97, a97
    v_accvgpr_read_b32 v98, a98
    v_accvgpr_read_b32 v99, a99
    v_accvgpr_read_b32 v100, a100
    v_accvgpr_read_b32 v101, a101
    v_accvgpr_read_b32 v102, a102
    v_accvgpr_read_b32 v103, a103
    v_accvgpr_read_b32 v104, a104
    v_accvgpr_read_b32 v105, a105
    v_accvgpr_read_b32 v106, a106
    v_accvgpr_read_b32 v107, a107
    v_accvgpr_read_b32 v108, a108
    v_accvgpr_read_b32 v109, a109
    v_accvgpr_read_b32 v110, a110
    v_accvgpr_read_b32 v111, a111
    v_accvgpr_read_b32 v112, a112
    v_accvgpr_read_b32 v113, a113
    v_accvgpr_read_b32 v114, a114
    v_accvgpr_read_b32 v115, a115
    v_accvgpr_read_b32 v116, a116
    v_accvgpr_read_b32 v117, a117
    v_accvgpr_read_b32 v118, a118
    v_accvgpr_read_b32 v119, a119
    v_accvgpr_read_b32 v120, a120
    v_accvgpr_read_b32 v121, a121
    v_accvgpr_read_b32 v122, a122
    v_accvgpr_read_b32 v123, a123
    v_accvgpr_read_b32 v124, a124
    v_accvgpr_read_b32 v125, a125
    v_accvgpr_read_b32 v126, a126
    v_accvgpr_read_b32 v127, a127
    v_accvgpr_read_b32 v128, a128
    v_accvgpr_read_b32 v129, a129
    v_accvgpr_read_b32 v130, a130
    v_accvgpr_read_b32 v131, a131
    v_accvgpr_read_b32 v132, a132
    v_accvgpr_read_b32 v133, a133
    v_accvgpr_read_b32 v134, a134
    v_accvgpr_read_b32 v135, a135
    v_accvgpr_read_b32 v136, a136
    v_accvgpr_read_b32 v137, a137
    v_accvgpr_read_b32 v138, a138
    v_accvgpr_read_b32 v139, a139
    v_accvgpr_read_b32 v140, a140
    v_accvgpr_read_b32 v141, a141
    v_accvgpr_read_b32 v142, a142
    v_accvgpr_read_b32 v143, a143
    v_accvgpr_read_b32 v144, a144
    v_accvgpr_read_b32 v145, a145
    v_accvgpr_read_b32 v146, a146
    v_accvgpr_read_b32 v147, a147
    v_accvgpr_read_b32 v148, a148
    v_accvgpr_read_b32 v149, a149
    v_accvgpr_read_b32 v150, a150
    v_accvgpr_read_b32 v151, a151
    v_accvgpr_read_b32 v152, a152
    v_accvgpr_read_b32 v153, a153
    v_accvgpr_read_b32 v154, a154
    v_accvgpr_read_b32 v155, a155
    v_accvgpr_read_b32 v156, a156
    v_accvgpr_read_b32 v157, a157
    v_accvgpr_read_b32 v158, a158
    v_accvgpr_read_b32 v159, a159
    v_accvgpr_read_b32 v160, a160
    v_accvgpr_read_b32 v161, a161
    v_accvgpr_read_b32 v162, a162
    v_accvgpr_read_b32 v163, a163
    v_accvgpr_read_b32 v164, a164
    v_accvgpr_read_b32 v165, a165
    v_accvgpr_read_b32 v166, a166
    v_accvgpr_read_b32 v167, a167
    v_accvgpr_read_b32 v168, a168
    v_accvgpr_read_b32 v169, a169
    v_accvgpr_read_b32 v170, a170
    v_accvgpr_read_b32 v171, a171
    v_accvgpr_read_b32 v172, a172
    v_accvgpr_read_b32 v173, a173
    v_accvgpr_read_b32 v174, a174
    v_accvgpr_read_b32 v175, a175
    v_accvgpr_read_b32 v176, a176
    v_accvgpr_read_b32 v177, a177
    v_accvgpr_read_b32 v178, a178
    v_accvgpr_read_b32 v179, a179
    v_accvgpr_read_b32 v180, a180
    v_accvgpr_read_b32 v181, a181
    v_accvgpr_read_b32 v182, a182
    v_accvgpr_read_b32 v183, a183
    v_accvgpr_read_b32 v184, a184
    v_accvgpr_read_b32 v185, a185
    v_accvgpr_read_b32 v186, a186
    v_accvgpr_read_b32 v187, a187
    v_accvgpr_read_b32 v188, a188
    v_accvgpr_read_b32 v189, a189
    v_accvgpr_read_b32 v190, a190
    v_accvgpr_read_b32 v191, a191
    v_accvgpr_read_b32 v192, a192
    v_accvgpr_read_b32 v193, a193
    v_accvgpr_read_b32 v194, a194
    v_accvgpr_read_b32 v195, a195
    v_accvgpr_read_b32 v196, a196
    v_accvgpr_read_b32 v197, a197
    v_accvgpr_read_b32 v198, a198
    v_accvgpr_read_b32 v199, a199
    v_accvgpr_read_b32 v200, a200
    v_accvgpr_read_b32 v201, a201
    v_accvgpr_read_b32 v202, a202
    v_accvgpr_read_b32 v203, a203
    v_accvgpr_read_b32 v204, a204
    v_accvgpr_read_b32 v205, a205
    v_accvgpr_read_b32 v206, a206
    v_accvgpr_read_b32 v207, a207
    v_accvgpr_read_b32 v208, a208
    v_accvgpr_read_b32 v209, a209
    v_accvgpr_read_b32 v210, a210
    v_accvgpr_read_b32 v211, a211
    v_accvgpr_read_b32 v212, a212
    v_accvgpr_read_b32 v213, a213
    v_accvgpr_read_b32 v214, a214
    v_accvgpr_read_b32 v215, a215
    v_accvgpr_read_b32 v216, a216
    v_accvgpr_read_b32 v217, a217
    v_accvgpr_read_b32 v218, a218
    v_accvgpr_read_b32 v219, a219
    v_accvgpr_read_b32 v220, a220
    v_accvgpr_read_b32 v221, a221
    v_accvgpr_read_b32 v222, a222
    v_accvgpr_read_b32 v223, a223
    v_accvgpr_read_b32 v224, a224
    v_accvgpr_read_b32 v225, a225
    v_accvgpr_read_b32 v226, a226
    v_accvgpr_read_b32 v227, a227
    v_accvgpr_read_b32 v228, a228
    v_accvgpr_read_b32 v229, a229
    v_accvgpr_read_b32 v230, a230
    v_accvgpr_read_b32 v231, a231
    v_accvgpr_read_b32 v232, a232
    v_accvgpr_read_b32 v233, a233
    v_accvgpr_read_b32 v234, a234
    v_accvgpr_read_b32 v235, a235
    v_accvgpr_read_b32 v236, a236
    v_accvgpr_read_b32 v237, a237
    v_accvgpr_read_b32 v238, a238
    v_accvgpr_read_b32 v239, a239
    v_accvgpr_read_b32 v240, a240
    v_accvgpr_read_b32 v241, a241
    v_accvgpr_read_b32 v242, a242
    v_accvgpr_read_b32 v243, a243
    v_accvgpr_read_b32 v244, a244
    v_accvgpr_read_b32 v245, a245
    v_accvgpr_read_b32 v246, a246
    v_accvgpr_read_b32 v247, a247
    v_accvgpr_read_b32 v248, a248
    v_accvgpr_read_b32 v249, a249
    v_accvgpr_read_b32 v250, a250
    v_accvgpr_read_b32 v251, a251
    v_accvgpr_read_b32 v252, a252
    v_accvgpr_read_b32 v253, a253
    v_accvgpr_read_b32 v254, a254
    v_accvgpr_read_b32 v255, a255
    s_mov_b32 s54, 0x05040100
    s_mov_b32 s55, 0x07060302
    v_perm_b32 v64, v100, v96, s54
    v_perm_b32 v65, v108, v104, s54
    v_perm_b32 v66, v116, v112, s54
    v_perm_b32 v67, v124, v120, s54
    v_perm_b32 v68, v100, v96, s55
    v_perm_b32 v69, v108, v104, s55
    v_perm_b32 v70, v116, v112, s55
    v_perm_b32 v71, v124, v120, s55
    v_perm_b32 v72, v101, v97, s54
    v_perm_b32 v73, v109, v105, s54
    v_perm_b32 v74, v117, v113, s54
    v_perm_b32 v75, v125, v121, s54
    v_perm_b32 v76, v101, v97, s55
    v_perm_b32 v77, v109, v105, s55
    v_perm_b32 v78, v117, v113, s55
    v_perm_b32 v79, v125, v121, s55
    v_perm_b32 v80, v102, v98, s54
    v_perm_b32 v81, v110, v106, s54
    v_perm_b32 v82, v118, v114, s54
    v_perm_b32 v83, v126, v122, s54
    v_perm_b32 v84, v102, v98, s55
    v_perm_b32 v85, v110, v106, s55
    v_perm_b32 v86, v118, v114, s55
    v_perm_b32 v87, v126, v122, s55
    v_perm_b32 v88, v103, v99, s54
    v_perm_b32 v89, v111, v107, s54
    v_perm_b32 v90, v119, v115, s54
    v_perm_b32 v91, v127, v123, s54
    v_perm_b32 v92, v103, v99, s55
    v_perm_b32 v93, v111, v107, s55
    v_perm_b32 v94, v119, v115, s55
    v_perm_b32 v95, v127, v123, s55
    v_perm_b32 v96, v132, v128, s54
    v_perm_b32 v97, v140, v136, s54
    v_perm_b32 v98, v148, v144, s54
    v_perm_b32 v99, v156, v152, s54
    v_perm_b32 v100, v132, v128, s55
    v_perm_b32 v101, v140, v136, s55
    v_perm_b32 v102, v148, v144, s55
    v_perm_b32 v103, v156, v152, s55
    v_perm_b32 v104, v133, v129, s54
    v_perm_b32 v105, v141, v137, s54
    v_perm_b32 v106, v149, v145, s54
    v_perm_b32 v107, v157, v153, s54
    v_perm_b32 v108, v133, v129, s55
    v_perm_b32 v109, v141, v137, s55
    v_perm_b32 v110, v149, v145, s55
    v_perm_b32 v111, v157, v153, s55
    v_perm_b32 v112, v134, v130, s54
    v_perm_b32 v113, v142, v138, s54
    v_perm_b32 v114, v150, v146, s54
    v_perm_b32 v115, v158, v154, s54
    v_perm_b32 v116, v134, v130, s55
    v_perm_b32 v117, v142, v138, s55
    v_perm_b32 v118, v150, v146, s55
    v_perm_b32 v119, v158, v154, s55
    v_perm_b32 v120, v135, v131, s54
    v_perm_b32 v121, v143, v139, s54
    v_perm_b32 v122, v151, v147, s54
    v_perm_b32 v123, v159, v155, s54
    v_perm_b32 v124, v135, v131, s55
    v_perm_b32 v125, v143, v139, s55
    v_perm_b32 v126, v151, v147, s55
    v_perm_b32 v127, v159, v155, s55
    v_perm_b32 v128, v164, v160, s54
    v_perm_b32 v129, v172, v168, s54
    v_perm_b32 v130, v180, v176, s54
    v_perm_b32 v131, v188, v184, s54
    v_perm_b32 v132, v164, v160, s55
    v_perm_b32 v133, v172, v168, s55
    v_perm_b32 v134, v180, v176, s55
    v_perm_b32 v135, v188, v184, s55
    v_perm_b32 v136, v165, v161, s54
    v_perm_b32 v137, v173, v169, s54
    v_perm_b32 v138, v181, v177, s54
    v_perm_b32 v139, v189, v185, s54
    v_perm_b32 v140, v165, v161, s55
    v_perm_b32 v141, v173, v169, s55
    v_perm_b32 v142, v181, v177, s55
    v_perm_b32 v143, v189, v185, s55
    v_perm_b32 v144, v166, v162, s54
    v_perm_b32 v145, v174, v170, s54
    v_perm_b32 v146, v182, v178, s54
    v_perm_b32 v147, v190, v186, s54
    v_perm_b32 v148, v166, v162, s55
    v_perm_b32 v149, v174, v170, s55
    v_perm_b32 v150, v182, v178, s55
    v_perm_b32 v151, v190, v186, s55
    v_perm_b32 v152, v167, v163, s54
    v_perm_b32 v153, v175, v171, s54
    v_perm_b32 v154, v183, v179, s54
    v_perm_b32 v155, v191, v187, s54
    v_perm_b32 v156, v167, v163, s55
    v_perm_b32 v157, v175, v171, s55
    v_perm_b32 v158, v183, v179, s55
    v_perm_b32 v159, v191, v187, s55
    v_perm_b32 v160, v196, v192, s54
    v_perm_b32 v161, v204, v200, s54
    v_perm_b32 v162, v212, v208, s54
    v_perm_b32 v163, v220, v216, s54
    v_perm_b32 v164, v196, v192, s55
    v_perm_b32 v165, v204, v200, s55
    v_perm_b32 v166, v212, v208, s55
    v_perm_b32 v167, v220, v216, s55
    v_perm_b32 v168, v197, v193, s54
    v_perm_b32 v169, v205, v201, s54
    v_perm_b32 v170, v213, v209, s54
    v_perm_b32 v171, v221, v217, s54
    v_perm_b32 v172, v197, v193, s55
    v_perm_b32 v173, v205, v201, s55
    v_perm_b32 v174, v213, v209, s55
    v_perm_b32 v175, v221, v217, s55
    v_perm_b32 v176, v198, v194, s54
    v_perm_b32 v177, v206, v202, s54
    v_perm_b32 v178, v214, v210, s54
    v_perm_b32 v179, v222, v218, s54
    v_perm_b32 v180, v198, v194, s55
    v_perm_b32 v181, v206, v202, s55
    v_perm_b32 v182, v214, v210, s55
    v_perm_b32 v183, v222, v218, s55
    v_perm_b32 v184, v199, v195, s54
    v_perm_b32 v185, v207, v203, s54
    v_perm_b32 v186, v215, v211, s54
    v_perm_b32 v187, v223, v219, s54
    v_perm_b32 v188, v199, v195, s55
    v_perm_b32 v189, v207, v203, s55
    v_perm_b32 v190, v215, v211, s55
    v_perm_b32 v191, v223, v219, s55
    v_perm_b32 v192, v225, v224, s54
    v_perm_b32 v193, v227, v226, s54
    v_perm_b32 v194, v229, v228, s54
    v_perm_b32 v195, v231, v230, s54
    v_perm_b32 v196, v225, v224, s55
    v_perm_b32 v197, v227, v226, s55
    v_perm_b32 v198, v229, v228, s55
    v_perm_b32 v199, v231, v230, s55
    v_perm_b32 v200, v233, v232, s54
    v_perm_b32 v201, v235, v234, s54
    v_perm_b32 v202, v237, v236, s54
    v_perm_b32 v203, v239, v238, s54
    v_perm_b32 v204, v233, v232, s55
    v_perm_b32 v205, v235, v234, s55
    v_perm_b32 v206, v237, v236, s55
    v_perm_b32 v207, v239, v238, s55
    v_perm_b32 v208, v241, v240, s54
    v_perm_b32 v209, v243, v242, s54
    v_perm_b32 v210, v245, v244, s54
    v_perm_b32 v211, v247, v246, s54
    v_perm_b32 v212, v241, v240, s55
    v_perm_b32 v213, v243, v242, s55
    v_perm_b32 v214, v245, v244, s55
    v_perm_b32 v215, v247, v246, s55
    v_perm_b32 v216, v249, v248, s54
    v_perm_b32 v217, v251, v250, s54
    v_perm_b32 v218, v253, v252, s54
    v_perm_b32 v219, v255, v254, s54
    v_perm_b32 v220, v249, v248, s55
    v_perm_b32 v221, v251, v250, s55
    v_perm_b32 v222, v253, v252, s55
    v_perm_b32 v223, v255, v254, s55
    s_mov_b32 s48, s26
    s_mov_b32 s49, s27
    s_mov_b32 s50, 9216
    s_mov_b32 s51, 0x20000
    s_mov_b32 s97, 1069066811
    s_mov_b32 s98, 0xffff0000
    s_lshl_b32 s54, s3, 9
    v_lshl_add_u32 v5, v3, 4, s54
    v_lshl_add_u32 v5, v4, 2, v5
    v_lshrrev_b32 v7, 2, v3
    v_lshlrev_b32 v7, 9, v7
    v_lshl_add_u32 v7, v4, 4, v7
    s_lshr_b32 s55, s52, 2
    s_add_u32 s55, s55, s3
    s_and_b32 s55, s55, 3
    s_and_b32 s54, s52, 3
    s_cmp_eq_u32 s54, s55
    s_cbranch_scc1 L_cshared
    s_lshl_b32 s58, s52, 2
    s_add_u32 s58, s58, s3
    s_lshl_b32 s58, s58, 13
    s_add_u32 s58, s58, 8388608
    s_add_u32 s59, s58, 4096
    v_min_u32 v6, 1, v3
    v_lshl_add_u32 v6, v6, 2, v4
    v_lshlrev_b32 v6, 4, v6
L_light_17:
    buffer_load_dword v236, v6, s[44:47], s59 offen offset:2048 sc1
    s_waitcnt vmcnt(0)
    v_cmp_ne_u32 vcc, -1, v236
    s_nop 0
    s_bcnt1_i32_b64 s54, vcc
    s_cmp_ge_u32 s54, 24
    s_cbranch_scc1 L_heavy_18
    s_sleep 2
    s_sub_u32 s101, s101, 1
    s_cbranch_scc0 L_light_17
    s_mov_b32 s101, 0
L_heavy_18:
    s_mov_b64 s[4:5], -1
    s_mov_b64 s[6:7], -1
    s_mov_b64 s[8:9], -1
L_mpoll_19:
    s_mov_b64 exec, s[4:5]
    buffer_load_dwordx4 v[232:235], v6, s[44:47], s59 offen offset:2048 sc1
    s_mov_b64 exec, s[6:7]
    buffer_load_dwordx4 v[16:19], v2, s[44:47], s58 offen offset:0 sc1
    s_mov_b64 exec, s[8:9]
    buffer_load_dwordx4 v[20:23], v2, s[44:47], s58 offen offset:1024 sc1
    s_mov_b64 exec, -1
    s_waitcnt vmcnt(0)
    v_max3_u32 v236, v232, v233, v234
    v_max3_u32 v237, v16, v17, v18
    v_max3_u32 v238, v20, v21, v22
    v_max_u32 v236, v236, v235
    v_max_u32 v237, v237, v19
    v_max_u32 v238, v238, v23
    v_cmp_eq_u32 s[4:5], -1, v236
    v_cmp_eq_u32 s[6:7], -1, v237
    v_cmp_eq_u32 s[8:9], -1, v238
    s_or_b64 vcc, s[4:5], s[6:7]
    s_or_b64 vcc, vcc, s[8:9]
    s_cbranch_scc0 L_mpollok_20
    s_sub_u32 s101, s101, 1
    s_cbranch_scc0 L_mpoll_19
    s_mov_b32 s101, 0
L_mpollok_20:
    v_cmp_gt_u32 vcc, 2, v3
    v_lshlrev_b32 v40, 16, v16
    s_nop 0
    v_cndmask_b32 v233, 0, v233, vcc
    v_and_b32 v16, s98, v16
    v_max_f32_dpp v234, v234, v234 row_ror:1 row_mask:0xf bank_mask:0xf
    v_lshlrev_b32 v41, 16, v17
    s_nop 0
    v_max_f32_dpp v234, v234, v234 row_ror:2 row_mask:0xf bank_mask:0xf
    v_and_b32 v17, s98, v17
    s_nop 0
    v_max_f32_dpp v234, v234, v234 row_ror:4 row_mask:0xf bank_mask:0xf
    v_lshlrev_b32 v42, 16, v18
    s_nop 0
    v_max_f32_dpp v234, v234, v234 row_ror:8 row_mask:0xf bank_mask:0xf
    v_and_b32 v18, s98, v18
    v_mov_b32 v236, v234
    v_lshlrev_b32 v43, 16, v19
    s_nop 0
    v_permlane16_swap_b32 v234, v236
    v_and_b32 v19, s98, v19
    v_max_f32 v234, v234, v236
    v_lshlrev_b32 v44, 16, v20
    v_mov_b32 v236, v234
    v_and_b32 v20, s98, v20
    s_nop 0
    v_permlane32_swap_b32 v234, v236
    v_lshlrev_b32 v45, 16, v21
    v_max_f32 v234, v234, v236
    v_and_b32 v21, s98, v21
    v_sub_f32 v232, v232, v234
    v_lshlrev_b32 v46, 16, v22
    v_mul_f32 v232, s97, v232
    v_and_b32 v22, s98, v22
    v_exp_f32 v232, v232
    v_lshlrev_b32 v47, 16, v23
    v_mul_f32 v233, v233, v232
    v_and_b32 v23, s98, v23
    s_nop 0
    v_add_f32_dpp v233, v233, v233 row_ror:1 row_mask:0xf bank_mask:0xf
    v_mul_f32_dpp v224, v232, v40 row_newbcast:0 row_mask:0xf bank_mask:0xf
    s_nop 0
    v_add_f32_dpp v233, v233, v233 row_ror:2 row_mask:0xf bank_mask:0xf
    v_mul_f32_dpp v225, v232, v16 row_newbcast:0 row_mask:0xf bank_mask:0xf
    s_nop 0
    v_add_f32_dpp v233, v233, v233 row_ror:4 row_mask:0xf bank_mask:0xf
    v_mul_f32_dpp v226, v232, v41 row_newbcast:0 row_mask:0xf bank_mask:0xf
    s_nop 0
    v_add_f32_dpp v233, v233, v233 row_ror:8 row_mask:0xf bank_mask:0xf
    v_mul_f32_dpp v227, v232, v17 row_newbcast:0 row_mask:0xf bank_mask:0xf
    v_mov_b32 v236, v233
    v_mul_f32_dpp v228, v232, v42 row_newbcast:0 row_mask:0xf bank_mask:0xf
    s_nop 0
    v_permlane16_swap_b32 v233, v236
    v_mul_f32_dpp v229, v232, v18 row_newbcast:0 row_mask:0xf bank_mask:0xf
    v_add_f32 v233, v233, v236
    v_mul_f32_dpp v230, v232, v43 row_newbcast:0 row_mask:0xf bank_mask:0xf
    v_mov_b32 v236, v233
    v_mul_f32_dpp v231, v232, v19 row_newbcast:0 row_mask:0xf bank_mask:0xf
    s_nop 0
    v_permlane32_swap_b32 v233, v236
    v_fmac_f32_dpp v224, v232, v44 row_newbcast:1 row_mask:0xf bank_mask:0xf
    v_add_f32 v233, v233, v236
    v_fmac_f32_dpp v225, v232, v20 row_newbcast:1 row_mask:0xf bank_mask:0xf
    v_rcp_f32 v233, v233
    v_fmac_f32_dpp v226, v232, v45 row_newbcast:1 row_mask:0xf bank_mask:0xf
    v_fmac_f32_dpp v227, v232, v21 row_newbcast:1 row_mask:0xf bank_mask:0xf
    v_fmac_f32_dpp v228, v232, v46 row_newbcast:1 row_mask:0xf bank_mask:0xf
    v_fmac_f32_dpp v229, v232, v22 row_newbcast:1 row_mask:0xf bank_mask:0xf
    v_fmac_f32_dpp v230, v232, v47 row_newbcast:1 row_mask:0xf bank_mask:0xf
    v_fmac_f32_dpp v231, v232, v23 row_newbcast:1 row_mask:0xf bank_mask:0xf
    v_permlane32_swap_b32 v224, v228
    v_permlane32_swap_b32 v225, v229
    v_permlane32_swap_b32 v226, v230
    v_permlane32_swap_b32 v227, v231
    v_add_f32 v224, v224, v228
    v_add_f32 v225, v225, v229
    v_add_f32 v226, v226, v230
    v_add_f32 v227, v227, v231
    s_nop 0
    v_permlane16_swap_b32 v224, v226
    v_permlane16_swap_b32 v225, v227
    v_add_f32 v224, v224, v226
    v_add_f32 v225, v225, v227
    v_mul_f32 v224, v224, v233
    v_mul_f32 v225, v225, v233
    s_branch L_cmerged
L_cshared:
    s_lshl_b32 s58, s52, 2
    s_add_u32 s58, s58, s3
    s_lshl_b32 s58, s58, 13
    s_add_u32 s58, s58, 8388608
    s_add_u32 s59, s58, 4096
    v_min_u32 v6, 5, v3
    v_lshl_add_u32 v6, v6, 2, v4
    v_lshlrev_b32 v6, 4, v6
L_light_21:
    buffer_load_dword v236, v6, s[44:47], s59 offen offset:2048 sc1
    s_waitcnt vmcnt(0)
    v_cmp_ne_u32 vcc, -1, v236
    s_nop 0
    s_bcnt1_i32_b64 s54, vcc
    s_cmp_ge_u32 s54, 24
    s_cbranch_scc1 L_heavy_22
    s_sleep 2
    s_sub_u32 s101, s101, 1
    s_cbranch_scc0 L_light_21
    s_mov_b32 s101, 0
L_heavy_22:
    s_mov_b64 s[4:5], -1
    s_mov_b64 s[6:7], -1
    s_mov_b64 s[8:9], -1
    s_mov_b64 s[10:11], -1
    s_mov_b64 s[12:13], -1
    s_mov_b64 s[14:15], -1
    s_mov_b64 s[16:17], -1
L_mpoll_23:
    s_mov_b64 exec, s[4:5]
    buffer_load_dwordx4 v[232:235], v6, s[44:47], s59 offen offset:2048 sc1
    s_mov_b64 exec, s[6:7]
    buffer_load_dwordx4 v[16:19], v2, s[44:47], s58 offen offset:0 sc1
    s_mov_b64 exec, s[8:9]
    buffer_load_dwordx4 v[20:23], v2, s[44:47], s58 offen offset:1024 sc1
    s_mov_b64 exec, s[10:11]
    buffer_load_dwordx4 v[24:27], v2, s[44:47], s58 offen offset:2048 sc1
    s_mov_b64 exec, s[12:13]
    buffer_load_dwordx4 v[28:31], v2, s[44:47], s58 offen offset:3072 sc1
    s_mov_b64 exec, s[14:15]
    buffer_load_dwordx4 v[32:35], v2, s[44:47], s59 offen offset:0 sc1
    s_mov_b64 exec, s[16:17]
    buffer_load_dwordx4 v[36:39], v2, s[44:47], s59 offen offset:1024 sc1
    s_mov_b64 exec, -1
    s_waitcnt vmcnt(0)
    v_max3_u32 v236, v232, v233, v234
    v_max3_u32 v237, v16, v17, v18
    v_max3_u32 v238, v20, v21, v22
    v_max3_u32 v239, v24, v25, v26
    v_max3_u32 v240, v28, v29, v30
    v_max3_u32 v241, v32, v33, v34
    v_max3_u32 v242, v36, v37, v38
    v_max_u32 v236, v236, v235
    v_max_u32 v237, v237, v19
    v_max_u32 v238, v238, v23
    v_max_u32 v239, v239, v27
    v_max_u32 v240, v240, v31
    v_max_u32 v241, v241, v35
    v_max_u32 v242, v242, v39
    v_cmp_eq_u32 s[4:5], -1, v236
    v_cmp_eq_u32 s[6:7], -1, v237
    v_cmp_eq_u32 s[8:9], -1, v238
    v_cmp_eq_u32 s[10:11], -1, v239
    v_cmp_eq_u32 s[12:13], -1, v240
    v_cmp_eq_u32 s[14:15], -1, v241
    v_cmp_eq_u32 s[16:17], -1, v242
    s_or_b64 vcc, s[4:5], s[6:7]
    s_or_b64 vcc, vcc, s[8:9]
    s_or_b64 vcc, vcc, s[10:11]
    s_or_b64 vcc, vcc, s[12:13]
    s_or_b64 vcc, vcc, s[14:15]
    s_or_b64 vcc, vcc, s[16:17]
    s_cbranch_scc0 L_mpollok_24
    s_sub_u32 s101, s101, 1
    s_cbranch_scc0 L_mpoll_23
    s_mov_b32 s101, 0
L_mpollok_24:
    v_cmp_gt_u32 vcc, 6, v3
    v_lshlrev_b32 v40, 16, v16
    v_and_b32 v16, s98, v16
    v_lshlrev_b32 v41, 16, v17
    v_cndmask_b32 v233, 0, v233, vcc
    v_and_b32 v17, s98, v17
    v_lshlrev_b32 v42, 16, v18
    v_and_b32 v18, s98, v18
    v_max_f32_dpp v234, v234, v234 row_ror:1 row_mask:0xf bank_mask:0xf
    v_lshlrev_b32 v43, 16, v19
    v_and_b32 v19, s98, v19
    v_lshlrev_b32 v44, 16, v20
    v_max_f32_dpp v234, v234, v234 row_ror:2 row_mask:0xf bank_mask:0xf
    v_and_b32 v20, s98, v20
    v_lshlrev_b32 v45, 16, v21
    v_and_b32 v21, s98, v21
    v_max_f32_dpp v234, v234, v234 row_ror:4 row_mask:0xf bank_mask:0xf
    v_lshlrev_b32 v46, 16, v22
    v_and_b32 v22, s98, v22
    v_lshlrev_b32 v47, 16, v23
    v_max_f32_dpp v234, v234, v234 row_ror:8 row_mask:0xf bank_mask:0xf
    v_and_b32 v23, s98, v23
    v_lshlrev_b32 v48, 16, v24
    v_and_b32 v24, s98, v24
    v_mov_b32 v236, v234
    v_lshlrev_b32 v49, 16, v25
    v_and_b32 v25, s98, v25
    v_lshlrev_b32 v50, 16, v26
    v_permlane16_swap_b32 v234, v236
    v_and_b32 v26, s98, v26
    v_lshlrev_b32 v51, 16, v27
    v_and_b32 v27, s98, v27
    v_max_f32 v234, v234, v236
    v_lshlrev_b32 v52, 16, v28
    v_and_b32 v28, s98, v28
    v_lshlrev_b32 v53, 16, v29
    v_mov_b32 v236, v234
    v_and_b32 v29, s98, v29
    v_lshlrev_b32 v54, 16, v30
    v_and_b32 v30, s98, v30
    v_permlane32_swap_b32 v234, v236
    v_lshlrev_b32 v55, 16, v31
    v_and_b32 v31, s98, v31
    v_lshlrev_b32 v56, 16, v32
    v_max_f32 v234, v234, v236
    v_and_b32 v32, s98, v32
    v_lshlrev_b32 v57, 16, v33
    v_and_b32 v33, s98, v33
    v_sub_f32 v232, v232, v234
    v_lshlrev_b32 v58, 16, v34
    v_and_b32 v34, s98, v34
    v_lshlrev_b32 v59, 16, v35
    v_mul_f32 v232, s97, v232
    v_and_b32 v35, s98, v35
    v_lshlrev_b32 v60, 16, v36
    v_and_b32 v36, s98, v36
    v_exp_f32 v232, v232
    v_lshlrev_b32 v61, 16, v37
    v_and_b32 v37, s98, v37
    v_lshlrev_b32 v62, 16, v38
    v_mul_f32 v233, v233, v232
    v_and_b32 v38, s98, v38
    v_lshlrev_b32 v63, 16, v39
    v_and_b32 v39, s98, v39
    v_add_f32_dpp v233, v233, v233 row_ror:1 row_mask:0xf bank_mask:0xf
    v_mul_f32_dpp v224, v232, v40 row_newbcast:0 row_mask:0xf bank_mask:0xf
    v_mul_f32_dpp v225, v232, v16 row_newbcast:0 row_mask:0xf bank_mask:0xf
    v_mul_f32_dpp v226, v232, v41 row_newbcast:0 row_mask:0xf bank_mask:0xf
    v_add_f32_dpp v233, v233, v233 row_ror:2 row_mask:0xf bank_mask:0xf
    v_mul_f32_dpp v227, v232, v17 row_newbcast:0 row_mask:0xf bank_mask:0xf
    v_mul_f32_dpp v228, v232, v42 row_newbcast:0 row_mask:0xf bank_mask:0xf
    v_mul_f32_dpp v229, v232, v18 row_newbcast:0 row_mask:0xf bank_mask:0xf
    v_add_f32_dpp v233, v233, v233 row_ror:4 row_mask:0xf bank_mask:0xf
    v_mul_f32_dpp v230, v232, v43 row_newbcast:0 row_mask:0xf bank_mask:0xf
    v_mul_f32_dpp v231, v232, v19 row_newbcast:0 row_mask:0xf bank_mask:0xf
    v_fmac_f32_dpp v224, v232, v44 row_newbcast:1 row_mask:0xf bank_mask:0xf
    v_add_f32_dpp v233, v233, v233 row_ror:8 row_mask:0xf bank_mask:0xf
    v_fmac_f32_dpp v225, v232, v20 row_newbcast:1 row_mask:0xf bank_mask:0xf
    v_fmac_f32_dpp v226, v232, v45 row_newbcast:1 row_mask:0xf bank_mask:0xf
    v_fmac_f32_dpp v227, v232, v21 row_newbcast:1 row_mask:0xf bank_mask:0xf
    v_mov_b32 v236, v233
    v_fmac_f32_dpp v228, v232, v46 row_newbcast:1 row_mask:0xf bank_mask:0xf
    v_fmac_f32_dpp v229, v232, v22 row_newbcast:1 row_mask:0xf bank_mask:0xf
    v_fmac_f32_dpp v230, v232, v47 row_newbcast:1 row_mask:0xf bank_mask:0xf
    v_permlane16_swap_b32 v233, v236
    v_fmac_f32_dpp v231, v232, v23 row_newbcast:1 row_mask:0xf bank_mask:0xf
    v_fmac_f32_dpp v224, v232, v48 row_newbcast:2 row_mask:0xf bank_mask:0xf
    v_fmac_f32_dpp v225, v232, v24 row_newbcast:2 row_mask:0xf bank_mask:0xf
    v_add_f32 v233, v233, v236
    v_fmac_f32_dpp v226, v232, v49 row_newbcast:2 row_mask:0xf bank_mask:0xf
    v_fmac_f32_dpp v227, v232, v25 row_newbcast:2 row_mask:0xf bank_mask:0xf
    v_fmac_f32_dpp v228, v232, v50 row_newbcast:2 row_mask:0xf bank_mask:0xf
    v_mov_b32 v236, v233
    v_fmac_f32_dpp v229, v232, v26 row_newbcast:2 row_mask:0xf bank_mask:0xf
    v_fmac_f32_dpp v230, v232, v51 row_newbcast:2 row_mask:0xf bank_mask:0xf
    v_fmac_f32_dpp v231, v232, v27 row_newbcast:2 row_mask:0xf bank_mask:0xf
    v_permlane32_swap_b32 v233, v236
    v_fmac_f32_dpp v224, v232, v52 row_newbcast:3 row_mask:0xf bank_mask:0xf
    v_fmac_f32_dpp v225, v232, v28 row_newbcast:3 row_mask:0xf bank_mask:0xf
    v_fmac_f32_dpp v226, v232, v53 row_newbcast:3 row_mask:0xf bank_mask:0xf
    v_add_f32 v233, v233, v236
    v_fmac_f32_dpp v227, v232, v29 row_newbcast:3 row_mask:0xf bank_mask:0xf
    v_fmac_f32_dpp v228, v232, v54 row_newbcast:3 row_mask:0xf bank_mask:0xf
    v_fmac_f32_dpp v229, v232, v30 row_newbcast:3 row_mask:0xf bank_mask:0xf
    v_rcp_f32 v233, v233
    v_fmac_f32_dpp v230, v232, v55 row_newbcast:3 row_mask:0xf bank_mask:0xf
    v_fmac_f32_dpp v231, v232, v31 row_newbcast:3 row_mask:0xf bank_mask:0xf
    v_fmac_f32_dpp v224, v232, v56 row_newbcast:4 row_mask:0xf bank_mask:0xf
    v_fmac_f32_dpp v225, v232, v32 row_newbcast:4 row_mask:0xf bank_mask:0xf
    v_fmac_f32_dpp v226, v232, v57 row_newbcast:4 row_mask:0xf bank_mask:0xf
    v_fmac_f32_dpp v227, v232, v33 row_newbcast:4 row_mask:0xf bank_mask:0xf
    v_fmac_f32_dpp v228, v232, v58 row_newbcast:4 row_mask:0xf bank_mask:0xf
    v_fmac_f32_dpp v229, v232, v34 row_newbcast:4 row_mask:0xf bank_mask:0xf
    v_fmac_f32_dpp v230, v232, v59 row_newbcast:4 row_mask:0xf bank_mask:0xf
    v_fmac_f32_dpp v231, v232, v35 row_newbcast:4 row_mask:0xf bank_mask:0xf
    v_fmac_f32_dpp v224, v232, v60 row_newbcast:5 row_mask:0xf bank_mask:0xf
    v_fmac_f32_dpp v225, v232, v36 row_newbcast:5 row_mask:0xf bank_mask:0xf
    v_fmac_f32_dpp v226, v232, v61 row_newbcast:5 row_mask:0xf bank_mask:0xf
    v_fmac_f32_dpp v227, v232, v37 row_newbcast:5 row_mask:0xf bank_mask:0xf
    v_fmac_f32_dpp v228, v232, v62 row_newbcast:5 row_mask:0xf bank_mask:0xf
    v_fmac_f32_dpp v229, v232, v38 row_newbcast:5 row_mask:0xf bank_mask:0xf
    v_fmac_f32_dpp v230, v232, v63 row_newbcast:5 row_mask:0xf bank_mask:0xf
    v_fmac_f32_dpp v231, v232, v39 row_newbcast:5 row_mask:0xf bank_mask:0xf
    v_permlane32_swap_b32 v224, v228
    v_permlane32_swap_b32 v225, v229
    v_permlane32_swap_b32 v226, v230
    v_permlane32_swap_b32 v227, v231
    v_add_f32 v224, v224, v228
    v_add_f32 v225, v225, v229
    v_add_f32 v226, v226, v230
    v_add_f32 v227, v227, v231
    s_nop 0
    v_permlane16_swap_b32 v224, v226
    v_permlane16_swap_b32 v225, v227
    v_add_f32 v224, v224, v226
    v_add_f32 v225, v225, v227
    v_mul_f32 v224, v224, v233
    v_mul_f32 v225, v225, v233
L_cmerged:
    v_cvt_pk_bf16_f32 v224, v224, v225
    ds_write_b32 v5, v224
    s_waitcnt lgkmcnt(0)
    s_barrier
    ds_read_b128 v[48:51], v7 offset:0
    ds_read_b128 v[52:55], v7 offset:64
    ds_read_b128 v[56:59], v7 offset:128
    ds_read_b128 v[60:63], v7 offset:192
    s_waitcnt lgkmcnt(0)
    v_mfma_f32_16x16x32_bf16 v[224:227], v[48:51], v[64:67], 0
    v_mfma_f32_16x16x32_bf16 v[228:231], v[48:51], v[68:71], 0
    v_mfma_f32_16x16x32_bf16 v[232:235], v[48:51], v[72:75], 0
    v_mfma_f32_16x16x32_bf16 v[236:239], v[48:51], v[76:79], 0
    v_mfma_f32_16x16x32_bf16 v[240:243], v[48:51], v[80:83], 0
    v_mfma_f32_16x16x32_bf16 v[244:247], v[48:51], v[84:87], 0
    v_mfma_f32_16x16x32_bf16 v[248:251], v[48:51], v[88:91], 0
    v_mfma_f32_16x16x32_bf16 v[252:255], v[48:51], v[92:95], 0
    v_mfma_f32_16x16x32_bf16 v[40:43], v[48:51], v[192:195], 0
    v_mfma_f32_16x16x32_bf16 v[44:47], v[48:51], v[196:199], 0
    v_mfma_f32_16x16x32_bf16 v[224:227], v[52:55], v[96:99], v[224:227]
    v_mfma_f32_16x16x32_bf16 v[228:231], v[52:55], v[100:103], v[228:231]
    v_mfma_f32_16x16x32_bf16 v[232:235], v[52:55], v[104:107], v[232:235]
    v_mfma_f32_16x16x32_bf16 v[236:239], v[52:55], v[108:111], v[236:239]
    v_mfma_f32_16x16x32_bf16 v[240:243], v[52:55], v[112:115], v[240:243]
    v_mfma_f32_16x16x32_bf16 v[244:247], v[52:55], v[116:119], v[244:247]
    v_mfma_f32_16x16x32_bf16 v[248:251], v[52:55], v[120:123], v[248:251]
    v_mfma_f32_16x16x32_bf16 v[252:255], v[52:55], v[124:127], v[252:255]
    v_mfma_f32_16x16x32_bf16 v[40:43], v[52:55], v[200:203], v[40:43]
    v_mfma_f32_16x16x32_bf16 v[44:47], v[52:55], v[204:207], v[44:47]
    v_mfma_f32_16x16x32_bf16 v[224:227], v[56:59], v[128:131], v[224:227]
    v_mfma_f32_16x16x32_bf16 v[228:231], v[56:59], v[132:135], v[228:231]
    v_mfma_f32_16x16x32_bf16 v[232:235], v[56:59], v[136:139], v[232:235]
    v_mfma_f32_16x16x32_bf16 v[236:239], v[56:59], v[140:143], v[236:239]
    v_mfma_f32_16x16x32_bf16 v[240:243], v[56:59], v[144:147], v[240:243]
    v_mfma_f32_16x16x32_bf16 v[244:247], v[56:59], v[148:151], v[244:247]
    v_mfma_f32_16x16x32_bf16 v[248:251], v[56:59], v[152:155], v[248:251]
    v_mfma_f32_16x16x32_bf16 v[252:255], v[56:59], v[156:159], v[252:255]
    v_mfma_f32_16x16x32_bf16 v[40:43], v[56:59], v[208:211], v[40:43]
    v_mfma_f32_16x16x32_bf16 v[44:47], v[56:59], v[212:215], v[44:47]
    v_mfma_f32_16x16x32_bf16 v[224:227], v[60:63], v[160:163], v[224:227]
    v_mfma_f32_16x16x32_bf16 v[228:231], v[60:63], v[164:167], v[228:231]
    v_mfma_f32_16x16x32_bf16 v[232:235], v[60:63], v[168:171], v[232:235]
    v_mfma_f32_16x16x32_bf16 v[236:239], v[60:63], v[172:175], v[236:239]
    v_mfma_f32_16x16x32_bf16 v[240:243], v[60:63], v[176:179], v[240:243]
    v_mfma_f32_16x16x32_bf16 v[244:247], v[60:63], v[180:183], v[244:247]
    v_mfma_f32_16x16x32_bf16 v[248:251], v[60:63], v[184:187], v[248:251]
    v_mfma_f32_16x16x32_bf16 v[252:255], v[60:63], v[188:191], v[252:255]
    v_mfma_f32_16x16x32_bf16 v[40:43], v[60:63], v[216:219], v[40:43]
    v_mfma_f32_16x16x32_bf16 v[44:47], v[60:63], v[220:223], v[44:47]
    v_mul_u32_u24 v7, 73728, v4
    v_lshrrev_b32 v5, 3, v3
    v_lshl_add_u32 v6, v5, 13, v7
    v_and_b32 v5, 7, v3
    v_lshl_add_u32 v6, v5, 4, v6
    v_lshl_add_u32 v7, v3, 3, v7
    v_add_u32 v7, 65536, v7
    s_lshl_b32 s56, s52, 7
    s_add_u32 s56, s56, 4194304
    s_lshl_b32 s54, s3, 14
    s_add_u32 s54, s54, s56
    s_add_u32 s55, s54, 4096
    s_and_b32 s57, s3, 1
    s_lshl_b32 s57, s57, 12
    s_add_u32 s56, s56, s57
    v_min_u32 v16, -2, v224
    v_min_u32 v17, -2, v228
    v_min_u32 v18, -2, v232
    v_min_u32 v19, -2, v236
    v_min_u32 v20, -2, v240
    v_min_u32 v21, -2, v244
    v_min_u32 v22, -2, v248
    v_min_u32 v23, -2, v252
    v_min_u32 v24, -2, v40
    v_min_u32 v25, -2, v44
    buffer_store_dwordx4 v[16:19], v6, s[44:47], s54 offen sc1
    buffer_store_dwordx4 v[20:23], v6, s[44:47], s55 offen sc1
    buffer_store_dwordx2 v[24:25], v7, s[44:47], s56 offen sc1
    s_lshl_b32 s54, s3, 5
    s_add_u32 s54, s54, s53
    s_cmp_ge_u32 s54, 72
    s_cbranch_scc1 L_nored_25
    s_lshl_b32 s55, s54, 12
    s_add_u32 s55, s55, 4194304
    s_mul_hi_u32 s56, s54, 238609295
    s_mul_i32 s57, s56, 18
    s_sub_u32 s57, s54, s57
    s_mul_i32 s56, s56, 2304
    s_add_u32 s56, s56, 0
    s_lshr_b32 s58, s57, 1
    s_lshl_b32 s58, s58, 7
    s_and_b32 s59, s57, 1
    s_cmp_lt_u32 s57, 16
    s_cselect_b32 s60, 3, 6
    s_cselect_b32 s61, 4, 3
    s_lshl_b32 s59, s59, s60
    s_add_u32 s56, s56, s58
    s_add_u32 s56, s56, s59
    v_lshlrev_b32 v5, s61, v1
    s_mov_b64 s[4:5], -1
    s_mov_b64 s[6:7], -1
    s_mov_b64 s[8:9], -1
    s_mov_b64 s[10:11], -1
L_mpoll_26:
    s_mov_b64 exec, s[4:5]
    buffer_load_dwordx4 v[16:19], v2, s[44:47], s55 offen offset:0 sc1
    s_mov_b64 exec, s[6:7]
    buffer_load_dwordx4 v[20:23], v2, s[44:47], s55 offen offset:1024 sc1
    s_mov_b64 exec, s[8:9]
    buffer_load_dwordx4 v[24:27], v2, s[44:47], s55 offen offset:2048 sc1
    s_mov_b64 exec, s[10:11]
    buffer_load_dwordx4 v[28:31], v2, s[44:47], s55 offen offset:3072 sc1
    s_mov_b64 exec, -1
    s_waitcnt vmcnt(0)
    v_max3_u32 v32, v16, v17, v18
    v_max3_u32 v33, v20, v21, v22
    v_max3_u32 v34, v24, v25, v26
    v_max3_u32 v35, v28, v29, v30
    v_max_u32 v32, v32, v19
    v_max_u32 v33, v33, v23
    v_max_u32 v34, v34, v27
    v_max_u32 v35, v35, v31
    v_cmp_eq_u32 s[4:5], -1, v32
    v_cmp_eq_u32 s[6:7], -1, v33
    v_cmp_eq_u32 s[8:9], -1, v34
    v_cmp_eq_u32 s[10:11], -1, v35
    s_or_b64 vcc, s[4:5], s[6:7]
    s_or_b64 vcc, vcc, s[8:9]
    s_or_b64 vcc, vcc, s[10:11]
    s_cbranch_scc0 L_mpollok_27
    s_sub_u32 s101, s101, 1
    s_cbranch_scc0 L_mpoll_26
    s_mov_b32 s101, 0
L_mpollok_27:
    v_add_f32 v16, v16, v20
    v_add_f32 v24, v24, v28
    v_add_f32 v17, v17, v21
    v_add_f32 v25, v25, v29
    v_add_f32 v18, v18, v22
    v_add_f32 v26, v26, v30
    v_add_f32 v19, v19, v23
    v_add_f32 v27, v27, v31
    v_add_f32 v16, v16, v24
    v_add_f32 v17, v17, v25
    v_add_f32 v18, v18, v26
    v_add_f32 v19, v19, v27
    v_add_f32_dpp v16, v16, v16 row_ror:8 row_mask:0xf bank_mask:0xf
    v_add_f32_dpp v17, v17, v17 row_ror:8 row_mask:0xf bank_mask:0xf
    v_add_f32_dpp v18, v18, v18 row_ror:8 row_mask:0xf bank_mask:0xf
    v_add_f32_dpp v19, v19, v19 row_ror:8 row_mask:0xf bank_mask:0xf
    v_mov_b32 v20, v16
    v_mov_b32 v21, v17
    v_mov_b32 v22, v18
    v_mov_b32 v23, v19
    v_permlane16_swap_b32 v16, v20
    v_permlane16_swap_b32 v17, v21
    v_permlane16_swap_b32 v18, v22
    v_permlane16_swap_b32 v19, v23
    v_add_f32 v16, v16, v20
    v_add_f32 v17, v17, v21
    v_add_f32 v18, v18, v22
    v_add_f32 v19, v19, v23
    v_mov_b32 v20, v16
    v_mov_b32 v21, v17
    v_mov_b32 v22, v18
    v_mov_b32 v23, v19
    v_permlane32_swap_b32 v16, v20
    v_permlane32_swap_b32 v17, v21
    v_permlane32_swap_b32 v18, v22
    v_permlane32_swap_b32 v19, v23
    v_add_f32 v16, v16, v20
    v_add_f32 v17, v17, v21
    v_add_f32 v18, v18, v22
    v_add_f32 v19, v19, v23
    v_cvt_pk_bf16_f32 v16, v16, v17
    v_cvt_pk_bf16_f32 v17, v18, v19
    s_mov_b64 exec, 0xff
    buffer_store_dwordx2 v[16:17], v5, s[48:51], s56 offen
    s_mov_b64 exec, -1
L_nored_25:
    s_endpgm
L_roleC_end:
L_exit:
    s_endpgm
.section .rodata,"a"
.p2align 6
.amdhsa_kernel concat_heads__mha_block_cached__compressed_kv_cla__decode_kernel
  .amdhsa_next_free_vgpr 512
  .amdhsa_next_free_sgpr 102
  .amdhsa_accum_offset 256
  .amdhsa_group_segment_fixed_size 0
  .amdhsa_kernarg_size 112
  .amdhsa_user_sgpr_count 2
  .amdhsa_user_sgpr_kernarg_segment_ptr 1
  .amdhsa_system_sgpr_workgroup_id_x 1
.end_amdhsa_kernel
```

```asm
; @launch grid=(256,1,1) block=(256,1,1) lds=163840
.amdgcn_target "amdgcn-amd-amdhsa--gfx950"
.text
.globl concat_heads__mha_block_cached__compressed_kv_cla__decode_kernel
.p2align 12
.p2align 8
.type concat_heads__mha_block_cached__compressed_kv_cla__decode_kernel,@function
concat_heads__mha_block_cached__compressed_kv_cla__decode_kernel:
    s_cmp_ge_u32 s2, 256
    s_cbranch_scc1 L_exit
    s_load_dwordx16 s[4:19], s[0:1], 0
    s_load_dwordx8 s[20:27], s[0:1], 64
    s_load_dwordx4 s[28:31], s[0:1], 96
    v_lshrrev_b32 v2, 6, v0
    v_and_b32 v1, 63, v0
    v_readfirstlane_b32 s3, v2
    v_and_b32 v3, 15, v0
    v_bfe_u32 v4, v0, 4, 2
    v_lshlrev_b32 v2, 4, v1
    s_and_b32 s52, s2, 31
    s_mov_b32 s53, s52
    s_cmp_lt_u32 s2, 32
    s_cbranch_scc1 L_roleH
    s_cmp_lt_u32 s2, 64
    s_cbranch_scc1 L_roleC
L_roleA:
    s_sub_u32 s54, s2, 64
    s_mul_hi_u32 s96, s54, 178956971
    s_mul_i32 s56, s96, 24
    s_sub_u32 s97, s54, s56
    s_lshr_b32 s55, s97, 3
    s_add_u32 s3, s3, s97
    s_add_u32 s3, s3, s55
    s_and_b32 s3, s3, 3
    s_add_u32 s56, s96, s3
    s_and_b32 s56, s56, 3
    s_lshr_b32 s55, s97, 3
    s_and_b32 s53, s97, 7
    s_lshl_b32 s96, s96, 2
    s_add_u32 s55, s55, s56
    s_add_u32 s55, s55, 1
    s_and_b32 s55, s55, 3
    s_add_u32 s52, s96, s55
    s_add_u32 s96, s96, s56
    s_lshl_b32 s100, s3, 25
    s_lshl_b32 s55, s52, 20
    s_add_u32 s100, s100, s55
    s_lshl_b32 s55, s53, 12
    s_add_u32 s100, s100, s55
    s_lshl_b32 s58, s52, 2
    s_add_u32 s58, s58, s3
    s_mul_i32 s58, s58, 163840
    s_add_u32 s59, s58, 1048576
    s_sub_u32 s61, s59, 65536
    s_and_b32 s99, s96, 28
    s_add_u32 s99, s99, s3
    s_mul_i32 s99, s99, 151552
    s_mov_b32 s63, s53
    s_getpc_b64 s[56:57]
L_pc_1:
    s_sub_u32 s56, s56, L_pc_1-L_roleA
    s_subb_u32 s57, s57, 0
    v_lshlrev_b32 v5, 7, v0
    v_min_u32 v6, L_roleA_end-L_roleA-4, v5
    global_load_dword v56, v6, s[56:57]
    s_mov_b32 s53, 536870912
    v_mov_b32 v18, s53
    v_cmp_eq_u32 vcc, 0, v1
    s_nop 1
    v_cndmask_b32 v18, v18, v1, vcc
    s_waitcnt lgkmcnt(0)
    s_mov_b32 s32, s6
    s_mov_b32 s33, s7
    s_mov_b32 s34, 134217728
    s_mov_b32 s35, 0x20000
    s_mov_b32 s36, s8
    s_mov_b32 s37, s9
    s_mov_b32 s38, 134217728
    s_mov_b32 s39, 0x20000
    s_mov_b32 s44, s30
    s_mov_b32 s45, s31
    s_mov_b32 s46, 536870912
    s_mov_b32 s47, 0x20000
    s_and_b32 s60, s58, 1015808
    s_or_b32 s60, s60, s100
    s_add_u32 s58, s58, 32768
    buffer_load_dwordx4 v[96:99], v2, s[32:35], s60 offen offset:0 nt
    buffer_load_dwordx4 v[100:103], v2, s[32:35], s60 offen offset:1024 nt
    buffer_load_dwordx4 v[104:107], v2, s[32:35], s60 offen offset:2048 nt
    buffer_load_dwordx4 v[108:111], v2, s[32:35], s60 offen offset:3072 nt
    buffer_load_dwordx4 a[32:35], v2, s[36:39], s60 offen offset:0 nt
    buffer_load_dwordx4 a[36:39], v2, s[36:39], s60 offen offset:1024 nt
    buffer_load_dwordx4 a[40:43], v2, s[36:39], s60 offen offset:2048 nt
    buffer_load_dwordx4 a[44:47], v2, s[36:39], s60 offen offset:3072 nt
    s_and_b32 s60, s58, 1015808
    s_or_b32 s60, s60, s100
    s_add_u32 s58, s58, 32768
    buffer_load_dwordx4 v[112:115], v2, s[32:35], s60 offen offset:0 nt
    buffer_load_dwordx4 v[116:119], v2, s[32:35], s60 offen offset:1024 nt
    buffer_load_dwordx4 v[120:123], v2, s[32:35], s60 offen offset:2048 nt
    buffer_load_dwordx4 v[124:127], v2, s[32:35], s60 offen offset:3072 nt
    buffer_load_dwordx4 a[48:51], v2, s[36:39], s60 offen offset:0 nt
    buffer_load_dwordx4 a[52:55], v2, s[36:39], s60 offen offset:1024 nt
    buffer_load_dwordx4 a[56:59], v2, s[36:39], s60 offen offset:2048 nt
    buffer_load_dwordx4 a[60:63], v2, s[36:39], s60 offen offset:3072 nt
    s_and_b32 s60, s58, 1015808
    s_or_b32 s60, s60, s100
    s_add_u32 s58, s58, 32768
    buffer_load_dwordx4 v[128:131], v2, s[32:35], s60 offen offset:0 nt
    buffer_load_dwordx4 v[132:135], v2, s[32:35], s60 offen offset:1024 nt
    buffer_load_dwordx4 v[136:139], v2, s[32:35], s60 offen offset:2048 nt
    buffer_load_dwordx4 v[140:143], v2, s[32:35], s60 offen offset:3072 nt
    buffer_load_dwordx4 a[64:67], v2, s[36:39], s60 offen offset:0 nt
    buffer_load_dwordx4 a[68:71], v2, s[36:39], s60 offen offset:1024 nt
    buffer_load_dwordx4 a[72:75], v2, s[36:39], s60 offen offset:2048 nt
    buffer_load_dwordx4 a[76:79], v2, s[36:39], s60 offen offset:3072 nt
    s_and_b32 s60, s58, 1015808
    s_or_b32 s60, s60, s100
    s_add_u32 s58, s58, 32768
    buffer_load_dwordx4 v[144:147], v2, s[32:35], s60 offen offset:0 nt
    buffer_load_dwordx4 v[148:151], v2, s[32:35], s60 offen offset:1024 nt
    buffer_load_dwordx4 v[152:155], v2, s[32:35], s60 offen offset:2048 nt
    buffer_load_dwordx4 v[156:159], v2, s[32:35], s60 offen offset:3072 nt
    buffer_load_dwordx4 a[80:83], v2, s[36:39], s60 offen offset:0 nt
    buffer_load_dwordx4 a[84:87], v2, s[36:39], s60 offen offset:1024 nt
    buffer_load_dwordx4 a[88:91], v2, s[36:39], s60 offen offset:2048 nt
    buffer_load_dwordx4 a[92:95], v2, s[36:39], s60 offen offset:3072 nt
    s_and_b32 s60, s58, 1015808
    s_or_b32 s60, s60, s100
    s_add_u32 s58, s58, 32768
    buffer_load_dwordx4 v[160:163], v2, s[32:35], s60 offen offset:0 nt
    buffer_load_dwordx4 v[164:167], v2, s[32:35], s60 offen offset:1024 nt
    buffer_load_dwordx4 v[168:171], v2, s[32:35], s60 offen offset:2048 nt
    buffer_load_dwordx4 v[172:175], v2, s[32:35], s60 offen offset:3072 nt
    buffer_load_dwordx4 a[96:99], v2, s[36:39], s60 offen offset:0 nt
    buffer_load_dwordx4 a[100:103], v2, s[36:39], s60 offen offset:1024 nt
    buffer_load_dwordx4 a[104:107], v2, s[36:39], s60 offen offset:2048 nt
    buffer_load_dwordx4 a[108:111], v2, s[36:39], s60 offen offset:3072 nt
    s_and_b32 s60, s58, 1015808
    s_or_b32 s60, s60, s100
    s_add_u32 s58, s58, 32768
    buffer_load_dwordx4 v[176:179], v2, s[32:35], s60 offen offset:0 nt
    buffer_load_dwordx4 v[180:183], v2, s[32:35], s60 offen offset:1024 nt
    buffer_load_dwordx4 v[184:187], v2, s[32:35], s60 offen offset:2048 nt
    buffer_load_dwordx4 v[188:191], v2, s[32:35], s60 offen offset:3072 nt
    buffer_load_dwordx4 a[112:115], v2, s[36:39], s60 offen offset:0 nt
    buffer_load_dwordx4 a[116:119], v2, s[36:39], s60 offen offset:1024 nt
    buffer_load_dwordx4 a[120:123], v2, s[36:39], s60 offen offset:2048 nt
    buffer_load_dwordx4 a[124:127], v2, s[36:39], s60 offen offset:3072 nt
    s_lshl_b32 s54, s52, 2
    s_lshl_b32 s55, s96, 2
    v_mov_b32 v58, s54
    v_mov_b32 v57, s55
    v_cndmask_b32 v58, v58, v57, vcc
    s_load_dword s18, s[28:29], s54
    s_load_dword s19, s[28:29], s55
    s_and_b32 s60, s58, 1015808
    s_or_b32 s60, s60, s100
    s_add_u32 s58, s58, 32768
    buffer_load_dwordx4 v[192:195], v2, s[32:35], s60 offen offset:0 nt
    buffer_load_dwordx4 v[196:199], v2, s[32:35], s60 offen offset:1024 nt
    buffer_load_dwordx4 v[200:203], v2, s[32:35], s60 offen offset:2048 nt
    buffer_load_dwordx4 v[204:207], v2, s[32:35], s60 offen offset:3072 nt
    buffer_load_dwordx4 a[128:131], v2, s[36:39], s60 offen offset:0 nt
    buffer_load_dwordx4 a[132:135], v2, s[36:39], s60 offen offset:1024 nt
    buffer_load_dwordx4 a[136:139], v2, s[36:39], s60 offen offset:2048 nt
    buffer_load_dwordx4 a[140:143], v2, s[36:39], s60 offen offset:3072 nt
    s_waitcnt vmcnt(48)
    s_and_b32 s60, s58, 1015808
    s_or_b32 s60, s60, s100
    s_add_u32 s58, s58, 32768
    buffer_load_dwordx4 v[208:211], v2, s[32:35], s60 offen offset:0 nt
    buffer_load_dwordx4 v[212:215], v2, s[32:35], s60 offen offset:1024 nt
    buffer_load_dwordx4 v[216:219], v2, s[32:35], s60 offen offset:2048 nt
    buffer_load_dwordx4 v[220:223], v2, s[32:35], s60 offen offset:3072 nt
    buffer_load_dwordx4 a[144:147], v2, s[36:39], s60 offen offset:0 nt
    buffer_load_dwordx4 a[148:151], v2, s[36:39], s60 offen offset:1024 nt
    buffer_load_dwordx4 a[152:155], v2, s[36:39], s60 offen offset:2048 nt
    buffer_load_dwordx4 a[156:159], v2, s[36:39], s60 offen offset:3072 nt
    s_waitcnt vmcnt(48)
    s_and_b32 s60, s58, 1015808
    s_or_b32 s60, s60, s100
    s_add_u32 s58, s58, 32768
    buffer_load_dwordx4 v[224:227], v2, s[32:35], s60 offen offset:0 nt
    buffer_load_dwordx4 v[228:231], v2, s[32:35], s60 offen offset:1024 nt
    buffer_load_dwordx4 v[232:235], v2, s[32:35], s60 offen offset:2048 nt
    buffer_load_dwordx4 v[236:239], v2, s[32:35], s60 offen offset:3072 nt
    buffer_load_dwordx4 a[160:163], v2, s[36:39], s60 offen offset:0 nt
    buffer_load_dwordx4 a[164:167], v2, s[36:39], s60 offen offset:1024 nt
    buffer_load_dwordx4 a[168:171], v2, s[36:39], s60 offen offset:2048 nt
    buffer_load_dwordx4 a[172:175], v2, s[36:39], s60 offen offset:3072 nt
    v_and_b32 v5, 1, v3
    v_cmp_eq_u32 vcc, 1, v5
    v_mov_b32 v5, 0xffff
    v_mov_b32 v6, 0xffff0000
    v_cndmask_b32 v5, v5, v6, vcc
    v_lshrrev_b32 v6, 1, v3
    v_cmp_eq_u32 vcc, 0, v6
    s_nop 1
    v_cndmask_b32 v8, 0, v5, vcc
    v_cmp_eq_u32 vcc, 1, v6
    s_nop 1
    v_cndmask_b32 v9, 0, v5, vcc
    v_cmp_eq_u32 vcc, 2, v6
    s_nop 1
    v_cndmask_b32 v10, 0, v5, vcc
    v_cmp_eq_u32 vcc, 3, v6
    s_nop 1
    v_cndmask_b32 v11, 0, v5, vcc
    v_mov_b32 v12, 0
    v_mov_b32 v13, 0
    v_mov_b32 v14, 0
    v_mov_b32 v15, 0
    v_mov_b32 v16, 0xff800000
    v_mov_b32 v17, 0
    v_lshrrev_b32 v5, 1, v4
    v_lshlrev_b32 v59, 5, v3
    v_lshl_add_u32 v59, v5, 4, v59
    v_and_b32 v5, 1, v4
    v_lshl_add_u32 v59, v5, 11, v59
    s_lshl_b32 s54, s52, 2
    s_add_u32 s54, s54, s3
    s_lshl_b32 s54, s54, 13
    s_lshl_b32 s55, s96, 2
    s_add_u32 s55, s55, s3
    s_lshl_b32 s55, s55, 13
    v_cmp_eq_u32 vcc, 1, v5
    v_mov_b32 v6, s54
    v_mov_b32 v7, s55
    v_cndmask_b32 v6, v6, v7, vcc
    v_mov_b32 v20, s63
    v_mov_b32 v7, s97
    v_cndmask_b32 v7, v20, v7, vcc
    v_lshl_add_u32 v20, v7, 4, v3
    v_lshl_add_u32 v20, v20, 4, v6
    v_lshl_add_u32 v21, v7, 4, v6
    v_add_u32 v21, 6144, v21
    v_mov_b32 v7, s53
    v_cmp_eq_u32 vcc, 0, v3
    s_nop 1
    v_cndmask_b32 v21, v7, v21, vcc
    v_cmp_gt_u32 vcc, 32, v1
    s_nop 1
    v_cndmask_b32 v3, v21, v20, vcc
    s_mov_b32 s8, 1015808
    s_mov_b32 s9, s100
    s_mov_b32 s10, 0xff000
    s_lshl_b32 s11, s3, 25
    s_lshl_b32 s54, s96, 20
    s_add_u32 s11, s11, s54
    s_lshl_b32 s57, s96, 2
    s_add_u32 s57, s57, s3
    s_lshl_b32 s57, s57, 7
    s_add_u32 s57, s57, 5373952
    s_lshl_b32 s54, s3, 9
    s_add_u32 s54, s54, 5242880
    s_lshl_b32 s56, s52, 12
    s_add_u32 s56, s56, s54
    s_lshl_b32 s12, s96, 12
    s_add_u32 s12, s12, s54
    s_mov_b32 s13, 0
    s_add_u32 s15, s59, 65536
    s_sub_u32 s14, s15, 131072
    s_mov_b32 s96, 1035273459
    s_mov_b32 s97, 1069066811
    s_mov_b32 s98, 0xffff0000
    s_mov_b32 s62, 2
    s_mov_b32 s101, 100000
    s_waitcnt lgkmcnt(0)
    s_min_u32 s18, s18, s19
    s_cmp_lt_u32 s18, 2
    s_cbranch_scc1 L_aflag
L_aflag_ok:
    buffer_load_dwordx4 v[60:63], v59, s[44:47], s56 offen sc1
    s_waitcnt vmcnt(49)
    s_and_b32 s60, s58, 1015808
    s_or_b32 s60, s60, s100
    s_add_u32 s58, s58, 32768
    buffer_load_dwordx4 v[240:243], v2, s[32:35], s60 offen offset:0 nt
    buffer_load_dwordx4 v[244:247], v2, s[32:35], s60 offen offset:1024 nt
    buffer_load_dwordx4 v[248:251], v2, s[32:35], s60 offen offset:2048 nt
    buffer_load_dwordx4 v[252:255], v2, s[32:35], s60 offen offset:3072 nt
    buffer_load_dwordx4 a[176:179], v2, s[36:39], s60 offen offset:0 nt
    buffer_load_dwordx4 a[180:183], v2, s[36:39], s60 offen offset:1024 nt
    buffer_load_dwordx4 a[184:187], v2, s[36:39], s60 offen offset:2048 nt
    buffer_load_dwordx4 a[188:191], v2, s[36:39], s60 offen offset:3072 nt
    s_waitcnt vmcnt(49)
    buffer_atomic_add v48, v18, s[44:47], s53 offen sc0
    s_and_b32 s60, s58, 1015808
    s_or_b32 s60, s60, s100
    s_add_u32 s58, s58, 32768
    buffer_load_dwordx4 v[64:67], v2, s[32:35], s60 offen offset:0 nt
    buffer_load_dwordx4 v[68:71], v2, s[32:35], s60 offen offset:1024 nt
    buffer_load_dwordx4 v[72:75], v2, s[32:35], s60 offen offset:2048 nt
    buffer_load_dwordx4 v[76:79], v2, s[32:35], s60 offen offset:3072 nt
    buffer_load_dwordx4 a[0:3], v2, s[36:39], s60 offen offset:0 nt
    buffer_load_dwordx4 a[4:7], v2, s[36:39], s60 offen offset:1024 nt
    buffer_load_dwordx4 a[8:11], v2, s[36:39], s60 offen offset:2048 nt
    buffer_load_dwordx4 a[12:15], v2, s[36:39], s60 offen offset:3072 nt
    s_waitcnt vmcnt(50)
    buffer_atomic_add v49, v18, s[44:47], s53 offen sc0
    s_and_b32 s60, s58, 1015808
    s_or_b32 s60, s60, s100
    s_add_u32 s58, s58, 32768
    buffer_load_dwordx4 v[80:83], v2, s[32:35], s60 offen offset:0 nt
    buffer_load_dwordx4 v[84:87], v2, s[32:35], s60 offen offset:1024 nt
    buffer_load_dwordx4 v[88:91], v2, s[32:35], s60 offen offset:2048 nt
    buffer_load_dwordx4 v[92:95], v2, s[32:35], s60 offen offset:3072 nt
    buffer_load_dwordx4 a[16:19], v2, s[36:39], s60 offen offset:0 nt
    buffer_load_dwordx4 a[20:23], v2, s[36:39], s60 offen offset:1024 nt
    buffer_load_dwordx4 a[24:27], v2, s[36:39], s60 offen offset:2048 nt
    buffer_load_dwordx4 a[28:31], v2, s[36:39], s60 offen offset:3072 nt
    s_waitcnt vmcnt(26)
L_aq1:
    v_max3_u32 v20, v60, v61, v62
    v_max_u32 v20, v20, v63
    v_cmp_eq_u32 vcc, -1, v20
    s_cbranch_vccz L_aq1_ok
    buffer_load_dwordx4 v[60:63], v59, s[44:47], s56 offen sc1
    s_waitcnt vmcnt(0)
    s_sub_u32 s101, s101, 1
    s_cbranch_scc0 L_aq1
    s_mov_b32 s101, 0
L_aq1_ok:
    v_mov_b32 v20, v60
    v_mov_b32 v21, v61
    v_mov_b32 v22, v62
    v_mov_b32 v23, v63
    v_permlane16_swap_b32 v60, v20
    v_permlane16_swap_b32 v61, v21
    v_permlane16_swap_b32 v62, v22
    v_permlane16_swap_b32 v63, v23
    v_add_f32 v60, v60, v20
    v_add_f32 v61, v61, v21
    v_add_f32 v62, v62, v22
    v_add_f32 v63, v63, v23
    v_cvt_pk_bf16_f32 v4, v60, v61
    v_cvt_pk_bf16_f32 v5, v62, v63
    v_mov_b32 v6, v4
    v_mov_b32 v7, v5
    s_nop 0
    v_permlane32_swap_b32 v4, v6
    v_permlane32_swap_b32 v5, v7
    s_mov_b32 s56, 1
L_aloop:
    s_waitcnt vmcnt(13)
    v_dot2_f32_bf16 v20, v64, v4, 0
    v_dot2_f32_bf16 v21, v68, v4, 0
    v_dot2_f32_bf16 v22, v72, v4, 0
    v_dot2_f32_bf16 v23, v76, v4, 0
    v_dot2_f32_bf16 v20, v65, v5, v20
    v_dot2_f32_bf16 v21, v69, v5, v21
    v_dot2_f32_bf16 v22, v73, v5, v22
    v_dot2_f32_bf16 v23, v77, v5, v23
    v_dot2_f32_bf16 v20, v66, v6, v20
    v_dot2_f32_bf16 v21, v70, v6, v21
    v_dot2_f32_bf16 v22, v74, v6, v22
    v_dot2_f32_bf16 v23, v78, v6, v23
    v_dot2_f32_bf16 v20, v67, v7, v20
    v_dot2_f32_bf16 v21, v71, v7, v21
    v_dot2_f32_bf16 v22, v75, v7, v22
    v_dot2_f32_bf16 v23, v79, v7, v23
    v_readfirstlane_b32 s54, v48
    v_mov_b32 v48, 1
    s_cmp_ge_u32 s58, s61
    s_cselect_b32 s55, s57, s53
    s_lshl_b32 s54, s54, 12
    s_add_u32 s60, s54, s99
    s_cmp_lt_u32 s58, s59
    s_cselect_b32 s60, s58, s60
    s_cselect_b32 s54, 0, s54
    s_cselect_b64 s[6:7], s[8:9], s[10:11]
    s_add_u32 s58, s58, 32768
    s_and_b32 s60, s60, s6
    s_or_b32 s60, s60, s7
    s_cmp_lt_u32 s54, 0x100000
    s_cselect_b32 s60, s60, 0x8000000
    s_cselect_b32 s55, s55, s53
    s_addc_u32 s62, s62, -1
    buffer_atomic_add v48, v18, s[44:47], s55 offen sc0
    buffer_load_dwordx4 v[64:67], v2, s[32:35], s60 offen offset:0 nt
    buffer_load_dwordx4 v[68:71], v2, s[32:35], s60 offen offset:1024 nt
    buffer_load_dwordx4 v[72:75], v2, s[32:35], s60 offen offset:2048 nt
    buffer_load_dwordx4 v[76:79], v2, s[32:35], s60 offen offset:3072 nt
    v_add_f32_dpp v24, v20, v20 row_ror:8 row_mask:0xf bank_mask:0x3
    v_add_f32_dpp v25, v22, v22 row_ror:8 row_mask:0xf bank_mask:0x3
    v_add_f32_dpp v24, v21, v21 row_ror:8 row_mask:0xf bank_mask:0xc
    v_add_f32_dpp v25, v23, v23 row_ror:8 row_mask:0xf bank_mask:0xc
    s_nop 0
    v_add_f32_dpp v26, v24, v24 row_shl:4 row_mask:0xf bank_mask:0x5
    v_add_f32_dpp v26, v25, v25 row_shr:4 row_mask:0xf bank_mask:0xa
    s_nop 1
    v_add_f32_dpp v26, v26, v26 quad_perm:[1,0,3,2] row_mask:0xf bank_mask:0xf
    s_nop 1
    v_add_f32_dpp v26, v26, v26 quad_perm:[2,3,0,1] row_mask:0xf bank_mask:0xf
    v_cvt_pk_bf16_f32 v26, v26, v26
    v_and_b32 v26, s98, v26
    v_mul_f32 v26, s96, v26
    v_cvt_pk_bf16_f32 v26, v26, v26
    v_and_b32 v26, s98, v26
    s_nop 1
    v_max_f32_dpp v27, v26, v26 row_ror:4 row_mask:0xf bank_mask:0xf
    s_nop 1
    v_max_f32_dpp v27, v27, v27 row_ror:8 row_mask:0xf bank_mask:0xf
    v_mov_b32 v28, v27
    s_nop 1
    v_permlane16_swap_b32 v27, v28
    v_max_f32 v27, v27, v28
    v_mov_b32 v28, v27
    s_nop 1
    v_permlane32_swap_b32 v27, v28
    v_max3_f32 v27, v27, v28, v16
    v_sub_f32 v28, v16, v27
    v_sub_f32 v29, v26, v27
    v_mul_f32 v28, s97, v28
    v_mul_f32 v29, s97, v29
    v_exp_f32 v28, v28
    v_exp_f32 v29, v29
    v_mov_b32 v16, v27
    v_fma_f32 v17, v17, v28, v29
    v_cvt_pk_bf16_f32 v29, v29, v29
    v_mul_f32 v12, v12, v28
    v_mul_f32 v13, v13, v28
    v_mul_f32 v14, v14, v28
    v_mul_f32 v15, v15, v28
    s_waitcnt vmcnt(14)
    v_and_b32_dpp v32, v29, v8 row_newbcast:0 row_mask:0xf bank_mask:0xf
    v_and_b32_dpp v33, v29, v9 row_newbcast:0 row_mask:0xf bank_mask:0xf
    v_and_b32_dpp v34, v29, v10 row_newbcast:0 row_mask:0xf bank_mask:0xf
    v_and_b32_dpp v35, v29, v11 row_newbcast:0 row_mask:0xf bank_mask:0xf
    v_and_b32_dpp v36, v29, v8 row_newbcast:8 row_mask:0xf bank_mask:0xf
    v_and_b32_dpp v37, v29, v9 row_newbcast:8 row_mask:0xf bank_mask:0xf
    v_and_b32_dpp v38, v29, v10 row_newbcast:8 row_mask:0xf bank_mask:0xf
    v_and_b32_dpp v39, v29, v11 row_newbcast:8 row_mask:0xf bank_mask:0xf
    v_and_b32_dpp v40, v29, v8 row_newbcast:4 row_mask:0xf bank_mask:0xf
    v_and_b32_dpp v41, v29, v9 row_newbcast:4 row_mask:0xf bank_mask:0xf
    v_and_b32_dpp v42, v29, v10 row_newbcast:4 row_mask:0xf bank_mask:0xf
    v_and_b32_dpp v43, v29, v11 row_newbcast:4 row_mask:0xf bank_mask:0xf
    v_and_b32_dpp v44, v29, v8 row_newbcast:12 row_mask:0xf bank_mask:0xf
    v_and_b32_dpp v45, v29, v9 row_newbcast:12 row_mask:0xf bank_mask:0xf
    v_and_b32_dpp v46, v29, v10 row_newbcast:12 row_mask:0xf bank_mask:0xf
    v_and_b32_dpp v47, v29, v11 row_newbcast:12 row_mask:0xf bank_mask:0xf
    v_mfma_f32_16x16x32_bf16 v[12:15], v[32:35], a[0:3], v[12:15]
    v_mfma_f32_16x16x32_bf16 v[12:15], v[36:39], a[4:7], v[12:15]
    v_mfma_f32_16x16x32_bf16 v[12:15], v[40:43], a[8:11], v[12:15]
    v_mfma_f32_16x16x32_bf16 v[12:15], v[44:47], a[12:15], v[12:15]
    buffer_load_dwordx4 a[0:3], v2, s[36:39], s60 offen offset:0 nt
    buffer_load_dwordx4 a[4:7], v2, s[36:39], s60 offen offset:1024 nt
    buffer_load_dwordx4 a[8:11], v2, s[36:39], s60 offen offset:2048 nt
    buffer_load_dwordx4 a[12:15], v2, s[36:39], s60 offen offset:3072 nt
    s_cmp_eq_u32 s62, 0
    s_cbranch_scc1 L_adone
    s_cmp_lg_u32 s56, 0
    s_cbranch_scc1 L_aext0
L_aback0:
    s_waitcnt vmcnt(13)
    v_dot2_f32_bf16 v20, v80, v4, 0
    v_dot2_f32_bf16 v21, v84, v4, 0
    v_dot2_f32_bf16 v22, v88, v4, 0
    v_dot2_f32_bf16 v23, v92, v4, 0
    v_dot2_f32_bf16 v20, v81, v5, v20
    v_dot2_f32_bf16 v21, v85, v5, v21
    v_dot2_f32_bf16 v22, v89, v5, v22
    v_dot2_f32_bf16 v23, v93, v5, v23
    v_dot2_f32_bf16 v20, v82, v6, v20
    v_dot2_f32_bf16 v21, v86, v6, v21
    v_dot2_f32_bf16 v22, v90, v6, v22
    v_dot2_f32_bf16 v23, v94, v6, v23
    v_dot2_f32_bf16 v20, v83, v7, v20
    v_dot2_f32_bf16 v21, v87, v7, v21
    v_dot2_f32_bf16 v22, v91, v7, v22
    v_dot2_f32_bf16 v23, v95, v7, v23
    v_readfirstlane_b32 s54, v49
    v_mov_b32 v49, 1
    s_cmp_ge_u32 s58, s61
    s_cselect_b32 s55, s57, s53
    s_lshl_b32 s54, s54, 12
    s_add_u32 s60, s54, s99
    s_cmp_lt_u32 s58, s59
    s_cselect_b32 s60, s58, s60
    s_cselect_b32 s54, 0, s54
    s_cselect_b64 s[6:7], s[8:9], s[10:11]
    s_add_u32 s58, s58, 32768
    s_and_b32 s60, s60, s6
    s_or_b32 s60, s60, s7
    s_cmp_lt_u32 s54, 0x100000
    s_cselect_b32 s60, s60, 0x8000000
    s_cselect_b32 s55, s55, s53
    s_addc_u32 s62, s62, -1
    buffer_atomic_add v49, v18, s[44:47], s55 offen sc0
    buffer_load_dwordx4 v[80:83], v2, s[32:35], s60 offen offset:0 nt
    buffer_load_dwordx4 v[84:87], v2, s[32:35], s60 offen offset:1024 nt
    buffer_load_dwordx4 v[88:91], v2, s[32:35], s60 offen offset:2048 nt
    buffer_load_dwordx4 v[92:95], v2, s[32:35], s60 offen offset:3072 nt
    v_add_f32_dpp v24, v20, v20 row_ror:8 row_mask:0xf bank_mask:0x3
    v_add_f32_dpp v25, v22, v22 row_ror:8 row_mask:0xf bank_mask:0x3
    v_add_f32_dpp v24, v21, v21 row_ror:8 row_mask:0xf bank_mask:0xc
    v_add_f32_dpp v25, v23, v23 row_ror:8 row_mask:0xf bank_mask:0xc
    s_nop 0
    v_add_f32_dpp v26, v24, v24 row_shl:4 row_mask:0xf bank_mask:0x5
    v_add_f32_dpp v26, v25, v25 row_shr:4 row_mask:0xf bank_mask:0xa
    s_nop 1
    v_add_f32_dpp v26, v26, v26 quad_perm:[1,0,3,2] row_mask:0xf bank_mask:0xf
    s_nop 1
    v_add_f32_dpp v26, v26, v26 quad_perm:[2,3,0,1] row_mask:0xf bank_mask:0xf
    v_cvt_pk_bf16_f32 v26, v26, v26
    v_and_b32 v26, s98, v26
    v_mul_f32 v26, s96, v26
    v_cvt_pk_bf16_f32 v26, v26, v26
    v_and_b32 v26, s98, v26
    s_nop 1
    v_max_f32_dpp v27, v26, v26 row_ror:4 row_mask:0xf bank_mask:0xf
    s_nop 1
    v_max_f32_dpp v27, v27, v27 row_ror:8 row_mask:0xf bank_mask:0xf
    v_mov_b32 v28, v27
    s_nop 1
    v_permlane16_swap_b32 v27, v28
    v_max_f32 v27, v27, v28
    v_mov_b32 v28, v27
    s_nop 1
    v_permlane32_swap_b32 v27, v28
    v_max3_f32 v27, v27, v28, v16
    v_sub_f32 v28, v16, v27
    v_sub_f32 v29, v26, v27
    v_mul_f32 v28, s97, v28
    v_mul_f32 v29, s97, v29
    v_exp_f32 v28, v28
    v_exp_f32 v29, v29
    v_mov_b32 v16, v27
    v_fma_f32 v17, v17, v28, v29
    v_cvt_pk_bf16_f32 v29, v29, v29
    v_mul_f32 v12, v12, v28
    v_mul_f32 v13, v13, v28
    v_mul_f32 v14, v14, v28
    v_mul_f32 v15, v15, v28
    s_waitcnt vmcnt(14)
    v_and_b32_dpp v32, v29, v8 row_newbcast:0 row_mask:0xf bank_mask:0xf
    v_and_b32_dpp v33, v29, v9 row_newbcast:0 row_mask:0xf bank_mask:0xf
    v_and_b32_dpp v34, v29, v10 row_newbcast:0 row_mask:0xf bank_mask:0xf
    v_and_b32_dpp v35, v29, v11 row_newbcast:0 row_mask:0xf bank_mask:0xf
    v_and_b32_dpp v36, v29, v8 row_newbcast:8 row_mask:0xf bank_mask:0xf
    v_and_b32_dpp v37, v29, v9 row_newbcast:8 row_mask:0xf bank_mask:0xf
    v_and_b32_dpp v38, v29, v10 row_newbcast:8 row_mask:0xf bank_mask:0xf
    v_and_b32_dpp v39, v29, v11 row_newbcast:8 row_mask:0xf bank_mask:0xf
    v_and_b32_dpp v40, v29, v8 row_newbcast:4 row_mask:0xf bank_mask:0xf
    v_and_b32_dpp v41, v29, v9 row_newbcast:4 row_mask:0xf bank_mask:0xf
    v_and_b32_dpp v42, v29, v10 row_newbcast:4 row_mask:0xf bank_mask:0xf
    v_and_b32_dpp v43, v29, v11 row_newbcast:4 row_mask:0xf bank_mask:0xf
    v_and_b32_dpp v44, v29, v8 row_newbcast:12 row_mask:0xf bank_mask:0xf
    v_and_b32_dpp v45, v29, v9 row_newbcast:12 row_mask:0xf bank_mask:0xf
    v_and_b32_dpp v46, v29, v10 row_newbcast:12 row_mask:0xf bank_mask:0xf
    v_and_b32_dpp v47, v29, v11 row_newbcast:12 row_mask:0xf bank_mask:0xf
    v_mfma_f32_16x16x32_bf16 v[12:15], v[32:35], a[16:19], v[12:15]
    v_mfma_f32_16x16x32_bf16 v[12:15], v[36:39], a[20:23], v[12:15]
    v_mfma_f32_16x16x32_bf16 v[12:15], v[40:43], a[24:27], v[12:15]
    v_mfma_f32_16x16x32_bf16 v[12:15], v[44:47], a[28:31], v[12:15]
    buffer_load_dwordx4 a[16:19], v2, s[36:39], s60 offen offset:0 nt
    buffer_load_dwordx4 a[20:23], v2, s[36:39], s60 offen offset:1024 nt
    buffer_load_dwordx4 a[24:27], v2, s[36:39], s60 offen offset:2048 nt
    buffer_load_dwordx4 a[28:31], v2, s[36:39], s60 offen offset:3072 nt
    s_cmp_eq_u32 s62, 0
    s_cbranch_scc1 L_adone
    s_cmp_lg_u32 s56, 0
    s_cbranch_scc1 L_aext1
L_aback1:
    s_cmp_lg_u32 s58, s14
    s_cbranch_scc1 L_aloop
    s_cmp_eq_u32 s14, s15
    s_cbranch_scc1 L_aswitch
    buffer_load_dwordx4 v[60:63], v59, s[44:47], s12 offen sc1
    s_mov_b32 s14, s15
    s_branch L_aloop
L_aswitch:
    s_nop 11
    v_add_f32_dpp v17, v17, v17 row_ror:4 row_mask:0xf bank_mask:0xf
    s_nop 1
    v_add_f32_dpp v17, v17, v17 row_ror:8 row_mask:0xf bank_mask:0xf
    v_mov_b32 v28, v17
    s_nop 1
    v_permlane16_swap_b32 v17, v28
    v_add_f32 v17, v17, v28
    v_mov_b32 v28, v17
    s_nop 1
    v_permlane32_swap_b32 v17, v28
    v_add_f32 v51, v17, v28
    v_mov_b32 v50, v16
    v_cvt_pk_bf16_f32 v52, v12, v13
    v_cvt_pk_bf16_f32 v53, v14, v15
    v_mov_b32 v12, 0
    v_mov_b32 v13, 0
    v_mov_b32 v14, 0
    v_mov_b32 v15, 0
    v_mov_b32 v16, 0xff800000
    v_mov_b32 v17, 0
    s_mov_b32 s13, 1
    s_cmp_eq_u32 s62, 0
    s_cbranch_scc1 L_adone
L_aq2:
    v_max3_u32 v20, v60, v61, v62
    v_max_u32 v20, v20, v63
    v_cmp_eq_u32 vcc, -1, v20
    s_cbranch_vccz L_aq2_ok
    buffer_load_dwordx4 v[60:63], v59, s[44:47], s12 offen sc1
    s_waitcnt vmcnt(0)
    s_sub_u32 s101, s101, 1
    s_cbranch_scc0 L_aq2
    s_mov_b32 s101, 0
L_aq2_ok:
    v_mov_b32 v20, v60
    v_mov_b32 v21, v61
    v_mov_b32 v22, v62
    v_mov_b32 v23, v63
    v_permlane16_swap_b32 v60, v20
    v_permlane16_swap_b32 v61, v21
    v_permlane16_swap_b32 v62, v22
    v_permlane16_swap_b32 v63, v23
    v_add_f32 v60, v60, v20
    v_add_f32 v61, v61, v21
    v_add_f32 v62, v62, v22
    v_add_f32 v63, v63, v23
    v_cvt_pk_bf16_f32 v4, v60, v61
    v_cvt_pk_bf16_f32 v5, v62, v63
    v_mov_b32 v6, v4
    v_mov_b32 v7, v5
    s_nop 0
    v_permlane32_swap_b32 v4, v6
    v_permlane32_swap_b32 v5, v7
    s_branch L_aloop
L_adone:
    s_cmp_eq_u32 s13, 0
    s_cbranch_scc1 L_aswitch
    v_add_f32_dpp v17, v17, v17 row_ror:4 row_mask:0xf bank_mask:0xf
    s_nop 1
    v_add_f32_dpp v17, v17, v17 row_ror:8 row_mask:0xf bank_mask:0xf
    v_mov_b32 v28, v17
    s_nop 1
    v_permlane16_swap_b32 v17, v28
    v_add_f32 v17, v17, v28
    v_mov_b32 v28, v17
    s_nop 1
    v_permlane32_swap_b32 v17, v28
    v_add_f32 v17, v17, v28
    v_cvt_pk_bf16_f32 v54, v12, v13
    v_cvt_pk_bf16_f32 v55, v14, v15
    v_cmp_gt_u32 vcc, 48, v1
    s_nop 1
    v_cndmask_b32 v16, v16, v50, vcc
    v_cndmask_b32 v17, v17, v51, vcc
    v_permlane16_swap_b32 v52, v54
    v_permlane16_swap_b32 v53, v55
    v_cmp_gt_u32 vcc, 32, v1
    s_nop 1
    v_cndmask_b32 v52, v16, v52, vcc
    v_cndmask_b32 v53, v17, v53, vcc
    v_cndmask_b32 v54, v16, v54, vcc
    v_cndmask_b32 v55, v17, v55, vcc
    v_min_u32 v52, -2, v52
    v_min_u32 v53, -2, v53
    v_min_u32 v54, -2, v54
    v_min_u32 v55, -2, v55
    s_mov_b32 s54, 8388608
    buffer_store_dwordx4 v[52:55], v3, s[44:47], s54 offen sc1
    s_endpgm
L_aext0:
    v_dot2_f32_bf16 v20, v96, v4, 0
    v_dot2_f32_bf16 v21, v100, v4, 0
    v_dot2_f32_bf16 v22, v104, v4, 0
    v_dot2_f32_bf16 v23, v108, v4, 0
    v_dot2_f32_bf16 v20, v97, v5, v20
    v_dot2_f32_bf16 v21, v101, v5, v21
    v_dot2_f32_bf16 v22, v105, v5, v22
    v_dot2_f32_bf16 v23, v109, v5, v23
    v_dot2_f32_bf16 v20, v98, v6, v20
    v_dot2_f32_bf16 v21, v102, v6, v21
    v_dot2_f32_bf16 v22, v106, v6, v22
    v_dot2_f32_bf16 v23, v110, v6, v23
    v_dot2_f32_bf16 v20, v99, v7, v20
    v_dot2_f32_bf16 v21, v103, v7, v21
    v_dot2_f32_bf16 v22, v107, v7, v22
    v_dot2_f32_bf16 v23, v111, v7, v23
    v_add_f32_dpp v24, v20, v20 row_ror:8 row_mask:0xf bank_mask:0x3
    s_nop 0
    v_add_f32_dpp v25, v22, v22 row_ror:8 row_mask:0xf bank_mask:0x3
    v_add_f32_dpp v24, v21, v21 row_ror:8 row_mask:0xf bank_mask:0xc
    v_add_f32_dpp v25, v23, v23 row_ror:8 row_mask:0xf bank_mask:0xc
    s_nop 0
    v_add_f32_dpp v26, v24, v24 row_shl:4 row_mask:0xf bank_mask:0x5
    v_add_f32_dpp v26, v25, v25 row_shr:4 row_mask:0xf bank_mask:0xa
    s_nop 1
    v_add_f32_dpp v26, v26, v26 quad_perm:[1,0,3,2] row_mask:0xf bank_mask:0xf
    s_nop 1
    v_add_f32_dpp v26, v26, v26 quad_perm:[2,3,0,1] row_mask:0xf bank_mask:0xf
    v_cvt_pk_bf16_f32 v26, v26, v26
    v_and_b32 v26, s98, v26
    v_mul_f32 v26, s96, v26
    v_cvt_pk_bf16_f32 v26, v26, v26
    v_and_b32 v26, s98, v26
    s_nop 1
    v_max_f32_dpp v27, v26, v26 row_ror:4 row_mask:0xf bank_mask:0xf
    s_nop 1
    v_max_f32_dpp v27, v27, v27 row_ror:8 row_mask:0xf bank_mask:0xf
    v_mov_b32 v28, v27
    s_nop 1
    v_permlane16_swap_b32 v27, v28
    v_max_f32 v27, v27, v28
    v_mov_b32 v28, v27
    s_nop 1
    v_permlane32_swap_b32 v27, v28
    v_max3_f32 v27, v27, v28, v16
    v_sub_f32 v28, v16, v27
    v_sub_f32 v29, v26, v27
    v_mul_f32 v28, s97, v28
    v_mul_f32 v29, s97, v29
    v_exp_f32 v28, v28
    v_exp_f32 v29, v29
    v_mov_b32 v16, v27
    v_fma_f32 v17, v17, v28, v29
    v_cvt_pk_bf16_f32 v29, v29, v29
    v_mul_f32 v12, v12, v28
    v_mul_f32 v13, v13, v28
    v_mul_f32 v14, v14, v28
    v_mul_f32 v15, v15, v28
    v_and_b32_dpp v32, v29, v8 row_newbcast:0 row_mask:0xf bank_mask:0xf
    v_and_b32_dpp v33, v29, v9 row_newbcast:0 row_mask:0xf bank_mask:0xf
    v_and_b32_dpp v34, v29, v10 row_newbcast:0 row_mask:0xf bank_mask:0xf
    v_and_b32_dpp v35, v29, v11 row_newbcast:0 row_mask:0xf bank_mask:0xf
    v_and_b32_dpp v36, v29, v8 row_newbcast:8 row_mask:0xf bank_mask:0xf
    v_and_b32_dpp v37, v29, v9 row_newbcast:8 row_mask:0xf bank_mask:0xf
    v_and_b32_dpp v38, v29, v10 row_newbcast:8 row_mask:0xf bank_mask:0xf
    v_and_b32_dpp v39, v29, v11 row_newbcast:8 row_mask:0xf bank_mask:0xf
    v_and_b32_dpp v40, v29, v8 row_newbcast:4 row_mask:0xf bank_mask:0xf
    v_and_b32_dpp v41, v29, v9 row_newbcast:4 row_mask:0xf bank_mask:0xf
    v_and_b32_dpp v42, v29, v10 row_newbcast:4 row_mask:0xf bank_mask:0xf
    v_and_b32_dpp v43, v29, v11 row_newbcast:4 row_mask:0xf bank_mask:0xf
    v_and_b32_dpp v44, v29, v8 row_newbcast:12 row_mask:0xf bank_mask:0xf
    v_and_b32_dpp v45, v29, v9 row_newbcast:12 row_mask:0xf bank_mask:0xf
    v_and_b32_dpp v46, v29, v10 row_newbcast:12 row_mask:0xf bank_mask:0xf
    v_and_b32_dpp v47, v29, v11 row_newbcast:12 row_mask:0xf bank_mask:0xf
    v_mfma_f32_16x16x32_bf16 v[12:15], v[32:35], a[32:35], v[12:15]
    v_mfma_f32_16x16x32_bf16 v[12:15], v[36:39], a[36:39], v[12:15]
    v_mfma_f32_16x16x32_bf16 v[12:15], v[40:43], a[40:43], v[12:15]
    v_mfma_f32_16x16x32_bf16 v[12:15], v[44:47], a[44:47], v[12:15]
    v_dot2_f32_bf16 v20, v112, v4, 0
    v_dot2_f32_bf16 v21, v116, v4, 0
    v_dot2_f32_bf16 v22, v120, v4, 0
    v_dot2_f32_bf16 v23, v124, v4, 0
    v_dot2_f32_bf16 v20, v113, v5, v20
    v_dot2_f32_bf16 v21, v117, v5, v21
    v_dot2_f32_bf16 v22, v121, v5, v22
    v_dot2_f32_bf16 v23, v125, v5, v23
    v_dot2_f32_bf16 v20, v114, v6, v20
    v_dot2_f32_bf16 v21, v118, v6, v21
    v_dot2_f32_bf16 v22, v122, v6, v22
    v_dot2_f32_bf16 v23, v126, v6, v23
    v_dot2_f32_bf16 v20, v115, v7, v20
    v_dot2_f32_bf16 v21, v119, v7, v21
    v_dot2_f32_bf16 v22, v123, v7, v22
    v_dot2_f32_bf16 v23, v127, v7, v23
    v_add_f32_dpp v24, v20, v20 row_ror:8 row_mask:0xf bank_mask:0x3
    s_nop 0
    v_add_f32_dpp v25, v22, v22 row_ror:8 row_mask:0xf bank_mask:0x3
    v_add_f32_dpp v24, v21, v21 row_ror:8 row_mask:0xf bank_mask:0xc
    v_add_f32_dpp v25, v23, v23 row_ror:8 row_mask:0xf bank_mask:0xc
    s_nop 0
    v_add_f32_dpp v26, v24, v24 row_shl:4 row_mask:0xf bank_mask:0x5
    v_add_f32_dpp v26, v25, v25 row_shr:4 row_mask:0xf bank_mask:0xa
    s_nop 1
    v_add_f32_dpp v26, v26, v26 quad_perm:[1,0,3,2] row_mask:0xf bank_mask:0xf
    s_nop 1
    v_add_f32_dpp v26, v26, v26 quad_perm:[2,3,0,1] row_mask:0xf bank_mask:0xf
    v_cvt_pk_bf16_f32 v26, v26, v26
    v_and_b32 v26, s98, v26
    v_mul_f32 v26, s96, v26
    v_cvt_pk_bf16_f32 v26, v26, v26
    v_and_b32 v26, s98, v26
    s_nop 1
    v_max_f32_dpp v27, v26, v26 row_ror:4 row_mask:0xf bank_mask:0xf
    s_nop 1
    v_max_f32_dpp v27, v27, v27 row_ror:8 row_mask:0xf bank_mask:0xf
    v_mov_b32 v28, v27
    s_nop 1
    v_permlane16_swap_b32 v27, v28
    v_max_f32 v27, v27, v28
    v_mov_b32 v28, v27
    s_nop 1
    v_permlane32_swap_b32 v27, v28
    v_max3_f32 v27, v27, v28, v16
    v_sub_f32 v28, v16, v27
    v_sub_f32 v29, v26, v27
    v_mul_f32 v28, s97, v28
    v_mul_f32 v29, s97, v29
    v_exp_f32 v28, v28
    v_exp_f32 v29, v29
    v_mov_b32 v16, v27
    v_fma_f32 v17, v17, v28, v29
    v_cvt_pk_bf16_f32 v29, v29, v29
    v_mul_f32 v12, v12, v28
    v_mul_f32 v13, v13, v28
    v_mul_f32 v14, v14, v28
    v_mul_f32 v15, v15, v28
    v_and_b32_dpp v32, v29, v8 row_newbcast:0 row_mask:0xf bank_mask:0xf
    v_and_b32_dpp v33, v29, v9 row_newbcast:0 row_mask:0xf bank_mask:0xf
    v_and_b32_dpp v34, v29, v10 row_newbcast:0 row_mask:0xf bank_mask:0xf
    v_and_b32_dpp v35, v29, v11 row_newbcast:0 row_mask:0xf bank_mask:0xf
    v_and_b32_dpp v36, v29, v8 row_newbcast:8 row_mask:0xf bank_mask:0xf
    v_and_b32_dpp v37, v29, v9 row_newbcast:8 row_mask:0xf bank_mask:0xf
    v_and_b32_dpp v38, v29, v10 row_newbcast:8 row_mask:0xf bank_mask:0xf
    v_and_b32_dpp v39, v29, v11 row_newbcast:8 row_mask:0xf bank_mask:0xf
    v_and_b32_dpp v40, v29, v8 row_newbcast:4 row_mask:0xf bank_mask:0xf
    v_and_b32_dpp v41, v29, v9 row_newbcast:4 row_mask:0xf bank_mask:0xf
    v_and_b32_dpp v42, v29, v10 row_newbcast:4 row_mask:0xf bank_mask:0xf
    v_and_b32_dpp v43, v29, v11 row_newbcast:4 row_mask:0xf bank_mask:0xf
    v_and_b32_dpp v44, v29, v8 row_newbcast:12 row_mask:0xf bank_mask:0xf
    v_and_b32_dpp v45, v29, v9 row_newbcast:12 row_mask:0xf bank_mask:0xf
    v_and_b32_dpp v46, v29, v10 row_newbcast:12 row_mask:0xf bank_mask:0xf
    v_and_b32_dpp v47, v29, v11 row_newbcast:12 row_mask:0xf bank_mask:0xf
    v_mfma_f32_16x16x32_bf16 v[12:15], v[32:35], a[48:51], v[12:15]
    v_mfma_f32_16x16x32_bf16 v[12:15], v[36:39], a[52:55], v[12:15]
    v_mfma_f32_16x16x32_bf16 v[12:15], v[40:43], a[56:59], v[12:15]
    v_mfma_f32_16x16x32_bf16 v[12:15], v[44:47], a[60:63], v[12:15]
    v_dot2_f32_bf16 v20, v128, v4, 0
    v_dot2_f32_bf16 v21, v132, v4, 0
    v_dot2_f32_bf16 v22, v136, v4, 0
    v_dot2_f32_bf16 v23, v140, v4, 0
    v_dot2_f32_bf16 v20, v129, v5, v20
    v_dot2_f32_bf16 v21, v133, v5, v21
    v_dot2_f32_bf16 v22, v137, v5, v22
    v_dot2_f32_bf16 v23, v141, v5, v23
    v_dot2_f32_bf16 v20, v130, v6, v20
    v_dot2_f32_bf16 v21, v134, v6, v21
    v_dot2_f32_bf16 v22, v138, v6, v22
    v_dot2_f32_bf16 v23, v142, v6, v23
    v_dot2_f32_bf16 v20, v131, v7, v20
    v_dot2_f32_bf16 v21, v135, v7, v21
    v_dot2_f32_bf16 v22, v139, v7, v22
    v_dot2_f32_bf16 v23, v143, v7, v23
    v_add_f32_dpp v24, v20, v20 row_ror:8 row_mask:0xf bank_mask:0x3
    s_nop 0
    v_add_f32_dpp v25, v22, v22 row_ror:8 row_mask:0xf bank_mask:0x3
    v_add_f32_dpp v24, v21, v21 row_ror:8 row_mask:0xf bank_mask:0xc
    v_add_f32_dpp v25, v23, v23 row_ror:8 row_mask:0xf bank_mask:0xc
    s_nop 0
    v_add_f32_dpp v26, v24, v24 row_shl:4 row_mask:0xf bank_mask:0x5
    v_add_f32_dpp v26, v25, v25 row_shr:4 row_mask:0xf bank_mask:0xa
    s_nop 1
    v_add_f32_dpp v26, v26, v26 quad_perm:[1,0,3,2] row_mask:0xf bank_mask:0xf
    s_nop 1
    v_add_f32_dpp v26, v26, v26 quad_perm:[2,3,0,1] row_mask:0xf bank_mask:0xf
    v_cvt_pk_bf16_f32 v26, v26, v26
    v_and_b32 v26, s98, v26
    v_mul_f32 v26, s96, v26
    v_cvt_pk_bf16_f32 v26, v26, v26
    v_and_b32 v26, s98, v26
    s_nop 1
    v_max_f32_dpp v27, v26, v26 row_ror:4 row_mask:0xf bank_mask:0xf
    s_nop 1
    v_max_f32_dpp v27, v27, v27 row_ror:8 row_mask:0xf bank_mask:0xf
    v_mov_b32 v28, v27
    s_nop 1
    v_permlane16_swap_b32 v27, v28
    v_max_f32 v27, v27, v28
    v_mov_b32 v28, v27
    s_nop 1
    v_permlane32_swap_b32 v27, v28
    v_max3_f32 v27, v27, v28, v16
    v_sub_f32 v28, v16, v27
    v_sub_f32 v29, v26, v27
    v_mul_f32 v28, s97, v28
    v_mul_f32 v29, s97, v29
    v_exp_f32 v28, v28
    v_exp_f32 v29, v29
    v_mov_b32 v16, v27
    v_fma_f32 v17, v17, v28, v29
    v_cvt_pk_bf16_f32 v29, v29, v29
    v_mul_f32 v12, v12, v28
    v_mul_f32 v13, v13, v28
    v_mul_f32 v14, v14, v28
    v_mul_f32 v15, v15, v28
    v_and_b32_dpp v32, v29, v8 row_newbcast:0 row_mask:0xf bank_mask:0xf
    v_and_b32_dpp v33, v29, v9 row_newbcast:0 row_mask:0xf bank_mask:0xf
    v_and_b32_dpp v34, v29, v10 row_newbcast:0 row_mask:0xf bank_mask:0xf
    v_and_b32_dpp v35, v29, v11 row_newbcast:0 row_mask:0xf bank_mask:0xf
    v_and_b32_dpp v36, v29, v8 row_newbcast:8 row_mask:0xf bank_mask:0xf
    v_and_b32_dpp v37, v29, v9 row_newbcast:8 row_mask:0xf bank_mask:0xf
    v_and_b32_dpp v38, v29, v10 row_newbcast:8 row_mask:0xf bank_mask:0xf
    v_and_b32_dpp v39, v29, v11 row_newbcast:8 row_mask:0xf bank_mask:0xf
    v_and_b32_dpp v40, v29, v8 row_newbcast:4 row_mask:0xf bank_mask:0xf
    v_and_b32_dpp v41, v29, v9 row_newbcast:4 row_mask:0xf bank_mask:0xf
    v_and_b32_dpp v42, v29, v10 row_newbcast:4 row_mask:0xf bank_mask:0xf
    v_and_b32_dpp v43, v29, v11 row_newbcast:4 row_mask:0xf bank_mask:0xf
    v_and_b32_dpp v44, v29, v8 row_newbcast:12 row_mask:0xf bank_mask:0xf
    v_and_b32_dpp v45, v29, v9 row_newbcast:12 row_mask:0xf bank_mask:0xf
    v_and_b32_dpp v46, v29, v10 row_newbcast:12 row_mask:0xf bank_mask:0xf
    v_and_b32_dpp v47, v29, v11 row_newbcast:12 row_mask:0xf bank_mask:0xf
    v_mfma_f32_16x16x32_bf16 v[12:15], v[32:35], a[64:67], v[12:15]
    v_mfma_f32_16x16x32_bf16 v[12:15], v[36:39], a[68:71], v[12:15]
    v_mfma_f32_16x16x32_bf16 v[12:15], v[40:43], a[72:75], v[12:15]
    v_mfma_f32_16x16x32_bf16 v[12:15], v[44:47], a[76:79], v[12:15]
    v_dot2_f32_bf16 v20, v144, v4, 0
    v_dot2_f32_bf16 v21, v148, v4, 0
    v_dot2_f32_bf16 v22, v152, v4, 0
    v_dot2_f32_bf16 v23, v156, v4, 0
    v_dot2_f32_bf16 v20, v145, v5, v20
    v_dot2_f32_bf16 v21, v149, v5, v21
    v_dot2_f32_bf16 v22, v153, v5, v22
    v_dot2_f32_bf16 v23, v157, v5, v23
    v_dot2_f32_bf16 v20, v146, v6, v20
    v_dot2_f32_bf16 v21, v150, v6, v21
    v_dot2_f32_bf16 v22, v154, v6, v22
    v_dot2_f32_bf16 v23, v158, v6, v23
    v_dot2_f32_bf16 v20, v147, v7, v20
    v_dot2_f32_bf16 v21, v151, v7, v21
    v_dot2_f32_bf16 v22, v155, v7, v22
    v_dot2_f32_bf16 v23, v159, v7, v23
    v_add_f32_dpp v24, v20, v20 row_ror:8 row_mask:0xf bank_mask:0x3
    s_nop 0
    v_add_f32_dpp v25, v22, v22 row_ror:8 row_mask:0xf bank_mask:0x3
    v_add_f32_dpp v24, v21, v21 row_ror:8 row_mask:0xf bank_mask:0xc
    v_add_f32_dpp v25, v23, v23 row_ror:8 row_mask:0xf bank_mask:0xc
    s_nop 0
    v_add_f32_dpp v26, v24, v24 row_shl:4 row_mask:0xf bank_mask:0x5
    v_add_f32_dpp v26, v25, v25 row_shr:4 row_mask:0xf bank_mask:0xa
    s_nop 1
    v_add_f32_dpp v26, v26, v26 quad_perm:[1,0,3,2] row_mask:0xf bank_mask:0xf
    s_nop 1
    v_add_f32_dpp v26, v26, v26 quad_perm:[2,3,0,1] row_mask:0xf bank_mask:0xf
    v_cvt_pk_bf16_f32 v26, v26, v26
    v_and_b32 v26, s98, v26
    v_mul_f32 v26, s96, v26
    v_cvt_pk_bf16_f32 v26, v26, v26
    v_and_b32 v26, s98, v26
    s_nop 1
    v_max_f32_dpp v27, v26, v26 row_ror:4 row_mask:0xf bank_mask:0xf
    s_nop 1
    v_max_f32_dpp v27, v27, v27 row_ror:8 row_mask:0xf bank_mask:0xf
    v_mov_b32 v28, v27
    s_nop 1
    v_permlane16_swap_b32 v27, v28
    v_max_f32 v27, v27, v28
    v_mov_b32 v28, v27
    s_nop 1
    v_permlane32_swap_b32 v27, v28
    v_max3_f32 v27, v27, v28, v16
    v_sub_f32 v28, v16, v27
    v_sub_f32 v29, v26, v27
    v_mul_f32 v28, s97, v28
    v_mul_f32 v29, s97, v29
    v_exp_f32 v28, v28
    v_exp_f32 v29, v29
    v_mov_b32 v16, v27
    v_fma_f32 v17, v17, v28, v29
    v_cvt_pk_bf16_f32 v29, v29, v29
    v_mul_f32 v12, v12, v28
    v_mul_f32 v13, v13, v28
    v_mul_f32 v14, v14, v28
    v_mul_f32 v15, v15, v28
    v_and_b32_dpp v32, v29, v8 row_newbcast:0 row_mask:0xf bank_mask:0xf
    v_and_b32_dpp v33, v29, v9 row_newbcast:0 row_mask:0xf bank_mask:0xf
    v_and_b32_dpp v34, v29, v10 row_newbcast:0 row_mask:0xf bank_mask:0xf
    v_and_b32_dpp v35, v29, v11 row_newbcast:0 row_mask:0xf bank_mask:0xf
    v_and_b32_dpp v36, v29, v8 row_newbcast:8 row_mask:0xf bank_mask:0xf
    v_and_b32_dpp v37, v29, v9 row_newbcast:8 row_mask:0xf bank_mask:0xf
    v_and_b32_dpp v38, v29, v10 row_newbcast:8 row_mask:0xf bank_mask:0xf
    v_and_b32_dpp v39, v29, v11 row_newbcast:8 row_mask:0xf bank_mask:0xf
    v_and_b32_dpp v40, v29, v8 row_newbcast:4 row_mask:0xf bank_mask:0xf
    v_and_b32_dpp v41, v29, v9 row_newbcast:4 row_mask:0xf bank_mask:0xf
    v_and_b32_dpp v42, v29, v10 row_newbcast:4 row_mask:0xf bank_mask:0xf
    v_and_b32_dpp v43, v29, v11 row_newbcast:4 row_mask:0xf bank_mask:0xf
    v_and_b32_dpp v44, v29, v8 row_newbcast:12 row_mask:0xf bank_mask:0xf
    v_and_b32_dpp v45, v29, v9 row_newbcast:12 row_mask:0xf bank_mask:0xf
    v_and_b32_dpp v46, v29, v10 row_newbcast:12 row_mask:0xf bank_mask:0xf
    v_and_b32_dpp v47, v29, v11 row_newbcast:12 row_mask:0xf bank_mask:0xf
    v_mfma_f32_16x16x32_bf16 v[12:15], v[32:35], a[80:83], v[12:15]
    v_mfma_f32_16x16x32_bf16 v[12:15], v[36:39], a[84:87], v[12:15]
    v_mfma_f32_16x16x32_bf16 v[12:15], v[40:43], a[88:91], v[12:15]
    v_mfma_f32_16x16x32_bf16 v[12:15], v[44:47], a[92:95], v[12:15]
    v_dot2_f32_bf16 v20, v160, v4, 0
    v_dot2_f32_bf16 v21, v164, v4, 0
    v_dot2_f32_bf16 v22, v168, v4, 0
    v_dot2_f32_bf16 v23, v172, v4, 0
    v_dot2_f32_bf16 v20, v161, v5, v20
    v_dot2_f32_bf16 v21, v165, v5, v21
    v_dot2_f32_bf16 v22, v169, v5, v22
    v_dot2_f32_bf16 v23, v173, v5, v23
    v_dot2_f32_bf16 v20, v162, v6, v20
    v_dot2_f32_bf16 v21, v166, v6, v21
    v_dot2_f32_bf16 v22, v170, v6, v22
    v_dot2_f32_bf16 v23, v174, v6, v23
    v_dot2_f32_bf16 v20, v163, v7, v20
    v_dot2_f32_bf16 v21, v167, v7, v21
    v_dot2_f32_bf16 v22, v171, v7, v22
    v_dot2_f32_bf16 v23, v175, v7, v23
    v_add_f32_dpp v24, v20, v20 row_ror:8 row_mask:0xf bank_mask:0x3
    s_nop 0
    v_add_f32_dpp v25, v22, v22 row_ror:8 row_mask:0xf bank_mask:0x3
    v_add_f32_dpp v24, v21, v21 row_ror:8 row_mask:0xf bank_mask:0xc
    v_add_f32_dpp v25, v23, v23 row_ror:8 row_mask:0xf bank_mask:0xc
    s_nop 0
    v_add_f32_dpp v26, v24, v24 row_shl:4 row_mask:0xf bank_mask:0x5
    v_add_f32_dpp v26, v25, v25 row_shr:4 row_mask:0xf bank_mask:0xa
    s_nop 1
    v_add_f32_dpp v26, v26, v26 quad_perm:[1,0,3,2] row_mask:0xf bank_mask:0xf
    s_nop 1
    v_add_f32_dpp v26, v26, v26 quad_perm:[2,3,0,1] row_mask:0xf bank_mask:0xf
    v_cvt_pk_bf16_f32 v26, v26, v26
    v_and_b32 v26, s98, v26
    v_mul_f32 v26, s96, v26
    v_cvt_pk_bf16_f32 v26, v26, v26
    v_and_b32 v26, s98, v26
    s_nop 1
    v_max_f32_dpp v27, v26, v26 row_ror:4 row_mask:0xf bank_mask:0xf
    s_nop 1
    v_max_f32_dpp v27, v27, v27 row_ror:8 row_mask:0xf bank_mask:0xf
    v_mov_b32 v28, v27
    s_nop 1
    v_permlane16_swap_b32 v27, v28
    v_max_f32 v27, v27, v28
    v_mov_b32 v28, v27
    s_nop 1
    v_permlane32_swap_b32 v27, v28
    v_max3_f32 v27, v27, v28, v16
    v_sub_f32 v28, v16, v27
    v_sub_f32 v29, v26, v27
    v_mul_f32 v28, s97, v28
    v_mul_f32 v29, s97, v29
    v_exp_f32 v28, v28
    v_exp_f32 v29, v29
    v_mov_b32 v16, v27
    v_fma_f32 v17, v17, v28, v29
    v_cvt_pk_bf16_f32 v29, v29, v29
    v_mul_f32 v12, v12, v28
    v_mul_f32 v13, v13, v28
    v_mul_f32 v14, v14, v28
    v_mul_f32 v15, v15, v28
    v_and_b32_dpp v32, v29, v8 row_newbcast:0 row_mask:0xf bank_mask:0xf
    v_and_b32_dpp v33, v29, v9 row_newbcast:0 row_mask:0xf bank_mask:0xf
    v_and_b32_dpp v34, v29, v10 row_newbcast:0 row_mask:0xf bank_mask:0xf
    v_and_b32_dpp v35, v29, v11 row_newbcast:0 row_mask:0xf bank_mask:0xf
    v_and_b32_dpp v36, v29, v8 row_newbcast:8 row_mask:0xf bank_mask:0xf
    v_and_b32_dpp v37, v29, v9 row_newbcast:8 row_mask:0xf bank_mask:0xf
    v_and_b32_dpp v38, v29, v10 row_newbcast:8 row_mask:0xf bank_mask:0xf
    v_and_b32_dpp v39, v29, v11 row_newbcast:8 row_mask:0xf bank_mask:0xf
    v_and_b32_dpp v40, v29, v8 row_newbcast:4 row_mask:0xf bank_mask:0xf
    v_and_b32_dpp v41, v29, v9 row_newbcast:4 row_mask:0xf bank_mask:0xf
    v_and_b32_dpp v42, v29, v10 row_newbcast:4 row_mask:0xf bank_mask:0xf
    v_and_b32_dpp v43, v29, v11 row_newbcast:4 row_mask:0xf bank_mask:0xf
    v_and_b32_dpp v44, v29, v8 row_newbcast:12 row_mask:0xf bank_mask:0xf
    v_and_b32_dpp v45, v29, v9 row_newbcast:12 row_mask:0xf bank_mask:0xf
    v_and_b32_dpp v46, v29, v10 row_newbcast:12 row_mask:0xf bank_mask:0xf
    v_and_b32_dpp v47, v29, v11 row_newbcast:12 row_mask:0xf bank_mask:0xf
    v_mfma_f32_16x16x32_bf16 v[12:15], v[32:35], a[96:99], v[12:15]
    v_mfma_f32_16x16x32_bf16 v[12:15], v[36:39], a[100:103], v[12:15]
    v_mfma_f32_16x16x32_bf16 v[12:15], v[40:43], a[104:107], v[12:15]
    v_mfma_f32_16x16x32_bf16 v[12:15], v[44:47], a[108:111], v[12:15]
    s_branch L_aback0
L_aext1:
    v_dot2_f32_bf16 v20, v176, v4, 0
    v_dot2_f32_bf16 v21, v180, v4, 0
    v_dot2_f32_bf16 v22, v184, v4, 0
    v_dot2_f32_bf16 v23, v188, v4, 0
    v_dot2_f32_bf16 v20, v177, v5, v20
    v_dot2_f32_bf16 v21, v181, v5, v21
    v_dot2_f32_bf16 v22, v185, v5, v22
    v_dot2_f32_bf16 v23, v189, v5, v23
    v_dot2_f32_bf16 v20, v178, v6, v20
    v_dot2_f32_bf16 v21, v182, v6, v21
    v_dot2_f32_bf16 v22, v186, v6, v22
    v_dot2_f32_bf16 v23, v190, v6, v23
    v_dot2_f32_bf16 v20, v179, v7, v20
    v_dot2_f32_bf16 v21, v183, v7, v21
    v_dot2_f32_bf16 v22, v187, v7, v22
    v_dot2_f32_bf16 v23, v191, v7, v23
    v_add_f32_dpp v24, v20, v20 row_ror:8 row_mask:0xf bank_mask:0x3
    s_nop 0
    v_add_f32_dpp v25, v22, v22 row_ror:8 row_mask:0xf bank_mask:0x3
    v_add_f32_dpp v24, v21, v21 row_ror:8 row_mask:0xf bank_mask:0xc
    v_add_f32_dpp v25, v23, v23 row_ror:8 row_mask:0xf bank_mask:0xc
    s_nop 0
    v_add_f32_dpp v26, v24, v24 row_shl:4 row_mask:0xf bank_mask:0x5
    v_add_f32_dpp v26, v25, v25 row_shr:4 row_mask:0xf bank_mask:0xa
    s_nop 1
    v_add_f32_dpp v26, v26, v26 quad_perm:[1,0,3,2] row_mask:0xf bank_mask:0xf
    s_nop 1
    v_add_f32_dpp v26, v26, v26 quad_perm:[2,3,0,1] row_mask:0xf bank_mask:0xf
    v_cvt_pk_bf16_f32 v26, v26, v26
    v_and_b32 v26, s98, v26
    v_mul_f32 v26, s96, v26
    v_cvt_pk_bf16_f32 v26, v26, v26
    v_and_b32 v26, s98, v26
    s_nop 1
    v_max_f32_dpp v27, v26, v26 row_ror:4 row_mask:0xf bank_mask:0xf
    s_nop 1
    v_max_f32_dpp v27, v27, v27 row_ror:8 row_mask:0xf bank_mask:0xf
    v_mov_b32 v28, v27
    s_nop 1
    v_permlane16_swap_b32 v27, v28
    v_max_f32 v27, v27, v28
    v_mov_b32 v28, v27
    s_nop 1
    v_permlane32_swap_b32 v27, v28
    v_max3_f32 v27, v27, v28, v16
    v_sub_f32 v28, v16, v27
    v_sub_f32 v29, v26, v27
    v_mul_f32 v28, s97, v28
    v_mul_f32 v29, s97, v29
    v_exp_f32 v28, v28
    v_exp_f32 v29, v29
    v_mov_b32 v16, v27
    v_fma_f32 v17, v17, v28, v29
    v_cvt_pk_bf16_f32 v29, v29, v29
    v_mul_f32 v12, v12, v28
    v_mul_f32 v13, v13, v28
    v_mul_f32 v14, v14, v28
    v_mul_f32 v15, v15, v28
    v_and_b32_dpp v32, v29, v8 row_newbcast:0 row_mask:0xf bank_mask:0xf
    v_and_b32_dpp v33, v29, v9 row_newbcast:0 row_mask:0xf bank_mask:0xf
    v_and_b32_dpp v34, v29, v10 row_newbcast:0 row_mask:0xf bank_mask:0xf
    v_and_b32_dpp v35, v29, v11 row_newbcast:0 row_mask:0xf bank_mask:0xf
    v_and_b32_dpp v36, v29, v8 row_newbcast:8 row_mask:0xf bank_mask:0xf
    v_and_b32_dpp v37, v29, v9 row_newbcast:8 row_mask:0xf bank_mask:0xf
    v_and_b32_dpp v38, v29, v10 row_newbcast:8 row_mask:0xf bank_mask:0xf
    v_and_b32_dpp v39, v29, v11 row_newbcast:8 row_mask:0xf bank_mask:0xf
    v_and_b32_dpp v40, v29, v8 row_newbcast:4 row_mask:0xf bank_mask:0xf
    v_and_b32_dpp v41, v29, v9 row_newbcast:4 row_mask:0xf bank_mask:0xf
    v_and_b32_dpp v42, v29, v10 row_newbcast:4 row_mask:0xf bank_mask:0xf
    v_and_b32_dpp v43, v29, v11 row_newbcast:4 row_mask:0xf bank_mask:0xf
    v_and_b32_dpp v44, v29, v8 row_newbcast:12 row_mask:0xf bank_mask:0xf
    v_and_b32_dpp v45, v29, v9 row_newbcast:12 row_mask:0xf bank_mask:0xf
    v_and_b32_dpp v46, v29, v10 row_newbcast:12 row_mask:0xf bank_mask:0xf
    v_and_b32_dpp v47, v29, v11 row_newbcast:12 row_mask:0xf bank_mask:0xf
    v_mfma_f32_16x16x32_bf16 v[12:15], v[32:35], a[112:115], v[12:15]
    v_mfma_f32_16x16x32_bf16 v[12:15], v[36:39], a[116:119], v[12:15]
    v_mfma_f32_16x16x32_bf16 v[12:15], v[40:43], a[120:123], v[12:15]
    v_mfma_f32_16x16x32_bf16 v[12:15], v[44:47], a[124:127], v[12:15]
    v_dot2_f32_bf16 v20, v192, v4, 0
    v_dot2_f32_bf16 v21, v196, v4, 0
    v_dot2_f32_bf16 v22, v200, v4, 0
    v_dot2_f32_bf16 v23, v204, v4, 0
    v_dot2_f32_bf16 v20, v193, v5, v20
    v_dot2_f32_bf16 v21, v197, v5, v21
    v_dot2_f32_bf16 v22, v201, v5, v22
    v_dot2_f32_bf16 v23, v205, v5, v23
    v_dot2_f32_bf16 v20, v194, v6, v20
    v_dot2_f32_bf16 v21, v198, v6, v21
    v_dot2_f32_bf16 v22, v202, v6, v22
    v_dot2_f32_bf16 v23, v206, v6, v23
    v_dot2_f32_bf16 v20, v195, v7, v20
    v_dot2_f32_bf16 v21, v199, v7, v21
    v_dot2_f32_bf16 v22, v203, v7, v22
    v_dot2_f32_bf16 v23, v207, v7, v23
    v_add_f32_dpp v24, v20, v20 row_ror:8 row_mask:0xf bank_mask:0x3
    s_nop 0
    v_add_f32_dpp v25, v22, v22 row_ror:8 row_mask:0xf bank_mask:0x3
    v_add_f32_dpp v24, v21, v21 row_ror:8 row_mask:0xf bank_mask:0xc
    v_add_f32_dpp v25, v23, v23 row_ror:8 row_mask:0xf bank_mask:0xc
    s_nop 0
    v_add_f32_dpp v26, v24, v24 row_shl:4 row_mask:0xf bank_mask:0x5
    v_add_f32_dpp v26, v25, v25 row_shr:4 row_mask:0xf bank_mask:0xa
    s_nop 1
    v_add_f32_dpp v26, v26, v26 quad_perm:[1,0,3,2] row_mask:0xf bank_mask:0xf
    s_nop 1
    v_add_f32_dpp v26, v26, v26 quad_perm:[2,3,0,1] row_mask:0xf bank_mask:0xf
    v_cvt_pk_bf16_f32 v26, v26, v26
    v_and_b32 v26, s98, v26
    v_mul_f32 v26, s96, v26
    v_cvt_pk_bf16_f32 v26, v26, v26
    v_and_b32 v26, s98, v26
    s_nop 1
    v_max_f32_dpp v27, v26, v26 row_ror:4 row_mask:0xf bank_mask:0xf
    s_nop 1
    v_max_f32_dpp v27, v27, v27 row_ror:8 row_mask:0xf bank_mask:0xf
    v_mov_b32 v28, v27
    s_nop 1
    v_permlane16_swap_b32 v27, v28
    v_max_f32 v27, v27, v28
    v_mov_b32 v28, v27
    s_nop 1
    v_permlane32_swap_b32 v27, v28
    v_max3_f32 v27, v27, v28, v16
    v_sub_f32 v28, v16, v27
    v_sub_f32 v29, v26, v27
    v_mul_f32 v28, s97, v28
    v_mul_f32 v29, s97, v29
    v_exp_f32 v28, v28
    v_exp_f32 v29, v29
    v_mov_b32 v16, v27
    v_fma_f32 v17, v17, v28, v29
    v_cvt_pk_bf16_f32 v29, v29, v29
    v_mul_f32 v12, v12, v28
    v_mul_f32 v13, v13, v28
    v_mul_f32 v14, v14, v28
    v_mul_f32 v15, v15, v28
    v_and_b32_dpp v32, v29, v8 row_newbcast:0 row_mask:0xf bank_mask:0xf
    v_and_b32_dpp v33, v29, v9 row_newbcast:0 row_mask:0xf bank_mask:0xf
    v_and_b32_dpp v34, v29, v10 row_newbcast:0 row_mask:0xf bank_mask:0xf
    v_and_b32_dpp v35, v29, v11 row_newbcast:0 row_mask:0xf bank_mask:0xf
    v_and_b32_dpp v36, v29, v8 row_newbcast:8 row_mask:0xf bank_mask:0xf
    v_and_b32_dpp v37, v29, v9 row_newbcast:8 row_mask:0xf bank_mask:0xf
    v_and_b32_dpp v38, v29, v10 row_newbcast:8 row_mask:0xf bank_mask:0xf
    v_and_b32_dpp v39, v29, v11 row_newbcast:8 row_mask:0xf bank_mask:0xf
    v_and_b32_dpp v40, v29, v8 row_newbcast:4 row_mask:0xf bank_mask:0xf
    v_and_b32_dpp v41, v29, v9 row_newbcast:4 row_mask:0xf bank_mask:0xf
    v_and_b32_dpp v42, v29, v10 row_newbcast:4 row_mask:0xf bank_mask:0xf
    v_and_b32_dpp v43, v29, v11 row_newbcast:4 row_mask:0xf bank_mask:0xf
    v_and_b32_dpp v44, v29, v8 row_newbcast:12 row_mask:0xf bank_mask:0xf
    v_and_b32_dpp v45, v29, v9 row_newbcast:12 row_mask:0xf bank_mask:0xf
    v_and_b32_dpp v46, v29, v10 row_newbcast:12 row_mask:0xf bank_mask:0xf
    v_and_b32_dpp v47, v29, v11 row_newbcast:12 row_mask:0xf bank_mask:0xf
    v_mfma_f32_16x16x32_bf16 v[12:15], v[32:35], a[128:131], v[12:15]
    v_mfma_f32_16x16x32_bf16 v[12:15], v[36:39], a[132:135], v[12:15]
    v_mfma_f32_16x16x32_bf16 v[12:15], v[40:43], a[136:139], v[12:15]
    v_mfma_f32_16x16x32_bf16 v[12:15], v[44:47], a[140:143], v[12:15]
    v_dot2_f32_bf16 v20, v208, v4, 0
    v_dot2_f32_bf16 v21, v212, v4, 0
    v_dot2_f32_bf16 v22, v216, v4, 0
    v_dot2_f32_bf16 v23, v220, v4, 0
    v_dot2_f32_bf16 v20, v209, v5, v20
    v_dot2_f32_bf16 v21, v213, v5, v21
    v_dot2_f32_bf16 v22, v217, v5, v22
    v_dot2_f32_bf16 v23, v221, v5, v23
    v_dot2_f32_bf16 v20, v210, v6, v20
    v_dot2_f32_bf16 v21, v214, v6, v21
    v_dot2_f32_bf16 v22, v218, v6, v22
    v_dot2_f32_bf16 v23, v222, v6, v23
    v_dot2_f32_bf16 v20, v211, v7, v20
    v_dot2_f32_bf16 v21, v215, v7, v21
    v_dot2_f32_bf16 v22, v219, v7, v22
    v_dot2_f32_bf16 v23, v223, v7, v23
    v_add_f32_dpp v24, v20, v20 row_ror:8 row_mask:0xf bank_mask:0x3
    s_nop 0
    v_add_f32_dpp v25, v22, v22 row_ror:8 row_mask:0xf bank_mask:0x3
    v_add_f32_dpp v24, v21, v21 row_ror:8 row_mask:0xf bank_mask:0xc
    v_add_f32_dpp v25, v23, v23 row_ror:8 row_mask:0xf bank_mask:0xc
    s_nop 0
    v_add_f32_dpp v26, v24, v24 row_shl:4 row_mask:0xf bank_mask:0x5
    v_add_f32_dpp v26, v25, v25 row_shr:4 row_mask:0xf bank_mask:0xa
    s_nop 1
    v_add_f32_dpp v26, v26, v26 quad_perm:[1,0,3,2] row_mask:0xf bank_mask:0xf
    s_nop 1
    v_add_f32_dpp v26, v26, v26 quad_perm:[2,3,0,1] row_mask:0xf bank_mask:0xf
    v_cvt_pk_bf16_f32 v26, v26, v26
    v_and_b32 v26, s98, v26
    v_mul_f32 v26, s96, v26
    v_cvt_pk_bf16_f32 v26, v26, v26
    v_and_b32 v26, s98, v26
    s_nop 1
    v_max_f32_dpp v27, v26, v26 row_ror:4 row_mask:0xf bank_mask:0xf
    s_nop 1
    v_max_f32_dpp v27, v27, v27 row_ror:8 row_mask:0xf bank_mask:0xf
    v_mov_b32 v28, v27
    s_nop 1
    v_permlane16_swap_b32 v27, v28
    v_max_f32 v27, v27, v28
    v_mov_b32 v28, v27
    s_nop 1
    v_permlane32_swap_b32 v27, v28
    v_max3_f32 v27, v27, v28, v16
    v_sub_f32 v28, v16, v27
    v_sub_f32 v29, v26, v27
    v_mul_f32 v28, s97, v28
    v_mul_f32 v29, s97, v29
    v_exp_f32 v28, v28
    v_exp_f32 v29, v29
    v_mov_b32 v16, v27
    v_fma_f32 v17, v17, v28, v29
    v_cvt_pk_bf16_f32 v29, v29, v29
    v_mul_f32 v12, v12, v28
    v_mul_f32 v13, v13, v28
    v_mul_f32 v14, v14, v28
    v_mul_f32 v15, v15, v28
    v_and_b32_dpp v32, v29, v8 row_newbcast:0 row_mask:0xf bank_mask:0xf
    v_and_b32_dpp v33, v29, v9 row_newbcast:0 row_mask:0xf bank_mask:0xf
    v_and_b32_dpp v34, v29, v10 row_newbcast:0 row_mask:0xf bank_mask:0xf
    v_and_b32_dpp v35, v29, v11 row_newbcast:0 row_mask:0xf bank_mask:0xf
    v_and_b32_dpp v36, v29, v8 row_newbcast:8 row_mask:0xf bank_mask:0xf
    v_and_b32_dpp v37, v29, v9 row_newbcast:8 row_mask:0xf bank_mask:0xf
    v_and_b32_dpp v38, v29, v10 row_newbcast:8 row_mask:0xf bank_mask:0xf
    v_and_b32_dpp v39, v29, v11 row_newbcast:8 row_mask:0xf bank_mask:0xf
    v_and_b32_dpp v40, v29, v8 row_newbcast:4 row_mask:0xf bank_mask:0xf
    v_and_b32_dpp v41, v29, v9 row_newbcast:4 row_mask:0xf bank_mask:0xf
    v_and_b32_dpp v42, v29, v10 row_newbcast:4 row_mask:0xf bank_mask:0xf
    v_and_b32_dpp v43, v29, v11 row_newbcast:4 row_mask:0xf bank_mask:0xf
    v_and_b32_dpp v44, v29, v8 row_newbcast:12 row_mask:0xf bank_mask:0xf
    v_and_b32_dpp v45, v29, v9 row_newbcast:12 row_mask:0xf bank_mask:0xf
    v_and_b32_dpp v46, v29, v10 row_newbcast:12 row_mask:0xf bank_mask:0xf
    v_and_b32_dpp v47, v29, v11 row_newbcast:12 row_mask:0xf bank_mask:0xf
    v_mfma_f32_16x16x32_bf16 v[12:15], v[32:35], a[144:147], v[12:15]
    v_mfma_f32_16x16x32_bf16 v[12:15], v[36:39], a[148:151], v[12:15]
    v_mfma_f32_16x16x32_bf16 v[12:15], v[40:43], a[152:155], v[12:15]
    v_mfma_f32_16x16x32_bf16 v[12:15], v[44:47], a[156:159], v[12:15]
    v_dot2_f32_bf16 v20, v224, v4, 0
    v_dot2_f32_bf16 v21, v228, v4, 0
    v_dot2_f32_bf16 v22, v232, v4, 0
    v_dot2_f32_bf16 v23, v236, v4, 0
    v_dot2_f32_bf16 v20, v225, v5, v20
    v_dot2_f32_bf16 v21, v229, v5, v21
    v_dot2_f32_bf16 v22, v233, v5, v22
    v_dot2_f32_bf16 v23, v237, v5, v23
    v_dot2_f32_bf16 v20, v226, v6, v20
    v_dot2_f32_bf16 v21, v230, v6, v21
    v_dot2_f32_bf16 v22, v234, v6, v22
    v_dot2_f32_bf16 v23, v238, v6, v23
    v_dot2_f32_bf16 v20, v227, v7, v20
    v_dot2_f32_bf16 v21, v231, v7, v21
    v_dot2_f32_bf16 v22, v235, v7, v22
    v_dot2_f32_bf16 v23, v239, v7, v23
    v_add_f32_dpp v24, v20, v20 row_ror:8 row_mask:0xf bank_mask:0x3
    s_nop 0
    v_add_f32_dpp v25, v22, v22 row_ror:8 row_mask:0xf bank_mask:0x3
    v_add_f32_dpp v24, v21, v21 row_ror:8 row_mask:0xf bank_mask:0xc
    v_add_f32_dpp v25, v23, v23 row_ror:8 row_mask:0xf bank_mask:0xc
    s_nop 0
    v_add_f32_dpp v26, v24, v24 row_shl:4 row_mask:0xf bank_mask:0x5
    v_add_f32_dpp v26, v25, v25 row_shr:4 row_mask:0xf bank_mask:0xa
    s_nop 1
    v_add_f32_dpp v26, v26, v26 quad_perm:[1,0,3,2] row_mask:0xf bank_mask:0xf
    s_nop 1
    v_add_f32_dpp v26, v26, v26 quad_perm:[2,3,0,1] row_mask:0xf bank_mask:0xf
    v_cvt_pk_bf16_f32 v26, v26, v26
    v_and_b32 v26, s98, v26
    v_mul_f32 v26, s96, v26
    v_cvt_pk_bf16_f32 v26, v26, v26
    v_and_b32 v26, s98, v26
    s_nop 1
    v_max_f32_dpp v27, v26, v26 row_ror:4 row_mask:0xf bank_mask:0xf
    s_nop 1
    v_max_f32_dpp v27, v27, v27 row_ror:8 row_mask:0xf bank_mask:0xf
    v_mov_b32 v28, v27
    s_nop 1
    v_permlane16_swap_b32 v27, v28
    v_max_f32 v27, v27, v28
    v_mov_b32 v28, v27
    s_nop 1
    v_permlane32_swap_b32 v27, v28
    v_max3_f32 v27, v27, v28, v16
    v_sub_f32 v28, v16, v27
    v_sub_f32 v29, v26, v27
    v_mul_f32 v28, s97, v28
    v_mul_f32 v29, s97, v29
    v_exp_f32 v28, v28
    v_exp_f32 v29, v29
    v_mov_b32 v16, v27
    v_fma_f32 v17, v17, v28, v29
    v_cvt_pk_bf16_f32 v29, v29, v29
    v_mul_f32 v12, v12, v28
    v_mul_f32 v13, v13, v28
    v_mul_f32 v14, v14, v28
    v_mul_f32 v15, v15, v28
    v_and_b32_dpp v32, v29, v8 row_newbcast:0 row_mask:0xf bank_mask:0xf
    v_and_b32_dpp v33, v29, v9 row_newbcast:0 row_mask:0xf bank_mask:0xf
    v_and_b32_dpp v34, v29, v10 row_newbcast:0 row_mask:0xf bank_mask:0xf
    v_and_b32_dpp v35, v29, v11 row_newbcast:0 row_mask:0xf bank_mask:0xf
    v_and_b32_dpp v36, v29, v8 row_newbcast:8 row_mask:0xf bank_mask:0xf
    v_and_b32_dpp v37, v29, v9 row_newbcast:8 row_mask:0xf bank_mask:0xf
    v_and_b32_dpp v38, v29, v10 row_newbcast:8 row_mask:0xf bank_mask:0xf
    v_and_b32_dpp v39, v29, v11 row_newbcast:8 row_mask:0xf bank_mask:0xf
    v_and_b32_dpp v40, v29, v8 row_newbcast:4 row_mask:0xf bank_mask:0xf
    v_and_b32_dpp v41, v29, v9 row_newbcast:4 row_mask:0xf bank_mask:0xf
    v_and_b32_dpp v42, v29, v10 row_newbcast:4 row_mask:0xf bank_mask:0xf
    v_and_b32_dpp v43, v29, v11 row_newbcast:4 row_mask:0xf bank_mask:0xf
    v_and_b32_dpp v44, v29, v8 row_newbcast:12 row_mask:0xf bank_mask:0xf
    v_and_b32_dpp v45, v29, v9 row_newbcast:12 row_mask:0xf bank_mask:0xf
    v_and_b32_dpp v46, v29, v10 row_newbcast:12 row_mask:0xf bank_mask:0xf
    v_and_b32_dpp v47, v29, v11 row_newbcast:12 row_mask:0xf bank_mask:0xf
    v_mfma_f32_16x16x32_bf16 v[12:15], v[32:35], a[160:163], v[12:15]
    v_mfma_f32_16x16x32_bf16 v[12:15], v[36:39], a[164:167], v[12:15]
    v_mfma_f32_16x16x32_bf16 v[12:15], v[40:43], a[168:171], v[12:15]
    v_mfma_f32_16x16x32_bf16 v[12:15], v[44:47], a[172:175], v[12:15]
    v_dot2_f32_bf16 v20, v240, v4, 0
    v_dot2_f32_bf16 v21, v244, v4, 0
    v_dot2_f32_bf16 v22, v248, v4, 0
    v_dot2_f32_bf16 v23, v252, v4, 0
    v_dot2_f32_bf16 v20, v241, v5, v20
    v_dot2_f32_bf16 v21, v245, v5, v21
    v_dot2_f32_bf16 v22, v249, v5, v22
    v_dot2_f32_bf16 v23, v253, v5, v23
    v_dot2_f32_bf16 v20, v242, v6, v20
    v_dot2_f32_bf16 v21, v246, v6, v21
    v_dot2_f32_bf16 v22, v250, v6, v22
    v_dot2_f32_bf16 v23, v254, v6, v23
    v_dot2_f32_bf16 v20, v243, v7, v20
    v_dot2_f32_bf16 v21, v247, v7, v21
    v_dot2_f32_bf16 v22, v251, v7, v22
    v_dot2_f32_bf16 v23, v255, v7, v23
    v_add_f32_dpp v24, v20, v20 row_ror:8 row_mask:0xf bank_mask:0x3
    s_nop 0
    v_add_f32_dpp v25, v22, v22 row_ror:8 row_mask:0xf bank_mask:0x3
    v_add_f32_dpp v24, v21, v21 row_ror:8 row_mask:0xf bank_mask:0xc
    v_add_f32_dpp v25, v23, v23 row_ror:8 row_mask:0xf bank_mask:0xc
    s_nop 0
    v_add_f32_dpp v26, v24, v24 row_shl:4 row_mask:0xf bank_mask:0x5
    v_add_f32_dpp v26, v25, v25 row_shr:4 row_mask:0xf bank_mask:0xa
    s_nop 1
    v_add_f32_dpp v26, v26, v26 quad_perm:[1,0,3,2] row_mask:0xf bank_mask:0xf
    s_nop 1
    v_add_f32_dpp v26, v26, v26 quad_perm:[2,3,0,1] row_mask:0xf bank_mask:0xf
    v_cvt_pk_bf16_f32 v26, v26, v26
    v_and_b32 v26, s98, v26
    v_mul_f32 v26, s96, v26
    v_cvt_pk_bf16_f32 v26, v26, v26
    v_and_b32 v26, s98, v26
    s_nop 1
    v_max_f32_dpp v27, v26, v26 row_ror:4 row_mask:0xf bank_mask:0xf
    s_nop 1
    v_max_f32_dpp v27, v27, v27 row_ror:8 row_mask:0xf bank_mask:0xf
    v_mov_b32 v28, v27
    s_nop 1
    v_permlane16_swap_b32 v27, v28
    v_max_f32 v27, v27, v28
    v_mov_b32 v28, v27
    s_nop 1
    v_permlane32_swap_b32 v27, v28
    v_max3_f32 v27, v27, v28, v16
    v_sub_f32 v28, v16, v27
    v_sub_f32 v29, v26, v27
    v_mul_f32 v28, s97, v28
    v_mul_f32 v29, s97, v29
    v_exp_f32 v28, v28
    v_exp_f32 v29, v29
    v_mov_b32 v16, v27
    v_fma_f32 v17, v17, v28, v29
    v_cvt_pk_bf16_f32 v29, v29, v29
    v_mul_f32 v12, v12, v28
    v_mul_f32 v13, v13, v28
    v_mul_f32 v14, v14, v28
    v_mul_f32 v15, v15, v28
    v_and_b32_dpp v32, v29, v8 row_newbcast:0 row_mask:0xf bank_mask:0xf
    v_and_b32_dpp v33, v29, v9 row_newbcast:0 row_mask:0xf bank_mask:0xf
    v_and_b32_dpp v34, v29, v10 row_newbcast:0 row_mask:0xf bank_mask:0xf
    v_and_b32_dpp v35, v29, v11 row_newbcast:0 row_mask:0xf bank_mask:0xf
    v_and_b32_dpp v36, v29, v8 row_newbcast:8 row_mask:0xf bank_mask:0xf
    v_and_b32_dpp v37, v29, v9 row_newbcast:8 row_mask:0xf bank_mask:0xf
    v_and_b32_dpp v38, v29, v10 row_newbcast:8 row_mask:0xf bank_mask:0xf
    v_and_b32_dpp v39, v29, v11 row_newbcast:8 row_mask:0xf bank_mask:0xf
    v_and_b32_dpp v40, v29, v8 row_newbcast:4 row_mask:0xf bank_mask:0xf
    v_and_b32_dpp v41, v29, v9 row_newbcast:4 row_mask:0xf bank_mask:0xf
    v_and_b32_dpp v42, v29, v10 row_newbcast:4 row_mask:0xf bank_mask:0xf
    v_and_b32_dpp v43, v29, v11 row_newbcast:4 row_mask:0xf bank_mask:0xf
    v_and_b32_dpp v44, v29, v8 row_newbcast:12 row_mask:0xf bank_mask:0xf
    v_and_b32_dpp v45, v29, v9 row_newbcast:12 row_mask:0xf bank_mask:0xf
    v_and_b32_dpp v46, v29, v10 row_newbcast:12 row_mask:0xf bank_mask:0xf
    v_and_b32_dpp v47, v29, v11 row_newbcast:12 row_mask:0xf bank_mask:0xf
    v_mfma_f32_16x16x32_bf16 v[12:15], v[32:35], a[176:179], v[12:15]
    v_mfma_f32_16x16x32_bf16 v[12:15], v[36:39], a[180:183], v[12:15]
    v_mfma_f32_16x16x32_bf16 v[12:15], v[40:43], a[184:187], v[12:15]
    v_mfma_f32_16x16x32_bf16 v[12:15], v[44:47], a[188:191], v[12:15]
    s_mov_b32 s56, 0
    s_branch L_aback1
L_aflag:
    s_sleep 2
    global_load_dword v57, v58, s[28:29] sc1
    s_waitcnt vmcnt(0)
    v_cmp_gt_u32 vcc, 2, v57
    s_cbranch_vccz L_aflag_ok
    s_sub_u32 s101, s101, 1
    s_cbranch_scc0 L_aflag
    s_mov_b32 s101, 0
    s_branch L_aflag_ok
L_roleA_end:
L_roleH:
    s_mov_b32 s101, 100000
    s_getpc_b64 s[56:57]
L_pc_2:
    s_sub_u32 s56, s56, L_pc_2-L_roleH
    s_subb_u32 s57, s57, 0
    v_lshlrev_b32 v5, 7, v0
    v_min_u32 v6, L_roleH_end-L_roleH-4, v5
    global_load_dword v122, v6, s[56:57]
    v_mov_b32 v20, -1
    v_mov_b32 v21, -1
    v_mov_b32 v22, -1
    v_mov_b32 v23, -1
    v_mul_u32_u24 v7, 73728, v4
    v_lshrrev_b32 v5, 3, v3
    v_lshl_add_u32 v6, v5, 13, v7
    v_and_b32 v5, 7, v3
    v_lshl_add_u32 v6, v5, 4, v6
    v_lshl_add_u32 v7, v3, 3, v7
    v_add_u32 v7, 65536, v7
    s_lshl_b32 s56, s52, 7
    s_add_u32 s56, s56, 4718592
    s_lshl_b32 s54, s3, 14
    s_add_u32 s54, s54, s56
    s_add_u32 s55, s54, 4096
    s_and_b32 s57, s3, 1
    s_lshl_b32 s57, s57, 12
    s_add_u32 s56, s56, s57
    s_waitcnt lgkmcnt(0)
    s_mov_b32 s44, s30
    s_mov_b32 s45, s31
    s_mov_b32 s46, 536870912
    s_mov_b32 s47, 0x20000
    buffer_store_dwordx4 v[20:23], v6, s[44:47], s54 offen sc1
    buffer_store_dwordx4 v[20:23], v6, s[44:47], s55 offen sc1
    buffer_store_dwordx2 v[20:21], v7, s[44:47], s56 offen sc1
    v_lshrrev_b32 v5, 2, v3
    v_lshlrev_b32 v5, 15, v5
    v_lshl_add_u32 v5, v4, 4, v5
    v_and_b32 v6, 3, v3
    v_lshl_add_u32 v5, v6, 6, v5
    s_lshl_b32 s54, s52, 10
    s_lshl_b32 s55, s3, 8
    s_add_u32 s54, s54, s55
    s_add_u32 s54, s54, 1048576
    buffer_store_dwordx4 v[20:23], v5, s[44:47], s54 offen sc1
    v_mov_b32 v7, 536870912
    v_cmp_gt_u32 vcc, 32, v1
    s_nop 1
    v_cndmask_b32 v123, v7, v2, vcc
    s_lshl_b32 s98, s52, 12
    s_lshl_b32 s54, s3, 9
    s_add_u32 s98, s98, s54
    s_add_u32 s98, s98, 5242880
    buffer_store_dwordx4 v[20:23], v123, s[44:47], s98 offen sc1
    s_mov_b32 s40, s10
    s_mov_b32 s41, s11
    s_mov_b32 s42, 4718592
    s_mov_b32 s43, 0x20000
    s_mov_b32 s48, s4
    s_mov_b32 s49, s5
    s_mov_b32 s50, 4608
    s_mov_b32 s51, 0x20000
    v_lshrrev_b32 v5, 3, v3
    v_mul_u32_u24 v5, 1152, v5
    v_mul_u32_u24 v6, 36, v4
    v_add_u32 v5, v5, v6
    s_mul_i32 s54, s3, 144
    buffer_load_dwordx4 v[24:27], v5, s[48:51], s54 offen offset:0
    buffer_load_dwordx4 v[28:31], v5, s[48:51], s54 offen offset:16
    buffer_load_dword v32, v5, s[48:51], s54 offen offset:32
    buffer_load_dwordx4 v[36:39], v5, s[48:51], s54 offen offset:2304
    buffer_load_dwordx4 v[40:43], v5, s[48:51], s54 offen offset:2320
    buffer_load_dword v44, v5, s[48:51], s54 offen offset:2336
    v_mul_u32_u24 v120, 147456, v4
    v_lshl_add_u32 v120, v3, 4, v120
    s_mul_i32 s61, s3, 589824
    s_lshl_b32 s54, s52, 8
    s_add_u32 s61, s61, s54
    buffer_load_dwordx4 a[0:3], v120, s[40:43], s61 offen nt
    s_add_u32 s61, s61, 8192
    buffer_load_dwordx4 a[4:7], v120, s[40:43], s61 offen nt
    s_add_u32 s61, s61, 8192
    buffer_load_dwordx4 a[8:11], v120, s[40:43], s61 offen nt
    s_add_u32 s61, s61, 8192
    buffer_load_dwordx4 a[12:15], v120, s[40:43], s61 offen nt
    s_add_u32 s61, s61, 8192
    buffer_load_dwordx4 a[16:19], v120, s[40:43], s61 offen nt
    s_add_u32 s61, s61, 8192
    buffer_load_dwordx4 a[20:23], v120, s[40:43], s61 offen nt
    s_add_u32 s61, s61, 8192
    buffer_load_dwordx4 a[24:27], v120, s[40:43], s61 offen nt
    s_add_u32 s61, s61, 8192
    buffer_load_dwordx4 a[28:31], v120, s[40:43], s61 offen nt
    s_add_u32 s61, s61, 8192
    buffer_load_dwordx4 a[32:35], v120, s[40:43], s61 offen nt
    s_add_u32 s61, s61, 8192
    buffer_load_dwordx4 a[36:39], v120, s[40:43], s61 offen nt
    s_add_u32 s61, s61, 8192
    buffer_load_dwordx4 a[40:43], v120, s[40:43], s61 offen nt
    s_add_u32 s61, s61, 8192
    buffer_load_dwordx4 a[44:47], v120, s[40:43], s61 offen nt
    s_add_u32 s61, s61, 8192
    buffer_load_dwordx4 a[48:51], v120, s[40:43], s61 offen nt
    s_add_u32 s61, s61, 8192
    buffer_load_dwordx4 a[52:55], v120, s[40:43], s61 offen nt
    s_add_u32 s61, s61, 8192
    buffer_load_dwordx4 a[56:59], v120, s[40:43], s61 offen nt
    s_add_u32 s61, s61, 8192
    buffer_load_dwordx4 a[60:63], v120, s[40:43], s61 offen nt
    s_add_u32 s61, s61, 8192
    buffer_load_dwordx4 a[64:67], v120, s[40:43], s61 offen nt
    s_add_u32 s61, s61, 8192
    buffer_load_dwordx4 a[68:71], v120, s[40:43], s61 offen nt
    s_add_u32 s61, s61, 8192
    s_mov_b32 s32, s18
    s_mov_b32 s33, s19
    s_mov_b32 s34, 4718592
    s_mov_b32 s35, 0x20000
    s_mov_b32 s36, s14
    s_mov_b32 s37, s15
    s_mov_b32 s38, 4608
    s_mov_b32 s39, 0x20000
    v_lshrrev_b32 v5, 3, v3
    v_mul_u32_u24 v5, 1152, v5
    v_mul_u32_u24 v6, 72, v4
    v_add_u32 v5, v5, v6
    s_mul_i32 s54, s3, 288
    buffer_load_dwordx4 v[48:51], v5, s[36:39], s54 offen offset:0
    buffer_load_dwordx4 v[52:55], v5, s[36:39], s54 offen offset:16
    buffer_load_dwordx4 v[56:59], v5, s[36:39], s54 offen offset:32
    buffer_load_dwordx4 v[60:63], v5, s[36:39], s54 offen offset:48
    buffer_load_dwordx2 v[64:65], v5, s[36:39], s54 offen offset:64
    buffer_load_dwordx4 v[68:71], v5, s[36:39], s54 offen offset:2304
    buffer_load_dwordx4 v[72:75], v5, s[36:39], s54 offen offset:2320
    buffer_load_dwordx4 v[76:79], v5, s[36:39], s54 offen offset:2336
    buffer_load_dwordx4 v[80:83], v5, s[36:39], s54 offen offset:2352
    buffer_load_dwordx2 v[84:85], v5, s[36:39], s54 offen offset:2368
    v_mul_u32_u24 v120, 294912, v4
    v_lshl_add_u32 v120, v3, 4, v120
    s_mul_i32 s61, s3, 1179648
    s_lshl_b32 s54, s52, 8
    s_add_u32 s61, s61, s54
    buffer_load_dwordx4 a[112:115], v120, s[32:35], s61 offen nt
    s_add_u32 s61, s61, 8192
    buffer_load_dwordx4 a[116:119], v120, s[32:35], s61 offen nt
    s_add_u32 s61, s61, 8192
    buffer_load_dwordx4 a[120:123], v120, s[32:35], s61 offen nt
    s_add_u32 s61, s61, 8192
    buffer_load_dwordx4 a[124:127], v120, s[32:35], s61 offen nt
    s_add_u32 s61, s61, 8192
    buffer_load_dwordx4 a[128:131], v120, s[32:35], s61 offen nt
    s_add_u32 s61, s61, 8192
    buffer_load_dwordx4 a[132:135], v120, s[32:35], s61 offen nt
    s_add_u32 s61, s61, 8192
    buffer_load_dwordx4 a[136:139], v120, s[32:35], s61 offen nt
    s_add_u32 s61, s61, 8192
    buffer_load_dwordx4 a[140:143], v120, s[32:35], s61 offen nt
    s_add_u32 s61, s61, 8192
    buffer_load_dwordx4 a[144:147], v120, s[32:35], s61 offen nt
    s_add_u32 s61, s61, 8192
    s_mov_b32 s36, s20
    s_mov_b32 s37, s21
    s_mov_b32 s38, 4194304
    s_mov_b32 s39, 0x20000
    s_mov_b32 s40, s22
    s_mov_b32 s41, s23
    s_mov_b32 s42, 4194304
    s_mov_b32 s43, 0x20000
    v_lshlrev_b32 v5, 2, v4
    v_xor_b32 v5, v5, v3
    v_lshlrev_b32 v6, 13, v4
    v_xor_b32 v7, 0, v5
    v_lshl_add_u32 v88, v7, 4, v6
    v_xor_b32 v7, 1, v5
    v_lshl_add_u32 v89, v7, 4, v6
    v_xor_b32 v7, 2, v5
    v_lshl_add_u32 v90, v7, 4, v6
    v_xor_b32 v7, 3, v5
    v_lshl_add_u32 v91, v7, 4, v6
    s_lshl_b32 s62, s3, 20
    s_lshl_b32 s54, s52, 8
    s_add_u32 s62, s62, s54
    s_mov_b32 s60, s62
    s_lshl_b32 s63, s3, 15
    v_lshlrev_b32 v121, 18, v4
    v_lshl_add_u32 v121, v3, 4, v121
    v_lshrrev_b32 v5, 2, v3
    v_and_b32 v6, 3, v3
    v_lshl_add_u32 v7, v5, 3, v6
    v_lshlrev_b32 v92, 8, v7
    v_lshl_or_b32 v5, v6, 2, v5
    v_xor_b32 v5, v5, v4
    v_lshl_add_u32 v92, v5, 4, v92
    v_add_u32 v92, s63, v92
    v_xor_b32 v93, 64, v92
    v_xor_b32 v94, 128, v92
    v_xor_b32 v95, 192, v92
    v_and_b32 v5, 1, v3
    v_cmp_eq_u32 vcc, 1, v5
    v_mov_b32 v5, 0x0c0c0100
    v_mov_b32 v6, 0x01000c0c
    v_cndmask_b32 v5, v5, v6, vcc
    v_mov_b32 v6, 0x0c0c0302
    v_mov_b32 v7, 0x03020c0c
    v_cndmask_b32 v6, v6, v7, vcc
    v_bfe_u32 v7, v3, 1, 2
    v_mov_b32 v16, 0x0c0c0c0c
    v_cmp_eq_u32 vcc, 0, v7
    s_nop 1
    v_cndmask_b32 v8, v16, v5, vcc
    v_cndmask_b32 v9, v16, v6, vcc
    v_cmp_eq_u32 vcc, 1, v7
    s_nop 1
    v_cndmask_b32 v10, v16, v5, vcc
    v_cndmask_b32 v11, v16, v6, vcc
    v_cmp_eq_u32 vcc, 2, v7
    s_nop 1
    v_cndmask_b32 v12, v16, v5, vcc
    v_cndmask_b32 v13, v16, v6, vcc
    v_cmp_eq_u32 vcc, 3, v7
    s_nop 1
    v_cndmask_b32 v14, v16, v5, vcc
    v_cndmask_b32 v15, v16, v6, vcc
    s_waitcnt vmcnt(43)
    s_barrier
    s_cmp_lg_u32 s3, 0
    s_cbranch_scc1 L_nosig_3
    s_lshl_b32 s54, s52, 2
    v_mov_b32 v5, s54
    v_mov_b32 v6, 1
    s_mov_b64 exec, 1
    global_atomic_add v5, v6, s[28:29]
    s_mov_b64 exec, -1
L_nosig_3:
    s_waitcnt vmcnt(28)
    buffer_load_dwordx4 a[148:151], v120, s[32:35], s61 offen nt
    s_add_u32 s61, s61, 8192
    buffer_load_dwordx4 a[152:155], v120, s[32:35], s61 offen nt
    s_add_u32 s61, s61, 8192
    buffer_load_dwordx4 a[156:159], v120, s[32:35], s61 offen nt
    s_add_u32 s61, s61, 8192
    buffer_load_dwordx4 a[160:163], v120, s[32:35], s61 offen nt
    s_add_u32 s61, s61, 8192
    buffer_load_dwordx4 a[164:167], v120, s[32:35], s61 offen nt
    s_add_u32 s61, s61, 8192
    buffer_load_dwordx4 a[168:171], v120, s[32:35], s61 offen nt
    s_add_u32 s61, s61, 8192
    buffer_load_dwordx4 a[172:175], v120, s[32:35], s61 offen nt
    s_add_u32 s61, s61, 8192
    buffer_load_dwordx4 a[176:179], v120, s[32:35], s61 offen nt
    s_add_u32 s61, s61, 8192
    buffer_load_dwordx4 a[180:183], v120, s[32:35], s61 offen nt
    s_add_u32 s61, s61, 8192
    buffer_load_dwordx4 a[184:187], v120, s[32:35], s61 offen nt
    s_add_u32 s61, s61, 8192
    v_perm_b32 v96, v24, v24, v8
    v_perm_b32 v97, v24, v24, v10
    v_perm_b32 v98, v24, v24, v12
    v_perm_b32 v99, v24, v24, v14
    s_nop 1
    v_mfma_f32_16x16x32_bf16 v[112:115], v[96:99], a[0:3], 0
    v_perm_b32 v100, v36, v36, v8
    v_perm_b32 v101, v36, v36, v10
    v_perm_b32 v102, v36, v36, v12
    v_perm_b32 v103, v36, v36, v14
    s_nop 1
    v_mfma_f32_16x16x32_bf16 v[116:119], v[100:103], a[0:3], 0
    v_perm_b32 v104, v24, v24, v9
    v_perm_b32 v105, v24, v24, v11
    v_perm_b32 v106, v24, v24, v13
    v_perm_b32 v107, v24, v24, v15
    s_nop 1
    v_mfma_f32_16x16x32_bf16 v[112:115], v[104:107], a[4:7], v[112:115]
    v_perm_b32 v108, v36, v36, v9
    v_perm_b32 v109, v36, v36, v11
    v_perm_b32 v110, v36, v36, v13
    v_perm_b32 v111, v36, v36, v15
    s_nop 1
    v_mfma_f32_16x16x32_bf16 v[116:119], v[108:111], a[4:7], v[116:119]
    v_perm_b32 v96, v25, v25, v8
    v_perm_b32 v97, v25, v25, v10
    v_perm_b32 v98, v25, v25, v12
    v_perm_b32 v99, v25, v25, v14
    s_nop 1
    v_mfma_f32_16x16x32_bf16 v[112:115], v[96:99], a[8:11], v[112:115]
    v_perm_b32 v100, v37, v37, v8
    v_perm_b32 v101, v37, v37, v10
    v_perm_b32 v102, v37, v37, v12
    v_perm_b32 v103, v37, v37, v14
    s_nop 1
    v_mfma_f32_16x16x32_bf16 v[116:119], v[100:103], a[8:11], v[116:119]
    v_perm_b32 v104, v25, v25, v9
    v_perm_b32 v105, v25, v25, v11
    v_perm_b32 v106, v25, v25, v13
    v_perm_b32 v107, v25, v25, v15
    s_nop 1
    v_mfma_f32_16x16x32_bf16 v[112:115], v[104:107], a[12:15], v[112:115]
    v_perm_b32 v108, v37, v37, v9
    v_perm_b32 v109, v37, v37, v11
    v_perm_b32 v110, v37, v37, v13
    v_perm_b32 v111, v37, v37, v15
    s_nop 1
    v_mfma_f32_16x16x32_bf16 v[116:119], v[108:111], a[12:15], v[116:119]
    v_perm_b32 v96, v26, v26, v8
    v_perm_b32 v97, v26, v26, v10
    v_perm_b32 v98, v26, v26, v12
    v_perm_b32 v99, v26, v26, v14
    s_nop 1
    v_mfma_f32_16x16x32_bf16 v[112:115], v[96:99], a[16:19], v[112:115]
    v_perm_b32 v100, v38, v38, v8
    v_perm_b32 v101, v38, v38, v10
    v_perm_b32 v102, v38, v38, v12
    v_perm_b32 v103, v38, v38, v14
    s_nop 1
    v_mfma_f32_16x16x32_bf16 v[116:119], v[100:103], a[16:19], v[116:119]
    v_perm_b32 v104, v26, v26, v9
    v_perm_b32 v105, v26, v26, v11
    v_perm_b32 v106, v26, v26, v13
    v_perm_b32 v107, v26, v26, v15
    s_nop 1
    v_mfma_f32_16x16x32_bf16 v[112:115], v[104:107], a[20:23], v[112:115]
    v_perm_b32 v108, v38, v38, v9
    v_perm_b32 v109, v38, v38, v11
    v_perm_b32 v110, v38, v38, v13
    v_perm_b32 v111, v38, v38, v15
    s_nop 1
    v_mfma_f32_16x16x32_bf16 v[116:119], v[108:111], a[20:23], v[116:119]
    v_perm_b32 v96, v27, v27, v8
    v_perm_b32 v97, v27, v27, v10
    v_perm_b32 v98, v27, v27, v12
    v_perm_b32 v99, v27, v27, v14
    s_nop 1
    v_mfma_f32_16x16x32_bf16 v[112:115], v[96:99], a[24:27], v[112:115]
    v_perm_b32 v100, v39, v39, v8
    v_perm_b32 v101, v39, v39, v10
    v_perm_b32 v102, v39, v39, v12
    v_perm_b32 v103, v39, v39, v14
    s_nop 1
    v_mfma_f32_16x16x32_bf16 v[116:119], v[100:103], a[24:27], v[116:119]
    v_perm_b32 v104, v27, v27, v9
    v_perm_b32 v105, v27, v27, v11
    v_perm_b32 v106, v27, v27, v13
    v_perm_b32 v107, v27, v27, v15
    s_nop 1
    v_mfma_f32_16x16x32_bf16 v[112:115], v[104:107], a[28:31], v[112:115]
    v_perm_b32 v108, v39, v39, v9
    v_perm_b32 v109, v39, v39, v11
    v_perm_b32 v110, v39, v39, v13
    v_perm_b32 v111, v39, v39, v15
    s_nop 1
    v_mfma_f32_16x16x32_bf16 v[116:119], v[108:111], a[28:31], v[116:119]
    v_perm_b32 v96, v28, v28, v8
    v_perm_b32 v97, v28, v28, v10
    v_perm_b32 v98, v28, v28, v12
    v_perm_b32 v99, v28, v28, v14
    s_nop 1
    v_mfma_f32_16x16x32_bf16 v[112:115], v[96:99], a[32:35], v[112:115]
    v_perm_b32 v100, v40, v40, v8
    v_perm_b32 v101, v40, v40, v10
    v_perm_b32 v102, v40, v40, v12
    v_perm_b32 v103, v40, v40, v14
    s_nop 1
    v_mfma_f32_16x16x32_bf16 v[116:119], v[100:103], a[32:35], v[116:119]
    s_waitcnt vmcnt(29)
    buffer_load_dwordx4 a[188:191], v120, s[32:35], s61 offen nt
    s_add_u32 s61, s61, 8192
    buffer_load_dwordx4 a[192:195], v120, s[32:35], s61 offen nt
    s_add_u32 s61, s61, 8192
    buffer_load_dwordx4 a[196:199], v120, s[32:35], s61 offen nt
    s_add_u32 s61, s61, 8192
    buffer_load_dwordx4 a[200:203], v120, s[32:35], s61 offen nt
    s_add_u32 s61, s61, 8192
    buffer_load_dwordx4 a[204:207], v120, s[32:35], s61 offen nt
    s_add_u32 s61, s61, 8192
    buffer_load_dwordx4 a[208:211], v120, s[32:35], s61 offen nt
    s_add_u32 s61, s61, 8192
    buffer_load_dwordx4 a[212:215], v120, s[32:35], s61 offen nt
    s_add_u32 s61, s61, 8192
    buffer_load_dwordx4 a[216:219], v120, s[32:35], s61 offen nt
    s_add_u32 s61, s61, 8192
    buffer_load_dwordx4 a[220:223], v120, s[32:35], s61 offen nt
    s_add_u32 s61, s61, 8192
    v_perm_b32 v104, v28, v28, v9
    v_perm_b32 v105, v28, v28, v11
    v_perm_b32 v106, v28, v28, v13
    v_perm_b32 v107, v28, v28, v15
    s_nop 1
    v_mfma_f32_16x16x32_bf16 v[112:115], v[104:107], a[36:39], v[112:115]
    v_perm_b32 v108, v40, v40, v9
    v_perm_b32 v109, v40, v40, v11
    v_perm_b32 v110, v40, v40, v13
    v_perm_b32 v111, v40, v40, v15
    s_nop 1
    v_mfma_f32_16x16x32_bf16 v[116:119], v[108:111], a[36:39], v[116:119]
    v_perm_b32 v96, v29, v29, v8
    v_perm_b32 v97, v29, v29, v10
    v_perm_b32 v98, v29, v29, v12
    v_perm_b32 v99, v29, v29, v14
    s_nop 1
    v_mfma_f32_16x16x32_bf16 v[112:115], v[96:99], a[40:43], v[112:115]
    v_perm_b32 v100, v41, v41, v8
    v_perm_b32 v101, v41, v41, v10
    v_perm_b32 v102, v41, v41, v12
    v_perm_b32 v103, v41, v41, v14
    s_nop 1
    v_mfma_f32_16x16x32_bf16 v[116:119], v[100:103], a[40:43], v[116:119]
    v_perm_b32 v104, v29, v29, v9
    v_perm_b32 v105, v29, v29, v11
    v_perm_b32 v106, v29, v29, v13
    v_perm_b32 v107, v29, v29, v15
    s_nop 1
    v_mfma_f32_16x16x32_bf16 v[112:115], v[104:107], a[44:47], v[112:115]
    v_perm_b32 v108, v41, v41, v9
    v_perm_b32 v109, v41, v41, v11
    v_perm_b32 v110, v41, v41, v13
    v_perm_b32 v111, v41, v41, v15
    s_nop 1
    v_mfma_f32_16x16x32_bf16 v[116:119], v[108:111], a[44:47], v[116:119]
    v_perm_b32 v96, v30, v30, v8
    v_perm_b32 v97, v30, v30, v10
    v_perm_b32 v98, v30, v30, v12
    v_perm_b32 v99, v30, v30, v14
    s_nop 1
    v_mfma_f32_16x16x32_bf16 v[112:115], v[96:99], a[48:51], v[112:115]
    v_perm_b32 v100, v42, v42, v8
    v_perm_b32 v101, v42, v42, v10
    v_perm_b32 v102, v42, v42, v12
    v_perm_b32 v103, v42, v42, v14
    s_nop 1
    v_mfma_f32_16x16x32_bf16 v[116:119], v[100:103], a[48:51], v[116:119]
    v_perm_b32 v104, v30, v30, v9
    v_perm_b32 v105, v30, v30, v11
    v_perm_b32 v106, v30, v30, v13
    v_perm_b32 v107, v30, v30, v15
    s_nop 1
    v_mfma_f32_16x16x32_bf16 v[112:115], v[104:107], a[52:55], v[112:115]
    v_perm_b32 v108, v42, v42, v9
    v_perm_b32 v109, v42, v42, v11
    v_perm_b32 v110, v42, v42, v13
    v_perm_b32 v111, v42, v42, v15
    s_nop 1
    v_mfma_f32_16x16x32_bf16 v[116:119], v[108:111], a[52:55], v[116:119]
    v_perm_b32 v96, v31, v31, v8
    v_perm_b32 v97, v31, v31, v10
    v_perm_b32 v98, v31, v31, v12
    v_perm_b32 v99, v31, v31, v14
    s_nop 1
    v_mfma_f32_16x16x32_bf16 v[112:115], v[96:99], a[56:59], v[112:115]
    v_perm_b32 v100, v43, v43, v8
    v_perm_b32 v101, v43, v43, v10
    v_perm_b32 v102, v43, v43, v12
    v_perm_b32 v103, v43, v43, v14
    s_nop 1
    v_mfma_f32_16x16x32_bf16 v[116:119], v[100:103], a[56:59], v[116:119]
    v_perm_b32 v104, v31, v31, v9
    v_perm_b32 v105, v31, v31, v11
    v_perm_b32 v106, v31, v31, v13
    v_perm_b32 v107, v31, v31, v15
    s_nop 1
    v_mfma_f32_16x16x32_bf16 v[112:115], v[104:107], a[60:63], v[112:115]
    v_perm_b32 v108, v43, v43, v9
    v_perm_b32 v109, v43, v43, v11
    v_perm_b32 v110, v43, v43, v13
    v_perm_b32 v111, v43, v43, v15
    s_nop 1
    v_mfma_f32_16x16x32_bf16 v[116:119], v[108:111], a[60:63], v[116:119]
    v_perm_b32 v96, v32, v32, v8
    v_perm_b32 v97, v32, v32, v10
    v_perm_b32 v98, v32, v32, v12
    v_perm_b32 v99, v32, v32, v14
    s_nop 1
    v_mfma_f32_16x16x32_bf16 v[112:115], v[96:99], a[64:67], v[112:115]
    v_perm_b32 v100, v44, v44, v8
    v_perm_b32 v101, v44, v44, v10
    v_perm_b32 v102, v44, v44, v12
    v_perm_b32 v103, v44, v44, v14
    s_nop 1
    v_mfma_f32_16x16x32_bf16 v[116:119], v[100:103], a[64:67], v[116:119]
    v_perm_b32 v104, v32, v32, v9
    v_perm_b32 v105, v32, v32, v11
    v_perm_b32 v106, v32, v32, v13
    v_perm_b32 v107, v32, v32, v15
    s_nop 1
    v_mfma_f32_16x16x32_bf16 v[112:115], v[104:107], a[68:71], v[112:115]
    v_perm_b32 v108, v44, v44, v9
    v_perm_b32 v109, v44, v44, v11
    v_perm_b32 v110, v44, v44, v13
    v_perm_b32 v111, v44, v44, v15
    s_nop 1
    v_mfma_f32_16x16x32_bf16 v[116:119], v[108:111], a[68:71], v[116:119]
    v_lshrrev_b32 v5, 1, v4
    v_lshlrev_b32 v5, 9, v5
    v_lshl_add_u32 v5, v3, 5, v5
    v_and_b32 v6, 1, v4
    v_lshl_add_u32 v5, v6, 4, v5
    s_lshl_b32 s54, s3, 11
    s_add_u32 s54, s54, 139264
    v_add_u32 v5, s54, v5
    ds_write_b128 v5, v[112:115]
    ds_write_b128 v5, v[116:119] offset:1024
    s_waitcnt lgkmcnt(0)
    s_barrier
    s_lshl_b32 s54, s3, 9
    s_add_u32 s54, s54, 139264
    v_add_u32 v5, s54, v2
    ds_read_b128 v[96:99], v5 offset:0
    ds_read_b128 v[100:103], v5 offset:2048
    ds_read_b128 v[104:107], v5 offset:4096
    ds_read_b128 v[108:111], v5 offset:6144
    s_waitcnt lgkmcnt(0)
    v_add_f32 v96, v96, v100
    v_add_f32 v104, v104, v108
    v_add_f32 v97, v97, v101
    v_add_f32 v105, v105, v109
    v_add_f32 v98, v98, v102
    v_add_f32 v106, v106, v110
    v_add_f32 v99, v99, v103
    v_add_f32 v107, v107, v111
    v_add_f32 v96, v96, v104
    v_add_f32 v97, v97, v105
    v_add_f32 v98, v98, v106
    v_add_f32 v99, v99, v107
    v_min_u32 v124, -2, v96
    v_min_u32 v125, -2, v97
    v_min_u32 v126, -2, v98
    v_min_u32 v127, -2, v99
    buffer_store_dwordx4 v[124:127], v123, s[44:47], s98 offen sc1
    s_waitcnt vmcnt(20)
    buffer_load_dwordx4 a[224:227], v120, s[32:35], s61 offen nt
    s_add_u32 s61, s61, 8192
    buffer_load_dwordx4 a[228:231], v120, s[32:35], s61 offen nt
    s_add_u32 s61, s61, 8192
    buffer_load_dwordx4 a[232:235], v120, s[32:35], s61 offen nt
    s_add_u32 s61, s61, 8192
    buffer_load_dwordx4 a[236:239], v120, s[32:35], s61 offen nt
    s_add_u32 s61, s61, 8192
    buffer_load_dwordx4 a[240:243], v120, s[32:35], s61 offen nt
    s_add_u32 s61, s61, 8192
    buffer_load_dwordx4 a[244:247], v120, s[32:35], s61 offen nt
    s_add_u32 s61, s61, 8192
    buffer_load_dwordx4 a[248:251], v120, s[32:35], s61 offen nt
    s_add_u32 s61, s61, 8192
    buffer_load_dwordx4 a[252:255], v120, s[32:35], s61 offen nt
    s_add_u32 s61, s61, 8192
    s_add_u32 m0, s63, 0
    s_nop 0
    buffer_load_dwordx4 v88, s[36:39], s60 offen nt lds
    s_add_u32 s60, s60, 32768
    v_perm_b32 v96, v48, v48, v8
    v_perm_b32 v97, v48, v48, v10
    v_perm_b32 v98, v48, v48, v12
    v_perm_b32 v99, v48, v48, v14
    s_nop 1
    v_mfma_f32_16x16x32_bf16 v[112:115], v[96:99], a[112:115], 0
    v_perm_b32 v100, v68, v68, v8
    v_perm_b32 v101, v68, v68, v10
    v_perm_b32 v102, v68, v68, v12
    v_perm_b32 v103, v68, v68, v14
    s_nop 1
    v_mfma_f32_16x16x32_bf16 v[116:119], v[100:103], a[112:115], 0
    v_perm_b32 v104, v48, v48, v9
    v_perm_b32 v105, v48, v48, v11
    v_perm_b32 v106, v48, v48, v13
    v_perm_b32 v107, v48, v48, v15
    s_nop 1
    v_mfma_f32_16x16x32_bf16 v[112:115], v[104:107], a[116:119], v[112:115]
    v_perm_b32 v108, v68, v68, v9
    v_perm_b32 v109, v68, v68, v11
    v_perm_b32 v110, v68, v68, v13
    v_perm_b32 v111, v68, v68, v15
    s_nop 1
    v_mfma_f32_16x16x32_bf16 v[116:119], v[108:111], a[116:119], v[116:119]
    v_perm_b32 v96, v49, v49, v8
    v_perm_b32 v97, v49, v49, v10
    v_perm_b32 v98, v49, v49, v12
    v_perm_b32 v99, v49, v49, v14
    s_nop 1
    v_mfma_f32_16x16x32_bf16 v[112:115], v[96:99], a[120:123], v[112:115]
    v_perm_b32 v100, v69, v69, v8
    v_perm_b32 v101, v69, v69, v10
    v_perm_b32 v102, v69, v69, v12
    v_perm_b32 v103, v69, v69, v14
    s_nop 1
    v_mfma_f32_16x16x32_bf16 v[116:119], v[100:103], a[120:123], v[116:119]
    v_perm_b32 v104, v49, v49, v9
    v_perm_b32 v105, v49, v49, v11
    v_perm_b32 v106, v49, v49, v13
    v_perm_b32 v107, v49, v49, v15
    s_nop 1
    v_mfma_f32_16x16x32_bf16 v[112:115], v[104:107], a[124:127], v[112:115]
    v_perm_b32 v108, v69, v69, v9
    v_perm_b32 v109, v69, v69, v11
    v_perm_b32 v110, v69, v69, v13
    v_perm_b32 v111, v69, v69, v15
    s_nop 1
    v_mfma_f32_16x16x32_bf16 v[116:119], v[108:111], a[124:127], v[116:119]
    v_perm_b32 v96, v50, v50, v8
    v_perm_b32 v97, v50, v50, v10
    v_perm_b32 v98, v50, v50, v12
    v_perm_b32 v99, v50, v50, v14
    s_nop 1
    v_mfma_f32_16x16x32_bf16 v[112:115], v[96:99], a[128:131], v[112:115]
    v_perm_b32 v100, v70, v70, v8
    v_perm_b32 v101, v70, v70, v10
    v_perm_b32 v102, v70, v70, v12
    v_perm_b32 v103, v70, v70, v14
    s_nop 1
    v_mfma_f32_16x16x32_bf16 v[116:119], v[100:103], a[128:131], v[116:119]
    v_perm_b32 v104, v50, v50, v9
    v_perm_b32 v105, v50, v50, v11
    v_perm_b32 v106, v50, v50, v13
    v_perm_b32 v107, v50, v50, v15
    s_nop 1
    v_mfma_f32_16x16x32_bf16 v[112:115], v[104:107], a[132:135], v[112:115]
    v_perm_b32 v108, v70, v70, v9
    v_perm_b32 v109, v70, v70, v11
    v_perm_b32 v110, v70, v70, v13
    v_perm_b32 v111, v70, v70, v15
    s_nop 1
    v_mfma_f32_16x16x32_bf16 v[116:119], v[108:111], a[132:135], v[116:119]
    v_perm_b32 v96, v51, v51, v8
    v_perm_b32 v97, v51, v51, v10
    v_perm_b32 v98, v51, v51, v12
    v_perm_b32 v99, v51, v51, v14
    s_nop 1
    v_mfma_f32_16x16x32_bf16 v[112:115], v[96:99], a[136:139], v[112:115]
    v_perm_b32 v100, v71, v71, v8
    v_perm_b32 v101, v71, v71, v10
    v_perm_b32 v102, v71, v71, v12
    v_perm_b32 v103, v71, v71, v14
    s_nop 1
    v_mfma_f32_16x16x32_bf16 v[116:119], v[100:103], a[136:139], v[116:119]
    v_perm_b32 v104, v51, v51, v9
    v_perm_b32 v105, v51, v51, v11
    v_perm_b32 v106, v51, v51, v13
    v_perm_b32 v107, v51, v51, v15
    s_nop 1
    v_mfma_f32_16x16x32_bf16 v[112:115], v[104:107], a[140:143], v[112:115]
    v_perm_b32 v108, v71, v71, v9
    v_perm_b32 v109, v71, v71, v11
    v_perm_b32 v110, v71, v71, v13
    v_perm_b32 v111, v71, v71, v15
    s_nop 1
    v_mfma_f32_16x16x32_bf16 v[116:119], v[108:111], a[140:143], v[116:119]
    v_perm_b32 v96, v52, v52, v8
    v_perm_b32 v97, v52, v52, v10
    v_perm_b32 v98, v52, v52, v12
    v_perm_b32 v99, v52, v52, v14
    s_nop 1
    v_mfma_f32_16x16x32_bf16 v[112:115], v[96:99], a[144:147], v[112:115]
    v_perm_b32 v100, v72, v72, v8
    v_perm_b32 v101, v72, v72, v10
    v_perm_b32 v102, v72, v72, v12
    v_perm_b32 v103, v72, v72, v14
    s_nop 1
    v_mfma_f32_16x16x32_bf16 v[116:119], v[100:103], a[144:147], v[116:119]
    s_waitcnt vmcnt(20)
    s_add_u32 m0, s63, 1024
    s_nop 0
    buffer_load_dwordx4 v88, s[36:39], s60 offen nt lds
    s_add_u32 s60, s60, 32768
    s_add_u32 m0, s63, 2048
    s_nop 0
    buffer_load_dwordx4 v89, s[36:39], s60 offen nt lds
    s_add_u32 s60, s60, 32768
    s_add_u32 m0, s63, 3072
    s_nop 0
    buffer_load_dwordx4 v89, s[36:39], s60 offen nt lds
    s_add_u32 s60, s60, 32768
    s_add_u32 m0, s63, 4096
    s_nop 0
    buffer_load_dwordx4 v90, s[36:39], s60 offen nt lds
    s_add_u32 s60, s60, 32768
    s_add_u32 m0, s63, 5120
    s_nop 0
    buffer_load_dwordx4 v90, s[36:39], s60 offen nt lds
    s_add_u32 s60, s60, 32768
    s_add_u32 m0, s63, 6144
    s_nop 0
    buffer_load_dwordx4 v91, s[36:39], s60 offen nt lds
    s_add_u32 s60, s60, 32768
    s_add_u32 m0, s63, 7168
    s_nop 0
    buffer_load_dwordx4 v91, s[36:39], s60 offen nt lds
    s_add_u32 s60, s60, 32768
    s_add_u32 m0, s63, 8192
    s_nop 0
    buffer_load_dwordx4 v88, s[36:39], s60 offen nt lds
    s_add_u32 s60, s60, 32768
    s_add_u32 m0, s63, 9216
    s_nop 0
    buffer_load_dwordx4 v88, s[36:39], s60 offen nt lds
    s_add_u32 s60, s60, 32768
    v_perm_b32 v104, v52, v52, v9
    v_perm_b32 v105, v52, v52, v11
    v_perm_b32 v106, v52, v52, v13
    v_perm_b32 v107, v52, v52, v15
    s_nop 1
    v_mfma_f32_16x16x32_bf16 v[112:115], v[104:107], a[148:151], v[112:115]
    v_perm_b32 v108, v72, v72, v9
    v_perm_b32 v109, v72, v72, v11
    v_perm_b32 v110, v72, v72, v13
    v_perm_b32 v111, v72, v72, v15
    s_nop 1
    v_mfma_f32_16x16x32_bf16 v[116:119], v[108:111], a[148:151], v[116:119]
    v_perm_b32 v96, v53, v53, v8
    v_perm_b32 v97, v53, v53, v10
    v_perm_b32 v98, v53, v53, v12
    v_perm_b32 v99, v53, v53, v14
    s_nop 1
    v_mfma_f32_16x16x32_bf16 v[112:115], v[96:99], a[152:155], v[112:115]
    v_perm_b32 v100, v73, v73, v8
    v_perm_b32 v101, v73, v73, v10
    v_perm_b32 v102, v73, v73, v12
    v_perm_b32 v103, v73, v73, v14
    s_nop 1
    v_mfma_f32_16x16x32_bf16 v[116:119], v[100:103], a[152:155], v[116:119]
    v_perm_b32 v104, v53, v53, v9
    v_perm_b32 v105, v53, v53, v11
    v_perm_b32 v106, v53, v53, v13
    v_perm_b32 v107, v53, v53, v15
    s_nop 1
    v_mfma_f32_16x16x32_bf16 v[112:115], v[104:107], a[156:159], v[112:115]
    v_perm_b32 v108, v73, v73, v9
    v_perm_b32 v109, v73, v73, v11
    v_perm_b32 v110, v73, v73, v13
    v_perm_b32 v111, v73, v73, v15
    s_nop 1
    v_mfma_f32_16x16x32_bf16 v[116:119], v[108:111], a[156:159], v[116:119]
    v_perm_b32 v96, v54, v54, v8
    v_perm_b32 v97, v54, v54, v10
    v_perm_b32 v98, v54, v54, v12
    v_perm_b32 v99, v54, v54, v14
    s_nop 1
    v_mfma_f32_16x16x32_bf16 v[112:115], v[96:99], a[160:163], v[112:115]
    v_perm_b32 v100, v74, v74, v8
    v_perm_b32 v101, v74, v74, v10
    v_perm_b32 v102, v74, v74, v12
    v_perm_b32 v103, v74, v74, v14
    s_nop 1
    v_mfma_f32_16x16x32_bf16 v[116:119], v[100:103], a[160:163], v[116:119]
    v_perm_b32 v104, v54, v54, v9
    v_perm_b32 v105, v54, v54, v11
    v_perm_b32 v106, v54, v54, v13
    v_perm_b32 v107, v54, v54, v15
    s_nop 1
    v_mfma_f32_16x16x32_bf16 v[112:115], v[104:107], a[164:167], v[112:115]
    v_perm_b32 v108, v74, v74, v9
    v_perm_b32 v109, v74, v74, v11
    v_perm_b32 v110, v74, v74, v13
    v_perm_b32 v111, v74, v74, v15
    s_nop 1
    v_mfma_f32_16x16x32_bf16 v[116:119], v[108:111], a[164:167], v[116:119]
    v_perm_b32 v96, v55, v55, v8
    v_perm_b32 v97, v55, v55, v10
    v_perm_b32 v98, v55, v55, v12
    v_perm_b32 v99, v55, v55, v14
    s_nop 1
    v_mfma_f32_16x16x32_bf16 v[112:115], v[96:99], a[168:171], v[112:115]
    v_perm_b32 v100, v75, v75, v8
    v_perm_b32 v101, v75, v75, v10
    v_perm_b32 v102, v75, v75, v12
    v_perm_b32 v103, v75, v75, v14
    s_nop 1
    v_mfma_f32_16x16x32_bf16 v[116:119], v[100:103], a[168:171], v[116:119]
    v_perm_b32 v104, v55, v55, v9
    v_perm_b32 v105, v55, v55, v11
    v_perm_b32 v106, v55, v55, v13
    v_perm_b32 v107, v55, v55, v15
    s_nop 1
    v_mfma_f32_16x16x32_bf16 v[112:115], v[104:107], a[172:175], v[112:115]
    v_perm_b32 v108, v75, v75, v9
    v_perm_b32 v109, v75, v75, v11
    v_perm_b32 v110, v75, v75, v13
    v_perm_b32 v111, v75, v75, v15
    s_nop 1
    v_mfma_f32_16x16x32_bf16 v[116:119], v[108:111], a[172:175], v[116:119]
    v_perm_b32 v96, v56, v56, v8
    v_perm_b32 v97, v56, v56, v10
    v_perm_b32 v98, v56, v56, v12
    v_perm_b32 v99, v56, v56, v14
    s_nop 1
    v_mfma_f32_16x16x32_bf16 v[112:115], v[96:99], a[176:179], v[112:115]
    v_perm_b32 v100, v76, v76, v8
    v_perm_b32 v101, v76, v76, v10
    v_perm_b32 v102, v76, v76, v12
    v_perm_b32 v103, v76, v76, v14
    s_nop 1
    v_mfma_f32_16x16x32_bf16 v[116:119], v[100:103], a[176:179], v[116:119]
    v_perm_b32 v104, v56, v56, v9
    v_perm_b32 v105, v56, v56, v11
    v_perm_b32 v106, v56, v56, v13
    v_perm_b32 v107, v56, v56, v15
    s_nop 1
    v_mfma_f32_16x16x32_bf16 v[112:115], v[104:107], a[180:183], v[112:115]
    v_perm_b32 v108, v76, v76, v9
    v_perm_b32 v109, v76, v76, v11
    v_perm_b32 v110, v76, v76, v13
    v_perm_b32 v111, v76, v76, v15
    s_nop 1
    v_mfma_f32_16x16x32_bf16 v[116:119], v[108:111], a[180:183], v[116:119]
    s_waitcnt vmcnt(20)
    s_add_u32 m0, s63, 10240
    s_nop 0
    buffer_load_dwordx4 v89, s[36:39], s60 offen nt lds
    s_add_u32 s60, s60, 32768
    s_add_u32 m0, s63, 11264
    s_nop 0
    buffer_load_dwordx4 v89, s[36:39], s60 offen nt lds
    s_add_u32 s60, s60, 32768
    s_add_u32 m0, s63, 12288
    s_nop 0
    buffer_load_dwordx4 v90, s[36:39], s60 offen nt lds
    s_add_u32 s60, s60, 32768
    s_add_u32 m0, s63, 13312
    s_nop 0
    buffer_load_dwordx4 v90, s[36:39], s60 offen nt lds
    s_add_u32 s60, s60, 32768
    s_add_u32 m0, s63, 14336
    s_nop 0
    buffer_load_dwordx4 v91, s[36:39], s60 offen nt lds
    s_add_u32 s60, s60, 32768
    s_add_u32 m0, s63, 15360
    s_nop 0
    buffer_load_dwordx4 v91, s[36:39], s60 offen nt lds
    s_add_u32 s60, s60, 32768
    s_add_u32 m0, s63, 16384
    s_nop 0
    buffer_load_dwordx4 v88, s[36:39], s60 offen nt lds
    s_add_u32 s60, s60, 32768
    s_add_u32 m0, s63, 17408
    s_nop 0
    buffer_load_dwordx4 v88, s[36:39], s60 offen nt lds
    s_add_u32 s60, s60, 32768
    s_add_u32 m0, s63, 18432
    s_nop 0
    buffer_load_dwordx4 v89, s[36:39], s60 offen nt lds
    s_add_u32 s60, s60, 32768
    v_perm_b32 v96, v57, v57, v8
    v_perm_b32 v97, v57, v57, v10
    v_perm_b32 v98, v57, v57, v12
    v_perm_b32 v99, v57, v57, v14
    s_nop 1
    v_mfma_f32_16x16x32_bf16 v[112:115], v[96:99], a[184:187], v[112:115]
    v_perm_b32 v100, v77, v77, v8
    v_perm_b32 v101, v77, v77, v10
    v_perm_b32 v102, v77, v77, v12
    v_perm_b32 v103, v77, v77, v14
    s_nop 1
    v_mfma_f32_16x16x32_bf16 v[116:119], v[100:103], a[184:187], v[116:119]
    v_perm_b32 v104, v57, v57, v9
    v_perm_b32 v105, v57, v57, v11
    v_perm_b32 v106, v57, v57, v13
    v_perm_b32 v107, v57, v57, v15
    s_nop 1
    v_mfma_f32_16x16x32_bf16 v[112:115], v[104:107], a[188:191], v[112:115]
    v_perm_b32 v108, v77, v77, v9
    v_perm_b32 v109, v77, v77, v11
    v_perm_b32 v110, v77, v77, v13
    v_perm_b32 v111, v77, v77, v15
    s_nop 1
    v_mfma_f32_16x16x32_bf16 v[116:119], v[108:111], a[188:191], v[116:119]
    v_perm_b32 v96, v58, v58, v8
    v_perm_b32 v97, v58, v58, v10
    v_perm_b32 v98, v58, v58, v12
    v_perm_b32 v99, v58, v58, v14
    s_nop 1
    v_mfma_f32_16x16x32_bf16 v[112:115], v[96:99], a[192:195], v[112:115]
    v_perm_b32 v100, v78, v78, v8
    v_perm_b32 v101, v78, v78, v10
    v_perm_b32 v102, v78, v78, v12
    v_perm_b32 v103, v78, v78, v14
    s_nop 1
    v_mfma_f32_16x16x32_bf16 v[116:119], v[100:103], a[192:195], v[116:119]
    v_perm_b32 v104, v58, v58, v9
    v_perm_b32 v105, v58, v58, v11
    v_perm_b32 v106, v58, v58, v13
    v_perm_b32 v107, v58, v58, v15
    s_nop 1
    v_mfma_f32_16x16x32_bf16 v[112:115], v[104:107], a[196:199], v[112:115]
    v_perm_b32 v108, v78, v78, v9
    v_perm_b32 v109, v78, v78, v11
    v_perm_b32 v110, v78, v78, v13
    v_perm_b32 v111, v78, v78, v15
    s_nop 1
    v_mfma_f32_16x16x32_bf16 v[116:119], v[108:111], a[196:199], v[116:119]
    v_perm_b32 v96, v59, v59, v8
    v_perm_b32 v97, v59, v59, v10
    v_perm_b32 v98, v59, v59, v12
    v_perm_b32 v99, v59, v59, v14
    s_nop 1
    v_mfma_f32_16x16x32_bf16 v[112:115], v[96:99], a[200:203], v[112:115]
    v_perm_b32 v100, v79, v79, v8
    v_perm_b32 v101, v79, v79, v10
    v_perm_b32 v102, v79, v79, v12
    v_perm_b32 v103, v79, v79, v14
    s_nop 1
    v_mfma_f32_16x16x32_bf16 v[116:119], v[100:103], a[200:203], v[116:119]
    v_perm_b32 v104, v59, v59, v9
    v_perm_b32 v105, v59, v59, v11
    v_perm_b32 v106, v59, v59, v13
    v_perm_b32 v107, v59, v59, v15
    s_nop 1
    v_mfma_f32_16x16x32_bf16 v[112:115], v[104:107], a[204:207], v[112:115]
    v_perm_b32 v108, v79, v79, v9
    v_perm_b32 v109, v79, v79, v11
    v_perm_b32 v110, v79, v79, v13
    v_perm_b32 v111, v79, v79, v15
    s_nop 1
    v_mfma_f32_16x16x32_bf16 v[116:119], v[108:111], a[204:207], v[116:119]
    v_perm_b32 v96, v60, v60, v8
    v_perm_b32 v97, v60, v60, v10
    v_perm_b32 v98, v60, v60, v12
    v_perm_b32 v99, v60, v60, v14
    s_nop 1
    v_mfma_f32_16x16x32_bf16 v[112:115], v[96:99], a[208:211], v[112:115]
    v_perm_b32 v100, v80, v80, v8
    v_perm_b32 v101, v80, v80, v10
    v_perm_b32 v102, v80, v80, v12
    v_perm_b32 v103, v80, v80, v14
    s_nop 1
    v_mfma_f32_16x16x32_bf16 v[116:119], v[100:103], a[208:211], v[116:119]
    v_perm_b32 v104, v60, v60, v9
    v_perm_b32 v105, v60, v60, v11
    v_perm_b32 v106, v60, v60, v13
    v_perm_b32 v107, v60, v60, v15
    s_nop 1
    v_mfma_f32_16x16x32_bf16 v[112:115], v[104:107], a[212:215], v[112:115]
    v_perm_b32 v108, v80, v80, v9
    v_perm_b32 v109, v80, v80, v11
    v_perm_b32 v110, v80, v80, v13
    v_perm_b32 v111, v80, v80, v15
    s_nop 1
    v_mfma_f32_16x16x32_bf16 v[116:119], v[108:111], a[212:215], v[116:119]
    v_perm_b32 v96, v61, v61, v8
    v_perm_b32 v97, v61, v61, v10
    v_perm_b32 v98, v61, v61, v12
    v_perm_b32 v99, v61, v61, v14
    s_nop 1
    v_mfma_f32_16x16x32_bf16 v[112:115], v[96:99], a[216:219], v[112:115]
    v_perm_b32 v100, v81, v81, v8
    v_perm_b32 v101, v81, v81, v10
    v_perm_b32 v102, v81, v81, v12
    v_perm_b32 v103, v81, v81, v14
    s_nop 1
    v_mfma_f32_16x16x32_bf16 v[116:119], v[100:103], a[216:219], v[116:119]
    s_waitcnt vmcnt(19)
    s_add_u32 m0, s63, 19456
    s_nop 0
    buffer_load_dwordx4 v89, s[36:39], s60 offen nt lds
    s_add_u32 s60, s60, 32768
    s_add_u32 m0, s63, 20480
    s_nop 0
    buffer_load_dwordx4 v90, s[36:39], s60 offen nt lds
    s_add_u32 s60, s60, 32768
    s_add_u32 m0, s63, 21504
    s_nop 0
    buffer_load_dwordx4 v90, s[36:39], s60 offen nt lds
    s_add_u32 s60, s60, 32768
    s_add_u32 m0, s63, 22528
    s_nop 0
    buffer_load_dwordx4 v91, s[36:39], s60 offen nt lds
    s_add_u32 s60, s60, 32768
    s_add_u32 m0, s63, 23552
    s_nop 0
    buffer_load_dwordx4 v91, s[36:39], s60 offen nt lds
    s_add_u32 s60, s60, 32768
    s_add_u32 m0, s63, 24576
    s_nop 0
    buffer_load_dwordx4 v88, s[36:39], s60 offen nt lds
    s_add_u32 s60, s60, 32768
    s_add_u32 m0, s63, 25600
    s_nop 0
    buffer_load_dwordx4 v88, s[36:39], s60 offen nt lds
    s_add_u32 s60, s60, 32768
    s_add_u32 m0, s63, 26624
    s_nop 0
    buffer_load_dwordx4 v89, s[36:39], s60 offen nt lds
    s_add_u32 s60, s60, 32768
    s_add_u32 m0, s63, 27648
    s_nop 0
    buffer_load_dwordx4 v89, s[36:39], s60 offen nt lds
    s_add_u32 s60, s60, 32768
    v_perm_b32 v104, v61, v61, v9
    v_perm_b32 v105, v61, v61, v11
    v_perm_b32 v106, v61, v61, v13
    v_perm_b32 v107, v61, v61, v15
    s_nop 1
    v_mfma_f32_16x16x32_bf16 v[112:115], v[104:107], a[220:223], v[112:115]
    v_perm_b32 v108, v81, v81, v9
    v_perm_b32 v109, v81, v81, v11
    v_perm_b32 v110, v81, v81, v13
    v_perm_b32 v111, v81, v81, v15
    s_nop 1
    v_mfma_f32_16x16x32_bf16 v[116:119], v[108:111], a[220:223], v[116:119]
    v_perm_b32 v96, v62, v62, v8
    v_perm_b32 v97, v62, v62, v10
    v_perm_b32 v98, v62, v62, v12
    v_perm_b32 v99, v62, v62, v14
    s_nop 1
    v_mfma_f32_16x16x32_bf16 v[112:115], v[96:99], a[224:227], v[112:115]
    v_perm_b32 v100, v82, v82, v8
    v_perm_b32 v101, v82, v82, v10
    v_perm_b32 v102, v82, v82, v12
    v_perm_b32 v103, v82, v82, v14
    s_nop 1
    v_mfma_f32_16x16x32_bf16 v[116:119], v[100:103], a[224:227], v[116:119]
    v_perm_b32 v104, v62, v62, v9
    v_perm_b32 v105, v62, v62, v11
    v_perm_b32 v106, v62, v62, v13
    v_perm_b32 v107, v62, v62, v15
    s_nop 1
    v_mfma_f32_16x16x32_bf16 v[112:115], v[104:107], a[228:231], v[112:115]
    v_perm_b32 v108, v82, v82, v9
    v_perm_b32 v109, v82, v82, v11
    v_perm_b32 v110, v82, v82, v13
    v_perm_b32 v111, v82, v82, v15
    s_nop 1
    v_mfma_f32_16x16x32_bf16 v[116:119], v[108:111], a[228:231], v[116:119]
    v_perm_b32 v96, v63, v63, v8
    v_perm_b32 v97, v63, v63, v10
    v_perm_b32 v98, v63, v63, v12
    v_perm_b32 v99, v63, v63, v14
    s_nop 1
    v_mfma_f32_16x16x32_bf16 v[112:115], v[96:99], a[232:235], v[112:115]
    v_perm_b32 v100, v83, v83, v8
    v_perm_b32 v101, v83, v83, v10
    v_perm_b32 v102, v83, v83, v12
    v_perm_b32 v103, v83, v83, v14
    s_nop 1
    v_mfma_f32_16x16x32_bf16 v[116:119], v[100:103], a[232:235], v[116:119]
    v_perm_b32 v104, v63, v63, v9
    v_perm_b32 v105, v63, v63, v11
    v_perm_b32 v106, v63, v63, v13
    v_perm_b32 v107, v63, v63, v15
    s_nop 1
    v_mfma_f32_16x16x32_bf16 v[112:115], v[104:107], a[236:239], v[112:115]
    v_perm_b32 v108, v83, v83, v9
    v_perm_b32 v109, v83, v83, v11
    v_perm_b32 v110, v83, v83, v13
    v_perm_b32 v111, v83, v83, v15
    s_nop 1
    v_mfma_f32_16x16x32_bf16 v[116:119], v[108:111], a[236:239], v[116:119]
    v_perm_b32 v96, v64, v64, v8
    v_perm_b32 v97, v64, v64, v10
    v_perm_b32 v98, v64, v64, v12
    v_perm_b32 v99, v64, v64, v14
    s_nop 1
    v_mfma_f32_16x16x32_bf16 v[112:115], v[96:99], a[240:243], v[112:115]
    v_perm_b32 v100, v84, v84, v8
    v_perm_b32 v101, v84, v84, v10
    v_perm_b32 v102, v84, v84, v12
    v_perm_b32 v103, v84, v84, v14
    s_nop 1
    v_mfma_f32_16x16x32_bf16 v[116:119], v[100:103], a[240:243], v[116:119]
    v_perm_b32 v104, v64, v64, v9
    v_perm_b32 v105, v64, v64, v11
    v_perm_b32 v106, v64, v64, v13
    v_perm_b32 v107, v64, v64, v15
    s_nop 1
    v_mfma_f32_16x16x32_bf16 v[112:115], v[104:107], a[244:247], v[112:115]
    v_perm_b32 v108, v84, v84, v9
    v_perm_b32 v109, v84, v84, v11
    v_perm_b32 v110, v84, v84, v13
    v_perm_b32 v111, v84, v84, v15
    s_nop 1
    v_mfma_f32_16x16x32_bf16 v[116:119], v[108:111], a[244:247], v[116:119]
    v_perm_b32 v96, v65, v65, v8
    v_perm_b32 v97, v65, v65, v10
    v_perm_b32 v98, v65, v65, v12
    v_perm_b32 v99, v65, v65, v14
    s_nop 1
    v_mfma_f32_16x16x32_bf16 v[112:115], v[96:99], a[248:251], v[112:115]
    v_perm_b32 v100, v85, v85, v8
    v_perm_b32 v101, v85, v85, v10
    v_perm_b32 v102, v85, v85, v12
    v_perm_b32 v103, v85, v85, v14
    s_nop 1
    v_mfma_f32_16x16x32_bf16 v[116:119], v[100:103], a[248:251], v[116:119]
    v_perm_b32 v104, v65, v65, v9
    v_perm_b32 v105, v65, v65, v11
    v_perm_b32 v106, v65, v65, v13
    v_perm_b32 v107, v65, v65, v15
    s_nop 1
    v_mfma_f32_16x16x32_bf16 v[112:115], v[104:107], a[252:255], v[112:115]
    v_perm_b32 v108, v85, v85, v9
    v_perm_b32 v109, v85, v85, v11
    v_perm_b32 v110, v85, v85, v13
    v_perm_b32 v111, v85, v85, v15
    s_nop 1
    v_mfma_f32_16x16x32_bf16 v[116:119], v[108:111], a[252:255], v[116:119]
    v_lshrrev_b32 v5, 1, v4
    v_lshlrev_b32 v5, 9, v5
    v_lshl_add_u32 v5, v3, 5, v5
    v_and_b32 v6, 1, v4
    v_lshl_add_u32 v5, v6, 4, v5
    s_lshl_b32 s54, s3, 11
    s_add_u32 s54, s54, 131072
    v_add_u32 v5, s54, v5
    ds_write_b128 v5, v[112:115]
    ds_write_b128 v5, v[116:119] offset:1024
    s_waitcnt lgkmcnt(0)
    s_barrier
    s_add_u32 m0, s63, 28672
    s_nop 0
    buffer_load_dwordx4 v90, s[36:39], s60 offen nt lds
    s_add_u32 s60, s60, 32768
    s_add_u32 m0, s63, 29696
    s_nop 0
    buffer_load_dwordx4 v90, s[36:39], s60 offen nt lds
    s_add_u32 s60, s60, 32768
    s_add_u32 m0, s63, 30720
    s_nop 0
    buffer_load_dwordx4 v91, s[36:39], s60 offen nt lds
    s_add_u32 s60, s60, 32768
    s_add_u32 m0, s63, 31744
    s_nop 0
    buffer_load_dwordx4 v91, s[36:39], s60 offen nt lds
    s_add_u32 s60, s60, 32768
    v_lshrrev_b32 v5, 2, v3
    v_lshlrev_b32 v5, 9, v5
    v_lshl_add_u32 v5, v4, 5, v5
    v_add_u32 v5, 131072, v5
    ds_read_b128 v[48:51], v5 offset:0
    ds_read_b128 v[52:55], v5 offset:16
    ds_read_b128 v[56:59], v5 offset:2048
    ds_read_b128 v[60:63], v5 offset:2064
    ds_read_b128 v[64:67], v5 offset:4096
    ds_read_b128 v[68:71], v5 offset:4112
    ds_read_b128 v[72:75], v5 offset:6144
    ds_read_b128 v[76:79], v5 offset:6160
    s_waitcnt lgkmcnt(0)
    v_add_f32 v48, v48, v56
    v_add_f32 v64, v64, v72
    v_add_f32 v49, v49, v57
    v_add_f32 v65, v65, v73
    v_add_f32 v50, v50, v58
    v_add_f32 v66, v66, v74
    v_add_f32 v51, v51, v59
    v_add_f32 v67, v67, v75
    v_add_f32 v52, v52, v60
    v_add_f32 v68, v68, v76
    v_add_f32 v53, v53, v61
    v_add_f32 v69, v69, v77
    v_add_f32 v54, v54, v62
    v_add_f32 v70, v70, v78
    v_add_f32 v55, v55, v63
    v_add_f32 v71, v71, v79
    v_add_f32 v48, v48, v64
    v_add_f32 v49, v49, v65
    v_add_f32 v50, v50, v66
    v_add_f32 v51, v51, v67
    v_add_f32 v52, v52, v68
    v_add_f32 v53, v53, v69
    v_add_f32 v54, v54, v70
    v_add_f32 v55, v55, v71
    v_cvt_pk_bf16_f32 v96, v48, v49
    v_cvt_pk_bf16_f32 v97, v50, v51
    v_cvt_pk_bf16_f32 v98, v52, v53
    v_cvt_pk_bf16_f32 v99, v54, v55
    ds_read_b128 v[48:51], v5 offset:128
    ds_read_b128 v[52:55], v5 offset:144
    ds_read_b128 v[56:59], v5 offset:2176
    ds_read_b128 v[60:63], v5 offset:2192
    ds_read_b128 v[64:67], v5 offset:4224
    ds_read_b128 v[68:71], v5 offset:4240
    ds_read_b128 v[72:75], v5 offset:6272
    ds_read_b128 v[76:79], v5 offset:6288
    s_waitcnt lgkmcnt(0)
    v_add_f32 v48, v48, v56
    v_add_f32 v64, v64, v72
    v_add_f32 v49, v49, v57
    v_add_f32 v65, v65, v73
    v_add_f32 v50, v50, v58
    v_add_f32 v66, v66, v74
    v_add_f32 v51, v51, v59
    v_add_f32 v67, v67, v75
    v_add_f32 v52, v52, v60
    v_add_f32 v68, v68, v76
    v_add_f32 v53, v53, v61
    v_add_f32 v69, v69, v77
    v_add_f32 v54, v54, v62
    v_add_f32 v70, v70, v78
    v_add_f32 v55, v55, v63
    v_add_f32 v71, v71, v79
    v_add_f32 v48, v48, v64
    v_add_f32 v49, v49, v65
    v_add_f32 v50, v50, v66
    v_add_f32 v51, v51, v67
    v_add_f32 v52, v52, v68
    v_add_f32 v53, v53, v69
    v_add_f32 v54, v54, v70
    v_add_f32 v55, v55, v71
    v_cvt_pk_bf16_f32 v100, v48, v49
    v_cvt_pk_bf16_f32 v101, v50, v51
    v_cvt_pk_bf16_f32 v102, v52, v53
    v_cvt_pk_bf16_f32 v103, v54, v55
    ds_read_b128 v[48:51], v5 offset:256
    ds_read_b128 v[52:55], v5 offset:272
    ds_read_b128 v[56:59], v5 offset:2304
    ds_read_b128 v[60:63], v5 offset:2320
    ds_read_b128 v[64:67], v5 offset:4352
    ds_read_b128 v[68:71], v5 offset:4368
    ds_read_b128 v[72:75], v5 offset:6400
    ds_read_b128 v[76:79], v5 offset:6416
    s_waitcnt lgkmcnt(0)
    v_add_f32 v48, v48, v56
    v_add_f32 v64, v64, v72
    v_add_f32 v49, v49, v57
    v_add_f32 v65, v65, v73
    v_add_f32 v50, v50, v58
    v_add_f32 v66, v66, v74
    v_add_f32 v51, v51, v59
    v_add_f32 v67, v67, v75
    v_add_f32 v52, v52, v60
    v_add_f32 v68, v68, v76
    v_add_f32 v53, v53, v61
    v_add_f32 v69, v69, v77
    v_add_f32 v54, v54, v62
    v_add_f32 v70, v70, v78
    v_add_f32 v55, v55, v63
    v_add_f32 v71, v71, v79
    v_add_f32 v48, v48, v64
    v_add_f32 v49, v49, v65
    v_add_f32 v50, v50, v66
    v_add_f32 v51, v51, v67
    v_add_f32 v52, v52, v68
    v_add_f32 v53, v53, v69
    v_add_f32 v54, v54, v70
    v_add_f32 v55, v55, v71
    v_cvt_pk_bf16_f32 v104, v48, v49
    v_cvt_pk_bf16_f32 v105, v50, v51
    v_cvt_pk_bf16_f32 v106, v52, v53
    v_cvt_pk_bf16_f32 v107, v54, v55
    ds_read_b128 v[48:51], v5 offset:384
    ds_read_b128 v[52:55], v5 offset:400
    ds_read_b128 v[56:59], v5 offset:2432
    ds_read_b128 v[60:63], v5 offset:2448
    ds_read_b128 v[64:67], v5 offset:4480
    ds_read_b128 v[68:71], v5 offset:4496
    ds_read_b128 v[72:75], v5 offset:6528
    ds_read_b128 v[76:79], v5 offset:6544
    s_waitcnt lgkmcnt(0)
    v_add_f32 v48, v48, v56
    v_add_f32 v64, v64, v72
    v_add_f32 v49, v49, v57
    v_add_f32 v65, v65, v73
    v_add_f32 v50, v50, v58
    v_add_f32 v66, v66, v74
    v_add_f32 v51, v51, v59
    v_add_f32 v67, v67, v75
    v_add_f32 v52, v52, v60
    v_add_f32 v68, v68, v76
    v_add_f32 v53, v53, v61
    v_add_f32 v69, v69, v77
    v_add_f32 v54, v54, v62
    v_add_f32 v70, v70, v78
    v_add_f32 v55, v55, v63
    v_add_f32 v71, v71, v79
    v_add_f32 v48, v48, v64
    v_add_f32 v49, v49, v65
    v_add_f32 v50, v50, v66
    v_add_f32 v51, v51, v67
    v_add_f32 v52, v52, v68
    v_add_f32 v53, v53, v69
    v_add_f32 v54, v54, v70
    v_add_f32 v55, v55, v71
    v_cvt_pk_bf16_f32 v108, v48, v49
    v_cvt_pk_bf16_f32 v109, v50, v51
    v_cvt_pk_bf16_f32 v110, v52, v53
    v_cvt_pk_bf16_f32 v111, v54, v55
    s_waitcnt vmcnt(24)
    ds_read_b128 v[128:131], v92 offset:0
    ds_read_b128 v[132:135], v93 offset:0
    ds_read_b128 v[136:139], v94 offset:0
    ds_read_b128 v[140:143], v95 offset:0
    ds_read_b128 v[144:147], v92 offset:1024
    ds_read_b128 v[148:151], v93 offset:1024
    ds_read_b128 v[152:155], v94 offset:1024
    ds_read_b128 v[156:159], v95 offset:1024
    s_waitcnt lgkmcnt(7)
    v_mfma_f32_16x16x32_bf16 v[48:51], v[128:131], v[96:99], 0
    s_waitcnt lgkmcnt(6)
    v_mfma_f32_16x16x32_bf16 v[48:51], v[132:135], v[100:103], v[48:51]
    s_waitcnt lgkmcnt(5)
    v_mfma_f32_16x16x32_bf16 v[48:51], v[136:139], v[104:107], v[48:51]
    s_waitcnt lgkmcnt(4)
    v_mfma_f32_16x16x32_bf16 v[48:51], v[140:143], v[108:111], v[48:51]
    s_waitcnt lgkmcnt(3)
    v_mfma_f32_16x16x32_bf16 v[52:55], v[144:147], v[96:99], 0
    s_waitcnt lgkmcnt(2)
    v_mfma_f32_16x16x32_bf16 v[52:55], v[148:151], v[100:103], v[52:55]
    s_waitcnt lgkmcnt(1)
    v_mfma_f32_16x16x32_bf16 v[52:55], v[152:155], v[104:107], v[52:55]
    s_waitcnt lgkmcnt(0)
    v_mfma_f32_16x16x32_bf16 v[52:55], v[156:159], v[108:111], v[52:55]
    s_waitcnt vmcnt(16)
    ds_read_b128 v[160:163], v92 offset:8192
    ds_read_b128 v[164:167], v93 offset:8192
    ds_read_b128 v[168:171], v94 offset:8192
    ds_read_b128 v[172:175], v95 offset:8192
    ds_read_b128 v[176:179], v92 offset:9216
    ds_read_b128 v[180:183], v93 offset:9216
    ds_read_b128 v[184:187], v94 offset:9216
    ds_read_b128 v[188:191], v95 offset:9216
    s_waitcnt lgkmcnt(7)
    v_mfma_f32_16x16x32_bf16 v[56:59], v[160:163], v[96:99], 0
    s_waitcnt lgkmcnt(6)
    v_mfma_f32_16x16x32_bf16 v[56:59], v[164:167], v[100:103], v[56:59]
    s_waitcnt lgkmcnt(5)
    v_mfma_f32_16x16x32_bf16 v[56:59], v[168:171], v[104:107], v[56:59]
    s_waitcnt lgkmcnt(4)
    v_mfma_f32_16x16x32_bf16 v[56:59], v[172:175], v[108:111], v[56:59]
    s_waitcnt lgkmcnt(3)
    v_mfma_f32_16x16x32_bf16 v[60:63], v[176:179], v[96:99], 0
    s_waitcnt lgkmcnt(2)
    v_mfma_f32_16x16x32_bf16 v[60:63], v[180:183], v[100:103], v[60:63]
    s_waitcnt lgkmcnt(1)
    v_mfma_f32_16x16x32_bf16 v[60:63], v[184:187], v[104:107], v[60:63]
    s_waitcnt lgkmcnt(0)
    v_mfma_f32_16x16x32_bf16 v[60:63], v[188:191], v[108:111], v[60:63]
    s_waitcnt vmcnt(8)
    ds_read_b128 v[128:131], v92 offset:16384
    ds_read_b128 v[132:135], v93 offset:16384
    ds_read_b128 v[136:139], v94 offset:16384
    ds_read_b128 v[140:143], v95 offset:16384
    ds_read_b128 v[144:147], v92 offset:17408
    ds_read_b128 v[148:151], v93 offset:17408
    ds_read_b128 v[152:155], v94 offset:17408
    ds_read_b128 v[156:159], v95 offset:17408
    s_waitcnt lgkmcnt(7)
    v_mfma_f32_16x16x32_bf16 v[64:67], v[128:131], v[96:99], 0
    s_waitcnt lgkmcnt(6)
    v_mfma_f32_16x16x32_bf16 v[64:67], v[132:135], v[100:103], v[64:67]
    s_waitcnt lgkmcnt(5)
    v_mfma_f32_16x16x32_bf16 v[64:67], v[136:139], v[104:107], v[64:67]
    s_waitcnt lgkmcnt(4)
    v_mfma_f32_16x16x32_bf16 v[64:67], v[140:143], v[108:111], v[64:67]
    s_waitcnt lgkmcnt(3)
    v_mfma_f32_16x16x32_bf16 v[68:71], v[144:147], v[96:99], 0
    s_waitcnt lgkmcnt(2)
    v_mfma_f32_16x16x32_bf16 v[68:71], v[148:151], v[100:103], v[68:71]
    s_waitcnt lgkmcnt(1)
    v_mfma_f32_16x16x32_bf16 v[68:71], v[152:155], v[104:107], v[68:71]
    s_waitcnt lgkmcnt(0)
    v_mfma_f32_16x16x32_bf16 v[68:71], v[156:159], v[108:111], v[68:71]
    s_waitcnt vmcnt(0)
    ds_read_b128 v[160:163], v92 offset:24576
    ds_read_b128 v[164:167], v93 offset:24576
    ds_read_b128 v[168:171], v94 offset:24576
    ds_read_b128 v[172:175], v95 offset:24576
    ds_read_b128 v[176:179], v92 offset:25600
    ds_read_b128 v[180:183], v93 offset:25600
    ds_read_b128 v[184:187], v94 offset:25600
    ds_read_b128 v[188:191], v95 offset:25600
    s_waitcnt lgkmcnt(7)
    v_mfma_f32_16x16x32_bf16 v[72:75], v[160:163], v[96:99], 0
    s_waitcnt lgkmcnt(6)
    v_mfma_f32_16x16x32_bf16 v[72:75], v[164:167], v[100:103], v[72:75]
    s_waitcnt lgkmcnt(5)
    v_mfma_f32_16x16x32_bf16 v[72:75], v[168:171], v[104:107], v[72:75]
    s_waitcnt lgkmcnt(4)
    v_mfma_f32_16x16x32_bf16 v[72:75], v[172:175], v[108:111], v[72:75]
    s_waitcnt lgkmcnt(3)
    v_mfma_f32_16x16x32_bf16 v[76:79], v[176:179], v[96:99], 0
    s_waitcnt lgkmcnt(2)
    v_mfma_f32_16x16x32_bf16 v[76:79], v[180:183], v[100:103], v[76:79]
    s_waitcnt lgkmcnt(1)
    v_mfma_f32_16x16x32_bf16 v[76:79], v[184:187], v[104:107], v[76:79]
    s_waitcnt lgkmcnt(0)
    v_mfma_f32_16x16x32_bf16 v[76:79], v[188:191], v[108:111], v[76:79]
    s_mov_b32 s96, 1040356334
    v_and_b32 v6, 3, v3
    v_cmp_eq_u32 vcc, 1, v6
    s_nop 1
    v_cndmask_b32 v48, v48, v56, vcc
    v_cndmask_b32 v49, v49, v57, vcc
    v_cndmask_b32 v50, v50, v58, vcc
    v_cndmask_b32 v51, v51, v59, vcc
    v_cndmask_b32 v52, v52, v60, vcc
    v_cndmask_b32 v53, v53, v61, vcc
    v_cndmask_b32 v54, v54, v62, vcc
    v_cndmask_b32 v55, v55, v63, vcc
    v_cmp_eq_u32 vcc, 2, v6
    s_nop 1
    v_cndmask_b32 v48, v48, v64, vcc
    v_cndmask_b32 v49, v49, v65, vcc
    v_cndmask_b32 v50, v50, v66, vcc
    v_cndmask_b32 v51, v51, v67, vcc
    v_cndmask_b32 v52, v52, v68, vcc
    v_cndmask_b32 v53, v53, v69, vcc
    v_cndmask_b32 v54, v54, v70, vcc
    v_cndmask_b32 v55, v55, v71, vcc
    v_cmp_eq_u32 vcc, 3, v6
    s_nop 1
    v_cndmask_b32 v48, v48, v72, vcc
    v_cndmask_b32 v49, v49, v73, vcc
    v_cndmask_b32 v50, v50, v74, vcc
    v_cndmask_b32 v51, v51, v75, vcc
    v_cndmask_b32 v52, v52, v76, vcc
    v_cndmask_b32 v53, v53, v77, vcc
    v_cndmask_b32 v54, v54, v78, vcc
    v_cndmask_b32 v55, v55, v79, vcc
    v_mul_f32 v48, s96, v48
    v_mul_f32 v49, s96, v49
    v_mul_f32 v50, s96, v50
    v_mul_f32 v51, s96, v51
    v_mul_f32 v52, s96, v52
    v_mul_f32 v53, s96, v53
    v_mul_f32 v54, s96, v54
    v_mul_f32 v55, s96, v55
    v_cvt_pk_bf16_f32 v24, v48, v49
    v_cvt_pk_bf16_f32 v25, v50, v51
    v_cvt_pk_bf16_f32 v26, v52, v53
    v_cvt_pk_bf16_f32 v27, v54, v55
    v_min_u32 v24, -2, v24
    v_min_u32 v25, -2, v25
    v_min_u32 v26, -2, v26
    v_min_u32 v27, -2, v27
    v_lshrrev_b32 v5, 2, v3
    v_lshlrev_b32 v5, 15, v5
    v_lshl_add_u32 v5, v4, 4, v5
    v_and_b32 v6, 3, v3
    v_lshl_add_u32 v5, v6, 6, v5
    s_lshl_b32 s54, s52, 10
    s_lshl_b32 s55, s3, 8
    s_add_u32 s54, s54, s55
    s_add_u32 s54, s54, 1048576
    buffer_store_dwordx4 v[24:27], v5, s[44:47], s54 offen sc1
    buffer_load_dwordx4 a[0:3], v121, s[40:43], s62 offen nt
    s_add_u32 s62, s62, 8192
    buffer_load_dwordx4 a[4:7], v121, s[40:43], s62 offen nt
    s_add_u32 s62, s62, 8192
    buffer_load_dwordx4 a[8:11], v121, s[40:43], s62 offen nt
    s_add_u32 s62, s62, 8192
    buffer_load_dwordx4 a[12:15], v121, s[40:43], s62 offen nt
    s_add_u32 s62, s62, 8192
    buffer_load_dwordx4 a[16:19], v121, s[40:43], s62 offen nt
    s_add_u32 s62, s62, 8192
    buffer_load_dwordx4 a[20:23], v121, s[40:43], s62 offen nt
    s_add_u32 s62, s62, 8192
    buffer_load_dwordx4 a[24:27], v121, s[40:43], s62 offen nt
    s_add_u32 s62, s62, 8192
    buffer_load_dwordx4 a[28:31], v121, s[40:43], s62 offen nt
    s_add_u32 s62, s62, 8192
    buffer_load_dwordx4 a[32:35], v121, s[40:43], s62 offen nt
    s_add_u32 s62, s62, 8192
    buffer_load_dwordx4 a[36:39], v121, s[40:43], s62 offen nt
    s_add_u32 s62, s62, 8192
    buffer_load_dwordx4 a[40:43], v121, s[40:43], s62 offen nt
    s_add_u32 s62, s62, 8192
    buffer_load_dwordx4 a[44:47], v121, s[40:43], s62 offen nt
    s_add_u32 s62, s62, 8192
    buffer_load_dwordx4 a[48:51], v121, s[40:43], s62 offen nt
    s_add_u32 s62, s62, 8192
    buffer_load_dwordx4 a[52:55], v121, s[40:43], s62 offen nt
    s_add_u32 s62, s62, 8192
    buffer_load_dwordx4 a[56:59], v121, s[40:43], s62 offen nt
    s_add_u32 s62, s62, 8192
    buffer_load_dwordx4 a[60:63], v121, s[40:43], s62 offen nt
    s_add_u32 s62, s62, 8192
    buffer_load_dwordx4 a[64:67], v121, s[40:43], s62 offen nt
    s_add_u32 s62, s62, 8192
    buffer_load_dwordx4 a[68:71], v121, s[40:43], s62 offen nt
    s_add_u32 s62, s62, 8192
    buffer_load_dwordx4 a[72:75], v121, s[40:43], s62 offen nt
    s_add_u32 s62, s62, 8192
    buffer_load_dwordx4 a[76:79], v121, s[40:43], s62 offen nt
    s_add_u32 s62, s62, 8192
    buffer_load_dwordx4 a[80:83], v121, s[40:43], s62 offen nt
    s_add_u32 s62, s62, 8192
    buffer_load_dwordx4 a[84:87], v121, s[40:43], s62 offen nt
    s_add_u32 s62, s62, 8192
    buffer_load_dwordx4 a[88:91], v121, s[40:43], s62 offen nt
    s_add_u32 s62, s62, 8192
    buffer_load_dwordx4 a[92:95], v121, s[40:43], s62 offen nt
    s_add_u32 s62, s62, 8192
    buffer_load_dwordx4 a[96:99], v121, s[40:43], s62 offen nt
    s_add_u32 s62, s62, 8192
    buffer_load_dwordx4 a[100:103], v121, s[40:43], s62 offen nt
    s_add_u32 s62, s62, 8192
    buffer_load_dwordx4 a[104:107], v121, s[40:43], s62 offen nt
    s_add_u32 s62, s62, 8192
    buffer_load_dwordx4 a[108:111], v121, s[40:43], s62 offen nt
    s_add_u32 s62, s62, 8192
    buffer_load_dwordx4 a[112:115], v121, s[40:43], s62 offen nt
    s_add_u32 s62, s62, 8192
    buffer_load_dwordx4 a[116:119], v121, s[40:43], s62 offen nt
    s_add_u32 s62, s62, 8192
    buffer_load_dwordx4 a[120:123], v121, s[40:43], s62 offen nt
    s_add_u32 s62, s62, 8192
    buffer_load_dwordx4 a[124:127], v121, s[40:43], s62 offen nt
    s_add_u32 s62, s62, 8192
    s_mov_b32 s36, s24
    s_mov_b32 s37, s25
    s_mov_b32 s38, 4718592
    s_mov_b32 s39, 0x20000
    v_mul_u32_u24 v81, 9216, v4
    v_lshl_add_u32 v80, v3, 4, v81
    v_lshl_add_u32 v81, v3, 2, v81
    s_mul_i32 s100, s52, 147456
    s_lshl_b32 s54, s3, 8
    s_add_u32 s99, s100, s54
    s_and_b32 s54, s3, 1
    s_lshl_b32 s54, s54, 6
    s_add_u32 s100, s100, s54
    s_add_u32 s100, s100, 1024
    buffer_load_dwordx4 v[96:99], v80, s[36:39], s99 offen offset:0 nt
    buffer_load_dwordx4 v[100:103], v80, s[36:39], s99 offen offset:1152 nt
    buffer_load_dwordx4 v[104:107], v80, s[36:39], s99 offen offset:2304 nt
    buffer_load_dwordx4 v[108:111], v80, s[36:39], s99 offen offset:3456 nt
    s_add_u32 s99, s99, 4608
    buffer_load_dwordx4 v[112:115], v80, s[36:39], s99 offen offset:0 nt
    buffer_load_dwordx4 v[116:119], v80, s[36:39], s99 offen offset:1152 nt
    buffer_load_dwordx4 v[120:123], v80, s[36:39], s99 offen offset:2304 nt
    buffer_load_dwordx4 v[124:127], v80, s[36:39], s99 offen offset:3456 nt
    s_add_u32 s99, s99, 32256
    buffer_load_dwordx4 v[128:131], v80, s[36:39], s99 offen offset:0 nt
    buffer_load_dwordx4 v[132:135], v80, s[36:39], s99 offen offset:1152 nt
    buffer_load_dwordx4 v[136:139], v80, s[36:39], s99 offen offset:2304 nt
    buffer_load_dwordx4 v[140:143], v80, s[36:39], s99 offen offset:3456 nt
    s_add_u32 s99, s99, 4608
    buffer_load_dwordx4 v[144:147], v80, s[36:39], s99 offen offset:0 nt
    buffer_load_dwordx4 v[148:151], v80, s[36:39], s99 offen offset:1152 nt
    buffer_load_dwordx4 v[152:155], v80, s[36:39], s99 offen offset:2304 nt
    buffer_load_dwordx4 v[156:159], v80, s[36:39], s99 offen offset:3456 nt
    s_add_u32 s99, s99, 32256
    buffer_load_dwordx4 v[160:163], v80, s[36:39], s99 offen offset:0 nt
    buffer_load_dwordx4 v[164:167], v80, s[36:39], s99 offen offset:1152 nt
    buffer_load_dwordx4 v[168:171], v80, s[36:39], s99 offen offset:2304 nt
    buffer_load_dwordx4 v[172:175], v80, s[36:39], s99 offen offset:3456 nt
    s_add_u32 s99, s99, 4608
    buffer_load_dwordx4 v[176:179], v80, s[36:39], s99 offen offset:0 nt
    buffer_load_dwordx4 v[180:183], v80, s[36:39], s99 offen offset:1152 nt
    buffer_load_dwordx4 v[184:187], v80, s[36:39], s99 offen offset:2304 nt
    buffer_load_dwordx4 v[188:191], v80, s[36:39], s99 offen offset:3456 nt
    s_add_u32 s99, s99, 32256
    buffer_load_dwordx4 v[192:195], v80, s[36:39], s99 offen offset:0 nt
    buffer_load_dwordx4 v[196:199], v80, s[36:39], s99 offen offset:1152 nt
    buffer_load_dwordx4 v[200:203], v80, s[36:39], s99 offen offset:2304 nt
    buffer_load_dwordx4 v[204:207], v80, s[36:39], s99 offen offset:3456 nt
    s_add_u32 s99, s99, 4608
    s_waitcnt vmcnt(40)
    buffer_load_dwordx4 v[208:211], v80, s[36:39], s99 offen offset:0 nt
    buffer_load_dwordx4 v[212:215], v80, s[36:39], s99 offen offset:1152 nt
    buffer_load_dwordx4 v[216:219], v80, s[36:39], s99 offen offset:2304 nt
    buffer_load_dwordx4 v[220:223], v80, s[36:39], s99 offen offset:3456 nt
    s_add_u32 s99, s99, 32256
    v_and_b32 v16, 31, v1
    v_lshlrev_b32 v16, 2, v16
    global_load_dword v17, v16, s[28:29] sc1
    buffer_load_dword v224, v81, s[36:39], s100 offen offset:0 nt
    buffer_load_dword v225, v81, s[36:39], s100 offen offset:1152 nt
    buffer_load_dword v226, v81, s[36:39], s100 offen offset:2304 nt
    buffer_load_dword v227, v81, s[36:39], s100 offen offset:3456 nt
    s_add_u32 s100, s100, 4608
    buffer_load_dword v228, v81, s[36:39], s100 offen offset:0 nt
    buffer_load_dword v229, v81, s[36:39], s100 offen offset:1152 nt
    buffer_load_dword v230, v81, s[36:39], s100 offen offset:2304 nt
    buffer_load_dword v231, v81, s[36:39], s100 offen offset:3456 nt
    s_add_u32 s100, s100, 32256
    buffer_load_dword v232, v81, s[36:39], s100 offen offset:0 nt
    buffer_load_dword v233, v81, s[36:39], s100 offen offset:1152 nt
    buffer_load_dword v234, v81, s[36:39], s100 offen offset:2304 nt
    buffer_load_dword v235, v81, s[36:39], s100 offen offset:3456 nt
    s_add_u32 s100, s100, 4608
    buffer_load_dword v236, v81, s[36:39], s100 offen offset:0 nt
    buffer_load_dword v237, v81, s[36:39], s100 offen offset:1152 nt
    buffer_load_dword v238, v81, s[36:39], s100 offen offset:2304 nt
    buffer_load_dword v239, v81, s[36:39], s100 offen offset:3456 nt
    s_add_u32 s100, s100, 32256
    s_waitcnt vmcnt(40)
    buffer_load_dword v240, v81, s[36:39], s100 offen offset:0 nt
    buffer_load_dword v241, v81, s[36:39], s100 offen offset:1152 nt
    buffer_load_dword v242, v81, s[36:39], s100 offen offset:2304 nt
    buffer_load_dword v243, v81, s[36:39], s100 offen offset:3456 nt
    s_add_u32 s100, s100, 4608
    buffer_load_dword v244, v81, s[36:39], s100 offen offset:0 nt
    buffer_load_dword v245, v81, s[36:39], s100 offen offset:1152 nt
    buffer_load_dword v246, v81, s[36:39], s100 offen offset:2304 nt
    buffer_load_dword v247, v81, s[36:39], s100 offen offset:3456 nt
    s_add_u32 s100, s100, 32256
    buffer_load_dword v248, v81, s[36:39], s100 offen offset:0 nt
    buffer_load_dword v249, v81, s[36:39], s100 offen offset:1152 nt
    buffer_load_dword v250, v81, s[36:39], s100 offen offset:2304 nt
    buffer_load_dword v251, v81, s[36:39], s100 offen offset:3456 nt
    s_add_u32 s100, s100, 4608
    buffer_load_dword v252, v81, s[36:39], s100 offen offset:0 nt
    buffer_load_dword v253, v81, s[36:39], s100 offen offset:1152 nt
    buffer_load_dword v254, v81, s[36:39], s100 offen offset:2304 nt
    buffer_load_dword v255, v81, s[36:39], s100 offen offset:3456 nt
    s_add_u32 s100, s100, 32256
    s_waitcnt vmcnt(0)
    s_mov_b32 s54, 0x05040100
    s_mov_b32 s55, 0x07060302
    v_perm_b32 v64, v100, v96, s54
    v_perm_b32 v65, v108, v104, s54
    v_perm_b32 v66, v116, v112, s54
    v_perm_b32 v67, v124, v120, s54
    v_perm_b32 v68, v100, v96, s55
    v_perm_b32 v69, v108, v104, s55
    v_perm_b32 v70, v116, v112, s55
    v_perm_b32 v71, v124, v120, s55
    v_perm_b32 v72, v101, v97, s54
    v_perm_b32 v73, v109, v105, s54
    v_perm_b32 v74, v117, v113, s54
    v_perm_b32 v75, v125, v121, s54
    v_perm_b32 v76, v101, v97, s55
    v_perm_b32 v77, v109, v105, s55
    v_perm_b32 v78, v117, v113, s55
    v_perm_b32 v79, v125, v121, s55
    v_perm_b32 v80, v102, v98, s54
    v_perm_b32 v81, v110, v106, s54
    v_perm_b32 v82, v118, v114, s54
    v_perm_b32 v83, v126, v122, s54
    v_perm_b32 v84, v102, v98, s55
    v_perm_b32 v85, v110, v106, s55
    v_perm_b32 v86, v118, v114, s55
    v_perm_b32 v87, v126, v122, s55
    v_perm_b32 v88, v103, v99, s54
    v_perm_b32 v89, v111, v107, s54
    v_perm_b32 v90, v119, v115, s54
    v_perm_b32 v91, v127, v123, s54
    v_perm_b32 v92, v103, v99, s55
    v_perm_b32 v93, v111, v107, s55
    v_perm_b32 v94, v119, v115, s55
    v_perm_b32 v95, v127, v123, s55
    v_perm_b32 v96, v132, v128, s54
    v_perm_b32 v97, v140, v136, s54
    v_perm_b32 v98, v148, v144, s54
    v_perm_b32 v99, v156, v152, s54
    v_perm_b32 v100, v132, v128, s55
    v_perm_b32 v101, v140, v136, s55
    v_perm_b32 v102, v148, v144, s55
    v_perm_b32 v103, v156, v152, s55
    v_perm_b32 v104, v133, v129, s54
    v_perm_b32 v105, v141, v137, s54
    v_perm_b32 v106, v149, v145, s54
    v_perm_b32 v107, v157, v153, s54
    v_perm_b32 v108, v133, v129, s55
    v_perm_b32 v109, v141, v137, s55
    v_perm_b32 v110, v149, v145, s55
    v_perm_b32 v111, v157, v153, s55
    v_perm_b32 v112, v134, v130, s54
    v_perm_b32 v113, v142, v138, s54
    v_perm_b32 v114, v150, v146, s54
    v_perm_b32 v115, v158, v154, s54
    v_perm_b32 v116, v134, v130, s55
    v_perm_b32 v117, v142, v138, s55
    v_perm_b32 v118, v150, v146, s55
    v_perm_b32 v119, v158, v154, s55
    v_perm_b32 v120, v135, v131, s54
    v_perm_b32 v121, v143, v139, s54
    v_perm_b32 v122, v151, v147, s54
    v_perm_b32 v123, v159, v155, s54
    v_perm_b32 v124, v135, v131, s55
    v_perm_b32 v125, v143, v139, s55
    v_perm_b32 v126, v151, v147, s55
    v_perm_b32 v127, v159, v155, s55
    v_perm_b32 v128, v164, v160, s54
    v_perm_b32 v129, v172, v168, s54
    v_perm_b32 v130, v180, v176, s54
    v_perm_b32 v131, v188, v184, s54
    v_perm_b32 v132, v164, v160, s55
    v_perm_b32 v133, v172, v168, s55
    v_perm_b32 v134, v180, v176, s55
    v_perm_b32 v135, v188, v184, s55
    v_perm_b32 v136, v165, v161, s54
    v_perm_b32 v137, v173, v169, s54
    v_perm_b32 v138, v181, v177, s54
    v_perm_b32 v139, v189, v185, s54
    v_perm_b32 v140, v165, v161, s55
    v_perm_b32 v141, v173, v169, s55
    v_perm_b32 v142, v181, v177, s55
    v_perm_b32 v143, v189, v185, s55
    v_perm_b32 v144, v166, v162, s54
    v_perm_b32 v145, v174, v170, s54
    v_perm_b32 v146, v182, v178, s54
    v_perm_b32 v147, v190, v186, s54
    v_perm_b32 v148, v166, v162, s55
    v_perm_b32 v149, v174, v170, s55
    v_perm_b32 v150, v182, v178, s55
    v_perm_b32 v151, v190, v186, s55
    v_perm_b32 v152, v167, v163, s54
    v_perm_b32 v153, v175, v171, s54
    v_perm_b32 v154, v183, v179, s54
    v_perm_b32 v155, v191, v187, s54
    v_perm_b32 v156, v167, v163, s55
    v_perm_b32 v157, v175, v171, s55
    v_perm_b32 v158, v183, v179, s55
    v_perm_b32 v159, v191, v187, s55
    v_perm_b32 v160, v196, v192, s54
    v_perm_b32 v161, v204, v200, s54
    v_perm_b32 v162, v212, v208, s54
    v_perm_b32 v163, v220, v216, s54
    v_perm_b32 v164, v196, v192, s55
    v_perm_b32 v165, v204, v200, s55
    v_perm_b32 v166, v212, v208, s55
    v_perm_b32 v167, v220, v216, s55
    v_perm_b32 v168, v197, v193, s54
    v_perm_b32 v169, v205, v201, s54
    v_perm_b32 v170, v213, v209, s54
    v_perm_b32 v171, v221, v217, s54
    v_perm_b32 v172, v197, v193, s55
    v_perm_b32 v173, v205, v201, s55
    v_perm_b32 v174, v213, v209, s55
    v_perm_b32 v175, v221, v217, s55
    v_perm_b32 v176, v198, v194, s54
    v_perm_b32 v177, v206, v202, s54
    v_perm_b32 v178, v214, v210, s54
    v_perm_b32 v179, v222, v218, s54
    v_perm_b32 v180, v198, v194, s55
    v_perm_b32 v181, v206, v202, s55
    v_perm_b32 v182, v214, v210, s55
    v_perm_b32 v183, v222, v218, s55
    v_perm_b32 v184, v199, v195, s54
    v_perm_b32 v185, v207, v203, s54
    v_perm_b32 v186, v215, v211, s54
    v_perm_b32 v187, v223, v219, s54
    v_perm_b32 v188, v199, v195, s55
    v_perm_b32 v189, v207, v203, s55
    v_perm_b32 v190, v215, v211, s55
    v_perm_b32 v191, v223, v219, s55
    v_perm_b32 v192, v225, v224, s54
    v_perm_b32 v193, v227, v226, s54
    v_perm_b32 v194, v229, v228, s54
    v_perm_b32 v195, v231, v230, s54
    v_perm_b32 v196, v225, v224, s55
    v_perm_b32 v197, v227, v226, s55
    v_perm_b32 v198, v229, v228, s55
    v_perm_b32 v199, v231, v230, s55
    v_perm_b32 v200, v233, v232, s54
    v_perm_b32 v201, v235, v234, s54
    v_perm_b32 v202, v237, v236, s54
    v_perm_b32 v203, v239, v238, s54
    v_perm_b32 v204, v233, v232, s55
    v_perm_b32 v205, v235, v234, s55
    v_perm_b32 v206, v237, v236, s55
    v_perm_b32 v207, v239, v238, s55
    v_perm_b32 v208, v241, v240, s54
    v_perm_b32 v209, v243, v242, s54
    v_perm_b32 v210, v245, v244, s54
    v_perm_b32 v211, v247, v246, s54
    v_perm_b32 v212, v241, v240, s55
    v_perm_b32 v213, v243, v242, s55
    v_perm_b32 v214, v245, v244, s55
    v_perm_b32 v215, v247, v246, s55
    v_perm_b32 v216, v249, v248, s54
    v_perm_b32 v217, v251, v250, s54
    v_perm_b32 v218, v253, v252, s54
    v_perm_b32 v219, v255, v254, s54
    v_perm_b32 v220, v249, v248, s55
    v_perm_b32 v221, v251, v250, s55
    v_perm_b32 v222, v253, v252, s55
    v_perm_b32 v223, v255, v254, s55
    s_barrier
L_flags_4:
    v_cmp_gt_u32 vcc, 2, v17
    s_cbranch_vccz L_flagsok_5
    s_sleep 2
    global_load_dword v17, v16, s[28:29] sc1
    s_waitcnt vmcnt(0)
    s_sub_u32 s101, s101, 1
    s_cbranch_scc0 L_flags_4
    s_mov_b32 s101, 0
L_flagsok_5:
    s_lshl_b32 s58, s3, 18
    s_lshl_b32 s54, s52, 10
    s_add_u32 s58, s58, s54
    s_add_u32 s58, s58, 2097152
    s_lshl_b32 s59, s3, 11
    s_lshl_b32 s54, s52, 3
    s_add_u32 s59, s59, s54
    s_add_u32 s59, s59, 3145728
    s_mov_b32 s98, 0xffff0000
    v_and_b32 v5, 7, v1
    v_lshlrev_b32 v5, 8, v5
L_blight_6:
    buffer_load_dwordx2 v[232:233], v5, s[44:47], s59 offen sc1
    s_waitcnt vmcnt(0)
    v_max_u32 v6, v232, v233
    v_cmp_eq_u32 vcc, -1, v6
    s_cbranch_vccz L_bheavy_7
    s_sleep 2
    s_sub_u32 s101, s101, 1
    s_cbranch_scc0 L_blight_6
    s_mov_b32 s101, 0
L_bheavy_7:
    buffer_load_dwordx4 v[16:19], v2, s[44:47], s58 offen sc1 nt
    s_add_u32 s58, s58, 32768
    buffer_load_dwordx4 v[20:23], v2, s[44:47], s58 offen sc1 nt
    s_add_u32 s58, s58, 32768
    buffer_load_dwordx4 v[24:27], v2, s[44:47], s58 offen sc1 nt
    s_add_u32 s58, s58, 32768
    buffer_load_dwordx4 v[28:31], v2, s[44:47], s58 offen sc1 nt
    s_add_u32 s58, s58, 32768
    buffer_load_dwordx4 v[32:35], v2, s[44:47], s58 offen sc1 nt
    s_add_u32 s58, s58, 32768
    buffer_load_dwordx4 v[36:39], v2, s[44:47], s58 offen sc1 nt
    s_add_u32 s58, s58, 32768
    buffer_load_dwordx4 v[40:43], v2, s[44:47], s58 offen sc1 nt
    s_add_u32 s58, s58, 32768
    buffer_load_dwordx4 v[44:47], v2, s[44:47], s58 offen sc1 nt
    s_add_u32 s58, s58, 32768
    v_max_f32_dpp v234, v232, v232 row_ror:1 row_mask:0xf bank_mask:0xf
    s_nop 1
    v_max_f32_dpp v234, v234, v234 row_ror:2 row_mask:0xf bank_mask:0xf
    s_nop 1
    v_max_f32_dpp v234, v234, v234 row_ror:4 row_mask:0xf bank_mask:0xf
    v_sub_f32 v232, v232, v234
    v_exp_f32 v232, v232
    s_nop 0
    v_mul_f32 v232, v232, v233
    s_nop 1
    v_add_f32_dpp v234, v232, v232 row_ror:1 row_mask:0xf bank_mask:0xf
    s_nop 1
    v_add_f32_dpp v234, v234, v234 row_ror:2 row_mask:0xf bank_mask:0xf
    s_nop 1
    v_add_f32_dpp v234, v234, v234 row_ror:4 row_mask:0xf bank_mask:0xf
    v_rcp_f32 v234, v234
    s_nop 0
    v_mul_f32 v232, v232, v234
    s_waitcnt vmcnt(7)
    v_lshlrev_b32 v240, 16, v16
    v_and_b32 v16, s98, v16
    v_lshlrev_b32 v241, 16, v17
    v_and_b32 v17, s98, v17
    v_lshlrev_b32 v242, 16, v18
    v_and_b32 v18, s98, v18
    v_lshlrev_b32 v243, 16, v19
    v_and_b32 v19, s98, v19
    v_mul_f32_dpp v224, v232, v240 row_newbcast:0 row_mask:0xf bank_mask:0xf
    v_mul_f32_dpp v225, v232, v16 row_newbcast:0 row_mask:0xf bank_mask:0xf
    v_mul_f32_dpp v226, v232, v241 row_newbcast:0 row_mask:0xf bank_mask:0xf
    v_mul_f32_dpp v227, v232, v17 row_newbcast:0 row_mask:0xf bank_mask:0xf
    v_mul_f32_dpp v228, v232, v242 row_newbcast:0 row_mask:0xf bank_mask:0xf
    v_mul_f32_dpp v229, v232, v18 row_newbcast:0 row_mask:0xf bank_mask:0xf
    v_mul_f32_dpp v230, v232, v243 row_newbcast:0 row_mask:0xf bank_mask:0xf
    v_mul_f32_dpp v231, v232, v19 row_newbcast:0 row_mask:0xf bank_mask:0xf
    s_waitcnt vmcnt(6)
    v_lshlrev_b32 v240, 16, v20
    v_and_b32 v20, s98, v20
    v_lshlrev_b32 v241, 16, v21
    v_and_b32 v21, s98, v21
    v_lshlrev_b32 v242, 16, v22
    v_and_b32 v22, s98, v22
    v_lshlrev_b32 v243, 16, v23
    v_and_b32 v23, s98, v23
    v_fmac_f32_dpp v224, v232, v240 row_newbcast:1 row_mask:0xf bank_mask:0xf
    v_fmac_f32_dpp v225, v232, v20 row_newbcast:1 row_mask:0xf bank_mask:0xf
    v_fmac_f32_dpp v226, v232, v241 row_newbcast:1 row_mask:0xf bank_mask:0xf
    v_fmac_f32_dpp v227, v232, v21 row_newbcast:1 row_mask:0xf bank_mask:0xf
    v_fmac_f32_dpp v228, v232, v242 row_newbcast:1 row_mask:0xf bank_mask:0xf
    v_fmac_f32_dpp v229, v232, v22 row_newbcast:1 row_mask:0xf bank_mask:0xf
    v_fmac_f32_dpp v230, v232, v243 row_newbcast:1 row_mask:0xf bank_mask:0xf
    v_fmac_f32_dpp v231, v232, v23 row_newbcast:1 row_mask:0xf bank_mask:0xf
    s_waitcnt vmcnt(5)
    v_lshlrev_b32 v240, 16, v24
    v_and_b32 v24, s98, v24
    v_lshlrev_b32 v241, 16, v25
    v_and_b32 v25, s98, v25
    v_lshlrev_b32 v242, 16, v26
    v_and_b32 v26, s98, v26
    v_lshlrev_b32 v243, 16, v27
    v_and_b32 v27, s98, v27
    v_fmac_f32_dpp v224, v232, v240 row_newbcast:2 row_mask:0xf bank_mask:0xf
    v_fmac_f32_dpp v225, v232, v24 row_newbcast:2 row_mask:0xf bank_mask:0xf
    v_fmac_f32_dpp v226, v232, v241 row_newbcast:2 row_mask:0xf bank_mask:0xf
    v_fmac_f32_dpp v227, v232, v25 row_newbcast:2 row_mask:0xf bank_mask:0xf
    v_fmac_f32_dpp v228, v232, v242 row_newbcast:2 row_mask:0xf bank_mask:0xf
    v_fmac_f32_dpp v229, v232, v26 row_newbcast:2 row_mask:0xf bank_mask:0xf
    v_fmac_f32_dpp v230, v232, v243 row_newbcast:2 row_mask:0xf bank_mask:0xf
    v_fmac_f32_dpp v231, v232, v27 row_newbcast:2 row_mask:0xf bank_mask:0xf
    s_waitcnt vmcnt(4)
    v_lshlrev_b32 v240, 16, v28
    v_and_b32 v28, s98, v28
    v_lshlrev_b32 v241, 16, v29
    v_and_b32 v29, s98, v29
    v_lshlrev_b32 v242, 16, v30
    v_and_b32 v30, s98, v30
    v_lshlrev_b32 v243, 16, v31
    v_and_b32 v31, s98, v31
    v_fmac_f32_dpp v224, v232, v240 row_newbcast:3 row_mask:0xf bank_mask:0xf
    v_fmac_f32_dpp v225, v232, v28 row_newbcast:3 row_mask:0xf bank_mask:0xf
    v_fmac_f32_dpp v226, v232, v241 row_newbcast:3 row_mask:0xf bank_mask:0xf
    v_fmac_f32_dpp v227, v232, v29 row_newbcast:3 row_mask:0xf bank_mask:0xf
    v_fmac_f32_dpp v228, v232, v242 row_newbcast:3 row_mask:0xf bank_mask:0xf
    v_fmac_f32_dpp v229, v232, v30 row_newbcast:3 row_mask:0xf bank_mask:0xf
    v_fmac_f32_dpp v230, v232, v243 row_newbcast:3 row_mask:0xf bank_mask:0xf
    v_fmac_f32_dpp v231, v232, v31 row_newbcast:3 row_mask:0xf bank_mask:0xf
    s_waitcnt vmcnt(3)
    v_lshlrev_b32 v240, 16, v32
    v_and_b32 v32, s98, v32
    v_lshlrev_b32 v241, 16, v33
    v_and_b32 v33, s98, v33
    v_lshlrev_b32 v242, 16, v34
    v_and_b32 v34, s98, v34
    v_lshlrev_b32 v243, 16, v35
    v_and_b32 v35, s98, v35
    v_fmac_f32_dpp v224, v232, v240 row_newbcast:4 row_mask:0xf bank_mask:0xf
    v_fmac_f32_dpp v225, v232, v32 row_newbcast:4 row_mask:0xf bank_mask:0xf
    v_fmac_f32_dpp v226, v232, v241 row_newbcast:4 row_mask:0xf bank_mask:0xf
    v_fmac_f32_dpp v227, v232, v33 row_newbcast:4 row_mask:0xf bank_mask:0xf
    v_fmac_f32_dpp v228, v232, v242 row_newbcast:4 row_mask:0xf bank_mask:0xf
    v_fmac_f32_dpp v229, v232, v34 row_newbcast:4 row_mask:0xf bank_mask:0xf
    v_fmac_f32_dpp v230, v232, v243 row_newbcast:4 row_mask:0xf bank_mask:0xf
    v_fmac_f32_dpp v231, v232, v35 row_newbcast:4 row_mask:0xf bank_mask:0xf
    s_waitcnt vmcnt(2)
    v_lshlrev_b32 v240, 16, v36
    v_and_b32 v36, s98, v36
    v_lshlrev_b32 v241, 16, v37
    v_and_b32 v37, s98, v37
    v_lshlrev_b32 v242, 16, v38
    v_and_b32 v38, s98, v38
    v_lshlrev_b32 v243, 16, v39
    v_and_b32 v39, s98, v39
    v_fmac_f32_dpp v224, v232, v240 row_newbcast:5 row_mask:0xf bank_mask:0xf
    v_fmac_f32_dpp v225, v232, v36 row_newbcast:5 row_mask:0xf bank_mask:0xf
    v_fmac_f32_dpp v226, v232, v241 row_newbcast:5 row_mask:0xf bank_mask:0xf
    v_fmac_f32_dpp v227, v232, v37 row_newbcast:5 row_mask:0xf bank_mask:0xf
    v_fmac_f32_dpp v228, v232, v242 row_newbcast:5 row_mask:0xf bank_mask:0xf
    v_fmac_f32_dpp v229, v232, v38 row_newbcast:5 row_mask:0xf bank_mask:0xf
    v_fmac_f32_dpp v230, v232, v243 row_newbcast:5 row_mask:0xf bank_mask:0xf
    v_fmac_f32_dpp v231, v232, v39 row_newbcast:5 row_mask:0xf bank_mask:0xf
    s_waitcnt vmcnt(1)
    v_lshlrev_b32 v240, 16, v40
    v_and_b32 v40, s98, v40
    v_lshlrev_b32 v241, 16, v41
    v_and_b32 v41, s98, v41
    v_lshlrev_b32 v242, 16, v42
    v_and_b32 v42, s98, v42
    v_lshlrev_b32 v243, 16, v43
    v_and_b32 v43, s98, v43
    v_fmac_f32_dpp v224, v232, v240 row_newbcast:6 row_mask:0xf bank_mask:0xf
    v_fmac_f32_dpp v225, v232, v40 row_newbcast:6 row_mask:0xf bank_mask:0xf
    v_fmac_f32_dpp v226, v232, v241 row_newbcast:6 row_mask:0xf bank_mask:0xf
    v_fmac_f32_dpp v227, v232, v41 row_newbcast:6 row_mask:0xf bank_mask:0xf
    v_fmac_f32_dpp v228, v232, v242 row_newbcast:6 row_mask:0xf bank_mask:0xf
    v_fmac_f32_dpp v229, v232, v42 row_newbcast:6 row_mask:0xf bank_mask:0xf
    v_fmac_f32_dpp v230, v232, v243 row_newbcast:6 row_mask:0xf bank_mask:0xf
    v_fmac_f32_dpp v231, v232, v43 row_newbcast:6 row_mask:0xf bank_mask:0xf
    s_waitcnt vmcnt(0)
    v_lshlrev_b32 v240, 16, v44
    v_and_b32 v44, s98, v44
    v_lshlrev_b32 v241, 16, v45
    v_and_b32 v45, s98, v45
    v_lshlrev_b32 v242, 16, v46
    v_and_b32 v46, s98, v46
    v_lshlrev_b32 v243, 16, v47
    v_and_b32 v47, s98, v47
    v_fmac_f32_dpp v224, v232, v240 row_newbcast:7 row_mask:0xf bank_mask:0xf
    v_fmac_f32_dpp v225, v232, v44 row_newbcast:7 row_mask:0xf bank_mask:0xf
    v_fmac_f32_dpp v226, v232, v241 row_newbcast:7 row_mask:0xf bank_mask:0xf
    v_fmac_f32_dpp v227, v232, v45 row_newbcast:7 row_mask:0xf bank_mask:0xf
    v_fmac_f32_dpp v228, v232, v242 row_newbcast:7 row_mask:0xf bank_mask:0xf
    v_fmac_f32_dpp v229, v232, v46 row_newbcast:7 row_mask:0xf bank_mask:0xf
    v_fmac_f32_dpp v230, v232, v243 row_newbcast:7 row_mask:0xf bank_mask:0xf
    v_fmac_f32_dpp v231, v232, v47 row_newbcast:7 row_mask:0xf bank_mask:0xf
    v_cvt_pk_bf16_f32 v244, v224, v225
    v_cvt_pk_bf16_f32 v245, v226, v227
    v_cvt_pk_bf16_f32 v246, v228, v229
    v_cvt_pk_bf16_f32 v247, v230, v231
    s_lshl_b32 s54, s3, 10
    v_add_u32 v5, s54, v2
    ds_write_b128 v5, v[244:247]
    v_lshrrev_b32 v5, 3, v3
    v_lshlrev_b32 v5, 10, v5
    v_lshl_add_u32 v5, v4, 6, v5
    s_lshl_b32 s54, s3, 8
    v_add_u32 v5, s54, v5
    s_waitcnt lgkmcnt(0)
    s_barrier
    ds_read_b128 v[16:19], v5 offset:0
    ds_read_b128 v[20:23], v5 offset:16
    ds_read_b128 v[24:27], v5 offset:32
    ds_read_b128 v[28:31], v5 offset:48
    ds_read_b128 v[32:35], v5 offset:2048
    ds_read_b128 v[36:39], v5 offset:2064
    ds_read_b128 v[40:43], v5 offset:2080
    ds_read_b128 v[44:47], v5 offset:2096
    s_waitcnt lgkmcnt(0)
    v_perm_b32 v48, v16, v16, v8
    v_perm_b32 v49, v16, v16, v10
    v_perm_b32 v50, v16, v16, v12
    v_perm_b32 v51, v16, v16, v14
    s_nop 1
    v_mfma_f32_16x16x32_bf16 v[224:227], v[48:51], a[0:3], 0
    v_perm_b32 v52, v32, v32, v8
    v_perm_b32 v53, v32, v32, v10
    v_perm_b32 v54, v32, v32, v12
    v_perm_b32 v55, v32, v32, v14
    s_nop 1
    v_mfma_f32_16x16x32_bf16 v[228:231], v[52:55], a[0:3], 0
    v_perm_b32 v56, v16, v16, v9
    v_perm_b32 v57, v16, v16, v11
    v_perm_b32 v58, v16, v16, v13
    v_perm_b32 v59, v16, v16, v15
    s_nop 1
    v_mfma_f32_16x16x32_bf16 v[224:227], v[56:59], a[4:7], v[224:227]
    v_perm_b32 v60, v32, v32, v9
    v_perm_b32 v61, v32, v32, v11
    v_perm_b32 v62, v32, v32, v13
    v_perm_b32 v63, v32, v32, v15
    s_nop 1
    v_mfma_f32_16x16x32_bf16 v[228:231], v[60:63], a[4:7], v[228:231]
    v_perm_b32 v48, v17, v17, v8
    v_perm_b32 v49, v17, v17, v10
    v_perm_b32 v50, v17, v17, v12
    v_perm_b32 v51, v17, v17, v14
    s_nop 1
    v_mfma_f32_16x16x32_bf16 v[224:227], v[48:51], a[8:11], v[224:227]
    v_perm_b32 v52, v33, v33, v8
    v_perm_b32 v53, v33, v33, v10
    v_perm_b32 v54, v33, v33, v12
    v_perm_b32 v55, v33, v33, v14
    s_nop 1
    v_mfma_f32_16x16x32_bf16 v[228:231], v[52:55], a[8:11], v[228:231]
    v_perm_b32 v56, v17, v17, v9
    v_perm_b32 v57, v17, v17, v11
    v_perm_b32 v58, v17, v17, v13
    v_perm_b32 v59, v17, v17, v15
    s_nop 1
    v_mfma_f32_16x16x32_bf16 v[224:227], v[56:59], a[12:15], v[224:227]
    v_perm_b32 v60, v33, v33, v9
    v_perm_b32 v61, v33, v33, v11
    v_perm_b32 v62, v33, v33, v13
    v_perm_b32 v63, v33, v33, v15
    s_nop 1
    v_mfma_f32_16x16x32_bf16 v[228:231], v[60:63], a[12:15], v[228:231]
    v_perm_b32 v48, v18, v18, v8
    v_perm_b32 v49, v18, v18, v10
    v_perm_b32 v50, v18, v18, v12
    v_perm_b32 v51, v18, v18, v14
    s_nop 1
    v_mfma_f32_16x16x32_bf16 v[224:227], v[48:51], a[16:19], v[224:227]
    v_perm_b32 v52, v34, v34, v8
    v_perm_b32 v53, v34, v34, v10
    v_perm_b32 v54, v34, v34, v12
    v_perm_b32 v55, v34, v34, v14
    s_nop 1
    v_mfma_f32_16x16x32_bf16 v[228:231], v[52:55], a[16:19], v[228:231]
    v_perm_b32 v56, v18, v18, v9
    v_perm_b32 v57, v18, v18, v11
    v_perm_b32 v58, v18, v18, v13
    v_perm_b32 v59, v18, v18, v15
    s_nop 1
    v_mfma_f32_16x16x32_bf16 v[224:227], v[56:59], a[20:23], v[224:227]
    v_perm_b32 v60, v34, v34, v9
    v_perm_b32 v61, v34, v34, v11
    v_perm_b32 v62, v34, v34, v13
    v_perm_b32 v63, v34, v34, v15
    s_nop 1
    v_mfma_f32_16x16x32_bf16 v[228:231], v[60:63], a[20:23], v[228:231]
    v_perm_b32 v48, v19, v19, v8
    v_perm_b32 v49, v19, v19, v10
    v_perm_b32 v50, v19, v19, v12
    v_perm_b32 v51, v19, v19, v14
    s_nop 1
    v_mfma_f32_16x16x32_bf16 v[224:227], v[48:51], a[24:27], v[224:227]
    v_perm_b32 v52, v35, v35, v8
    v_perm_b32 v53, v35, v35, v10
    v_perm_b32 v54, v35, v35, v12
    v_perm_b32 v55, v35, v35, v14
    s_nop 1
    v_mfma_f32_16x16x32_bf16 v[228:231], v[52:55], a[24:27], v[228:231]
    v_perm_b32 v56, v19, v19, v9
    v_perm_b32 v57, v19, v19, v11
    v_perm_b32 v58, v19, v19, v13
    v_perm_b32 v59, v19, v19, v15
    s_nop 1
    v_mfma_f32_16x16x32_bf16 v[224:227], v[56:59], a[28:31], v[224:227]
    v_perm_b32 v60, v35, v35, v9
    v_perm_b32 v61, v35, v35, v11
    v_perm_b32 v62, v35, v35, v13
    v_perm_b32 v63, v35, v35, v15
    s_nop 1
    v_mfma_f32_16x16x32_bf16 v[228:231], v[60:63], a[28:31], v[228:231]
    v_perm_b32 v48, v20, v20, v8
    v_perm_b32 v49, v20, v20, v10
    v_perm_b32 v50, v20, v20, v12
    v_perm_b32 v51, v20, v20, v14
    s_nop 1
    v_mfma_f32_16x16x32_bf16 v[224:227], v[48:51], a[32:35], v[224:227]
    v_perm_b32 v52, v36, v36, v8
    v_perm_b32 v53, v36, v36, v10
    v_perm_b32 v54, v36, v36, v12
    v_perm_b32 v55, v36, v36, v14
    s_nop 1
    v_mfma_f32_16x16x32_bf16 v[228:231], v[52:55], a[32:35], v[228:231]
    v_perm_b32 v56, v20, v20, v9
    v_perm_b32 v57, v20, v20, v11
    v_perm_b32 v58, v20, v20, v13
    v_perm_b32 v59, v20, v20, v15
    s_nop 1
    v_mfma_f32_16x16x32_bf16 v[224:227], v[56:59], a[36:39], v[224:227]
    v_perm_b32 v60, v36, v36, v9
    v_perm_b32 v61, v36, v36, v11
    v_perm_b32 v62, v36, v36, v13
    v_perm_b32 v63, v36, v36, v15
    s_nop 1
    v_mfma_f32_16x16x32_bf16 v[228:231], v[60:63], a[36:39], v[228:231]
    v_perm_b32 v48, v21, v21, v8
    v_perm_b32 v49, v21, v21, v10
    v_perm_b32 v50, v21, v21, v12
    v_perm_b32 v51, v21, v21, v14
    s_nop 1
    v_mfma_f32_16x16x32_bf16 v[224:227], v[48:51], a[40:43], v[224:227]
    v_perm_b32 v52, v37, v37, v8
    v_perm_b32 v53, v37, v37, v10
    v_perm_b32 v54, v37, v37, v12
    v_perm_b32 v55, v37, v37, v14
    s_nop 1
    v_mfma_f32_16x16x32_bf16 v[228:231], v[52:55], a[40:43], v[228:231]
    v_perm_b32 v56, v21, v21, v9
    v_perm_b32 v57, v21, v21, v11
    v_perm_b32 v58, v21, v21, v13
    v_perm_b32 v59, v21, v21, v15
    s_nop 1
    v_mfma_f32_16x16x32_bf16 v[224:227], v[56:59], a[44:47], v[224:227]
    v_perm_b32 v60, v37, v37, v9
    v_perm_b32 v61, v37, v37, v11
    v_perm_b32 v62, v37, v37, v13
    v_perm_b32 v63, v37, v37, v15
    s_nop 1
    v_mfma_f32_16x16x32_bf16 v[228:231], v[60:63], a[44:47], v[228:231]
    v_perm_b32 v48, v22, v22, v8
    v_perm_b32 v49, v22, v22, v10
    v_perm_b32 v50, v22, v22, v12
    v_perm_b32 v51, v22, v22, v14
    s_nop 1
    v_mfma_f32_16x16x32_bf16 v[224:227], v[48:51], a[48:51], v[224:227]
    v_perm_b32 v52, v38, v38, v8
    v_perm_b32 v53, v38, v38, v10
    v_perm_b32 v54, v38, v38, v12
    v_perm_b32 v55, v38, v38, v14
    s_nop 1
    v_mfma_f32_16x16x32_bf16 v[228:231], v[52:55], a[48:51], v[228:231]
    v_perm_b32 v56, v22, v22, v9
    v_perm_b32 v57, v22, v22, v11
    v_perm_b32 v58, v22, v22, v13
    v_perm_b32 v59, v22, v22, v15
    s_nop 1
    v_mfma_f32_16x16x32_bf16 v[224:227], v[56:59], a[52:55], v[224:227]
    v_perm_b32 v60, v38, v38, v9
    v_perm_b32 v61, v38, v38, v11
    v_perm_b32 v62, v38, v38, v13
    v_perm_b32 v63, v38, v38, v15
    s_nop 1
    v_mfma_f32_16x16x32_bf16 v[228:231], v[60:63], a[52:55], v[228:231]
    v_perm_b32 v48, v23, v23, v8
    v_perm_b32 v49, v23, v23, v10
    v_perm_b32 v50, v23, v23, v12
    v_perm_b32 v51, v23, v23, v14
    s_nop 1
    v_mfma_f32_16x16x32_bf16 v[224:227], v[48:51], a[56:59], v[224:227]
    v_perm_b32 v52, v39, v39, v8
    v_perm_b32 v53, v39, v39, v10
    v_perm_b32 v54, v39, v39, v12
    v_perm_b32 v55, v39, v39, v14
    s_nop 1
    v_mfma_f32_16x16x32_bf16 v[228:231], v[52:55], a[56:59], v[228:231]
    v_perm_b32 v56, v23, v23, v9
    v_perm_b32 v57, v23, v23, v11
    v_perm_b32 v58, v23, v23, v13
    v_perm_b32 v59, v23, v23, v15
    s_nop 1
    v_mfma_f32_16x16x32_bf16 v[224:227], v[56:59], a[60:63], v[224:227]
    v_perm_b32 v60, v39, v39, v9
    v_perm_b32 v61, v39, v39, v11
    v_perm_b32 v62, v39, v39, v13
    v_perm_b32 v63, v39, v39, v15
    s_nop 1
    v_mfma_f32_16x16x32_bf16 v[228:231], v[60:63], a[60:63], v[228:231]
    v_perm_b32 v48, v24, v24, v8
    v_perm_b32 v49, v24, v24, v10
    v_perm_b32 v50, v24, v24, v12
    v_perm_b32 v51, v24, v24, v14
    s_nop 1
    v_mfma_f32_16x16x32_bf16 v[224:227], v[48:51], a[64:67], v[224:227]
    v_perm_b32 v52, v40, v40, v8
    v_perm_b32 v53, v40, v40, v10
    v_perm_b32 v54, v40, v40, v12
    v_perm_b32 v55, v40, v40, v14
    s_nop 1
    v_mfma_f32_16x16x32_bf16 v[228:231], v[52:55], a[64:67], v[228:231]
    v_perm_b32 v56, v24, v24, v9
    v_perm_b32 v57, v24, v24, v11
    v_perm_b32 v58, v24, v24, v13
    v_perm_b32 v59, v24, v24, v15
    s_nop 1
    v_mfma_f32_16x16x32_bf16 v[224:227], v[56:59], a[68:71], v[224:227]
    v_perm_b32 v60, v40, v40, v9
    v_perm_b32 v61, v40, v40, v11
    v_perm_b32 v62, v40, v40, v13
    v_perm_b32 v63, v40, v40, v15
    s_nop 1
    v_mfma_f32_16x16x32_bf16 v[228:231], v[60:63], a[68:71], v[228:231]
    v_perm_b32 v48, v25, v25, v8
    v_perm_b32 v49, v25, v25, v10
    v_perm_b32 v50, v25, v25, v12
    v_perm_b32 v51, v25, v25, v14
    s_nop 1
    v_mfma_f32_16x16x32_bf16 v[224:227], v[48:51], a[72:75], v[224:227]
    v_perm_b32 v52, v41, v41, v8
    v_perm_b32 v53, v41, v41, v10
    v_perm_b32 v54, v41, v41, v12
    v_perm_b32 v55, v41, v41, v14
    s_nop 1
    v_mfma_f32_16x16x32_bf16 v[228:231], v[52:55], a[72:75], v[228:231]
    v_perm_b32 v56, v25, v25, v9
    v_perm_b32 v57, v25, v25, v11
    v_perm_b32 v58, v25, v25, v13
    v_perm_b32 v59, v25, v25, v15
    s_nop 1
    v_mfma_f32_16x16x32_bf16 v[224:227], v[56:59], a[76:79], v[224:227]
    v_perm_b32 v60, v41, v41, v9
    v_perm_b32 v61, v41, v41, v11
    v_perm_b32 v62, v41, v41, v13
    v_perm_b32 v63, v41, v41, v15
    s_nop 1
    v_mfma_f32_16x16x32_bf16 v[228:231], v[60:63], a[76:79], v[228:231]
    v_perm_b32 v48, v26, v26, v8
    v_perm_b32 v49, v26, v26, v10
    v_perm_b32 v50, v26, v26, v12
    v_perm_b32 v51, v26, v26, v14
    s_nop 1
    v_mfma_f32_16x16x32_bf16 v[224:227], v[48:51], a[80:83], v[224:227]
    v_perm_b32 v52, v42, v42, v8
    v_perm_b32 v53, v42, v42, v10
    v_perm_b32 v54, v42, v42, v12
    v_perm_b32 v55, v42, v42, v14
    s_nop 1
    v_mfma_f32_16x16x32_bf16 v[228:231], v[52:55], a[80:83], v[228:231]
    v_perm_b32 v56, v26, v26, v9
    v_perm_b32 v57, v26, v26, v11
    v_perm_b32 v58, v26, v26, v13
    v_perm_b32 v59, v26, v26, v15
    s_nop 1
    v_mfma_f32_16x16x32_bf16 v[224:227], v[56:59], a[84:87], v[224:227]
    v_perm_b32 v60, v42, v42, v9
    v_perm_b32 v61, v42, v42, v11
    v_perm_b32 v62, v42, v42, v13
    v_perm_b32 v63, v42, v42, v15
    s_nop 1
    v_mfma_f32_16x16x32_bf16 v[228:231], v[60:63], a[84:87], v[228:231]
    v_perm_b32 v48, v27, v27, v8
    v_perm_b32 v49, v27, v27, v10
    v_perm_b32 v50, v27, v27, v12
    v_perm_b32 v51, v27, v27, v14
    s_nop 1
    v_mfma_f32_16x16x32_bf16 v[224:227], v[48:51], a[88:91], v[224:227]
    v_perm_b32 v52, v43, v43, v8
    v_perm_b32 v53, v43, v43, v10
    v_perm_b32 v54, v43, v43, v12
    v_perm_b32 v55, v43, v43, v14
    s_nop 1
    v_mfma_f32_16x16x32_bf16 v[228:231], v[52:55], a[88:91], v[228:231]
    v_perm_b32 v56, v27, v27, v9
    v_perm_b32 v57, v27, v27, v11
    v_perm_b32 v58, v27, v27, v13
    v_perm_b32 v59, v27, v27, v15
    s_nop 1
    v_mfma_f32_16x16x32_bf16 v[224:227], v[56:59], a[92:95], v[224:227]
    v_perm_b32 v60, v43, v43, v9
    v_perm_b32 v61, v43, v43, v11
    v_perm_b32 v62, v43, v43, v13
    v_perm_b32 v63, v43, v43, v15
    s_nop 1
    v_mfma_f32_16x16x32_bf16 v[228:231], v[60:63], a[92:95], v[228:231]
    v_perm_b32 v48, v28, v28, v8
    v_perm_b32 v49, v28, v28, v10
    v_perm_b32 v50, v28, v28, v12
    v_perm_b32 v51, v28, v28, v14
    s_nop 1
    v_mfma_f32_16x16x32_bf16 v[224:227], v[48:51], a[96:99], v[224:227]
    v_perm_b32 v52, v44, v44, v8
    v_perm_b32 v53, v44, v44, v10
    v_perm_b32 v54, v44, v44, v12
    v_perm_b32 v55, v44, v44, v14
    s_nop 1
    v_mfma_f32_16x16x32_bf16 v[228:231], v[52:55], a[96:99], v[228:231]
    v_perm_b32 v56, v28, v28, v9
    v_perm_b32 v57, v28, v28, v11
    v_perm_b32 v58, v28, v28, v13
    v_perm_b32 v59, v28, v28, v15
    s_nop 1
    v_mfma_f32_16x16x32_bf16 v[224:227], v[56:59], a[100:103], v[224:227]
    v_perm_b32 v60, v44, v44, v9
    v_perm_b32 v61, v44, v44, v11
    v_perm_b32 v62, v44, v44, v13
    v_perm_b32 v63, v44, v44, v15
    s_nop 1
    v_mfma_f32_16x16x32_bf16 v[228:231], v[60:63], a[100:103], v[228:231]
    v_perm_b32 v48, v29, v29, v8
    v_perm_b32 v49, v29, v29, v10
    v_perm_b32 v50, v29, v29, v12
    v_perm_b32 v51, v29, v29, v14
    s_nop 1
    v_mfma_f32_16x16x32_bf16 v[224:227], v[48:51], a[104:107], v[224:227]
    v_perm_b32 v52, v45, v45, v8
    v_perm_b32 v53, v45, v45, v10
    v_perm_b32 v54, v45, v45, v12
    v_perm_b32 v55, v45, v45, v14
    s_nop 1
    v_mfma_f32_16x16x32_bf16 v[228:231], v[52:55], a[104:107], v[228:231]
    v_perm_b32 v56, v29, v29, v9
    v_perm_b32 v57, v29, v29, v11
    v_perm_b32 v58, v29, v29, v13
    v_perm_b32 v59, v29, v29, v15
    s_nop 1
    v_mfma_f32_16x16x32_bf16 v[224:227], v[56:59], a[108:111], v[224:227]
    v_perm_b32 v60, v45, v45, v9
    v_perm_b32 v61, v45, v45, v11
    v_perm_b32 v62, v45, v45, v13
    v_perm_b32 v63, v45, v45, v15
    s_nop 1
    v_mfma_f32_16x16x32_bf16 v[228:231], v[60:63], a[108:111], v[228:231]
    v_perm_b32 v48, v30, v30, v8
    v_perm_b32 v49, v30, v30, v10
    v_perm_b32 v50, v30, v30, v12
    v_perm_b32 v51, v30, v30, v14
    s_nop 1
    v_mfma_f32_16x16x32_bf16 v[224:227], v[48:51], a[112:115], v[224:227]
    v_perm_b32 v52, v46, v46, v8
    v_perm_b32 v53, v46, v46, v10
    v_perm_b32 v54, v46, v46, v12
    v_perm_b32 v55, v46, v46, v14
    s_nop 1
    v_mfma_f32_16x16x32_bf16 v[228:231], v[52:55], a[112:115], v[228:231]
    v_perm_b32 v56, v30, v30, v9
    v_perm_b32 v57, v30, v30, v11
    v_perm_b32 v58, v30, v30, v13
    v_perm_b32 v59, v30, v30, v15
    s_nop 1
    v_mfma_f32_16x16x32_bf16 v[224:227], v[56:59], a[116:119], v[224:227]
    v_perm_b32 v60, v46, v46, v9
    v_perm_b32 v61, v46, v46, v11
    v_perm_b32 v62, v46, v46, v13
    v_perm_b32 v63, v46, v46, v15
    s_nop 1
    v_mfma_f32_16x16x32_bf16 v[228:231], v[60:63], a[116:119], v[228:231]
    v_perm_b32 v48, v31, v31, v8
    v_perm_b32 v49, v31, v31, v10
    v_perm_b32 v50, v31, v31, v12
    v_perm_b32 v51, v31, v31, v14
    s_nop 1
    v_mfma_f32_16x16x32_bf16 v[224:227], v[48:51], a[120:123], v[224:227]
    v_perm_b32 v52, v47, v47, v8
    v_perm_b32 v53, v47, v47, v10
    v_perm_b32 v54, v47, v47, v12
    v_perm_b32 v55, v47, v47, v14
    s_nop 1
    v_mfma_f32_16x16x32_bf16 v[228:231], v[52:55], a[120:123], v[228:231]
    v_perm_b32 v56, v31, v31, v9
    v_perm_b32 v57, v31, v31, v11
    v_perm_b32 v58, v31, v31, v13
    v_perm_b32 v59, v31, v31, v15
    s_nop 1
    v_mfma_f32_16x16x32_bf16 v[224:227], v[56:59], a[124:127], v[224:227]
    v_perm_b32 v60, v47, v47, v9
    v_perm_b32 v61, v47, v47, v11
    v_perm_b32 v62, v47, v47, v13
    v_perm_b32 v63, v47, v47, v15
    s_nop 1
    v_mfma_f32_16x16x32_bf16 v[228:231], v[60:63], a[124:127], v[228:231]
    v_lshrrev_b32 v5, 1, v4
    v_lshlrev_b32 v5, 9, v5
    v_lshl_add_u32 v5, v3, 5, v5
    v_and_b32 v6, 1, v4
    v_lshl_add_u32 v5, v6, 4, v5
    s_lshl_b32 s54, s3, 11
    s_add_u32 s54, s54, 131072
    v_add_u32 v5, s54, v5
    ds_write_b128 v5, v[224:227]
    ds_write_b128 v5, v[228:231] offset:1024
    s_waitcnt lgkmcnt(0)
    s_barrier
    v_lshrrev_b32 v5, 2, v3
    v_lshlrev_b32 v5, 9, v5
    v_lshl_add_u32 v5, v4, 5, v5
    v_add_u32 v5, 131072, v5
    ds_read_b128 v[16:19], v5 offset:0
    ds_read_b128 v[20:23], v5 offset:16
    ds_read_b128 v[24:27], v5 offset:2048
    ds_read_b128 v[28:31], v5 offset:2064
    ds_read_b128 v[32:35], v5 offset:4096
    ds_read_b128 v[36:39], v5 offset:4112
    ds_read_b128 v[40:43], v5 offset:6144
    ds_read_b128 v[44:47], v5 offset:6160
    s_waitcnt lgkmcnt(0)
    v_add_f32 v16, v16, v24
    v_add_f32 v32, v32, v40
    v_add_f32 v17, v17, v25
    v_add_f32 v33, v33, v41
    v_add_f32 v18, v18, v26
    v_add_f32 v34, v34, v42
    v_add_f32 v19, v19, v27
    v_add_f32 v35, v35, v43
    v_add_f32 v20, v20, v28
    v_add_f32 v36, v36, v44
    v_add_f32 v21, v21, v29
    v_add_f32 v37, v37, v45
    v_add_f32 v22, v22, v30
    v_add_f32 v38, v38, v46
    v_add_f32 v23, v23, v31
    v_add_f32 v39, v39, v47
    v_add_f32 v16, v16, v32
    v_add_f32 v17, v17, v33
    v_add_f32 v18, v18, v34
    v_add_f32 v19, v19, v35
    v_add_f32 v20, v20, v36
    v_add_f32 v21, v21, v37
    v_add_f32 v22, v22, v38
    v_add_f32 v23, v23, v39
    v_cvt_pk_bf16_f32 v48, v16, v17
    v_cvt_pk_bf16_f32 v49, v18, v19
    v_cvt_pk_bf16_f32 v50, v20, v21
    v_cvt_pk_bf16_f32 v51, v22, v23
    ds_read_b128 v[16:19], v5 offset:128
    ds_read_b128 v[20:23], v5 offset:144
    ds_read_b128 v[24:27], v5 offset:2176
    ds_read_b128 v[28:31], v5 offset:2192
    ds_read_b128 v[32:35], v5 offset:4224
    ds_read_b128 v[36:39], v5 offset:4240
    ds_read_b128 v[40:43], v5 offset:6272
    ds_read_b128 v[44:47], v5 offset:6288
    s_waitcnt lgkmcnt(0)
    v_add_f32 v16, v16, v24
    v_add_f32 v32, v32, v40
    v_add_f32 v17, v17, v25
    v_add_f32 v33, v33, v41
    v_add_f32 v18, v18, v26
    v_add_f32 v34, v34, v42
    v_add_f32 v19, v19, v27
    v_add_f32 v35, v35, v43
    v_add_f32 v20, v20, v28
    v_add_f32 v36, v36, v44
    v_add_f32 v21, v21, v29
    v_add_f32 v37, v37, v45
    v_add_f32 v22, v22, v30
    v_add_f32 v38, v38, v46
    v_add_f32 v23, v23, v31
    v_add_f32 v39, v39, v47
    v_add_f32 v16, v16, v32
    v_add_f32 v17, v17, v33
    v_add_f32 v18, v18, v34
    v_add_f32 v19, v19, v35
    v_add_f32 v20, v20, v36
    v_add_f32 v21, v21, v37
    v_add_f32 v22, v22, v38
    v_add_f32 v23, v23, v39
    v_cvt_pk_bf16_f32 v52, v16, v17
    v_cvt_pk_bf16_f32 v53, v18, v19
    v_cvt_pk_bf16_f32 v54, v20, v21
    v_cvt_pk_bf16_f32 v55, v22, v23
    ds_read_b128 v[16:19], v5 offset:256
    ds_read_b128 v[20:23], v5 offset:272
    ds_read_b128 v[24:27], v5 offset:2304
    ds_read_b128 v[28:31], v5 offset:2320
    ds_read_b128 v[32:35], v5 offset:4352
    ds_read_b128 v[36:39], v5 offset:4368
    ds_read_b128 v[40:43], v5 offset:6400
    ds_read_b128 v[44:47], v5 offset:6416
    s_waitcnt lgkmcnt(0)
    v_add_f32 v16, v16, v24
    v_add_f32 v32, v32, v40
    v_add_f32 v17, v17, v25
    v_add_f32 v33, v33, v41
    v_add_f32 v18, v18, v26
    v_add_f32 v34, v34, v42
    v_add_f32 v19, v19, v27
    v_add_f32 v35, v35, v43
    v_add_f32 v20, v20, v28
    v_add_f32 v36, v36, v44
    v_add_f32 v21, v21, v29
    v_add_f32 v37, v37, v45
    v_add_f32 v22, v22, v30
    v_add_f32 v38, v38, v46
    v_add_f32 v23, v23, v31
    v_add_f32 v39, v39, v47
    v_add_f32 v16, v16, v32
    v_add_f32 v17, v17, v33
    v_add_f32 v18, v18, v34
    v_add_f32 v19, v19, v35
    v_add_f32 v20, v20, v36
    v_add_f32 v21, v21, v37
    v_add_f32 v22, v22, v38
    v_add_f32 v23, v23, v39
    v_cvt_pk_bf16_f32 v56, v16, v17
    v_cvt_pk_bf16_f32 v57, v18, v19
    v_cvt_pk_bf16_f32 v58, v20, v21
    v_cvt_pk_bf16_f32 v59, v22, v23
    ds_read_b128 v[16:19], v5 offset:384
    ds_read_b128 v[20:23], v5 offset:400
    ds_read_b128 v[24:27], v5 offset:2432
    ds_read_b128 v[28:31], v5 offset:2448
    ds_read_b128 v[32:35], v5 offset:4480
    ds_read_b128 v[36:39], v5 offset:4496
    ds_read_b128 v[40:43], v5 offset:6528
    ds_read_b128 v[44:47], v5 offset:6544
    s_waitcnt lgkmcnt(0)
    v_add_f32 v16, v16, v24
    v_add_f32 v32, v32, v40
    v_add_f32 v17, v17, v25
    v_add_f32 v33, v33, v41
    v_add_f32 v18, v18, v26
    v_add_f32 v34, v34, v42
    v_add_f32 v19, v19, v27
    v_add_f32 v35, v35, v43
    v_add_f32 v20, v20, v28
    v_add_f32 v36, v36, v44
    v_add_f32 v21, v21, v29
    v_add_f32 v37, v37, v45
    v_add_f32 v22, v22, v30
    v_add_f32 v38, v38, v46
    v_add_f32 v23, v23, v31
    v_add_f32 v39, v39, v47
    v_add_f32 v16, v16, v32
    v_add_f32 v17, v17, v33
    v_add_f32 v18, v18, v34
    v_add_f32 v19, v19, v35
    v_add_f32 v20, v20, v36
    v_add_f32 v21, v21, v37
    v_add_f32 v22, v22, v38
    v_add_f32 v23, v23, v39
    v_cvt_pk_bf16_f32 v60, v16, v17
    v_cvt_pk_bf16_f32 v61, v18, v19
    v_cvt_pk_bf16_f32 v62, v20, v21
    v_cvt_pk_bf16_f32 v63, v22, v23
    v_mfma_f32_16x16x32_bf16 v[224:227], v[48:51], v[64:67], 0
    v_mfma_f32_16x16x32_bf16 v[228:231], v[48:51], v[68:71], 0
    v_mfma_f32_16x16x32_bf16 v[232:235], v[48:51], v[72:75], 0
    v_mfma_f32_16x16x32_bf16 v[236:239], v[48:51], v[76:79], 0
    v_mfma_f32_16x16x32_bf16 v[240:243], v[48:51], v[80:83], 0
    v_mfma_f32_16x16x32_bf16 v[244:247], v[48:51], v[84:87], 0
    v_mfma_f32_16x16x32_bf16 v[248:251], v[48:51], v[88:91], 0
    v_mfma_f32_16x16x32_bf16 v[252:255], v[48:51], v[92:95], 0
    v_mfma_f32_16x16x32_bf16 v[40:43], v[48:51], v[192:195], 0
    v_mfma_f32_16x16x32_bf16 v[44:47], v[48:51], v[196:199], 0
    v_mfma_f32_16x16x32_bf16 v[224:227], v[52:55], v[96:99], v[224:227]
    v_mfma_f32_16x16x32_bf16 v[228:231], v[52:55], v[100:103], v[228:231]
    v_mfma_f32_16x16x32_bf16 v[232:235], v[52:55], v[104:107], v[232:235]
    v_mfma_f32_16x16x32_bf16 v[236:239], v[52:55], v[108:111], v[236:239]
    v_mfma_f32_16x16x32_bf16 v[240:243], v[52:55], v[112:115], v[240:243]
    v_mfma_f32_16x16x32_bf16 v[244:247], v[52:55], v[116:119], v[244:247]
    v_mfma_f32_16x16x32_bf16 v[248:251], v[52:55], v[120:123], v[248:251]
    v_mfma_f32_16x16x32_bf16 v[252:255], v[52:55], v[124:127], v[252:255]
    v_mfma_f32_16x16x32_bf16 v[40:43], v[52:55], v[200:203], v[40:43]
    v_mfma_f32_16x16x32_bf16 v[44:47], v[52:55], v[204:207], v[44:47]
    v_mfma_f32_16x16x32_bf16 v[224:227], v[56:59], v[128:131], v[224:227]
    v_mfma_f32_16x16x32_bf16 v[228:231], v[56:59], v[132:135], v[228:231]
    v_mfma_f32_16x16x32_bf16 v[232:235], v[56:59], v[136:139], v[232:235]
    v_mfma_f32_16x16x32_bf16 v[236:239], v[56:59], v[140:143], v[236:239]
    v_mfma_f32_16x16x32_bf16 v[240:243], v[56:59], v[144:147], v[240:243]
    v_mfma_f32_16x16x32_bf16 v[244:247], v[56:59], v[148:151], v[244:247]
    v_mfma_f32_16x16x32_bf16 v[248:251], v[56:59], v[152:155], v[248:251]
    v_mfma_f32_16x16x32_bf16 v[252:255], v[56:59], v[156:159], v[252:255]
    v_mfma_f32_16x16x32_bf16 v[40:43], v[56:59], v[208:211], v[40:43]
    v_mfma_f32_16x16x32_bf16 v[44:47], v[56:59], v[212:215], v[44:47]
    v_mfma_f32_16x16x32_bf16 v[224:227], v[60:63], v[160:163], v[224:227]
    v_mfma_f32_16x16x32_bf16 v[228:231], v[60:63], v[164:167], v[228:231]
    v_mfma_f32_16x16x32_bf16 v[232:235], v[60:63], v[168:171], v[232:235]
    v_mfma_f32_16x16x32_bf16 v[236:239], v[60:63], v[172:175], v[236:239]
    v_mfma_f32_16x16x32_bf16 v[240:243], v[60:63], v[176:179], v[240:243]
    v_mfma_f32_16x16x32_bf16 v[244:247], v[60:63], v[180:183], v[244:247]
    v_mfma_f32_16x16x32_bf16 v[248:251], v[60:63], v[184:187], v[248:251]
    v_mfma_f32_16x16x32_bf16 v[252:255], v[60:63], v[188:191], v[252:255]
    v_mfma_f32_16x16x32_bf16 v[40:43], v[60:63], v[216:219], v[40:43]
    v_mfma_f32_16x16x32_bf16 v[44:47], v[60:63], v[220:223], v[44:47]
    v_mul_u32_u24 v7, 73728, v4
    v_lshrrev_b32 v5, 3, v3
    v_lshl_add_u32 v6, v5, 13, v7
    v_and_b32 v5, 7, v3
    v_lshl_add_u32 v6, v5, 4, v6
    v_lshl_add_u32 v7, v3, 3, v7
    v_add_u32 v7, 65536, v7
    s_lshl_b32 s56, s52, 7
    s_add_u32 s56, s56, 4718592
    s_lshl_b32 s54, s3, 14
    s_add_u32 s54, s54, s56
    s_add_u32 s55, s54, 4096
    s_and_b32 s57, s3, 1
    s_lshl_b32 s57, s57, 12
    s_add_u32 s56, s56, s57
    v_min_u32 v16, -2, v224
    v_min_u32 v17, -2, v228
    v_min_u32 v18, -2, v232
    v_min_u32 v19, -2, v236
    v_min_u32 v20, -2, v240
    v_min_u32 v21, -2, v244
    v_min_u32 v22, -2, v248
    v_min_u32 v23, -2, v252
    v_min_u32 v24, -2, v40
    v_min_u32 v25, -2, v44
    buffer_store_dwordx4 v[16:19], v6, s[44:47], s54 offen sc1
    buffer_store_dwordx4 v[20:23], v6, s[44:47], s55 offen sc1
    buffer_store_dwordx2 v[24:25], v7, s[44:47], s56 offen sc1
    s_mov_b32 s48, s26
    s_mov_b32 s49, s27
    s_mov_b32 s50, 9216
    s_mov_b32 s51, 0x20000
    s_lshl_b32 s54, s3, 5
    s_add_u32 s54, s54, s53
    s_cmp_ge_u32 s54, 72
    s_cbranch_scc1 L_nored_8
    v_mov_b32 v48, -1
    v_mov_b32 v49, -1
    v_mov_b32 v50, -1
    v_mov_b32 v51, -1
    v_mov_b32 v52, -1
    v_mov_b32 v53, -1
    v_mov_b32 v54, -1
    v_mov_b32 v55, -1
    v_mov_b32 v56, -1
    v_mov_b32 v57, -1
    v_mov_b32 v58, -1
    v_mov_b32 v59, -1
    v_mov_b32 v60, -1
    v_mov_b32 v61, -1
    v_mov_b32 v62, -1
    v_mov_b32 v63, -1
    s_lshl_b32 s55, s54, 12
    s_add_u32 s55, s55, 4718592
    s_mul_hi_u32 s56, s54, 238609295
    s_mul_i32 s57, s56, 18
    s_sub_u32 s57, s54, s57
    s_mul_i32 s56, s56, 2304
    s_add_u32 s56, s56, 1152
    s_lshr_b32 s58, s57, 1
    s_lshl_b32 s58, s58, 7
    s_and_b32 s59, s57, 1
    s_cmp_lt_u32 s57, 16
    s_cselect_b32 s60, 3, 6
    s_cselect_b32 s61, 4, 3
    s_lshl_b32 s59, s59, s60
    s_add_u32 s56, s56, s58
    s_add_u32 s56, s56, s59
    v_lshlrev_b32 v5, s61, v3
    v_lshl_add_u32 v5, v4, 1, v5
    v_mov_b32 v6, 0x4000
    v_cmp_gt_u32 vcc, 8, v3
    s_nop 1
    v_cndmask_b32 v5, v6, v5, vcc
    s_mov_b64 s[4:5], -1
    s_mov_b64 s[6:7], -1
    s_mov_b64 s[8:9], -1
    s_mov_b64 s[10:11], -1
L_mpoll_9:
    s_mov_b64 exec, s[4:5]
    buffer_load_dwordx4 v[48:51], v2, s[44:47], s55 offen offset:0 sc1
    s_mov_b64 exec, s[6:7]
    buffer_load_dwordx4 v[52:55], v2, s[44:47], s55 offen offset:1024 sc1
    s_mov_b64 exec, s[8:9]
    buffer_load_dwordx4 v[56:59], v2, s[44:47], s55 offen offset:2048 sc1
    s_mov_b64 exec, s[10:11]
    buffer_load_dwordx4 v[60:63], v2, s[44:47], s55 offen offset:3072 sc1
    s_mov_b64 exec, -1
    s_waitcnt vmcnt(4)
    v_max3_u32 v32, v48, v49, v50
    v_max3_u32 v33, v52, v53, v54
    v_max3_u32 v34, v56, v57, v58
    v_max3_u32 v35, v60, v61, v62
    v_max_u32 v32, v32, v51
    v_max_u32 v33, v33, v55
    v_max_u32 v34, v34, v59
    v_max_u32 v35, v35, v63
    v_cmp_eq_u32 s[4:5], -1, v32
    v_cmp_eq_u32 s[6:7], -1, v33
    v_cmp_eq_u32 s[8:9], -1, v34
    v_cmp_eq_u32 s[10:11], -1, v35
    s_or_b64 vcc, s[4:5], s[6:7]
    s_or_b64 vcc, vcc, s[8:9]
    s_or_b64 vcc, vcc, s[10:11]
    s_cbranch_scc0 L_mpollok_10
    s_sub_u32 s101, s101, 1
    s_cbranch_scc0 L_mpoll_9
    s_mov_b32 s101, 0
L_mpollok_10:
    v_add_f32 v16, v48, v52
    v_add_f32 v24, v56, v60
    v_add_f32 v18, v50, v54
    v_add_f32 v26, v58, v62
    v_add_f32 v17, v49, v53
    v_add_f32 v25, v57, v61
    v_add_f32 v19, v51, v55
    v_add_f32 v27, v59, v63
    v_add_f32 v16, v16, v24
    v_add_f32 v18, v18, v26
    v_add_f32 v17, v17, v25
    v_add_f32 v19, v19, v27
    v_permlane32_swap_b32 v16, v18
    s_nop 0
    v_permlane32_swap_b32 v17, v19
    v_add_f32 v16, v16, v18
    v_add_f32 v17, v17, v19
    s_nop 1
    v_permlane16_swap_b32 v16, v17
    v_add_f32 v16, v16, v17
    s_nop 1
    v_add_f32_dpp v16, v16, v16 row_ror:8 row_mask:0xf bank_mask:0xf
    v_cvt_pk_bf16_f32 v16, v16, v16
    buffer_store_short v16, v5, s[48:51], s56 offen
L_nored_8:
    s_lshl_b32 s54, s3, 5
    s_add_u32 s54, s54, s53
    s_sub_u32 s54, 127, s54
    s_cmp_ge_u32 s54, 72
    s_cbranch_scc1 L_nored_11
    s_waitcnt vmcnt(0)
    v_mov_b32 v48, -1
    v_mov_b32 v49, -1
    v_mov_b32 v50, -1
    v_mov_b32 v51, -1
    v_mov_b32 v52, -1
    v_mov_b32 v53, -1
    v_mov_b32 v54, -1
    v_mov_b32 v55, -1
    v_mov_b32 v56, -1
    v_mov_b32 v57, -1
    v_mov_b32 v58, -1
    v_mov_b32 v59, -1
    v_mov_b32 v60, -1
    v_mov_b32 v61, -1
    v_mov_b32 v62, -1
    v_mov_b32 v63, -1
    s_lshl_b32 s55, s54, 12
    s_add_u32 s55, s55, 4194304
    s_mul_hi_u32 s56, s54, 238609295
    s_mul_i32 s57, s56, 18
    s_sub_u32 s57, s54, s57
    s_mul_i32 s56, s56, 2304
    s_add_u32 s56, s56, 0
    s_lshr_b32 s58, s57, 1
    s_lshl_b32 s58, s58, 7
    s_and_b32 s59, s57, 1
    s_cmp_lt_u32 s57, 16
    s_cselect_b32 s60, 3, 6
    s_cselect_b32 s61, 4, 3
    s_lshl_b32 s59, s59, s60
    s_add_u32 s56, s56, s58
    s_add_u32 s56, s56, s59
    v_lshlrev_b32 v5, s61, v3
    v_lshl_add_u32 v5, v4, 1, v5
    v_mov_b32 v6, 0x4000
    v_cmp_gt_u32 vcc, 8, v3
    s_nop 1
    v_cndmask_b32 v5, v6, v5, vcc
    s_mov_b64 s[4:5], -1
    s_mov_b64 s[6:7], -1
    s_mov_b64 s[8:9], -1
    s_mov_b64 s[10:11], -1
L_mpoll_12:
    s_mov_b64 exec, s[4:5]
    buffer_load_dwordx4 v[48:51], v2, s[44:47], s55 offen offset:0 sc1
    s_mov_b64 exec, s[6:7]
    buffer_load_dwordx4 v[52:55], v2, s[44:47], s55 offen offset:1024 sc1
    s_mov_b64 exec, s[8:9]
    buffer_load_dwordx4 v[56:59], v2, s[44:47], s55 offen offset:2048 sc1
    s_mov_b64 exec, s[10:11]
    buffer_load_dwordx4 v[60:63], v2, s[44:47], s55 offen offset:3072 sc1
    s_mov_b64 exec, -1
    s_waitcnt vmcnt(4)
    v_max3_u32 v32, v48, v49, v50
    v_max3_u32 v33, v52, v53, v54
    v_max3_u32 v34, v56, v57, v58
    v_max3_u32 v35, v60, v61, v62
    v_max_u32 v32, v32, v51
    v_max_u32 v33, v33, v55
    v_max_u32 v34, v34, v59
    v_max_u32 v35, v35, v63
    v_cmp_eq_u32 s[4:5], -1, v32
    v_cmp_eq_u32 s[6:7], -1, v33
    v_cmp_eq_u32 s[8:9], -1, v34
    v_cmp_eq_u32 s[10:11], -1, v35
    s_or_b64 vcc, s[4:5], s[6:7]
    s_or_b64 vcc, vcc, s[8:9]
    s_or_b64 vcc, vcc, s[10:11]
    s_cbranch_scc0 L_mpollok_13
    s_and_b64 vcc, s[4:5], s[6:7]
    s_and_b64 vcc, vcc, s[8:9]
    s_and_b64 vcc, vcc, s[10:11]
    s_cmp_eq_u64 vcc, -1
    s_cbranch_scc0 L_mpoll_12_b
    s_sleep 4
L_mpoll_12_b:
    s_sub_u32 s101, s101, 1
    s_cbranch_scc0 L_mpoll_12
    s_mov_b32 s101, 0
L_mpollok_13:
    v_add_f32 v16, v48, v52
    v_add_f32 v24, v56, v60
    v_add_f32 v18, v50, v54
    v_add_f32 v26, v58, v62
    v_add_f32 v17, v49, v53
    v_add_f32 v25, v57, v61
    v_add_f32 v19, v51, v55
    v_add_f32 v27, v59, v63
    v_add_f32 v16, v16, v24
    v_add_f32 v18, v18, v26
    v_add_f32 v17, v17, v25
    v_add_f32 v19, v19, v27
    v_permlane32_swap_b32 v16, v18
    s_nop 0
    v_permlane32_swap_b32 v17, v19
    v_add_f32 v16, v16, v18
    v_add_f32 v17, v17, v19
    s_nop 1
    v_permlane16_swap_b32 v16, v17
    v_add_f32 v16, v16, v17
    s_nop 1
    v_add_f32_dpp v16, v16, v16 row_ror:8 row_mask:0xf bank_mask:0xf
    v_cvt_pk_bf16_f32 v16, v16, v16
    buffer_store_short v16, v5, s[48:51], s56 offen
L_nored_11:
    s_endpgm
L_roleH_end:
L_roleC:
    s_mov_b32 s101, 100000
    s_getpc_b64 s[56:57]
L_pc_14:
    s_sub_u32 s56, s56, L_pc_14-L_roleC
    s_subb_u32 s57, s57, 0
    v_lshlrev_b32 v5, 7, v0
    v_min_u32 v6, L_roleC_end-L_roleC-4, v5
    global_load_dword v122, v6, s[56:57]
    v_add_u32 v5, 32768, v5
    v_min_u32 v6, L_roleC_end-L_roleC-4, v5
    global_load_dword v122, v6, s[56:57]
    v_mov_b32 v20, -1
    v_mov_b32 v21, -1
    v_mov_b32 v22, -1
    v_mov_b32 v23, -1
    v_mul_u32_u24 v7, 73728, v4
    v_lshrrev_b32 v5, 3, v3
    v_lshl_add_u32 v6, v5, 13, v7
    v_and_b32 v5, 7, v3
    v_lshl_add_u32 v6, v5, 4, v6
    v_lshl_add_u32 v7, v3, 3, v7
    v_add_u32 v7, 65536, v7
    s_lshl_b32 s56, s52, 7
    s_add_u32 s56, s56, 4194304
    s_lshl_b32 s54, s3, 14
    s_add_u32 s54, s54, s56
    s_add_u32 s55, s54, 4096
    s_and_b32 s57, s3, 1
    s_lshl_b32 s57, s57, 12
    s_add_u32 s56, s56, s57
    s_waitcnt lgkmcnt(0)
    s_mov_b32 s44, s30
    s_mov_b32 s45, s31
    s_mov_b32 s46, 536870912
    s_mov_b32 s47, 0x20000
    buffer_store_dwordx4 v[20:23], v6, s[44:47], s54 offen sc1
    buffer_store_dwordx4 v[20:23], v6, s[44:47], s55 offen sc1
    buffer_store_dwordx2 v[20:21], v7, s[44:47], s56 offen sc1
    v_mov_b32 v7, 536870912
    v_cmp_gt_u32 vcc, 32, v1
    s_nop 1
    v_cndmask_b32 v123, v7, v2, vcc
    s_lshl_b32 s98, s52, 12
    s_lshl_b32 s54, s3, 9
    s_add_u32 s98, s98, s54
    s_add_u32 s98, s98, 5244928
    buffer_store_dwordx4 v[20:23], v123, s[44:47], s98 offen sc1
    s_lshl_b32 s58, s52, 2
    s_add_u32 s58, s58, s3
    s_lshl_b32 s58, s58, 13
    s_add_u32 s58, s58, 8388608
    s_add_u32 s59, s58, 4096
    v_min_u32 v6, 1, v3
    v_lshl_add_u32 v6, v6, 2, v4
    v_lshlrev_b32 v6, 4, v6
    s_lshr_b32 s55, s52, 2
    s_add_u32 s55, s55, s3
    s_and_b32 s55, s55, 3
    s_and_b32 s54, s52, 3
    s_cmp_eq_u32 s54, s55
    s_mov_b32 s56, 255
    s_cselect_b32 s56, 16777215, s56
    s_mov_b32 s57, 0
    s_cbranch_scc0 L_cclr
    buffer_store_dwordx4 v[20:23], v2, s[44:47], s58 offen offset:2048 sc1
    buffer_store_dwordx4 v[20:23], v2, s[44:47], s58 offen offset:3072 sc1
    buffer_store_dwordx4 v[20:23], v2, s[44:47], s59 offen offset:0 sc1
    buffer_store_dwordx4 v[20:23], v2, s[44:47], s59 offen offset:1024 sc1
    s_lshl_b32 s55, s52, 2
    s_add_u32 s55, s55, s3
    s_lshl_b32 s55, s55, 7
    s_add_u32 s55, s55, 5373952
    v_mov_b32 v5, 0
    s_mov_b64 exec, 1
    buffer_store_dword v5, v5, s[44:47], s55 offen sc1
    s_lshl_b32 s55, s53, 8
    s_add_u32 s55, s55, 3145728
    s_mov_b64 exec, 0xffff
    buffer_store_dwordx4 v[20:23], v2, s[44:47], s55 offen sc1
    s_mov_b64 exec, -1
L_cclr:
    buffer_store_dwordx4 v[20:23], v2, s[44:47], s58 offen offset:0 sc1
    buffer_store_dwordx4 v[20:23], v2, s[44:47], s58 offen offset:1024 sc1
    s_mov_b64 exec, s[56:57]
    buffer_store_dwordx4 v[20:23], v2, s[44:47], s59 offen offset:2048 sc1
    s_mov_b64 exec, -1
    s_mov_b32 s40, s10
    s_mov_b32 s41, s11
    s_mov_b32 s42, 4718592
    s_mov_b32 s43, 0x20000
    s_mov_b32 s48, s4
    s_mov_b32 s49, s5
    s_mov_b32 s50, 4608
    s_mov_b32 s51, 0x20000
    s_mov_b32 s32, s16
    s_mov_b32 s33, s17
    s_mov_b32 s34, 16777216
    s_mov_b32 s35, 0x20000
    v_lshrrev_b32 v5, 3, v3
    v_mul_u32_u24 v5, 1152, v5
    v_mul_u32_u24 v6, 36, v4
    v_add_u32 v5, v5, v6
    s_mul_i32 s54, s3, 144
    s_add_u32 s54, s54, 576
    buffer_load_dwordx4 v[48:51], v5, s[48:51], s54 offen offset:0
    buffer_load_dwordx4 v[52:55], v5, s[48:51], s54 offen offset:16
    buffer_load_dword v56, v5, s[48:51], s54 offen offset:32
    buffer_load_dwordx4 v[60:63], v5, s[48:51], s54 offen offset:2304
    buffer_load_dwordx4 v[64:67], v5, s[48:51], s54 offen offset:2320
    buffer_load_dword v68, v5, s[48:51], s54 offen offset:2336
    v_mul_u32_u24 v120, 147456, v4
    v_lshl_add_u32 v120, v3, 4, v120
    s_mul_i32 s61, s3, 589824
    s_lshl_b32 s54, s52, 8
    s_add_u32 s61, s61, s54
    s_add_u32 s61, s61, 2359296
    buffer_load_dwordx4 a[0:3], v120, s[40:43], s61 offen nt
    s_add_u32 s61, s61, 8192
    buffer_load_dwordx4 a[4:7], v120, s[40:43], s61 offen nt
    s_add_u32 s61, s61, 8192
    buffer_load_dwordx4 a[8:11], v120, s[40:43], s61 offen nt
    s_add_u32 s61, s61, 8192
    buffer_load_dwordx4 a[12:15], v120, s[40:43], s61 offen nt
    s_add_u32 s61, s61, 8192
    buffer_load_dwordx4 a[16:19], v120, s[40:43], s61 offen nt
    s_add_u32 s61, s61, 8192
    buffer_load_dwordx4 a[20:23], v120, s[40:43], s61 offen nt
    s_add_u32 s61, s61, 8192
    buffer_load_dwordx4 a[24:27], v120, s[40:43], s61 offen nt
    s_add_u32 s61, s61, 8192
    buffer_load_dwordx4 a[28:31], v120, s[40:43], s61 offen nt
    s_add_u32 s61, s61, 8192
    buffer_load_dwordx4 a[32:35], v120, s[40:43], s61 offen nt
    s_add_u32 s61, s61, 8192
    buffer_load_dwordx4 a[36:39], v120, s[40:43], s61 offen nt
    s_add_u32 s61, s61, 8192
    buffer_load_dwordx4 a[40:43], v120, s[40:43], s61 offen nt
    s_add_u32 s61, s61, 8192
    buffer_load_dwordx4 a[44:47], v120, s[40:43], s61 offen nt
    s_add_u32 s61, s61, 8192
    buffer_load_dwordx4 a[48:51], v120, s[40:43], s61 offen nt
    s_add_u32 s61, s61, 8192
    buffer_load_dwordx4 a[52:55], v120, s[40:43], s61 offen nt
    s_add_u32 s61, s61, 8192
    buffer_load_dwordx4 a[56:59], v120, s[40:43], s61 offen nt
    s_add_u32 s61, s61, 8192
    buffer_load_dwordx4 a[60:63], v120, s[40:43], s61 offen nt
    s_add_u32 s61, s61, 8192
    buffer_load_dwordx4 a[64:67], v120, s[40:43], s61 offen nt
    s_add_u32 s61, s61, 8192
    buffer_load_dwordx4 a[68:71], v120, s[40:43], s61 offen nt
    s_add_u32 s61, s61, 8192
    v_and_b32 v5, 1, v3
    v_cmp_eq_u32 vcc, 1, v5
    v_mov_b32 v5, 0x0c0c0100
    v_mov_b32 v6, 0x01000c0c
    v_cndmask_b32 v5, v5, v6, vcc
    v_mov_b32 v6, 0x0c0c0302
    v_mov_b32 v7, 0x03020c0c
    v_cndmask_b32 v6, v6, v7, vcc
    v_bfe_u32 v7, v3, 1, 2
    v_mov_b32 v16, 0x0c0c0c0c
    v_cmp_eq_u32 vcc, 0, v7
    s_nop 1
    v_cndmask_b32 v8, v16, v5, vcc
    v_cndmask_b32 v9, v16, v6, vcc
    v_cmp_eq_u32 vcc, 1, v7
    s_nop 1
    v_cndmask_b32 v10, v16, v5, vcc
    v_cndmask_b32 v11, v16, v6, vcc
    v_cmp_eq_u32 vcc, 2, v7
    s_nop 1
    v_cndmask_b32 v12, v16, v5, vcc
    v_cndmask_b32 v13, v16, v6, vcc
    v_cmp_eq_u32 vcc, 3, v7
    s_nop 1
    v_cndmask_b32 v14, v16, v5, vcc
    v_cndmask_b32 v15, v16, v6, vcc
    s_waitcnt vmcnt(24)
    s_barrier
    s_cmp_lg_u32 s3, 0
    s_cbranch_scc1 L_nosig_15
    s_lshl_b32 s54, s52, 2
    v_mov_b32 v5, s54
    v_mov_b32 v6, 1
    s_mov_b64 exec, 1
    global_atomic_add v5, v6, s[28:29]
    s_mov_b64 exec, -1
L_nosig_15:
    v_lshlrev_b32 v5, 2, v4
    v_xor_b32 v5, v5, v3
    v_lshlrev_b32 v6, 10, v4
    v_xor_b32 v7, 0, v5
    v_lshl_add_u32 v20, v7, 4, v6
    v_xor_b32 v7, 1, v5
    v_lshl_add_u32 v21, v7, 4, v6
    v_add_u32 v21, 4096, v21
    v_xor_b32 v7, 2, v5
    v_lshl_add_u32 v22, v7, 4, v6
    v_add_u32 v22, 8192, v22
    v_xor_b32 v7, 3, v5
    v_lshl_add_u32 v23, v7, 4, v6
    v_add_u32 v23, 12288, v23
    s_lshl_b32 s58, s53, 19
    s_lshl_b32 s54, s3, 8
    s_add_u32 s58, s58, s54
    s_lshl_b32 s63, s3, 15
    s_mov_b32 s59, s63
    s_add_u32 m0, s59, 0
    s_add_u32 s54, s58, 0
    buffer_load_dwordx4 v20, s[32:35], s54 offen nt lds
    s_add_u32 m0, s59, 1024
    s_add_u32 s54, s58, 0
    buffer_load_dwordx4 v21, s[32:35], s54 offen nt lds
    s_add_u32 m0, s59, 2048
    s_add_u32 s54, s58, 0
    buffer_load_dwordx4 v22, s[32:35], s54 offen nt lds
    s_add_u32 m0, s59, 3072
    s_add_u32 s54, s58, 0
    buffer_load_dwordx4 v23, s[32:35], s54 offen nt lds
    s_add_u32 m0, s59, 4096
    s_add_u32 s54, s58, 16384
    buffer_load_dwordx4 v20, s[32:35], s54 offen nt lds
    s_add_u32 m0, s59, 5120
    s_add_u32 s54, s58, 16384
    buffer_load_dwordx4 v21, s[32:35], s54 offen nt lds
    s_add_u32 m0, s59, 6144
    s_add_u32 s54, s58, 16384
    buffer_load_dwordx4 v22, s[32:35], s54 offen nt lds
    s_add_u32 m0, s59, 7168
    s_add_u32 s54, s58, 16384
    buffer_load_dwordx4 v23, s[32:35], s54 offen nt lds
    s_add_u32 s58, s58, 32768
    s_add_u32 s59, s59, 8192
    s_waitcnt vmcnt(17)
    v_perm_b32 v96, v48, v48, v8
    v_perm_b32 v97, v48, v48, v10
    v_perm_b32 v98, v48, v48, v12
    v_perm_b32 v99, v48, v48, v14
    s_nop 1
    v_mfma_f32_16x16x32_bf16 v[112:115], v[96:99], a[0:3], 0
    v_perm_b32 v100, v60, v60, v8
    v_perm_b32 v101, v60, v60, v10
    v_perm_b32 v102, v60, v60, v12
    v_perm_b32 v103, v60, v60, v14
    s_nop 1
    v_mfma_f32_16x16x32_bf16 v[116:119], v[100:103], a[0:3], 0
    v_perm_b32 v104, v48, v48, v9
    v_perm_b32 v105, v48, v48, v11
    v_perm_b32 v106, v48, v48, v13
    v_perm_b32 v107, v48, v48, v15
    s_nop 1
    v_mfma_f32_16x16x32_bf16 v[112:115], v[104:107], a[4:7], v[112:115]
    v_perm_b32 v108, v60, v60, v9
    v_perm_b32 v109, v60, v60, v11
    v_perm_b32 v110, v60, v60, v13
    v_perm_b32 v111, v60, v60, v15
    s_nop 1
    v_mfma_f32_16x16x32_bf16 v[116:119], v[108:111], a[4:7], v[116:119]
    v_perm_b32 v96, v49, v49, v8
    v_perm_b32 v97, v49, v49, v10
    v_perm_b32 v98, v49, v49, v12
    v_perm_b32 v99, v49, v49, v14
    s_nop 1
    v_mfma_f32_16x16x32_bf16 v[112:115], v[96:99], a[8:11], v[112:115]
    v_perm_b32 v100, v61, v61, v8
    v_perm_b32 v101, v61, v61, v10
    v_perm_b32 v102, v61, v61, v12
    v_perm_b32 v103, v61, v61, v14
    s_nop 1
    v_mfma_f32_16x16x32_bf16 v[116:119], v[100:103], a[8:11], v[116:119]
    v_perm_b32 v104, v49, v49, v9
    v_perm_b32 v105, v49, v49, v11
    v_perm_b32 v106, v49, v49, v13
    v_perm_b32 v107, v49, v49, v15
    s_nop 1
    v_mfma_f32_16x16x32_bf16 v[112:115], v[104:107], a[12:15], v[112:115]
    v_perm_b32 v108, v61, v61, v9
    v_perm_b32 v109, v61, v61, v11
    v_perm_b32 v110, v61, v61, v13
    v_perm_b32 v111, v61, v61, v15
    s_nop 1
    v_mfma_f32_16x16x32_bf16 v[116:119], v[108:111], a[12:15], v[116:119]
    v_perm_b32 v96, v50, v50, v8
    v_perm_b32 v97, v50, v50, v10
    v_perm_b32 v98, v50, v50, v12
    v_perm_b32 v99, v50, v50, v14
    s_nop 1
    v_mfma_f32_16x16x32_bf16 v[112:115], v[96:99], a[16:19], v[112:115]
    v_perm_b32 v100, v62, v62, v8
    v_perm_b32 v101, v62, v62, v10
    v_perm_b32 v102, v62, v62, v12
    v_perm_b32 v103, v62, v62, v14
    s_nop 1
    v_mfma_f32_16x16x32_bf16 v[116:119], v[100:103], a[16:19], v[116:119]
    v_perm_b32 v104, v50, v50, v9
    v_perm_b32 v105, v50, v50, v11
    v_perm_b32 v106, v50, v50, v13
    v_perm_b32 v107, v50, v50, v15
    s_nop 1
    v_mfma_f32_16x16x32_bf16 v[112:115], v[104:107], a[20:23], v[112:115]
    v_perm_b32 v108, v62, v62, v9
    v_perm_b32 v109, v62, v62, v11
    v_perm_b32 v110, v62, v62, v13
    v_perm_b32 v111, v62, v62, v15
    s_nop 1
    v_mfma_f32_16x16x32_bf16 v[116:119], v[108:111], a[20:23], v[116:119]
    v_perm_b32 v96, v51, v51, v8
    v_perm_b32 v97, v51, v51, v10
    v_perm_b32 v98, v51, v51, v12
    v_perm_b32 v99, v51, v51, v14
    s_nop 1
    v_mfma_f32_16x16x32_bf16 v[112:115], v[96:99], a[24:27], v[112:115]
    v_perm_b32 v100, v63, v63, v8
    v_perm_b32 v101, v63, v63, v10
    v_perm_b32 v102, v63, v63, v12
    v_perm_b32 v103, v63, v63, v14
    s_nop 1
    v_mfma_f32_16x16x32_bf16 v[116:119], v[100:103], a[24:27], v[116:119]
    v_perm_b32 v104, v51, v51, v9
    v_perm_b32 v105, v51, v51, v11
    v_perm_b32 v106, v51, v51, v13
    v_perm_b32 v107, v51, v51, v15
    s_nop 1
    v_mfma_f32_16x16x32_bf16 v[112:115], v[104:107], a[28:31], v[112:115]
    v_perm_b32 v108, v63, v63, v9
    v_perm_b32 v109, v63, v63, v11
    v_perm_b32 v110, v63, v63, v13
    v_perm_b32 v111, v63, v63, v15
    s_nop 1
    v_mfma_f32_16x16x32_bf16 v[116:119], v[108:111], a[28:31], v[116:119]
    v_perm_b32 v96, v52, v52, v8
    v_perm_b32 v97, v52, v52, v10
    v_perm_b32 v98, v52, v52, v12
    v_perm_b32 v99, v52, v52, v14
    s_nop 1
    v_mfma_f32_16x16x32_bf16 v[112:115], v[96:99], a[32:35], v[112:115]
    v_perm_b32 v100, v64, v64, v8
    v_perm_b32 v101, v64, v64, v10
    v_perm_b32 v102, v64, v64, v12
    v_perm_b32 v103, v64, v64, v14
    s_nop 1
    v_mfma_f32_16x16x32_bf16 v[116:119], v[100:103], a[32:35], v[116:119]
    s_waitcnt vmcnt(8)
    v_perm_b32 v104, v52, v52, v9
    v_perm_b32 v105, v52, v52, v11
    v_perm_b32 v106, v52, v52, v13
    v_perm_b32 v107, v52, v52, v15
    s_nop 1
    v_mfma_f32_16x16x32_bf16 v[112:115], v[104:107], a[36:39], v[112:115]
    v_perm_b32 v108, v64, v64, v9
    v_perm_b32 v109, v64, v64, v11
    v_perm_b32 v110, v64, v64, v13
    v_perm_b32 v111, v64, v64, v15
    s_nop 1
    v_mfma_f32_16x16x32_bf16 v[116:119], v[108:111], a[36:39], v[116:119]
    v_perm_b32 v96, v53, v53, v8
    v_perm_b32 v97, v53, v53, v10
    v_perm_b32 v98, v53, v53, v12
    v_perm_b32 v99, v53, v53, v14
    s_nop 1
    v_mfma_f32_16x16x32_bf16 v[112:115], v[96:99], a[40:43], v[112:115]
    v_perm_b32 v100, v65, v65, v8
    v_perm_b32 v101, v65, v65, v10
    v_perm_b32 v102, v65, v65, v12
    v_perm_b32 v103, v65, v65, v14
    s_nop 1
    v_mfma_f32_16x16x32_bf16 v[116:119], v[100:103], a[40:43], v[116:119]
    v_perm_b32 v104, v53, v53, v9
    v_perm_b32 v105, v53, v53, v11
    v_perm_b32 v106, v53, v53, v13
    v_perm_b32 v107, v53, v53, v15
    s_nop 1
    v_mfma_f32_16x16x32_bf16 v[112:115], v[104:107], a[44:47], v[112:115]
    v_perm_b32 v108, v65, v65, v9
    v_perm_b32 v109, v65, v65, v11
    v_perm_b32 v110, v65, v65, v13
    v_perm_b32 v111, v65, v65, v15
    s_nop 1
    v_mfma_f32_16x16x32_bf16 v[116:119], v[108:111], a[44:47], v[116:119]
    v_perm_b32 v96, v54, v54, v8
    v_perm_b32 v97, v54, v54, v10
    v_perm_b32 v98, v54, v54, v12
    v_perm_b32 v99, v54, v54, v14
    s_nop 1
    v_mfma_f32_16x16x32_bf16 v[112:115], v[96:99], a[48:51], v[112:115]
    v_perm_b32 v100, v66, v66, v8
    v_perm_b32 v101, v66, v66, v10
    v_perm_b32 v102, v66, v66, v12
    v_perm_b32 v103, v66, v66, v14
    s_nop 1
    v_mfma_f32_16x16x32_bf16 v[116:119], v[100:103], a[48:51], v[116:119]
    v_perm_b32 v104, v54, v54, v9
    v_perm_b32 v105, v54, v54, v11
    v_perm_b32 v106, v54, v54, v13
    v_perm_b32 v107, v54, v54, v15
    s_nop 1
    v_mfma_f32_16x16x32_bf16 v[112:115], v[104:107], a[52:55], v[112:115]
    v_perm_b32 v108, v66, v66, v9
    v_perm_b32 v109, v66, v66, v11
    v_perm_b32 v110, v66, v66, v13
    v_perm_b32 v111, v66, v66, v15
    s_nop 1
    v_mfma_f32_16x16x32_bf16 v[116:119], v[108:111], a[52:55], v[116:119]
    v_perm_b32 v96, v55, v55, v8
    v_perm_b32 v97, v55, v55, v10
    v_perm_b32 v98, v55, v55, v12
    v_perm_b32 v99, v55, v55, v14
    s_nop 1
    v_mfma_f32_16x16x32_bf16 v[112:115], v[96:99], a[56:59], v[112:115]
    v_perm_b32 v100, v67, v67, v8
    v_perm_b32 v101, v67, v67, v10
    v_perm_b32 v102, v67, v67, v12
    v_perm_b32 v103, v67, v67, v14
    s_nop 1
    v_mfma_f32_16x16x32_bf16 v[116:119], v[100:103], a[56:59], v[116:119]
    v_perm_b32 v104, v55, v55, v9
    v_perm_b32 v105, v55, v55, v11
    v_perm_b32 v106, v55, v55, v13
    v_perm_b32 v107, v55, v55, v15
    s_nop 1
    v_mfma_f32_16x16x32_bf16 v[112:115], v[104:107], a[60:63], v[112:115]
    v_perm_b32 v108, v67, v67, v9
    v_perm_b32 v109, v67, v67, v11
    v_perm_b32 v110, v67, v67, v13
    v_perm_b32 v111, v67, v67, v15
    s_nop 1
    v_mfma_f32_16x16x32_bf16 v[116:119], v[108:111], a[60:63], v[116:119]
    v_perm_b32 v96, v56, v56, v8
    v_perm_b32 v97, v56, v56, v10
    v_perm_b32 v98, v56, v56, v12
    v_perm_b32 v99, v56, v56, v14
    s_nop 1
    v_mfma_f32_16x16x32_bf16 v[112:115], v[96:99], a[64:67], v[112:115]
    v_perm_b32 v100, v68, v68, v8
    v_perm_b32 v101, v68, v68, v10
    v_perm_b32 v102, v68, v68, v12
    v_perm_b32 v103, v68, v68, v14
    s_nop 1
    v_mfma_f32_16x16x32_bf16 v[116:119], v[100:103], a[64:67], v[116:119]
    v_perm_b32 v104, v56, v56, v9
    v_perm_b32 v105, v56, v56, v11
    v_perm_b32 v106, v56, v56, v13
    v_perm_b32 v107, v56, v56, v15
    s_nop 1
    v_mfma_f32_16x16x32_bf16 v[112:115], v[104:107], a[68:71], v[112:115]
    v_perm_b32 v108, v68, v68, v9
    v_perm_b32 v109, v68, v68, v11
    v_perm_b32 v110, v68, v68, v13
    v_perm_b32 v111, v68, v68, v15
    s_nop 1
    v_mfma_f32_16x16x32_bf16 v[116:119], v[108:111], a[68:71], v[116:119]
    v_lshrrev_b32 v5, 1, v4
    v_lshlrev_b32 v5, 9, v5
    v_lshl_add_u32 v5, v3, 5, v5
    v_and_b32 v6, 1, v4
    v_lshl_add_u32 v5, v6, 4, v5
    s_lshl_b32 s54, s3, 11
    s_add_u32 s54, s54, 139264
    v_add_u32 v5, s54, v5
    ds_write_b128 v5, v[112:115]
    ds_write_b128 v5, v[116:119] offset:1024
    s_waitcnt lgkmcnt(0)
    s_barrier
    s_lshl_b32 s54, s3, 9
    s_add_u32 s54, s54, 139264
    v_add_u32 v5, s54, v2
    ds_read_b128 v[96:99], v5 offset:0
    ds_read_b128 v[100:103], v5 offset:2048
    ds_read_b128 v[104:107], v5 offset:4096
    ds_read_b128 v[108:111], v5 offset:6144
    s_waitcnt lgkmcnt(0)
    v_add_f32 v96, v96, v100
    v_add_f32 v104, v104, v108
    v_add_f32 v97, v97, v101
    v_add_f32 v105, v105, v109
    v_add_f32 v98, v98, v102
    v_add_f32 v106, v106, v110
    v_add_f32 v99, v99, v103
    v_add_f32 v107, v107, v111
    v_add_f32 v96, v96, v104
    v_add_f32 v97, v97, v105
    v_add_f32 v98, v98, v106
    v_add_f32 v99, v99, v107
    v_min_u32 v124, -2, v96
    v_min_u32 v125, -2, v97
    v_min_u32 v126, -2, v98
    v_min_u32 v127, -2, v99
    buffer_store_dwordx4 v[124:127], v123, s[44:47], s98 offen sc1
    s_add_u32 m0, s59, 0
    s_add_u32 s54, s58, 0
    buffer_load_dwordx4 v20, s[32:35], s54 offen nt lds
    s_add_u32 m0, s59, 1024
    s_add_u32 s54, s58, 0
    buffer_load_dwordx4 v21, s[32:35], s54 offen nt lds
    s_add_u32 m0, s59, 2048
    s_add_u32 s54, s58, 0
    buffer_load_dwordx4 v22, s[32:35], s54 offen nt lds
    s_add_u32 m0, s59, 3072
    s_add_u32 s54, s58, 0
    buffer_load_dwordx4 v23, s[32:35], s54 offen nt lds
    s_add_u32 m0, s59, 4096
    s_add_u32 s54, s58, 16384
    buffer_load_dwordx4 v20, s[32:35], s54 offen nt lds
    s_add_u32 m0, s59, 5120
    s_add_u32 s54, s58, 16384
    buffer_load_dwordx4 v21, s[32:35], s54 offen nt lds
    s_add_u32 m0, s59, 6144
    s_add_u32 s54, s58, 16384
    buffer_load_dwordx4 v22, s[32:35], s54 offen nt lds
    s_add_u32 m0, s59, 7168
    s_add_u32 s54, s58, 16384
    buffer_load_dwordx4 v23, s[32:35], s54 offen nt lds
    s_add_u32 s58, s58, 32768
    s_add_u32 s59, s59, 8192
    s_add_u32 m0, s59, 0
    s_add_u32 s54, s58, 0
    buffer_load_dwordx4 v20, s[32:35], s54 offen nt lds
    s_add_u32 m0, s59, 1024
    s_add_u32 s54, s58, 0
    buffer_load_dwordx4 v21, s[32:35], s54 offen nt lds
    s_add_u32 m0, s59, 2048
    s_add_u32 s54, s58, 0
    buffer_load_dwordx4 v22, s[32:35], s54 offen nt lds
    s_add_u32 m0, s59, 3072
    s_add_u32 s54, s58, 0
    buffer_load_dwordx4 v23, s[32:35], s54 offen nt lds
    s_add_u32 m0, s59, 4096
    s_add_u32 s54, s58, 16384
    buffer_load_dwordx4 v20, s[32:35], s54 offen nt lds
    s_add_u32 m0, s59, 5120
    s_add_u32 s54, s58, 16384
    buffer_load_dwordx4 v21, s[32:35], s54 offen nt lds
    s_add_u32 m0, s59, 6144
    s_add_u32 s54, s58, 16384
    buffer_load_dwordx4 v22, s[32:35], s54 offen nt lds
    s_add_u32 m0, s59, 7168
    s_add_u32 s54, s58, 16384
    buffer_load_dwordx4 v23, s[32:35], s54 offen nt lds
    s_add_u32 s58, s58, 32768
    s_add_u32 s59, s59, 8192
    s_add_u32 m0, s59, 0
    s_add_u32 s54, s58, 0
    buffer_load_dwordx4 v20, s[32:35], s54 offen nt lds
    s_add_u32 m0, s59, 1024
    s_add_u32 s54, s58, 0
    buffer_load_dwordx4 v21, s[32:35], s54 offen nt lds
    s_add_u32 m0, s59, 2048
    s_add_u32 s54, s58, 0
    buffer_load_dwordx4 v22, s[32:35], s54 offen nt lds
    s_add_u32 m0, s59, 3072
    s_add_u32 s54, s58, 0
    buffer_load_dwordx4 v23, s[32:35], s54 offen nt lds
    s_add_u32 m0, s59, 4096
    s_add_u32 s54, s58, 16384
    buffer_load_dwordx4 v20, s[32:35], s54 offen nt lds
    s_add_u32 m0, s59, 5120
    s_add_u32 s54, s58, 16384
    buffer_load_dwordx4 v21, s[32:35], s54 offen nt lds
    s_add_u32 m0, s59, 6144
    s_add_u32 s54, s58, 16384
    buffer_load_dwordx4 v22, s[32:35], s54 offen nt lds
    s_add_u32 m0, s59, 7168
    s_add_u32 s54, s58, 16384
    buffer_load_dwordx4 v23, s[32:35], s54 offen nt lds
    s_add_u32 s58, s58, 32768
    s_add_u32 s59, s59, 8192
    s_waitcnt vmcnt(40)
    buffer_load_dwordx4 a[96:99], v20, s[32:35], s58 offen nt
    buffer_load_dwordx4 a[100:103], v21, s[32:35], s58 offen nt
    buffer_load_dwordx4 a[104:107], v22, s[32:35], s58 offen nt
    buffer_load_dwordx4 a[108:111], v23, s[32:35], s58 offen nt
    s_add_u32 s58, s58, 16384
    buffer_load_dwordx4 a[112:115], v20, s[32:35], s58 offen nt
    buffer_load_dwordx4 a[116:119], v21, s[32:35], s58 offen nt
    buffer_load_dwordx4 a[120:123], v22, s[32:35], s58 offen nt
    buffer_load_dwordx4 a[124:127], v23, s[32:35], s58 offen nt
    s_add_u32 s58, s58, 16384
    s_waitcnt vmcnt(40)
    buffer_load_dwordx4 a[128:131], v20, s[32:35], s58 offen nt
    buffer_load_dwordx4 a[132:135], v21, s[32:35], s58 offen nt
    buffer_load_dwordx4 a[136:139], v22, s[32:35], s58 offen nt
    buffer_load_dwordx4 a[140:143], v23, s[32:35], s58 offen nt
    s_add_u32 s58, s58, 16384
    buffer_load_dwordx4 a[144:147], v20, s[32:35], s58 offen nt
    buffer_load_dwordx4 a[148:151], v21, s[32:35], s58 offen nt
    buffer_load_dwordx4 a[152:155], v22, s[32:35], s58 offen nt
    buffer_load_dwordx4 a[156:159], v23, s[32:35], s58 offen nt
    s_add_u32 s58, s58, 16384
    s_waitcnt vmcnt(40)
    buffer_load_dwordx4 a[160:163], v20, s[32:35], s58 offen nt
    buffer_load_dwordx4 a[164:167], v21, s[32:35], s58 offen nt
    buffer_load_dwordx4 a[168:171], v22, s[32:35], s58 offen nt
    buffer_load_dwordx4 a[172:175], v23, s[32:35], s58 offen nt
    s_add_u32 s58, s58, 16384
    buffer_load_dwordx4 a[176:179], v20, s[32:35], s58 offen nt
    buffer_load_dwordx4 a[180:183], v21, s[32:35], s58 offen nt
    buffer_load_dwordx4 a[184:187], v22, s[32:35], s58 offen nt
    buffer_load_dwordx4 a[188:191], v23, s[32:35], s58 offen nt
    s_add_u32 s58, s58, 16384
    s_waitcnt vmcnt(40)
    buffer_load_dwordx4 a[192:195], v20, s[32:35], s58 offen nt
    buffer_load_dwordx4 a[196:199], v21, s[32:35], s58 offen nt
    buffer_load_dwordx4 a[200:203], v22, s[32:35], s58 offen nt
    buffer_load_dwordx4 a[204:207], v23, s[32:35], s58 offen nt
    s_add_u32 s58, s58, 16384
    buffer_load_dwordx4 a[208:211], v20, s[32:35], s58 offen nt
    buffer_load_dwordx4 a[212:215], v21, s[32:35], s58 offen nt
    buffer_load_dwordx4 a[216:219], v22, s[32:35], s58 offen nt
    buffer_load_dwordx4 a[220:223], v23, s[32:35], s58 offen nt
    s_add_u32 s58, s58, 16384
    s_waitcnt vmcnt(40)
    v_and_b32 v27, 31, v1
    v_lshlrev_b32 v27, 2, v27
    global_load_dword v18, v27, s[28:29] sc1
    buffer_load_dwordx4 a[224:227], v20, s[32:35], s58 offen nt
    buffer_load_dwordx4 a[228:231], v21, s[32:35], s58 offen nt
    buffer_load_dwordx4 a[232:235], v22, s[32:35], s58 offen nt
    buffer_load_dwordx4 a[236:239], v23, s[32:35], s58 offen nt
    s_add_u32 s58, s58, 16384
    buffer_load_dwordx4 a[240:243], v20, s[32:35], s58 offen nt
    buffer_load_dwordx4 a[244:247], v21, s[32:35], s58 offen nt
    buffer_load_dwordx4 a[248:251], v22, s[32:35], s58 offen nt
    buffer_load_dwordx4 a[252:255], v23, s[32:35], s58 offen nt
    s_add_u32 s58, s58, 16384
    s_waitcnt vmcnt(40)
    buffer_load_dwordx4 v[224:227], v20, s[32:35], s58 offen nt
    buffer_load_dwordx4 v[228:231], v21, s[32:35], s58 offen nt
    buffer_load_dwordx4 v[232:235], v22, s[32:35], s58 offen nt
    buffer_load_dwordx4 v[236:239], v23, s[32:35], s58 offen nt
    s_add_u32 s58, s58, 16384
    buffer_load_dwordx4 v[240:243], v20, s[32:35], s58 offen nt
    buffer_load_dwordx4 v[244:247], v21, s[32:35], s58 offen nt
    buffer_load_dwordx4 v[248:251], v22, s[32:35], s58 offen nt
    buffer_load_dwordx4 v[252:255], v23, s[32:35], s58 offen nt
    s_add_u32 s58, s58, 16384
    s_mov_b32 s36, s12
    s_mov_b32 s37, s13
    s_mov_b32 s38, 4718592
    s_mov_b32 s39, 0x20000
    v_mul_u32_u24 v49, 9216, v4
    v_lshl_add_u32 v48, v3, 4, v49
    v_lshl_add_u32 v49, v3, 2, v49
    s_mul_i32 s100, s52, 147456
    s_lshl_b32 s54, s3, 8
    s_add_u32 s99, s100, s54
    s_and_b32 s54, s3, 1
    s_lshl_b32 s54, s54, 6
    s_add_u32 s100, s100, s54
    s_add_u32 s100, s100, 1024
    v_add_u32 v26, s63, v2
    v_and_b32 v24, 31, v1
    v_lshrrev_b32 v25, 5, v1
    v_lshlrev_b32 v19, 10, v24
    v_lshl_add_u32 v19, v25, 4, v19
    s_lshr_b32 s96, s53, 3
    s_lshl_b32 s96, s96, 15
    s_lshl_b32 s55, s3, 8
    s_add_u32 s96, s96, s55
    s_add_u32 s96, s96, 1048576
    v_and_b32 v5, 3, v24
    v_lshlrev_b32 v5, 2, v5
    v_bfe_u32 v6, v24, 2, 2
    v_or_b32 v5, v5, v6
    v_xor_b32 v5, v5, v25
    v_lshlrev_b32 v32, 8, v24
    v_lshl_add_u32 v32, v5, 4, v32
    v_add_u32 v32, s63, v32
    v_bfe_u32 v5, v1, 2, 2
    v_lshl_add_u32 v6, v25, 2, v5
    v_lshlrev_b32 v40, 8, v6
    v_and_b32 v6, 1, v1
    v_lshl_add_u32 v40, v6, 3, v40
    v_bfe_u32 v6, v1, 4, 1
    v_lshlrev_b32 v6, 1, v6
    v_bfe_u32 v7, v1, 1, 1
    v_or_b32 v6, v6, v7
    v_xor_b32 v6, v6, v25
    v_lshl_or_b32 v6, v5, 2, v6
    v_lshl_add_u32 v40, v6, 4, v40
    v_add_u32 v40, s63, v40
    v_xor_b32 v33, 32, v32
    v_xor_b32 v41, 32, v40
    v_xor_b32 v34, 64, v32
    v_xor_b32 v42, 64, v40
    v_xor_b32 v35, 96, v32
    v_xor_b32 v43, 96, v40
    v_xor_b32 v36, 128, v32
    v_xor_b32 v44, 128, v40
    v_xor_b32 v37, 160, v32
    v_xor_b32 v45, 160, v40
    v_xor_b32 v38, 192, v32
    v_xor_b32 v46, 192, v40
    v_xor_b32 v39, 224, v32
    v_xor_b32 v47, 224, v40
    s_lshl_b32 s54, s3, 12
    s_add_u32 s54, s54, 131072
    v_add_u32 v28, s54, v2
    v_xor_b32 v29, 4096, v28
    v_xor_b32 v30, 8192, v28
    v_xor_b32 v31, 12288, v28
    v_mov_b32 v64, 0
    v_mov_b32 v65, 0
    v_mov_b32 v66, 0
    v_mov_b32 v67, 0
    v_mov_b32 v68, 0
    v_mov_b32 v69, 0
    v_mov_b32 v70, 0
    v_mov_b32 v71, 0
    v_mov_b32 v72, 0
    v_mov_b32 v73, 0
    v_mov_b32 v74, 0
    v_mov_b32 v75, 0
    v_mov_b32 v76, 0
    v_mov_b32 v77, 0
    v_mov_b32 v78, 0
    v_mov_b32 v79, 0
    v_mov_b32 v80, 0
    v_mov_b32 v81, 0
    v_mov_b32 v82, 0
    v_mov_b32 v83, 0
    v_mov_b32 v84, 0
    v_mov_b32 v85, 0
    v_mov_b32 v86, 0
    v_mov_b32 v87, 0
    v_mov_b32 v88, 0
    v_mov_b32 v89, 0
    v_mov_b32 v90, 0
    v_mov_b32 v91, 0
    v_mov_b32 v92, 0
    v_mov_b32 v93, 0
    v_mov_b32 v94, 0
    v_mov_b32 v95, 0
    v_mov_b32 v96, 0
    v_mov_b32 v97, 0
    v_mov_b32 v98, 0
    v_mov_b32 v99, 0
    v_mov_b32 v100, 0
    v_mov_b32 v101, 0
    v_mov_b32 v102, 0
    v_mov_b32 v103, 0
    v_mov_b32 v104, 0
    v_mov_b32 v105, 0
    v_mov_b32 v106, 0
    v_mov_b32 v107, 0
    v_mov_b32 v108, 0
    v_mov_b32 v109, 0
    v_mov_b32 v110, 0
    v_mov_b32 v111, 0
    v_mov_b32 v112, 0
    v_mov_b32 v113, 0
    v_mov_b32 v114, 0
    v_mov_b32 v115, 0
    v_mov_b32 v116, 0
    v_mov_b32 v117, 0
    v_mov_b32 v118, 0
    v_mov_b32 v119, 0
    v_mov_b32 v120, 0
    v_mov_b32 v121, 0
    v_mov_b32 v122, 0
    v_mov_b32 v123, 0
    v_mov_b32 v124, 0
    v_mov_b32 v125, 0
    v_mov_b32 v126, 0
    v_mov_b32 v127, 0
    v_mov_b32 v216, 0xff800000
    v_mov_b32 v217, 0
    s_waitcnt vmcnt(0)
L_flags_16:
    v_cmp_gt_u32 vcc, 2, v18
    s_cbranch_vccz L_flagsok_17
    s_sleep 2
    global_load_dword v18, v27, s[28:29] sc1
    s_waitcnt vmcnt(0)
    s_sub_u32 s101, s101, 1
    s_cbranch_scc0 L_flags_16
    s_mov_b32 s101, 0
L_flagsok_17:
    s_barrier
    ds_read_b128 a[32:35], v32 offset:0
    ds_read_b128 a[36:39], v33 offset:0
    ds_read_b128 a[40:43], v34 offset:0
    ds_read_b128 a[44:47], v35 offset:0
    ds_read_b128 a[48:51], v36 offset:0
    ds_read_b128 a[52:55], v37 offset:0
    ds_read_b128 a[56:59], v38 offset:0
    ds_read_b128 a[60:63], v39 offset:0
L_qpoll_18:
    buffer_load_dwordx4 v[128:131], v19, s[44:47], s96 offen offset:0 sc1
    buffer_load_dwordx4 v[132:135], v19, s[44:47], s96 offen offset:32 sc1
    buffer_load_dwordx4 v[136:139], v19, s[44:47], s96 offen offset:64 sc1
    buffer_load_dwordx4 v[140:143], v19, s[44:47], s96 offen offset:96 sc1
    buffer_load_dwordx4 v[144:147], v19, s[44:47], s96 offen offset:128 sc1
    buffer_load_dwordx4 v[148:151], v19, s[44:47], s96 offen offset:160 sc1
    buffer_load_dwordx4 v[152:155], v19, s[44:47], s96 offen offset:192 sc1
    buffer_load_dwordx4 v[156:159], v19, s[44:47], s96 offen offset:224 sc1
    s_waitcnt vmcnt(0)
    v_max3_u32 v5, v128, v129, v130
    v_max3_u32 v6, v144, v145, v146
    v_max3_u32 v5, v5, v131, v132
    v_max3_u32 v6, v6, v147, v148
    v_max3_u32 v5, v5, v133, v134
    v_max3_u32 v6, v6, v149, v150
    v_max3_u32 v5, v5, v135, v136
    v_max3_u32 v6, v6, v151, v152
    v_max3_u32 v5, v5, v137, v138
    v_max3_u32 v6, v6, v153, v154
    v_max3_u32 v5, v5, v139, v140
    v_max3_u32 v6, v6, v155, v156
    v_max3_u32 v5, v5, v141, v142
    v_max3_u32 v6, v6, v157, v158
    v_max3_u32 v5, v5, v143, v159
    v_max_u32 v5, v5, v6
    v_cmp_eq_u32 vcc, -1, v5
    s_nop 0
    s_mov_b64 exec, vcc
    s_cbranch_execz L_qok_19
    s_sub_u32 s101, s101, 1
    s_cbranch_scc0 L_qpoll_18
    s_mov_b32 s101, 0
L_qok_19:
    s_mov_b64 exec, -1
    v_accvgpr_write_b32 a0, v128
    v_accvgpr_write_b32 a1, v129
    v_accvgpr_write_b32 a2, v130
    v_accvgpr_write_b32 a3, v131
    v_accvgpr_write_b32 a4, v132
    v_accvgpr_write_b32 a5, v133
    v_accvgpr_write_b32 a6, v134
    v_accvgpr_write_b32 a7, v135
    v_accvgpr_write_b32 a8, v136
    v_accvgpr_write_b32 a9, v137
    v_accvgpr_write_b32 a10, v138
    v_accvgpr_write_b32 a11, v139
    v_accvgpr_write_b32 a12, v140
    v_accvgpr_write_b32 a13, v141
    v_accvgpr_write_b32 a14, v142
    v_accvgpr_write_b32 a15, v143
    v_accvgpr_write_b32 a16, v144
    v_accvgpr_write_b32 a17, v145
    v_accvgpr_write_b32 a18, v146
    v_accvgpr_write_b32 a19, v147
    v_accvgpr_write_b32 a20, v148
    v_accvgpr_write_b32 a21, v149
    v_accvgpr_write_b32 a22, v150
    v_accvgpr_write_b32 a23, v151
    v_accvgpr_write_b32 a24, v152
    v_accvgpr_write_b32 a25, v153
    v_accvgpr_write_b32 a26, v154
    v_accvgpr_write_b32 a27, v155
    v_accvgpr_write_b32 a28, v156
    v_accvgpr_write_b32 a29, v157
    v_accvgpr_write_b32 a30, v158
    v_accvgpr_write_b32 a31, v159
    s_waitcnt lgkmcnt(0)
    v_mfma_f32_32x32x16_bf16 v[128:143], a[32:35], a[0:3], 0
    v_mfma_f32_32x32x16_bf16 v[128:143], a[36:39], a[4:7], v[128:143]
    v_mfma_f32_32x32x16_bf16 v[128:143], a[40:43], a[8:11], v[128:143]
    v_mfma_f32_32x32x16_bf16 v[128:143], a[44:47], a[12:15], v[128:143]
    v_mfma_f32_32x32x16_bf16 v[128:143], a[48:51], a[16:19], v[128:143]
    v_mfma_f32_32x32x16_bf16 v[128:143], a[52:55], a[20:23], v[128:143]
    v_mfma_f32_32x32x16_bf16 v[128:143], a[56:59], a[24:27], v[128:143]
    v_mfma_f32_32x32x16_bf16 v[128:143], a[60:63], a[28:31], v[128:143]
    s_nop 11
    ds_write_b128 v28, v[128:131] offset:0
    ds_write_b128 v28, v[132:135] offset:1024
    ds_write_b128 v28, v[136:139] offset:2048
    ds_write_b128 v28, v[140:143] offset:3072
    s_waitcnt lgkmcnt(0)
    s_barrier
    ds_read_b128 v[144:147], v29 offset:0
    ds_read_b128 v[148:151], v29 offset:1024
    ds_read_b128 v[152:155], v29 offset:2048
    ds_read_b128 v[156:159], v29 offset:3072
    ds_read_b128 v[160:163], v30 offset:0
    ds_read_b128 v[164:167], v30 offset:1024
    ds_read_b128 v[168:171], v30 offset:2048
    ds_read_b128 v[172:175], v30 offset:3072
    ds_read_b128 v[176:179], v31 offset:0
    ds_read_b128 v[180:183], v31 offset:1024
    ds_read_b128 v[184:187], v31 offset:2048
    ds_read_b128 v[188:191], v31 offset:3072
    ds_read_b128 a[32:35], v32 offset:8192
    ds_read_b128 a[36:39], v33 offset:8192
    ds_read_b128 a[40:43], v34 offset:8192
    ds_read_b128 a[44:47], v35 offset:8192
    ds_read_b128 a[48:51], v36 offset:8192
    ds_read_b128 a[52:55], v37 offset:8192
    ds_read_b128 a[56:59], v38 offset:8192
    ds_read_b128 a[60:63], v39 offset:8192
    s_waitcnt lgkmcnt(8)
    v_add_f32 v144, v144, v128
    v_add_f32 v145, v145, v129
    v_add_f32 v146, v146, v130
    v_add_f32 v147, v147, v131
    v_add_f32 v148, v148, v132
    v_add_f32 v149, v149, v133
    v_add_f32 v150, v150, v134
    v_add_f32 v151, v151, v135
    v_add_f32 v152, v152, v136
    v_add_f32 v153, v153, v137
    v_add_f32 v154, v154, v138
    v_add_f32 v155, v155, v139
    v_add_f32 v156, v156, v140
    v_add_f32 v157, v157, v141
    v_add_f32 v158, v158, v142
    v_add_f32 v159, v159, v143
    s_waitcnt lgkmcnt(0)
    v_mfma_f32_32x32x16_bf16 v[128:143], a[32:35], a[0:3], 0
    ds_read_b64_tr_b16 a[64:65], v40 offset:0
    ds_read_b64_tr_b16 a[66:67], v41 offset:2048
    v_add_f32 v160, v160, v176
    v_add_f32 v161, v161, v177
    v_add_f32 v162, v162, v178
    v_add_f32 v163, v163, v179
    v_add_f32 v164, v164, v180
    v_mfma_f32_32x32x16_bf16 v[128:143], a[36:39], a[4:7], v[128:143]
    ds_read_b64_tr_b16 a[72:73], v42 offset:0
    ds_read_b64_tr_b16 a[74:75], v43 offset:2048
    v_add_f32 v165, v165, v181
    v_add_f32 v166, v166, v182
    v_add_f32 v167, v167, v183
    v_add_f32 v168, v168, v184
    v_add_f32 v169, v169, v185
    v_mfma_f32_32x32x16_bf16 v[128:143], a[40:43], a[8:11], v[128:143]
    ds_read_b64_tr_b16 a[80:81], v44 offset:0
    ds_read_b64_tr_b16 a[82:83], v45 offset:2048
    v_add_f32 v170, v170, v186
    v_add_f32 v171, v171, v187
    v_add_f32 v172, v172, v188
    v_add_f32 v173, v173, v189
    v_add_f32 v174, v174, v190
    v_mfma_f32_32x32x16_bf16 v[128:143], a[44:47], a[12:15], v[128:143]
    ds_read_b64_tr_b16 a[88:89], v46 offset:0
    ds_read_b64_tr_b16 a[90:91], v47 offset:2048
    v_add_f32 v175, v175, v191
    v_add_f32 v144, v144, v160
    v_add_f32 v145, v145, v161
    v_add_f32 v146, v146, v162
    v_add_f32 v147, v147, v163
    v_mfma_f32_32x32x16_bf16 v[128:143], a[48:51], a[16:19], v[128:143]
    ds_read_b64_tr_b16 a[68:69], v40 offset:4096
    ds_read_b64_tr_b16 a[70:71], v41 offset:6144
    v_add_f32 v148, v148, v164
    v_add_f32 v149, v149, v165
    v_add_f32 v150, v150, v166
    v_add_f32 v151, v151, v167
    v_add_f32 v152, v152, v168
    v_mfma_f32_32x32x16_bf16 v[128:143], a[52:55], a[20:23], v[128:143]
    ds_read_b64_tr_b16 a[76:77], v42 offset:4096
    ds_read_b64_tr_b16 a[78:79], v43 offset:6144
    v_add_f32 v153, v153, v169
    v_add_f32 v154, v154, v170
    v_add_f32 v155, v155, v171
    v_add_f32 v156, v156, v172
    v_add_f32 v157, v157, v173
    v_mfma_f32_32x32x16_bf16 v[128:143], a[56:59], a[24:27], v[128:143]
    ds_read_b64_tr_b16 a[84:85], v44 offset:4096
    ds_read_b64_tr_b16 a[86:87], v45 offset:6144
    v_add_f32 v158, v158, v174
    v_add_f32 v159, v159, v175
    v_max3_f32 v218, v144, v145, v146
    v_max3_f32 v219, v147, v148, v149
    v_max3_f32 v220, v150, v151, v152
    v_mfma_f32_32x32x16_bf16 v[128:143], a[60:63], a[28:31], v[128:143]
    ds_read_b64_tr_b16 a[92:93], v46 offset:4096
    ds_read_b64_tr_b16 a[94:95], v47 offset:6144
    v_max3_f32 v221, v153, v154, v155
    v_max3_f32 v218, v218, v156, v157
    v_max3_f32 v219, v219, v158, v159
    v_max3_f32 v218, v218, v219, v220
    v_max_f32 v218, v218, v221
    v_mov_b32 v219, v218
    s_nop 1
    v_permlane32_swap_b32 v218, v219
    v_max3_f32 v218, v218, v219, v216
    v_sub_f32 v220, v216, v218
    v_mov_b32 v216, v218
    v_exp_f32 v220, v220
    v_sub_f32 v192, v144, v218
    v_sub_f32 v193, v145, v218
    v_sub_f32 v194, v146, v218
    v_sub_f32 v195, v147, v218
    v_sub_f32 v196, v148, v218
    v_sub_f32 v197, v149, v218
    v_sub_f32 v198, v150, v218
    v_sub_f32 v199, v151, v218
    v_sub_f32 v200, v152, v218
    v_sub_f32 v201, v153, v218
    v_sub_f32 v202, v154, v218
    v_sub_f32 v203, v155, v218
    v_sub_f32 v204, v156, v218
    v_sub_f32 v205, v157, v218
    v_sub_f32 v206, v158, v218
    v_sub_f32 v207, v159, v218
    ds_write_b128 v28, v[128:131] offset:16384
    v_exp_f32 v192, v192
    v_exp_f32 v193, v193
    v_exp_f32 v194, v194
    v_exp_f32 v195, v195
    ds_write_b128 v28, v[132:135] offset:17408
    v_exp_f32 v196, v196
    v_exp_f32 v197, v197
    v_exp_f32 v198, v198
    v_exp_f32 v199, v199
    ds_write_b128 v28, v[136:139] offset:18432
    v_exp_f32 v200, v200
    v_exp_f32 v201, v201
    v_exp_f32 v202, v202
    v_exp_f32 v203, v203
    ds_write_b128 v28, v[140:143] offset:19456
    v_exp_f32 v204, v204
    v_exp_f32 v205, v205
    v_exp_f32 v206, v206
    v_exp_f32 v207, v207
    v_mul_f32 v217, v217, v220
    v_cvt_pk_bf16_f32 v208, v192, v193
    v_cvt_pk_bf16_f32 v209, v194, v195
    v_cvt_pk_bf16_f32 v210, v196, v197
    v_cvt_pk_bf16_f32 v211, v198, v199
    v_cvt_pk_bf16_f32 v212, v200, v201
    v_cvt_pk_bf16_f32 v213, v202, v203
    v_cvt_pk_bf16_f32 v214, v204, v205
    v_cvt_pk_bf16_f32 v215, v206, v207
    v_mul_f32 v64, v64, v220
    v_mul_f32 v65, v65, v220
    v_mul_f32 v66, v66, v220
    v_mul_f32 v67, v67, v220
    v_mul_f32 v68, v68, v220
    v_mul_f32 v69, v69, v220
    v_mul_f32 v70, v70, v220
    v_mul_f32 v71, v71, v220
    v_mul_f32 v72, v72, v220
    v_mul_f32 v73, v73, v220
    v_mul_f32 v74, v74, v220
    v_mul_f32 v75, v75, v220
    v_mul_f32 v76, v76, v220
    v_mul_f32 v77, v77, v220
    v_mul_f32 v78, v78, v220
    v_mul_f32 v79, v79, v220
    s_waitcnt lgkmcnt(0)
    s_barrier
    v_mfma_f32_32x32x16_bf16 v[64:79], a[64:67], v[208:211], v[64:79]
    ds_read_b128 v[144:147], v29 offset:16384
    v_mul_f32 v80, v80, v220
    v_mul_f32 v81, v81, v220
    ds_read_b128 v[148:151], v29 offset:17408
    ds_write_b128 v26, a[96:99] offset:0
    buffer_load_dwordx4 a[96:99], v20, s[32:35], s58 offen nt
    v_mul_f32 v82, v82, v220
    v_mul_f32 v83, v83, v220
    ds_read_b128 v[152:155], v29 offset:18432
    v_mul_f32 v84, v84, v220
    v_mfma_f32_32x32x16_bf16 v[64:79], a[68:71], v[212:215], v[64:79]
    v_mul_f32 v85, v85, v220
    ds_read_b128 v[156:159], v29 offset:19456
    v_mul_f32 v86, v86, v220
    ds_write_b128 v26, a[100:103] offset:1024
    buffer_load_dwordx4 a[100:103], v21, s[32:35], s58 offen nt
    v_mul_f32 v87, v87, v220
    v_mul_f32 v88, v88, v220
    v_mul_f32 v89, v89, v220
    v_mul_f32 v90, v90, v220
    v_mul_f32 v91, v91, v220
    v_mul_f32 v92, v92, v220
    v_mul_f32 v93, v93, v220
    v_mul_f32 v94, v94, v220
    v_mul_f32 v95, v95, v220
    s_nop 1
    v_mfma_f32_32x32x16_bf16 v[80:95], a[72:75], v[208:211], v[80:95]
    ds_read_b128 v[160:163], v30 offset:16384
    v_mul_f32 v96, v96, v220
    v_mul_f32 v97, v97, v220
    ds_read_b128 v[164:167], v30 offset:17408
    ds_write_b128 v26, a[104:107] offset:2048
    buffer_load_dwordx4 a[104:107], v22, s[32:35], s58 offen nt
    v_mul_f32 v98, v98, v220
    v_mul_f32 v99, v99, v220
    ds_read_b128 v[168:171], v30 offset:18432
    v_mul_f32 v100, v100, v220
    v_mfma_f32_32x32x16_bf16 v[80:95], a[76:79], v[212:215], v[80:95]
    v_mul_f32 v101, v101, v220
    ds_read_b128 v[172:175], v30 offset:19456
    v_mul_f32 v102, v102, v220
    ds_write_b128 v26, a[108:111] offset:3072
    buffer_load_dwordx4 a[108:111], v23, s[32:35], s58 offen nt
    s_add_u32 s58, s58, 16384
    v_mul_f32 v103, v103, v220
    v_mul_f32 v104, v104, v220
    v_mul_f32 v105, v105, v220
    v_mul_f32 v106, v106, v220
    v_mul_f32 v107, v107, v220
    v_mul_f32 v108, v108, v220
    v_mul_f32 v109, v109, v220
    v_mul_f32 v110, v110, v220
    v_mul_f32 v111, v111, v220
    s_nop 1
    v_mfma_f32_32x32x16_bf16 v[96:111], a[80:83], v[208:211], v[96:111]
    ds_read_b128 v[176:179], v31 offset:16384
    v_mul_f32 v112, v112, v220
    v_mul_f32 v113, v113, v220
    ds_read_b128 v[180:183], v31 offset:17408
    ds_write_b128 v26, a[112:115] offset:4096
    buffer_load_dwordx4 a[112:115], v20, s[32:35], s58 offen nt
    v_mul_f32 v114, v114, v220
    v_mul_f32 v115, v115, v220
    ds_read_b128 v[184:187], v31 offset:18432
    v_mul_f32 v116, v116, v220
    v_mfma_f32_32x32x16_bf16 v[96:111], a[84:87], v[212:215], v[96:111]
    v_mul_f32 v117, v117, v220
    ds_read_b128 v[188:191], v31 offset:19456
    v_mul_f32 v118, v118, v220
    ds_write_b128 v26, a[116:119] offset:5120
    buffer_load_dwordx4 a[116:119], v21, s[32:35], s58 offen nt
    v_mul_f32 v119, v119, v220
    v_mul_f32 v120, v120, v220
    v_mul_f32 v121, v121, v220
    v_mul_f32 v122, v122, v220
    v_mul_f32 v123, v123, v220
    v_mul_f32 v124, v124, v220
    v_mul_f32 v125, v125, v220
    v_mul_f32 v126, v126, v220
    v_mul_f32 v127, v127, v220
    s_nop 1
    v_mfma_f32_32x32x16_bf16 v[112:127], a[88:91], v[208:211], v[112:127]
    v_add_f32 v192, v192, v200
    v_add_f32 v193, v193, v201
    v_add_f32 v194, v194, v202
    v_add_f32 v195, v195, v203
    ds_write_b128 v26, a[120:123] offset:6144
    buffer_load_dwordx4 a[120:123], v22, s[32:35], s58 offen nt
    v_add_f32 v196, v196, v204
    v_add_f32 v197, v197, v205
    v_add_f32 v198, v198, v206
    v_add_f32 v199, v199, v207
    v_mfma_f32_32x32x16_bf16 v[112:127], a[92:95], v[212:215], v[112:127]
    v_add_f32 v192, v192, v196
    v_add_f32 v193, v193, v197
    v_add_f32 v194, v194, v198
    ds_write_b128 v26, a[124:127] offset:7168
    buffer_load_dwordx4 a[124:127], v23, s[32:35], s58 offen nt
    s_add_u32 s58, s58, 16384
    v_add_f32 v195, v195, v199
    v_add_f32 v192, v192, v193
    v_add_f32 v194, v194, v195
    v_add_f32 v192, v192, v194
    v_add_f32 v217, v217, v192
    ds_read_b128 a[32:35], v32 offset:16384
    ds_read_b128 a[36:39], v33 offset:16384
    ds_read_b128 a[40:43], v34 offset:16384
    ds_read_b128 a[44:47], v35 offset:16384
    ds_read_b128 a[48:51], v36 offset:16384
    ds_read_b128 a[52:55], v37 offset:16384
    ds_read_b128 a[56:59], v38 offset:16384
    ds_read_b128 a[60:63], v39 offset:16384
    s_waitcnt lgkmcnt(8)
    v_add_f32 v144, v144, v128
    v_add_f32 v145, v145, v129
    v_add_f32 v146, v146, v130
    v_add_f32 v147, v147, v131
    v_add_f32 v148, v148, v132
    v_add_f32 v149, v149, v133
    v_add_f32 v150, v150, v134
    v_add_f32 v151, v151, v135
    v_add_f32 v152, v152, v136
    v_add_f32 v153, v153, v137
    v_add_f32 v154, v154, v138
    v_add_f32 v155, v155, v139
    v_add_f32 v156, v156, v140
    v_add_f32 v157, v157, v141
    v_add_f32 v158, v158, v142
    v_add_f32 v159, v159, v143
    s_waitcnt lgkmcnt(0)
    v_mfma_f32_32x32x16_bf16 v[128:143], a[32:35], a[0:3], 0
    ds_read_b64_tr_b16 a[64:65], v40 offset:8192
    ds_read_b64_tr_b16 a[66:67], v41 offset:10240
    v_add_f32 v160, v160, v176
    v_add_f32 v161, v161, v177
    v_add_f32 v162, v162, v178
    v_add_f32 v163, v163, v179
    v_add_f32 v164, v164, v180
    v_mfma_f32_32x32x16_bf16 v[128:143], a[36:39], a[4:7], v[128:143]
    ds_read_b64_tr_b16 a[72:73], v42 offset:8192
    ds_read_b64_tr_b16 a[74:75], v43 offset:10240
    v_add_f32 v165, v165, v181
    v_add_f32 v166, v166, v182
    v_add_f32 v167, v167, v183
    v_add_f32 v168, v168, v184
    v_add_f32 v169, v169, v185
    v_mfma_f32_32x32x16_bf16 v[128:143], a[40:43], a[8:11], v[128:143]
    ds_read_b64_tr_b16 a[80:81], v44 offset:8192
    ds_read_b64_tr_b16 a[82:83], v45 offset:10240
    v_add_f32 v170, v170, v186
    v_add_f32 v171, v171, v187
    v_add_f32 v172, v172, v188
    v_add_f32 v173, v173, v189
    v_add_f32 v174, v174, v190
    v_mfma_f32_32x32x16_bf16 v[128:143], a[44:47], a[12:15], v[128:143]
    ds_read_b64_tr_b16 a[88:89], v46 offset:8192
    ds_read_b64_tr_b16 a[90:91], v47 offset:10240
    v_add_f32 v175, v175, v191
    v_add_f32 v144, v144, v160
    v_add_f32 v145, v145, v161
    v_add_f32 v146, v146, v162
    v_add_f32 v147, v147, v163
    v_mfma_f32_32x32x16_bf16 v[128:143], a[48:51], a[16:19], v[128:143]
    ds_read_b64_tr_b16 a[68:69], v40 offset:12288
    ds_read_b64_tr_b16 a[70:71], v41 offset:14336
    v_add_f32 v148, v148, v164
    v_add_f32 v149, v149, v165
    v_add_f32 v150, v150, v166
    v_add_f32 v151, v151, v167
    v_add_f32 v152, v152, v168
    v_mfma_f32_32x32x16_bf16 v[128:143], a[52:55], a[20:23], v[128:143]
    ds_read_b64_tr_b16 a[76:77], v42 offset:12288
    ds_read_b64_tr_b16 a[78:79], v43 offset:14336
    v_add_f32 v153, v153, v169
    v_add_f32 v154, v154, v170
    v_add_f32 v155, v155, v171
    v_add_f32 v156, v156, v172
    v_add_f32 v157, v157, v173
    v_mfma_f32_32x32x16_bf16 v[128:143], a[56:59], a[24:27], v[128:143]
    ds_read_b64_tr_b16 a[84:85], v44 offset:12288
    ds_read_b64_tr_b16 a[86:87], v45 offset:14336
    v_add_f32 v158, v158, v174
    v_add_f32 v159, v159, v175
    v_max3_f32 v218, v144, v145, v146
    v_max3_f32 v219, v147, v148, v149
    v_max3_f32 v220, v150, v151, v152
    v_mfma_f32_32x32x16_bf16 v[128:143], a[60:63], a[28:31], v[128:143]
    ds_read_b64_tr_b16 a[92:93], v46 offset:12288
    ds_read_b64_tr_b16 a[94:95], v47 offset:14336
    v_max3_f32 v221, v153, v154, v155
    v_max3_f32 v218, v218, v156, v157
    v_max3_f32 v219, v219, v158, v159
    v_max3_f32 v218, v218, v219, v220
    v_max_f32 v218, v218, v221
    v_mov_b32 v219, v218
    s_nop 1
    v_permlane32_swap_b32 v218, v219
    v_max3_f32 v218, v218, v219, v216
    v_sub_f32 v220, v216, v218
    v_mov_b32 v216, v218
    v_exp_f32 v220, v220
    v_sub_f32 v192, v144, v218
    v_sub_f32 v193, v145, v218
    v_sub_f32 v194, v146, v218
    v_sub_f32 v195, v147, v218
    v_sub_f32 v196, v148, v218
    v_sub_f32 v197, v149, v218
    v_sub_f32 v198, v150, v218
    v_sub_f32 v199, v151, v218
    v_sub_f32 v200, v152, v218
    v_sub_f32 v201, v153, v218
    v_sub_f32 v202, v154, v218
    v_sub_f32 v203, v155, v218
    v_sub_f32 v204, v156, v218
    v_sub_f32 v205, v157, v218
    v_sub_f32 v206, v158, v218
    v_sub_f32 v207, v159, v218
    ds_write_b128 v28, v[128:131] offset:0
    v_exp_f32 v192, v192
    v_exp_f32 v193, v193
    v_exp_f32 v194, v194
    v_exp_f32 v195, v195
    ds_write_b128 v28, v[132:135] offset:1024
    v_exp_f32 v196, v196
    v_exp_f32 v197, v197
    v_exp_f32 v198, v198
    v_exp_f32 v199, v199
    ds_write_b128 v28, v[136:139] offset:2048
    v_exp_f32 v200, v200
    v_exp_f32 v201, v201
    v_exp_f32 v202, v202
    v_exp_f32 v203, v203
    ds_write_b128 v28, v[140:143] offset:3072
    v_exp_f32 v204, v204
    v_exp_f32 v205, v205
    v_exp_f32 v206, v206
    v_exp_f32 v207, v207
    v_mul_f32 v217, v217, v220
    v_cvt_pk_bf16_f32 v208, v192, v193
    v_cvt_pk_bf16_f32 v209, v194, v195
    v_cvt_pk_bf16_f32 v210, v196, v197
    v_cvt_pk_bf16_f32 v211, v198, v199
    v_cvt_pk_bf16_f32 v212, v200, v201
    v_cvt_pk_bf16_f32 v213, v202, v203
    v_cvt_pk_bf16_f32 v214, v204, v205
    v_cvt_pk_bf16_f32 v215, v206, v207
    v_mul_f32 v64, v64, v220
    v_mul_f32 v65, v65, v220
    v_mul_f32 v66, v66, v220
    v_mul_f32 v67, v67, v220
    v_mul_f32 v68, v68, v220
    v_mul_f32 v69, v69, v220
    v_mul_f32 v70, v70, v220
    v_mul_f32 v71, v71, v220
    v_mul_f32 v72, v72, v220
    v_mul_f32 v73, v73, v220
    v_mul_f32 v74, v74, v220
    v_mul_f32 v75, v75, v220
    v_mul_f32 v76, v76, v220
    v_mul_f32 v77, v77, v220
    v_mul_f32 v78, v78, v220
    v_mul_f32 v79, v79, v220
    s_waitcnt lgkmcnt(0)
    s_barrier
    v_mfma_f32_32x32x16_bf16 v[64:79], a[64:67], v[208:211], v[64:79]
    ds_read_b128 v[144:147], v29 offset:0
    v_mul_f32 v80, v80, v220
    v_mul_f32 v81, v81, v220
    ds_read_b128 v[148:151], v29 offset:1024
    ds_write_b128 v26, a[128:131] offset:8192
    buffer_load_dwordx4 a[128:131], v20, s[32:35], s58 offen nt
    v_mul_f32 v82, v82, v220
    v_mul_f32 v83, v83, v220
    ds_read_b128 v[152:155], v29 offset:2048
    v_mul_f32 v84, v84, v220
    v_mfma_f32_32x32x16_bf16 v[64:79], a[68:71], v[212:215], v[64:79]
    v_mul_f32 v85, v85, v220
    ds_read_b128 v[156:159], v29 offset:3072
    v_mul_f32 v86, v86, v220
    ds_write_b128 v26, a[132:135] offset:9216
    buffer_load_dwordx4 a[132:135], v21, s[32:35], s58 offen nt
    v_mul_f32 v87, v87, v220
    v_mul_f32 v88, v88, v220
    v_mul_f32 v89, v89, v220
    v_mul_f32 v90, v90, v220
    v_mul_f32 v91, v91, v220
    v_mul_f32 v92, v92, v220
    v_mul_f32 v93, v93, v220
    v_mul_f32 v94, v94, v220
    v_mul_f32 v95, v95, v220
    s_nop 1
    v_mfma_f32_32x32x16_bf16 v[80:95], a[72:75], v[208:211], v[80:95]
    ds_read_b128 v[160:163], v30 offset:0
    v_mul_f32 v96, v96, v220
    v_mul_f32 v97, v97, v220
    ds_read_b128 v[164:167], v30 offset:1024
    ds_write_b128 v26, a[136:139] offset:10240
    buffer_load_dwordx4 a[136:139], v22, s[32:35], s58 offen nt
    v_mul_f32 v98, v98, v220
    v_mul_f32 v99, v99, v220
    ds_read_b128 v[168:171], v30 offset:2048
    v_mul_f32 v100, v100, v220
    v_mfma_f32_32x32x16_bf16 v[80:95], a[76:79], v[212:215], v[80:95]
    v_mul_f32 v101, v101, v220
    ds_read_b128 v[172:175], v30 offset:3072
    v_mul_f32 v102, v102, v220
    ds_write_b128 v26, a[140:143] offset:11264
    buffer_load_dwordx4 a[140:143], v23, s[32:35], s58 offen nt
    s_add_u32 s58, s58, 16384
    v_mul_f32 v103, v103, v220
    v_mul_f32 v104, v104, v220
    v_mul_f32 v105, v105, v220
    v_mul_f32 v106, v106, v220
    v_mul_f32 v107, v107, v220
    v_mul_f32 v108, v108, v220
    v_mul_f32 v109, v109, v220
    v_mul_f32 v110, v110, v220
    v_mul_f32 v111, v111, v220
    s_nop 1
    v_mfma_f32_32x32x16_bf16 v[96:111], a[80:83], v[208:211], v[96:111]
    ds_read_b128 v[176:179], v31 offset:0
    v_mul_f32 v112, v112, v220
    v_mul_f32 v113, v113, v220
    ds_read_b128 v[180:183], v31 offset:1024
    ds_write_b128 v26, a[144:147] offset:12288
    buffer_load_dwordx4 a[144:147], v20, s[32:35], s58 offen nt
    v_mul_f32 v114, v114, v220
    v_mul_f32 v115, v115, v220
    ds_read_b128 v[184:187], v31 offset:2048
    v_mul_f32 v116, v116, v220
    v_mfma_f32_32x32x16_bf16 v[96:111], a[84:87], v[212:215], v[96:111]
    v_mul_f32 v117, v117, v220
    ds_read_b128 v[188:191], v31 offset:3072
    v_mul_f32 v118, v118, v220
    ds_write_b128 v26, a[148:151] offset:13312
    buffer_load_dwordx4 a[148:151], v21, s[32:35], s58 offen nt
    v_mul_f32 v119, v119, v220
    v_mul_f32 v120, v120, v220
    v_mul_f32 v121, v121, v220
    v_mul_f32 v122, v122, v220
    v_mul_f32 v123, v123, v220
    v_mul_f32 v124, v124, v220
    v_mul_f32 v125, v125, v220
    v_mul_f32 v126, v126, v220
    v_mul_f32 v127, v127, v220
    s_nop 1
    v_mfma_f32_32x32x16_bf16 v[112:127], a[88:91], v[208:211], v[112:127]
    v_add_f32 v192, v192, v200
    v_add_f32 v193, v193, v201
    v_add_f32 v194, v194, v202
    v_add_f32 v195, v195, v203
    ds_write_b128 v26, a[152:155] offset:14336
    buffer_load_dwordx4 a[152:155], v22, s[32:35], s58 offen nt
    v_add_f32 v196, v196, v204
    v_add_f32 v197, v197, v205
    v_add_f32 v198, v198, v206
    v_add_f32 v199, v199, v207
    v_mfma_f32_32x32x16_bf16 v[112:127], a[92:95], v[212:215], v[112:127]
    v_add_f32 v192, v192, v196
    v_add_f32 v193, v193, v197
    v_add_f32 v194, v194, v198
    ds_write_b128 v26, a[156:159] offset:15360
    buffer_load_dwordx4 a[156:159], v23, s[32:35], s58 offen nt
    s_add_u32 s58, s58, 16384
    v_add_f32 v195, v195, v199
    v_add_f32 v192, v192, v193
    v_add_f32 v194, v194, v195
    v_add_f32 v192, v192, v194
    v_add_f32 v217, v217, v192
    ds_read_b128 a[32:35], v32 offset:24576
    ds_read_b128 a[36:39], v33 offset:24576
    ds_read_b128 a[40:43], v34 offset:24576
    ds_read_b128 a[44:47], v35 offset:24576
    ds_read_b128 a[48:51], v36 offset:24576
    ds_read_b128 a[52:55], v37 offset:24576
    ds_read_b128 a[56:59], v38 offset:24576
    ds_read_b128 a[60:63], v39 offset:24576
    s_waitcnt lgkmcnt(8)
    v_add_f32 v144, v144, v128
    v_add_f32 v145, v145, v129
    v_add_f32 v146, v146, v130
    v_add_f32 v147, v147, v131
    v_add_f32 v148, v148, v132
    v_add_f32 v149, v149, v133
    v_add_f32 v150, v150, v134
    v_add_f32 v151, v151, v135
    v_add_f32 v152, v152, v136
    v_add_f32 v153, v153, v137
    v_add_f32 v154, v154, v138
    v_add_f32 v155, v155, v139
    v_add_f32 v156, v156, v140
    v_add_f32 v157, v157, v141
    v_add_f32 v158, v158, v142
    v_add_f32 v159, v159, v143
    s_waitcnt lgkmcnt(0)
    v_mfma_f32_32x32x16_bf16 v[128:143], a[32:35], a[0:3], 0
    ds_read_b64_tr_b16 a[64:65], v40 offset:16384
    ds_read_b64_tr_b16 a[66:67], v41 offset:18432
    v_add_f32 v160, v160, v176
    v_add_f32 v161, v161, v177
    v_add_f32 v162, v162, v178
    v_add_f32 v163, v163, v179
    v_add_f32 v164, v164, v180
    v_mfma_f32_32x32x16_bf16 v[128:143], a[36:39], a[4:7], v[128:143]
    ds_read_b64_tr_b16 a[72:73], v42 offset:16384
    ds_read_b64_tr_b16 a[74:75], v43 offset:18432
    v_add_f32 v165, v165, v181
    v_add_f32 v166, v166, v182
    v_add_f32 v167, v167, v183
    v_add_f32 v168, v168, v184
    v_add_f32 v169, v169, v185
    v_mfma_f32_32x32x16_bf16 v[128:143], a[40:43], a[8:11], v[128:143]
    ds_read_b64_tr_b16 a[80:81], v44 offset:16384
    ds_read_b64_tr_b16 a[82:83], v45 offset:18432
    v_add_f32 v170, v170, v186
    v_add_f32 v171, v171, v187
    v_add_f32 v172, v172, v188
    v_add_f32 v173, v173, v189
    v_add_f32 v174, v174, v190
    v_mfma_f32_32x32x16_bf16 v[128:143], a[44:47], a[12:15], v[128:143]
    ds_read_b64_tr_b16 a[88:89], v46 offset:16384
    ds_read_b64_tr_b16 a[90:91], v47 offset:18432
    v_add_f32 v175, v175, v191
    v_add_f32 v144, v144, v160
    v_add_f32 v145, v145, v161
    v_add_f32 v146, v146, v162
    v_add_f32 v147, v147, v163
    v_mfma_f32_32x32x16_bf16 v[128:143], a[48:51], a[16:19], v[128:143]
    ds_read_b64_tr_b16 a[68:69], v40 offset:20480
    ds_read_b64_tr_b16 a[70:71], v41 offset:22528
    v_add_f32 v148, v148, v164
    v_add_f32 v149, v149, v165
    v_add_f32 v150, v150, v166
    v_add_f32 v151, v151, v167
    v_add_f32 v152, v152, v168
    v_mfma_f32_32x32x16_bf16 v[128:143], a[52:55], a[20:23], v[128:143]
    ds_read_b64_tr_b16 a[76:77], v42 offset:20480
    ds_read_b64_tr_b16 a[78:79], v43 offset:22528
    v_add_f32 v153, v153, v169
    v_add_f32 v154, v154, v170
    v_add_f32 v155, v155, v171
    v_add_f32 v156, v156, v172
    v_add_f32 v157, v157, v173
    v_mfma_f32_32x32x16_bf16 v[128:143], a[56:59], a[24:27], v[128:143]
    ds_read_b64_tr_b16 a[84:85], v44 offset:20480
    ds_read_b64_tr_b16 a[86:87], v45 offset:22528
    v_add_f32 v158, v158, v174
    v_add_f32 v159, v159, v175
    v_max3_f32 v218, v144, v145, v146
    v_max3_f32 v219, v147, v148, v149
    v_max3_f32 v220, v150, v151, v152
    v_mfma_f32_32x32x16_bf16 v[128:143], a[60:63], a[28:31], v[128:143]
    ds_read_b64_tr_b16 a[92:93], v46 offset:20480
    ds_read_b64_tr_b16 a[94:95], v47 offset:22528
    v_max3_f32 v221, v153, v154, v155
    v_max3_f32 v218, v218, v156, v157
    v_max3_f32 v219, v219, v158, v159
    v_max3_f32 v218, v218, v219, v220
    v_max_f32 v218, v218, v221
    v_mov_b32 v219, v218
    s_nop 1
    v_permlane32_swap_b32 v218, v219
    v_max3_f32 v218, v218, v219, v216
    v_sub_f32 v220, v216, v218
    v_mov_b32 v216, v218
    v_exp_f32 v220, v220
    v_sub_f32 v192, v144, v218
    v_sub_f32 v193, v145, v218
    v_sub_f32 v194, v146, v218
    v_sub_f32 v195, v147, v218
    v_sub_f32 v196, v148, v218
    v_sub_f32 v197, v149, v218
    v_sub_f32 v198, v150, v218
    v_sub_f32 v199, v151, v218
    v_sub_f32 v200, v152, v218
    v_sub_f32 v201, v153, v218
    v_sub_f32 v202, v154, v218
    v_sub_f32 v203, v155, v218
    v_sub_f32 v204, v156, v218
    v_sub_f32 v205, v157, v218
    v_sub_f32 v206, v158, v218
    v_sub_f32 v207, v159, v218
    ds_write_b128 v28, v[128:131] offset:16384
    v_exp_f32 v192, v192
    v_exp_f32 v193, v193
    v_exp_f32 v194, v194
    v_exp_f32 v195, v195
    ds_write_b128 v28, v[132:135] offset:17408
    v_exp_f32 v196, v196
    v_exp_f32 v197, v197
    v_exp_f32 v198, v198
    v_exp_f32 v199, v199
    ds_write_b128 v28, v[136:139] offset:18432
    v_exp_f32 v200, v200
    v_exp_f32 v201, v201
    v_exp_f32 v202, v202
    v_exp_f32 v203, v203
    ds_write_b128 v28, v[140:143] offset:19456
    v_exp_f32 v204, v204
    v_exp_f32 v205, v205
    v_exp_f32 v206, v206
    v_exp_f32 v207, v207
    v_mul_f32 v217, v217, v220
    v_cvt_pk_bf16_f32 v208, v192, v193
    v_cvt_pk_bf16_f32 v209, v194, v195
    v_cvt_pk_bf16_f32 v210, v196, v197
    v_cvt_pk_bf16_f32 v211, v198, v199
    v_cvt_pk_bf16_f32 v212, v200, v201
    v_cvt_pk_bf16_f32 v213, v202, v203
    v_cvt_pk_bf16_f32 v214, v204, v205
    v_cvt_pk_bf16_f32 v215, v206, v207
    v_mul_f32 v64, v64, v220
    v_mul_f32 v65, v65, v220
    v_mul_f32 v66, v66, v220
    v_mul_f32 v67, v67, v220
    v_mul_f32 v68, v68, v220
    v_mul_f32 v69, v69, v220
    v_mul_f32 v70, v70, v220
    v_mul_f32 v71, v71, v220
    v_mul_f32 v72, v72, v220
    v_mul_f32 v73, v73, v220
    v_mul_f32 v74, v74, v220
    v_mul_f32 v75, v75, v220
    v_mul_f32 v76, v76, v220
    v_mul_f32 v77, v77, v220
    v_mul_f32 v78, v78, v220
    v_mul_f32 v79, v79, v220
    s_waitcnt lgkmcnt(0)
    s_barrier
    v_mfma_f32_32x32x16_bf16 v[64:79], a[64:67], v[208:211], v[64:79]
    ds_read_b128 v[144:147], v29 offset:16384
    v_mul_f32 v80, v80, v220
    v_mul_f32 v81, v81, v220
    ds_read_b128 v[148:151], v29 offset:17408
    ds_write_b128 v26, a[160:163] offset:16384
    buffer_load_dwordx4 a[160:163], v20, s[32:35], s58 offen nt
    v_mul_f32 v82, v82, v220
    v_mul_f32 v83, v83, v220
    ds_read_b128 v[152:155], v29 offset:18432
    v_mul_f32 v84, v84, v220
    v_mfma_f32_32x32x16_bf16 v[64:79], a[68:71], v[212:215], v[64:79]
    v_mul_f32 v85, v85, v220
    ds_read_b128 v[156:159], v29 offset:19456
    v_mul_f32 v86, v86, v220
    ds_write_b128 v26, a[164:167] offset:17408
    buffer_load_dwordx4 a[164:167], v21, s[32:35], s58 offen nt
    v_mul_f32 v87, v87, v220
    v_mul_f32 v88, v88, v220
    v_mul_f32 v89, v89, v220
    v_mul_f32 v90, v90, v220
    v_mul_f32 v91, v91, v220
    v_mul_f32 v92, v92, v220
    v_mul_f32 v93, v93, v220
    v_mul_f32 v94, v94, v220
    v_mul_f32 v95, v95, v220
    s_nop 1
    v_mfma_f32_32x32x16_bf16 v[80:95], a[72:75], v[208:211], v[80:95]
    ds_read_b128 v[160:163], v30 offset:16384
    v_mul_f32 v96, v96, v220
    v_mul_f32 v97, v97, v220
    ds_read_b128 v[164:167], v30 offset:17408
    ds_write_b128 v26, a[168:171] offset:18432
    buffer_load_dwordx4 a[168:171], v22, s[32:35], s58 offen nt
    v_mul_f32 v98, v98, v220
    v_mul_f32 v99, v99, v220
    ds_read_b128 v[168:171], v30 offset:18432
    v_mul_f32 v100, v100, v220
    v_mfma_f32_32x32x16_bf16 v[80:95], a[76:79], v[212:215], v[80:95]
    v_mul_f32 v101, v101, v220
    ds_read_b128 v[172:175], v30 offset:19456
    v_mul_f32 v102, v102, v220
    ds_write_b128 v26, a[172:175] offset:19456
    v_mul_f32 v103, v103, v220
    v_mul_f32 v104, v104, v220
    v_mul_f32 v105, v105, v220
    v_mul_f32 v106, v106, v220
    v_mul_f32 v107, v107, v220
    v_mul_f32 v108, v108, v220
    v_mul_f32 v109, v109, v220
    v_mul_f32 v110, v110, v220
    v_mul_f32 v111, v111, v220
    s_nop 1
    v_mfma_f32_32x32x16_bf16 v[96:111], a[80:83], v[208:211], v[96:111]
    ds_read_b128 v[176:179], v31 offset:16384
    v_mul_f32 v112, v112, v220
    v_mul_f32 v113, v113, v220
    ds_read_b128 v[180:183], v31 offset:17408
    ds_write_b128 v26, a[176:179] offset:20480
    buffer_load_dwordx4 a[172:175], v23, s[32:35], s58 offen nt
    s_add_u32 s58, s58, 16384
    v_mul_f32 v114, v114, v220
    v_mul_f32 v115, v115, v220
    ds_read_b128 v[184:187], v31 offset:18432
    v_mul_f32 v116, v116, v220
    v_mfma_f32_32x32x16_bf16 v[96:111], a[84:87], v[212:215], v[96:111]
    v_mul_f32 v117, v117, v220
    ds_read_b128 v[188:191], v31 offset:19456
    v_mul_f32 v118, v118, v220
    ds_write_b128 v26, a[180:183] offset:21504
    buffer_load_dwordx4 a[176:179], v20, s[32:35], s58 offen nt
    v_mul_f32 v119, v119, v220
    v_mul_f32 v120, v120, v220
    v_mul_f32 v121, v121, v220
    v_mul_f32 v122, v122, v220
    v_mul_f32 v123, v123, v220
    v_mul_f32 v124, v124, v220
    v_mul_f32 v125, v125, v220
    v_mul_f32 v126, v126, v220
    v_mul_f32 v127, v127, v220
    s_nop 1
    v_mfma_f32_32x32x16_bf16 v[112:127], a[88:91], v[208:211], v[112:127]
    v_add_f32 v192, v192, v200
    v_add_f32 v193, v193, v201
    v_add_f32 v194, v194, v202
    v_add_f32 v195, v195, v203
    ds_write_b128 v26, a[184:187] offset:22528
    buffer_load_dwordx4 a[180:183], v21, s[32:35], s58 offen nt
    v_add_f32 v196, v196, v204
    v_add_f32 v197, v197, v205
    v_add_f32 v198, v198, v206
    v_add_f32 v199, v199, v207
    v_mfma_f32_32x32x16_bf16 v[112:127], a[92:95], v[212:215], v[112:127]
    v_add_f32 v192, v192, v196
    v_add_f32 v193, v193, v197
    v_add_f32 v194, v194, v198
    ds_write_b128 v26, a[188:191] offset:23552
    v_add_f32 v195, v195, v199
    v_add_f32 v192, v192, v193
    v_add_f32 v194, v194, v195
    v_add_f32 v192, v192, v194
    v_add_f32 v217, v217, v192
    ds_read_b128 a[32:35], v32 offset:0
    ds_read_b128 a[36:39], v33 offset:0
    ds_read_b128 a[40:43], v34 offset:0
    ds_read_b128 a[44:47], v35 offset:0
    ds_read_b128 a[48:51], v36 offset:0
    ds_read_b128 a[52:55], v37 offset:0
    ds_read_b128 a[56:59], v38 offset:0
    ds_read_b128 a[60:63], v39 offset:0
    s_waitcnt lgkmcnt(8)
    v_add_f32 v144, v144, v128
    v_add_f32 v145, v145, v129
    v_add_f32 v146, v146, v130
    v_add_f32 v147, v147, v131
    buffer_load_dwordx4 a[184:187], v22, s[32:35], s58 offen nt
    v_add_f32 v148, v148, v132
    v_add_f32 v149, v149, v133
    v_add_f32 v150, v150, v134
    v_add_f32 v151, v151, v135
    v_add_f32 v152, v152, v136
    v_add_f32 v153, v153, v137
    v_add_f32 v154, v154, v138
    v_add_f32 v155, v155, v139
    v_add_f32 v156, v156, v140
    v_add_f32 v157, v157, v141
    v_add_f32 v158, v158, v142
    v_add_f32 v159, v159, v143
    s_waitcnt lgkmcnt(0)
    v_mfma_f32_32x32x16_bf16 v[128:143], a[32:35], a[0:3], 0
    ds_read_b64_tr_b16 a[64:65], v40 offset:24576
    ds_read_b64_tr_b16 a[66:67], v41 offset:26624
    v_add_f32 v160, v160, v176
    v_add_f32 v161, v161, v177
    v_add_f32 v162, v162, v178
    v_add_f32 v163, v163, v179
    v_add_f32 v164, v164, v180
    v_mfma_f32_32x32x16_bf16 v[128:143], a[36:39], a[4:7], v[128:143]
    ds_read_b64_tr_b16 a[72:73], v42 offset:24576
    ds_read_b64_tr_b16 a[74:75], v43 offset:26624
    v_add_f32 v165, v165, v181
    v_add_f32 v166, v166, v182
    v_add_f32 v167, v167, v183
    v_add_f32 v168, v168, v184
    v_add_f32 v169, v169, v185
    v_mfma_f32_32x32x16_bf16 v[128:143], a[40:43], a[8:11], v[128:143]
    ds_read_b64_tr_b16 a[80:81], v44 offset:24576
    ds_read_b64_tr_b16 a[82:83], v45 offset:26624
    v_add_f32 v170, v170, v186
    v_add_f32 v171, v171, v187
    v_add_f32 v172, v172, v188
    v_add_f32 v173, v173, v189
    v_add_f32 v174, v174, v190
    v_mfma_f32_32x32x16_bf16 v[128:143], a[44:47], a[12:15], v[128:143]
    ds_read_b64_tr_b16 a[88:89], v46 offset:24576
    ds_read_b64_tr_b16 a[90:91], v47 offset:26624
    v_add_f32 v175, v175, v191
    v_add_f32 v144, v144, v160
    v_add_f32 v145, v145, v161
    v_add_f32 v146, v146, v162
    v_add_f32 v147, v147, v163
    v_mfma_f32_32x32x16_bf16 v[128:143], a[48:51], a[16:19], v[128:143]
    ds_read_b64_tr_b16 a[68:69], v40 offset:28672
    ds_read_b64_tr_b16 a[70:71], v41 offset:30720
    v_add_f32 v148, v148, v164
    v_add_f32 v149, v149, v165
    v_add_f32 v150, v150, v166
    v_add_f32 v151, v151, v167
    v_add_f32 v152, v152, v168
    v_mfma_f32_32x32x16_bf16 v[128:143], a[52:55], a[20:23], v[128:143]
    ds_read_b64_tr_b16 a[76:77], v42 offset:28672
    ds_read_b64_tr_b16 a[78:79], v43 offset:30720
    v_add_f32 v153, v153, v169
    v_add_f32 v154, v154, v170
    v_add_f32 v155, v155, v171
    v_add_f32 v156, v156, v172
    v_add_f32 v157, v157, v173
    v_mfma_f32_32x32x16_bf16 v[128:143], a[56:59], a[24:27], v[128:143]
    ds_read_b64_tr_b16 a[84:85], v44 offset:28672
    ds_read_b64_tr_b16 a[86:87], v45 offset:30720
    v_add_f32 v158, v158, v174
    v_add_f32 v159, v159, v175
    v_max3_f32 v218, v144, v145, v146
    v_max3_f32 v219, v147, v148, v149
    v_max3_f32 v220, v150, v151, v152
    v_mfma_f32_32x32x16_bf16 v[128:143], a[60:63], a[28:31], v[128:143]
    ds_read_b64_tr_b16 a[92:93], v46 offset:28672
    ds_read_b64_tr_b16 a[94:95], v47 offset:30720
    v_max3_f32 v221, v153, v154, v155
    v_max3_f32 v218, v218, v156, v157
    v_max3_f32 v219, v219, v158, v159
    v_max3_f32 v218, v218, v219, v220
    v_max_f32 v218, v218, v221
    v_mov_b32 v219, v218
    s_nop 1
    v_permlane32_swap_b32 v218, v219
    v_max3_f32 v218, v218, v219, v216
    v_sub_f32 v220, v216, v218
    v_mov_b32 v216, v218
    v_exp_f32 v220, v220
    v_sub_f32 v192, v144, v218
    v_sub_f32 v193, v145, v218
    buffer_load_dwordx4 a[188:191], v23, s[32:35], s58 offen nt
    s_add_u32 s58, s58, 16384
    v_sub_f32 v194, v146, v218
    v_sub_f32 v195, v147, v218
    v_sub_f32 v196, v148, v218
    v_sub_f32 v197, v149, v218
    v_sub_f32 v198, v150, v218
    v_sub_f32 v199, v151, v218
    v_sub_f32 v200, v152, v218
    v_sub_f32 v201, v153, v218
    v_sub_f32 v202, v154, v218
    v_sub_f32 v203, v155, v218
    v_sub_f32 v204, v156, v218
    v_sub_f32 v205, v157, v218
    v_sub_f32 v206, v158, v218
    v_sub_f32 v207, v159, v218
    ds_write_b128 v28, v[128:131] offset:0
    v_exp_f32 v192, v192
    v_exp_f32 v193, v193
    v_exp_f32 v194, v194
    v_exp_f32 v195, v195
    ds_write_b128 v28, v[132:135] offset:1024
    v_exp_f32 v196, v196
    v_exp_f32 v197, v197
    v_exp_f32 v198, v198
    v_exp_f32 v199, v199
    ds_write_b128 v28, v[136:139] offset:2048
    v_exp_f32 v200, v200
    v_exp_f32 v201, v201
    v_exp_f32 v202, v202
    v_exp_f32 v203, v203
    ds_write_b128 v28, v[140:143] offset:3072
    v_exp_f32 v204, v204
    v_exp_f32 v205, v205
    v_exp_f32 v206, v206
    v_exp_f32 v207, v207
    v_mul_f32 v217, v217, v220
    v_cvt_pk_bf16_f32 v208, v192, v193
    v_cvt_pk_bf16_f32 v209, v194, v195
    v_cvt_pk_bf16_f32 v210, v196, v197
    v_cvt_pk_bf16_f32 v211, v198, v199
    v_cvt_pk_bf16_f32 v212, v200, v201
    v_cvt_pk_bf16_f32 v213, v202, v203
    v_cvt_pk_bf16_f32 v214, v204, v205
    v_cvt_pk_bf16_f32 v215, v206, v207
    v_mul_f32 v64, v64, v220
    v_mul_f32 v65, v65, v220
    v_mul_f32 v66, v66, v220
    v_mul_f32 v67, v67, v220
    v_mul_f32 v68, v68, v220
    v_mul_f32 v69, v69, v220
    v_mul_f32 v70, v70, v220
    v_mul_f32 v71, v71, v220
    v_mul_f32 v72, v72, v220
    v_mul_f32 v73, v73, v220
    v_mul_f32 v74, v74, v220
    v_mul_f32 v75, v75, v220
    v_mul_f32 v76, v76, v220
    v_mul_f32 v77, v77, v220
    v_mul_f32 v78, v78, v220
    v_mul_f32 v79, v79, v220
    s_waitcnt lgkmcnt(0)
    s_barrier
    v_mfma_f32_32x32x16_bf16 v[64:79], a[64:67], v[208:211], v[64:79]
    ds_read_b128 v[144:147], v29 offset:0
    v_mul_f32 v80, v80, v220
    v_mul_f32 v81, v81, v220
    ds_read_b128 v[148:151], v29 offset:1024
    ds_write_b128 v26, a[192:195] offset:24576
    buffer_load_dwordx4 a[192:195], v20, s[32:35], s58 offen nt
    v_mul_f32 v82, v82, v220
    v_mul_f32 v83, v83, v220
    ds_read_b128 v[152:155], v29 offset:2048
    v_mul_f32 v84, v84, v220
    v_mfma_f32_32x32x16_bf16 v[64:79], a[68:71], v[212:215], v[64:79]
    v_mul_f32 v85, v85, v220
    ds_read_b128 v[156:159], v29 offset:3072
    v_mul_f32 v86, v86, v220
    ds_write_b128 v26, a[196:199] offset:25600
    v_mul_f32 v87, v87, v220
    v_mul_f32 v88, v88, v220
    v_mul_f32 v89, v89, v220
    v_mul_f32 v90, v90, v220
    v_mul_f32 v91, v91, v220
    v_mul_f32 v92, v92, v220
    v_mul_f32 v93, v93, v220
    v_mul_f32 v94, v94, v220
    v_mul_f32 v95, v95, v220
    s_nop 1
    v_mfma_f32_32x32x16_bf16 v[80:95], a[72:75], v[208:211], v[80:95]
    ds_read_b128 v[160:163], v30 offset:0
    v_mul_f32 v96, v96, v220
    v_mul_f32 v97, v97, v220
    ds_read_b128 v[164:167], v30 offset:1024
    ds_write_b128 v26, a[200:203] offset:26624
    buffer_load_dwordx4 a[196:199], v21, s[32:35], s58 offen nt
    v_mul_f32 v98, v98, v220
    v_mul_f32 v99, v99, v220
    ds_read_b128 v[168:171], v30 offset:2048
    v_mul_f32 v100, v100, v220
    v_mfma_f32_32x32x16_bf16 v[80:95], a[76:79], v[212:215], v[80:95]
    v_mul_f32 v101, v101, v220
    ds_read_b128 v[172:175], v30 offset:3072
    v_mul_f32 v102, v102, v220
    ds_write_b128 v26, a[204:207] offset:27648
    v_mul_f32 v103, v103, v220
    v_mul_f32 v104, v104, v220
    v_mul_f32 v105, v105, v220
    v_mul_f32 v106, v106, v220
    v_mul_f32 v107, v107, v220
    v_mul_f32 v108, v108, v220
    v_mul_f32 v109, v109, v220
    v_mul_f32 v110, v110, v220
    v_mul_f32 v111, v111, v220
    s_nop 1
    v_mfma_f32_32x32x16_bf16 v[96:111], a[80:83], v[208:211], v[96:111]
    ds_read_b128 v[176:179], v31 offset:0
    v_mul_f32 v112, v112, v220
    v_mul_f32 v113, v113, v220
    ds_read_b128 v[180:183], v31 offset:1024
    ds_write_b128 v26, a[208:211] offset:28672
    buffer_load_dwordx4 a[200:203], v22, s[32:35], s58 offen nt
    v_mul_f32 v114, v114, v220
    v_mul_f32 v115, v115, v220
    ds_read_b128 v[184:187], v31 offset:2048
    v_mul_f32 v116, v116, v220
    v_mfma_f32_32x32x16_bf16 v[96:111], a[84:87], v[212:215], v[96:111]
    v_mul_f32 v117, v117, v220
    ds_read_b128 v[188:191], v31 offset:3072
    v_mul_f32 v118, v118, v220
    ds_write_b128 v26, a[212:215] offset:29696
    v_mul_f32 v119, v119, v220
    v_mul_f32 v120, v120, v220
    v_mul_f32 v121, v121, v220
    v_mul_f32 v122, v122, v220
    v_mul_f32 v123, v123, v220
    v_mul_f32 v124, v124, v220
    v_mul_f32 v125, v125, v220
    v_mul_f32 v126, v126, v220
    v_mul_f32 v127, v127, v220
    s_nop 1
    v_mfma_f32_32x32x16_bf16 v[112:127], a[88:91], v[208:211], v[112:127]
    v_add_f32 v192, v192, v200
    v_add_f32 v193, v193, v201
    v_add_f32 v194, v194, v202
    v_add_f32 v195, v195, v203
    ds_write_b128 v26, a[216:219] offset:30720
    buffer_load_dwordx4 a[204:207], v23, s[32:35], s58 offen nt
    s_add_u32 s58, s58, 16384
    v_add_f32 v196, v196, v204
    v_add_f32 v197, v197, v205
    v_add_f32 v198, v198, v206
    v_add_f32 v199, v199, v207
    v_mfma_f32_32x32x16_bf16 v[112:127], a[92:95], v[212:215], v[112:127]
    v_add_f32 v192, v192, v196
    v_add_f32 v193, v193, v197
    v_add_f32 v194, v194, v198
    ds_write_b128 v26, a[220:223] offset:31744
    v_add_f32 v195, v195, v199
    v_add_f32 v192, v192, v193
    v_add_f32 v194, v194, v195
    v_add_f32 v192, v192, v194
    v_add_f32 v217, v217, v192
    ds_read_b128 a[32:35], v32 offset:8192
    ds_read_b128 a[36:39], v33 offset:8192
    ds_read_b128 a[40:43], v34 offset:8192
    ds_read_b128 a[44:47], v35 offset:8192
    ds_read_b128 a[48:51], v36 offset:8192
    ds_read_b128 a[52:55], v37 offset:8192
    ds_read_b128 a[56:59], v38 offset:8192
    ds_read_b128 a[60:63], v39 offset:8192
    s_waitcnt lgkmcnt(8)
    v_add_f32 v144, v144, v128
    v_add_f32 v145, v145, v129
    v_add_f32 v146, v146, v130
    v_add_f32 v147, v147, v131
    buffer_load_dwordx4 a[208:211], v20, s[32:35], s58 offen nt
    v_add_f32 v148, v148, v132
    v_add_f32 v149, v149, v133
    v_add_f32 v150, v150, v134
    v_add_f32 v151, v151, v135
    v_add_f32 v152, v152, v136
    v_add_f32 v153, v153, v137
    v_add_f32 v154, v154, v138
    v_add_f32 v155, v155, v139
    v_add_f32 v156, v156, v140
    v_add_f32 v157, v157, v141
    v_add_f32 v158, v158, v142
    v_add_f32 v159, v159, v143
    s_waitcnt lgkmcnt(0)
    v_mfma_f32_32x32x16_bf16 v[128:143], a[32:35], a[0:3], 0
    ds_read_b64_tr_b16 a[64:65], v40 offset:0
    ds_read_b64_tr_b16 a[66:67], v41 offset:2048
    v_add_f32 v160, v160, v176
    v_add_f32 v161, v161, v177
    v_add_f32 v162, v162, v178
    v_add_f32 v163, v163, v179
    v_add_f32 v164, v164, v180
    v_mfma_f32_32x32x16_bf16 v[128:143], a[36:39], a[4:7], v[128:143]
    ds_read_b64_tr_b16 a[72:73], v42 offset:0
    ds_read_b64_tr_b16 a[74:75], v43 offset:2048
    v_add_f32 v165, v165, v181
    v_add_f32 v166, v166, v182
    v_add_f32 v167, v167, v183
    v_add_f32 v168, v168, v184
    v_add_f32 v169, v169, v185
    v_mfma_f32_32x32x16_bf16 v[128:143], a[40:43], a[8:11], v[128:143]
    ds_read_b64_tr_b16 a[80:81], v44 offset:0
    ds_read_b64_tr_b16 a[82:83], v45 offset:2048
    v_add_f32 v170, v170, v186
    v_add_f32 v171, v171, v187
    v_add_f32 v172, v172, v188
    v_add_f32 v173, v173, v189
    v_add_f32 v174, v174, v190
    v_mfma_f32_32x32x16_bf16 v[128:143], a[44:47], a[12:15], v[128:143]
    ds_read_b64_tr_b16 a[88:89], v46 offset:0
    ds_read_b64_tr_b16 a[90:91], v47 offset:2048
    v_add_f32 v175, v175, v191
    v_add_f32 v144, v144, v160
    v_add_f32 v145, v145, v161
    v_add_f32 v146, v146, v162
    v_add_f32 v147, v147, v163
    v_mfma_f32_32x32x16_bf16 v[128:143], a[48:51], a[16:19], v[128:143]
    ds_read_b64_tr_b16 a[68:69], v40 offset:4096
    ds_read_b64_tr_b16 a[70:71], v41 offset:6144
    v_add_f32 v148, v148, v164
    v_add_f32 v149, v149, v165
    v_add_f32 v150, v150, v166
    v_add_f32 v151, v151, v167
    v_add_f32 v152, v152, v168
    v_mfma_f32_32x32x16_bf16 v[128:143], a[52:55], a[20:23], v[128:143]
    ds_read_b64_tr_b16 a[76:77], v42 offset:4096
    ds_read_b64_tr_b16 a[78:79], v43 offset:6144
    v_add_f32 v153, v153, v169
    v_add_f32 v154, v154, v170
    v_add_f32 v155, v155, v171
    v_add_f32 v156, v156, v172
    v_add_f32 v157, v157, v173
    v_mfma_f32_32x32x16_bf16 v[128:143], a[56:59], a[24:27], v[128:143]
    ds_read_b64_tr_b16 a[84:85], v44 offset:4096
    ds_read_b64_tr_b16 a[86:87], v45 offset:6144
    v_add_f32 v158, v158, v174
    v_add_f32 v159, v159, v175
    v_max3_f32 v218, v144, v145, v146
    v_max3_f32 v219, v147, v148, v149
    v_max3_f32 v220, v150, v151, v152
    v_mfma_f32_32x32x16_bf16 v[128:143], a[60:63], a[28:31], v[128:143]
    ds_read_b64_tr_b16 a[92:93], v46 offset:4096
    ds_read_b64_tr_b16 a[94:95], v47 offset:6144
    v_max3_f32 v221, v153, v154, v155
    v_max3_f32 v218, v218, v156, v157
    v_max3_f32 v219, v219, v158, v159
    v_max3_f32 v218, v218, v219, v220
    v_max_f32 v218, v218, v221
    v_mov_b32 v219, v218
    s_nop 1
    v_permlane32_swap_b32 v218, v219
    v_max3_f32 v218, v218, v219, v216
    v_sub_f32 v220, v216, v218
    v_mov_b32 v216, v218
    v_exp_f32 v220, v220
    v_sub_f32 v192, v144, v218
    v_sub_f32 v193, v145, v218
    buffer_load_dwordx4 a[212:215], v21, s[32:35], s58 offen nt
    v_sub_f32 v194, v146, v218
    v_sub_f32 v195, v147, v218
    v_sub_f32 v196, v148, v218
    v_sub_f32 v197, v149, v218
    v_sub_f32 v198, v150, v218
    buffer_load_dwordx4 a[216:219], v22, s[32:35], s58 offen nt
    v_sub_f32 v199, v151, v218
    v_sub_f32 v200, v152, v218
    v_sub_f32 v201, v153, v218
    v_sub_f32 v202, v154, v218
    v_sub_f32 v203, v155, v218
    v_sub_f32 v204, v156, v218
    v_sub_f32 v205, v157, v218
    v_sub_f32 v206, v158, v218
    v_sub_f32 v207, v159, v218
    ds_write_b128 v28, v[128:131] offset:16384
    v_exp_f32 v192, v192
    v_exp_f32 v193, v193
    v_exp_f32 v194, v194
    v_exp_f32 v195, v195
    ds_write_b128 v28, v[132:135] offset:17408
    v_exp_f32 v196, v196
    v_exp_f32 v197, v197
    v_exp_f32 v198, v198
    v_exp_f32 v199, v199
    ds_write_b128 v28, v[136:139] offset:18432
    v_exp_f32 v200, v200
    v_exp_f32 v201, v201
    v_exp_f32 v202, v202
    v_exp_f32 v203, v203
    ds_write_b128 v28, v[140:143] offset:19456
    v_exp_f32 v204, v204
    v_exp_f32 v205, v205
    v_exp_f32 v206, v206
    v_exp_f32 v207, v207
    v_mul_f32 v217, v217, v220
    v_cvt_pk_bf16_f32 v208, v192, v193
    v_cvt_pk_bf16_f32 v209, v194, v195
    v_cvt_pk_bf16_f32 v210, v196, v197
    v_cvt_pk_bf16_f32 v211, v198, v199
    v_cvt_pk_bf16_f32 v212, v200, v201
    v_cvt_pk_bf16_f32 v213, v202, v203
    v_cvt_pk_bf16_f32 v214, v204, v205
    v_cvt_pk_bf16_f32 v215, v206, v207
    v_mul_f32 v64, v64, v220
    v_mul_f32 v65, v65, v220
    v_mul_f32 v66, v66, v220
    v_mul_f32 v67, v67, v220
    v_mul_f32 v68, v68, v220
    v_mul_f32 v69, v69, v220
    v_mul_f32 v70, v70, v220
    v_mul_f32 v71, v71, v220
    v_mul_f32 v72, v72, v220
    v_mul_f32 v73, v73, v220
    v_mul_f32 v74, v74, v220
    v_mul_f32 v75, v75, v220
    v_mul_f32 v76, v76, v220
    v_mul_f32 v77, v77, v220
    v_mul_f32 v78, v78, v220
    v_mul_f32 v79, v79, v220
    s_waitcnt lgkmcnt(0)
    s_barrier
    v_mfma_f32_32x32x16_bf16 v[64:79], a[64:67], v[208:211], v[64:79]
    ds_read_b128 v[144:147], v29 offset:16384
    v_mul_f32 v80, v80, v220
    v_mul_f32 v81, v81, v220
    ds_read_b128 v[148:151], v29 offset:17408
    ds_write_b128 v26, a[224:227] offset:0
    buffer_load_dwordx4 a[220:223], v23, s[32:35], s58 offen nt
    s_add_u32 s58, s58, 16384
    v_mul_f32 v82, v82, v220
    v_mul_f32 v83, v83, v220
    ds_read_b128 v[152:155], v29 offset:18432
    v_mul_f32 v84, v84, v220
    v_mfma_f32_32x32x16_bf16 v[64:79], a[68:71], v[212:215], v[64:79]
    v_mul_f32 v85, v85, v220
    ds_read_b128 v[156:159], v29 offset:19456
    v_mul_f32 v86, v86, v220
    ds_write_b128 v26, a[228:231] offset:1024
    v_mul_f32 v87, v87, v220
    v_mul_f32 v88, v88, v220
    v_mul_f32 v89, v89, v220
    v_mul_f32 v90, v90, v220
    v_mul_f32 v91, v91, v220
    v_mul_f32 v92, v92, v220
    v_mul_f32 v93, v93, v220
    v_mul_f32 v94, v94, v220
    v_mul_f32 v95, v95, v220
    s_nop 1
    v_mfma_f32_32x32x16_bf16 v[80:95], a[72:75], v[208:211], v[80:95]
    ds_read_b128 v[160:163], v30 offset:16384
    v_mul_f32 v96, v96, v220
    v_mul_f32 v97, v97, v220
    ds_read_b128 v[164:167], v30 offset:17408
    ds_write_b128 v26, a[232:235] offset:2048
    buffer_load_dwordx4 a[224:227], v20, s[32:35], s58 offen nt
    v_mul_f32 v98, v98, v220
    v_mul_f32 v99, v99, v220
    ds_read_b128 v[168:171], v30 offset:18432
    v_mul_f32 v100, v100, v220
    v_mfma_f32_32x32x16_bf16 v[80:95], a[76:79], v[212:215], v[80:95]
    v_mul_f32 v101, v101, v220
    ds_read_b128 v[172:175], v30 offset:19456
    v_mul_f32 v102, v102, v220
    ds_write_b128 v26, a[236:239] offset:3072
    v_mul_f32 v103, v103, v220
    v_mul_f32 v104, v104, v220
    v_mul_f32 v105, v105, v220
    v_mul_f32 v106, v106, v220
    v_mul_f32 v107, v107, v220
    v_mul_f32 v108, v108, v220
    v_mul_f32 v109, v109, v220
    v_mul_f32 v110, v110, v220
    v_mul_f32 v111, v111, v220
    s_nop 1
    v_mfma_f32_32x32x16_bf16 v[96:111], a[80:83], v[208:211], v[96:111]
    ds_read_b128 v[176:179], v31 offset:16384
    v_mul_f32 v112, v112, v220
    v_mul_f32 v113, v113, v220
    ds_read_b128 v[180:183], v31 offset:17408
    ds_write_b128 v26, a[240:243] offset:4096
    v_mul_f32 v114, v114, v220
    v_mul_f32 v115, v115, v220
    ds_read_b128 v[184:187], v31 offset:18432
    v_mul_f32 v116, v116, v220
    v_mfma_f32_32x32x16_bf16 v[96:111], a[84:87], v[212:215], v[96:111]
    v_mul_f32 v117, v117, v220
    ds_read_b128 v[188:191], v31 offset:19456
    v_mul_f32 v118, v118, v220
    ds_write_b128 v26, a[244:247] offset:5120
    buffer_load_dwordx4 a[228:231], v21, s[32:35], s58 offen nt
    v_mul_f32 v119, v119, v220
    v_mul_f32 v120, v120, v220
    v_mul_f32 v121, v121, v220
    v_mul_f32 v122, v122, v220
    v_mul_f32 v123, v123, v220
    v_mul_f32 v124, v124, v220
    v_mul_f32 v125, v125, v220
    v_mul_f32 v126, v126, v220
    v_mul_f32 v127, v127, v220
    s_nop 1
    v_mfma_f32_32x32x16_bf16 v[112:127], a[88:91], v[208:211], v[112:127]
    v_add_f32 v192, v192, v200
    v_add_f32 v193, v193, v201
    v_add_f32 v194, v194, v202
    v_add_f32 v195, v195, v203
    ds_write_b128 v26, a[248:251] offset:6144
    v_add_f32 v196, v196, v204
    v_add_f32 v197, v197, v205
    v_add_f32 v198, v198, v206
    v_add_f32 v199, v199, v207
    v_mfma_f32_32x32x16_bf16 v[112:127], a[92:95], v[212:215], v[112:127]
    v_add_f32 v192, v192, v196
    v_add_f32 v193, v193, v197
    v_add_f32 v194, v194, v198
    ds_write_b128 v26, a[252:255] offset:7168
    v_add_f32 v195, v195, v199
    v_add_f32 v192, v192, v193
    v_add_f32 v194, v194, v195
    v_add_f32 v192, v192, v194
    v_add_f32 v217, v217, v192
    ds_read_b128 a[32:35], v32 offset:16384
    ds_read_b128 a[36:39], v33 offset:16384
    ds_read_b128 a[40:43], v34 offset:16384
    ds_read_b128 a[44:47], v35 offset:16384
    ds_read_b128 a[48:51], v36 offset:16384
    ds_read_b128 a[52:55], v37 offset:16384
    ds_read_b128 a[56:59], v38 offset:16384
    ds_read_b128 a[60:63], v39 offset:16384
    s_waitcnt lgkmcnt(8)
    v_add_f32 v144, v144, v128
    v_add_f32 v145, v145, v129
    v_add_f32 v146, v146, v130
    v_add_f32 v147, v147, v131
    buffer_load_dwordx4 a[232:235], v22, s[32:35], s58 offen nt
    v_add_f32 v148, v148, v132
    v_add_f32 v149, v149, v133
    v_add_f32 v150, v150, v134
    v_add_f32 v151, v151, v135
    v_add_f32 v152, v152, v136
    v_add_f32 v153, v153, v137
    v_add_f32 v154, v154, v138
    v_add_f32 v155, v155, v139
    v_add_f32 v156, v156, v140
    v_add_f32 v157, v157, v141
    v_add_f32 v158, v158, v142
    v_add_f32 v159, v159, v143
    s_waitcnt lgkmcnt(0)
    v_mfma_f32_32x32x16_bf16 v[128:143], a[32:35], a[0:3], 0
    ds_read_b64_tr_b16 a[64:65], v40 offset:8192
    ds_read_b64_tr_b16 a[66:67], v41 offset:10240
    v_add_f32 v160, v160, v176
    v_add_f32 v161, v161, v177
    v_add_f32 v162, v162, v178
    v_add_f32 v163, v163, v179
    v_add_f32 v164, v164, v180
    v_mfma_f32_32x32x16_bf16 v[128:143], a[36:39], a[4:7], v[128:143]
    ds_read_b64_tr_b16 a[72:73], v42 offset:8192
    ds_read_b64_tr_b16 a[74:75], v43 offset:10240
    v_add_f32 v165, v165, v181
    v_add_f32 v166, v166, v182
    v_add_f32 v167, v167, v183
    v_add_f32 v168, v168, v184
    v_add_f32 v169, v169, v185
    v_mfma_f32_32x32x16_bf16 v[128:143], a[40:43], a[8:11], v[128:143]
    ds_read_b64_tr_b16 a[80:81], v44 offset:8192
    ds_read_b64_tr_b16 a[82:83], v45 offset:10240
    v_add_f32 v170, v170, v186
    v_add_f32 v171, v171, v187
    v_add_f32 v172, v172, v188
    v_add_f32 v173, v173, v189
    v_add_f32 v174, v174, v190
    v_mfma_f32_32x32x16_bf16 v[128:143], a[44:47], a[12:15], v[128:143]
    ds_read_b64_tr_b16 a[88:89], v46 offset:8192
    ds_read_b64_tr_b16 a[90:91], v47 offset:10240
    v_add_f32 v175, v175, v191
    v_add_f32 v144, v144, v160
    v_add_f32 v145, v145, v161
    v_add_f32 v146, v146, v162
    v_add_f32 v147, v147, v163
    v_mfma_f32_32x32x16_bf16 v[128:143], a[48:51], a[16:19], v[128:143]
    ds_read_b64_tr_b16 a[68:69], v40 offset:12288
    ds_read_b64_tr_b16 a[70:71], v41 offset:14336
    v_add_f32 v148, v148, v164
    v_add_f32 v149, v149, v165
    v_add_f32 v150, v150, v166
    v_add_f32 v151, v151, v167
    v_add_f32 v152, v152, v168
    v_mfma_f32_32x32x16_bf16 v[128:143], a[52:55], a[20:23], v[128:143]
    ds_read_b64_tr_b16 a[76:77], v42 offset:12288
    ds_read_b64_tr_b16 a[78:79], v43 offset:14336
    v_add_f32 v153, v153, v169
    v_add_f32 v154, v154, v170
    v_add_f32 v155, v155, v171
    v_add_f32 v156, v156, v172
    v_add_f32 v157, v157, v173
    v_mfma_f32_32x32x16_bf16 v[128:143], a[56:59], a[24:27], v[128:143]
    ds_read_b64_tr_b16 a[84:85], v44 offset:12288
    ds_read_b64_tr_b16 a[86:87], v45 offset:14336
    v_add_f32 v158, v158, v174
    v_add_f32 v159, v159, v175
    v_max3_f32 v218, v144, v145, v146
    v_max3_f32 v219, v147, v148, v149
    v_max3_f32 v220, v150, v151, v152
    v_mfma_f32_32x32x16_bf16 v[128:143], a[60:63], a[28:31], v[128:143]
    ds_read_b64_tr_b16 a[92:93], v46 offset:12288
    ds_read_b64_tr_b16 a[94:95], v47 offset:14336
    v_max3_f32 v221, v153, v154, v155
    v_max3_f32 v218, v218, v156, v157
    v_max3_f32 v219, v219, v158, v159
    v_max3_f32 v218, v218, v219, v220
    v_max_f32 v218, v218, v221
    v_mov_b32 v219, v218
    s_nop 1
    v_permlane32_swap_b32 v218, v219
    v_max3_f32 v218, v218, v219, v216
    v_sub_f32 v220, v216, v218
    v_mov_b32 v216, v218
    v_exp_f32 v220, v220
    v_sub_f32 v192, v144, v218
    v_sub_f32 v193, v145, v218
    buffer_load_dwordx4 a[236:239], v23, s[32:35], s58 offen nt
    s_add_u32 s58, s58, 16384
    v_sub_f32 v194, v146, v218
    v_sub_f32 v195, v147, v218
    v_sub_f32 v196, v148, v218
    v_sub_f32 v197, v149, v218
    v_sub_f32 v198, v150, v218
    buffer_load_dwordx4 a[240:243], v20, s[32:35], s58 offen nt
    v_sub_f32 v199, v151, v218
    v_sub_f32 v200, v152, v218
    v_sub_f32 v201, v153, v218
    v_sub_f32 v202, v154, v218
    v_sub_f32 v203, v155, v218
    v_sub_f32 v204, v156, v218
    v_sub_f32 v205, v157, v218
    v_sub_f32 v206, v158, v218
    v_sub_f32 v207, v159, v218
    ds_write_b128 v28, v[128:131] offset:0
    v_exp_f32 v192, v192
    v_exp_f32 v193, v193
    v_exp_f32 v194, v194
    v_exp_f32 v195, v195
    ds_write_b128 v28, v[132:135] offset:1024
    v_exp_f32 v196, v196
    v_exp_f32 v197, v197
    v_exp_f32 v198, v198
    v_exp_f32 v199, v199
    ds_write_b128 v28, v[136:139] offset:2048
    v_exp_f32 v200, v200
    v_exp_f32 v201, v201
    v_exp_f32 v202, v202
    v_exp_f32 v203, v203
    ds_write_b128 v28, v[140:143] offset:3072
    v_exp_f32 v204, v204
    v_exp_f32 v205, v205
    v_exp_f32 v206, v206
    v_exp_f32 v207, v207
    v_mul_f32 v217, v217, v220
    v_cvt_pk_bf16_f32 v208, v192, v193
    v_cvt_pk_bf16_f32 v209, v194, v195
    v_cvt_pk_bf16_f32 v210, v196, v197
    v_cvt_pk_bf16_f32 v211, v198, v199
    v_cvt_pk_bf16_f32 v212, v200, v201
    v_cvt_pk_bf16_f32 v213, v202, v203
    v_cvt_pk_bf16_f32 v214, v204, v205
    v_cvt_pk_bf16_f32 v215, v206, v207
    v_mul_f32 v64, v64, v220
    v_mul_f32 v65, v65, v220
    v_mul_f32 v66, v66, v220
    v_mul_f32 v67, v67, v220
    v_mul_f32 v68, v68, v220
    v_mul_f32 v69, v69, v220
    v_mul_f32 v70, v70, v220
    v_mul_f32 v71, v71, v220
    v_mul_f32 v72, v72, v220
    v_mul_f32 v73, v73, v220
    v_mul_f32 v74, v74, v220
    v_mul_f32 v75, v75, v220
    v_mul_f32 v76, v76, v220
    v_mul_f32 v77, v77, v220
    v_mul_f32 v78, v78, v220
    v_mul_f32 v79, v79, v220
    s_waitcnt lgkmcnt(0)
    s_barrier
    v_mfma_f32_32x32x16_bf16 v[64:79], a[64:67], v[208:211], v[64:79]
    ds_read_b128 v[144:147], v29 offset:0
    v_mul_f32 v80, v80, v220
    v_mul_f32 v81, v81, v220
    ds_read_b128 v[148:151], v29 offset:1024
    ds_write_b128 v26, v[224:227] offset:8192
    buffer_load_dwordx4 a[244:247], v21, s[32:35], s58 offen nt
    v_mul_f32 v82, v82, v220
    v_mul_f32 v83, v83, v220
    ds_read_b128 v[152:155], v29 offset:2048
    v_mul_f32 v84, v84, v220
    v_mfma_f32_32x32x16_bf16 v[64:79], a[68:71], v[212:215], v[64:79]
    v_mul_f32 v85, v85, v220
    ds_read_b128 v[156:159], v29 offset:3072
    v_mul_f32 v86, v86, v220
    ds_write_b128 v26, v[228:231] offset:9216
    v_mul_f32 v87, v87, v220
    v_mul_f32 v88, v88, v220
    v_mul_f32 v89, v89, v220
    v_mul_f32 v90, v90, v220
    v_mul_f32 v91, v91, v220
    v_mul_f32 v92, v92, v220
    v_mul_f32 v93, v93, v220
    v_mul_f32 v94, v94, v220
    v_mul_f32 v95, v95, v220
    s_nop 1
    v_mfma_f32_32x32x16_bf16 v[80:95], a[72:75], v[208:211], v[80:95]
    ds_read_b128 v[160:163], v30 offset:0
    v_mul_f32 v96, v96, v220
    v_mul_f32 v97, v97, v220
    ds_read_b128 v[164:167], v30 offset:1024
    ds_write_b128 v26, v[232:235] offset:10240
    buffer_load_dwordx4 a[248:251], v22, s[32:35], s58 offen nt
    v_mul_f32 v98, v98, v220
    v_mul_f32 v99, v99, v220
    ds_read_b128 v[168:171], v30 offset:2048
    v_mul_f32 v100, v100, v220
    v_mfma_f32_32x32x16_bf16 v[80:95], a[76:79], v[212:215], v[80:95]
    v_mul_f32 v101, v101, v220
    ds_read_b128 v[172:175], v30 offset:3072
    v_mul_f32 v102, v102, v220
    ds_write_b128 v26, v[236:239] offset:11264
    v_mul_f32 v103, v103, v220
    v_mul_f32 v104, v104, v220
    v_mul_f32 v105, v105, v220
    v_mul_f32 v106, v106, v220
    v_mul_f32 v107, v107, v220
    v_mul_f32 v108, v108, v220
    v_mul_f32 v109, v109, v220
    v_mul_f32 v110, v110, v220
    v_mul_f32 v111, v111, v220
    s_nop 1
    v_mfma_f32_32x32x16_bf16 v[96:111], a[80:83], v[208:211], v[96:111]
    ds_read_b128 v[176:179], v31 offset:0
    v_mul_f32 v112, v112, v220
    v_mul_f32 v113, v113, v220
    ds_read_b128 v[180:183], v31 offset:1024
    ds_write_b128 v26, v[240:243] offset:12288
    v_mul_f32 v114, v114, v220
    v_mul_f32 v115, v115, v220
    ds_read_b128 v[184:187], v31 offset:2048
    v_mul_f32 v116, v116, v220
    v_mfma_f32_32x32x16_bf16 v[96:111], a[84:87], v[212:215], v[96:111]
    v_mul_f32 v117, v117, v220
    ds_read_b128 v[188:191], v31 offset:3072
    v_mul_f32 v118, v118, v220
    ds_write_b128 v26, v[244:247] offset:13312
    buffer_load_dwordx4 a[252:255], v23, s[32:35], s58 offen nt
    s_add_u32 s58, s58, 16384
    v_mul_f32 v119, v119, v220
    v_mul_f32 v120, v120, v220
    v_mul_f32 v121, v121, v220
    v_mul_f32 v122, v122, v220
    v_mul_f32 v123, v123, v220
    v_mul_f32 v124, v124, v220
    v_mul_f32 v125, v125, v220
    v_mul_f32 v126, v126, v220
    v_mul_f32 v127, v127, v220
    s_nop 1
    v_mfma_f32_32x32x16_bf16 v[112:127], a[88:91], v[208:211], v[112:127]
    v_add_f32 v192, v192, v200
    v_add_f32 v193, v193, v201
    v_add_f32 v194, v194, v202
    v_add_f32 v195, v195, v203
    ds_write_b128 v26, v[248:251] offset:14336
    v_add_f32 v196, v196, v204
    v_add_f32 v197, v197, v205
    v_add_f32 v198, v198, v206
    v_add_f32 v199, v199, v207
    v_mfma_f32_32x32x16_bf16 v[112:127], a[92:95], v[212:215], v[112:127]
    v_add_f32 v192, v192, v196
    v_add_f32 v193, v193, v197
    v_add_f32 v194, v194, v198
    ds_write_b128 v26, v[252:255] offset:15360
    v_add_f32 v195, v195, v199
    v_add_f32 v192, v192, v193
    v_add_f32 v194, v194, v195
    v_add_f32 v192, v192, v194
    v_add_f32 v217, v217, v192
    ds_read_b128 a[32:35], v32 offset:24576
    ds_read_b128 a[36:39], v33 offset:24576
    ds_read_b128 a[40:43], v34 offset:24576
    ds_read_b128 a[44:47], v35 offset:24576
    ds_read_b128 a[48:51], v36 offset:24576
    ds_read_b128 a[52:55], v37 offset:24576
    ds_read_b128 a[56:59], v38 offset:24576
    ds_read_b128 a[60:63], v39 offset:24576
    s_waitcnt lgkmcnt(8)
    v_add_f32 v144, v144, v128
    v_add_f32 v145, v145, v129
    v_add_f32 v146, v146, v130
    v_add_f32 v147, v147, v131
    buffer_load_dwordx4 v[224:227], v20, s[32:35], s58 offen nt
    v_add_f32 v148, v148, v132
    v_add_f32 v149, v149, v133
    v_add_f32 v150, v150, v134
    v_add_f32 v151, v151, v135
    v_add_f32 v152, v152, v136
    v_add_f32 v153, v153, v137
    v_add_f32 v154, v154, v138
    v_add_f32 v155, v155, v139
    v_add_f32 v156, v156, v140
    v_add_f32 v157, v157, v141
    v_add_f32 v158, v158, v142
    v_add_f32 v159, v159, v143
    s_waitcnt lgkmcnt(0)
    v_mfma_f32_32x32x16_bf16 v[128:143], a[32:35], a[0:3], 0
    ds_read_b64_tr_b16 a[64:65], v40 offset:16384
    ds_read_b64_tr_b16 a[66:67], v41 offset:18432
    v_add_f32 v160, v160, v176
    v_add_f32 v161, v161, v177
    v_add_f32 v162, v162, v178
    v_add_f32 v163, v163, v179
    v_add_f32 v164, v164, v180
    v_mfma_f32_32x32x16_bf16 v[128:143], a[36:39], a[4:7], v[128:143]
    ds_read_b64_tr_b16 a[72:73], v42 offset:16384
    ds_read_b64_tr_b16 a[74:75], v43 offset:18432
    v_add_f32 v165, v165, v181
    v_add_f32 v166, v166, v182
    v_add_f32 v167, v167, v183
    v_add_f32 v168, v168, v184
    v_add_f32 v169, v169, v185
    v_mfma_f32_32x32x16_bf16 v[128:143], a[40:43], a[8:11], v[128:143]
    ds_read_b64_tr_b16 a[80:81], v44 offset:16384
    ds_read_b64_tr_b16 a[82:83], v45 offset:18432
    v_add_f32 v170, v170, v186
    v_add_f32 v171, v171, v187
    v_add_f32 v172, v172, v188
    v_add_f32 v173, v173, v189
    v_add_f32 v174, v174, v190
    v_mfma_f32_32x32x16_bf16 v[128:143], a[44:47], a[12:15], v[128:143]
    ds_read_b64_tr_b16 a[88:89], v46 offset:16384
    ds_read_b64_tr_b16 a[90:91], v47 offset:18432
    v_add_f32 v175, v175, v191
    v_add_f32 v144, v144, v160
    v_add_f32 v145, v145, v161
    v_add_f32 v146, v146, v162
    v_add_f32 v147, v147, v163
    v_mfma_f32_32x32x16_bf16 v[128:143], a[48:51], a[16:19], v[128:143]
    ds_read_b64_tr_b16 a[68:69], v40 offset:20480
    ds_read_b64_tr_b16 a[70:71], v41 offset:22528
    v_add_f32 v148, v148, v164
    v_add_f32 v149, v149, v165
    v_add_f32 v150, v150, v166
    v_add_f32 v151, v151, v167
    v_add_f32 v152, v152, v168
    v_mfma_f32_32x32x16_bf16 v[128:143], a[52:55], a[20:23], v[128:143]
    ds_read_b64_tr_b16 a[76:77], v42 offset:20480
    ds_read_b64_tr_b16 a[78:79], v43 offset:22528
    v_add_f32 v153, v153, v169
    v_add_f32 v154, v154, v170
    v_add_f32 v155, v155, v171
    v_add_f32 v156, v156, v172
    v_add_f32 v157, v157, v173
    v_mfma_f32_32x32x16_bf16 v[128:143], a[56:59], a[24:27], v[128:143]
    ds_read_b64_tr_b16 a[84:85], v44 offset:20480
    ds_read_b64_tr_b16 a[86:87], v45 offset:22528
    v_add_f32 v158, v158, v174
    v_add_f32 v159, v159, v175
    v_max3_f32 v218, v144, v145, v146
    v_max3_f32 v219, v147, v148, v149
    v_max3_f32 v220, v150, v151, v152
    v_mfma_f32_32x32x16_bf16 v[128:143], a[60:63], a[28:31], v[128:143]
    ds_read_b64_tr_b16 a[92:93], v46 offset:20480
    ds_read_b64_tr_b16 a[94:95], v47 offset:22528
    v_max3_f32 v221, v153, v154, v155
    v_max3_f32 v218, v218, v156, v157
    v_max3_f32 v219, v219, v158, v159
    v_max3_f32 v218, v218, v219, v220
    v_max_f32 v218, v218, v221
    v_mov_b32 v219, v218
    s_nop 1
    v_permlane32_swap_b32 v218, v219
    v_max3_f32 v218, v218, v219, v216
    v_sub_f32 v220, v216, v218
    v_mov_b32 v216, v218
    v_exp_f32 v220, v220
    v_sub_f32 v192, v144, v218
    v_sub_f32 v193, v145, v218
    buffer_load_dwordx4 v[228:231], v21, s[32:35], s58 offen nt
    v_sub_f32 v194, v146, v218
    v_sub_f32 v195, v147, v218
    v_sub_f32 v196, v148, v218
    v_sub_f32 v197, v149, v218
    v_sub_f32 v198, v150, v218
    buffer_load_dwordx4 v[232:235], v22, s[32:35], s58 offen nt
    v_sub_f32 v199, v151, v218
    v_sub_f32 v200, v152, v218
    v_sub_f32 v201, v153, v218
    v_sub_f32 v202, v154, v218
    v_sub_f32 v203, v155, v218
    v_sub_f32 v204, v156, v218
    v_sub_f32 v205, v157, v218
    v_sub_f32 v206, v158, v218
    v_sub_f32 v207, v159, v218
    ds_write_b128 v28, v[128:131] offset:16384
    v_exp_f32 v192, v192
    v_exp_f32 v193, v193
    v_exp_f32 v194, v194
    v_exp_f32 v195, v195
    ds_write_b128 v28, v[132:135] offset:17408
    v_exp_f32 v196, v196
    v_exp_f32 v197, v197
    v_exp_f32 v198, v198
    v_exp_f32 v199, v199
    ds_write_b128 v28, v[136:139] offset:18432
    v_exp_f32 v200, v200
    v_exp_f32 v201, v201
    v_exp_f32 v202, v202
    v_exp_f32 v203, v203
    ds_write_b128 v28, v[140:143] offset:19456
    v_exp_f32 v204, v204
    v_exp_f32 v205, v205
    v_exp_f32 v206, v206
    v_exp_f32 v207, v207
    v_mul_f32 v217, v217, v220
    v_cvt_pk_bf16_f32 v208, v192, v193
    v_cvt_pk_bf16_f32 v209, v194, v195
    v_cvt_pk_bf16_f32 v210, v196, v197
    v_cvt_pk_bf16_f32 v211, v198, v199
    v_cvt_pk_bf16_f32 v212, v200, v201
    v_cvt_pk_bf16_f32 v213, v202, v203
    v_cvt_pk_bf16_f32 v214, v204, v205
    v_cvt_pk_bf16_f32 v215, v206, v207
    v_mul_f32 v64, v64, v220
    v_mul_f32 v65, v65, v220
    v_mul_f32 v66, v66, v220
    v_mul_f32 v67, v67, v220
    v_mul_f32 v68, v68, v220
    v_mul_f32 v69, v69, v220
    v_mul_f32 v70, v70, v220
    v_mul_f32 v71, v71, v220
    v_mul_f32 v72, v72, v220
    v_mul_f32 v73, v73, v220
    v_mul_f32 v74, v74, v220
    v_mul_f32 v75, v75, v220
    v_mul_f32 v76, v76, v220
    v_mul_f32 v77, v77, v220
    v_mul_f32 v78, v78, v220
    v_mul_f32 v79, v79, v220
    s_waitcnt lgkmcnt(0)
    s_barrier
    v_mfma_f32_32x32x16_bf16 v[64:79], a[64:67], v[208:211], v[64:79]
    ds_read_b128 v[144:147], v29 offset:16384
    v_mul_f32 v80, v80, v220
    v_mul_f32 v81, v81, v220
    ds_read_b128 v[148:151], v29 offset:17408
    buffer_load_dwordx4 v[236:239], v23, s[32:35], s58 offen nt
    s_add_u32 s58, s58, 16384
    v_mul_f32 v82, v82, v220
    v_mul_f32 v83, v83, v220
    ds_read_b128 v[152:155], v29 offset:18432
    v_mul_f32 v84, v84, v220
    v_mfma_f32_32x32x16_bf16 v[64:79], a[68:71], v[212:215], v[64:79]
    v_mul_f32 v85, v85, v220
    ds_read_b128 v[156:159], v29 offset:19456
    v_mul_f32 v86, v86, v220
    v_mul_f32 v87, v87, v220
    v_mul_f32 v88, v88, v220
    v_mul_f32 v89, v89, v220
    v_mul_f32 v90, v90, v220
    v_mul_f32 v91, v91, v220
    v_mul_f32 v92, v92, v220
    v_mul_f32 v93, v93, v220
    v_mul_f32 v94, v94, v220
    v_mul_f32 v95, v95, v220
    s_nop 1
    v_mfma_f32_32x32x16_bf16 v[80:95], a[72:75], v[208:211], v[80:95]
    ds_read_b128 v[160:163], v30 offset:16384
    v_mul_f32 v96, v96, v220
    v_mul_f32 v97, v97, v220
    ds_read_b128 v[164:167], v30 offset:17408
    buffer_load_dwordx4 v[240:243], v20, s[32:35], s58 offen nt
    v_mul_f32 v98, v98, v220
    v_mul_f32 v99, v99, v220
    ds_read_b128 v[168:171], v30 offset:18432
    v_mul_f32 v100, v100, v220
    v_mfma_f32_32x32x16_bf16 v[80:95], a[76:79], v[212:215], v[80:95]
    v_mul_f32 v101, v101, v220
    ds_read_b128 v[172:175], v30 offset:19456
    v_mul_f32 v102, v102, v220
    v_mul_f32 v103, v103, v220
    v_mul_f32 v104, v104, v220
    v_mul_f32 v105, v105, v220
    v_mul_f32 v106, v106, v220
    v_mul_f32 v107, v107, v220
    v_mul_f32 v108, v108, v220
    v_mul_f32 v109, v109, v220
    v_mul_f32 v110, v110, v220
    v_mul_f32 v111, v111, v220
    s_nop 1
    v_mfma_f32_32x32x16_bf16 v[96:111], a[80:83], v[208:211], v[96:111]
    ds_read_b128 v[176:179], v31 offset:16384
    v_mul_f32 v112, v112, v220
    v_mul_f32 v113, v113, v220
    ds_read_b128 v[180:183], v31 offset:17408
    v_mul_f32 v114, v114, v220
    v_mul_f32 v115, v115, v220
    ds_read_b128 v[184:187], v31 offset:18432
    v_mul_f32 v116, v116, v220
    v_mfma_f32_32x32x16_bf16 v[96:111], a[84:87], v[212:215], v[96:111]
    v_mul_f32 v117, v117, v220
    ds_read_b128 v[188:191], v31 offset:19456
    v_mul_f32 v118, v118, v220
    buffer_load_dwordx4 v[244:247], v21, s[32:35], s58 offen nt
    v_mul_f32 v119, v119, v220
    v_mul_f32 v120, v120, v220
    v_mul_f32 v121, v121, v220
    v_mul_f32 v122, v122, v220
    v_mul_f32 v123, v123, v220
    v_mul_f32 v124, v124, v220
    v_mul_f32 v125, v125, v220
    v_mul_f32 v126, v126, v220
    v_mul_f32 v127, v127, v220
    s_nop 1
    v_mfma_f32_32x32x16_bf16 v[112:127], a[88:91], v[208:211], v[112:127]
    v_add_f32 v192, v192, v200
    v_add_f32 v193, v193, v201
    v_add_f32 v194, v194, v202
    v_add_f32 v195, v195, v203
    v_add_f32 v196, v196, v204
    v_add_f32 v197, v197, v205
    v_add_f32 v198, v198, v206
    v_add_f32 v199, v199, v207
    v_mfma_f32_32x32x16_bf16 v[112:127], a[92:95], v[212:215], v[112:127]
    v_add_f32 v192, v192, v196
    v_add_f32 v193, v193, v197
    v_add_f32 v194, v194, v198
    v_add_f32 v195, v195, v199
    v_add_f32 v192, v192, v193
    v_add_f32 v194, v194, v195
    v_add_f32 v192, v192, v194
    v_add_f32 v217, v217, v192
    ds_read_b128 a[32:35], v32 offset:0
    ds_read_b128 a[36:39], v33 offset:0
    ds_read_b128 a[40:43], v34 offset:0
    ds_read_b128 a[44:47], v35 offset:0
    ds_read_b128 a[48:51], v36 offset:0
    ds_read_b128 a[52:55], v37 offset:0
    ds_read_b128 a[56:59], v38 offset:0
    ds_read_b128 a[60:63], v39 offset:0
    s_waitcnt lgkmcnt(8)
    v_add_f32 v144, v144, v128
    v_add_f32 v145, v145, v129
    v_add_f32 v146, v146, v130
    v_add_f32 v147, v147, v131
    buffer_load_dwordx4 v[248:251], v22, s[32:35], s58 offen nt
    v_add_f32 v148, v148, v132
    v_add_f32 v149, v149, v133
    v_add_f32 v150, v150, v134
    v_add_f32 v151, v151, v135
    v_add_f32 v152, v152, v136
    v_add_f32 v153, v153, v137
    v_add_f32 v154, v154, v138
    v_add_f32 v155, v155, v139
    v_add_f32 v156, v156, v140
    v_add_f32 v157, v157, v141
    v_add_f32 v158, v158, v142
    v_add_f32 v159, v159, v143
    s_waitcnt lgkmcnt(0)
    v_mfma_f32_32x32x16_bf16 v[128:143], a[32:35], a[0:3], 0
    ds_read_b64_tr_b16 a[64:65], v40 offset:24576
    ds_read_b64_tr_b16 a[66:67], v41 offset:26624
    v_add_f32 v160, v160, v176
    v_add_f32 v161, v161, v177
    v_add_f32 v162, v162, v178
    v_add_f32 v163, v163, v179
    v_add_f32 v164, v164, v180
    v_mfma_f32_32x32x16_bf16 v[128:143], a[36:39], a[4:7], v[128:143]
    ds_read_b64_tr_b16 a[72:73], v42 offset:24576
    ds_read_b64_tr_b16 a[74:75], v43 offset:26624
    v_add_f32 v165, v165, v181
    v_add_f32 v166, v166, v182
    v_add_f32 v167, v167, v183
    v_add_f32 v168, v168, v184
    v_add_f32 v169, v169, v185
    v_mfma_f32_32x32x16_bf16 v[128:143], a[40:43], a[8:11], v[128:143]
    ds_read_b64_tr_b16 a[80:81], v44 offset:24576
    ds_read_b64_tr_b16 a[82:83], v45 offset:26624
    v_add_f32 v170, v170, v186
    v_add_f32 v171, v171, v187
    v_add_f32 v172, v172, v188
    v_add_f32 v173, v173, v189
    v_add_f32 v174, v174, v190
    v_mfma_f32_32x32x16_bf16 v[128:143], a[44:47], a[12:15], v[128:143]
    ds_read_b64_tr_b16 a[88:89], v46 offset:24576
    ds_read_b64_tr_b16 a[90:91], v47 offset:26624
    v_add_f32 v175, v175, v191
    v_add_f32 v144, v144, v160
    v_add_f32 v145, v145, v161
    v_add_f32 v146, v146, v162
    v_add_f32 v147, v147, v163
    v_mfma_f32_32x32x16_bf16 v[128:143], a[48:51], a[16:19], v[128:143]
    ds_read_b64_tr_b16 a[68:69], v40 offset:28672
    ds_read_b64_tr_b16 a[70:71], v41 offset:30720
    v_add_f32 v148, v148, v164
    v_add_f32 v149, v149, v165
    v_add_f32 v150, v150, v166
    v_add_f32 v151, v151, v167
    v_add_f32 v152, v152, v168
    v_mfma_f32_32x32x16_bf16 v[128:143], a[52:55], a[20:23], v[128:143]
    ds_read_b64_tr_b16 a[76:77], v42 offset:28672
    ds_read_b64_tr_b16 a[78:79], v43 offset:30720
    v_add_f32 v153, v153, v169
    v_add_f32 v154, v154, v170
    v_add_f32 v155, v155, v171
    v_add_f32 v156, v156, v172
    v_add_f32 v157, v157, v173
    v_mfma_f32_32x32x16_bf16 v[128:143], a[56:59], a[24:27], v[128:143]
    ds_read_b64_tr_b16 a[84:85], v44 offset:28672
    ds_read_b64_tr_b16 a[86:87], v45 offset:30720
    v_add_f32 v158, v158, v174
    v_add_f32 v159, v159, v175
    v_max3_f32 v218, v144, v145, v146
    v_max3_f32 v219, v147, v148, v149
    v_max3_f32 v220, v150, v151, v152
    v_mfma_f32_32x32x16_bf16 v[128:143], a[60:63], a[28:31], v[128:143]
    ds_read_b64_tr_b16 a[92:93], v46 offset:28672
    ds_read_b64_tr_b16 a[94:95], v47 offset:30720
    v_max3_f32 v221, v153, v154, v155
    v_max3_f32 v218, v218, v156, v157
    v_max3_f32 v219, v219, v158, v159
    v_max3_f32 v218, v218, v219, v220
    v_max_f32 v218, v218, v221
    v_mov_b32 v219, v218
    s_nop 1
    v_permlane32_swap_b32 v218, v219
    v_max3_f32 v218, v218, v219, v216
    v_sub_f32 v220, v216, v218
    v_mov_b32 v216, v218
    v_exp_f32 v220, v220
    v_sub_f32 v192, v144, v218
    v_sub_f32 v193, v145, v218
    buffer_load_dwordx4 v[252:255], v23, s[32:35], s58 offen nt
    s_add_u32 s58, s58, 16384
    v_sub_f32 v194, v146, v218
    v_sub_f32 v195, v147, v218
    v_sub_f32 v196, v148, v218
    v_sub_f32 v197, v149, v218
    v_sub_f32 v198, v150, v218
    v_sub_f32 v199, v151, v218
    v_sub_f32 v200, v152, v218
    v_sub_f32 v201, v153, v218
    v_sub_f32 v202, v154, v218
    v_sub_f32 v203, v155, v218
    v_sub_f32 v204, v156, v218
    v_sub_f32 v205, v157, v218
    v_sub_f32 v206, v158, v218
    v_sub_f32 v207, v159, v218
    ds_write_b128 v28, v[128:131] offset:0
    v_exp_f32 v192, v192
    v_exp_f32 v193, v193
    v_exp_f32 v194, v194
    v_exp_f32 v195, v195
    ds_write_b128 v28, v[132:135] offset:1024
    v_exp_f32 v196, v196
    v_exp_f32 v197, v197
    v_exp_f32 v198, v198
    v_exp_f32 v199, v199
    ds_write_b128 v28, v[136:139] offset:2048
    v_exp_f32 v200, v200
    v_exp_f32 v201, v201
    v_exp_f32 v202, v202
    v_exp_f32 v203, v203
    ds_write_b128 v28, v[140:143] offset:3072
    v_exp_f32 v204, v204
    v_exp_f32 v205, v205
    v_exp_f32 v206, v206
    v_exp_f32 v207, v207
    v_mul_f32 v217, v217, v220
    v_cvt_pk_bf16_f32 v208, v192, v193
    v_cvt_pk_bf16_f32 v209, v194, v195
    v_cvt_pk_bf16_f32 v210, v196, v197
    v_cvt_pk_bf16_f32 v211, v198, v199
    v_cvt_pk_bf16_f32 v212, v200, v201
    v_cvt_pk_bf16_f32 v213, v202, v203
    v_cvt_pk_bf16_f32 v214, v204, v205
    v_cvt_pk_bf16_f32 v215, v206, v207
    v_mul_f32 v64, v64, v220
    v_mul_f32 v65, v65, v220
    v_mul_f32 v66, v66, v220
    v_mul_f32 v67, v67, v220
    v_mul_f32 v68, v68, v220
    v_mul_f32 v69, v69, v220
    v_mul_f32 v70, v70, v220
    v_mul_f32 v71, v71, v220
    v_mul_f32 v72, v72, v220
    v_mul_f32 v73, v73, v220
    v_mul_f32 v74, v74, v220
    v_mul_f32 v75, v75, v220
    v_mul_f32 v76, v76, v220
    v_mul_f32 v77, v77, v220
    v_mul_f32 v78, v78, v220
    v_mul_f32 v79, v79, v220
    s_waitcnt lgkmcnt(0)
    s_barrier
    v_mfma_f32_32x32x16_bf16 v[64:79], a[64:67], v[208:211], v[64:79]
    ds_read_b128 v[144:147], v29 offset:0
    v_mul_f32 v80, v80, v220
    v_mul_f32 v81, v81, v220
    ds_read_b128 v[148:151], v29 offset:1024
    v_mul_f32 v82, v82, v220
    v_mul_f32 v83, v83, v220
    ds_read_b128 v[152:155], v29 offset:2048
    v_mul_f32 v84, v84, v220
    v_mfma_f32_32x32x16_bf16 v[64:79], a[68:71], v[212:215], v[64:79]
    v_mul_f32 v85, v85, v220
    ds_read_b128 v[156:159], v29 offset:3072
    v_mul_f32 v86, v86, v220
    v_mul_f32 v87, v87, v220
    v_mul_f32 v88, v88, v220
    v_mul_f32 v89, v89, v220
    v_mul_f32 v90, v90, v220
    v_mul_f32 v91, v91, v220
    v_mul_f32 v92, v92, v220
    v_mul_f32 v93, v93, v220
    v_mul_f32 v94, v94, v220
    v_mul_f32 v95, v95, v220
    s_nop 1
    v_mfma_f32_32x32x16_bf16 v[80:95], a[72:75], v[208:211], v[80:95]
    ds_read_b128 v[160:163], v30 offset:0
    v_mul_f32 v96, v96, v220
    v_mul_f32 v97, v97, v220
    ds_read_b128 v[164:167], v30 offset:1024
    v_mul_f32 v98, v98, v220
    v_mul_f32 v99, v99, v220
    ds_read_b128 v[168:171], v30 offset:2048
    v_mul_f32 v100, v100, v220
    v_mfma_f32_32x32x16_bf16 v[80:95], a[76:79], v[212:215], v[80:95]
    v_mul_f32 v101, v101, v220
    ds_read_b128 v[172:175], v30 offset:3072
    v_mul_f32 v102, v102, v220
    v_mul_f32 v103, v103, v220
    v_mul_f32 v104, v104, v220
    v_mul_f32 v105, v105, v220
    v_mul_f32 v106, v106, v220
    v_mul_f32 v107, v107, v220
    v_mul_f32 v108, v108, v220
    v_mul_f32 v109, v109, v220
    v_mul_f32 v110, v110, v220
    v_mul_f32 v111, v111, v220
    s_nop 1
    v_mfma_f32_32x32x16_bf16 v[96:111], a[80:83], v[208:211], v[96:111]
    ds_read_b128 v[176:179], v31 offset:0
    v_mul_f32 v112, v112, v220
    v_mul_f32 v113, v113, v220
    ds_read_b128 v[180:183], v31 offset:1024
    v_mul_f32 v114, v114, v220
    v_mul_f32 v115, v115, v220
    ds_read_b128 v[184:187], v31 offset:2048
    v_mul_f32 v116, v116, v220
    v_mfma_f32_32x32x16_bf16 v[96:111], a[84:87], v[212:215], v[96:111]
    v_mul_f32 v117, v117, v220
    ds_read_b128 v[188:191], v31 offset:3072
    v_mul_f32 v118, v118, v220
    v_mul_f32 v119, v119, v220
    v_mul_f32 v120, v120, v220
    v_mul_f32 v121, v121, v220
    v_mul_f32 v122, v122, v220
    v_mul_f32 v123, v123, v220
    v_mul_f32 v124, v124, v220
    v_mul_f32 v125, v125, v220
    v_mul_f32 v126, v126, v220
    v_mul_f32 v127, v127, v220
    s_nop 1
    v_mfma_f32_32x32x16_bf16 v[112:127], a[88:91], v[208:211], v[112:127]
    v_add_f32 v192, v192, v200
    v_add_f32 v193, v193, v201
    v_add_f32 v194, v194, v202
    v_add_f32 v195, v195, v203
    v_add_f32 v196, v196, v204
    v_add_f32 v197, v197, v205
    v_add_f32 v198, v198, v206
    v_add_f32 v199, v199, v207
    v_mfma_f32_32x32x16_bf16 v[112:127], a[92:95], v[212:215], v[112:127]
    v_add_f32 v192, v192, v196
    v_add_f32 v193, v193, v197
    v_add_f32 v194, v194, v198
    v_add_f32 v195, v195, v199
    v_add_f32 v192, v192, v193
    v_add_f32 v194, v194, v195
    v_add_f32 v192, v192, v194
    v_add_f32 v217, v217, v192
    ds_read_b128 a[32:35], v32 offset:8192
    ds_read_b128 a[36:39], v33 offset:8192
    ds_read_b128 a[40:43], v34 offset:8192
    ds_read_b128 a[44:47], v35 offset:8192
    ds_read_b128 a[48:51], v36 offset:8192
    ds_read_b128 a[52:55], v37 offset:8192
    ds_read_b128 a[56:59], v38 offset:8192
    ds_read_b128 a[60:63], v39 offset:8192
    s_waitcnt lgkmcnt(8)
    v_add_f32 v144, v144, v128
    v_add_f32 v145, v145, v129
    v_add_f32 v146, v146, v130
    v_add_f32 v147, v147, v131
    v_add_f32 v148, v148, v132
    v_add_f32 v149, v149, v133
    v_add_f32 v150, v150, v134
    v_add_f32 v151, v151, v135
    v_add_f32 v152, v152, v136
    v_add_f32 v153, v153, v137
    v_add_f32 v154, v154, v138
    v_add_f32 v155, v155, v139
    v_add_f32 v156, v156, v140
    v_add_f32 v157, v157, v141
    v_add_f32 v158, v158, v142
    v_add_f32 v159, v159, v143
    s_waitcnt lgkmcnt(0)
    v_mfma_f32_32x32x16_bf16 v[128:143], a[32:35], a[0:3], 0
    ds_read_b64_tr_b16 a[64:65], v40 offset:0
    ds_read_b64_tr_b16 a[66:67], v41 offset:2048
    v_add_f32 v160, v160, v176
    v_add_f32 v161, v161, v177
    v_add_f32 v162, v162, v178
    v_add_f32 v163, v163, v179
    v_add_f32 v164, v164, v180
    v_mfma_f32_32x32x16_bf16 v[128:143], a[36:39], a[4:7], v[128:143]
    ds_read_b64_tr_b16 a[72:73], v42 offset:0
    ds_read_b64_tr_b16 a[74:75], v43 offset:2048
    v_add_f32 v165, v165, v181
    v_add_f32 v166, v166, v182
    v_add_f32 v167, v167, v183
    v_add_f32 v168, v168, v184
    v_add_f32 v169, v169, v185
    v_mfma_f32_32x32x16_bf16 v[128:143], a[40:43], a[8:11], v[128:143]
    ds_read_b64_tr_b16 a[80:81], v44 offset:0
    ds_read_b64_tr_b16 a[82:83], v45 offset:2048
    v_add_f32 v170, v170, v186
    v_add_f32 v171, v171, v187
    v_add_f32 v172, v172, v188
    v_add_f32 v173, v173, v189
    v_add_f32 v174, v174, v190
    v_mfma_f32_32x32x16_bf16 v[128:143], a[44:47], a[12:15], v[128:143]
    ds_read_b64_tr_b16 a[88:89], v46 offset:0
    ds_read_b64_tr_b16 a[90:91], v47 offset:2048
    v_add_f32 v175, v175, v191
    v_add_f32 v144, v144, v160
    v_add_f32 v145, v145, v161
    v_add_f32 v146, v146, v162
    v_add_f32 v147, v147, v163
    v_mfma_f32_32x32x16_bf16 v[128:143], a[48:51], a[16:19], v[128:143]
    ds_read_b64_tr_b16 a[68:69], v40 offset:4096
    ds_read_b64_tr_b16 a[70:71], v41 offset:6144
    v_add_f32 v148, v148, v164
    v_add_f32 v149, v149, v165
    v_add_f32 v150, v150, v166
    v_add_f32 v151, v151, v167
    v_add_f32 v152, v152, v168
    v_mfma_f32_32x32x16_bf16 v[128:143], a[52:55], a[20:23], v[128:143]
    ds_read_b64_tr_b16 a[76:77], v42 offset:4096
    ds_read_b64_tr_b16 a[78:79], v43 offset:6144
    v_add_f32 v153, v153, v169
    v_add_f32 v154, v154, v170
    v_add_f32 v155, v155, v171
    v_add_f32 v156, v156, v172
    v_add_f32 v157, v157, v173
    v_mfma_f32_32x32x16_bf16 v[128:143], a[56:59], a[24:27], v[128:143]
    ds_read_b64_tr_b16 a[84:85], v44 offset:4096
    ds_read_b64_tr_b16 a[86:87], v45 offset:6144
    v_add_f32 v158, v158, v174
    v_add_f32 v159, v159, v175
    v_max3_f32 v218, v144, v145, v146
    v_max3_f32 v219, v147, v148, v149
    v_max3_f32 v220, v150, v151, v152
    v_mfma_f32_32x32x16_bf16 v[128:143], a[60:63], a[28:31], v[128:143]
    ds_read_b64_tr_b16 a[92:93], v46 offset:4096
    ds_read_b64_tr_b16 a[94:95], v47 offset:6144
    v_max3_f32 v221, v153, v154, v155
    v_max3_f32 v218, v218, v156, v157
    v_max3_f32 v219, v219, v158, v159
    v_max3_f32 v218, v218, v219, v220
    v_max_f32 v218, v218, v221
    v_mov_b32 v219, v218
    s_nop 1
    v_permlane32_swap_b32 v218, v219
    v_max3_f32 v218, v218, v219, v216
    v_sub_f32 v220, v216, v218
    v_mov_b32 v216, v218
    v_exp_f32 v220, v220
    v_sub_f32 v192, v144, v218
    v_sub_f32 v193, v145, v218
    v_sub_f32 v194, v146, v218
    v_sub_f32 v195, v147, v218
    v_sub_f32 v196, v148, v218
    v_sub_f32 v197, v149, v218
    v_sub_f32 v198, v150, v218
    v_sub_f32 v199, v151, v218
    v_sub_f32 v200, v152, v218
    v_sub_f32 v201, v153, v218
    v_sub_f32 v202, v154, v218
    v_sub_f32 v203, v155, v218
    v_sub_f32 v204, v156, v218
    v_sub_f32 v205, v157, v218
    v_sub_f32 v206, v158, v218
    v_sub_f32 v207, v159, v218
    ds_write_b128 v28, v[128:131] offset:16384
    v_exp_f32 v192, v192
    v_exp_f32 v193, v193
    v_exp_f32 v194, v194
    v_exp_f32 v195, v195
    ds_write_b128 v28, v[132:135] offset:17408
    v_exp_f32 v196, v196
    v_exp_f32 v197, v197
    v_exp_f32 v198, v198
    v_exp_f32 v199, v199
    ds_write_b128 v28, v[136:139] offset:18432
    v_exp_f32 v200, v200
    v_exp_f32 v201, v201
    v_exp_f32 v202, v202
    v_exp_f32 v203, v203
    ds_write_b128 v28, v[140:143] offset:19456
    v_exp_f32 v204, v204
    v_exp_f32 v205, v205
    v_exp_f32 v206, v206
    v_exp_f32 v207, v207
    v_mul_f32 v217, v217, v220
    v_cvt_pk_bf16_f32 v208, v192, v193
    v_cvt_pk_bf16_f32 v209, v194, v195
    v_cvt_pk_bf16_f32 v210, v196, v197
    v_cvt_pk_bf16_f32 v211, v198, v199
    v_cvt_pk_bf16_f32 v212, v200, v201
    v_cvt_pk_bf16_f32 v213, v202, v203
    v_cvt_pk_bf16_f32 v214, v204, v205
    v_cvt_pk_bf16_f32 v215, v206, v207
    v_mul_f32 v64, v64, v220
    v_mul_f32 v65, v65, v220
    v_mul_f32 v66, v66, v220
    v_mul_f32 v67, v67, v220
    v_mul_f32 v68, v68, v220
    v_mul_f32 v69, v69, v220
    v_mul_f32 v70, v70, v220
    v_mul_f32 v71, v71, v220
    v_mul_f32 v72, v72, v220
    v_mul_f32 v73, v73, v220
    v_mul_f32 v74, v74, v220
    v_mul_f32 v75, v75, v220
    v_mul_f32 v76, v76, v220
    v_mul_f32 v77, v77, v220
    v_mul_f32 v78, v78, v220
    v_mul_f32 v79, v79, v220
    s_waitcnt lgkmcnt(0)
    s_barrier
    v_mfma_f32_32x32x16_bf16 v[64:79], a[64:67], v[208:211], v[64:79]
    ds_read_b128 v[144:147], v29 offset:16384
    v_mul_f32 v80, v80, v220
    v_mul_f32 v81, v81, v220
    ds_read_b128 v[148:151], v29 offset:17408
    s_waitcnt vmcnt(47)
    ds_write_b128 v26, a[96:99] offset:16384
    buffer_load_dwordx4 a[96:99], v48, s[36:39], s99 offen offset:0 nt
    v_mul_f32 v82, v82, v220
    v_mul_f32 v83, v83, v220
    ds_read_b128 v[152:155], v29 offset:18432
    v_mul_f32 v84, v84, v220
    v_mfma_f32_32x32x16_bf16 v[64:79], a[68:71], v[212:215], v[64:79]
    v_mul_f32 v85, v85, v220
    ds_read_b128 v[156:159], v29 offset:19456
    v_mul_f32 v86, v86, v220
    s_waitcnt vmcnt(47)
    ds_write_b128 v26, a[100:103] offset:17408
    buffer_load_dwordx4 a[100:103], v48, s[36:39], s99 offen offset:1152 nt
    v_mul_f32 v87, v87, v220
    v_mul_f32 v88, v88, v220
    v_mul_f32 v89, v89, v220
    v_mul_f32 v90, v90, v220
    v_mul_f32 v91, v91, v220
    v_mul_f32 v92, v92, v220
    v_mul_f32 v93, v93, v220
    v_mul_f32 v94, v94, v220
    v_mul_f32 v95, v95, v220
    s_nop 1
    v_mfma_f32_32x32x16_bf16 v[80:95], a[72:75], v[208:211], v[80:95]
    ds_read_b128 v[160:163], v30 offset:16384
    v_mul_f32 v96, v96, v220
    v_mul_f32 v97, v97, v220
    ds_read_b128 v[164:167], v30 offset:17408
    s_waitcnt vmcnt(47)
    ds_write_b128 v26, a[104:107] offset:18432
    buffer_load_dwordx4 a[104:107], v48, s[36:39], s99 offen offset:2304 nt
    v_mul_f32 v98, v98, v220
    v_mul_f32 v99, v99, v220
    ds_read_b128 v[168:171], v30 offset:18432
    v_mul_f32 v100, v100, v220
    v_mfma_f32_32x32x16_bf16 v[80:95], a[76:79], v[212:215], v[80:95]
    v_mul_f32 v101, v101, v220
    ds_read_b128 v[172:175], v30 offset:19456
    v_mul_f32 v102, v102, v220
    s_waitcnt vmcnt(47)
    ds_write_b128 v26, a[108:111] offset:19456
    v_mul_f32 v103, v103, v220
    v_mul_f32 v104, v104, v220
    v_mul_f32 v105, v105, v220
    v_mul_f32 v106, v106, v220
    v_mul_f32 v107, v107, v220
    v_mul_f32 v108, v108, v220
    v_mul_f32 v109, v109, v220
    v_mul_f32 v110, v110, v220
    v_mul_f32 v111, v111, v220
    s_nop 1
    v_mfma_f32_32x32x16_bf16 v[96:111], a[80:83], v[208:211], v[96:111]
    ds_read_b128 v[176:179], v31 offset:16384
    v_mul_f32 v112, v112, v220
    v_mul_f32 v113, v113, v220
    ds_read_b128 v[180:183], v31 offset:17408
    s_waitcnt vmcnt(46)
    ds_write_b128 v26, a[112:115] offset:20480
    buffer_load_dwordx4 a[108:111], v48, s[36:39], s99 offen offset:3456 nt
    s_add_u32 s99, s99, 4608
    v_mul_f32 v114, v114, v220
    v_mul_f32 v115, v115, v220
    ds_read_b128 v[184:187], v31 offset:18432
    v_mul_f32 v116, v116, v220
    v_mfma_f32_32x32x16_bf16 v[96:111], a[84:87], v[212:215], v[96:111]
    v_mul_f32 v117, v117, v220
    ds_read_b128 v[188:191], v31 offset:19456
    v_mul_f32 v118, v118, v220
    s_waitcnt vmcnt(46)
    ds_write_b128 v26, a[116:119] offset:21504
    buffer_load_dwordx4 a[112:115], v48, s[36:39], s99 offen offset:0 nt
    v_mul_f32 v119, v119, v220
    v_mul_f32 v120, v120, v220
    v_mul_f32 v121, v121, v220
    v_mul_f32 v122, v122, v220
    v_mul_f32 v123, v123, v220
    v_mul_f32 v124, v124, v220
    v_mul_f32 v125, v125, v220
    v_mul_f32 v126, v126, v220
    v_mul_f32 v127, v127, v220
    s_nop 1
    v_mfma_f32_32x32x16_bf16 v[112:127], a[88:91], v[208:211], v[112:127]
    v_add_f32 v192, v192, v200
    v_add_f32 v193, v193, v201
    v_add_f32 v194, v194, v202
    v_add_f32 v195, v195, v203
    s_waitcnt vmcnt(46)
    ds_write_b128 v26, a[120:123] offset:22528
    buffer_load_dwordx4 a[116:119], v48, s[36:39], s99 offen offset:1152 nt
    v_add_f32 v196, v196, v204
    v_add_f32 v197, v197, v205
    v_add_f32 v198, v198, v206
    v_add_f32 v199, v199, v207
    v_mfma_f32_32x32x16_bf16 v[112:127], a[92:95], v[212:215], v[112:127]
    v_add_f32 v192, v192, v196
    v_add_f32 v193, v193, v197
    v_add_f32 v194, v194, v198
    s_waitcnt vmcnt(46)
    ds_write_b128 v26, a[124:127] offset:23552
    v_add_f32 v195, v195, v199
    v_add_f32 v192, v192, v193
    v_add_f32 v194, v194, v195
    v_add_f32 v192, v192, v194
    v_add_f32 v217, v217, v192
    ds_read_b128 a[32:35], v32 offset:16384
    ds_read_b128 a[36:39], v33 offset:16384
    ds_read_b128 a[40:43], v34 offset:16384
    ds_read_b128 a[44:47], v35 offset:16384
    ds_read_b128 a[48:51], v36 offset:16384
    ds_read_b128 a[52:55], v37 offset:16384
    ds_read_b128 a[56:59], v38 offset:16384
    ds_read_b128 a[60:63], v39 offset:16384
    s_waitcnt lgkmcnt(8)
    v_add_f32 v144, v144, v128
    v_add_f32 v145, v145, v129
    v_add_f32 v146, v146, v130
    v_add_f32 v147, v147, v131
    buffer_load_dwordx4 a[120:123], v48, s[36:39], s99 offen offset:2304 nt
    v_add_f32 v148, v148, v132
    v_add_f32 v149, v149, v133
    v_add_f32 v150, v150, v134
    v_add_f32 v151, v151, v135
    v_add_f32 v152, v152, v136
    v_add_f32 v153, v153, v137
    v_add_f32 v154, v154, v138
    v_add_f32 v155, v155, v139
    v_add_f32 v156, v156, v140
    v_add_f32 v157, v157, v141
    v_add_f32 v158, v158, v142
    v_add_f32 v159, v159, v143
    s_waitcnt lgkmcnt(0)
    v_mfma_f32_32x32x16_bf16 v[128:143], a[32:35], a[0:3], 0
    ds_read_b64_tr_b16 a[64:65], v40 offset:8192
    ds_read_b64_tr_b16 a[66:67], v41 offset:10240
    v_add_f32 v160, v160, v176
    v_add_f32 v161, v161, v177
    v_add_f32 v162, v162, v178
    v_add_f32 v163, v163, v179
    v_add_f32 v164, v164, v180
    v_mfma_f32_32x32x16_bf16 v[128:143], a[36:39], a[4:7], v[128:143]
    ds_read_b64_tr_b16 a[72:73], v42 offset:8192
    ds_read_b64_tr_b16 a[74:75], v43 offset:10240
    v_add_f32 v165, v165, v181
    v_add_f32 v166, v166, v182
    v_add_f32 v167, v167, v183
    v_add_f32 v168, v168, v184
    v_add_f32 v169, v169, v185
    v_mfma_f32_32x32x16_bf16 v[128:143], a[40:43], a[8:11], v[128:143]
    ds_read_b64_tr_b16 a[80:81], v44 offset:8192
    ds_read_b64_tr_b16 a[82:83], v45 offset:10240
    v_add_f32 v170, v170, v186
    v_add_f32 v171, v171, v187
    v_add_f32 v172, v172, v188
    v_add_f32 v173, v173, v189
    v_add_f32 v174, v174, v190
    v_mfma_f32_32x32x16_bf16 v[128:143], a[44:47], a[12:15], v[128:143]
    ds_read_b64_tr_b16 a[88:89], v46 offset:8192
    ds_read_b64_tr_b16 a[90:91], v47 offset:10240
    v_add_f32 v175, v175, v191
    v_add_f32 v144, v144, v160
    v_add_f32 v145, v145, v161
    v_add_f32 v146, v146, v162
    v_add_f32 v147, v147, v163
    v_mfma_f32_32x32x16_bf16 v[128:143], a[48:51], a[16:19], v[128:143]
    ds_read_b64_tr_b16 a[68:69], v40 offset:12288
    ds_read_b64_tr_b16 a[70:71], v41 offset:14336
    v_add_f32 v148, v148, v164
    v_add_f32 v149, v149, v165
    v_add_f32 v150, v150, v166
    v_add_f32 v151, v151, v167
    v_add_f32 v152, v152, v168
    v_mfma_f32_32x32x16_bf16 v[128:143], a[52:55], a[20:23], v[128:143]
    ds_read_b64_tr_b16 a[76:77], v42 offset:12288
    ds_read_b64_tr_b16 a[78:79], v43 offset:14336
    v_add_f32 v153, v153, v169
    v_add_f32 v154, v154, v170
    v_add_f32 v155, v155, v171
    v_add_f32 v156, v156, v172
    v_add_f32 v157, v157, v173
    v_mfma_f32_32x32x16_bf16 v[128:143], a[56:59], a[24:27], v[128:143]
    ds_read_b64_tr_b16 a[84:85], v44 offset:12288
    ds_read_b64_tr_b16 a[86:87], v45 offset:14336
    v_add_f32 v158, v158, v174
    v_add_f32 v159, v159, v175
    v_max3_f32 v218, v144, v145, v146
    v_max3_f32 v219, v147, v148, v149
    v_max3_f32 v220, v150, v151, v152
    v_mfma_f32_32x32x16_bf16 v[128:143], a[60:63], a[28:31], v[128:143]
    ds_read_b64_tr_b16 a[92:93], v46 offset:12288
    ds_read_b64_tr_b16 a[94:95], v47 offset:14336
    v_max3_f32 v221, v153, v154, v155
    v_max3_f32 v218, v218, v156, v157
    v_max3_f32 v219, v219, v158, v159
    v_max3_f32 v218, v218, v219, v220
    v_max_f32 v218, v218, v221
    v_mov_b32 v219, v218
    s_nop 1
    v_permlane32_swap_b32 v218, v219
    v_max3_f32 v218, v218, v219, v216
    v_sub_f32 v220, v216, v218
    v_mov_b32 v216, v218
    v_exp_f32 v220, v220
    v_sub_f32 v192, v144, v218
    v_sub_f32 v193, v145, v218
    buffer_load_dwordx4 a[124:127], v48, s[36:39], s99 offen offset:3456 nt
    s_add_u32 s99, s99, 32256
    v_sub_f32 v194, v146, v218
    v_sub_f32 v195, v147, v218
    v_sub_f32 v196, v148, v218
    v_sub_f32 v197, v149, v218
    v_sub_f32 v198, v150, v218
    v_sub_f32 v199, v151, v218
    v_sub_f32 v200, v152, v218
    v_sub_f32 v201, v153, v218
    v_sub_f32 v202, v154, v218
    v_sub_f32 v203, v155, v218
    v_sub_f32 v204, v156, v218
    v_sub_f32 v205, v157, v218
    v_sub_f32 v206, v158, v218
    v_sub_f32 v207, v159, v218
    ds_write_b128 v28, v[128:131] offset:0
    v_exp_f32 v192, v192
    v_exp_f32 v193, v193
    v_exp_f32 v194, v194
    v_exp_f32 v195, v195
    ds_write_b128 v28, v[132:135] offset:1024
    v_exp_f32 v196, v196
    v_exp_f32 v197, v197
    v_exp_f32 v198, v198
    v_exp_f32 v199, v199
    ds_write_b128 v28, v[136:139] offset:2048
    v_exp_f32 v200, v200
    v_exp_f32 v201, v201
    v_exp_f32 v202, v202
    v_exp_f32 v203, v203
    ds_write_b128 v28, v[140:143] offset:3072
    v_exp_f32 v204, v204
    v_exp_f32 v205, v205
    v_exp_f32 v206, v206
    v_exp_f32 v207, v207
    v_mul_f32 v217, v217, v220
    v_cvt_pk_bf16_f32 v208, v192, v193
    v_cvt_pk_bf16_f32 v209, v194, v195
    v_cvt_pk_bf16_f32 v210, v196, v197
    v_cvt_pk_bf16_f32 v211, v198, v199
    v_cvt_pk_bf16_f32 v212, v200, v201
    v_cvt_pk_bf16_f32 v213, v202, v203
    v_cvt_pk_bf16_f32 v214, v204, v205
    v_cvt_pk_bf16_f32 v215, v206, v207
    v_mul_f32 v64, v64, v220
    v_mul_f32 v65, v65, v220
    v_mul_f32 v66, v66, v220
    v_mul_f32 v67, v67, v220
    v_mul_f32 v68, v68, v220
    v_mul_f32 v69, v69, v220
    v_mul_f32 v70, v70, v220
    v_mul_f32 v71, v71, v220
    v_mul_f32 v72, v72, v220
    v_mul_f32 v73, v73, v220
    v_mul_f32 v74, v74, v220
    v_mul_f32 v75, v75, v220
    v_mul_f32 v76, v76, v220
    v_mul_f32 v77, v77, v220
    v_mul_f32 v78, v78, v220
    v_mul_f32 v79, v79, v220
    s_waitcnt lgkmcnt(0)
    s_barrier
    v_mfma_f32_32x32x16_bf16 v[64:79], a[64:67], v[208:211], v[64:79]
    ds_read_b128 v[144:147], v29 offset:0
    v_mul_f32 v80, v80, v220
    v_mul_f32 v81, v81, v220
    ds_read_b128 v[148:151], v29 offset:1024
    s_waitcnt vmcnt(47)
    ds_write_b128 v26, a[128:131] offset:24576
    buffer_load_dwordx4 a[128:131], v48, s[36:39], s99 offen offset:0 nt
    v_mul_f32 v82, v82, v220
    v_mul_f32 v83, v83, v220
    ds_read_b128 v[152:155], v29 offset:2048
    v_mul_f32 v84, v84, v220
    v_mfma_f32_32x32x16_bf16 v[64:79], a[68:71], v[212:215], v[64:79]
    v_mul_f32 v85, v85, v220
    ds_read_b128 v[156:159], v29 offset:3072
    v_mul_f32 v86, v86, v220
    s_waitcnt vmcnt(47)
    ds_write_b128 v26, a[132:135] offset:25600
    v_mul_f32 v87, v87, v220
    v_mul_f32 v88, v88, v220
    v_mul_f32 v89, v89, v220
    v_mul_f32 v90, v90, v220
    v_mul_f32 v91, v91, v220
    v_mul_f32 v92, v92, v220
    v_mul_f32 v93, v93, v220
    v_mul_f32 v94, v94, v220
    v_mul_f32 v95, v95, v220
    s_nop 1
    v_mfma_f32_32x32x16_bf16 v[80:95], a[72:75], v[208:211], v[80:95]
    ds_read_b128 v[160:163], v30 offset:0
    v_mul_f32 v96, v96, v220
    v_mul_f32 v97, v97, v220
    ds_read_b128 v[164:167], v30 offset:1024
    s_waitcnt vmcnt(46)
    ds_write_b128 v26, a[136:139] offset:26624
    buffer_load_dwordx4 a[132:135], v48, s[36:39], s99 offen offset:1152 nt
    v_mul_f32 v98, v98, v220
    v_mul_f32 v99, v99, v220
    ds_read_b128 v[168:171], v30 offset:2048
    v_mul_f32 v100, v100, v220
    v_mfma_f32_32x32x16_bf16 v[80:95], a[76:79], v[212:215], v[80:95]
    v_mul_f32 v101, v101, v220
    ds_read_b128 v[172:175], v30 offset:3072
    v_mul_f32 v102, v102, v220
    s_waitcnt vmcnt(46)
    ds_write_b128 v26, a[140:143] offset:27648
    v_mul_f32 v103, v103, v220
    v_mul_f32 v104, v104, v220
    v_mul_f32 v105, v105, v220
    v_mul_f32 v106, v106, v220
    v_mul_f32 v107, v107, v220
    v_mul_f32 v108, v108, v220
    v_mul_f32 v109, v109, v220
    v_mul_f32 v110, v110, v220
    v_mul_f32 v111, v111, v220
    s_nop 1
    v_mfma_f32_32x32x16_bf16 v[96:111], a[80:83], v[208:211], v[96:111]
    ds_read_b128 v[176:179], v31 offset:0
    v_mul_f32 v112, v112, v220
    v_mul_f32 v113, v113, v220
    ds_read_b128 v[180:183], v31 offset:1024
    s_waitcnt vmcnt(45)
    ds_write_b128 v26, a[144:147] offset:28672
    buffer_load_dwordx4 a[136:139], v48, s[36:39], s99 offen offset:2304 nt
    v_mul_f32 v114, v114, v220
    v_mul_f32 v115, v115, v220
    ds_read_b128 v[184:187], v31 offset:2048
    v_mul_f32 v116, v116, v220
    v_mfma_f32_32x32x16_bf16 v[96:111], a[84:87], v[212:215], v[96:111]
    v_mul_f32 v117, v117, v220
    ds_read_b128 v[188:191], v31 offset:3072
    v_mul_f32 v118, v118, v220
    s_waitcnt vmcnt(45)
    ds_write_b128 v26, a[148:151] offset:29696
    v_mul_f32 v119, v119, v220
    v_mul_f32 v120, v120, v220
    v_mul_f32 v121, v121, v220
    v_mul_f32 v122, v122, v220
    v_mul_f32 v123, v123, v220
    v_mul_f32 v124, v124, v220
    v_mul_f32 v125, v125, v220
    v_mul_f32 v126, v126, v220
    v_mul_f32 v127, v127, v220
    s_nop 1
    v_mfma_f32_32x32x16_bf16 v[112:127], a[88:91], v[208:211], v[112:127]
    v_add_f32 v192, v192, v200
    v_add_f32 v193, v193, v201
    v_add_f32 v194, v194, v202
    v_add_f32 v195, v195, v203
    s_waitcnt vmcnt(44)
    ds_write_b128 v26, a[152:155] offset:30720
    buffer_load_dwordx4 a[140:143], v48, s[36:39], s99 offen offset:3456 nt
    s_add_u32 s99, s99, 4608
    v_add_f32 v196, v196, v204
    v_add_f32 v197, v197, v205
    v_add_f32 v198, v198, v206
    v_add_f32 v199, v199, v207
    v_mfma_f32_32x32x16_bf16 v[112:127], a[92:95], v[212:215], v[112:127]
    v_add_f32 v192, v192, v196
    v_add_f32 v193, v193, v197
    v_add_f32 v194, v194, v198
    s_waitcnt vmcnt(44)
    ds_write_b128 v26, a[156:159] offset:31744
    v_add_f32 v195, v195, v199
    v_add_f32 v192, v192, v193
    v_add_f32 v194, v194, v195
    v_add_f32 v192, v192, v194
    v_add_f32 v217, v217, v192
    ds_read_b128 a[32:35], v32 offset:24576
    ds_read_b128 a[36:39], v33 offset:24576
    ds_read_b128 a[40:43], v34 offset:24576
    ds_read_b128 a[44:47], v35 offset:24576
    ds_read_b128 a[48:51], v36 offset:24576
    ds_read_b128 a[52:55], v37 offset:24576
    ds_read_b128 a[56:59], v38 offset:24576
    ds_read_b128 a[60:63], v39 offset:24576
    s_waitcnt lgkmcnt(8)
    v_add_f32 v144, v144, v128
    v_add_f32 v145, v145, v129
    v_add_f32 v146, v146, v130
    v_add_f32 v147, v147, v131
    buffer_load_dwordx4 a[144:147], v48, s[36:39], s99 offen offset:0 nt
    v_add_f32 v148, v148, v132
    v_add_f32 v149, v149, v133
    v_add_f32 v150, v150, v134
    v_add_f32 v151, v151, v135
    v_add_f32 v152, v152, v136
    v_add_f32 v153, v153, v137
    v_add_f32 v154, v154, v138
    v_add_f32 v155, v155, v139
    v_add_f32 v156, v156, v140
    v_add_f32 v157, v157, v141
    v_add_f32 v158, v158, v142
    v_add_f32 v159, v159, v143
    s_waitcnt lgkmcnt(0)
    v_mfma_f32_32x32x16_bf16 v[128:143], a[32:35], a[0:3], 0
    ds_read_b64_tr_b16 a[64:65], v40 offset:16384
    ds_read_b64_tr_b16 a[66:67], v41 offset:18432
    v_add_f32 v160, v160, v176
    v_add_f32 v161, v161, v177
    v_add_f32 v162, v162, v178
    v_add_f32 v163, v163, v179
    v_add_f32 v164, v164, v180
    v_mfma_f32_32x32x16_bf16 v[128:143], a[36:39], a[4:7], v[128:143]
    ds_read_b64_tr_b16 a[72:73], v42 offset:16384
    ds_read_b64_tr_b16 a[74:75], v43 offset:18432
    v_add_f32 v165, v165, v181
    v_add_f32 v166, v166, v182
    v_add_f32 v167, v167, v183
    v_add_f32 v168, v168, v184
    v_add_f32 v169, v169, v185
    v_mfma_f32_32x32x16_bf16 v[128:143], a[40:43], a[8:11], v[128:143]
    ds_read_b64_tr_b16 a[80:81], v44 offset:16384
    ds_read_b64_tr_b16 a[82:83], v45 offset:18432
    v_add_f32 v170, v170, v186
    v_add_f32 v171, v171, v187
    v_add_f32 v172, v172, v188
    v_add_f32 v173, v173, v189
    v_add_f32 v174, v174, v190
    v_mfma_f32_32x32x16_bf16 v[128:143], a[44:47], a[12:15], v[128:143]
    ds_read_b64_tr_b16 a[88:89], v46 offset:16384
    ds_read_b64_tr_b16 a[90:91], v47 offset:18432
    v_add_f32 v175, v175, v191
    v_add_f32 v144, v144, v160
    v_add_f32 v145, v145, v161
    v_add_f32 v146, v146, v162
    v_add_f32 v147, v147, v163
    v_mfma_f32_32x32x16_bf16 v[128:143], a[48:51], a[16:19], v[128:143]
    ds_read_b64_tr_b16 a[68:69], v40 offset:20480
    ds_read_b64_tr_b16 a[70:71], v41 offset:22528
    v_add_f32 v148, v148, v164
    v_add_f32 v149, v149, v165
    v_add_f32 v150, v150, v166
    v_add_f32 v151, v151, v167
    v_add_f32 v152, v152, v168
    v_mfma_f32_32x32x16_bf16 v[128:143], a[52:55], a[20:23], v[128:143]
    ds_read_b64_tr_b16 a[76:77], v42 offset:20480
    ds_read_b64_tr_b16 a[78:79], v43 offset:22528
    v_add_f32 v153, v153, v169
    v_add_f32 v154, v154, v170
    v_add_f32 v155, v155, v171
    v_add_f32 v156, v156, v172
    v_add_f32 v157, v157, v173
    v_mfma_f32_32x32x16_bf16 v[128:143], a[56:59], a[24:27], v[128:143]
    ds_read_b64_tr_b16 a[84:85], v44 offset:20480
    ds_read_b64_tr_b16 a[86:87], v45 offset:22528
    v_add_f32 v158, v158, v174
    v_add_f32 v159, v159, v175
    v_max3_f32 v218, v144, v145, v146
    v_max3_f32 v219, v147, v148, v149
    v_max3_f32 v220, v150, v151, v152
    v_mfma_f32_32x32x16_bf16 v[128:143], a[60:63], a[28:31], v[128:143]
    ds_read_b64_tr_b16 a[92:93], v46 offset:20480
    ds_read_b64_tr_b16 a[94:95], v47 offset:22528
    v_max3_f32 v221, v153, v154, v155
    v_max3_f32 v218, v218, v156, v157
    v_max3_f32 v219, v219, v158, v159
    v_max3_f32 v218, v218, v219, v220
    v_max_f32 v218, v218, v221
    v_mov_b32 v219, v218
    s_nop 1
    v_permlane32_swap_b32 v218, v219
    v_max3_f32 v218, v218, v219, v216
    v_sub_f32 v220, v216, v218
    v_mov_b32 v216, v218
    v_exp_f32 v220, v220
    v_sub_f32 v192, v144, v218
    v_sub_f32 v193, v145, v218
    buffer_load_dwordx4 a[148:151], v48, s[36:39], s99 offen offset:1152 nt
    v_sub_f32 v194, v146, v218
    v_sub_f32 v195, v147, v218
    v_sub_f32 v196, v148, v218
    v_sub_f32 v197, v149, v218
    v_sub_f32 v198, v150, v218
    buffer_load_dwordx4 a[152:155], v48, s[36:39], s99 offen offset:2304 nt
    v_sub_f32 v199, v151, v218
    v_sub_f32 v200, v152, v218
    v_sub_f32 v201, v153, v218
    v_sub_f32 v202, v154, v218
    v_sub_f32 v203, v155, v218
    v_sub_f32 v204, v156, v218
    v_sub_f32 v205, v157, v218
    v_sub_f32 v206, v158, v218
    v_sub_f32 v207, v159, v218
    ds_write_b128 v28, v[128:131] offset:16384
    v_exp_f32 v192, v192
    v_exp_f32 v193, v193
    v_exp_f32 v194, v194
    v_exp_f32 v195, v195
    ds_write_b128 v28, v[132:135] offset:17408
    v_exp_f32 v196, v196
    v_exp_f32 v197, v197
    v_exp_f32 v198, v198
    v_exp_f32 v199, v199
    ds_write_b128 v28, v[136:139] offset:18432
    v_exp_f32 v200, v200
    v_exp_f32 v201, v201
    v_exp_f32 v202, v202
    v_exp_f32 v203, v203
    ds_write_b128 v28, v[140:143] offset:19456
    v_exp_f32 v204, v204
    v_exp_f32 v205, v205
    v_exp_f32 v206, v206
    v_exp_f32 v207, v207
    v_mul_f32 v217, v217, v220
    v_cvt_pk_bf16_f32 v208, v192, v193
    v_cvt_pk_bf16_f32 v209, v194, v195
    v_cvt_pk_bf16_f32 v210, v196, v197
    v_cvt_pk_bf16_f32 v211, v198, v199
    v_cvt_pk_bf16_f32 v212, v200, v201
    v_cvt_pk_bf16_f32 v213, v202, v203
    v_cvt_pk_bf16_f32 v214, v204, v205
    v_cvt_pk_bf16_f32 v215, v206, v207
    v_mul_f32 v64, v64, v220
    v_mul_f32 v65, v65, v220
    v_mul_f32 v66, v66, v220
    v_mul_f32 v67, v67, v220
    v_mul_f32 v68, v68, v220
    v_mul_f32 v69, v69, v220
    v_mul_f32 v70, v70, v220
    v_mul_f32 v71, v71, v220
    v_mul_f32 v72, v72, v220
    v_mul_f32 v73, v73, v220
    v_mul_f32 v74, v74, v220
    v_mul_f32 v75, v75, v220
    v_mul_f32 v76, v76, v220
    v_mul_f32 v77, v77, v220
    v_mul_f32 v78, v78, v220
    v_mul_f32 v79, v79, v220
    s_waitcnt lgkmcnt(0)
    s_barrier
    v_mfma_f32_32x32x16_bf16 v[64:79], a[64:67], v[208:211], v[64:79]
    ds_read_b128 v[144:147], v29 offset:16384
    v_mul_f32 v80, v80, v220
    v_mul_f32 v81, v81, v220
    ds_read_b128 v[148:151], v29 offset:17408
    s_waitcnt vmcnt(46)
    ds_write_b128 v26, a[160:163] offset:0
    buffer_load_dwordx4 a[156:159], v48, s[36:39], s99 offen offset:3456 nt
    s_add_u32 s99, s99, 32256
    v_mul_f32 v82, v82, v220
    v_mul_f32 v83, v83, v220
    ds_read_b128 v[152:155], v29 offset:18432
    v_mul_f32 v84, v84, v220
    v_mfma_f32_32x32x16_bf16 v[64:79], a[68:71], v[212:215], v[64:79]
    v_mul_f32 v85, v85, v220
    ds_read_b128 v[156:159], v29 offset:19456
    v_mul_f32 v86, v86, v220
    s_waitcnt vmcnt(46)
    ds_write_b128 v26, a[164:167] offset:1024
    v_mul_f32 v87, v87, v220
    v_mul_f32 v88, v88, v220
    v_mul_f32 v89, v89, v220
    v_mul_f32 v90, v90, v220
    v_mul_f32 v91, v91, v220
    v_mul_f32 v92, v92, v220
    v_mul_f32 v93, v93, v220
    v_mul_f32 v94, v94, v220
    v_mul_f32 v95, v95, v220
    s_nop 1
    v_mfma_f32_32x32x16_bf16 v[80:95], a[72:75], v[208:211], v[80:95]
    ds_read_b128 v[160:163], v30 offset:16384
    v_mul_f32 v96, v96, v220
    v_mul_f32 v97, v97, v220
    ds_read_b128 v[164:167], v30 offset:17408
    s_waitcnt vmcnt(45)
    ds_write_b128 v26, a[168:171] offset:2048
    buffer_load_dwordx4 a[160:163], v48, s[36:39], s99 offen offset:0 nt
    v_mul_f32 v98, v98, v220
    v_mul_f32 v99, v99, v220
    ds_read_b128 v[168:171], v30 offset:18432
    v_mul_f32 v100, v100, v220
    v_mfma_f32_32x32x16_bf16 v[80:95], a[76:79], v[212:215], v[80:95]
    v_mul_f32 v101, v101, v220
    ds_read_b128 v[172:175], v30 offset:19456
    v_mul_f32 v102, v102, v220
    s_waitcnt vmcnt(45)
    ds_write_b128 v26, a[172:175] offset:3072
    v_mul_f32 v103, v103, v220
    v_mul_f32 v104, v104, v220
    v_mul_f32 v105, v105, v220
    v_mul_f32 v106, v106, v220
    v_mul_f32 v107, v107, v220
    v_mul_f32 v108, v108, v220
    v_mul_f32 v109, v109, v220
    v_mul_f32 v110, v110, v220
    v_mul_f32 v111, v111, v220
    s_nop 1
    v_mfma_f32_32x32x16_bf16 v[96:111], a[80:83], v[208:211], v[96:111]
    ds_read_b128 v[176:179], v31 offset:16384
    v_mul_f32 v112, v112, v220
    v_mul_f32 v113, v113, v220
    ds_read_b128 v[180:183], v31 offset:17408
    s_waitcnt vmcnt(44)
    ds_write_b128 v26, a[176:179] offset:4096
    v_mul_f32 v114, v114, v220
    v_mul_f32 v115, v115, v220
    ds_read_b128 v[184:187], v31 offset:18432
    v_mul_f32 v116, v116, v220
    v_mfma_f32_32x32x16_bf16 v[96:111], a[84:87], v[212:215], v[96:111]
    v_mul_f32 v117, v117, v220
    ds_read_b128 v[188:191], v31 offset:19456
    v_mul_f32 v118, v118, v220
    s_waitcnt vmcnt(43)
    ds_write_b128 v26, a[180:183] offset:5120
    buffer_load_dwordx4 a[164:167], v48, s[36:39], s99 offen offset:1152 nt
    v_mul_f32 v119, v119, v220
    v_mul_f32 v120, v120, v220
    v_mul_f32 v121, v121, v220
    v_mul_f32 v122, v122, v220
    v_mul_f32 v123, v123, v220
    v_mul_f32 v124, v124, v220
    v_mul_f32 v125, v125, v220
    v_mul_f32 v126, v126, v220
    v_mul_f32 v127, v127, v220
    s_nop 1
    v_mfma_f32_32x32x16_bf16 v[112:127], a[88:91], v[208:211], v[112:127]
    v_add_f32 v192, v192, v200
    v_add_f32 v193, v193, v201
    v_add_f32 v194, v194, v202
    v_add_f32 v195, v195, v203
    s_waitcnt vmcnt(43)
    ds_write_b128 v26, a[184:187] offset:6144
    v_add_f32 v196, v196, v204
    v_add_f32 v197, v197, v205
    v_add_f32 v198, v198, v206
    v_add_f32 v199, v199, v207
    v_mfma_f32_32x32x16_bf16 v[112:127], a[92:95], v[212:215], v[112:127]
    v_add_f32 v192, v192, v196
    v_add_f32 v193, v193, v197
    v_add_f32 v194, v194, v198
    s_waitcnt vmcnt(42)
    ds_write_b128 v26, a[188:191] offset:7168
    v_add_f32 v195, v195, v199
    v_add_f32 v192, v192, v193
    v_add_f32 v194, v194, v195
    v_add_f32 v192, v192, v194
    v_add_f32 v217, v217, v192
    ds_read_b128 a[32:35], v32 offset:0
    ds_read_b128 a[36:39], v33 offset:0
    ds_read_b128 a[40:43], v34 offset:0
    ds_read_b128 a[44:47], v35 offset:0
    ds_read_b128 a[48:51], v36 offset:0
    ds_read_b128 a[52:55], v37 offset:0
    ds_read_b128 a[56:59], v38 offset:0
    ds_read_b128 a[60:63], v39 offset:0
    s_waitcnt lgkmcnt(8)
    v_add_f32 v144, v144, v128
    v_add_f32 v145, v145, v129
    v_add_f32 v146, v146, v130
    v_add_f32 v147, v147, v131
    buffer_load_dwordx4 a[168:171], v48, s[36:39], s99 offen offset:2304 nt
    v_add_f32 v148, v148, v132
    v_add_f32 v149, v149, v133
    v_add_f32 v150, v150, v134
    v_add_f32 v151, v151, v135
    v_add_f32 v152, v152, v136
    v_add_f32 v153, v153, v137
    v_add_f32 v154, v154, v138
    v_add_f32 v155, v155, v139
    v_add_f32 v156, v156, v140
    v_add_f32 v157, v157, v141
    v_add_f32 v158, v158, v142
    v_add_f32 v159, v159, v143
    s_waitcnt lgkmcnt(0)
    v_mfma_f32_32x32x16_bf16 v[128:143], a[32:35], a[0:3], 0
    ds_read_b64_tr_b16 a[64:65], v40 offset:24576
    ds_read_b64_tr_b16 a[66:67], v41 offset:26624
    v_add_f32 v160, v160, v176
    v_add_f32 v161, v161, v177
    v_add_f32 v162, v162, v178
    v_add_f32 v163, v163, v179
    v_add_f32 v164, v164, v180
    v_mfma_f32_32x32x16_bf16 v[128:143], a[36:39], a[4:7], v[128:143]
    ds_read_b64_tr_b16 a[72:73], v42 offset:24576
    ds_read_b64_tr_b16 a[74:75], v43 offset:26624
    v_add_f32 v165, v165, v181
    v_add_f32 v166, v166, v182
    v_add_f32 v167, v167, v183
    v_add_f32 v168, v168, v184
    v_add_f32 v169, v169, v185
    v_mfma_f32_32x32x16_bf16 v[128:143], a[40:43], a[8:11], v[128:143]
    ds_read_b64_tr_b16 a[80:81], v44 offset:24576
    ds_read_b64_tr_b16 a[82:83], v45 offset:26624
    v_add_f32 v170, v170, v186
    v_add_f32 v171, v171, v187
    v_add_f32 v172, v172, v188
    v_add_f32 v173, v173, v189
    v_add_f32 v174, v174, v190
    v_mfma_f32_32x32x16_bf16 v[128:143], a[44:47], a[12:15], v[128:143]
    ds_read_b64_tr_b16 a[88:89], v46 offset:24576
    ds_read_b64_tr_b16 a[90:91], v47 offset:26624
    v_add_f32 v175, v175, v191
    v_add_f32 v144, v144, v160
    v_add_f32 v145, v145, v161
    v_add_f32 v146, v146, v162
    v_add_f32 v147, v147, v163
    v_mfma_f32_32x32x16_bf16 v[128:143], a[48:51], a[16:19], v[128:143]
    ds_read_b64_tr_b16 a[68:69], v40 offset:28672
    ds_read_b64_tr_b16 a[70:71], v41 offset:30720
    v_add_f32 v148, v148, v164
    v_add_f32 v149, v149, v165
    v_add_f32 v150, v150, v166
    v_add_f32 v151, v151, v167
    v_add_f32 v152, v152, v168
    v_mfma_f32_32x32x16_bf16 v[128:143], a[52:55], a[20:23], v[128:143]
    ds_read_b64_tr_b16 a[76:77], v42 offset:28672
    ds_read_b64_tr_b16 a[78:79], v43 offset:30720
    v_add_f32 v153, v153, v169
    v_add_f32 v154, v154, v170
    v_add_f32 v155, v155, v171
    v_add_f32 v156, v156, v172
    v_add_f32 v157, v157, v173
    v_mfma_f32_32x32x16_bf16 v[128:143], a[56:59], a[24:27], v[128:143]
    ds_read_b64_tr_b16 a[84:85], v44 offset:28672
    ds_read_b64_tr_b16 a[86:87], v45 offset:30720
    v_add_f32 v158, v158, v174
    v_add_f32 v159, v159, v175
    v_max3_f32 v218, v144, v145, v146
    v_max3_f32 v219, v147, v148, v149
    v_max3_f32 v220, v150, v151, v152
    v_mfma_f32_32x32x16_bf16 v[128:143], a[60:63], a[28:31], v[128:143]
    ds_read_b64_tr_b16 a[92:93], v46 offset:28672
    ds_read_b64_tr_b16 a[94:95], v47 offset:30720
    v_max3_f32 v221, v153, v154, v155
    v_max3_f32 v218, v218, v156, v157
    v_max3_f32 v219, v219, v158, v159
    v_max3_f32 v218, v218, v219, v220
    v_max_f32 v218, v218, v221
    v_mov_b32 v219, v218
    s_nop 1
    v_permlane32_swap_b32 v218, v219
    v_max3_f32 v218, v218, v219, v216
    v_sub_f32 v220, v216, v218
    v_mov_b32 v216, v218
    v_exp_f32 v220, v220
    v_sub_f32 v192, v144, v218
    v_sub_f32 v193, v145, v218
    buffer_load_dwordx4 a[172:175], v48, s[36:39], s99 offen offset:3456 nt
    s_add_u32 s99, s99, 4608
    v_sub_f32 v194, v146, v218
    v_sub_f32 v195, v147, v218
    v_sub_f32 v196, v148, v218
    v_sub_f32 v197, v149, v218
    v_sub_f32 v198, v150, v218
    buffer_load_dwordx4 a[176:179], v48, s[36:39], s99 offen offset:0 nt
    v_sub_f32 v199, v151, v218
    v_sub_f32 v200, v152, v218
    v_sub_f32 v201, v153, v218
    v_sub_f32 v202, v154, v218
    v_sub_f32 v203, v155, v218
    v_sub_f32 v204, v156, v218
    v_sub_f32 v205, v157, v218
    v_sub_f32 v206, v158, v218
    v_sub_f32 v207, v159, v218
    ds_write_b128 v28, v[128:131] offset:0
    v_exp_f32 v192, v192
    v_exp_f32 v193, v193
    v_exp_f32 v194, v194
    v_exp_f32 v195, v195
    ds_write_b128 v28, v[132:135] offset:1024
    v_exp_f32 v196, v196
    v_exp_f32 v197, v197
    v_exp_f32 v198, v198
    v_exp_f32 v199, v199
    ds_write_b128 v28, v[136:139] offset:2048
    v_exp_f32 v200, v200
    v_exp_f32 v201, v201
    v_exp_f32 v202, v202
    v_exp_f32 v203, v203
    ds_write_b128 v28, v[140:143] offset:3072
    v_exp_f32 v204, v204
    v_exp_f32 v205, v205
    v_exp_f32 v206, v206
    v_exp_f32 v207, v207
    v_mul_f32 v217, v217, v220
    v_cvt_pk_bf16_f32 v208, v192, v193
    v_cvt_pk_bf16_f32 v209, v194, v195
    v_cvt_pk_bf16_f32 v210, v196, v197
    v_cvt_pk_bf16_f32 v211, v198, v199
    v_cvt_pk_bf16_f32 v212, v200, v201
    v_cvt_pk_bf16_f32 v213, v202, v203
    v_cvt_pk_bf16_f32 v214, v204, v205
    v_cvt_pk_bf16_f32 v215, v206, v207
    v_mul_f32 v64, v64, v220
    v_mul_f32 v65, v65, v220
    v_mul_f32 v66, v66, v220
    v_mul_f32 v67, v67, v220
    v_mul_f32 v68, v68, v220
    v_mul_f32 v69, v69, v220
    v_mul_f32 v70, v70, v220
    v_mul_f32 v71, v71, v220
    v_mul_f32 v72, v72, v220
    v_mul_f32 v73, v73, v220
    v_mul_f32 v74, v74, v220
    v_mul_f32 v75, v75, v220
    v_mul_f32 v76, v76, v220
    v_mul_f32 v77, v77, v220
    v_mul_f32 v78, v78, v220
    v_mul_f32 v79, v79, v220
    s_waitcnt lgkmcnt(0)
    s_barrier
    v_mfma_f32_32x32x16_bf16 v[64:79], a[64:67], v[208:211], v[64:79]
    ds_read_b128 v[144:147], v29 offset:0
    v_mul_f32 v80, v80, v220
    v_mul_f32 v81, v81, v220
    ds_read_b128 v[148:151], v29 offset:1024
    s_waitcnt vmcnt(44)
    ds_write_b128 v26, a[192:195] offset:8192
    buffer_load_dwordx4 a[180:183], v48, s[36:39], s99 offen offset:1152 nt
    v_mul_f32 v82, v82, v220
    v_mul_f32 v83, v83, v220
    ds_read_b128 v[152:155], v29 offset:2048
    v_mul_f32 v84, v84, v220
    v_mfma_f32_32x32x16_bf16 v[64:79], a[68:71], v[212:215], v[64:79]
    v_mul_f32 v85, v85, v220
    ds_read_b128 v[156:159], v29 offset:3072
    v_mul_f32 v86, v86, v220
    s_waitcnt vmcnt(44)
    ds_write_b128 v26, a[196:199] offset:9216
    v_mul_f32 v87, v87, v220
    v_mul_f32 v88, v88, v220
    v_mul_f32 v89, v89, v220
    v_mul_f32 v90, v90, v220
    v_mul_f32 v91, v91, v220
    v_mul_f32 v92, v92, v220
    v_mul_f32 v93, v93, v220
    v_mul_f32 v94, v94, v220
    v_mul_f32 v95, v95, v220
    s_nop 1
    v_mfma_f32_32x32x16_bf16 v[80:95], a[72:75], v[208:211], v[80:95]
    ds_read_b128 v[160:163], v30 offset:0
    v_mul_f32 v96, v96, v220
    v_mul_f32 v97, v97, v220
    ds_read_b128 v[164:167], v30 offset:1024
    s_waitcnt vmcnt(43)
    ds_write_b128 v26, a[200:203] offset:10240
    buffer_load_dwordx4 a[184:187], v48, s[36:39], s99 offen offset:2304 nt
    v_mul_f32 v98, v98, v220
    v_mul_f32 v99, v99, v220
    ds_read_b128 v[168:171], v30 offset:2048
    v_mul_f32 v100, v100, v220
    v_mfma_f32_32x32x16_bf16 v[80:95], a[76:79], v[212:215], v[80:95]
    v_mul_f32 v101, v101, v220
    ds_read_b128 v[172:175], v30 offset:3072
    v_mul_f32 v102, v102, v220
    s_waitcnt vmcnt(43)
    ds_write_b128 v26, a[204:207] offset:11264
    v_mul_f32 v103, v103, v220
    v_mul_f32 v104, v104, v220
    v_mul_f32 v105, v105, v220
    v_mul_f32 v106, v106, v220
    v_mul_f32 v107, v107, v220
    v_mul_f32 v108, v108, v220
    v_mul_f32 v109, v109, v220
    v_mul_f32 v110, v110, v220
    v_mul_f32 v111, v111, v220
    s_nop 1
    v_mfma_f32_32x32x16_bf16 v[96:111], a[80:83], v[208:211], v[96:111]
    ds_read_b128 v[176:179], v31 offset:0
    v_mul_f32 v112, v112, v220
    v_mul_f32 v113, v113, v220
    ds_read_b128 v[180:183], v31 offset:1024
    s_waitcnt vmcnt(42)
    ds_write_b128 v26, a[208:211] offset:12288
    v_mul_f32 v114, v114, v220
    v_mul_f32 v115, v115, v220
    ds_read_b128 v[184:187], v31 offset:2048
    v_mul_f32 v116, v116, v220
    v_mfma_f32_32x32x16_bf16 v[96:111], a[84:87], v[212:215], v[96:111]
    v_mul_f32 v117, v117, v220
    ds_read_b128 v[188:191], v31 offset:3072
    v_mul_f32 v118, v118, v220
    s_waitcnt vmcnt(41)
    ds_write_b128 v26, a[212:215] offset:13312
    buffer_load_dwordx4 a[188:191], v48, s[36:39], s99 offen offset:3456 nt
    s_add_u32 s99, s99, 32256
    v_mul_f32 v119, v119, v220
    v_mul_f32 v120, v120, v220
    v_mul_f32 v121, v121, v220
    v_mul_f32 v122, v122, v220
    v_mul_f32 v123, v123, v220
    v_mul_f32 v124, v124, v220
    v_mul_f32 v125, v125, v220
    v_mul_f32 v126, v126, v220
    v_mul_f32 v127, v127, v220
    s_nop 1
    v_mfma_f32_32x32x16_bf16 v[112:127], a[88:91], v[208:211], v[112:127]
    v_add_f32 v192, v192, v200
    v_add_f32 v193, v193, v201
    v_add_f32 v194, v194, v202
    v_add_f32 v195, v195, v203
    s_waitcnt vmcnt(41)
    ds_write_b128 v26, a[216:219] offset:14336
    v_add_f32 v196, v196, v204
    v_add_f32 v197, v197, v205
    v_add_f32 v198, v198, v206
    v_add_f32 v199, v199, v207
    v_mfma_f32_32x32x16_bf16 v[112:127], a[92:95], v[212:215], v[112:127]
    v_add_f32 v192, v192, v196
    v_add_f32 v193, v193, v197
    v_add_f32 v194, v194, v198
    s_waitcnt vmcnt(40)
    ds_write_b128 v26, a[220:223] offset:15360
    v_add_f32 v195, v195, v199
    v_add_f32 v192, v192, v193
    v_add_f32 v194, v194, v195
    v_add_f32 v192, v192, v194
    v_add_f32 v217, v217, v192
    ds_read_b128 a[32:35], v32 offset:8192
    ds_read_b128 a[36:39], v33 offset:8192
    ds_read_b128 a[40:43], v34 offset:8192
    ds_read_b128 a[44:47], v35 offset:8192
    ds_read_b128 a[48:51], v36 offset:8192
    ds_read_b128 a[52:55], v37 offset:8192
    ds_read_b128 a[56:59], v38 offset:8192
    ds_read_b128 a[60:63], v39 offset:8192
    s_waitcnt lgkmcnt(8)
    v_add_f32 v144, v144, v128
    v_add_f32 v145, v145, v129
    v_add_f32 v146, v146, v130
    v_add_f32 v147, v147, v131
    buffer_load_dwordx4 a[192:195], v48, s[36:39], s99 offen offset:0 nt
    v_add_f32 v148, v148, v132
    v_add_f32 v149, v149, v133
    v_add_f32 v150, v150, v134
    v_add_f32 v151, v151, v135
    v_add_f32 v152, v152, v136
    v_add_f32 v153, v153, v137
    v_add_f32 v154, v154, v138
    v_add_f32 v155, v155, v139
    v_add_f32 v156, v156, v140
    v_add_f32 v157, v157, v141
    v_add_f32 v158, v158, v142
    v_add_f32 v159, v159, v143
    s_waitcnt lgkmcnt(0)
    v_mfma_f32_32x32x16_bf16 v[128:143], a[32:35], a[0:3], 0
    ds_read_b64_tr_b16 a[64:65], v40 offset:0
    ds_read_b64_tr_b16 a[66:67], v41 offset:2048
    v_add_f32 v160, v160, v176
    v_add_f32 v161, v161, v177
    v_add_f32 v162, v162, v178
    v_add_f32 v163, v163, v179
    v_add_f32 v164, v164, v180
    v_mfma_f32_32x32x16_bf16 v[128:143], a[36:39], a[4:7], v[128:143]
    ds_read_b64_tr_b16 a[72:73], v42 offset:0
    ds_read_b64_tr_b16 a[74:75], v43 offset:2048
    v_add_f32 v165, v165, v181
    v_add_f32 v166, v166, v182
    v_add_f32 v167, v167, v183
    v_add_f32 v168, v168, v184
    v_add_f32 v169, v169, v185
    v_mfma_f32_32x32x16_bf16 v[128:143], a[40:43], a[8:11], v[128:143]
    ds_read_b64_tr_b16 a[80:81], v44 offset:0
    ds_read_b64_tr_b16 a[82:83], v45 offset:2048
    v_add_f32 v170, v170, v186
    v_add_f32 v171, v171, v187
    v_add_f32 v172, v172, v188
    v_add_f32 v173, v173, v189
    v_add_f32 v174, v174, v190
    v_mfma_f32_32x32x16_bf16 v[128:143], a[44:47], a[12:15], v[128:143]
    ds_read_b64_tr_b16 a[88:89], v46 offset:0
    ds_read_b64_tr_b16 a[90:91], v47 offset:2048
    v_add_f32 v175, v175, v191
    v_add_f32 v144, v144, v160
    v_add_f32 v145, v145, v161
    v_add_f32 v146, v146, v162
    v_add_f32 v147, v147, v163
    v_mfma_f32_32x32x16_bf16 v[128:143], a[48:51], a[16:19], v[128:143]
    ds_read_b64_tr_b16 a[68:69], v40 offset:4096
    ds_read_b64_tr_b16 a[70:71], v41 offset:6144
    v_add_f32 v148, v148, v164
    v_add_f32 v149, v149, v165
    v_add_f32 v150, v150, v166
    v_add_f32 v151, v151, v167
    v_add_f32 v152, v152, v168
    v_mfma_f32_32x32x16_bf16 v[128:143], a[52:55], a[20:23], v[128:143]
    ds_read_b64_tr_b16 a[76:77], v42 offset:4096
    ds_read_b64_tr_b16 a[78:79], v43 offset:6144
    v_add_f32 v153, v153, v169
    v_add_f32 v154, v154, v170
    v_add_f32 v155, v155, v171
    v_add_f32 v156, v156, v172
    v_add_f32 v157, v157, v173
    v_mfma_f32_32x32x16_bf16 v[128:143], a[56:59], a[24:27], v[128:143]
    ds_read_b64_tr_b16 a[84:85], v44 offset:4096
    ds_read_b64_tr_b16 a[86:87], v45 offset:6144
    v_add_f32 v158, v158, v174
    v_add_f32 v159, v159, v175
    v_max3_f32 v218, v144, v145, v146
    v_max3_f32 v219, v147, v148, v149
    v_max3_f32 v220, v150, v151, v152
    v_mfma_f32_32x32x16_bf16 v[128:143], a[60:63], a[28:31], v[128:143]
    ds_read_b64_tr_b16 a[92:93], v46 offset:4096
    ds_read_b64_tr_b16 a[94:95], v47 offset:6144
    v_max3_f32 v221, v153, v154, v155
    v_max3_f32 v218, v218, v156, v157
    v_max3_f32 v219, v219, v158, v159
    v_max3_f32 v218, v218, v219, v220
    v_max_f32 v218, v218, v221
    v_mov_b32 v219, v218
    s_nop 1
    v_permlane32_swap_b32 v218, v219
    v_max3_f32 v218, v218, v219, v216
    v_sub_f32 v220, v216, v218
    v_mov_b32 v216, v218
    v_exp_f32 v220, v220
    v_sub_f32 v192, v144, v218
    v_sub_f32 v193, v145, v218
    buffer_load_dwordx4 a[196:199], v48, s[36:39], s99 offen offset:1152 nt
    v_sub_f32 v194, v146, v218
    v_sub_f32 v195, v147, v218
    v_sub_f32 v196, v148, v218
    v_sub_f32 v197, v149, v218
    v_sub_f32 v198, v150, v218
    buffer_load_dwordx4 a[200:203], v48, s[36:39], s99 offen offset:2304 nt
    v_sub_f32 v199, v151, v218
    v_sub_f32 v200, v152, v218
    v_sub_f32 v201, v153, v218
    v_sub_f32 v202, v154, v218
    v_sub_f32 v203, v155, v218
    v_sub_f32 v204, v156, v218
    v_sub_f32 v205, v157, v218
    v_sub_f32 v206, v158, v218
    v_sub_f32 v207, v159, v218
    ds_write_b128 v28, v[128:131] offset:16384
    v_exp_f32 v192, v192
    v_exp_f32 v193, v193
    v_exp_f32 v194, v194
    v_exp_f32 v195, v195
    ds_write_b128 v28, v[132:135] offset:17408
    v_exp_f32 v196, v196
    v_exp_f32 v197, v197
    v_exp_f32 v198, v198
    v_exp_f32 v199, v199
    ds_write_b128 v28, v[136:139] offset:18432
    v_exp_f32 v200, v200
    v_exp_f32 v201, v201
    v_exp_f32 v202, v202
    v_exp_f32 v203, v203
    ds_write_b128 v28, v[140:143] offset:19456
    v_exp_f32 v204, v204
    v_exp_f32 v205, v205
    v_exp_f32 v206, v206
    v_exp_f32 v207, v207
    v_mul_f32 v217, v217, v220
    v_cvt_pk_bf16_f32 v208, v192, v193
    v_cvt_pk_bf16_f32 v209, v194, v195
    v_cvt_pk_bf16_f32 v210, v196, v197
    v_cvt_pk_bf16_f32 v211, v198, v199
    v_cvt_pk_bf16_f32 v212, v200, v201
    v_cvt_pk_bf16_f32 v213, v202, v203
    v_cvt_pk_bf16_f32 v214, v204, v205
    v_cvt_pk_bf16_f32 v215, v206, v207
    v_mul_f32 v64, v64, v220
    v_mul_f32 v65, v65, v220
    v_mul_f32 v66, v66, v220
    v_mul_f32 v67, v67, v220
    v_mul_f32 v68, v68, v220
    v_mul_f32 v69, v69, v220
    v_mul_f32 v70, v70, v220
    v_mul_f32 v71, v71, v220
    v_mul_f32 v72, v72, v220
    v_mul_f32 v73, v73, v220
    v_mul_f32 v74, v74, v220
    v_mul_f32 v75, v75, v220
    v_mul_f32 v76, v76, v220
    v_mul_f32 v77, v77, v220
    v_mul_f32 v78, v78, v220
    v_mul_f32 v79, v79, v220
    s_waitcnt lgkmcnt(0)
    s_barrier
    v_mfma_f32_32x32x16_bf16 v[64:79], a[64:67], v[208:211], v[64:79]
    ds_read_b128 v[144:147], v29 offset:16384
    v_mul_f32 v80, v80, v220
    v_mul_f32 v81, v81, v220
    ds_read_b128 v[148:151], v29 offset:17408
    s_waitcnt vmcnt(42)
    ds_write_b128 v26, a[224:227] offset:16384
    buffer_load_dwordx4 a[204:207], v48, s[36:39], s99 offen offset:3456 nt
    s_add_u32 s99, s99, 4608
    v_mul_f32 v82, v82, v220
    v_mul_f32 v83, v83, v220
    ds_read_b128 v[152:155], v29 offset:18432
    v_mul_f32 v84, v84, v220
    v_mfma_f32_32x32x16_bf16 v[64:79], a[68:71], v[212:215], v[64:79]
    v_mul_f32 v85, v85, v220
    ds_read_b128 v[156:159], v29 offset:19456
    v_mul_f32 v86, v86, v220
    s_waitcnt vmcnt(42)
    ds_write_b128 v26, a[228:231] offset:17408
    v_mul_f32 v87, v87, v220
    v_mul_f32 v88, v88, v220
    v_mul_f32 v89, v89, v220
    v_mul_f32 v90, v90, v220
    v_mul_f32 v91, v91, v220
    v_mul_f32 v92, v92, v220
    v_mul_f32 v93, v93, v220
    v_mul_f32 v94, v94, v220
    v_mul_f32 v95, v95, v220
    s_nop 1
    v_mfma_f32_32x32x16_bf16 v[80:95], a[72:75], v[208:211], v[80:95]
    ds_read_b128 v[160:163], v30 offset:16384
    v_mul_f32 v96, v96, v220
    v_mul_f32 v97, v97, v220
    ds_read_b128 v[164:167], v30 offset:17408
    s_waitcnt vmcnt(41)
    ds_write_b128 v26, a[232:235] offset:18432
    buffer_load_dwordx4 a[208:211], v48, s[36:39], s99 offen offset:0 nt
    v_mul_f32 v98, v98, v220
    v_mul_f32 v99, v99, v220
    ds_read_b128 v[168:171], v30 offset:18432
    v_mul_f32 v100, v100, v220
    v_mfma_f32_32x32x16_bf16 v[80:95], a[76:79], v[212:215], v[80:95]
    v_mul_f32 v101, v101, v220
    ds_read_b128 v[172:175], v30 offset:19456
    v_mul_f32 v102, v102, v220
    s_waitcnt vmcnt(41)
    ds_write_b128 v26, a[236:239] offset:19456
    v_mul_f32 v103, v103, v220
    v_mul_f32 v104, v104, v220
    v_mul_f32 v105, v105, v220
    v_mul_f32 v106, v106, v220
    v_mul_f32 v107, v107, v220
    v_mul_f32 v108, v108, v220
    v_mul_f32 v109, v109, v220
    v_mul_f32 v110, v110, v220
    v_mul_f32 v111, v111, v220
    s_nop 1
    v_mfma_f32_32x32x16_bf16 v[96:111], a[80:83], v[208:211], v[96:111]
    ds_read_b128 v[176:179], v31 offset:16384
    v_mul_f32 v112, v112, v220
    v_mul_f32 v113, v113, v220
    ds_read_b128 v[180:183], v31 offset:17408
    s_waitcnt vmcnt(40)
    ds_write_b128 v26, a[240:243] offset:20480
    v_mul_f32 v114, v114, v220
    v_mul_f32 v115, v115, v220
    ds_read_b128 v[184:187], v31 offset:18432
    v_mul_f32 v116, v116, v220
    v_mfma_f32_32x32x16_bf16 v[96:111], a[84:87], v[212:215], v[96:111]
    v_mul_f32 v117, v117, v220
    ds_read_b128 v[188:191], v31 offset:19456
    v_mul_f32 v118, v118, v220
    s_waitcnt vmcnt(39)
    ds_write_b128 v26, a[244:247] offset:21504
    buffer_load_dwordx4 a[212:215], v48, s[36:39], s99 offen offset:1152 nt
    v_mul_f32 v119, v119, v220
    v_mul_f32 v120, v120, v220
    v_mul_f32 v121, v121, v220
    v_mul_f32 v122, v122, v220
    v_mul_f32 v123, v123, v220
    v_mul_f32 v124, v124, v220
    v_mul_f32 v125, v125, v220
    v_mul_f32 v126, v126, v220
    v_mul_f32 v127, v127, v220
    s_nop 1
    v_mfma_f32_32x32x16_bf16 v[112:127], a[88:91], v[208:211], v[112:127]
    v_add_f32 v192, v192, v200
    v_add_f32 v193, v193, v201
    v_add_f32 v194, v194, v202
    v_add_f32 v195, v195, v203
    s_waitcnt vmcnt(39)
    ds_write_b128 v26, a[248:251] offset:22528
    v_add_f32 v196, v196, v204
    v_add_f32 v197, v197, v205
    v_add_f32 v198, v198, v206
    v_add_f32 v199, v199, v207
    v_mfma_f32_32x32x16_bf16 v[112:127], a[92:95], v[212:215], v[112:127]
    v_add_f32 v192, v192, v196
    v_add_f32 v193, v193, v197
    v_add_f32 v194, v194, v198
    s_waitcnt vmcnt(38)
    ds_write_b128 v26, a[252:255] offset:23552
    v_add_f32 v195, v195, v199
    v_add_f32 v192, v192, v193
    v_add_f32 v194, v194, v195
    v_add_f32 v192, v192, v194
    v_add_f32 v217, v217, v192
    ds_read_b128 a[32:35], v32 offset:16384
    ds_read_b128 a[36:39], v33 offset:16384
    ds_read_b128 a[40:43], v34 offset:16384
    ds_read_b128 a[44:47], v35 offset:16384
    ds_read_b128 a[48:51], v36 offset:16384
    ds_read_b128 a[52:55], v37 offset:16384
    ds_read_b128 a[56:59], v38 offset:16384
    ds_read_b128 a[60:63], v39 offset:16384
    s_waitcnt lgkmcnt(8)
    v_add_f32 v144, v144, v128
    v_add_f32 v145, v145, v129
    v_add_f32 v146, v146, v130
    v_add_f32 v147, v147, v131
    buffer_load_dwordx4 a[216:219], v48, s[36:39], s99 offen offset:2304 nt
    v_add_f32 v148, v148, v132
    v_add_f32 v149, v149, v133
    v_add_f32 v150, v150, v134
    v_add_f32 v151, v151, v135
    v_add_f32 v152, v152, v136
    v_add_f32 v153, v153, v137
    v_add_f32 v154, v154, v138
    v_add_f32 v155, v155, v139
    v_add_f32 v156, v156, v140
    v_add_f32 v157, v157, v141
    v_add_f32 v158, v158, v142
    v_add_f32 v159, v159, v143
    s_waitcnt lgkmcnt(0)
    v_mfma_f32_32x32x16_bf16 v[128:143], a[32:35], a[0:3], 0
    ds_read_b64_tr_b16 a[64:65], v40 offset:8192
    ds_read_b64_tr_b16 a[66:67], v41 offset:10240
    v_add_f32 v160, v160, v176
    v_add_f32 v161, v161, v177
    v_add_f32 v162, v162, v178
    v_add_f32 v163, v163, v179
    v_add_f32 v164, v164, v180
    v_mfma_f32_32x32x16_bf16 v[128:143], a[36:39], a[4:7], v[128:143]
    ds_read_b64_tr_b16 a[72:73], v42 offset:8192
    ds_read_b64_tr_b16 a[74:75], v43 offset:10240
    v_add_f32 v165, v165, v181
    v_add_f32 v166, v166, v182
    v_add_f32 v167, v167, v183
    v_add_f32 v168, v168, v184
    v_add_f32 v169, v169, v185
    v_mfma_f32_32x32x16_bf16 v[128:143], a[40:43], a[8:11], v[128:143]
    ds_read_b64_tr_b16 a[80:81], v44 offset:8192
    ds_read_b64_tr_b16 a[82:83], v45 offset:10240
    v_add_f32 v170, v170, v186
    v_add_f32 v171, v171, v187
    v_add_f32 v172, v172, v188
    v_add_f32 v173, v173, v189
    v_add_f32 v174, v174, v190
    v_mfma_f32_32x32x16_bf16 v[128:143], a[44:47], a[12:15], v[128:143]
    ds_read_b64_tr_b16 a[88:89], v46 offset:8192
    ds_read_b64_tr_b16 a[90:91], v47 offset:10240
    v_add_f32 v175, v175, v191
    v_add_f32 v144, v144, v160
    v_add_f32 v145, v145, v161
    v_add_f32 v146, v146, v162
    v_add_f32 v147, v147, v163
    v_mfma_f32_32x32x16_bf16 v[128:143], a[48:51], a[16:19], v[128:143]
    ds_read_b64_tr_b16 a[68:69], v40 offset:12288
    ds_read_b64_tr_b16 a[70:71], v41 offset:14336
    v_add_f32 v148, v148, v164
    v_add_f32 v149, v149, v165
    v_add_f32 v150, v150, v166
    v_add_f32 v151, v151, v167
    v_add_f32 v152, v152, v168
    v_mfma_f32_32x32x16_bf16 v[128:143], a[52:55], a[20:23], v[128:143]
    ds_read_b64_tr_b16 a[76:77], v42 offset:12288
    ds_read_b64_tr_b16 a[78:79], v43 offset:14336
    v_add_f32 v153, v153, v169
    v_add_f32 v154, v154, v170
    v_add_f32 v155, v155, v171
    v_add_f32 v156, v156, v172
    v_add_f32 v157, v157, v173
    v_mfma_f32_32x32x16_bf16 v[128:143], a[56:59], a[24:27], v[128:143]
    ds_read_b64_tr_b16 a[84:85], v44 offset:12288
    ds_read_b64_tr_b16 a[86:87], v45 offset:14336
    v_add_f32 v158, v158, v174
    v_add_f32 v159, v159, v175
    v_max3_f32 v218, v144, v145, v146
    v_max3_f32 v219, v147, v148, v149
    v_max3_f32 v220, v150, v151, v152
    v_mfma_f32_32x32x16_bf16 v[128:143], a[60:63], a[28:31], v[128:143]
    ds_read_b64_tr_b16 a[92:93], v46 offset:12288
    ds_read_b64_tr_b16 a[94:95], v47 offset:14336
    v_max3_f32 v221, v153, v154, v155
    v_max3_f32 v218, v218, v156, v157
    v_max3_f32 v219, v219, v158, v159
    v_max3_f32 v218, v218, v219, v220
    v_max_f32 v218, v218, v221
    v_mov_b32 v219, v218
    s_nop 1
    v_permlane32_swap_b32 v218, v219
    v_max3_f32 v218, v218, v219, v216
    v_sub_f32 v220, v216, v218
    v_mov_b32 v216, v218
    v_exp_f32 v220, v220
    v_sub_f32 v192, v144, v218
    v_sub_f32 v193, v145, v218
    v_sub_f32 v194, v146, v218
    v_sub_f32 v195, v147, v218
    v_sub_f32 v196, v148, v218
    v_sub_f32 v197, v149, v218
    v_sub_f32 v198, v150, v218
    v_sub_f32 v199, v151, v218
    v_sub_f32 v200, v152, v218
    v_sub_f32 v201, v153, v218
    v_sub_f32 v202, v154, v218
    v_sub_f32 v203, v155, v218
    v_sub_f32 v204, v156, v218
    v_sub_f32 v205, v157, v218
    v_sub_f32 v206, v158, v218
    v_sub_f32 v207, v159, v218
    ds_write_b128 v28, v[128:131] offset:0
    v_exp_f32 v192, v192
    v_exp_f32 v193, v193
    v_exp_f32 v194, v194
    v_exp_f32 v195, v195
    ds_write_b128 v28, v[132:135] offset:1024
    v_exp_f32 v196, v196
    v_exp_f32 v197, v197
    v_exp_f32 v198, v198
    v_exp_f32 v199, v199
    ds_write_b128 v28, v[136:139] offset:2048
    v_exp_f32 v200, v200
    v_exp_f32 v201, v201
    v_exp_f32 v202, v202
    v_exp_f32 v203, v203
    ds_write_b128 v28, v[140:143] offset:3072
    v_exp_f32 v204, v204
    v_exp_f32 v205, v205
    v_exp_f32 v206, v206
    v_exp_f32 v207, v207
    v_mul_f32 v217, v217, v220
    v_cvt_pk_bf16_f32 v208, v192, v193
    v_cvt_pk_bf16_f32 v209, v194, v195
    v_cvt_pk_bf16_f32 v210, v196, v197
    v_cvt_pk_bf16_f32 v211, v198, v199
    v_cvt_pk_bf16_f32 v212, v200, v201
    v_cvt_pk_bf16_f32 v213, v202, v203
    v_cvt_pk_bf16_f32 v214, v204, v205
    v_cvt_pk_bf16_f32 v215, v206, v207
    v_mul_f32 v64, v64, v220
    v_mul_f32 v65, v65, v220
    v_mul_f32 v66, v66, v220
    v_mul_f32 v67, v67, v220
    v_mul_f32 v68, v68, v220
    v_mul_f32 v69, v69, v220
    v_mul_f32 v70, v70, v220
    v_mul_f32 v71, v71, v220
    v_mul_f32 v72, v72, v220
    v_mul_f32 v73, v73, v220
    v_mul_f32 v74, v74, v220
    v_mul_f32 v75, v75, v220
    v_mul_f32 v76, v76, v220
    v_mul_f32 v77, v77, v220
    v_mul_f32 v78, v78, v220
    v_mul_f32 v79, v79, v220
    s_waitcnt lgkmcnt(0)
    s_barrier
    v_mfma_f32_32x32x16_bf16 v[64:79], a[64:67], v[208:211], v[64:79]
    ds_read_b128 v[144:147], v29 offset:0
    v_mul_f32 v80, v80, v220
    v_mul_f32 v81, v81, v220
    ds_read_b128 v[148:151], v29 offset:1024
    s_waitcnt vmcnt(38)
    ds_write_b128 v26, v[224:227] offset:24576
    buffer_load_dwordx4 a[220:223], v48, s[36:39], s99 offen offset:3456 nt
    s_add_u32 s99, s99, 32256
    v_mul_f32 v82, v82, v220
    v_mul_f32 v83, v83, v220
    ds_read_b128 v[152:155], v29 offset:2048
    v_mul_f32 v84, v84, v220
    v_mfma_f32_32x32x16_bf16 v[64:79], a[68:71], v[212:215], v[64:79]
    v_mul_f32 v85, v85, v220
    ds_read_b128 v[156:159], v29 offset:3072
    v_mul_f32 v86, v86, v220
    s_waitcnt vmcnt(38)
    ds_write_b128 v26, v[228:231] offset:25600
    v_mul_f32 v87, v87, v220
    v_mul_f32 v88, v88, v220
    v_mul_f32 v89, v89, v220
    v_mul_f32 v90, v90, v220
    v_mul_f32 v91, v91, v220
    v_mul_f32 v92, v92, v220
    v_mul_f32 v93, v93, v220
    v_mul_f32 v94, v94, v220
    v_mul_f32 v95, v95, v220
    s_nop 1
    v_mfma_f32_32x32x16_bf16 v[80:95], a[72:75], v[208:211], v[80:95]
    ds_read_b128 v[160:163], v30 offset:0
    v_mul_f32 v96, v96, v220
    v_mul_f32 v97, v97, v220
    ds_read_b128 v[164:167], v30 offset:1024
    s_waitcnt vmcnt(37)
    ds_write_b128 v26, v[232:235] offset:26624
    v_mul_f32 v98, v98, v220
    v_mul_f32 v99, v99, v220
    ds_read_b128 v[168:171], v30 offset:2048
    v_mul_f32 v100, v100, v220
    v_mfma_f32_32x32x16_bf16 v[80:95], a[76:79], v[212:215], v[80:95]
    v_mul_f32 v101, v101, v220
    ds_read_b128 v[172:175], v30 offset:3072
    v_mul_f32 v102, v102, v220
    s_waitcnt vmcnt(36)
    ds_write_b128 v26, v[236:239] offset:27648
    v_mul_f32 v103, v103, v220
    v_mul_f32 v104, v104, v220
    v_mul_f32 v105, v105, v220
    v_mul_f32 v106, v106, v220
    v_mul_f32 v107, v107, v220
    v_mul_f32 v108, v108, v220
    v_mul_f32 v109, v109, v220
    v_mul_f32 v110, v110, v220
    v_mul_f32 v111, v111, v220
    s_nop 1
    v_mfma_f32_32x32x16_bf16 v[96:111], a[80:83], v[208:211], v[96:111]
    ds_read_b128 v[176:179], v31 offset:0
    v_mul_f32 v112, v112, v220
    v_mul_f32 v113, v113, v220
    ds_read_b128 v[180:183], v31 offset:1024
    s_waitcnt vmcnt(35)
    ds_write_b128 v26, v[240:243] offset:28672
    v_mul_f32 v114, v114, v220
    v_mul_f32 v115, v115, v220
    ds_read_b128 v[184:187], v31 offset:2048
    v_mul_f32 v116, v116, v220
    v_mfma_f32_32x32x16_bf16 v[96:111], a[84:87], v[212:215], v[96:111]
    v_mul_f32 v117, v117, v220
    ds_read_b128 v[188:191], v31 offset:3072
    v_mul_f32 v118, v118, v220
    s_waitcnt vmcnt(34)
    ds_write_b128 v26, v[244:247] offset:29696
    v_mul_f32 v119, v119, v220
    v_mul_f32 v120, v120, v220
    v_mul_f32 v121, v121, v220
    v_mul_f32 v122, v122, v220
    v_mul_f32 v123, v123, v220
    v_mul_f32 v124, v124, v220
    v_mul_f32 v125, v125, v220
    v_mul_f32 v126, v126, v220
    v_mul_f32 v127, v127, v220
    s_nop 1
    v_mfma_f32_32x32x16_bf16 v[112:127], a[88:91], v[208:211], v[112:127]
    v_add_f32 v192, v192, v200
    v_add_f32 v193, v193, v201
    v_add_f32 v194, v194, v202
    v_add_f32 v195, v195, v203
    s_waitcnt vmcnt(33)
    ds_write_b128 v26, v[248:251] offset:30720
    v_add_f32 v196, v196, v204
    v_add_f32 v197, v197, v205
    v_add_f32 v198, v198, v206
    v_add_f32 v199, v199, v207
    v_mfma_f32_32x32x16_bf16 v[112:127], a[92:95], v[212:215], v[112:127]
    v_add_f32 v192, v192, v196
    v_add_f32 v193, v193, v197
    v_add_f32 v194, v194, v198
    s_waitcnt vmcnt(32)
    ds_write_b128 v26, v[252:255] offset:31744
    v_add_f32 v195, v195, v199
    v_add_f32 v192, v192, v193
    v_add_f32 v194, v194, v195
    v_add_f32 v192, v192, v194
    v_add_f32 v217, v217, v192
    ds_read_b128 a[32:35], v32 offset:24576
    ds_read_b128 a[36:39], v33 offset:24576
    ds_read_b128 a[40:43], v34 offset:24576
    ds_read_b128 a[44:47], v35 offset:24576
    ds_read_b128 a[48:51], v36 offset:24576
    ds_read_b128 a[52:55], v37 offset:24576
    ds_read_b128 a[56:59], v38 offset:24576
    ds_read_b128 a[60:63], v39 offset:24576
    s_waitcnt lgkmcnt(8)
    v_add_f32 v144, v144, v128
    v_add_f32 v145, v145, v129
    v_add_f32 v146, v146, v130
    v_add_f32 v147, v147, v131
    v_add_f32 v148, v148, v132
    v_add_f32 v149, v149, v133
    v_add_f32 v150, v150, v134
    v_add_f32 v151, v151, v135
    v_add_f32 v152, v152, v136
    v_add_f32 v153, v153, v137
    v_add_f32 v154, v154, v138
    v_add_f32 v155, v155, v139
    v_add_f32 v156, v156, v140
    v_add_f32 v157, v157, v141
    v_add_f32 v158, v158, v142
    v_add_f32 v159, v159, v143
    s_waitcnt lgkmcnt(0)
    v_mfma_f32_32x32x16_bf16 v[128:143], a[32:35], a[0:3], 0
    ds_read_b64_tr_b16 a[64:65], v40 offset:16384
    ds_read_b64_tr_b16 a[66:67], v41 offset:18432
    v_add_f32 v160, v160, v176
    v_add_f32 v161, v161, v177
    v_add_f32 v162, v162, v178
    v_add_f32 v163, v163, v179
    v_add_f32 v164, v164, v180
    v_mfma_f32_32x32x16_bf16 v[128:143], a[36:39], a[4:7], v[128:143]
    ds_read_b64_tr_b16 a[72:73], v42 offset:16384
    ds_read_b64_tr_b16 a[74:75], v43 offset:18432
    v_add_f32 v165, v165, v181
    v_add_f32 v166, v166, v182
    v_add_f32 v167, v167, v183
    v_add_f32 v168, v168, v184
    v_add_f32 v169, v169, v185
    v_mfma_f32_32x32x16_bf16 v[128:143], a[40:43], a[8:11], v[128:143]
    ds_read_b64_tr_b16 a[80:81], v44 offset:16384
    ds_read_b64_tr_b16 a[82:83], v45 offset:18432
    v_add_f32 v170, v170, v186
    v_add_f32 v171, v171, v187
    v_add_f32 v172, v172, v188
    v_add_f32 v173, v173, v189
    v_add_f32 v174, v174, v190
    v_mfma_f32_32x32x16_bf16 v[128:143], a[44:47], a[12:15], v[128:143]
    ds_read_b64_tr_b16 a[88:89], v46 offset:16384
    ds_read_b64_tr_b16 a[90:91], v47 offset:18432
    v_add_f32 v175, v175, v191
    v_add_f32 v144, v144, v160
    v_add_f32 v145, v145, v161
    v_add_f32 v146, v146, v162
    v_add_f32 v147, v147, v163
    v_mfma_f32_32x32x16_bf16 v[128:143], a[48:51], a[16:19], v[128:143]
    ds_read_b64_tr_b16 a[68:69], v40 offset:20480
    ds_read_b64_tr_b16 a[70:71], v41 offset:22528
    v_add_f32 v148, v148, v164
    v_add_f32 v149, v149, v165
    v_add_f32 v150, v150, v166
    v_add_f32 v151, v151, v167
    v_add_f32 v152, v152, v168
    v_mfma_f32_32x32x16_bf16 v[128:143], a[52:55], a[20:23], v[128:143]
    ds_read_b64_tr_b16 a[76:77], v42 offset:20480
    ds_read_b64_tr_b16 a[78:79], v43 offset:22528
    v_add_f32 v153, v153, v169
    v_add_f32 v154, v154, v170
    v_add_f32 v155, v155, v171
    v_add_f32 v156, v156, v172
    v_add_f32 v157, v157, v173
    v_mfma_f32_32x32x16_bf16 v[128:143], a[56:59], a[24:27], v[128:143]
    ds_read_b64_tr_b16 a[84:85], v44 offset:20480
    ds_read_b64_tr_b16 a[86:87], v45 offset:22528
    v_add_f32 v158, v158, v174
    v_add_f32 v159, v159, v175
    v_max3_f32 v218, v144, v145, v146
    v_max3_f32 v219, v147, v148, v149
    v_max3_f32 v220, v150, v151, v152
    v_mfma_f32_32x32x16_bf16 v[128:143], a[60:63], a[28:31], v[128:143]
    ds_read_b64_tr_b16 a[92:93], v46 offset:20480
    ds_read_b64_tr_b16 a[94:95], v47 offset:22528
    v_max3_f32 v221, v153, v154, v155
    v_max3_f32 v218, v218, v156, v157
    v_max3_f32 v219, v219, v158, v159
    v_max3_f32 v218, v218, v219, v220
    v_max_f32 v218, v218, v221
    v_mov_b32 v219, v218
    s_nop 1
    v_permlane32_swap_b32 v218, v219
    v_max3_f32 v218, v218, v219, v216
    v_sub_f32 v220, v216, v218
    v_mov_b32 v216, v218
    v_exp_f32 v220, v220
    v_sub_f32 v192, v144, v218
    v_sub_f32 v193, v145, v218
    v_sub_f32 v194, v146, v218
    v_sub_f32 v195, v147, v218
    v_sub_f32 v196, v148, v218
    v_sub_f32 v197, v149, v218
    v_sub_f32 v198, v150, v218
    v_sub_f32 v199, v151, v218
    v_sub_f32 v200, v152, v218
    v_sub_f32 v201, v153, v218
    v_sub_f32 v202, v154, v218
    v_sub_f32 v203, v155, v218
    v_sub_f32 v204, v156, v218
    v_sub_f32 v205, v157, v218
    v_sub_f32 v206, v158, v218
    v_sub_f32 v207, v159, v218
    ds_write_b128 v28, v[128:131] offset:16384
    v_exp_f32 v192, v192
    v_exp_f32 v193, v193
    v_exp_f32 v194, v194
    v_exp_f32 v195, v195
    ds_write_b128 v28, v[132:135] offset:17408
    v_exp_f32 v196, v196
    v_exp_f32 v197, v197
    v_exp_f32 v198, v198
    v_exp_f32 v199, v199
    ds_write_b128 v28, v[136:139] offset:18432
    v_exp_f32 v200, v200
    v_exp_f32 v201, v201
    v_exp_f32 v202, v202
    v_exp_f32 v203, v203
    ds_write_b128 v28, v[140:143] offset:19456
    v_exp_f32 v204, v204
    v_exp_f32 v205, v205
    v_exp_f32 v206, v206
    v_exp_f32 v207, v207
    v_mul_f32 v217, v217, v220
    v_cvt_pk_bf16_f32 v208, v192, v193
    v_cvt_pk_bf16_f32 v209, v194, v195
    v_cvt_pk_bf16_f32 v210, v196, v197
    v_cvt_pk_bf16_f32 v211, v198, v199
    v_cvt_pk_bf16_f32 v212, v200, v201
    v_cvt_pk_bf16_f32 v213, v202, v203
    v_cvt_pk_bf16_f32 v214, v204, v205
    v_cvt_pk_bf16_f32 v215, v206, v207
    v_mul_f32 v64, v64, v220
    v_mul_f32 v65, v65, v220
    v_mul_f32 v66, v66, v220
    v_mul_f32 v67, v67, v220
    v_mul_f32 v68, v68, v220
    v_mul_f32 v69, v69, v220
    v_mul_f32 v70, v70, v220
    v_mul_f32 v71, v71, v220
    v_mul_f32 v72, v72, v220
    v_mul_f32 v73, v73, v220
    v_mul_f32 v74, v74, v220
    v_mul_f32 v75, v75, v220
    v_mul_f32 v76, v76, v220
    v_mul_f32 v77, v77, v220
    v_mul_f32 v78, v78, v220
    v_mul_f32 v79, v79, v220
    s_waitcnt lgkmcnt(0)
    s_barrier
    v_mfma_f32_32x32x16_bf16 v[64:79], a[64:67], v[208:211], v[64:79]
    ds_read_b128 v[144:147], v29 offset:16384
    v_mul_f32 v80, v80, v220
    v_mul_f32 v81, v81, v220
    ds_read_b128 v[148:151], v29 offset:17408
    v_mul_f32 v82, v82, v220
    v_mul_f32 v83, v83, v220
    ds_read_b128 v[152:155], v29 offset:18432
    v_mul_f32 v84, v84, v220
    v_mfma_f32_32x32x16_bf16 v[64:79], a[68:71], v[212:215], v[64:79]
    v_mul_f32 v85, v85, v220
    ds_read_b128 v[156:159], v29 offset:19456
    v_mul_f32 v86, v86, v220
    v_mul_f32 v87, v87, v220
    v_mul_f32 v88, v88, v220
    v_mul_f32 v89, v89, v220
    v_mul_f32 v90, v90, v220
    v_mul_f32 v91, v91, v220
    v_mul_f32 v92, v92, v220
    v_mul_f32 v93, v93, v220
    v_mul_f32 v94, v94, v220
    v_mul_f32 v95, v95, v220
    s_nop 1
    v_mfma_f32_32x32x16_bf16 v[80:95], a[72:75], v[208:211], v[80:95]
    ds_read_b128 v[160:163], v30 offset:16384
    v_mul_f32 v96, v96, v220
    v_mul_f32 v97, v97, v220
    ds_read_b128 v[164:167], v30 offset:17408
    v_mul_f32 v98, v98, v220
    v_mul_f32 v99, v99, v220
    ds_read_b128 v[168:171], v30 offset:18432
    v_mul_f32 v100, v100, v220
    v_mfma_f32_32x32x16_bf16 v[80:95], a[76:79], v[212:215], v[80:95]
    v_mul_f32 v101, v101, v220
    ds_read_b128 v[172:175], v30 offset:19456
    v_mul_f32 v102, v102, v220
    v_mul_f32 v103, v103, v220
    v_mul_f32 v104, v104, v220
    v_mul_f32 v105, v105, v220
    v_mul_f32 v106, v106, v220
    v_mul_f32 v107, v107, v220
    v_mul_f32 v108, v108, v220
    v_mul_f32 v109, v109, v220
    v_mul_f32 v110, v110, v220
    v_mul_f32 v111, v111, v220
    s_nop 1
    v_mfma_f32_32x32x16_bf16 v[96:111], a[80:83], v[208:211], v[96:111]
    ds_read_b128 v[176:179], v31 offset:16384
    v_mul_f32 v112, v112, v220
    v_mul_f32 v113, v113, v220
    ds_read_b128 v[180:183], v31 offset:17408
    v_mul_f32 v114, v114, v220
    v_mul_f32 v115, v115, v220
    ds_read_b128 v[184:187], v31 offset:18432
    v_mul_f32 v116, v116, v220
    v_mfma_f32_32x32x16_bf16 v[96:111], a[84:87], v[212:215], v[96:111]
    v_mul_f32 v117, v117, v220
    ds_read_b128 v[188:191], v31 offset:19456
    v_mul_f32 v118, v118, v220
    v_mul_f32 v119, v119, v220
    v_mul_f32 v120, v120, v220
    v_mul_f32 v121, v121, v220
    v_mul_f32 v122, v122, v220
    v_mul_f32 v123, v123, v220
    v_mul_f32 v124, v124, v220
    v_mul_f32 v125, v125, v220
    v_mul_f32 v126, v126, v220
    v_mul_f32 v127, v127, v220
    s_nop 1
    v_mfma_f32_32x32x16_bf16 v[112:127], a[88:91], v[208:211], v[112:127]
    v_add_f32 v192, v192, v200
    v_add_f32 v193, v193, v201
    v_add_f32 v194, v194, v202
    v_add_f32 v195, v195, v203
    v_add_f32 v196, v196, v204
    v_add_f32 v197, v197, v205
    v_add_f32 v198, v198, v206
    v_add_f32 v199, v199, v207
    v_mfma_f32_32x32x16_bf16 v[112:127], a[92:95], v[212:215], v[112:127]
    v_add_f32 v192, v192, v196
    v_add_f32 v193, v193, v197
    v_add_f32 v194, v194, v198
    v_add_f32 v195, v195, v199
    v_add_f32 v192, v192, v193
    v_add_f32 v194, v194, v195
    v_add_f32 v192, v192, v194
    v_add_f32 v217, v217, v192
    s_waitcnt lgkmcnt(0)
    v_add_f32 v144, v144, v128
    v_add_f32 v145, v145, v129
    v_add_f32 v146, v146, v130
    v_add_f32 v147, v147, v131
    v_add_f32 v148, v148, v132
    v_add_f32 v149, v149, v133
    v_add_f32 v150, v150, v134
    v_add_f32 v151, v151, v135
    v_add_f32 v152, v152, v136
    v_add_f32 v153, v153, v137
    v_add_f32 v154, v154, v138
    v_add_f32 v155, v155, v139
    v_add_f32 v156, v156, v140
    v_add_f32 v157, v157, v141
    v_add_f32 v158, v158, v142
    v_add_f32 v159, v159, v143
    s_waitcnt lgkmcnt(0)
    ds_read_b64_tr_b16 a[64:65], v40 offset:24576
    ds_read_b64_tr_b16 a[66:67], v41 offset:26624
    v_add_f32 v160, v160, v176
    v_add_f32 v161, v161, v177
    v_add_f32 v162, v162, v178
    v_add_f32 v163, v163, v179
    v_add_f32 v164, v164, v180
    ds_read_b64_tr_b16 a[72:73], v42 offset:24576
    ds_read_b64_tr_b16 a[74:75], v43 offset:26624
    v_add_f32 v165, v165, v181
    v_add_f32 v166, v166, v182
    v_add_f32 v167, v167, v183
    v_add_f32 v168, v168, v184
    v_add_f32 v169, v169, v185
    ds_read_b64_tr_b16 a[80:81], v44 offset:24576
    ds_read_b64_tr_b16 a[82:83], v45 offset:26624
    v_add_f32 v170, v170, v186
    v_add_f32 v171, v171, v187
    v_add_f32 v172, v172, v188
    v_add_f32 v173, v173, v189
    v_add_f32 v174, v174, v190
    ds_read_b64_tr_b16 a[88:89], v46 offset:24576
    ds_read_b64_tr_b16 a[90:91], v47 offset:26624
    v_add_f32 v175, v175, v191
    v_add_f32 v144, v144, v160
    v_add_f32 v145, v145, v161
    v_add_f32 v146, v146, v162
    v_add_f32 v147, v147, v163
    ds_read_b64_tr_b16 a[68:69], v40 offset:28672
    ds_read_b64_tr_b16 a[70:71], v41 offset:30720
    v_add_f32 v148, v148, v164
    v_add_f32 v149, v149, v165
    v_add_f32 v150, v150, v166
    v_add_f32 v151, v151, v167
    v_add_f32 v152, v152, v168
    ds_read_b64_tr_b16 a[76:77], v42 offset:28672
    ds_read_b64_tr_b16 a[78:79], v43 offset:30720
    v_add_f32 v153, v153, v169
    v_add_f32 v154, v154, v170
    v_add_f32 v155, v155, v171
    v_add_f32 v156, v156, v172
    v_add_f32 v157, v157, v173
    ds_read_b64_tr_b16 a[84:85], v44 offset:28672
    ds_read_b64_tr_b16 a[86:87], v45 offset:30720
    v_add_f32 v158, v158, v174
    v_add_f32 v159, v159, v175
    v_max3_f32 v218, v144, v145, v146
    v_max3_f32 v219, v147, v148, v149
    v_max3_f32 v220, v150, v151, v152
    ds_read_b64_tr_b16 a[92:93], v46 offset:28672
    ds_read_b64_tr_b16 a[94:95], v47 offset:30720
    v_max3_f32 v221, v153, v154, v155
    v_max3_f32 v218, v218, v156, v157
    v_max3_f32 v219, v219, v158, v159
    v_max3_f32 v218, v218, v219, v220
    v_max_f32 v218, v218, v221
    v_mov_b32 v219, v218
    s_nop 1
    v_permlane32_swap_b32 v218, v219
    v_max3_f32 v218, v218, v219, v216
    v_sub_f32 v220, v216, v218
    v_mov_b32 v216, v218
    v_exp_f32 v220, v220
    v_sub_f32 v192, v144, v218
    v_sub_f32 v193, v145, v218
    v_sub_f32 v194, v146, v218
    v_sub_f32 v195, v147, v218
    v_sub_f32 v196, v148, v218
    v_sub_f32 v197, v149, v218
    v_sub_f32 v198, v150, v218
    v_sub_f32 v199, v151, v218
    v_sub_f32 v200, v152, v218
    v_sub_f32 v201, v153, v218
    v_sub_f32 v202, v154, v218
    v_sub_f32 v203, v155, v218
    v_sub_f32 v204, v156, v218
    v_sub_f32 v205, v157, v218
    v_sub_f32 v206, v158, v218
    v_sub_f32 v207, v159, v218
    v_exp_f32 v192, v192
    v_exp_f32 v193, v193
    v_exp_f32 v194, v194
    v_exp_f32 v195, v195
    v_exp_f32 v196, v196
    v_exp_f32 v197, v197
    v_exp_f32 v198, v198
    v_exp_f32 v199, v199
    v_exp_f32 v200, v200
    v_exp_f32 v201, v201
    v_exp_f32 v202, v202
    v_exp_f32 v203, v203
    v_exp_f32 v204, v204
    v_exp_f32 v205, v205
    v_exp_f32 v206, v206
    v_exp_f32 v207, v207
    v_mul_f32 v217, v217, v220
    v_cvt_pk_bf16_f32 v208, v192, v193
    v_cvt_pk_bf16_f32 v209, v194, v195
    v_cvt_pk_bf16_f32 v210, v196, v197
    v_cvt_pk_bf16_f32 v211, v198, v199
    v_cvt_pk_bf16_f32 v212, v200, v201
    v_cvt_pk_bf16_f32 v213, v202, v203
    v_cvt_pk_bf16_f32 v214, v204, v205
    v_cvt_pk_bf16_f32 v215, v206, v207
    v_mul_f32 v64, v64, v220
    v_mul_f32 v65, v65, v220
    v_mul_f32 v66, v66, v220
    v_mul_f32 v67, v67, v220
    v_mul_f32 v68, v68, v220
    v_mul_f32 v69, v69, v220
    v_mul_f32 v70, v70, v220
    v_mul_f32 v71, v71, v220
    v_mul_f32 v72, v72, v220
    v_mul_f32 v73, v73, v220
    v_mul_f32 v74, v74, v220
    v_mul_f32 v75, v75, v220
    v_mul_f32 v76, v76, v220
    v_mul_f32 v77, v77, v220
    v_mul_f32 v78, v78, v220
    v_mul_f32 v79, v79, v220
    s_waitcnt lgkmcnt(0)
    s_nop 0
    v_mfma_f32_32x32x16_bf16 v[64:79], a[64:67], v[208:211], v[64:79]
    v_mul_f32 v80, v80, v220
    v_mul_f32 v81, v81, v220
    v_mul_f32 v82, v82, v220
    v_mul_f32 v83, v83, v220
    v_mul_f32 v84, v84, v220
    v_mul_f32 v85, v85, v220
    v_mul_f32 v86, v86, v220
    v_mul_f32 v87, v87, v220
    v_mfma_f32_32x32x16_bf16 v[64:79], a[68:71], v[212:215], v[64:79]
    v_mul_f32 v88, v88, v220
    v_mul_f32 v89, v89, v220
    v_mul_f32 v90, v90, v220
    v_mul_f32 v91, v91, v220
    v_mul_f32 v92, v92, v220
    v_mul_f32 v93, v93, v220
    v_mul_f32 v94, v94, v220
    v_mul_f32 v95, v95, v220
    s_nop 1
    v_mfma_f32_32x32x16_bf16 v[80:95], a[72:75], v[208:211], v[80:95]
    v_mul_f32 v96, v96, v220
    v_mul_f32 v97, v97, v220
    v_mul_f32 v98, v98, v220
    v_mul_f32 v99, v99, v220
    v_mul_f32 v100, v100, v220
    v_mul_f32 v101, v101, v220
    v_mul_f32 v102, v102, v220
    v_mul_f32 v103, v103, v220
    v_mfma_f32_32x32x16_bf16 v[80:95], a[76:79], v[212:215], v[80:95]
    v_mul_f32 v104, v104, v220
    v_mul_f32 v105, v105, v220
    v_mul_f32 v106, v106, v220
    v_mul_f32 v107, v107, v220
    v_mul_f32 v108, v108, v220
    v_mul_f32 v109, v109, v220
    v_mul_f32 v110, v110, v220
    v_mul_f32 v111, v111, v220
    s_nop 1
    v_mfma_f32_32x32x16_bf16 v[96:111], a[80:83], v[208:211], v[96:111]
    v_mul_f32 v112, v112, v220
    v_mul_f32 v113, v113, v220
    v_mul_f32 v114, v114, v220
    v_mul_f32 v115, v115, v220
    v_mul_f32 v116, v116, v220
    v_mul_f32 v117, v117, v220
    v_mul_f32 v118, v118, v220
    v_mul_f32 v119, v119, v220
    v_mfma_f32_32x32x16_bf16 v[96:111], a[84:87], v[212:215], v[96:111]
    v_mul_f32 v120, v120, v220
    v_mul_f32 v121, v121, v220
    v_mul_f32 v122, v122, v220
    v_mul_f32 v123, v123, v220
    v_mul_f32 v124, v124, v220
    v_mul_f32 v125, v125, v220
    v_mul_f32 v126, v126, v220
    v_mul_f32 v127, v127, v220
    s_nop 1
    v_mfma_f32_32x32x16_bf16 v[112:127], a[88:91], v[208:211], v[112:127]
    v_add_f32 v192, v192, v200
    v_add_f32 v193, v193, v201
    v_add_f32 v194, v194, v202
    v_add_f32 v195, v195, v203
    v_add_f32 v196, v196, v204
    v_add_f32 v197, v197, v205
    v_add_f32 v198, v198, v206
    v_add_f32 v199, v199, v207
    v_mfma_f32_32x32x16_bf16 v[112:127], a[92:95], v[212:215], v[112:127]
    v_add_f32 v192, v192, v196
    v_add_f32 v193, v193, v197
    v_add_f32 v194, v194, v198
    v_add_f32 v195, v195, v199
    v_add_f32 v192, v192, v193
    v_add_f32 v194, v194, v195
    v_add_f32 v192, v192, v194
    v_add_f32 v217, v217, v192
    s_waitcnt lgkmcnt(0)
    v_mov_b32 v219, v217
    s_nop 1
    v_permlane32_swap_b32 v217, v219
    v_add_f32 v217, v217, v219
    v_rcp_f32 v220, v217
    v_mul_u32_u24 v5, 272, v24
    v_lshl_add_u32 v5, v25, 3, v5
    v_add_u32 v5, s63, v5
    v_mul_f32 v64, v64, v220
    v_mul_f32 v65, v65, v220
    v_mul_f32 v66, v66, v220
    v_mul_f32 v67, v67, v220
    v_mul_f32 v68, v68, v220
    v_mul_f32 v69, v69, v220
    v_mul_f32 v70, v70, v220
    v_mul_f32 v71, v71, v220
    v_mul_f32 v72, v72, v220
    v_mul_f32 v73, v73, v220
    v_mul_f32 v74, v74, v220
    v_mul_f32 v75, v75, v220
    v_mul_f32 v76, v76, v220
    v_mul_f32 v77, v77, v220
    v_mul_f32 v78, v78, v220
    v_mul_f32 v79, v79, v220
    v_mul_f32 v80, v80, v220
    v_mul_f32 v81, v81, v220
    v_mul_f32 v82, v82, v220
    v_mul_f32 v83, v83, v220
    v_mul_f32 v84, v84, v220
    v_mul_f32 v85, v85, v220
    v_mul_f32 v86, v86, v220
    v_mul_f32 v87, v87, v220
    v_mul_f32 v88, v88, v220
    v_mul_f32 v89, v89, v220
    v_mul_f32 v90, v90, v220
    v_mul_f32 v91, v91, v220
    v_mul_f32 v92, v92, v220
    v_mul_f32 v93, v93, v220
    v_mul_f32 v94, v94, v220
    v_mul_f32 v95, v95, v220
    v_mul_f32 v96, v96, v220
    v_mul_f32 v97, v97, v220
    v_mul_f32 v98, v98, v220
    v_mul_f32 v99, v99, v220
    v_mul_f32 v100, v100, v220
    v_mul_f32 v101, v101, v220
    v_mul_f32 v102, v102, v220
    v_mul_f32 v103, v103, v220
    v_mul_f32 v104, v104, v220
    v_mul_f32 v105, v105, v220
    v_mul_f32 v106, v106, v220
    v_mul_f32 v107, v107, v220
    v_mul_f32 v108, v108, v220
    v_mul_f32 v109, v109, v220
    v_mul_f32 v110, v110, v220
    v_mul_f32 v111, v111, v220
    v_mul_f32 v112, v112, v220
    v_mul_f32 v113, v113, v220
    v_mul_f32 v114, v114, v220
    v_mul_f32 v115, v115, v220
    v_mul_f32 v116, v116, v220
    v_mul_f32 v117, v117, v220
    v_mul_f32 v118, v118, v220
    v_mul_f32 v119, v119, v220
    v_mul_f32 v120, v120, v220
    v_mul_f32 v121, v121, v220
    v_mul_f32 v122, v122, v220
    v_mul_f32 v123, v123, v220
    v_mul_f32 v124, v124, v220
    v_mul_f32 v125, v125, v220
    v_mul_f32 v126, v126, v220
    v_mul_f32 v127, v127, v220
    v_cvt_pk_bf16_f32 v128, v64, v65
    v_cvt_pk_bf16_f32 v129, v66, v67
    v_cvt_pk_bf16_f32 v130, v68, v69
    v_cvt_pk_bf16_f32 v131, v70, v71
    v_cvt_pk_bf16_f32 v132, v72, v73
    v_cvt_pk_bf16_f32 v133, v74, v75
    v_cvt_pk_bf16_f32 v134, v76, v77
    v_cvt_pk_bf16_f32 v135, v78, v79
    v_cvt_pk_bf16_f32 v136, v80, v81
    v_cvt_pk_bf16_f32 v137, v82, v83
    v_cvt_pk_bf16_f32 v138, v84, v85
    v_cvt_pk_bf16_f32 v139, v86, v87
    v_cvt_pk_bf16_f32 v140, v88, v89
    v_cvt_pk_bf16_f32 v141, v90, v91
    v_cvt_pk_bf16_f32 v142, v92, v93
    v_cvt_pk_bf16_f32 v143, v94, v95
    v_cvt_pk_bf16_f32 v144, v96, v97
    v_cvt_pk_bf16_f32 v145, v98, v99
    v_cvt_pk_bf16_f32 v146, v100, v101
    v_cvt_pk_bf16_f32 v147, v102, v103
    v_cvt_pk_bf16_f32 v148, v104, v105
    v_cvt_pk_bf16_f32 v149, v106, v107
    v_cvt_pk_bf16_f32 v150, v108, v109
    v_cvt_pk_bf16_f32 v151, v110, v111
    v_cvt_pk_bf16_f32 v152, v112, v113
    v_cvt_pk_bf16_f32 v153, v114, v115
    v_cvt_pk_bf16_f32 v154, v116, v117
    v_cvt_pk_bf16_f32 v155, v118, v119
    v_cvt_pk_bf16_f32 v156, v120, v121
    v_cvt_pk_bf16_f32 v157, v122, v123
    v_cvt_pk_bf16_f32 v158, v124, v125
    v_cvt_pk_bf16_f32 v159, v126, v127
    v_min_u32 v216, -2, v216
    v_min_u32 v217, -2, v217
    s_nop 0
    v_mov_b32_dpp v218, v216 quad_perm:[1,1,3,3] row_mask:0xf bank_mask:0xf
    v_mov_b32_dpp v219, v217 quad_perm:[1,1,3,3] row_mask:0xf bank_mask:0xf
    ds_write_b64 v5, v[128:129] offset:0
    ds_write_b64 v5, v[130:131] offset:16
    ds_write_b64 v5, v[132:133] offset:32
    ds_write_b64 v5, v[134:135] offset:48
    ds_write_b64 v5, v[136:137] offset:64
    ds_write_b64 v5, v[138:139] offset:80
    ds_write_b64 v5, v[140:141] offset:96
    ds_write_b64 v5, v[142:143] offset:112
    ds_write_b64 v5, v[144:145] offset:128
    ds_write_b64 v5, v[146:147] offset:144
    ds_write_b64 v5, v[148:149] offset:160
    ds_write_b64 v5, v[150:151] offset:176
    ds_write_b64 v5, v[152:153] offset:192
    ds_write_b64 v5, v[154:155] offset:208
    ds_write_b64 v5, v[156:157] offset:224
    ds_write_b64 v5, v[158:159] offset:240
    v_mul_u32_u24 v6, 272, v4
    v_lshl_add_u32 v6, v3, 4, v6
    v_add_u32 v6, s63, v6
    s_waitcnt lgkmcnt(0)
    ds_read_b128 v[64:67], v6 offset:0
    ds_read_b128 v[68:71], v6 offset:1088
    ds_read_b128 v[72:75], v6 offset:2176
    ds_read_b128 v[76:79], v6 offset:3264
    ds_read_b128 v[80:83], v6 offset:4352
    ds_read_b128 v[84:87], v6 offset:5440
    ds_read_b128 v[88:91], v6 offset:6528
    ds_read_b128 v[92:95], v6 offset:7616
    v_lshlrev_b32 v7, 10, v4
    v_lshl_add_u32 v7, v3, 4, v7
    s_lshl_b32 s54, s53, 15
    s_lshl_b32 s55, s3, 8
    s_add_u32 s54, s54, s55
    s_add_u32 s54, s54, 2097152
    s_waitcnt lgkmcnt(7)
    buffer_store_dwordx4 v[64:67], v7, s[44:47], s54 offen sc1
    s_add_u32 s54, s54, 4096
    s_waitcnt lgkmcnt(6)
    buffer_store_dwordx4 v[68:71], v7, s[44:47], s54 offen sc1
    s_add_u32 s54, s54, 4096
    s_waitcnt lgkmcnt(5)
    buffer_store_dwordx4 v[72:75], v7, s[44:47], s54 offen sc1
    s_add_u32 s54, s54, 4096
    s_waitcnt lgkmcnt(4)
    buffer_store_dwordx4 v[76:79], v7, s[44:47], s54 offen sc1
    s_add_u32 s54, s54, 4096
    s_waitcnt lgkmcnt(3)
    buffer_store_dwordx4 v[80:83], v7, s[44:47], s54 offen sc1
    s_add_u32 s54, s54, 4096
    s_waitcnt lgkmcnt(2)
    buffer_store_dwordx4 v[84:87], v7, s[44:47], s54 offen sc1
    s_add_u32 s54, s54, 4096
    s_waitcnt lgkmcnt(1)
    buffer_store_dwordx4 v[88:91], v7, s[44:47], s54 offen sc1
    s_add_u32 s54, s54, 4096
    s_waitcnt lgkmcnt(0)
    buffer_store_dwordx4 v[92:95], v7, s[44:47], s54 offen sc1
    s_add_u32 s54, s54, 4096
    buffer_load_dword a224, v49, s[36:39], s100 offen offset:0 nt
    buffer_load_dword a225, v49, s[36:39], s100 offen offset:1152 nt
    buffer_load_dword a226, v49, s[36:39], s100 offen offset:2304 nt
    buffer_load_dword a227, v49, s[36:39], s100 offen offset:3456 nt
    s_add_u32 s100, s100, 4608
    buffer_load_dword a228, v49, s[36:39], s100 offen offset:0 nt
    buffer_load_dword a229, v49, s[36:39], s100 offen offset:1152 nt
    buffer_load_dword a230, v49, s[36:39], s100 offen offset:2304 nt
    buffer_load_dword a231, v49, s[36:39], s100 offen offset:3456 nt
    s_add_u32 s100, s100, 32256
    v_lshlrev_b32 v5, 3, v1
    s_lshl_b32 s54, s53, 8
    s_add_u32 s54, s54, 3145728
    s_cmp_eq_u32 s3, 0
    s_cselect_b32 s56, 0x55555555, 0
    s_mov_b32 s57, 0
    s_waitcnt vmcnt(8)
    s_barrier
    s_mov_b64 exec, s[56:57]
    buffer_store_dwordx4 v[216:219], v5, s[44:47], s54 offen sc1
    s_mov_b64 exec, -1
    buffer_load_dword a232, v49, s[36:39], s100 offen offset:0 nt
    buffer_load_dword a233, v49, s[36:39], s100 offen offset:1152 nt
    buffer_load_dword a234, v49, s[36:39], s100 offen offset:2304 nt
    buffer_load_dword a235, v49, s[36:39], s100 offen offset:3456 nt
    s_add_u32 s100, s100, 4608
    buffer_load_dword a236, v49, s[36:39], s100 offen offset:0 nt
    buffer_load_dword a237, v49, s[36:39], s100 offen offset:1152 nt
    buffer_load_dword a238, v49, s[36:39], s100 offen offset:2304 nt
    buffer_load_dword a239, v49, s[36:39], s100 offen offset:3456 nt
    s_add_u32 s100, s100, 32256
    buffer_load_dword a240, v49, s[36:39], s100 offen offset:0 nt
    buffer_load_dword a241, v49, s[36:39], s100 offen offset:1152 nt
    buffer_load_dword a242, v49, s[36:39], s100 offen offset:2304 nt
    buffer_load_dword a243, v49, s[36:39], s100 offen offset:3456 nt
    s_add_u32 s100, s100, 4608
    buffer_load_dword a244, v49, s[36:39], s100 offen offset:0 nt
    buffer_load_dword a245, v49, s[36:39], s100 offen offset:1152 nt
    buffer_load_dword a246, v49, s[36:39], s100 offen offset:2304 nt
    buffer_load_dword a247, v49, s[36:39], s100 offen offset:3456 nt
    s_add_u32 s100, s100, 32256
    buffer_load_dword a248, v49, s[36:39], s100 offen offset:0 nt
    buffer_load_dword a249, v49, s[36:39], s100 offen offset:1152 nt
    buffer_load_dword a250, v49, s[36:39], s100 offen offset:2304 nt
    buffer_load_dword a251, v49, s[36:39], s100 offen offset:3456 nt
    s_add_u32 s100, s100, 4608
    buffer_load_dword a252, v49, s[36:39], s100 offen offset:0 nt
    buffer_load_dword a253, v49, s[36:39], s100 offen offset:1152 nt
    buffer_load_dword a254, v49, s[36:39], s100 offen offset:2304 nt
    buffer_load_dword a255, v49, s[36:39], s100 offen offset:3456 nt
    s_add_u32 s100, s100, 32256
    s_waitcnt vmcnt(0)
    v_accvgpr_read_b32 v96, a96
    v_accvgpr_read_b32 v97, a97
    v_accvgpr_read_b32 v98, a98
    v_accvgpr_read_b32 v99, a99
    v_accvgpr_read_b32 v100, a100
    v_accvgpr_read_b32 v101, a101
    v_accvgpr_read_b32 v102, a102
    v_accvgpr_read_b32 v103, a103
    v_accvgpr_read_b32 v104, a104
    v_accvgpr_read_b32 v105, a105
    v_accvgpr_read_b32 v106, a106
    v_accvgpr_read_b32 v107, a107
    v_accvgpr_read_b32 v108, a108
    v_accvgpr_read_b32 v109, a109
    v_accvgpr_read_b32 v110, a110
    v_accvgpr_read_b32 v111, a111
    v_accvgpr_read_b32 v112, a112
    v_accvgpr_read_b32 v113, a113
    v_accvgpr_read_b32 v114, a114
    v_accvgpr_read_b32 v115, a115
    v_accvgpr_read_b32 v116, a116
    v_accvgpr_read_b32 v117, a117
    v_accvgpr_read_b32 v118, a118
    v_accvgpr_read_b32 v119, a119
    v_accvgpr_read_b32 v120, a120
    v_accvgpr_read_b32 v121, a121
    v_accvgpr_read_b32 v122, a122
    v_accvgpr_read_b32 v123, a123
    v_accvgpr_read_b32 v124, a124
    v_accvgpr_read_b32 v125, a125
    v_accvgpr_read_b32 v126, a126
    v_accvgpr_read_b32 v127, a127
    v_accvgpr_read_b32 v128, a128
    v_accvgpr_read_b32 v129, a129
    v_accvgpr_read_b32 v130, a130
    v_accvgpr_read_b32 v131, a131
    v_accvgpr_read_b32 v132, a132
    v_accvgpr_read_b32 v133, a133
    v_accvgpr_read_b32 v134, a134
    v_accvgpr_read_b32 v135, a135
    v_accvgpr_read_b32 v136, a136
    v_accvgpr_read_b32 v137, a137
    v_accvgpr_read_b32 v138, a138
    v_accvgpr_read_b32 v139, a139
    v_accvgpr_read_b32 v140, a140
    v_accvgpr_read_b32 v141, a141
    v_accvgpr_read_b32 v142, a142
    v_accvgpr_read_b32 v143, a143
    v_accvgpr_read_b32 v144, a144
    v_accvgpr_read_b32 v145, a145
    v_accvgpr_read_b32 v146, a146
    v_accvgpr_read_b32 v147, a147
    v_accvgpr_read_b32 v148, a148
    v_accvgpr_read_b32 v149, a149
    v_accvgpr_read_b32 v150, a150
    v_accvgpr_read_b32 v151, a151
    v_accvgpr_read_b32 v152, a152
    v_accvgpr_read_b32 v153, a153
    v_accvgpr_read_b32 v154, a154
    v_accvgpr_read_b32 v155, a155
    v_accvgpr_read_b32 v156, a156
    v_accvgpr_read_b32 v157, a157
    v_accvgpr_read_b32 v158, a158
    v_accvgpr_read_b32 v159, a159
    v_accvgpr_read_b32 v160, a160
    v_accvgpr_read_b32 v161, a161
    v_accvgpr_read_b32 v162, a162
    v_accvgpr_read_b32 v163, a163
    v_accvgpr_read_b32 v164, a164
    v_accvgpr_read_b32 v165, a165
    v_accvgpr_read_b32 v166, a166
    v_accvgpr_read_b32 v167, a167
    v_accvgpr_read_b32 v168, a168
    v_accvgpr_read_b32 v169, a169
    v_accvgpr_read_b32 v170, a170
    v_accvgpr_read_b32 v171, a171
    v_accvgpr_read_b32 v172, a172
    v_accvgpr_read_b32 v173, a173
    v_accvgpr_read_b32 v174, a174
    v_accvgpr_read_b32 v175, a175
    v_accvgpr_read_b32 v176, a176
    v_accvgpr_read_b32 v177, a177
    v_accvgpr_read_b32 v178, a178
    v_accvgpr_read_b32 v179, a179
    v_accvgpr_read_b32 v180, a180
    v_accvgpr_read_b32 v181, a181
    v_accvgpr_read_b32 v182, a182
    v_accvgpr_read_b32 v183, a183
    v_accvgpr_read_b32 v184, a184
    v_accvgpr_read_b32 v185, a185
    v_accvgpr_read_b32 v186, a186
    v_accvgpr_read_b32 v187, a187
    v_accvgpr_read_b32 v188, a188
    v_accvgpr_read_b32 v189, a189
    v_accvgpr_read_b32 v190, a190
    v_accvgpr_read_b32 v191, a191
    v_accvgpr_read_b32 v192, a192
    v_accvgpr_read_b32 v193, a193
    v_accvgpr_read_b32 v194, a194
    v_accvgpr_read_b32 v195, a195
    v_accvgpr_read_b32 v196, a196
    v_accvgpr_read_b32 v197, a197
    v_accvgpr_read_b32 v198, a198
    v_accvgpr_read_b32 v199, a199
    v_accvgpr_read_b32 v200, a200
    v_accvgpr_read_b32 v201, a201
    v_accvgpr_read_b32 v202, a202
    v_accvgpr_read_b32 v203, a203
    v_accvgpr_read_b32 v204, a204
    v_accvgpr_read_b32 v205, a205
    v_accvgpr_read_b32 v206, a206
    v_accvgpr_read_b32 v207, a207
    v_accvgpr_read_b32 v208, a208
    v_accvgpr_read_b32 v209, a209
    v_accvgpr_read_b32 v210, a210
    v_accvgpr_read_b32 v211, a211
    v_accvgpr_read_b32 v212, a212
    v_accvgpr_read_b32 v213, a213
    v_accvgpr_read_b32 v214, a214
    v_accvgpr_read_b32 v215, a215
    v_accvgpr_read_b32 v216, a216
    v_accvgpr_read_b32 v217, a217
    v_accvgpr_read_b32 v218, a218
    v_accvgpr_read_b32 v219, a219
    v_accvgpr_read_b32 v220, a220
    v_accvgpr_read_b32 v221, a221
    v_accvgpr_read_b32 v222, a222
    v_accvgpr_read_b32 v223, a223
    v_accvgpr_read_b32 v224, a224
    v_accvgpr_read_b32 v225, a225
    v_accvgpr_read_b32 v226, a226
    v_accvgpr_read_b32 v227, a227
    v_accvgpr_read_b32 v228, a228
    v_accvgpr_read_b32 v229, a229
    v_accvgpr_read_b32 v230, a230
    v_accvgpr_read_b32 v231, a231
    v_accvgpr_read_b32 v232, a232
    v_accvgpr_read_b32 v233, a233
    v_accvgpr_read_b32 v234, a234
    v_accvgpr_read_b32 v235, a235
    v_accvgpr_read_b32 v236, a236
    v_accvgpr_read_b32 v237, a237
    v_accvgpr_read_b32 v238, a238
    v_accvgpr_read_b32 v239, a239
    v_accvgpr_read_b32 v240, a240
    v_accvgpr_read_b32 v241, a241
    v_accvgpr_read_b32 v242, a242
    v_accvgpr_read_b32 v243, a243
    v_accvgpr_read_b32 v244, a244
    v_accvgpr_read_b32 v245, a245
    v_accvgpr_read_b32 v246, a246
    v_accvgpr_read_b32 v247, a247
    v_accvgpr_read_b32 v248, a248
    v_accvgpr_read_b32 v249, a249
    v_accvgpr_read_b32 v250, a250
    v_accvgpr_read_b32 v251, a251
    v_accvgpr_read_b32 v252, a252
    v_accvgpr_read_b32 v253, a253
    v_accvgpr_read_b32 v254, a254
    v_accvgpr_read_b32 v255, a255
    s_mov_b32 s54, 0x05040100
    s_mov_b32 s55, 0x07060302
    v_perm_b32 v64, v100, v96, s54
    v_perm_b32 v65, v108, v104, s54
    v_perm_b32 v66, v116, v112, s54
    v_perm_b32 v67, v124, v120, s54
    v_perm_b32 v68, v100, v96, s55
    v_perm_b32 v69, v108, v104, s55
    v_perm_b32 v70, v116, v112, s55
    v_perm_b32 v71, v124, v120, s55
    v_perm_b32 v72, v101, v97, s54
    v_perm_b32 v73, v109, v105, s54
    v_perm_b32 v74, v117, v113, s54
    v_perm_b32 v75, v125, v121, s54
    v_perm_b32 v76, v101, v97, s55
    v_perm_b32 v77, v109, v105, s55
    v_perm_b32 v78, v117, v113, s55
    v_perm_b32 v79, v125, v121, s55
    v_perm_b32 v80, v102, v98, s54
    v_perm_b32 v81, v110, v106, s54
    v_perm_b32 v82, v118, v114, s54
    v_perm_b32 v83, v126, v122, s54
    v_perm_b32 v84, v102, v98, s55
    v_perm_b32 v85, v110, v106, s55
    v_perm_b32 v86, v118, v114, s55
    v_perm_b32 v87, v126, v122, s55
    v_perm_b32 v88, v103, v99, s54
    v_perm_b32 v89, v111, v107, s54
    v_perm_b32 v90, v119, v115, s54
    v_perm_b32 v91, v127, v123, s54
    v_perm_b32 v92, v103, v99, s55
    v_perm_b32 v93, v111, v107, s55
    v_perm_b32 v94, v119, v115, s55
    v_perm_b32 v95, v127, v123, s55
    v_perm_b32 v96, v132, v128, s54
    v_perm_b32 v97, v140, v136, s54
    v_perm_b32 v98, v148, v144, s54
    v_perm_b32 v99, v156, v152, s54
    v_perm_b32 v100, v132, v128, s55
    v_perm_b32 v101, v140, v136, s55
    v_perm_b32 v102, v148, v144, s55
    v_perm_b32 v103, v156, v152, s55
    v_perm_b32 v104, v133, v129, s54
    v_perm_b32 v105, v141, v137, s54
    v_perm_b32 v106, v149, v145, s54
    v_perm_b32 v107, v157, v153, s54
    v_perm_b32 v108, v133, v129, s55
    v_perm_b32 v109, v141, v137, s55
    v_perm_b32 v110, v149, v145, s55
    v_perm_b32 v111, v157, v153, s55
    v_perm_b32 v112, v134, v130, s54
    v_perm_b32 v113, v142, v138, s54
    v_perm_b32 v114, v150, v146, s54
    v_perm_b32 v115, v158, v154, s54
    v_perm_b32 v116, v134, v130, s55
    v_perm_b32 v117, v142, v138, s55
    v_perm_b32 v118, v150, v146, s55
    v_perm_b32 v119, v158, v154, s55
    v_perm_b32 v120, v135, v131, s54
    v_perm_b32 v121, v143, v139, s54
    v_perm_b32 v122, v151, v147, s54
    v_perm_b32 v123, v159, v155, s54
    v_perm_b32 v124, v135, v131, s55
    v_perm_b32 v125, v143, v139, s55
    v_perm_b32 v126, v151, v147, s55
    v_perm_b32 v127, v159, v155, s55
    v_perm_b32 v128, v164, v160, s54
    v_perm_b32 v129, v172, v168, s54
    v_perm_b32 v130, v180, v176, s54
    v_perm_b32 v131, v188, v184, s54
    v_perm_b32 v132, v164, v160, s55
    v_perm_b32 v133, v172, v168, s55
    v_perm_b32 v134, v180, v176, s55
    v_perm_b32 v135, v188, v184, s55
    v_perm_b32 v136, v165, v161, s54
    v_perm_b32 v137, v173, v169, s54
    v_perm_b32 v138, v181, v177, s54
    v_perm_b32 v139, v189, v185, s54
    v_perm_b32 v140, v165, v161, s55
    v_perm_b32 v141, v173, v169, s55
    v_perm_b32 v142, v181, v177, s55
    v_perm_b32 v143, v189, v185, s55
    v_perm_b32 v144, v166, v162, s54
    v_perm_b32 v145, v174, v170, s54
    v_perm_b32 v146, v182, v178, s54
    v_perm_b32 v147, v190, v186, s54
    v_perm_b32 v148, v166, v162, s55
    v_perm_b32 v149, v174, v170, s55
    v_perm_b32 v150, v182, v178, s55
    v_perm_b32 v151, v190, v186, s55
    v_perm_b32 v152, v167, v163, s54
    v_perm_b32 v153, v175, v171, s54
    v_perm_b32 v154, v183, v179, s54
    v_perm_b32 v155, v191, v187, s54
    v_perm_b32 v156, v167, v163, s55
    v_perm_b32 v157, v175, v171, s55
    v_perm_b32 v158, v183, v179, s55
    v_perm_b32 v159, v191, v187, s55
    v_perm_b32 v160, v196, v192, s54
    v_perm_b32 v161, v204, v200, s54
    v_perm_b32 v162, v212, v208, s54
    v_perm_b32 v163, v220, v216, s54
    v_perm_b32 v164, v196, v192, s55
    v_perm_b32 v165, v204, v200, s55
    v_perm_b32 v166, v212, v208, s55
    v_perm_b32 v167, v220, v216, s55
    v_perm_b32 v168, v197, v193, s54
    v_perm_b32 v169, v205, v201, s54
    v_perm_b32 v170, v213, v209, s54
    v_perm_b32 v171, v221, v217, s54
    v_perm_b32 v172, v197, v193, s55
    v_perm_b32 v173, v205, v201, s55
    v_perm_b32 v174, v213, v209, s55
    v_perm_b32 v175, v221, v217, s55
    v_perm_b32 v176, v198, v194, s54
    v_perm_b32 v177, v206, v202, s54
    v_perm_b32 v178, v214, v210, s54
    v_perm_b32 v179, v222, v218, s54
    v_perm_b32 v180, v198, v194, s55
    v_perm_b32 v181, v206, v202, s55
    v_perm_b32 v182, v214, v210, s55
    v_perm_b32 v183, v222, v218, s55
    v_perm_b32 v184, v199, v195, s54
    v_perm_b32 v185, v207, v203, s54
    v_perm_b32 v186, v215, v211, s54
    v_perm_b32 v187, v223, v219, s54
    v_perm_b32 v188, v199, v195, s55
    v_perm_b32 v189, v207, v203, s55
    v_perm_b32 v190, v215, v211, s55
    v_perm_b32 v191, v223, v219, s55
    v_perm_b32 v192, v225, v224, s54
    v_perm_b32 v193, v227, v226, s54
    v_perm_b32 v194, v229, v228, s54
    v_perm_b32 v195, v231, v230, s54
    v_perm_b32 v196, v225, v224, s55
    v_perm_b32 v197, v227, v226, s55
    v_perm_b32 v198, v229, v228, s55
    v_perm_b32 v199, v231, v230, s55
    v_perm_b32 v200, v233, v232, s54
    v_perm_b32 v201, v235, v234, s54
    v_perm_b32 v202, v237, v236, s54
    v_perm_b32 v203, v239, v238, s54
    v_perm_b32 v204, v233, v232, s55
    v_perm_b32 v205, v235, v234, s55
    v_perm_b32 v206, v237, v236, s55
    v_perm_b32 v207, v239, v238, s55
    v_perm_b32 v208, v241, v240, s54
    v_perm_b32 v209, v243, v242, s54
    v_perm_b32 v210, v245, v244, s54
    v_perm_b32 v211, v247, v246, s54
    v_perm_b32 v212, v241, v240, s55
    v_perm_b32 v213, v243, v242, s55
    v_perm_b32 v214, v245, v244, s55
    v_perm_b32 v215, v247, v246, s55
    v_perm_b32 v216, v249, v248, s54
    v_perm_b32 v217, v251, v250, s54
    v_perm_b32 v218, v253, v252, s54
    v_perm_b32 v219, v255, v254, s54
    v_perm_b32 v220, v249, v248, s55
    v_perm_b32 v221, v251, v250, s55
    v_perm_b32 v222, v253, v252, s55
    v_perm_b32 v223, v255, v254, s55
    s_mov_b32 s97, 1069066811
    s_mov_b32 s98, 0xffff0000
    v_mul_u32_u24 v7, 73728, v4
    v_lshrrev_b32 v5, 3, v3
    v_lshl_add_u32 v6, v5, 13, v7
    v_and_b32 v5, 7, v3
    v_lshl_add_u32 v6, v5, 4, v6
    v_lshl_add_u32 v7, v3, 3, v7
    v_add_u32 v7, 65536, v7
    s_lshl_b32 s56, s52, 7
    s_add_u32 s56, s56, 4194304
    s_lshl_b32 s54, s3, 14
    s_add_u32 s54, s54, s56
    s_add_u32 s55, s54, 4096
    s_and_b32 s57, s3, 1
    s_lshl_b32 s57, s57, 12
    s_add_u32 s56, s56, s57
    v_mov_b32 v0, v6
    v_mov_b32 v1, v7
    s_mov_b32 s60, s54
    s_mov_b32 s61, s55
    s_mov_b32 s62, s56
    v_and_b32 v5, 1, v3
    v_cmp_eq_u32 vcc, 1, v5
    v_mov_b32 v5, 0xffff
    v_mov_b32 v6, 0xffff0000
    v_cndmask_b32 v5, v5, v6, vcc
    v_lshrrev_b32 v6, 1, v3
    v_cmp_eq_u32 vcc, 0, v6
    s_nop 1
    v_cndmask_b32 v8, 0, v5, vcc
    v_cmp_eq_u32 vcc, 1, v6
    s_nop 1
    v_cndmask_b32 v9, 0, v5, vcc
    v_cmp_eq_u32 vcc, 2, v6
    s_nop 1
    v_cndmask_b32 v10, 0, v5, vcc
    v_cmp_eq_u32 vcc, 3, v6
    s_nop 1
    v_cndmask_b32 v11, 0, v5, vcc
    v_mov_b32 v16, -1
    v_mov_b32 v17, -1
    v_mov_b32 v18, -1
    v_mov_b32 v19, -1
    v_mov_b32 v20, -1
    v_mov_b32 v21, -1
    v_mov_b32 v22, -1
    v_mov_b32 v23, -1
    v_mov_b32 v24, -1
    v_mov_b32 v25, -1
    v_mov_b32 v26, -1
    v_mov_b32 v27, -1
    v_mov_b32 v28, -1
    v_mov_b32 v29, -1
    v_mov_b32 v30, -1
    v_mov_b32 v31, -1
    v_mov_b32 v32, -1
    v_mov_b32 v33, -1
    v_mov_b32 v34, -1
    v_mov_b32 v35, -1
    v_mov_b32 v36, -1
    v_mov_b32 v37, -1
    v_mov_b32 v38, -1
    v_mov_b32 v39, -1
    v_mov_b32 v40, -1
    v_mov_b32 v41, -1
    v_mov_b32 v42, -1
    v_mov_b32 v43, -1
    s_lshl_b32 s54, s3, 9
    v_lshl_add_u32 v5, v3, 4, s54
    v_and_b32 v6, 1, v4
    v_lshl_add_u32 v5, v6, 3, v5
    v_lshrrev_b32 v6, 1, v4
    v_lshl_add_u32 v5, v6, 8, v5
    v_lshrrev_b32 v7, 2, v3
    v_lshlrev_b32 v7, 9, v7
    v_lshl_add_u32 v7, v4, 4, v7
    s_lshl_b32 s58, s52, 2
    s_add_u32 s58, s58, s3
    s_lshl_b32 s58, s58, 13
    s_add_u32 s58, s58, 8388608
    s_add_u32 s59, s58, 4096
    v_min_u32 v6, 1, v3
    v_lshl_add_u32 v6, v6, 2, v4
    v_lshlrev_b32 v6, 4, v6
    s_lshr_b32 s55, s52, 2
    s_add_u32 s55, s55, s3
    s_and_b32 s55, s55, 3
    s_and_b32 s54, s52, 3
    s_cmp_eq_u32 s54, s55
    s_cbranch_scc1 L_cshared
    v_and_b32 v6, 1, v3
    v_cmp_gt_u32 s[20:21], 2, v6
    v_min_u32 v6, 1, v6
    v_lshl_add_u32 v6, v6, 2, v4
    v_lshlrev_b32 v6, 4, v6
L_light_20:
    buffer_load_dword v236, v6, s[44:47], s59 offen offset:2048 sc1
    s_waitcnt vmcnt(0)
    v_cmp_ne_u32 vcc, -1, v236
    s_nop 0
    s_bcnt1_i32_b64 s54, vcc
    s_cmp_ge_u32 s54, 24
    s_cbranch_scc1 L_heavy_21
    s_sleep 2
    s_sub_u32 s101, s101, 1
    s_cbranch_scc0 L_light_20
    s_mov_b32 s101, 0
L_heavy_21:
    s_mov_b64 s[4:5], -1
    s_mov_b64 s[6:7], -1
    s_mov_b64 s[8:9], -1
L_mpoll_22:
    s_mov_b64 exec, s[4:5]
    buffer_load_dwordx4 v[40:43], v6, s[44:47], s59 offen offset:2048 sc1
    s_mov_b64 exec, s[6:7]
    buffer_load_dwordx4 v[16:19], v2, s[44:47], s58 offen offset:0 sc1
    s_mov_b64 exec, s[8:9]
    buffer_load_dwordx4 v[20:23], v2, s[44:47], s58 offen offset:1024 sc1
    s_mov_b64 exec, -1
    s_waitcnt vmcnt(3)
    v_max3_u32 v236, v40, v41, v42
    v_max3_u32 v237, v16, v17, v18
    v_max3_u32 v238, v20, v21, v22
    v_max_u32 v236, v236, v43
    v_max_u32 v237, v237, v19
    v_max_u32 v238, v238, v23
    v_cmp_eq_u32 s[4:5], -1, v236
    v_cmp_eq_u32 s[6:7], -1, v237
    v_cmp_eq_u32 s[8:9], -1, v238
    s_or_b64 vcc, s[4:5], s[6:7]
    s_or_b64 vcc, vcc, s[8:9]
    s_cbranch_scc0 L_mpollok_23
    s_sub_u32 s101, s101, 1
    s_cbranch_scc0 L_mpoll_22
    s_mov_b32 s101, 0
L_mpollok_23:
    v_max_f32_dpp v44, v40, v40 row_ror:1 row_mask:0xf bank_mask:0xf
    v_cndmask_b32 v47, 0, v41, s[20:21]
    v_mov_b32 v45, v44
    s_nop 1
    v_permlane16_swap_b32 v44, v45
    v_max_f32 v44, v44, v45
    v_mov_b32 v45, v44
    s_nop 1
    v_permlane32_swap_b32 v44, v45
    v_max_f32 v44, v44, v45
    v_sub_f32 v45, v40, v44
    v_mul_f32 v45, s97, v45
    v_exp_f32 v45, v45
    s_nop 0
    v_cvt_pk_bf16_f32 v46, v45, v45
    v_and_b32 v45, s98, v46
    v_mul_f32 v47, v47, v45
    v_and_b32_dpp v232, v46, v8 row_newbcast:0 row_mask:0xf bank_mask:0xf
    v_and_b32_dpp v233, v46, v9 row_newbcast:0 row_mask:0xf bank_mask:0xf
    v_add_f32_dpp v47, v47, v47 row_ror:1 row_mask:0xf bank_mask:0xf
    v_and_b32_dpp v234, v46, v10 row_newbcast:0 row_mask:0xf bank_mask:0xf
    v_and_b32_dpp v235, v46, v11 row_newbcast:0 row_mask:0xf bank_mask:0xf
    v_and_b32_dpp v236, v46, v8 row_newbcast:1 row_mask:0xf bank_mask:0xf
    v_mov_b32 v45, v47
    v_and_b32_dpp v237, v46, v9 row_newbcast:1 row_mask:0xf bank_mask:0xf
    v_and_b32_dpp v238, v46, v10 row_newbcast:1 row_mask:0xf bank_mask:0xf
    v_and_b32_dpp v239, v46, v11 row_newbcast:1 row_mask:0xf bank_mask:0xf
    v_permlane16_swap_b32 v47, v45
    v_mfma_f32_16x16x32_bf16 v[228:231], v[232:235], v[16:19], 0
    v_add_f32 v47, v47, v45
    v_mfma_f32_16x16x32_bf16 v[228:231], v[236:239], v[20:23], v[228:231]
    v_mov_b32 v45, v47
    s_nop 1
    v_permlane32_swap_b32 v47, v45
    v_add_f32 v47, v47, v45
    v_rcp_f32 v47, v47
    s_nop 1
    v_mul_f32 v228, v228, v47
    v_mul_f32 v229, v229, v47
    v_mul_f32 v230, v230, v47
    v_mul_f32 v231, v231, v47
    v_cvt_pk_bf16_f32 v224, v228, v229
    v_cvt_pk_bf16_f32 v225, v230, v231
    s_branch L_cmerged
L_cshared:
    v_and_b32 v6, 7, v3
    v_cmp_gt_u32 s[20:21], 6, v6
    v_min_u32 v6, 5, v6
    v_lshl_add_u32 v6, v6, 2, v4
    v_lshlrev_b32 v6, 4, v6
L_light_24:
    buffer_load_dword v236, v6, s[44:47], s59 offen offset:2048 sc1
    s_waitcnt vmcnt(0)
    v_cmp_ne_u32 vcc, -1, v236
    s_nop 0
    s_bcnt1_i32_b64 s54, vcc
    s_cmp_ge_u32 s54, 24
    s_cbranch_scc1 L_heavy_25
    s_sleep 2
    s_sub_u32 s101, s101, 1
    s_cbranch_scc0 L_light_24
    s_mov_b32 s101, 0
L_heavy_25:
    s_mov_b64 s[4:5], -1
    s_mov_b64 s[6:7], -1
    s_mov_b64 s[8:9], -1
    s_mov_b64 s[10:11], -1
    s_mov_b64 s[12:13], -1
    s_mov_b64 s[14:15], -1
    s_mov_b64 s[16:17], -1
L_mpoll_26:
    s_mov_b64 exec, s[4:5]
    buffer_load_dwordx4 v[40:43], v6, s[44:47], s59 offen offset:2048 sc1
    s_mov_b64 exec, s[6:7]
    buffer_load_dwordx4 v[16:19], v2, s[44:47], s58 offen offset:0 sc1
    s_mov_b64 exec, s[8:9]
    buffer_load_dwordx4 v[20:23], v2, s[44:47], s58 offen offset:1024 sc1
    s_mov_b64 exec, s[10:11]
    buffer_load_dwordx4 v[24:27], v2, s[44:47], s58 offen offset:2048 sc1
    s_mov_b64 exec, s[12:13]
    buffer_load_dwordx4 v[28:31], v2, s[44:47], s58 offen offset:3072 sc1
    s_mov_b64 exec, s[14:15]
    buffer_load_dwordx4 v[32:35], v2, s[44:47], s59 offen offset:0 sc1
    s_mov_b64 exec, s[16:17]
    buffer_load_dwordx4 v[36:39], v2, s[44:47], s59 offen offset:1024 sc1
    s_mov_b64 exec, -1
    s_waitcnt vmcnt(7)
    v_max3_u32 v236, v40, v41, v42
    v_max3_u32 v237, v16, v17, v18
    v_max3_u32 v238, v20, v21, v22
    v_max3_u32 v239, v24, v25, v26
    v_max3_u32 v240, v28, v29, v30
    v_max3_u32 v241, v32, v33, v34
    v_max3_u32 v242, v36, v37, v38
    v_max_u32 v236, v236, v43
    v_max_u32 v237, v237, v19
    v_max_u32 v238, v238, v23
    v_max_u32 v239, v239, v27
    v_max_u32 v240, v240, v31
    v_max_u32 v241, v241, v35
    v_max_u32 v242, v242, v39
    v_cmp_eq_u32 s[4:5], -1, v236
    v_cmp_eq_u32 s[6:7], -1, v237
    v_cmp_eq_u32 s[8:9], -1, v238
    v_cmp_eq_u32 s[10:11], -1, v239
    v_cmp_eq_u32 s[12:13], -1, v240
    v_cmp_eq_u32 s[14:15], -1, v241
    v_cmp_eq_u32 s[16:17], -1, v242
    s_or_b64 vcc, s[4:5], s[6:7]
    s_or_b64 vcc, vcc, s[8:9]
    s_or_b64 vcc, vcc, s[10:11]
    s_or_b64 vcc, vcc, s[12:13]
    s_or_b64 vcc, vcc, s[14:15]
    s_or_b64 vcc, vcc, s[16:17]
    s_cbranch_scc0 L_mpollok_27
    s_sub_u32 s101, s101, 1
    s_cbranch_scc0 L_mpoll_26
    s_mov_b32 s101, 0
L_mpollok_27:
    v_max_f32_dpp v44, v40, v40 row_ror:1 row_mask:0xf bank_mask:0xf
    v_cndmask_b32 v47, 0, v41, s[20:21]
    s_nop 0
    v_max_f32_dpp v44, v44, v44 row_ror:2 row_mask:0xf bank_mask:0xf
    s_nop 1
    v_max_f32_dpp v44, v44, v44 row_ror:4 row_mask:0xf bank_mask:0xf
    v_mov_b32 v45, v44
    s_nop 1
    v_permlane16_swap_b32 v44, v45
    v_max_f32 v44, v44, v45
    v_mov_b32 v45, v44
    s_nop 1
    v_permlane32_swap_b32 v44, v45
    v_max_f32 v44, v44, v45
    v_sub_f32 v45, v40, v44
    v_mul_f32 v45, s97, v45
    v_exp_f32 v45, v45
    s_nop 0
    v_cvt_pk_bf16_f32 v46, v45, v45
    v_and_b32 v45, s98, v46
    v_mul_f32 v47, v47, v45
    v_and_b32_dpp v232, v46, v8 row_newbcast:0 row_mask:0xf bank_mask:0xf
    v_and_b32_dpp v233, v46, v9 row_newbcast:0 row_mask:0xf bank_mask:0xf
    v_add_f32_dpp v47, v47, v47 row_ror:1 row_mask:0xf bank_mask:0xf
    v_and_b32_dpp v234, v46, v10 row_newbcast:0 row_mask:0xf bank_mask:0xf
    v_and_b32_dpp v235, v46, v11 row_newbcast:0 row_mask:0xf bank_mask:0xf
    v_and_b32_dpp v236, v46, v8 row_newbcast:1 row_mask:0xf bank_mask:0xf
    v_and_b32_dpp v237, v46, v9 row_newbcast:1 row_mask:0xf bank_mask:0xf
    v_add_f32_dpp v47, v47, v47 row_ror:2 row_mask:0xf bank_mask:0xf
    v_and_b32_dpp v238, v46, v10 row_newbcast:1 row_mask:0xf bank_mask:0xf
    v_and_b32_dpp v239, v46, v11 row_newbcast:1 row_mask:0xf bank_mask:0xf
    v_mfma_f32_16x16x32_bf16 v[228:231], v[232:235], v[16:19], 0
    v_and_b32_dpp v240, v46, v8 row_newbcast:2 row_mask:0xf bank_mask:0xf
    v_add_f32_dpp v47, v47, v47 row_ror:4 row_mask:0xf bank_mask:0xf
    v_and_b32_dpp v241, v46, v9 row_newbcast:2 row_mask:0xf bank_mask:0xf
    v_and_b32_dpp v242, v46, v10 row_newbcast:2 row_mask:0xf bank_mask:0xf
    v_and_b32_dpp v243, v46, v11 row_newbcast:2 row_mask:0xf bank_mask:0xf
    v_mfma_f32_16x16x32_bf16 v[228:231], v[236:239], v[20:23], v[228:231]
    v_mov_b32 v45, v47
    v_and_b32_dpp v244, v46, v8 row_newbcast:3 row_mask:0xf bank_mask:0xf
    v_and_b32_dpp v245, v46, v9 row_newbcast:3 row_mask:0xf bank_mask:0xf
    v_and_b32_dpp v246, v46, v10 row_newbcast:3 row_mask:0xf bank_mask:0xf
    v_and_b32_dpp v247, v46, v11 row_newbcast:3 row_mask:0xf bank_mask:0xf
    v_permlane16_swap_b32 v47, v45
    v_mfma_f32_16x16x32_bf16 v[228:231], v[240:243], v[24:27], v[228:231]
    v_and_b32_dpp v248, v46, v8 row_newbcast:4 row_mask:0xf bank_mask:0xf
    v_and_b32_dpp v249, v46, v9 row_newbcast:4 row_mask:0xf bank_mask:0xf
    v_and_b32_dpp v250, v46, v10 row_newbcast:4 row_mask:0xf bank_mask:0xf
    v_add_f32 v47, v47, v45
    v_and_b32_dpp v251, v46, v11 row_newbcast:4 row_mask:0xf bank_mask:0xf
    v_mfma_f32_16x16x32_bf16 v[228:231], v[244:247], v[28:31], v[228:231]
    v_and_b32_dpp v252, v46, v8 row_newbcast:5 row_mask:0xf bank_mask:0xf
    v_and_b32_dpp v253, v46, v9 row_newbcast:5 row_mask:0xf bank_mask:0xf
    v_mov_b32 v45, v47
    v_and_b32_dpp v254, v46, v10 row_newbcast:5 row_mask:0xf bank_mask:0xf
    v_and_b32_dpp v255, v46, v11 row_newbcast:5 row_mask:0xf bank_mask:0xf
    v_mfma_f32_16x16x32_bf16 v[228:231], v[248:251], v[32:35], v[228:231]
    v_permlane32_swap_b32 v47, v45
    v_add_f32 v47, v47, v45
    v_mfma_f32_16x16x32_bf16 v[228:231], v[252:255], v[36:39], v[228:231]
    v_rcp_f32 v47, v47
    s_nop 6
    v_mul_f32 v228, v228, v47
    v_mul_f32 v229, v229, v47
    v_mul_f32 v230, v230, v47
    v_mul_f32 v231, v231, v47
    v_cvt_pk_bf16_f32 v224, v228, v229
    v_cvt_pk_bf16_f32 v225, v230, v231
L_cmerged:
    ds_write_b64 v5, v[224:225]
    s_waitcnt lgkmcnt(0)
    s_barrier
    ds_read_b128 v[48:51], v7 offset:0
    ds_read_b128 v[52:55], v7 offset:64
    ds_read_b128 v[56:59], v7 offset:128
    ds_read_b128 v[60:63], v7 offset:192
    s_waitcnt lgkmcnt(3)
    v_mfma_f32_16x16x32_bf16 v[224:227], v[48:51], v[64:67], 0
    v_mfma_f32_16x16x32_bf16 v[228:231], v[48:51], v[68:71], 0
    v_mfma_f32_16x16x32_bf16 v[232:235], v[48:51], v[72:75], 0
    v_mfma_f32_16x16x32_bf16 v[236:239], v[48:51], v[76:79], 0
    v_mfma_f32_16x16x32_bf16 v[8:11], v[48:51], v[192:195], 0
    v_mfma_f32_16x16x32_bf16 v[12:15], v[48:51], v[196:199], 0
    s_waitcnt lgkmcnt(2)
    v_mfma_f32_16x16x32_bf16 v[224:227], v[52:55], v[96:99], v[224:227]
    v_mfma_f32_16x16x32_bf16 v[228:231], v[52:55], v[100:103], v[228:231]
    v_mfma_f32_16x16x32_bf16 v[232:235], v[52:55], v[104:107], v[232:235]
    v_mfma_f32_16x16x32_bf16 v[236:239], v[52:55], v[108:111], v[236:239]
    v_mfma_f32_16x16x32_bf16 v[8:11], v[52:55], v[200:203], v[8:11]
    v_mfma_f32_16x16x32_bf16 v[12:15], v[52:55], v[204:207], v[12:15]
    s_waitcnt lgkmcnt(1)
    v_mfma_f32_16x16x32_bf16 v[224:227], v[56:59], v[128:131], v[224:227]
    v_mfma_f32_16x16x32_bf16 v[228:231], v[56:59], v[132:135], v[228:231]
    v_mfma_f32_16x16x32_bf16 v[232:235], v[56:59], v[136:139], v[232:235]
    v_mfma_f32_16x16x32_bf16 v[236:239], v[56:59], v[140:143], v[236:239]
    v_mfma_f32_16x16x32_bf16 v[8:11], v[56:59], v[208:211], v[8:11]
    v_mfma_f32_16x16x32_bf16 v[12:15], v[56:59], v[212:215], v[12:15]
    s_waitcnt lgkmcnt(0)
    v_mfma_f32_16x16x32_bf16 v[224:227], v[60:63], v[160:163], v[224:227]
    v_mfma_f32_16x16x32_bf16 v[228:231], v[60:63], v[164:167], v[228:231]
    v_mfma_f32_16x16x32_bf16 v[232:235], v[60:63], v[168:171], v[232:235]
    v_mfma_f32_16x16x32_bf16 v[236:239], v[60:63], v[172:175], v[236:239]
    v_mfma_f32_16x16x32_bf16 v[8:11], v[60:63], v[216:219], v[8:11]
    v_mfma_f32_16x16x32_bf16 v[12:15], v[60:63], v[220:223], v[12:15]
    v_mfma_f32_16x16x32_bf16 v[240:243], v[48:51], v[80:83], 0
    v_mfma_f32_16x16x32_bf16 v[244:247], v[48:51], v[84:87], 0
    v_mfma_f32_16x16x32_bf16 v[248:251], v[48:51], v[88:91], 0
    v_mfma_f32_16x16x32_bf16 v[252:255], v[48:51], v[92:95], 0
    v_min_u32 v224, -2, v224
    v_mfma_f32_16x16x32_bf16 v[240:243], v[52:55], v[112:115], v[240:243]
    v_min_u32 v225, -2, v228
    v_mfma_f32_16x16x32_bf16 v[244:247], v[52:55], v[116:119], v[244:247]
    v_min_u32 v226, -2, v232
    v_mfma_f32_16x16x32_bf16 v[248:251], v[52:55], v[120:123], v[248:251]
    v_min_u32 v227, -2, v236
    v_mfma_f32_16x16x32_bf16 v[252:255], v[52:55], v[124:127], v[252:255]
    buffer_store_dwordx4 v[224:227], v0, s[44:47], s60 offen sc1
    v_mfma_f32_16x16x32_bf16 v[240:243], v[56:59], v[144:147], v[240:243]
    v_min_u32 v8, -2, v8
    v_mfma_f32_16x16x32_bf16 v[244:247], v[56:59], v[148:151], v[244:247]
    v_min_u32 v9, -2, v12
    v_mfma_f32_16x16x32_bf16 v[248:251], v[56:59], v[152:155], v[248:251]
    buffer_store_dwordx2 v[8:9], v1, s[44:47], s62 offen sc1
    v_mfma_f32_16x16x32_bf16 v[252:255], v[56:59], v[156:159], v[252:255]
    v_mfma_f32_16x16x32_bf16 v[240:243], v[60:63], v[176:179], v[240:243]
    v_mfma_f32_16x16x32_bf16 v[244:247], v[60:63], v[180:183], v[244:247]
    v_mfma_f32_16x16x32_bf16 v[248:251], v[60:63], v[184:187], v[248:251]
    v_mfma_f32_16x16x32_bf16 v[252:255], v[60:63], v[188:191], v[252:255]
    s_nop 4
    v_min_u32 v240, -2, v240
    v_min_u32 v241, -2, v244
    v_min_u32 v242, -2, v248
    v_min_u32 v243, -2, v252
    buffer_store_dwordx4 v[240:243], v0, s[44:47], s61 offen sc1
    s_endpgm
L_roleC_end:
L_exit:
    s_endpgm
.section .rodata,"a"
.p2align 6
.amdhsa_kernel concat_heads__mha_block_cached__compressed_kv_cla__decode_kernel
  .amdhsa_next_free_vgpr 512
  .amdhsa_next_free_sgpr 102
  .amdhsa_accum_offset 256
  .amdhsa_group_segment_fixed_size 0
  .amdhsa_kernarg_size 112
  .amdhsa_user_sgpr_count 2
  .amdhsa_user_sgpr_kernarg_segment_ptr 1
  .amdhsa_system_sgpr_workgroup_id_x 1
.end_amdhsa_kernel
```

```asm
; @launch grid=(256,1,1) block=(256,1,1) lds=163840
.amdgcn_target "amdgcn-amd-amdhsa--gfx950"
.text
.globl concat_heads__mha_block_cached__compressed_kv_cla__decode_kernel
.p2align 12
.p2align 8
.type concat_heads__mha_block_cached__compressed_kv_cla__decode_kernel,@function
concat_heads__mha_block_cached__compressed_kv_cla__decode_kernel:
    s_cmp_ge_u32 s2, 256
    s_cbranch_scc1 L_exit
    s_load_dwordx16 s[4:19], s[0:1], 0
    s_load_dwordx8 s[20:27], s[0:1], 64
    s_load_dwordx4 s[28:31], s[0:1], 96
    v_lshrrev_b32 v2, 6, v0
    v_and_b32 v1, 63, v0
    v_readfirstlane_b32 s3, v2
    v_and_b32 v3, 15, v0
    v_bfe_u32 v4, v0, 4, 2
    v_lshlrev_b32 v2, 4, v1
    s_and_b32 s52, s2, 31
    s_mov_b32 s53, s52
    s_cmp_lt_u32 s2, 32
    s_cbranch_scc1 L_roleH
    s_cmp_lt_u32 s2, 64
    s_cbranch_scc1 L_roleC
L_roleA:
    s_sub_u32 s54, s2, 64
    s_mul_hi_u32 s96, s54, 178956971
    s_mul_i32 s56, s96, 24
    s_sub_u32 s97, s54, s56
    s_lshr_b32 s55, s97, 3
    s_add_u32 s3, s3, s97
    s_add_u32 s3, s3, s55
    s_and_b32 s3, s3, 3
    s_add_u32 s56, s96, s3
    s_and_b32 s56, s56, 3
    s_lshr_b32 s55, s97, 3
    s_and_b32 s53, s97, 7
    s_lshl_b32 s96, s96, 2
    s_add_u32 s55, s55, s56
    s_add_u32 s55, s55, 1
    s_and_b32 s55, s55, 3
    s_add_u32 s52, s96, s55
    s_add_u32 s96, s96, s56
    s_lshl_b32 s100, s3, 25
    s_lshl_b32 s55, s52, 20
    s_add_u32 s100, s100, s55
    s_lshl_b32 s55, s53, 12
    s_add_u32 s100, s100, s55
    s_lshl_b32 s58, s52, 2
    s_add_u32 s58, s58, s3
    s_mul_i32 s58, s58, 163840
    s_add_u32 s59, s58, 1048576
    s_sub_u32 s61, s59, 65536
    s_and_b32 s99, s96, 28
    s_add_u32 s99, s99, s3
    s_mul_i32 s99, s99, 151552
    s_mov_b32 s63, s53
    s_getpc_b64 s[56:57]
L_pc_1:
    s_sub_u32 s56, s56, L_pc_1-L_roleA
    s_subb_u32 s57, s57, 0
    v_lshlrev_b32 v5, 7, v0
    v_min_u32 v6, L_roleA_end-L_roleA-4, v5
    global_load_dword v56, v6, s[56:57]
    s_mov_b32 s53, 536870912
    v_mov_b32 v18, s53
    v_cmp_eq_u32 vcc, 0, v1
    s_nop 1
    v_cndmask_b32 v18, v18, v1, vcc
    s_waitcnt lgkmcnt(0)
    s_mov_b32 s32, s6
    s_mov_b32 s33, s7
    s_mov_b32 s34, 134217728
    s_mov_b32 s35, 0x20000
    s_mov_b32 s36, s8
    s_mov_b32 s37, s9
    s_mov_b32 s38, 134217728
    s_mov_b32 s39, 0x20000
    s_mov_b32 s44, s30
    s_mov_b32 s45, s31
    s_mov_b32 s46, 536870912
    s_mov_b32 s47, 0x20000
    s_and_b32 s60, s58, 1015808
    s_or_b32 s60, s60, s100
    s_add_u32 s58, s58, 32768
    buffer_load_dwordx4 v[96:99], v2, s[32:35], s60 offen offset:0 nt
    buffer_load_dwordx4 v[100:103], v2, s[32:35], s60 offen offset:1024 nt
    buffer_load_dwordx4 v[104:107], v2, s[32:35], s60 offen offset:2048 nt
    buffer_load_dwordx4 v[108:111], v2, s[32:35], s60 offen offset:3072 nt
    buffer_load_dwordx4 a[32:35], v2, s[36:39], s60 offen offset:0 nt
    buffer_load_dwordx4 a[36:39], v2, s[36:39], s60 offen offset:1024 nt
    buffer_load_dwordx4 a[40:43], v2, s[36:39], s60 offen offset:2048 nt
    buffer_load_dwordx4 a[44:47], v2, s[36:39], s60 offen offset:3072 nt
    s_and_b32 s60, s58, 1015808
    s_or_b32 s60, s60, s100
    s_add_u32 s58, s58, 32768
    buffer_load_dwordx4 v[112:115], v2, s[32:35], s60 offen offset:0 nt
    buffer_load_dwordx4 v[116:119], v2, s[32:35], s60 offen offset:1024 nt
    buffer_load_dwordx4 v[120:123], v2, s[32:35], s60 offen offset:2048 nt
    buffer_load_dwordx4 v[124:127], v2, s[32:35], s60 offen offset:3072 nt
    buffer_load_dwordx4 a[48:51], v2, s[36:39], s60 offen offset:0 nt
    buffer_load_dwordx4 a[52:55], v2, s[36:39], s60 offen offset:1024 nt
    buffer_load_dwordx4 a[56:59], v2, s[36:39], s60 offen offset:2048 nt
    buffer_load_dwordx4 a[60:63], v2, s[36:39], s60 offen offset:3072 nt
    s_and_b32 s60, s58, 1015808
    s_or_b32 s60, s60, s100
    s_add_u32 s58, s58, 32768
    buffer_load_dwordx4 v[128:131], v2, s[32:35], s60 offen offset:0 nt
    buffer_load_dwordx4 v[132:135], v2, s[32:35], s60 offen offset:1024 nt
    buffer_load_dwordx4 v[136:139], v2, s[32:35], s60 offen offset:2048 nt
    buffer_load_dwordx4 v[140:143], v2, s[32:35], s60 offen offset:3072 nt
    buffer_load_dwordx4 a[64:67], v2, s[36:39], s60 offen offset:0 nt
    buffer_load_dwordx4 a[68:71], v2, s[36:39], s60 offen offset:1024 nt
    buffer_load_dwordx4 a[72:75], v2, s[36:39], s60 offen offset:2048 nt
    buffer_load_dwordx4 a[76:79], v2, s[36:39], s60 offen offset:3072 nt
    s_and_b32 s60, s58, 1015808
    s_or_b32 s60, s60, s100
    s_add_u32 s58, s58, 32768
    buffer_load_dwordx4 v[144:147], v2, s[32:35], s60 offen offset:0 nt
    buffer_load_dwordx4 v[148:151], v2, s[32:35], s60 offen offset:1024 nt
    buffer_load_dwordx4 v[152:155], v2, s[32:35], s60 offen offset:2048 nt
    buffer_load_dwordx4 v[156:159], v2, s[32:35], s60 offen offset:3072 nt
    buffer_load_dwordx4 a[80:83], v2, s[36:39], s60 offen offset:0 nt
    buffer_load_dwordx4 a[84:87], v2, s[36:39], s60 offen offset:1024 nt
    buffer_load_dwordx4 a[88:91], v2, s[36:39], s60 offen offset:2048 nt
    buffer_load_dwordx4 a[92:95], v2, s[36:39], s60 offen offset:3072 nt
    s_and_b32 s60, s58, 1015808
    s_or_b32 s60, s60, s100
    s_add_u32 s58, s58, 32768
    buffer_load_dwordx4 v[160:163], v2, s[32:35], s60 offen offset:0 nt
    buffer_load_dwordx4 v[164:167], v2, s[32:35], s60 offen offset:1024 nt
    buffer_load_dwordx4 v[168:171], v2, s[32:35], s60 offen offset:2048 nt
    buffer_load_dwordx4 v[172:175], v2, s[32:35], s60 offen offset:3072 nt
    buffer_load_dwordx4 a[96:99], v2, s[36:39], s60 offen offset:0 nt
    buffer_load_dwordx4 a[100:103], v2, s[36:39], s60 offen offset:1024 nt
    buffer_load_dwordx4 a[104:107], v2, s[36:39], s60 offen offset:2048 nt
    buffer_load_dwordx4 a[108:111], v2, s[36:39], s60 offen offset:3072 nt
    s_and_b32 s60, s58, 1015808
    s_or_b32 s60, s60, s100
    s_add_u32 s58, s58, 32768
    buffer_load_dwordx4 v[176:179], v2, s[32:35], s60 offen offset:0 nt
    buffer_load_dwordx4 v[180:183], v2, s[32:35], s60 offen offset:1024 nt
    buffer_load_dwordx4 v[184:187], v2, s[32:35], s60 offen offset:2048 nt
    buffer_load_dwordx4 v[188:191], v2, s[32:35], s60 offen offset:3072 nt
    buffer_load_dwordx4 a[112:115], v2, s[36:39], s60 offen offset:0 nt
    buffer_load_dwordx4 a[116:119], v2, s[36:39], s60 offen offset:1024 nt
    buffer_load_dwordx4 a[120:123], v2, s[36:39], s60 offen offset:2048 nt
    buffer_load_dwordx4 a[124:127], v2, s[36:39], s60 offen offset:3072 nt
    s_lshl_b32 s54, s52, 2
    s_lshl_b32 s55, s96, 2
    v_mov_b32 v58, s54
    v_mov_b32 v57, s55
    v_cndmask_b32 v58, v58, v57, vcc
    s_sub_u32 s23, s2, 64
    s_and_b32 s26, s23, 7
    s_lshr_b32 s23, s23, 3
    s_mul_i32 s27, s23, 43
    s_lshr_b32 s27, s27, 8
    s_lshl_b32 s26, s26, 2
    s_add_u32 s26, s26, s27
    s_mul_i32 s27, s27, 6
    s_sub_u32 s23, s23, s27
    s_lshl_b32 s27, s26, 2
    v_writelane_b32 v58, s27, 1
    s_load_dword s17, s[28:29], s27
    s_load_dword s18, s[28:29], s54
    s_load_dword s19, s[28:29], s55
    s_and_b32 s60, s58, 1015808
    s_or_b32 s60, s60, s100
    s_add_u32 s58, s58, 32768
    buffer_load_dwordx4 v[192:195], v2, s[32:35], s60 offen offset:0 nt
    buffer_load_dwordx4 v[196:199], v2, s[32:35], s60 offen offset:1024 nt
    buffer_load_dwordx4 v[200:203], v2, s[32:35], s60 offen offset:2048 nt
    buffer_load_dwordx4 v[204:207], v2, s[32:35], s60 offen offset:3072 nt
    buffer_load_dwordx4 a[128:131], v2, s[36:39], s60 offen offset:0 nt
    buffer_load_dwordx4 a[132:135], v2, s[36:39], s60 offen offset:1024 nt
    buffer_load_dwordx4 a[136:139], v2, s[36:39], s60 offen offset:2048 nt
    buffer_load_dwordx4 a[140:143], v2, s[36:39], s60 offen offset:3072 nt
    s_waitcnt vmcnt(48)
    s_and_b32 s60, s58, 1015808
    s_or_b32 s60, s60, s100
    s_add_u32 s58, s58, 32768
    buffer_load_dwordx4 v[208:211], v2, s[32:35], s60 offen offset:0 nt
    buffer_load_dwordx4 v[212:215], v2, s[32:35], s60 offen offset:1024 nt
    buffer_load_dwordx4 v[216:219], v2, s[32:35], s60 offen offset:2048 nt
    buffer_load_dwordx4 v[220:223], v2, s[32:35], s60 offen offset:3072 nt
    buffer_load_dwordx4 a[144:147], v2, s[36:39], s60 offen offset:0 nt
    buffer_load_dwordx4 a[148:151], v2, s[36:39], s60 offen offset:1024 nt
    buffer_load_dwordx4 a[152:155], v2, s[36:39], s60 offen offset:2048 nt
    buffer_load_dwordx4 a[156:159], v2, s[36:39], s60 offen offset:3072 nt
    s_waitcnt vmcnt(48)
    s_and_b32 s60, s58, 1015808
    s_or_b32 s60, s60, s100
    s_add_u32 s58, s58, 32768
    buffer_load_dwordx4 v[224:227], v2, s[32:35], s60 offen offset:0 nt
    buffer_load_dwordx4 v[228:231], v2, s[32:35], s60 offen offset:1024 nt
    buffer_load_dwordx4 v[232:235], v2, s[32:35], s60 offen offset:2048 nt
    buffer_load_dwordx4 v[236:239], v2, s[32:35], s60 offen offset:3072 nt
    buffer_load_dwordx4 a[160:163], v2, s[36:39], s60 offen offset:0 nt
    buffer_load_dwordx4 a[164:167], v2, s[36:39], s60 offen offset:1024 nt
    buffer_load_dwordx4 a[168:171], v2, s[36:39], s60 offen offset:2048 nt
    buffer_load_dwordx4 a[172:175], v2, s[36:39], s60 offen offset:3072 nt
    v_and_b32 v5, 1, v3
    v_cmp_eq_u32 vcc, 1, v5
    v_mov_b32 v5, 0xffff
    v_mov_b32 v6, 0xffff0000
    v_cndmask_b32 v5, v5, v6, vcc
    v_lshrrev_b32 v6, 1, v3
    v_cmp_eq_u32 vcc, 0, v6
    s_nop 1
    v_cndmask_b32 v8, 0, v5, vcc
    v_cmp_eq_u32 vcc, 1, v6
    s_nop 1
    v_cndmask_b32 v9, 0, v5, vcc
    v_cmp_eq_u32 vcc, 2, v6
    s_nop 1
    v_cndmask_b32 v10, 0, v5, vcc
    v_cmp_eq_u32 vcc, 3, v6
    s_nop 1
    v_cndmask_b32 v11, 0, v5, vcc
    s_bitcmp1_b32 s23, 0
    s_cselect_b32 s40, s24, s12
    s_cselect_b32 s41, s25, s13
    s_cselect_b32 s25, 524288, 0
    s_add_u32 s25, s25, 4194304
    s_mov_b32 s42, 4718592
    s_mov_b32 s43, 0x20000
    s_lshr_b32 s54, s23, 1
    s_mul_i32 s54, s54, 3
    s_add_u32 s54, s54, s3
    s_and_b32 s23, s23, 1
    s_mul_i32 s24, s26, 147456
    s_lshl_b32 s55, s54, 7
    s_add_u32 s24, s24, s55
    s_lshl_b32 s54, s54, 13
    s_lshl_b32 s55, s26, 7
    s_add_u32 s54, s54, s55
    s_add_u32 s25, s25, s54
    s_lshl_b32 s27, s26, 10
    s_add_u32 s27, s27, 5439488
    s_lshl_b32 s22, s26, 2
    s_add_u32 s22, s22, s3
    s_lshl_b32 s22, s22, 13
    s_add_u32 s22, s22, 8388608
    s_lshr_b32 s55, s26, 2
    s_add_u32 s55, s55, s3
    s_and_b32 s55, s55, 3
    s_and_b32 s54, s26, 3
    s_cmp_eq_u32 s54, s55
    s_cselect_b32 s54, 7, 1
    s_cselect_b32 s55, 5, 1
    s_cselect_b32 s26, 2, 0
    s_or_b32 s23, s23, s26
    v_and_b32 v30, s54, v3
    v_min_u32 v30, s55, v30
    v_lshl_add_u32 v30, v30, 2, v4
    v_lshlrev_b32 v30, 4, v30
    v_add_u32 v30, 6144, v30
    v_lshrrev_b32 v19, 3, v3
    v_lshl_add_u32 v19, v19, 2, v4
    v_mul_u32_u24 v19, 9216, v19
    v_and_b32 v5, 7, v3
    v_lshl_add_u32 v19, v5, 4, v19
    v_mov_b32 v12, 0
    v_mov_b32 v13, 0
    v_mov_b32 v14, 0
    v_mov_b32 v15, 0
    v_mov_b32 v16, 0xff800000
    v_mov_b32 v17, 0
    v_lshrrev_b32 v5, 1, v4
    v_lshlrev_b32 v59, 5, v3
    v_lshl_add_u32 v59, v5, 4, v59
    v_and_b32 v5, 1, v4
    v_lshl_add_u32 v59, v5, 11, v59
    s_lshl_b32 s54, s52, 2
    s_add_u32 s54, s54, s3
    s_lshl_b32 s54, s54, 13
    s_lshl_b32 s55, s96, 2
    s_add_u32 s55, s55, s3
    s_lshl_b32 s55, s55, 13
    v_cmp_eq_u32 vcc, 1, v5
    v_mov_b32 v6, s54
    v_mov_b32 v7, s55
    v_cndmask_b32 v6, v6, v7, vcc
    v_mov_b32 v20, s63
    v_mov_b32 v7, s97
    v_cndmask_b32 v7, v20, v7, vcc
    v_lshl_add_u32 v20, v7, 4, v3
    v_lshl_add_u32 v20, v20, 4, v6
    v_lshl_add_u32 v21, v7, 4, v6
    v_add_u32 v21, 6144, v21
    v_mov_b32 v7, s53
    v_cmp_eq_u32 vcc, 0, v3
    s_nop 1
    v_cndmask_b32 v21, v7, v21, vcc
    v_cmp_gt_u32 vcc, 32, v1
    s_nop 1
    v_cndmask_b32 v3, v21, v20, vcc
    s_mov_b32 s8, 1015808
    s_mov_b32 s9, s100
    s_mov_b32 s10, 0xff000
    s_lshl_b32 s11, s3, 25
    s_lshl_b32 s54, s96, 20
    s_add_u32 s11, s11, s54
    s_lshl_b32 s57, s96, 2
    s_add_u32 s57, s57, s3
    s_lshl_b32 s57, s57, 7
    s_add_u32 s57, s57, 5373952
    s_lshl_b32 s54, s3, 9
    s_add_u32 s54, s54, 5242880
    s_lshl_b32 s56, s52, 12
    s_add_u32 s56, s56, s54
    s_lshl_b32 s12, s96, 12
    s_add_u32 s12, s12, s54
    s_mov_b32 s13, 0
    s_add_u32 s15, s59, 65536
    s_sub_u32 s14, s15, 131072
    s_mov_b32 s96, 1035273459
    s_mov_b32 s97, 1069066811
    s_mov_b32 s98, 0xffff0000
    s_mov_b32 s62, 2
    s_mov_b32 s101, 100000
    s_waitcnt lgkmcnt(0)
    s_min_u32 s18, s18, s17
    s_min_u32 s18, s18, s19
    s_cmp_lt_u32 s18, 2
    s_cbranch_scc1 L_aflag
L_aflag_ok:
    s_cmp_eq_u32 s3, 3
    s_cselect_b32 s19, -1, 0x100000
    buffer_load_dwordx4 v[60:63], v59, s[44:47], s56 offen sc1
    s_waitcnt vmcnt(49)
    s_and_b32 s60, s58, 1015808
    s_or_b32 s60, s60, s100
    s_add_u32 s58, s58, 32768
    buffer_load_dwordx4 v[240:243], v2, s[32:35], s60 offen offset:0 nt
    buffer_load_dwordx4 v[244:247], v2, s[32:35], s60 offen offset:1024 nt
    buffer_load_dwordx4 v[248:251], v2, s[32:35], s60 offen offset:2048 nt
    buffer_load_dwordx4 v[252:255], v2, s[32:35], s60 offen offset:3072 nt
    buffer_load_dwordx4 a[176:179], v2, s[36:39], s60 offen offset:0 nt
    buffer_load_dwordx4 a[180:183], v2, s[36:39], s60 offen offset:1024 nt
    buffer_load_dwordx4 a[184:187], v2, s[36:39], s60 offen offset:2048 nt
    buffer_load_dwordx4 a[188:191], v2, s[36:39], s60 offen offset:3072 nt
    s_waitcnt vmcnt(49)
    buffer_atomic_add v48, v18, s[44:47], s53 offen sc0
    s_and_b32 s60, s58, 1015808
    s_or_b32 s60, s60, s100
    s_add_u32 s58, s58, 32768
    buffer_load_dwordx4 v[64:67], v2, s[32:35], s60 offen offset:0 nt
    buffer_load_dwordx4 v[68:71], v2, s[32:35], s60 offen offset:1024 nt
    buffer_load_dwordx4 v[72:75], v2, s[32:35], s60 offen offset:2048 nt
    buffer_load_dwordx4 v[76:79], v2, s[32:35], s60 offen offset:3072 nt
    buffer_load_dwordx4 a[0:3], v2, s[36:39], s60 offen offset:0 nt
    buffer_load_dwordx4 a[4:7], v2, s[36:39], s60 offen offset:1024 nt
    buffer_load_dwordx4 a[8:11], v2, s[36:39], s60 offen offset:2048 nt
    buffer_load_dwordx4 a[12:15], v2, s[36:39], s60 offen offset:3072 nt
    s_waitcnt vmcnt(50)
    buffer_atomic_add v49, v18, s[44:47], s53 offen sc0
    s_and_b32 s60, s58, 1015808
    s_or_b32 s60, s60, s100
    s_add_u32 s58, s58, 32768
    buffer_load_dwordx4 v[80:83], v2, s[32:35], s60 offen offset:0 nt
    buffer_load_dwordx4 v[84:87], v2, s[32:35], s60 offen offset:1024 nt
    buffer_load_dwordx4 v[88:91], v2, s[32:35], s60 offen offset:2048 nt
    buffer_load_dwordx4 v[92:95], v2, s[32:35], s60 offen offset:3072 nt
    buffer_load_dwordx4 a[16:19], v2, s[36:39], s60 offen offset:0 nt
    buffer_load_dwordx4 a[20:23], v2, s[36:39], s60 offen offset:1024 nt
    buffer_load_dwordx4 a[24:27], v2, s[36:39], s60 offen offset:2048 nt
    buffer_load_dwordx4 a[28:31], v2, s[36:39], s60 offen offset:3072 nt
    s_waitcnt vmcnt(26)
L_aq1:
    v_max3_u32 v20, v60, v61, v62
    v_max_u32 v20, v20, v63
    v_cmp_eq_u32 vcc, -1, v20
    s_cbranch_vccz L_aq1_ok
    buffer_load_dwordx4 v[60:63], v59, s[44:47], s56 offen sc1
    s_waitcnt vmcnt(0)
    s_sub_u32 s101, s101, 1
    s_cbranch_scc0 L_aq1
    s_mov_b32 s101, 0
L_aq1_ok:
    v_mov_b32 v20, v60
    v_mov_b32 v21, v61
    v_mov_b32 v22, v62
    v_mov_b32 v23, v63
    v_permlane16_swap_b32 v60, v20
    v_permlane16_swap_b32 v61, v21
    v_permlane16_swap_b32 v62, v22
    v_permlane16_swap_b32 v63, v23
    v_add_f32 v60, v60, v20
    v_add_f32 v61, v61, v21
    v_add_f32 v62, v62, v22
    v_add_f32 v63, v63, v23
    v_cvt_pk_bf16_f32 v4, v60, v61
    v_cvt_pk_bf16_f32 v5, v62, v63
    v_mov_b32 v6, v4
    v_mov_b32 v7, v5
    s_nop 0
    v_permlane32_swap_b32 v4, v6
    v_permlane32_swap_b32 v5, v7
    s_mov_b32 s56, 1
L_aloop:
    s_waitcnt vmcnt(13)
    v_dot2_f32_bf16 v20, v64, v4, 0
    v_dot2_f32_bf16 v21, v68, v4, 0
    v_dot2_f32_bf16 v22, v72, v4, 0
    v_dot2_f32_bf16 v23, v76, v4, 0
    v_dot2_f32_bf16 v20, v65, v5, v20
    v_dot2_f32_bf16 v21, v69, v5, v21
    v_dot2_f32_bf16 v22, v73, v5, v22
    v_dot2_f32_bf16 v23, v77, v5, v23
    v_dot2_f32_bf16 v20, v66, v6, v20
    v_dot2_f32_bf16 v21, v70, v6, v21
    v_dot2_f32_bf16 v22, v74, v6, v22
    v_dot2_f32_bf16 v23, v78, v6, v23
    v_dot2_f32_bf16 v20, v67, v7, v20
    v_dot2_f32_bf16 v21, v71, v7, v21
    v_dot2_f32_bf16 v22, v75, v7, v22
    v_dot2_f32_bf16 v23, v79, v7, v23
    v_readfirstlane_b32 s54, v48
    v_mov_b32 v48, 1
    s_cmp_ge_u32 s58, s61
    s_cselect_b32 s55, s57, s53
    s_lshl_b32 s54, s54, 12
    s_add_u32 s60, s54, s99
    s_cmp_lt_u32 s58, s59
    s_cselect_b32 s60, s58, s60
    s_cselect_b32 s54, 0, s54
    s_cselect_b64 s[6:7], s[8:9], s[10:11]
    s_cmp_ge_u32 s54, s19
    s_cbranch_scc1 L_adrain0
    s_add_u32 s58, s58, 32768
    s_and_b32 s60, s60, s6
    s_or_b32 s60, s60, s7
    s_cmp_lt_u32 s54, 0x100000
    s_cselect_b32 s60, s60, 0x8000000
    s_cselect_b32 s55, s55, s53
    s_addc_u32 s62, s62, -1
    buffer_atomic_add v48, v18, s[44:47], s55 offen sc0
    buffer_load_dwordx4 v[64:67], v2, s[32:35], s60 offen offset:0 nt
    buffer_load_dwordx4 v[68:71], v2, s[32:35], s60 offen offset:1024 nt
    buffer_load_dwordx4 v[72:75], v2, s[32:35], s60 offen offset:2048 nt
    buffer_load_dwordx4 v[76:79], v2, s[32:35], s60 offen offset:3072 nt
    v_add_f32_dpp v24, v20, v20 row_ror:8 row_mask:0xf bank_mask:0x3
    v_add_f32_dpp v25, v22, v22 row_ror:8 row_mask:0xf bank_mask:0x3
    v_add_f32_dpp v24, v21, v21 row_ror:8 row_mask:0xf bank_mask:0xc
    v_add_f32_dpp v25, v23, v23 row_ror:8 row_mask:0xf bank_mask:0xc
    s_nop 0
    v_add_f32_dpp v26, v24, v24 row_shl:4 row_mask:0xf bank_mask:0x5
    v_add_f32_dpp v26, v25, v25 row_shr:4 row_mask:0xf bank_mask:0xa
    s_nop 1
    v_add_f32_dpp v26, v26, v26 quad_perm:[1,0,3,2] row_mask:0xf bank_mask:0xf
    s_nop 1
    v_add_f32_dpp v26, v26, v26 quad_perm:[2,3,0,1] row_mask:0xf bank_mask:0xf
    v_cvt_pk_bf16_f32 v26, v26, v26
    v_and_b32 v26, s98, v26
    v_mul_f32 v26, s96, v26
    v_cvt_pk_bf16_f32 v26, v26, v26
    v_and_b32 v26, s98, v26
    s_nop 1
    v_max_f32_dpp v27, v26, v26 row_ror:4 row_mask:0xf bank_mask:0xf
    s_nop 1
    v_max_f32_dpp v27, v27, v27 row_ror:8 row_mask:0xf bank_mask:0xf
    v_mov_b32 v28, v27
    s_nop 1
    v_permlane16_swap_b32 v27, v28
    v_max_f32 v27, v27, v28
    v_mov_b32 v28, v27
    s_nop 1
    v_permlane32_swap_b32 v27, v28
    v_max3_f32 v27, v27, v28, v16
    v_sub_f32 v28, v16, v27
    v_sub_f32 v29, v26, v27
    v_mul_f32 v28, s97, v28
    v_mul_f32 v29, s97, v29
    v_exp_f32 v28, v28
    v_exp_f32 v29, v29
    v_mov_b32 v16, v27
    v_fma_f32 v17, v17, v28, v29
    v_cvt_pk_bf16_f32 v29, v29, v29
    v_mul_f32 v12, v12, v28
    v_mul_f32 v13, v13, v28
    v_mul_f32 v14, v14, v28
    v_mul_f32 v15, v15, v28
    s_waitcnt vmcnt(14)
    v_and_b32_dpp v32, v29, v8 row_newbcast:0 row_mask:0xf bank_mask:0xf
    v_and_b32_dpp v33, v29, v9 row_newbcast:0 row_mask:0xf bank_mask:0xf
    v_and_b32_dpp v34, v29, v10 row_newbcast:0 row_mask:0xf bank_mask:0xf
    v_and_b32_dpp v35, v29, v11 row_newbcast:0 row_mask:0xf bank_mask:0xf
    v_and_b32_dpp v36, v29, v8 row_newbcast:8 row_mask:0xf bank_mask:0xf
    v_and_b32_dpp v37, v29, v9 row_newbcast:8 row_mask:0xf bank_mask:0xf
    v_and_b32_dpp v38, v29, v10 row_newbcast:8 row_mask:0xf bank_mask:0xf
    v_and_b32_dpp v39, v29, v11 row_newbcast:8 row_mask:0xf bank_mask:0xf
    v_and_b32_dpp v40, v29, v8 row_newbcast:4 row_mask:0xf bank_mask:0xf
    v_and_b32_dpp v41, v29, v9 row_newbcast:4 row_mask:0xf bank_mask:0xf
    v_and_b32_dpp v42, v29, v10 row_newbcast:4 row_mask:0xf bank_mask:0xf
    v_and_b32_dpp v43, v29, v11 row_newbcast:4 row_mask:0xf bank_mask:0xf
    v_and_b32_dpp v44, v29, v8 row_newbcast:12 row_mask:0xf bank_mask:0xf
    v_and_b32_dpp v45, v29, v9 row_newbcast:12 row_mask:0xf bank_mask:0xf
    v_and_b32_dpp v46, v29, v10 row_newbcast:12 row_mask:0xf bank_mask:0xf
    v_and_b32_dpp v47, v29, v11 row_newbcast:12 row_mask:0xf bank_mask:0xf
    v_mfma_f32_16x16x32_bf16 v[12:15], v[32:35], a[0:3], v[12:15]
    v_mfma_f32_16x16x32_bf16 v[12:15], v[36:39], a[4:7], v[12:15]
    v_mfma_f32_16x16x32_bf16 v[12:15], v[40:43], a[8:11], v[12:15]
    v_mfma_f32_16x16x32_bf16 v[12:15], v[44:47], a[12:15], v[12:15]
    buffer_load_dwordx4 a[0:3], v2, s[36:39], s60 offen offset:0 nt
    buffer_load_dwordx4 a[4:7], v2, s[36:39], s60 offen offset:1024 nt
    buffer_load_dwordx4 a[8:11], v2, s[36:39], s60 offen offset:2048 nt
    buffer_load_dwordx4 a[12:15], v2, s[36:39], s60 offen offset:3072 nt
    s_cmp_eq_u32 s62, 0
    s_cbranch_scc1 L_adone
    s_cmp_lg_u32 s56, 0
    s_cbranch_scc1 L_aext0
L_aback0:
    s_waitcnt vmcnt(13)
    v_dot2_f32_bf16 v20, v80, v4, 0
    v_dot2_f32_bf16 v21, v84, v4, 0
    v_dot2_f32_bf16 v22, v88, v4, 0
    v_dot2_f32_bf16 v23, v92, v4, 0
    v_dot2_f32_bf16 v20, v81, v5, v20
    v_dot2_f32_bf16 v21, v85, v5, v21
    v_dot2_f32_bf16 v22, v89, v5, v22
    v_dot2_f32_bf16 v23, v93, v5, v23
    v_dot2_f32_bf16 v20, v82, v6, v20
    v_dot2_f32_bf16 v21, v86, v6, v21
    v_dot2_f32_bf16 v22, v90, v6, v22
    v_dot2_f32_bf16 v23, v94, v6, v23
    v_dot2_f32_bf16 v20, v83, v7, v20
    v_dot2_f32_bf16 v21, v87, v7, v21
    v_dot2_f32_bf16 v22, v91, v7, v22
    v_dot2_f32_bf16 v23, v95, v7, v23
    v_readfirstlane_b32 s54, v49
    v_mov_b32 v49, 1
    s_cmp_ge_u32 s58, s61
    s_cselect_b32 s55, s57, s53
    s_lshl_b32 s54, s54, 12
    s_add_u32 s60, s54, s99
    s_cmp_lt_u32 s58, s59
    s_cselect_b32 s60, s58, s60
    s_cselect_b32 s54, 0, s54
    s_cselect_b64 s[6:7], s[8:9], s[10:11]
    s_cmp_ge_u32 s54, s19
    s_cbranch_scc1 L_adrain1
    s_add_u32 s58, s58, 32768
    s_and_b32 s60, s60, s6
    s_or_b32 s60, s60, s7
    s_cmp_lt_u32 s54, 0x100000
    s_cselect_b32 s60, s60, 0x8000000
    s_cselect_b32 s55, s55, s53
    s_addc_u32 s62, s62, -1
    buffer_atomic_add v49, v18, s[44:47], s55 offen sc0
    buffer_load_dwordx4 v[80:83], v2, s[32:35], s60 offen offset:0 nt
    buffer_load_dwordx4 v[84:87], v2, s[32:35], s60 offen offset:1024 nt
    buffer_load_dwordx4 v[88:91], v2, s[32:35], s60 offen offset:2048 nt
    buffer_load_dwordx4 v[92:95], v2, s[32:35], s60 offen offset:3072 nt
    v_add_f32_dpp v24, v20, v20 row_ror:8 row_mask:0xf bank_mask:0x3
    v_add_f32_dpp v25, v22, v22 row_ror:8 row_mask:0xf bank_mask:0x3
    v_add_f32_dpp v24, v21, v21 row_ror:8 row_mask:0xf bank_mask:0xc
    v_add_f32_dpp v25, v23, v23 row_ror:8 row_mask:0xf bank_mask:0xc
    s_nop 0
    v_add_f32_dpp v26, v24, v24 row_shl:4 row_mask:0xf bank_mask:0x5
    v_add_f32_dpp v26, v25, v25 row_shr:4 row_mask:0xf bank_mask:0xa
    s_nop 1
    v_add_f32_dpp v26, v26, v26 quad_perm:[1,0,3,2] row_mask:0xf bank_mask:0xf
    s_nop 1
    v_add_f32_dpp v26, v26, v26 quad_perm:[2,3,0,1] row_mask:0xf bank_mask:0xf
    v_cvt_pk_bf16_f32 v26, v26, v26
    v_and_b32 v26, s98, v26
    v_mul_f32 v26, s96, v26
    v_cvt_pk_bf16_f32 v26, v26, v26
    v_and_b32 v26, s98, v26
    s_nop 1
    v_max_f32_dpp v27, v26, v26 row_ror:4 row_mask:0xf bank_mask:0xf
    s_nop 1
    v_max_f32_dpp v27, v27, v27 row_ror:8 row_mask:0xf bank_mask:0xf
    v_mov_b32 v28, v27
    s_nop 1
    v_permlane16_swap_b32 v27, v28
    v_max_f32 v27, v27, v28
    v_mov_b32 v28, v27
    s_nop 1
    v_permlane32_swap_b32 v27, v28
    v_max3_f32 v27, v27, v28, v16
    v_sub_f32 v28, v16, v27
    v_sub_f32 v29, v26, v27
    v_mul_f32 v28, s97, v28
    v_mul_f32 v29, s97, v29
    v_exp_f32 v28, v28
    v_exp_f32 v29, v29
    v_mov_b32 v16, v27
    v_fma_f32 v17, v17, v28, v29
    v_cvt_pk_bf16_f32 v29, v29, v29
    v_mul_f32 v12, v12, v28
    v_mul_f32 v13, v13, v28
    v_mul_f32 v14, v14, v28
    v_mul_f32 v15, v15, v28
    s_waitcnt vmcnt(14)
    v_and_b32_dpp v32, v29, v8 row_newbcast:0 row_mask:0xf bank_mask:0xf
    v_and_b32_dpp v33, v29, v9 row_newbcast:0 row_mask:0xf bank_mask:0xf
    v_and_b32_dpp v34, v29, v10 row_newbcast:0 row_mask:0xf bank_mask:0xf
    v_and_b32_dpp v35, v29, v11 row_newbcast:0 row_mask:0xf bank_mask:0xf
    v_and_b32_dpp v36, v29, v8 row_newbcast:8 row_mask:0xf bank_mask:0xf
    v_and_b32_dpp v37, v29, v9 row_newbcast:8 row_mask:0xf bank_mask:0xf
    v_and_b32_dpp v38, v29, v10 row_newbcast:8 row_mask:0xf bank_mask:0xf
    v_and_b32_dpp v39, v29, v11 row_newbcast:8 row_mask:0xf bank_mask:0xf
    v_and_b32_dpp v40, v29, v8 row_newbcast:4 row_mask:0xf bank_mask:0xf
    v_and_b32_dpp v41, v29, v9 row_newbcast:4 row_mask:0xf bank_mask:0xf
    v_and_b32_dpp v42, v29, v10 row_newbcast:4 row_mask:0xf bank_mask:0xf
    v_and_b32_dpp v43, v29, v11 row_newbcast:4 row_mask:0xf bank_mask:0xf
    v_and_b32_dpp v44, v29, v8 row_newbcast:12 row_mask:0xf bank_mask:0xf
    v_and_b32_dpp v45, v29, v9 row_newbcast:12 row_mask:0xf bank_mask:0xf
    v_and_b32_dpp v46, v29, v10 row_newbcast:12 row_mask:0xf bank_mask:0xf
    v_and_b32_dpp v47, v29, v11 row_newbcast:12 row_mask:0xf bank_mask:0xf
    v_mfma_f32_16x16x32_bf16 v[12:15], v[32:35], a[16:19], v[12:15]
    v_mfma_f32_16x16x32_bf16 v[12:15], v[36:39], a[20:23], v[12:15]
    v_mfma_f32_16x16x32_bf16 v[12:15], v[40:43], a[24:27], v[12:15]
    v_mfma_f32_16x16x32_bf16 v[12:15], v[44:47], a[28:31], v[12:15]
    buffer_load_dwordx4 a[16:19], v2, s[36:39], s60 offen offset:0 nt
    buffer_load_dwordx4 a[20:23], v2, s[36:39], s60 offen offset:1024 nt
    buffer_load_dwordx4 a[24:27], v2, s[36:39], s60 offen offset:2048 nt
    buffer_load_dwordx4 a[28:31], v2, s[36:39], s60 offen offset:3072 nt
    s_cmp_eq_u32 s62, 0
    s_cbranch_scc1 L_adone
    s_cmp_lg_u32 s56, 0
    s_cbranch_scc1 L_aext1
L_aback1:
    s_cmp_lg_u32 s58, s14
    s_cbranch_scc1 L_aloop
    s_cmp_eq_u32 s14, s15
    s_cbranch_scc1 L_aswitch
    buffer_load_dwordx4 v[60:63], v59, s[44:47], s12 offen sc1
    s_mov_b32 s14, s15
    s_branch L_aloop
L_aswitch:
    s_nop 11
    v_add_f32_dpp v17, v17, v17 row_ror:4 row_mask:0xf bank_mask:0xf
    s_nop 1
    v_add_f32_dpp v17, v17, v17 row_ror:8 row_mask:0xf bank_mask:0xf
    v_mov_b32 v28, v17
    s_nop 1
    v_permlane16_swap_b32 v17, v28
    v_add_f32 v17, v17, v28
    v_mov_b32 v28, v17
    s_nop 1
    v_permlane32_swap_b32 v17, v28
    v_add_f32 v51, v17, v28
    v_mov_b32 v50, v16
    v_cvt_pk_bf16_f32 v52, v12, v13
    v_cvt_pk_bf16_f32 v53, v14, v15
    v_mov_b32 v12, 0
    v_mov_b32 v13, 0
    v_mov_b32 v14, 0
    v_mov_b32 v15, 0
    v_mov_b32 v16, 0xff800000
    v_mov_b32 v17, 0
    s_mov_b32 s13, 1
    s_cmp_eq_u32 s62, 0
    s_cbranch_scc1 L_adone
L_aq2:
    v_max3_u32 v20, v60, v61, v62
    v_max_u32 v20, v20, v63
    v_cmp_eq_u32 vcc, -1, v20
    s_cbranch_vccz L_aq2_ok
    buffer_load_dwordx4 v[60:63], v59, s[44:47], s12 offen sc1
    s_waitcnt vmcnt(0)
    s_sub_u32 s101, s101, 1
    s_cbranch_scc0 L_aq2
    s_mov_b32 s101, 0
L_aq2_ok:
    v_mov_b32 v20, v60
    v_mov_b32 v21, v61
    v_mov_b32 v22, v62
    v_mov_b32 v23, v63
    v_permlane16_swap_b32 v60, v20
    v_permlane16_swap_b32 v61, v21
    v_permlane16_swap_b32 v62, v22
    v_permlane16_swap_b32 v63, v23
    v_add_f32 v60, v60, v20
    v_add_f32 v61, v61, v21
    v_add_f32 v62, v62, v22
    v_add_f32 v63, v63, v23
    v_cvt_pk_bf16_f32 v4, v60, v61
    v_cvt_pk_bf16_f32 v5, v62, v63
    v_mov_b32 v6, v4
    v_mov_b32 v7, v5
    s_nop 0
    v_permlane32_swap_b32 v4, v6
    v_permlane32_swap_b32 v5, v7
    s_cmp_lg_u32 s62, 3
    s_cbranch_scc1 L_aloop
    s_branch L_alast0
L_adrain1:
    buffer_load_dwordx4 v[128:131], v19, s[40:43], s24 offen offset:0 nt
    buffer_load_dwordx4 v[132:135], v19, s[40:43], s24 offen offset:1152 nt
    buffer_load_dwordx4 v[136:139], v19, s[40:43], s24 offen offset:2304 nt
    buffer_load_dwordx4 v[140:143], v19, s[40:43], s24 offen offset:3456 nt
    s_add_u32 s24, s24, 4608
    buffer_load_dwordx4 v[144:147], v19, s[40:43], s24 offen offset:0 nt
    buffer_load_dwordx4 v[148:151], v19, s[40:43], s24 offen offset:1152 nt
    buffer_load_dwordx4 v[152:155], v19, s[40:43], s24 offen offset:2304 nt
    buffer_load_dwordx4 v[156:159], v19, s[40:43], s24 offen offset:3456 nt
    s_add_u32 s24, s24, 69120
    v_add_f32_dpp v24, v20, v20 row_ror:8 row_mask:0xf bank_mask:0x3
    v_add_f32_dpp v25, v22, v22 row_ror:8 row_mask:0xf bank_mask:0x3
    v_add_f32_dpp v24, v21, v21 row_ror:8 row_mask:0xf bank_mask:0xc
    v_add_f32_dpp v25, v23, v23 row_ror:8 row_mask:0xf bank_mask:0xc
    s_nop 0
    v_add_f32_dpp v26, v24, v24 row_shl:4 row_mask:0xf bank_mask:0x5
    v_add_f32_dpp v26, v25, v25 row_shr:4 row_mask:0xf bank_mask:0xa
    s_nop 1
    v_add_f32_dpp v26, v26, v26 quad_perm:[1,0,3,2] row_mask:0xf bank_mask:0xf
    s_nop 1
    v_add_f32_dpp v26, v26, v26 quad_perm:[2,3,0,1] row_mask:0xf bank_mask:0xf
    v_cvt_pk_bf16_f32 v26, v26, v26
    v_and_b32 v26, s98, v26
    v_mul_f32 v26, s96, v26
    v_cvt_pk_bf16_f32 v26, v26, v26
    v_and_b32 v26, s98, v26
    s_nop 1
    v_max_f32_dpp v27, v26, v26 row_ror:4 row_mask:0xf bank_mask:0xf
    s_nop 1
    v_max_f32_dpp v27, v27, v27 row_ror:8 row_mask:0xf bank_mask:0xf
    v_mov_b32 v28, v27
    s_nop 1
    v_permlane16_swap_b32 v27, v28
    v_max_f32 v27, v27, v28
    v_mov_b32 v28, v27
    s_nop 1
    v_permlane32_swap_b32 v27, v28
    v_max3_f32 v27, v27, v28, v16
    v_sub_f32 v28, v16, v27
    v_sub_f32 v29, v26, v27
    v_mul_f32 v28, s97, v28
    v_mul_f32 v29, s97, v29
    v_exp_f32 v28, v28
    v_exp_f32 v29, v29
    v_mov_b32 v16, v27
    v_fma_f32 v17, v17, v28, v29
    v_cvt_pk_bf16_f32 v29, v29, v29
    v_mul_f32 v12, v12, v28
    v_mul_f32 v13, v13, v28
    v_mul_f32 v14, v14, v28
    v_mul_f32 v15, v15, v28
    s_waitcnt vmcnt(17)
    v_and_b32_dpp v32, v29, v8 row_newbcast:0 row_mask:0xf bank_mask:0xf
    v_and_b32_dpp v33, v29, v9 row_newbcast:0 row_mask:0xf bank_mask:0xf
    v_and_b32_dpp v34, v29, v10 row_newbcast:0 row_mask:0xf bank_mask:0xf
    v_and_b32_dpp v35, v29, v11 row_newbcast:0 row_mask:0xf bank_mask:0xf
    v_and_b32_dpp v36, v29, v8 row_newbcast:8 row_mask:0xf bank_mask:0xf
    v_and_b32_dpp v37, v29, v9 row_newbcast:8 row_mask:0xf bank_mask:0xf
    v_and_b32_dpp v38, v29, v10 row_newbcast:8 row_mask:0xf bank_mask:0xf
    v_and_b32_dpp v39, v29, v11 row_newbcast:8 row_mask:0xf bank_mask:0xf
    v_and_b32_dpp v40, v29, v8 row_newbcast:4 row_mask:0xf bank_mask:0xf
    v_and_b32_dpp v41, v29, v9 row_newbcast:4 row_mask:0xf bank_mask:0xf
    v_and_b32_dpp v42, v29, v10 row_newbcast:4 row_mask:0xf bank_mask:0xf
    v_and_b32_dpp v43, v29, v11 row_newbcast:4 row_mask:0xf bank_mask:0xf
    v_and_b32_dpp v44, v29, v8 row_newbcast:12 row_mask:0xf bank_mask:0xf
    v_and_b32_dpp v45, v29, v9 row_newbcast:12 row_mask:0xf bank_mask:0xf
    v_and_b32_dpp v46, v29, v10 row_newbcast:12 row_mask:0xf bank_mask:0xf
    v_and_b32_dpp v47, v29, v11 row_newbcast:12 row_mask:0xf bank_mask:0xf
    v_mfma_f32_16x16x32_bf16 v[12:15], v[32:35], a[16:19], v[12:15]
    v_mfma_f32_16x16x32_bf16 v[12:15], v[36:39], a[20:23], v[12:15]
    v_mfma_f32_16x16x32_bf16 v[12:15], v[40:43], a[24:27], v[12:15]
    v_mfma_f32_16x16x32_bf16 v[12:15], v[44:47], a[28:31], v[12:15]
    s_mov_b32 s62, 3
    s_cmp_eq_u32 s13, 0
    s_cbranch_scc1 L_aswitch
L_alast0:
    s_waitcnt vmcnt(12)
    v_dot2_f32_bf16 v20, v64, v4, 0
    v_dot2_f32_bf16 v21, v68, v4, 0
    v_dot2_f32_bf16 v22, v72, v4, 0
    v_dot2_f32_bf16 v23, v76, v4, 0
    v_dot2_f32_bf16 v20, v65, v5, v20
    v_dot2_f32_bf16 v21, v69, v5, v21
    v_dot2_f32_bf16 v22, v73, v5, v22
    v_dot2_f32_bf16 v23, v77, v5, v23
    v_dot2_f32_bf16 v20, v66, v6, v20
    v_dot2_f32_bf16 v21, v70, v6, v21
    v_dot2_f32_bf16 v22, v74, v6, v22
    v_dot2_f32_bf16 v23, v78, v6, v23
    v_dot2_f32_bf16 v20, v67, v7, v20
    v_dot2_f32_bf16 v21, v71, v7, v21
    v_dot2_f32_bf16 v22, v75, v7, v22
    v_dot2_f32_bf16 v23, v79, v7, v23
    buffer_load_dwordx4 v[160:163], v19, s[40:43], s24 offen offset:0 nt
    buffer_load_dwordx4 v[164:167], v19, s[40:43], s24 offen offset:1152 nt
    buffer_load_dwordx4 v[168:171], v19, s[40:43], s24 offen offset:2304 nt
    buffer_load_dwordx4 v[172:175], v19, s[40:43], s24 offen offset:3456 nt
    s_add_u32 s24, s24, 4608
    buffer_load_dwordx4 v[176:179], v19, s[40:43], s24 offen offset:0 nt
    buffer_load_dwordx4 v[180:183], v19, s[40:43], s24 offen offset:1152 nt
    buffer_load_dwordx4 v[184:187], v19, s[40:43], s24 offen offset:2304 nt
    buffer_load_dwordx4 v[188:191], v19, s[40:43], s24 offen offset:3456 nt
    v_add_f32_dpp v24, v20, v20 row_ror:8 row_mask:0xf bank_mask:0x3
    v_add_f32_dpp v25, v22, v22 row_ror:8 row_mask:0xf bank_mask:0x3
    v_add_f32_dpp v24, v21, v21 row_ror:8 row_mask:0xf bank_mask:0xc
    v_add_f32_dpp v25, v23, v23 row_ror:8 row_mask:0xf bank_mask:0xc
    s_nop 0
    v_add_f32_dpp v26, v24, v24 row_shl:4 row_mask:0xf bank_mask:0x5
    v_add_f32_dpp v26, v25, v25 row_shr:4 row_mask:0xf bank_mask:0xa
    s_nop 1
    v_add_f32_dpp v26, v26, v26 quad_perm:[1,0,3,2] row_mask:0xf bank_mask:0xf
    s_nop 1
    v_add_f32_dpp v26, v26, v26 quad_perm:[2,3,0,1] row_mask:0xf bank_mask:0xf
    v_cvt_pk_bf16_f32 v26, v26, v26
    v_and_b32 v26, s98, v26
    v_mul_f32 v26, s96, v26
    v_cvt_pk_bf16_f32 v26, v26, v26
    v_and_b32 v26, s98, v26
    s_nop 1
    v_max_f32_dpp v27, v26, v26 row_ror:4 row_mask:0xf bank_mask:0xf
    s_nop 1
    v_max_f32_dpp v27, v27, v27 row_ror:8 row_mask:0xf bank_mask:0xf
    v_mov_b32 v28, v27
    s_nop 1
    v_permlane16_swap_b32 v27, v28
    v_max_f32 v27, v27, v28
    v_mov_b32 v28, v27
    s_nop 1
    v_permlane32_swap_b32 v27, v28
    v_max3_f32 v27, v27, v28, v16
    v_sub_f32 v28, v16, v27
    v_sub_f32 v29, v26, v27
    v_mul_f32 v28, s97, v28
    v_mul_f32 v29, s97, v29
    v_exp_f32 v28, v28
    v_exp_f32 v29, v29
    v_mov_b32 v16, v27
    v_fma_f32 v17, v17, v28, v29
    v_cvt_pk_bf16_f32 v29, v29, v29
    v_mul_f32 v12, v12, v28
    v_mul_f32 v13, v13, v28
    v_mul_f32 v14, v14, v28
    v_mul_f32 v15, v15, v28
    s_waitcnt vmcnt(16)
    v_and_b32_dpp v32, v29, v8 row_newbcast:0 row_mask:0xf bank_mask:0xf
    v_and_b32_dpp v33, v29, v9 row_newbcast:0 row_mask:0xf bank_mask:0xf
    v_and_b32_dpp v34, v29, v10 row_newbcast:0 row_mask:0xf bank_mask:0xf
    v_and_b32_dpp v35, v29, v11 row_newbcast:0 row_mask:0xf bank_mask:0xf
    v_and_b32_dpp v36, v29, v8 row_newbcast:8 row_mask:0xf bank_mask:0xf
    v_and_b32_dpp v37, v29, v9 row_newbcast:8 row_mask:0xf bank_mask:0xf
    v_and_b32_dpp v38, v29, v10 row_newbcast:8 row_mask:0xf bank_mask:0xf
    v_and_b32_dpp v39, v29, v11 row_newbcast:8 row_mask:0xf bank_mask:0xf
    v_and_b32_dpp v40, v29, v8 row_newbcast:4 row_mask:0xf bank_mask:0xf
    v_and_b32_dpp v41, v29, v9 row_newbcast:4 row_mask:0xf bank_mask:0xf
    v_and_b32_dpp v42, v29, v10 row_newbcast:4 row_mask:0xf bank_mask:0xf
    v_and_b32_dpp v43, v29, v11 row_newbcast:4 row_mask:0xf bank_mask:0xf
    v_and_b32_dpp v44, v29, v8 row_newbcast:12 row_mask:0xf bank_mask:0xf
    v_and_b32_dpp v45, v29, v9 row_newbcast:12 row_mask:0xf bank_mask:0xf
    v_and_b32_dpp v46, v29, v10 row_newbcast:12 row_mask:0xf bank_mask:0xf
    v_and_b32_dpp v47, v29, v11 row_newbcast:12 row_mask:0xf bank_mask:0xf
    v_mfma_f32_16x16x32_bf16 v[12:15], v[32:35], a[0:3], v[12:15]
    v_mfma_f32_16x16x32_bf16 v[12:15], v[36:39], a[4:7], v[12:15]
    v_mfma_f32_16x16x32_bf16 v[12:15], v[40:43], a[8:11], v[12:15]
    v_mfma_f32_16x16x32_bf16 v[12:15], v[44:47], a[12:15], v[12:15]
    s_nop 3
    s_branch L_adone2
L_adrain0:
    buffer_load_dwordx4 v[128:131], v19, s[40:43], s24 offen offset:0 nt
    buffer_load_dwordx4 v[132:135], v19, s[40:43], s24 offen offset:1152 nt
    buffer_load_dwordx4 v[136:139], v19, s[40:43], s24 offen offset:2304 nt
    buffer_load_dwordx4 v[140:143], v19, s[40:43], s24 offen offset:3456 nt
    s_add_u32 s24, s24, 4608
    buffer_load_dwordx4 v[144:147], v19, s[40:43], s24 offen offset:0 nt
    buffer_load_dwordx4 v[148:151], v19, s[40:43], s24 offen offset:1152 nt
    buffer_load_dwordx4 v[152:155], v19, s[40:43], s24 offen offset:2304 nt
    buffer_load_dwordx4 v[156:159], v19, s[40:43], s24 offen offset:3456 nt
    s_add_u32 s24, s24, 69120
    v_add_f32_dpp v24, v20, v20 row_ror:8 row_mask:0xf bank_mask:0x3
    v_add_f32_dpp v25, v22, v22 row_ror:8 row_mask:0xf bank_mask:0x3
    v_add_f32_dpp v24, v21, v21 row_ror:8 row_mask:0xf bank_mask:0xc
    v_add_f32_dpp v25, v23, v23 row_ror:8 row_mask:0xf bank_mask:0xc
    s_nop 0
    v_add_f32_dpp v26, v24, v24 row_shl:4 row_mask:0xf bank_mask:0x5
    v_add_f32_dpp v26, v25, v25 row_shr:4 row_mask:0xf bank_mask:0xa
    s_nop 1
    v_add_f32_dpp v26, v26, v26 quad_perm:[1,0,3,2] row_mask:0xf bank_mask:0xf
    s_nop 1
    v_add_f32_dpp v26, v26, v26 quad_perm:[2,3,0,1] row_mask:0xf bank_mask:0xf
    v_cvt_pk_bf16_f32 v26, v26, v26
    v_and_b32 v26, s98, v26
    v_mul_f32 v26, s96, v26
    v_cvt_pk_bf16_f32 v26, v26, v26
    v_and_b32 v26, s98, v26
    s_nop 1
    v_max_f32_dpp v27, v26, v26 row_ror:4 row_mask:0xf bank_mask:0xf
    s_nop 1
    v_max_f32_dpp v27, v27, v27 row_ror:8 row_mask:0xf bank_mask:0xf
    v_mov_b32 v28, v27
    s_nop 1
    v_permlane16_swap_b32 v27, v28
    v_max_f32 v27, v27, v28
    v_mov_b32 v28, v27
    s_nop 1
    v_permlane32_swap_b32 v27, v28
    v_max3_f32 v27, v27, v28, v16
    v_sub_f32 v28, v16, v27
    v_sub_f32 v29, v26, v27
    v_mul_f32 v28, s97, v28
    v_mul_f32 v29, s97, v29
    v_exp_f32 v28, v28
    v_exp_f32 v29, v29
    v_mov_b32 v16, v27
    v_fma_f32 v17, v17, v28, v29
    v_cvt_pk_bf16_f32 v29, v29, v29
    v_mul_f32 v12, v12, v28
    v_mul_f32 v13, v13, v28
    v_mul_f32 v14, v14, v28
    v_mul_f32 v15, v15, v28
    s_waitcnt vmcnt(17)
    v_and_b32_dpp v32, v29, v8 row_newbcast:0 row_mask:0xf bank_mask:0xf
    v_and_b32_dpp v33, v29, v9 row_newbcast:0 row_mask:0xf bank_mask:0xf
    v_and_b32_dpp v34, v29, v10 row_newbcast:0 row_mask:0xf bank_mask:0xf
    v_and_b32_dpp v35, v29, v11 row_newbcast:0 row_mask:0xf bank_mask:0xf
    v_and_b32_dpp v36, v29, v8 row_newbcast:8 row_mask:0xf bank_mask:0xf
    v_and_b32_dpp v37, v29, v9 row_newbcast:8 row_mask:0xf bank_mask:0xf
    v_and_b32_dpp v38, v29, v10 row_newbcast:8 row_mask:0xf bank_mask:0xf
    v_and_b32_dpp v39, v29, v11 row_newbcast:8 row_mask:0xf bank_mask:0xf
    v_and_b32_dpp v40, v29, v8 row_newbcast:4 row_mask:0xf bank_mask:0xf
    v_and_b32_dpp v41, v29, v9 row_newbcast:4 row_mask:0xf bank_mask:0xf
    v_and_b32_dpp v42, v29, v10 row_newbcast:4 row_mask:0xf bank_mask:0xf
    v_and_b32_dpp v43, v29, v11 row_newbcast:4 row_mask:0xf bank_mask:0xf
    v_and_b32_dpp v44, v29, v8 row_newbcast:12 row_mask:0xf bank_mask:0xf
    v_and_b32_dpp v45, v29, v9 row_newbcast:12 row_mask:0xf bank_mask:0xf
    v_and_b32_dpp v46, v29, v10 row_newbcast:12 row_mask:0xf bank_mask:0xf
    v_and_b32_dpp v47, v29, v11 row_newbcast:12 row_mask:0xf bank_mask:0xf
    v_mfma_f32_16x16x32_bf16 v[12:15], v[32:35], a[0:3], v[12:15]
    v_mfma_f32_16x16x32_bf16 v[12:15], v[36:39], a[4:7], v[12:15]
    v_mfma_f32_16x16x32_bf16 v[12:15], v[40:43], a[8:11], v[12:15]
    v_mfma_f32_16x16x32_bf16 v[12:15], v[44:47], a[12:15], v[12:15]
    s_waitcnt vmcnt(12)
    v_dot2_f32_bf16 v20, v80, v4, 0
    v_dot2_f32_bf16 v21, v84, v4, 0
    v_dot2_f32_bf16 v22, v88, v4, 0
    v_dot2_f32_bf16 v23, v92, v4, 0
    v_dot2_f32_bf16 v20, v81, v5, v20
    v_dot2_f32_bf16 v21, v85, v5, v21
    v_dot2_f32_bf16 v22, v89, v5, v22
    v_dot2_f32_bf16 v23, v93, v5, v23
    v_dot2_f32_bf16 v20, v82, v6, v20
    v_dot2_f32_bf16 v21, v86, v6, v21
    v_dot2_f32_bf16 v22, v90, v6, v22
    v_dot2_f32_bf16 v23, v94, v6, v23
    v_dot2_f32_bf16 v20, v83, v7, v20
    v_dot2_f32_bf16 v21, v87, v7, v21
    v_dot2_f32_bf16 v22, v91, v7, v22
    v_dot2_f32_bf16 v23, v95, v7, v23
    buffer_load_dwordx4 v[160:163], v19, s[40:43], s24 offen offset:0 nt
    buffer_load_dwordx4 v[164:167], v19, s[40:43], s24 offen offset:1152 nt
    buffer_load_dwordx4 v[168:171], v19, s[40:43], s24 offen offset:2304 nt
    buffer_load_dwordx4 v[172:175], v19, s[40:43], s24 offen offset:3456 nt
    s_add_u32 s24, s24, 4608
    buffer_load_dwordx4 v[176:179], v19, s[40:43], s24 offen offset:0 nt
    buffer_load_dwordx4 v[180:183], v19, s[40:43], s24 offen offset:1152 nt
    buffer_load_dwordx4 v[184:187], v19, s[40:43], s24 offen offset:2304 nt
    buffer_load_dwordx4 v[188:191], v19, s[40:43], s24 offen offset:3456 nt
    v_add_f32_dpp v24, v20, v20 row_ror:8 row_mask:0xf bank_mask:0x3
    v_add_f32_dpp v25, v22, v22 row_ror:8 row_mask:0xf bank_mask:0x3
    v_add_f32_dpp v24, v21, v21 row_ror:8 row_mask:0xf bank_mask:0xc
    v_add_f32_dpp v25, v23, v23 row_ror:8 row_mask:0xf bank_mask:0xc
    s_nop 0
    v_add_f32_dpp v26, v24, v24 row_shl:4 row_mask:0xf bank_mask:0x5
    v_add_f32_dpp v26, v25, v25 row_shr:4 row_mask:0xf bank_mask:0xa
    s_nop 1
    v_add_f32_dpp v26, v26, v26 quad_perm:[1,0,3,2] row_mask:0xf bank_mask:0xf
    s_nop 1
    v_add_f32_dpp v26, v26, v26 quad_perm:[2,3,0,1] row_mask:0xf bank_mask:0xf
    v_cvt_pk_bf16_f32 v26, v26, v26
    v_and_b32 v26, s98, v26
    v_mul_f32 v26, s96, v26
    v_cvt_pk_bf16_f32 v26, v26, v26
    v_and_b32 v26, s98, v26
    s_nop 1
    v_max_f32_dpp v27, v26, v26 row_ror:4 row_mask:0xf bank_mask:0xf
    s_nop 1
    v_max_f32_dpp v27, v27, v27 row_ror:8 row_mask:0xf bank_mask:0xf
    v_mov_b32 v28, v27
    s_nop 1
    v_permlane16_swap_b32 v27, v28
    v_max_f32 v27, v27, v28
    v_mov_b32 v28, v27
    s_nop 1
    v_permlane32_swap_b32 v27, v28
    v_max3_f32 v27, v27, v28, v16
    v_sub_f32 v28, v16, v27
    v_sub_f32 v29, v26, v27
    v_mul_f32 v28, s97, v28
    v_mul_f32 v29, s97, v29
    v_exp_f32 v28, v28
    v_exp_f32 v29, v29
    v_mov_b32 v16, v27
    v_fma_f32 v17, v17, v28, v29
    v_cvt_pk_bf16_f32 v29, v29, v29
    v_mul_f32 v12, v12, v28
    v_mul_f32 v13, v13, v28
    v_mul_f32 v14, v14, v28
    v_mul_f32 v15, v15, v28
    s_waitcnt vmcnt(16)
    v_and_b32_dpp v32, v29, v8 row_newbcast:0 row_mask:0xf bank_mask:0xf
    v_and_b32_dpp v33, v29, v9 row_newbcast:0 row_mask:0xf bank_mask:0xf
    v_and_b32_dpp v34, v29, v10 row_newbcast:0 row_mask:0xf bank_mask:0xf
    v_and_b32_dpp v35, v29, v11 row_newbcast:0 row_mask:0xf bank_mask:0xf
    v_and_b32_dpp v36, v29, v8 row_newbcast:8 row_mask:0xf bank_mask:0xf
    v_and_b32_dpp v37, v29, v9 row_newbcast:8 row_mask:0xf bank_mask:0xf
    v_and_b32_dpp v38, v29, v10 row_newbcast:8 row_mask:0xf bank_mask:0xf
    v_and_b32_dpp v39, v29, v11 row_newbcast:8 row_mask:0xf bank_mask:0xf
    v_and_b32_dpp v40, v29, v8 row_newbcast:4 row_mask:0xf bank_mask:0xf
    v_and_b32_dpp v41, v29, v9 row_newbcast:4 row_mask:0xf bank_mask:0xf
    v_and_b32_dpp v42, v29, v10 row_newbcast:4 row_mask:0xf bank_mask:0xf
    v_and_b32_dpp v43, v29, v11 row_newbcast:4 row_mask:0xf bank_mask:0xf
    v_and_b32_dpp v44, v29, v8 row_newbcast:12 row_mask:0xf bank_mask:0xf
    v_and_b32_dpp v45, v29, v9 row_newbcast:12 row_mask:0xf bank_mask:0xf
    v_and_b32_dpp v46, v29, v10 row_newbcast:12 row_mask:0xf bank_mask:0xf
    v_and_b32_dpp v47, v29, v11 row_newbcast:12 row_mask:0xf bank_mask:0xf
    v_mfma_f32_16x16x32_bf16 v[12:15], v[32:35], a[16:19], v[12:15]
    v_mfma_f32_16x16x32_bf16 v[12:15], v[36:39], a[20:23], v[12:15]
    v_mfma_f32_16x16x32_bf16 v[12:15], v[40:43], a[24:27], v[12:15]
    v_mfma_f32_16x16x32_bf16 v[12:15], v[44:47], a[28:31], v[12:15]
    s_mov_b32 s62, 0
L_adone:
    s_cmp_eq_u32 s13, 0
    s_cbranch_scc1 L_aswitch
L_adone2:
    v_add_f32_dpp v17, v17, v17 row_ror:4 row_mask:0xf bank_mask:0xf
    s_nop 1
    v_add_f32_dpp v17, v17, v17 row_ror:8 row_mask:0xf bank_mask:0xf
    v_mov_b32 v28, v17
    s_nop 1
    v_permlane16_swap_b32 v17, v28
    v_add_f32 v17, v17, v28
    v_mov_b32 v28, v17
    s_nop 1
    v_permlane32_swap_b32 v17, v28
    v_add_f32 v17, v17, v28
    v_cvt_pk_bf16_f32 v54, v12, v13
    v_cvt_pk_bf16_f32 v55, v14, v15
    v_cmp_gt_u32 vcc, 48, v1
    s_nop 1
    v_cndmask_b32 v16, v16, v50, vcc
    v_cndmask_b32 v17, v17, v51, vcc
    v_permlane16_swap_b32 v52, v54
    v_permlane16_swap_b32 v53, v55
    v_cmp_gt_u32 vcc, 32, v1
    s_nop 1
    v_cndmask_b32 v52, v16, v52, vcc
    v_cndmask_b32 v53, v17, v53, vcc
    v_cndmask_b32 v54, v16, v54, vcc
    v_cndmask_b32 v55, v17, v55, vcc
    v_min_u32 v52, -2, v52
    v_min_u32 v53, -2, v53
    v_min_u32 v54, -2, v54
    v_min_u32 v55, -2, v55
    s_mov_b32 s54, 8388608
    buffer_store_dwordx4 v[52:55], v3, s[44:47], s54 offen sc1
    s_mov_b32 s58, s22
    s_add_u32 s59, s22, 4096
    s_cmp_eq_u32 s23, 2
    s_cbranch_scc1 L_eshared
    s_cmp_lg_u32 s23, 0
    s_cbranch_scc1 L_epiB
    buffer_load_dwordx4 v[40:43], v30, s[44:47], s58 offen sc1
    buffer_load_dwordx4 v[192:195], v2, s[44:47], s58 offen offset:0 sc1
    buffer_load_dwordx4 v[196:199], v2, s[44:47], s58 offen offset:1024 sc1
    v_and_b32 v3, 15, v1
    v_lshrrev_b32 v4, 4, v1
    s_mov_b32 s60, 0x05040100
    s_mov_b32 s61, 0x07060302
    v_mul_u32_u24 v0, 73728, v4
    v_bfe_u32 v5, v1, 2, 1
    v_lshl_add_u32 v0, v5, 12, v0
    v_and_b32 v5, 3, v1
    v_lshl_add_u32 v0, v5, 5, v0
    v_bfe_u32 v5, v1, 3, 1
    v_lshl_add_u32 v0, v5, 4, v0
    s_lshl_b32 s54, s3, 9
    v_lshl_add_u32 v5, v3, 4, s54
    v_and_b32 v6, 1, v4
    v_lshl_add_u32 v5, v6, 3, v5
    v_lshrrev_b32 v6, 1, v4
    v_lshl_add_u32 v5, v6, 8, v5
    v_lshrrev_b32 v7, 2, v3
    v_lshlrev_b32 v7, 9, v7
    v_lshl_add_u32 v7, v4, 4, v7
    v_and_b32 v6, 1, v1
    v_lshl_add_u32 v7, v6, 6, v7
    v_and_b32 v6, 1, v3
    v_cmp_gt_u32 s[20:21], 2, v6
    s_waitcnt vmcnt(17)
    v_perm_b32 v64, v132, v128, s60
    v_perm_b32 v68, v132, v128, s61
    v_perm_b32 v72, v133, v129, s60
    v_perm_b32 v76, v133, v129, s61
    v_perm_b32 v80, v134, v130, s60
    v_perm_b32 v84, v134, v130, s61
    v_perm_b32 v88, v135, v131, s60
    v_perm_b32 v92, v135, v131, s61
    s_waitcnt vmcnt(15)
    v_perm_b32 v65, v140, v136, s60
    v_perm_b32 v69, v140, v136, s61
    v_perm_b32 v73, v141, v137, s60
    v_perm_b32 v77, v141, v137, s61
    v_perm_b32 v81, v142, v138, s60
    v_perm_b32 v85, v142, v138, s61
    v_perm_b32 v89, v143, v139, s60
    v_perm_b32 v93, v143, v139, s61
    s_waitcnt vmcnt(13)
    v_perm_b32 v66, v148, v144, s60
    v_perm_b32 v70, v148, v144, s61
    v_perm_b32 v74, v149, v145, s60
    v_perm_b32 v78, v149, v145, s61
    v_perm_b32 v82, v150, v146, s60
    v_perm_b32 v86, v150, v146, s61
    v_perm_b32 v90, v151, v147, s60
    v_perm_b32 v94, v151, v147, s61
    s_waitcnt vmcnt(11)
    v_perm_b32 v67, v156, v152, s60
    v_perm_b32 v71, v156, v152, s61
    v_perm_b32 v75, v157, v153, s60
    v_perm_b32 v79, v157, v153, s61
    v_perm_b32 v83, v158, v154, s60
    v_perm_b32 v87, v158, v154, s61
    v_perm_b32 v91, v159, v155, s60
    v_perm_b32 v95, v159, v155, s61
    s_waitcnt vmcnt(9)
    v_perm_b32 v96, v164, v160, s60
    v_perm_b32 v100, v164, v160, s61
    v_perm_b32 v104, v165, v161, s60
    v_perm_b32 v108, v165, v161, s61
    v_perm_b32 v112, v166, v162, s60
    v_perm_b32 v116, v166, v162, s61
    v_perm_b32 v120, v167, v163, s60
    v_perm_b32 v124, v167, v163, s61
    s_waitcnt vmcnt(7)
    v_perm_b32 v97, v172, v168, s60
    v_perm_b32 v101, v172, v168, s61
    v_perm_b32 v105, v173, v169, s60
    v_perm_b32 v109, v173, v169, s61
    v_perm_b32 v113, v174, v170, s60
    v_perm_b32 v117, v174, v170, s61
    v_perm_b32 v121, v175, v171, s60
    v_perm_b32 v125, v175, v171, s61
    s_waitcnt vmcnt(5)
    v_perm_b32 v98, v180, v176, s60
    v_perm_b32 v102, v180, v176, s61
    v_perm_b32 v106, v181, v177, s60
    v_perm_b32 v110, v181, v177, s61
    v_perm_b32 v114, v182, v178, s60
    v_perm_b32 v118, v182, v178, s61
    v_perm_b32 v122, v183, v179, s60
    v_perm_b32 v126, v183, v179, s61
    s_waitcnt vmcnt(3)
    v_perm_b32 v99, v188, v184, s60
    v_perm_b32 v103, v188, v184, s61
    v_perm_b32 v107, v189, v185, s60
    v_perm_b32 v111, v189, v185, s61
    v_perm_b32 v115, v190, v186, s60
    v_perm_b32 v119, v190, v186, s61
    v_perm_b32 v123, v191, v187, s60
    v_perm_b32 v127, v191, v187, s61
    s_waitcnt vmcnt(0)
    s_branch L_mpoll_4_c
L_mpoll_4:
    s_mov_b64 exec, s[4:5]
    buffer_load_dwordx4 v[40:43], v30, s[44:47], s58 offen sc1
    s_mov_b64 exec, s[6:7]
    buffer_load_dwordx4 v[192:195], v2, s[44:47], s58 offen offset:0 sc1
    s_mov_b64 exec, s[8:9]
    buffer_load_dwordx4 v[196:199], v2, s[44:47], s58 offen offset:1024 sc1
    s_mov_b64 exec, -1
    s_waitcnt vmcnt(3)
L_mpoll_4_c:
    v_max3_u32 v236, v40, v41, v42
    v_max3_u32 v237, v192, v193, v194
    v_max3_u32 v238, v196, v197, v198
    v_max_u32 v236, v236, v43
    v_max_u32 v237, v237, v195
    v_max_u32 v238, v238, v199
    v_cmp_eq_u32 s[4:5], -1, v236
    v_cmp_eq_u32 s[6:7], -1, v237
    v_cmp_eq_u32 s[8:9], -1, v238
    s_or_b64 vcc, s[4:5], s[6:7]
    s_or_b64 vcc, vcc, s[8:9]
    s_cbranch_scc0 L_mpollok_5
    s_sub_u32 s101, s101, 1
    s_cbranch_scc0 L_mpoll_4
    s_mov_b32 s101, 0
L_mpollok_5:
    v_max_f32_dpp v44, v40, v40 row_ror:1 row_mask:0xf bank_mask:0xf
    v_cndmask_b32 v47, 0, v41, s[20:21]
    v_mov_b32 v45, v44
    s_nop 1
    v_permlane16_swap_b32 v44, v45
    v_max_f32 v44, v44, v45
    v_mov_b32 v45, v44
    s_nop 1
    v_permlane32_swap_b32 v44, v45
    v_max_f32 v44, v44, v45
    v_sub_f32 v45, v40, v44
    v_mul_f32 v45, s97, v45
    v_exp_f32 v45, v45
    s_nop 0
    v_cvt_pk_bf16_f32 v46, v45, v45
    v_and_b32 v45, s98, v46
    v_mul_f32 v47, v47, v45
    v_and_b32_dpp v232, v46, v8 row_newbcast:0 row_mask:0xf bank_mask:0xf
    v_and_b32_dpp v233, v46, v9 row_newbcast:0 row_mask:0xf bank_mask:0xf
    v_add_f32_dpp v47, v47, v47 row_ror:1 row_mask:0xf bank_mask:0xf
    v_and_b32_dpp v234, v46, v10 row_newbcast:0 row_mask:0xf bank_mask:0xf
    v_and_b32_dpp v235, v46, v11 row_newbcast:0 row_mask:0xf bank_mask:0xf
    v_and_b32_dpp v236, v46, v8 row_newbcast:1 row_mask:0xf bank_mask:0xf
    v_mov_b32 v45, v47
    v_and_b32_dpp v237, v46, v9 row_newbcast:1 row_mask:0xf bank_mask:0xf
    v_and_b32_dpp v238, v46, v10 row_newbcast:1 row_mask:0xf bank_mask:0xf
    v_and_b32_dpp v239, v46, v11 row_newbcast:1 row_mask:0xf bank_mask:0xf
    v_permlane16_swap_b32 v47, v45
    v_mfma_f32_16x16x32_bf16 v[228:231], v[232:235], v[192:195], 0
    v_add_f32 v47, v47, v45
    v_mfma_f32_16x16x32_bf16 v[228:231], v[236:239], v[196:199], v[228:231]
    v_mov_b32 v45, v47
    s_nop 1
    v_permlane32_swap_b32 v47, v45
    v_add_f32 v47, v47, v45
    v_rcp_f32 v47, v47
    s_nop 1
    v_mul_f32 v228, v228, v47
    v_mul_f32 v229, v229, v47
    v_mul_f32 v230, v230, v47
    v_mul_f32 v231, v231, v47
    v_cvt_pk_bf16_f32 v224, v228, v229
    v_cvt_pk_bf16_f32 v225, v230, v231
    s_branch L_emerged
L_eshared:
    buffer_load_dwordx4 v[40:43], v30, s[44:47], s58 offen sc1
    buffer_load_dwordx4 v[192:195], v2, s[44:47], s58 offen offset:0 sc1
    buffer_load_dwordx4 v[196:199], v2, s[44:47], s58 offen offset:1024 sc1
    buffer_load_dwordx4 v[200:203], v2, s[44:47], s58 offen offset:2048 sc1
    buffer_load_dwordx4 v[204:207], v2, s[44:47], s58 offen offset:3072 sc1
    buffer_load_dwordx4 v[208:211], v2, s[44:47], s59 offen offset:0 sc1
    buffer_load_dwordx4 v[212:215], v2, s[44:47], s59 offen offset:1024 sc1
    v_and_b32 v3, 15, v1
    v_lshrrev_b32 v4, 4, v1
    s_mov_b32 s60, 0x05040100
    s_mov_b32 s61, 0x07060302
    v_mul_u32_u24 v0, 73728, v4
    v_bfe_u32 v5, v1, 2, 1
    v_lshl_add_u32 v0, v5, 12, v0
    v_and_b32 v5, 3, v1
    v_lshl_add_u32 v0, v5, 5, v0
    v_bfe_u32 v5, v1, 3, 1
    v_lshl_add_u32 v0, v5, 4, v0
    s_lshl_b32 s54, s3, 9
    v_lshl_add_u32 v5, v3, 4, s54
    v_and_b32 v6, 1, v4
    v_lshl_add_u32 v5, v6, 3, v5
    v_lshrrev_b32 v6, 1, v4
    v_lshl_add_u32 v5, v6, 8, v5
    v_lshrrev_b32 v7, 2, v3
    v_lshlrev_b32 v7, 9, v7
    v_lshl_add_u32 v7, v4, 4, v7
    v_and_b32 v6, 1, v1
    v_lshl_add_u32 v7, v6, 6, v7
    v_and_b32 v6, 7, v3
    v_cmp_gt_u32 s[20:21], 6, v6
    s_waitcnt vmcnt(21)
    v_perm_b32 v64, v132, v128, s60
    v_perm_b32 v68, v132, v128, s61
    v_perm_b32 v72, v133, v129, s60
    v_perm_b32 v76, v133, v129, s61
    v_perm_b32 v80, v134, v130, s60
    v_perm_b32 v84, v134, v130, s61
    v_perm_b32 v88, v135, v131, s60
    v_perm_b32 v92, v135, v131, s61
    s_waitcnt vmcnt(19)
    v_perm_b32 v65, v140, v136, s60
    v_perm_b32 v69, v140, v136, s61
    v_perm_b32 v73, v141, v137, s60
    v_perm_b32 v77, v141, v137, s61
    v_perm_b32 v81, v142, v138, s60
    v_perm_b32 v85, v142, v138, s61
    v_perm_b32 v89, v143, v139, s60
    v_perm_b32 v93, v143, v139, s61
    s_waitcnt vmcnt(17)
    v_perm_b32 v66, v148, v144, s60
    v_perm_b32 v70, v148, v144, s61
    v_perm_b32 v74, v149, v145, s60
    v_perm_b32 v78, v149, v145, s61
    v_perm_b32 v82, v150, v146, s60
    v_perm_b32 v86, v150, v146, s61
    v_perm_b32 v90, v151, v147, s60
    v_perm_b32 v94, v151, v147, s61
    s_waitcnt vmcnt(15)
    v_perm_b32 v67, v156, v152, s60
    v_perm_b32 v71, v156, v152, s61
    v_perm_b32 v75, v157, v153, s60
    v_perm_b32 v79, v157, v153, s61
    v_perm_b32 v83, v158, v154, s60
    v_perm_b32 v87, v158, v154, s61
    v_perm_b32 v91, v159, v155, s60
    v_perm_b32 v95, v159, v155, s61
    s_waitcnt vmcnt(13)
    v_perm_b32 v96, v164, v160, s60
    v_perm_b32 v100, v164, v160, s61
    v_perm_b32 v104, v165, v161, s60
    v_perm_b32 v108, v165, v161, s61
    v_perm_b32 v112, v166, v162, s60
    v_perm_b32 v116, v166, v162, s61
    v_perm_b32 v120, v167, v163, s60
    v_perm_b32 v124, v167, v163, s61
    s_waitcnt vmcnt(11)
    v_perm_b32 v97, v172, v168, s60
    v_perm_b32 v101, v172, v168, s61
    v_perm_b32 v105, v173, v169, s60
    v_perm_b32 v109, v173, v169, s61
    v_perm_b32 v113, v174, v170, s60
    v_perm_b32 v117, v174, v170, s61
    v_perm_b32 v121, v175, v171, s60
    v_perm_b32 v125, v175, v171, s61
    s_waitcnt vmcnt(9)
    v_perm_b32 v98, v180, v176, s60
    v_perm_b32 v102, v180, v176, s61
    v_perm_b32 v106, v181, v177, s60
    v_perm_b32 v110, v181, v177, s61
    v_perm_b32 v114, v182, v178, s60
    v_perm_b32 v118, v182, v178, s61
    v_perm_b32 v122, v183, v179, s60
    v_perm_b32 v126, v183, v179, s61
    s_waitcnt vmcnt(7)
    v_perm_b32 v99, v188, v184, s60
    v_perm_b32 v103, v188, v184, s61
    v_perm_b32 v107, v189, v185, s60
    v_perm_b32 v111, v189, v185, s61
    v_perm_b32 v115, v190, v186, s60
    v_perm_b32 v119, v190, v186, s61
    v_perm_b32 v123, v191, v187, s60
    v_perm_b32 v127, v191, v187, s61
    s_waitcnt vmcnt(0)
    s_branch L_mpoll_8_c
L_mpoll_8:
    s_mov_b64 exec, s[4:5]
    buffer_load_dwordx4 v[40:43], v30, s[44:47], s58 offen sc1
    s_mov_b64 exec, s[6:7]
    buffer_load_dwordx4 v[192:195], v2, s[44:47], s58 offen offset:0 sc1
    s_mov_b64 exec, s[8:9]
    buffer_load_dwordx4 v[196:199], v2, s[44:47], s58 offen offset:1024 sc1
    s_mov_b64 exec, s[10:11]
    buffer_load_dwordx4 v[200:203], v2, s[44:47], s58 offen offset:2048 sc1
    s_mov_b64 exec, s[12:13]
    buffer_load_dwordx4 v[204:207], v2, s[44:47], s58 offen offset:3072 sc1
    s_mov_b64 exec, s[14:15]
    buffer_load_dwordx4 v[208:211], v2, s[44:47], s59 offen offset:0 sc1
    s_mov_b64 exec, s[16:17]
    buffer_load_dwordx4 v[212:215], v2, s[44:47], s59 offen offset:1024 sc1
    s_mov_b64 exec, -1
    s_waitcnt vmcnt(7)
L_mpoll_8_c:
    v_max3_u32 v236, v40, v41, v42
    v_max3_u32 v237, v192, v193, v194
    v_max3_u32 v238, v196, v197, v198
    v_max3_u32 v239, v200, v201, v202
    v_max3_u32 v240, v204, v205, v206
    v_max3_u32 v241, v208, v209, v210
    v_max3_u32 v242, v212, v213, v214
    v_max_u32 v236, v236, v43
    v_max_u32 v237, v237, v195
    v_max_u32 v238, v238, v199
    v_max_u32 v239, v239, v203
    v_max_u32 v240, v240, v207
    v_max_u32 v241, v241, v211
    v_max_u32 v242, v242, v215
    v_cmp_eq_u32 s[4:5], -1, v236
    v_cmp_eq_u32 s[6:7], -1, v237
    v_cmp_eq_u32 s[8:9], -1, v238
    v_cmp_eq_u32 s[10:11], -1, v239
    v_cmp_eq_u32 s[12:13], -1, v240
    v_cmp_eq_u32 s[14:15], -1, v241
    v_cmp_eq_u32 s[16:17], -1, v242
    s_or_b64 vcc, s[4:5], s[6:7]
    s_or_b64 vcc, vcc, s[8:9]
    s_or_b64 vcc, vcc, s[10:11]
    s_or_b64 vcc, vcc, s[12:13]
    s_or_b64 vcc, vcc, s[14:15]
    s_or_b64 vcc, vcc, s[16:17]
    s_cbranch_scc0 L_mpollok_9
    s_sub_u32 s101, s101, 1
    s_cbranch_scc0 L_mpoll_8
    s_mov_b32 s101, 0
L_mpollok_9:
    v_max_f32_dpp v44, v40, v40 row_ror:1 row_mask:0xf bank_mask:0xf
    v_cndmask_b32 v47, 0, v41, s[20:21]
    s_nop 0
    v_max_f32_dpp v44, v44, v44 row_ror:2 row_mask:0xf bank_mask:0xf
    s_nop 1
    v_max_f32_dpp v44, v44, v44 row_ror:4 row_mask:0xf bank_mask:0xf
    v_mov_b32 v45, v44
    s_nop 1
    v_permlane16_swap_b32 v44, v45
    v_max_f32 v44, v44, v45
    v_mov_b32 v45, v44
    s_nop 1
    v_permlane32_swap_b32 v44, v45
    v_max_f32 v44, v44, v45
    v_sub_f32 v45, v40, v44
    v_mul_f32 v45, s97, v45
    v_exp_f32 v45, v45
    s_nop 0
    v_cvt_pk_bf16_f32 v46, v45, v45
    v_and_b32 v45, s98, v46
    v_mul_f32 v47, v47, v45
    v_and_b32_dpp v232, v46, v8 row_newbcast:0 row_mask:0xf bank_mask:0xf
    v_and_b32_dpp v233, v46, v9 row_newbcast:0 row_mask:0xf bank_mask:0xf
    v_add_f32_dpp v47, v47, v47 row_ror:1 row_mask:0xf bank_mask:0xf
    v_and_b32_dpp v234, v46, v10 row_newbcast:0 row_mask:0xf bank_mask:0xf
    v_and_b32_dpp v235, v46, v11 row_newbcast:0 row_mask:0xf bank_mask:0xf
    v_and_b32_dpp v236, v46, v8 row_newbcast:1 row_mask:0xf bank_mask:0xf
    v_and_b32_dpp v237, v46, v9 row_newbcast:1 row_mask:0xf bank_mask:0xf
    v_add_f32_dpp v47, v47, v47 row_ror:2 row_mask:0xf bank_mask:0xf
    v_and_b32_dpp v238, v46, v10 row_newbcast:1 row_mask:0xf bank_mask:0xf
    v_and_b32_dpp v239, v46, v11 row_newbcast:1 row_mask:0xf bank_mask:0xf
    v_mfma_f32_16x16x32_bf16 v[228:231], v[232:235], v[192:195], 0
    v_and_b32_dpp v240, v46, v8 row_newbcast:2 row_mask:0xf bank_mask:0xf
    v_add_f32_dpp v47, v47, v47 row_ror:4 row_mask:0xf bank_mask:0xf
    v_and_b32_dpp v241, v46, v9 row_newbcast:2 row_mask:0xf bank_mask:0xf
    v_and_b32_dpp v242, v46, v10 row_newbcast:2 row_mask:0xf bank_mask:0xf
    v_and_b32_dpp v243, v46, v11 row_newbcast:2 row_mask:0xf bank_mask:0xf
    v_mfma_f32_16x16x32_bf16 v[228:231], v[236:239], v[196:199], v[228:231]
    v_mov_b32 v45, v47
    v_and_b32_dpp v244, v46, v8 row_newbcast:3 row_mask:0xf bank_mask:0xf
    v_and_b32_dpp v245, v46, v9 row_newbcast:3 row_mask:0xf bank_mask:0xf
    v_and_b32_dpp v246, v46, v10 row_newbcast:3 row_mask:0xf bank_mask:0xf
    v_and_b32_dpp v247, v46, v11 row_newbcast:3 row_mask:0xf bank_mask:0xf
    v_permlane16_swap_b32 v47, v45
    v_mfma_f32_16x16x32_bf16 v[228:231], v[240:243], v[200:203], v[228:231]
    v_and_b32_dpp v248, v46, v8 row_newbcast:4 row_mask:0xf bank_mask:0xf
    v_and_b32_dpp v249, v46, v9 row_newbcast:4 row_mask:0xf bank_mask:0xf
    v_and_b32_dpp v250, v46, v10 row_newbcast:4 row_mask:0xf bank_mask:0xf
    v_add_f32 v47, v47, v45
    v_and_b32_dpp v251, v46, v11 row_newbcast:4 row_mask:0xf bank_mask:0xf
    v_mfma_f32_16x16x32_bf16 v[228:231], v[244:247], v[204:207], v[228:231]
    v_and_b32_dpp v252, v46, v8 row_newbcast:5 row_mask:0xf bank_mask:0xf
    v_and_b32_dpp v253, v46, v9 row_newbcast:5 row_mask:0xf bank_mask:0xf
    v_mov_b32 v45, v47
    v_and_b32_dpp v254, v46, v10 row_newbcast:5 row_mask:0xf bank_mask:0xf
    v_and_b32_dpp v255, v46, v11 row_newbcast:5 row_mask:0xf bank_mask:0xf
    v_mfma_f32_16x16x32_bf16 v[228:231], v[248:251], v[208:211], v[228:231]
    v_permlane32_swap_b32 v47, v45
    v_add_f32 v47, v47, v45
    v_mfma_f32_16x16x32_bf16 v[228:231], v[252:255], v[212:215], v[228:231]
    v_rcp_f32 v47, v47
    s_nop 6
    v_mul_f32 v228, v228, v47
    v_mul_f32 v229, v229, v47
    v_mul_f32 v230, v230, v47
    v_mul_f32 v231, v231, v47
    v_cvt_pk_bf16_f32 v224, v228, v229
    v_cvt_pk_bf16_f32 v225, v230, v231
L_emerged:
    ds_write_b64 v5, v[224:225]
    s_cmp_eq_u32 s3, 3
    s_waitcnt lgkmcnt(0)
    s_barrier
    s_cbranch_scc1 L_eendA
    ds_read_b128 v[48:51], v7 offset:0
    ds_read_b128 v[52:55], v7 offset:128
    s_waitcnt lgkmcnt(1)
    v_mfma_f32_16x16x32_bf16 v[224:227], v[48:51], v[64:67], 0
    v_mfma_f32_16x16x32_bf16 v[228:231], v[48:51], v[68:71], 0
    v_mfma_f32_16x16x32_bf16 v[232:235], v[48:51], v[72:75], 0
    v_mfma_f32_16x16x32_bf16 v[236:239], v[48:51], v[76:79], 0
    v_mfma_f32_16x16x32_bf16 v[240:243], v[48:51], v[80:83], 0
    v_mfma_f32_16x16x32_bf16 v[244:247], v[48:51], v[84:87], 0
    v_mfma_f32_16x16x32_bf16 v[248:251], v[48:51], v[88:91], 0
    v_mfma_f32_16x16x32_bf16 v[252:255], v[48:51], v[92:95], 0
    s_waitcnt lgkmcnt(0)
    v_mfma_f32_16x16x32_bf16 v[224:227], v[52:55], v[96:99], v[224:227]
    s_nop 1
    v_mfma_f32_16x16x32_bf16 v[228:231], v[52:55], v[100:103], v[228:231]
    s_nop 1
    v_mfma_f32_16x16x32_bf16 v[232:235], v[52:55], v[104:107], v[232:235]
    s_nop 1
    v_mfma_f32_16x16x32_bf16 v[236:239], v[52:55], v[108:111], v[236:239]
    s_nop 0
    v_add_f32_dpp v56, v225, v224 row_ror:8 row_mask:0xf bank_mask:0x3
    v_mfma_f32_16x16x32_bf16 v[240:243], v[52:55], v[112:115], v[240:243]
    s_nop 0
    v_add_f32_dpp v57, v229, v228 row_ror:8 row_mask:0xf bank_mask:0x3
    v_mfma_f32_16x16x32_bf16 v[244:247], v[52:55], v[116:119], v[244:247]
    s_nop 0
    v_add_f32_dpp v58, v233, v232 row_ror:8 row_mask:0xf bank_mask:0x3
    v_mfma_f32_16x16x32_bf16 v[248:251], v[52:55], v[120:123], v[248:251]
    s_nop 0
    v_add_f32_dpp v59, v237, v236 row_ror:8 row_mask:0xf bank_mask:0x3
    v_mfma_f32_16x16x32_bf16 v[252:255], v[52:55], v[124:127], v[252:255]
    s_nop 0
    v_add_f32_dpp v56, v240, v241 row_ror:8 row_mask:0xf bank_mask:0xc
    v_add_f32_dpp v57, v244, v245 row_ror:8 row_mask:0xf bank_mask:0xc
    v_min_u32 v56, -2, v56
    s_nop 0
    v_add_f32_dpp v58, v248, v249 row_ror:8 row_mask:0xf bank_mask:0xc
    v_min_u32 v57, -2, v57
    s_nop 0
    v_add_f32_dpp v59, v252, v253 row_ror:8 row_mask:0xf bank_mask:0xc
    v_min_u32 v58, -2, v58
    v_min_u32 v59, -2, v59
    buffer_store_dwordx4 v[56:59], v0, s[44:47], s25 offen sc1
L_eendA:
    s_endpgm
L_epiB:
    s_cmp_eq_u32 s3, 3
    s_cbranch_scc1 L_eendB
    v_bfe_u32 v6, v1, 2, 2
    v_lshlrev_b32 v6, 6, v6
    v_and_b32 v5, 48, v1
    v_add_u32 v6, v6, v5
    v_and_b32 v5, 1, v1
    v_lshl_add_u32 v6, v5, 8, v6
    buffer_load_dwordx4 v[48:51], v6, s[44:47], s27 offen offset:0 sc1
    buffer_load_dwordx4 v[52:55], v6, s[44:47], s27 offen offset:512 sc1
    v_and_b32 v3, 15, v1
    v_lshrrev_b32 v4, 4, v1
    s_mov_b32 s60, 0x05040100
    s_mov_b32 s61, 0x07060302
    v_mul_u32_u24 v0, 73728, v4
    v_bfe_u32 v5, v1, 2, 1
    v_lshl_add_u32 v0, v5, 12, v0
    v_and_b32 v5, 3, v1
    v_lshl_add_u32 v0, v5, 5, v0
    v_bfe_u32 v5, v1, 3, 1
    v_lshl_add_u32 v0, v5, 4, v0
    s_waitcnt vmcnt(16)
    v_perm_b32 v64, v132, v128, s60
    v_perm_b32 v68, v132, v128, s61
    v_perm_b32 v72, v133, v129, s60
    v_perm_b32 v76, v133, v129, s61
    v_perm_b32 v80, v134, v130, s60
    v_perm_b32 v84, v134, v130, s61
    v_perm_b32 v88, v135, v131, s60
    v_perm_b32 v92, v135, v131, s61
    s_waitcnt vmcnt(14)
    v_perm_b32 v65, v140, v136, s60
    v_perm_b32 v69, v140, v136, s61
    v_perm_b32 v73, v141, v137, s60
    v_perm_b32 v77, v141, v137, s61
    v_perm_b32 v81, v142, v138, s60
    v_perm_b32 v85, v142, v138, s61
    v_perm_b32 v89, v143, v139, s60
    v_perm_b32 v93, v143, v139, s61
    s_waitcnt vmcnt(12)
    v_perm_b32 v66, v148, v144, s60
    v_perm_b32 v70, v148, v144, s61
    v_perm_b32 v74, v149, v145, s60
    v_perm_b32 v78, v149, v145, s61
    v_perm_b32 v82, v150, v146, s60
    v_perm_b32 v86, v150, v146, s61
    v_perm_b32 v90, v151, v147, s60
    v_perm_b32 v94, v151, v147, s61
    s_waitcnt vmcnt(10)
    v_perm_b32 v67, v156, v152, s60
    v_perm_b32 v71, v156, v152, s61
    v_perm_b32 v75, v157, v153, s60
    v_perm_b32 v79, v157, v153, s61
    v_perm_b32 v83, v158, v154, s60
    v_perm_b32 v87, v158, v154, s61
    v_perm_b32 v91, v159, v155, s60
    v_perm_b32 v95, v159, v155, s61
    s_waitcnt vmcnt(8)
    v_perm_b32 v96, v164, v160, s60
    v_perm_b32 v100, v164, v160, s61
    v_perm_b32 v104, v165, v161, s60
    v_perm_b32 v108, v165, v161, s61
    v_perm_b32 v112, v166, v162, s60
    v_perm_b32 v116, v166, v162, s61
    v_perm_b32 v120, v167, v163, s60
    v_perm_b32 v124, v167, v163, s61
    s_waitcnt vmcnt(6)
    v_perm_b32 v97, v172, v168, s60
    v_perm_b32 v101, v172, v168, s61
    v_perm_b32 v105, v173, v169, s60
    v_perm_b32 v109, v173, v169, s61
    v_perm_b32 v113, v174, v170, s60
    v_perm_b32 v117, v174, v170, s61
    v_perm_b32 v121, v175, v171, s60
    v_perm_b32 v125, v175, v171, s61
    s_waitcnt vmcnt(4)
    v_perm_b32 v98, v180, v176, s60
    v_perm_b32 v102, v180, v176, s61
    v_perm_b32 v106, v181, v177, s60
    v_perm_b32 v110, v181, v177, s61
    v_perm_b32 v114, v182, v178, s60
    v_perm_b32 v118, v182, v178, s61
    v_perm_b32 v122, v183, v179, s60
    v_perm_b32 v126, v183, v179, s61
    s_waitcnt vmcnt(2)
    v_perm_b32 v99, v188, v184, s60
    v_perm_b32 v103, v188, v184, s61
    v_perm_b32 v107, v189, v185, s60
    v_perm_b32 v111, v189, v185, s61
    v_perm_b32 v115, v190, v186, s60
    v_perm_b32 v119, v190, v186, s61
    v_perm_b32 v123, v191, v187, s60
    v_perm_b32 v127, v191, v187, s61
    s_waitcnt vmcnt(0)
    s_branch L_mpoll_10_c
L_mpoll_10:
    s_mov_b64 exec, s[4:5]
    buffer_load_dwordx4 v[48:51], v6, s[44:47], s27 offen offset:0 sc1
    s_mov_b64 exec, s[6:7]
    buffer_load_dwordx4 v[52:55], v6, s[44:47], s27 offen offset:512 sc1
    s_mov_b64 exec, -1
    s_waitcnt vmcnt(0)
L_mpoll_10_c:
    v_max3_u32 v236, v48, v49, v50
    v_max3_u32 v237, v52, v53, v54
    v_max_u32 v236, v236, v51
    v_max_u32 v237, v237, v55
    v_cmp_eq_u32 s[4:5], -1, v236
    v_cmp_eq_u32 s[6:7], -1, v237
    s_nop 0
    s_or_b64 vcc, s[4:5], s[6:7]
    s_cbranch_scc0 L_mpollok_11
    s_sub_u32 s101, s101, 1
    s_cbranch_scc0 L_mpoll_10
    s_mov_b32 s101, 0
L_mpollok_11:
    v_mfma_f32_16x16x32_bf16 v[224:227], v[48:51], v[64:67], 0
    v_mfma_f32_16x16x32_bf16 v[228:231], v[48:51], v[68:71], 0
    v_mfma_f32_16x16x32_bf16 v[232:235], v[48:51], v[72:75], 0
    v_mfma_f32_16x16x32_bf16 v[236:239], v[48:51], v[76:79], 0
    v_mfma_f32_16x16x32_bf16 v[240:243], v[48:51], v[80:83], 0
    v_mfma_f32_16x16x32_bf16 v[244:247], v[48:51], v[84:87], 0
    v_mfma_f32_16x16x32_bf16 v[248:251], v[48:51], v[88:91], 0
    v_mfma_f32_16x16x32_bf16 v[252:255], v[48:51], v[92:95], 0
    v_mfma_f32_16x16x32_bf16 v[224:227], v[52:55], v[96:99], v[224:227]
    s_nop 1
    v_mfma_f32_16x16x32_bf16 v[228:231], v[52:55], v[100:103], v[228:231]
    s_nop 1
    v_mfma_f32_16x16x32_bf16 v[232:235], v[52:55], v[104:107], v[232:235]
    s_nop 1
    v_mfma_f32_16x16x32_bf16 v[236:239], v[52:55], v[108:111], v[236:239]
    s_nop 0
    v_add_f32_dpp v56, v225, v224 row_ror:8 row_mask:0xf bank_mask:0x3
    v_mfma_f32_16x16x32_bf16 v[240:243], v[52:55], v[112:115], v[240:243]
    s_nop 0
    v_add_f32_dpp v57, v229, v228 row_ror:8 row_mask:0xf bank_mask:0x3
    v_mfma_f32_16x16x32_bf16 v[244:247], v[52:55], v[116:119], v[244:247]
    s_nop 0
    v_add_f32_dpp v58, v233, v232 row_ror:8 row_mask:0xf bank_mask:0x3
    v_mfma_f32_16x16x32_bf16 v[248:251], v[52:55], v[120:123], v[248:251]
    s_nop 0
    v_add_f32_dpp v59, v237, v236 row_ror:8 row_mask:0xf bank_mask:0x3
    v_mfma_f32_16x16x32_bf16 v[252:255], v[52:55], v[124:127], v[252:255]
    s_nop 0
    v_add_f32_dpp v56, v240, v241 row_ror:8 row_mask:0xf bank_mask:0xc
    v_add_f32_dpp v57, v244, v245 row_ror:8 row_mask:0xf bank_mask:0xc
    v_min_u32 v56, -2, v56
    s_nop 0
    v_add_f32_dpp v58, v248, v249 row_ror:8 row_mask:0xf bank_mask:0xc
    v_min_u32 v57, -2, v57
    s_nop 0
    v_add_f32_dpp v59, v252, v253 row_ror:8 row_mask:0xf bank_mask:0xc
    v_min_u32 v58, -2, v58
    v_min_u32 v59, -2, v59
    buffer_store_dwordx4 v[56:59], v0, s[44:47], s25 offen sc1
L_eendB:
    s_endpgm
L_aext0:
    v_dot2_f32_bf16 v20, v96, v4, 0
    v_dot2_f32_bf16 v21, v100, v4, 0
    v_dot2_f32_bf16 v22, v104, v4, 0
    v_dot2_f32_bf16 v23, v108, v4, 0
    v_dot2_f32_bf16 v20, v97, v5, v20
    v_dot2_f32_bf16 v21, v101, v5, v21
    v_dot2_f32_bf16 v22, v105, v5, v22
    v_dot2_f32_bf16 v23, v109, v5, v23
    v_dot2_f32_bf16 v20, v98, v6, v20
    v_dot2_f32_bf16 v21, v102, v6, v21
    v_dot2_f32_bf16 v22, v106, v6, v22
    v_dot2_f32_bf16 v23, v110, v6, v23
    v_dot2_f32_bf16 v20, v99, v7, v20
    v_dot2_f32_bf16 v21, v103, v7, v21
    v_dot2_f32_bf16 v22, v107, v7, v22
    v_dot2_f32_bf16 v23, v111, v7, v23
    v_add_f32_dpp v24, v20, v20 row_ror:8 row_mask:0xf bank_mask:0x3
    s_nop 0
    v_add_f32_dpp v25, v22, v22 row_ror:8 row_mask:0xf bank_mask:0x3
    v_add_f32_dpp v24, v21, v21 row_ror:8 row_mask:0xf bank_mask:0xc
    v_add_f32_dpp v25, v23, v23 row_ror:8 row_mask:0xf bank_mask:0xc
    s_nop 0
    v_add_f32_dpp v26, v24, v24 row_shl:4 row_mask:0xf bank_mask:0x5
    v_add_f32_dpp v26, v25, v25 row_shr:4 row_mask:0xf bank_mask:0xa
    s_nop 1
    v_add_f32_dpp v26, v26, v26 quad_perm:[1,0,3,2] row_mask:0xf bank_mask:0xf
    s_nop 1
    v_add_f32_dpp v26, v26, v26 quad_perm:[2,3,0,1] row_mask:0xf bank_mask:0xf
    v_cvt_pk_bf16_f32 v26, v26, v26
    v_and_b32 v26, s98, v26
    v_mul_f32 v26, s96, v26
    v_cvt_pk_bf16_f32 v26, v26, v26
    v_and_b32 v26, s98, v26
    s_nop 1
    v_max_f32_dpp v27, v26, v26 row_ror:4 row_mask:0xf bank_mask:0xf
    s_nop 1
    v_max_f32_dpp v27, v27, v27 row_ror:8 row_mask:0xf bank_mask:0xf
    v_mov_b32 v28, v27
    s_nop 1
    v_permlane16_swap_b32 v27, v28
    v_max_f32 v27, v27, v28
    v_mov_b32 v28, v27
    s_nop 1
    v_permlane32_swap_b32 v27, v28
    v_max3_f32 v27, v27, v28, v16
    v_sub_f32 v28, v16, v27
    v_sub_f32 v29, v26, v27
    v_mul_f32 v28, s97, v28
    v_mul_f32 v29, s97, v29
    v_exp_f32 v28, v28
    v_exp_f32 v29, v29
    v_mov_b32 v16, v27
    v_fma_f32 v17, v17, v28, v29
    v_cvt_pk_bf16_f32 v29, v29, v29
    v_mul_f32 v12, v12, v28
    v_mul_f32 v13, v13, v28
    v_mul_f32 v14, v14, v28
    v_mul_f32 v15, v15, v28
    v_and_b32_dpp v32, v29, v8 row_newbcast:0 row_mask:0xf bank_mask:0xf
    v_and_b32_dpp v33, v29, v9 row_newbcast:0 row_mask:0xf bank_mask:0xf
    v_and_b32_dpp v34, v29, v10 row_newbcast:0 row_mask:0xf bank_mask:0xf
    v_and_b32_dpp v35, v29, v11 row_newbcast:0 row_mask:0xf bank_mask:0xf
    v_and_b32_dpp v36, v29, v8 row_newbcast:8 row_mask:0xf bank_mask:0xf
    v_and_b32_dpp v37, v29, v9 row_newbcast:8 row_mask:0xf bank_mask:0xf
    v_and_b32_dpp v38, v29, v10 row_newbcast:8 row_mask:0xf bank_mask:0xf
    v_and_b32_dpp v39, v29, v11 row_newbcast:8 row_mask:0xf bank_mask:0xf
    v_and_b32_dpp v40, v29, v8 row_newbcast:4 row_mask:0xf bank_mask:0xf
    v_and_b32_dpp v41, v29, v9 row_newbcast:4 row_mask:0xf bank_mask:0xf
    v_and_b32_dpp v42, v29, v10 row_newbcast:4 row_mask:0xf bank_mask:0xf
    v_and_b32_dpp v43, v29, v11 row_newbcast:4 row_mask:0xf bank_mask:0xf
    v_and_b32_dpp v44, v29, v8 row_newbcast:12 row_mask:0xf bank_mask:0xf
    v_and_b32_dpp v45, v29, v9 row_newbcast:12 row_mask:0xf bank_mask:0xf
    v_and_b32_dpp v46, v29, v10 row_newbcast:12 row_mask:0xf bank_mask:0xf
    v_and_b32_dpp v47, v29, v11 row_newbcast:12 row_mask:0xf bank_mask:0xf
    v_mfma_f32_16x16x32_bf16 v[12:15], v[32:35], a[32:35], v[12:15]
    v_mfma_f32_16x16x32_bf16 v[12:15], v[36:39], a[36:39], v[12:15]
    v_mfma_f32_16x16x32_bf16 v[12:15], v[40:43], a[40:43], v[12:15]
    v_mfma_f32_16x16x32_bf16 v[12:15], v[44:47], a[44:47], v[12:15]
    v_dot2_f32_bf16 v20, v112, v4, 0
    v_dot2_f32_bf16 v21, v116, v4, 0
    v_dot2_f32_bf16 v22, v120, v4, 0
    v_dot2_f32_bf16 v23, v124, v4, 0
    v_dot2_f32_bf16 v20, v113, v5, v20
    v_dot2_f32_bf16 v21, v117, v5, v21
    v_dot2_f32_bf16 v22, v121, v5, v22
    v_dot2_f32_bf16 v23, v125, v5, v23
    v_dot2_f32_bf16 v20, v114, v6, v20
    v_dot2_f32_bf16 v21, v118, v6, v21
    v_dot2_f32_bf16 v22, v122, v6, v22
    v_dot2_f32_bf16 v23, v126, v6, v23
    v_dot2_f32_bf16 v20, v115, v7, v20
    v_dot2_f32_bf16 v21, v119, v7, v21
    v_dot2_f32_bf16 v22, v123, v7, v22
    v_dot2_f32_bf16 v23, v127, v7, v23
    v_add_f32_dpp v24, v20, v20 row_ror:8 row_mask:0xf bank_mask:0x3
    s_nop 0
    v_add_f32_dpp v25, v22, v22 row_ror:8 row_mask:0xf bank_mask:0x3
    v_add_f32_dpp v24, v21, v21 row_ror:8 row_mask:0xf bank_mask:0xc
    v_add_f32_dpp v25, v23, v23 row_ror:8 row_mask:0xf bank_mask:0xc
    s_nop 0
    v_add_f32_dpp v26, v24, v24 row_shl:4 row_mask:0xf bank_mask:0x5
    v_add_f32_dpp v26, v25, v25 row_shr:4 row_mask:0xf bank_mask:0xa
    s_nop 1
    v_add_f32_dpp v26, v26, v26 quad_perm:[1,0,3,2] row_mask:0xf bank_mask:0xf
    s_nop 1
    v_add_f32_dpp v26, v26, v26 quad_perm:[2,3,0,1] row_mask:0xf bank_mask:0xf
    v_cvt_pk_bf16_f32 v26, v26, v26
    v_and_b32 v26, s98, v26
    v_mul_f32 v26, s96, v26
    v_cvt_pk_bf16_f32 v26, v26, v26
    v_and_b32 v26, s98, v26
    s_nop 1
    v_max_f32_dpp v27, v26, v26 row_ror:4 row_mask:0xf bank_mask:0xf
    s_nop 1
    v_max_f32_dpp v27, v27, v27 row_ror:8 row_mask:0xf bank_mask:0xf
    v_mov_b32 v28, v27
    s_nop 1
    v_permlane16_swap_b32 v27, v28
    v_max_f32 v27, v27, v28
    v_mov_b32 v28, v27
    s_nop 1
    v_permlane32_swap_b32 v27, v28
    v_max3_f32 v27, v27, v28, v16
    v_sub_f32 v28, v16, v27
    v_sub_f32 v29, v26, v27
    v_mul_f32 v28, s97, v28
    v_mul_f32 v29, s97, v29
    v_exp_f32 v28, v28
    v_exp_f32 v29, v29
    v_mov_b32 v16, v27
    v_fma_f32 v17, v17, v28, v29
    v_cvt_pk_bf16_f32 v29, v29, v29
    v_mul_f32 v12, v12, v28
    v_mul_f32 v13, v13, v28
    v_mul_f32 v14, v14, v28
    v_mul_f32 v15, v15, v28
    v_and_b32_dpp v32, v29, v8 row_newbcast:0 row_mask:0xf bank_mask:0xf
    v_and_b32_dpp v33, v29, v9 row_newbcast:0 row_mask:0xf bank_mask:0xf
    v_and_b32_dpp v34, v29, v10 row_newbcast:0 row_mask:0xf bank_mask:0xf
    v_and_b32_dpp v35, v29, v11 row_newbcast:0 row_mask:0xf bank_mask:0xf
    v_and_b32_dpp v36, v29, v8 row_newbcast:8 row_mask:0xf bank_mask:0xf
    v_and_b32_dpp v37, v29, v9 row_newbcast:8 row_mask:0xf bank_mask:0xf
    v_and_b32_dpp v38, v29, v10 row_newbcast:8 row_mask:0xf bank_mask:0xf
    v_and_b32_dpp v39, v29, v11 row_newbcast:8 row_mask:0xf bank_mask:0xf
    v_and_b32_dpp v40, v29, v8 row_newbcast:4 row_mask:0xf bank_mask:0xf
    v_and_b32_dpp v41, v29, v9 row_newbcast:4 row_mask:0xf bank_mask:0xf
    v_and_b32_dpp v42, v29, v10 row_newbcast:4 row_mask:0xf bank_mask:0xf
    v_and_b32_dpp v43, v29, v11 row_newbcast:4 row_mask:0xf bank_mask:0xf
    v_and_b32_dpp v44, v29, v8 row_newbcast:12 row_mask:0xf bank_mask:0xf
    v_and_b32_dpp v45, v29, v9 row_newbcast:12 row_mask:0xf bank_mask:0xf
    v_and_b32_dpp v46, v29, v10 row_newbcast:12 row_mask:0xf bank_mask:0xf
    v_and_b32_dpp v47, v29, v11 row_newbcast:12 row_mask:0xf bank_mask:0xf
    v_mfma_f32_16x16x32_bf16 v[12:15], v[32:35], a[48:51], v[12:15]
    v_mfma_f32_16x16x32_bf16 v[12:15], v[36:39], a[52:55], v[12:15]
    v_mfma_f32_16x16x32_bf16 v[12:15], v[40:43], a[56:59], v[12:15]
    v_mfma_f32_16x16x32_bf16 v[12:15], v[44:47], a[60:63], v[12:15]
    v_dot2_f32_bf16 v20, v128, v4, 0
    v_dot2_f32_bf16 v21, v132, v4, 0
    v_dot2_f32_bf16 v22, v136, v4, 0
    v_dot2_f32_bf16 v23, v140, v4, 0
    v_dot2_f32_bf16 v20, v129, v5, v20
    v_dot2_f32_bf16 v21, v133, v5, v21
    v_dot2_f32_bf16 v22, v137, v5, v22
    v_dot2_f32_bf16 v23, v141, v5, v23
    v_dot2_f32_bf16 v20, v130, v6, v20
    v_dot2_f32_bf16 v21, v134, v6, v21
    v_dot2_f32_bf16 v22, v138, v6, v22
    v_dot2_f32_bf16 v23, v142, v6, v23
    v_dot2_f32_bf16 v20, v131, v7, v20
    v_dot2_f32_bf16 v21, v135, v7, v21
    v_dot2_f32_bf16 v22, v139, v7, v22
    v_dot2_f32_bf16 v23, v143, v7, v23
    v_add_f32_dpp v24, v20, v20 row_ror:8 row_mask:0xf bank_mask:0x3
    s_nop 0
    v_add_f32_dpp v25, v22, v22 row_ror:8 row_mask:0xf bank_mask:0x3
    v_add_f32_dpp v24, v21, v21 row_ror:8 row_mask:0xf bank_mask:0xc
    v_add_f32_dpp v25, v23, v23 row_ror:8 row_mask:0xf bank_mask:0xc
    s_nop 0
    v_add_f32_dpp v26, v24, v24 row_shl:4 row_mask:0xf bank_mask:0x5
    v_add_f32_dpp v26, v25, v25 row_shr:4 row_mask:0xf bank_mask:0xa
    s_nop 1
    v_add_f32_dpp v26, v26, v26 quad_perm:[1,0,3,2] row_mask:0xf bank_mask:0xf
    s_nop 1
    v_add_f32_dpp v26, v26, v26 quad_perm:[2,3,0,1] row_mask:0xf bank_mask:0xf
    v_cvt_pk_bf16_f32 v26, v26, v26
    v_and_b32 v26, s98, v26
    v_mul_f32 v26, s96, v26
    v_cvt_pk_bf16_f32 v26, v26, v26
    v_and_b32 v26, s98, v26
    s_nop 1
    v_max_f32_dpp v27, v26, v26 row_ror:4 row_mask:0xf bank_mask:0xf
    s_nop 1
    v_max_f32_dpp v27, v27, v27 row_ror:8 row_mask:0xf bank_mask:0xf
    v_mov_b32 v28, v27
    s_nop 1
    v_permlane16_swap_b32 v27, v28
    v_max_f32 v27, v27, v28
    v_mov_b32 v28, v27
    s_nop 1
    v_permlane32_swap_b32 v27, v28
    v_max3_f32 v27, v27, v28, v16
    v_sub_f32 v28, v16, v27
    v_sub_f32 v29, v26, v27
    v_mul_f32 v28, s97, v28
    v_mul_f32 v29, s97, v29
    v_exp_f32 v28, v28
    v_exp_f32 v29, v29
    v_mov_b32 v16, v27
    v_fma_f32 v17, v17, v28, v29
    v_cvt_pk_bf16_f32 v29, v29, v29
    v_mul_f32 v12, v12, v28
    v_mul_f32 v13, v13, v28
    v_mul_f32 v14, v14, v28
    v_mul_f32 v15, v15, v28
    v_and_b32_dpp v32, v29, v8 row_newbcast:0 row_mask:0xf bank_mask:0xf
    v_and_b32_dpp v33, v29, v9 row_newbcast:0 row_mask:0xf bank_mask:0xf
    v_and_b32_dpp v34, v29, v10 row_newbcast:0 row_mask:0xf bank_mask:0xf
    v_and_b32_dpp v35, v29, v11 row_newbcast:0 row_mask:0xf bank_mask:0xf
    v_and_b32_dpp v36, v29, v8 row_newbcast:8 row_mask:0xf bank_mask:0xf
    v_and_b32_dpp v37, v29, v9 row_newbcast:8 row_mask:0xf bank_mask:0xf
    v_and_b32_dpp v38, v29, v10 row_newbcast:8 row_mask:0xf bank_mask:0xf
    v_and_b32_dpp v39, v29, v11 row_newbcast:8 row_mask:0xf bank_mask:0xf
    v_and_b32_dpp v40, v29, v8 row_newbcast:4 row_mask:0xf bank_mask:0xf
    v_and_b32_dpp v41, v29, v9 row_newbcast:4 row_mask:0xf bank_mask:0xf
    v_and_b32_dpp v42, v29, v10 row_newbcast:4 row_mask:0xf bank_mask:0xf
    v_and_b32_dpp v43, v29, v11 row_newbcast:4 row_mask:0xf bank_mask:0xf
    v_and_b32_dpp v44, v29, v8 row_newbcast:12 row_mask:0xf bank_mask:0xf
    v_and_b32_dpp v45, v29, v9 row_newbcast:12 row_mask:0xf bank_mask:0xf
    v_and_b32_dpp v46, v29, v10 row_newbcast:12 row_mask:0xf bank_mask:0xf
    v_and_b32_dpp v47, v29, v11 row_newbcast:12 row_mask:0xf bank_mask:0xf
    v_mfma_f32_16x16x32_bf16 v[12:15], v[32:35], a[64:67], v[12:15]
    v_mfma_f32_16x16x32_bf16 v[12:15], v[36:39], a[68:71], v[12:15]
    v_mfma_f32_16x16x32_bf16 v[12:15], v[40:43], a[72:75], v[12:15]
    v_mfma_f32_16x16x32_bf16 v[12:15], v[44:47], a[76:79], v[12:15]
    v_dot2_f32_bf16 v20, v144, v4, 0
    v_dot2_f32_bf16 v21, v148, v4, 0
    v_dot2_f32_bf16 v22, v152, v4, 0
    v_dot2_f32_bf16 v23, v156, v4, 0
    v_dot2_f32_bf16 v20, v145, v5, v20
    v_dot2_f32_bf16 v21, v149, v5, v21
    v_dot2_f32_bf16 v22, v153, v5, v22
    v_dot2_f32_bf16 v23, v157, v5, v23
    v_dot2_f32_bf16 v20, v146, v6, v20
    v_dot2_f32_bf16 v21, v150, v6, v21
    v_dot2_f32_bf16 v22, v154, v6, v22
    v_dot2_f32_bf16 v23, v158, v6, v23
    v_dot2_f32_bf16 v20, v147, v7, v20
    v_dot2_f32_bf16 v21, v151, v7, v21
    v_dot2_f32_bf16 v22, v155, v7, v22
    v_dot2_f32_bf16 v23, v159, v7, v23
    v_add_f32_dpp v24, v20, v20 row_ror:8 row_mask:0xf bank_mask:0x3
    s_nop 0
    v_add_f32_dpp v25, v22, v22 row_ror:8 row_mask:0xf bank_mask:0x3
    v_add_f32_dpp v24, v21, v21 row_ror:8 row_mask:0xf bank_mask:0xc
    v_add_f32_dpp v25, v23, v23 row_ror:8 row_mask:0xf bank_mask:0xc
    s_nop 0
    v_add_f32_dpp v26, v24, v24 row_shl:4 row_mask:0xf bank_mask:0x5
    v_add_f32_dpp v26, v25, v25 row_shr:4 row_mask:0xf bank_mask:0xa
    s_nop 1
    v_add_f32_dpp v26, v26, v26 quad_perm:[1,0,3,2] row_mask:0xf bank_mask:0xf
    s_nop 1
    v_add_f32_dpp v26, v26, v26 quad_perm:[2,3,0,1] row_mask:0xf bank_mask:0xf
    v_cvt_pk_bf16_f32 v26, v26, v26
    v_and_b32 v26, s98, v26
    v_mul_f32 v26, s96, v26
    v_cvt_pk_bf16_f32 v26, v26, v26
    v_and_b32 v26, s98, v26
    s_nop 1
    v_max_f32_dpp v27, v26, v26 row_ror:4 row_mask:0xf bank_mask:0xf
    s_nop 1
    v_max_f32_dpp v27, v27, v27 row_ror:8 row_mask:0xf bank_mask:0xf
    v_mov_b32 v28, v27
    s_nop 1
    v_permlane16_swap_b32 v27, v28
    v_max_f32 v27, v27, v28
    v_mov_b32 v28, v27
    s_nop 1
    v_permlane32_swap_b32 v27, v28
    v_max3_f32 v27, v27, v28, v16
    v_sub_f32 v28, v16, v27
    v_sub_f32 v29, v26, v27
    v_mul_f32 v28, s97, v28
    v_mul_f32 v29, s97, v29
    v_exp_f32 v28, v28
    v_exp_f32 v29, v29
    v_mov_b32 v16, v27
    v_fma_f32 v17, v17, v28, v29
    v_cvt_pk_bf16_f32 v29, v29, v29
    v_mul_f32 v12, v12, v28
    v_mul_f32 v13, v13, v28
    v_mul_f32 v14, v14, v28
    v_mul_f32 v15, v15, v28
    v_and_b32_dpp v32, v29, v8 row_newbcast:0 row_mask:0xf bank_mask:0xf
    v_and_b32_dpp v33, v29, v9 row_newbcast:0 row_mask:0xf bank_mask:0xf
    v_and_b32_dpp v34, v29, v10 row_newbcast:0 row_mask:0xf bank_mask:0xf
    v_and_b32_dpp v35, v29, v11 row_newbcast:0 row_mask:0xf bank_mask:0xf
    v_and_b32_dpp v36, v29, v8 row_newbcast:8 row_mask:0xf bank_mask:0xf
    v_and_b32_dpp v37, v29, v9 row_newbcast:8 row_mask:0xf bank_mask:0xf
    v_and_b32_dpp v38, v29, v10 row_newbcast:8 row_mask:0xf bank_mask:0xf
    v_and_b32_dpp v39, v29, v11 row_newbcast:8 row_mask:0xf bank_mask:0xf
    v_and_b32_dpp v40, v29, v8 row_newbcast:4 row_mask:0xf bank_mask:0xf
    v_and_b32_dpp v41, v29, v9 row_newbcast:4 row_mask:0xf bank_mask:0xf
    v_and_b32_dpp v42, v29, v10 row_newbcast:4 row_mask:0xf bank_mask:0xf
    v_and_b32_dpp v43, v29, v11 row_newbcast:4 row_mask:0xf bank_mask:0xf
    v_and_b32_dpp v44, v29, v8 row_newbcast:12 row_mask:0xf bank_mask:0xf
    v_and_b32_dpp v45, v29, v9 row_newbcast:12 row_mask:0xf bank_mask:0xf
    v_and_b32_dpp v46, v29, v10 row_newbcast:12 row_mask:0xf bank_mask:0xf
    v_and_b32_dpp v47, v29, v11 row_newbcast:12 row_mask:0xf bank_mask:0xf
    v_mfma_f32_16x16x32_bf16 v[12:15], v[32:35], a[80:83], v[12:15]
    v_mfma_f32_16x16x32_bf16 v[12:15], v[36:39], a[84:87], v[12:15]
    v_mfma_f32_16x16x32_bf16 v[12:15], v[40:43], a[88:91], v[12:15]
    v_mfma_f32_16x16x32_bf16 v[12:15], v[44:47], a[92:95], v[12:15]
    v_dot2_f32_bf16 v20, v160, v4, 0
    v_dot2_f32_bf16 v21, v164, v4, 0
    v_dot2_f32_bf16 v22, v168, v4, 0
    v_dot2_f32_bf16 v23, v172, v4, 0
    v_dot2_f32_bf16 v20, v161, v5, v20
    v_dot2_f32_bf16 v21, v165, v5, v21
    v_dot2_f32_bf16 v22, v169, v5, v22
    v_dot2_f32_bf16 v23, v173, v5, v23
    v_dot2_f32_bf16 v20, v162, v6, v20
    v_dot2_f32_bf16 v21, v166, v6, v21
    v_dot2_f32_bf16 v22, v170, v6, v22
    v_dot2_f32_bf16 v23, v174, v6, v23
    v_dot2_f32_bf16 v20, v163, v7, v20
    v_dot2_f32_bf16 v21, v167, v7, v21
    v_dot2_f32_bf16 v22, v171, v7, v22
    v_dot2_f32_bf16 v23, v175, v7, v23
    v_add_f32_dpp v24, v20, v20 row_ror:8 row_mask:0xf bank_mask:0x3
    s_nop 0
    v_add_f32_dpp v25, v22, v22 row_ror:8 row_mask:0xf bank_mask:0x3
    v_add_f32_dpp v24, v21, v21 row_ror:8 row_mask:0xf bank_mask:0xc
    v_add_f32_dpp v25, v23, v23 row_ror:8 row_mask:0xf bank_mask:0xc
    s_nop 0
    v_add_f32_dpp v26, v24, v24 row_shl:4 row_mask:0xf bank_mask:0x5
    v_add_f32_dpp v26, v25, v25 row_shr:4 row_mask:0xf bank_mask:0xa
    s_nop 1
    v_add_f32_dpp v26, v26, v26 quad_perm:[1,0,3,2] row_mask:0xf bank_mask:0xf
    s_nop 1
    v_add_f32_dpp v26, v26, v26 quad_perm:[2,3,0,1] row_mask:0xf bank_mask:0xf
    v_cvt_pk_bf16_f32 v26, v26, v26
    v_and_b32 v26, s98, v26
    v_mul_f32 v26, s96, v26
    v_cvt_pk_bf16_f32 v26, v26, v26
    v_and_b32 v26, s98, v26
    s_nop 1
    v_max_f32_dpp v27, v26, v26 row_ror:4 row_mask:0xf bank_mask:0xf
    s_nop 1
    v_max_f32_dpp v27, v27, v27 row_ror:8 row_mask:0xf bank_mask:0xf
    v_mov_b32 v28, v27
    s_nop 1
    v_permlane16_swap_b32 v27, v28
    v_max_f32 v27, v27, v28
    v_mov_b32 v28, v27
    s_nop 1
    v_permlane32_swap_b32 v27, v28
    v_max3_f32 v27, v27, v28, v16
    v_sub_f32 v28, v16, v27
    v_sub_f32 v29, v26, v27
    v_mul_f32 v28, s97, v28
    v_mul_f32 v29, s97, v29
    v_exp_f32 v28, v28
    v_exp_f32 v29, v29
    v_mov_b32 v16, v27
    v_fma_f32 v17, v17, v28, v29
    v_cvt_pk_bf16_f32 v29, v29, v29
    v_mul_f32 v12, v12, v28
    v_mul_f32 v13, v13, v28
    v_mul_f32 v14, v14, v28
    v_mul_f32 v15, v15, v28
    v_and_b32_dpp v32, v29, v8 row_newbcast:0 row_mask:0xf bank_mask:0xf
    v_and_b32_dpp v33, v29, v9 row_newbcast:0 row_mask:0xf bank_mask:0xf
    v_and_b32_dpp v34, v29, v10 row_newbcast:0 row_mask:0xf bank_mask:0xf
    v_and_b32_dpp v35, v29, v11 row_newbcast:0 row_mask:0xf bank_mask:0xf
    v_and_b32_dpp v36, v29, v8 row_newbcast:8 row_mask:0xf bank_mask:0xf
    v_and_b32_dpp v37, v29, v9 row_newbcast:8 row_mask:0xf bank_mask:0xf
    v_and_b32_dpp v38, v29, v10 row_newbcast:8 row_mask:0xf bank_mask:0xf
    v_and_b32_dpp v39, v29, v11 row_newbcast:8 row_mask:0xf bank_mask:0xf
    v_and_b32_dpp v40, v29, v8 row_newbcast:4 row_mask:0xf bank_mask:0xf
    v_and_b32_dpp v41, v29, v9 row_newbcast:4 row_mask:0xf bank_mask:0xf
    v_and_b32_dpp v42, v29, v10 row_newbcast:4 row_mask:0xf bank_mask:0xf
    v_and_b32_dpp v43, v29, v11 row_newbcast:4 row_mask:0xf bank_mask:0xf
    v_and_b32_dpp v44, v29, v8 row_newbcast:12 row_mask:0xf bank_mask:0xf
    v_and_b32_dpp v45, v29, v9 row_newbcast:12 row_mask:0xf bank_mask:0xf
    v_and_b32_dpp v46, v29, v10 row_newbcast:12 row_mask:0xf bank_mask:0xf
    v_and_b32_dpp v47, v29, v11 row_newbcast:12 row_mask:0xf bank_mask:0xf
    v_mfma_f32_16x16x32_bf16 v[12:15], v[32:35], a[96:99], v[12:15]
    v_mfma_f32_16x16x32_bf16 v[12:15], v[36:39], a[100:103], v[12:15]
    v_mfma_f32_16x16x32_bf16 v[12:15], v[40:43], a[104:107], v[12:15]
    v_mfma_f32_16x16x32_bf16 v[12:15], v[44:47], a[108:111], v[12:15]
    s_branch L_aback0
L_aext1:
    v_dot2_f32_bf16 v20, v176, v4, 0
    v_dot2_f32_bf16 v21, v180, v4, 0
    v_dot2_f32_bf16 v22, v184, v4, 0
    v_dot2_f32_bf16 v23, v188, v4, 0
    v_dot2_f32_bf16 v20, v177, v5, v20
    v_dot2_f32_bf16 v21, v181, v5, v21
    v_dot2_f32_bf16 v22, v185, v5, v22
    v_dot2_f32_bf16 v23, v189, v5, v23
    v_dot2_f32_bf16 v20, v178, v6, v20
    v_dot2_f32_bf16 v21, v182, v6, v21
    v_dot2_f32_bf16 v22, v186, v6, v22
    v_dot2_f32_bf16 v23, v190, v6, v23
    v_dot2_f32_bf16 v20, v179, v7, v20
    v_dot2_f32_bf16 v21, v183, v7, v21
    v_dot2_f32_bf16 v22, v187, v7, v22
    v_dot2_f32_bf16 v23, v191, v7, v23
    v_add_f32_dpp v24, v20, v20 row_ror:8 row_mask:0xf bank_mask:0x3
    s_nop 0
    v_add_f32_dpp v25, v22, v22 row_ror:8 row_mask:0xf bank_mask:0x3
    v_add_f32_dpp v24, v21, v21 row_ror:8 row_mask:0xf bank_mask:0xc
    v_add_f32_dpp v25, v23, v23 row_ror:8 row_mask:0xf bank_mask:0xc
    s_nop 0
    v_add_f32_dpp v26, v24, v24 row_shl:4 row_mask:0xf bank_mask:0x5
    v_add_f32_dpp v26, v25, v25 row_shr:4 row_mask:0xf bank_mask:0xa
    s_nop 1
    v_add_f32_dpp v26, v26, v26 quad_perm:[1,0,3,2] row_mask:0xf bank_mask:0xf
    s_nop 1
    v_add_f32_dpp v26, v26, v26 quad_perm:[2,3,0,1] row_mask:0xf bank_mask:0xf
    v_cvt_pk_bf16_f32 v26, v26, v26
    v_and_b32 v26, s98, v26
    v_mul_f32 v26, s96, v26
    v_cvt_pk_bf16_f32 v26, v26, v26
    v_and_b32 v26, s98, v26
    s_nop 1
    v_max_f32_dpp v27, v26, v26 row_ror:4 row_mask:0xf bank_mask:0xf
    s_nop 1
    v_max_f32_dpp v27, v27, v27 row_ror:8 row_mask:0xf bank_mask:0xf
    v_mov_b32 v28, v27
    s_nop 1
    v_permlane16_swap_b32 v27, v28
    v_max_f32 v27, v27, v28
    v_mov_b32 v28, v27
    s_nop 1
    v_permlane32_swap_b32 v27, v28
    v_max3_f32 v27, v27, v28, v16
    v_sub_f32 v28, v16, v27
    v_sub_f32 v29, v26, v27
    v_mul_f32 v28, s97, v28
    v_mul_f32 v29, s97, v29
    v_exp_f32 v28, v28
    v_exp_f32 v29, v29
    v_mov_b32 v16, v27
    v_fma_f32 v17, v17, v28, v29
    v_cvt_pk_bf16_f32 v29, v29, v29
    v_mul_f32 v12, v12, v28
    v_mul_f32 v13, v13, v28
    v_mul_f32 v14, v14, v28
    v_mul_f32 v15, v15, v28
    v_and_b32_dpp v32, v29, v8 row_newbcast:0 row_mask:0xf bank_mask:0xf
    v_and_b32_dpp v33, v29, v9 row_newbcast:0 row_mask:0xf bank_mask:0xf
    v_and_b32_dpp v34, v29, v10 row_newbcast:0 row_mask:0xf bank_mask:0xf
    v_and_b32_dpp v35, v29, v11 row_newbcast:0 row_mask:0xf bank_mask:0xf
    v_and_b32_dpp v36, v29, v8 row_newbcast:8 row_mask:0xf bank_mask:0xf
    v_and_b32_dpp v37, v29, v9 row_newbcast:8 row_mask:0xf bank_mask:0xf
    v_and_b32_dpp v38, v29, v10 row_newbcast:8 row_mask:0xf bank_mask:0xf
    v_and_b32_dpp v39, v29, v11 row_newbcast:8 row_mask:0xf bank_mask:0xf
    v_and_b32_dpp v40, v29, v8 row_newbcast:4 row_mask:0xf bank_mask:0xf
    v_and_b32_dpp v41, v29, v9 row_newbcast:4 row_mask:0xf bank_mask:0xf
    v_and_b32_dpp v42, v29, v10 row_newbcast:4 row_mask:0xf bank_mask:0xf
    v_and_b32_dpp v43, v29, v11 row_newbcast:4 row_mask:0xf bank_mask:0xf
    v_and_b32_dpp v44, v29, v8 row_newbcast:12 row_mask:0xf bank_mask:0xf
    v_and_b32_dpp v45, v29, v9 row_newbcast:12 row_mask:0xf bank_mask:0xf
    v_and_b32_dpp v46, v29, v10 row_newbcast:12 row_mask:0xf bank_mask:0xf
    v_and_b32_dpp v47, v29, v11 row_newbcast:12 row_mask:0xf bank_mask:0xf
    v_mfma_f32_16x16x32_bf16 v[12:15], v[32:35], a[112:115], v[12:15]
    v_mfma_f32_16x16x32_bf16 v[12:15], v[36:39], a[116:119], v[12:15]
    v_mfma_f32_16x16x32_bf16 v[12:15], v[40:43], a[120:123], v[12:15]
    v_mfma_f32_16x16x32_bf16 v[12:15], v[44:47], a[124:127], v[12:15]
    v_dot2_f32_bf16 v20, v192, v4, 0
    v_dot2_f32_bf16 v21, v196, v4, 0
    v_dot2_f32_bf16 v22, v200, v4, 0
    v_dot2_f32_bf16 v23, v204, v4, 0
    v_dot2_f32_bf16 v20, v193, v5, v20
    v_dot2_f32_bf16 v21, v197, v5, v21
    v_dot2_f32_bf16 v22, v201, v5, v22
    v_dot2_f32_bf16 v23, v205, v5, v23
    v_dot2_f32_bf16 v20, v194, v6, v20
    v_dot2_f32_bf16 v21, v198, v6, v21
    v_dot2_f32_bf16 v22, v202, v6, v22
    v_dot2_f32_bf16 v23, v206, v6, v23
    v_dot2_f32_bf16 v20, v195, v7, v20
    v_dot2_f32_bf16 v21, v199, v7, v21
    v_dot2_f32_bf16 v22, v203, v7, v22
    v_dot2_f32_bf16 v23, v207, v7, v23
    v_add_f32_dpp v24, v20, v20 row_ror:8 row_mask:0xf bank_mask:0x3
    s_nop 0
    v_add_f32_dpp v25, v22, v22 row_ror:8 row_mask:0xf bank_mask:0x3
    v_add_f32_dpp v24, v21, v21 row_ror:8 row_mask:0xf bank_mask:0xc
    v_add_f32_dpp v25, v23, v23 row_ror:8 row_mask:0xf bank_mask:0xc
    s_nop 0
    v_add_f32_dpp v26, v24, v24 row_shl:4 row_mask:0xf bank_mask:0x5
    v_add_f32_dpp v26, v25, v25 row_shr:4 row_mask:0xf bank_mask:0xa
    s_nop 1
    v_add_f32_dpp v26, v26, v26 quad_perm:[1,0,3,2] row_mask:0xf bank_mask:0xf
    s_nop 1
    v_add_f32_dpp v26, v26, v26 quad_perm:[2,3,0,1] row_mask:0xf bank_mask:0xf
    v_cvt_pk_bf16_f32 v26, v26, v26
    v_and_b32 v26, s98, v26
    v_mul_f32 v26, s96, v26
    v_cvt_pk_bf16_f32 v26, v26, v26
    v_and_b32 v26, s98, v26
    s_nop 1
    v_max_f32_dpp v27, v26, v26 row_ror:4 row_mask:0xf bank_mask:0xf
    s_nop 1
    v_max_f32_dpp v27, v27, v27 row_ror:8 row_mask:0xf bank_mask:0xf
    v_mov_b32 v28, v27
    s_nop 1
    v_permlane16_swap_b32 v27, v28
    v_max_f32 v27, v27, v28
    v_mov_b32 v28, v27
    s_nop 1
    v_permlane32_swap_b32 v27, v28
    v_max3_f32 v27, v27, v28, v16
    v_sub_f32 v28, v16, v27
    v_sub_f32 v29, v26, v27
    v_mul_f32 v28, s97, v28
    v_mul_f32 v29, s97, v29
    v_exp_f32 v28, v28
    v_exp_f32 v29, v29
    v_mov_b32 v16, v27
    v_fma_f32 v17, v17, v28, v29
    v_cvt_pk_bf16_f32 v29, v29, v29
    v_mul_f32 v12, v12, v28
    v_mul_f32 v13, v13, v28
    v_mul_f32 v14, v14, v28
    v_mul_f32 v15, v15, v28
    v_and_b32_dpp v32, v29, v8 row_newbcast:0 row_mask:0xf bank_mask:0xf
    v_and_b32_dpp v33, v29, v9 row_newbcast:0 row_mask:0xf bank_mask:0xf
    v_and_b32_dpp v34, v29, v10 row_newbcast:0 row_mask:0xf bank_mask:0xf
    v_and_b32_dpp v35, v29, v11 row_newbcast:0 row_mask:0xf bank_mask:0xf
    v_and_b32_dpp v36, v29, v8 row_newbcast:8 row_mask:0xf bank_mask:0xf
    v_and_b32_dpp v37, v29, v9 row_newbcast:8 row_mask:0xf bank_mask:0xf
    v_and_b32_dpp v38, v29, v10 row_newbcast:8 row_mask:0xf bank_mask:0xf
    v_and_b32_dpp v39, v29, v11 row_newbcast:8 row_mask:0xf bank_mask:0xf
    v_and_b32_dpp v40, v29, v8 row_newbcast:4 row_mask:0xf bank_mask:0xf
    v_and_b32_dpp v41, v29, v9 row_newbcast:4 row_mask:0xf bank_mask:0xf
    v_and_b32_dpp v42, v29, v10 row_newbcast:4 row_mask:0xf bank_mask:0xf
    v_and_b32_dpp v43, v29, v11 row_newbcast:4 row_mask:0xf bank_mask:0xf
    v_and_b32_dpp v44, v29, v8 row_newbcast:12 row_mask:0xf bank_mask:0xf
    v_and_b32_dpp v45, v29, v9 row_newbcast:12 row_mask:0xf bank_mask:0xf
    v_and_b32_dpp v46, v29, v10 row_newbcast:12 row_mask:0xf bank_mask:0xf
    v_and_b32_dpp v47, v29, v11 row_newbcast:12 row_mask:0xf bank_mask:0xf
    v_mfma_f32_16x16x32_bf16 v[12:15], v[32:35], a[128:131], v[12:15]
    v_mfma_f32_16x16x32_bf16 v[12:15], v[36:39], a[132:135], v[12:15]
    v_mfma_f32_16x16x32_bf16 v[12:15], v[40:43], a[136:139], v[12:15]
    v_mfma_f32_16x16x32_bf16 v[12:15], v[44:47], a[140:143], v[12:15]
    v_dot2_f32_bf16 v20, v208, v4, 0
    v_dot2_f32_bf16 v21, v212, v4, 0
    v_dot2_f32_bf16 v22, v216, v4, 0
    v_dot2_f32_bf16 v23, v220, v4, 0
    v_dot2_f32_bf16 v20, v209, v5, v20
    v_dot2_f32_bf16 v21, v213, v5, v21
    v_dot2_f32_bf16 v22, v217, v5, v22
    v_dot2_f32_bf16 v23, v221, v5, v23
    v_dot2_f32_bf16 v20, v210, v6, v20
    v_dot2_f32_bf16 v21, v214, v6, v21
    v_dot2_f32_bf16 v22, v218, v6, v22
    v_dot2_f32_bf16 v23, v222, v6, v23
    v_dot2_f32_bf16 v20, v211, v7, v20
    v_dot2_f32_bf16 v21, v215, v7, v21
    v_dot2_f32_bf16 v22, v219, v7, v22
    v_dot2_f32_bf16 v23, v223, v7, v23
    v_add_f32_dpp v24, v20, v20 row_ror:8 row_mask:0xf bank_mask:0x3
    s_nop 0
    v_add_f32_dpp v25, v22, v22 row_ror:8 row_mask:0xf bank_mask:0x3
    v_add_f32_dpp v24, v21, v21 row_ror:8 row_mask:0xf bank_mask:0xc
    v_add_f32_dpp v25, v23, v23 row_ror:8 row_mask:0xf bank_mask:0xc
    s_nop 0
    v_add_f32_dpp v26, v24, v24 row_shl:4 row_mask:0xf bank_mask:0x5
    v_add_f32_dpp v26, v25, v25 row_shr:4 row_mask:0xf bank_mask:0xa
    s_nop 1
    v_add_f32_dpp v26, v26, v26 quad_perm:[1,0,3,2] row_mask:0xf bank_mask:0xf
    s_nop 1
    v_add_f32_dpp v26, v26, v26 quad_perm:[2,3,0,1] row_mask:0xf bank_mask:0xf
    v_cvt_pk_bf16_f32 v26, v26, v26
    v_and_b32 v26, s98, v26
    v_mul_f32 v26, s96, v26
    v_cvt_pk_bf16_f32 v26, v26, v26
    v_and_b32 v26, s98, v26
    s_nop 1
    v_max_f32_dpp v27, v26, v26 row_ror:4 row_mask:0xf bank_mask:0xf
    s_nop 1
    v_max_f32_dpp v27, v27, v27 row_ror:8 row_mask:0xf bank_mask:0xf
    v_mov_b32 v28, v27
    s_nop 1
    v_permlane16_swap_b32 v27, v28
    v_max_f32 v27, v27, v28
    v_mov_b32 v28, v27
    s_nop 1
    v_permlane32_swap_b32 v27, v28
    v_max3_f32 v27, v27, v28, v16
    v_sub_f32 v28, v16, v27
    v_sub_f32 v29, v26, v27
    v_mul_f32 v28, s97, v28
    v_mul_f32 v29, s97, v29
    v_exp_f32 v28, v28
    v_exp_f32 v29, v29
    v_mov_b32 v16, v27
    v_fma_f32 v17, v17, v28, v29
    v_cvt_pk_bf16_f32 v29, v29, v29
    v_mul_f32 v12, v12, v28
    v_mul_f32 v13, v13, v28
    v_mul_f32 v14, v14, v28
    v_mul_f32 v15, v15, v28
    v_and_b32_dpp v32, v29, v8 row_newbcast:0 row_mask:0xf bank_mask:0xf
    v_and_b32_dpp v33, v29, v9 row_newbcast:0 row_mask:0xf bank_mask:0xf
    v_and_b32_dpp v34, v29, v10 row_newbcast:0 row_mask:0xf bank_mask:0xf
    v_and_b32_dpp v35, v29, v11 row_newbcast:0 row_mask:0xf bank_mask:0xf
    v_and_b32_dpp v36, v29, v8 row_newbcast:8 row_mask:0xf bank_mask:0xf
    v_and_b32_dpp v37, v29, v9 row_newbcast:8 row_mask:0xf bank_mask:0xf
    v_and_b32_dpp v38, v29, v10 row_newbcast:8 row_mask:0xf bank_mask:0xf
    v_and_b32_dpp v39, v29, v11 row_newbcast:8 row_mask:0xf bank_mask:0xf
    v_and_b32_dpp v40, v29, v8 row_newbcast:4 row_mask:0xf bank_mask:0xf
    v_and_b32_dpp v41, v29, v9 row_newbcast:4 row_mask:0xf bank_mask:0xf
    v_and_b32_dpp v42, v29, v10 row_newbcast:4 row_mask:0xf bank_mask:0xf
    v_and_b32_dpp v43, v29, v11 row_newbcast:4 row_mask:0xf bank_mask:0xf
    v_and_b32_dpp v44, v29, v8 row_newbcast:12 row_mask:0xf bank_mask:0xf
    v_and_b32_dpp v45, v29, v9 row_newbcast:12 row_mask:0xf bank_mask:0xf
    v_and_b32_dpp v46, v29, v10 row_newbcast:12 row_mask:0xf bank_mask:0xf
    v_and_b32_dpp v47, v29, v11 row_newbcast:12 row_mask:0xf bank_mask:0xf
    v_mfma_f32_16x16x32_bf16 v[12:15], v[32:35], a[144:147], v[12:15]
    v_mfma_f32_16x16x32_bf16 v[12:15], v[36:39], a[148:151], v[12:15]
    v_mfma_f32_16x16x32_bf16 v[12:15], v[40:43], a[152:155], v[12:15]
    v_mfma_f32_16x16x32_bf16 v[12:15], v[44:47], a[156:159], v[12:15]
    v_dot2_f32_bf16 v20, v224, v4, 0
    v_dot2_f32_bf16 v21, v228, v4, 0
    v_dot2_f32_bf16 v22, v232, v4, 0
    v_dot2_f32_bf16 v23, v236, v4, 0
    v_dot2_f32_bf16 v20, v225, v5, v20
    v_dot2_f32_bf16 v21, v229, v5, v21
    v_dot2_f32_bf16 v22, v233, v5, v22
    v_dot2_f32_bf16 v23, v237, v5, v23
    v_dot2_f32_bf16 v20, v226, v6, v20
    v_dot2_f32_bf16 v21, v230, v6, v21
    v_dot2_f32_bf16 v22, v234, v6, v22
    v_dot2_f32_bf16 v23, v238, v6, v23
    v_dot2_f32_bf16 v20, v227, v7, v20
    v_dot2_f32_bf16 v21, v231, v7, v21
    v_dot2_f32_bf16 v22, v235, v7, v22
    v_dot2_f32_bf16 v23, v239, v7, v23
    v_add_f32_dpp v24, v20, v20 row_ror:8 row_mask:0xf bank_mask:0x3
    s_nop 0
    v_add_f32_dpp v25, v22, v22 row_ror:8 row_mask:0xf bank_mask:0x3
    v_add_f32_dpp v24, v21, v21 row_ror:8 row_mask:0xf bank_mask:0xc
    v_add_f32_dpp v25, v23, v23 row_ror:8 row_mask:0xf bank_mask:0xc
    s_nop 0
    v_add_f32_dpp v26, v24, v24 row_shl:4 row_mask:0xf bank_mask:0x5
    v_add_f32_dpp v26, v25, v25 row_shr:4 row_mask:0xf bank_mask:0xa
    s_nop 1
    v_add_f32_dpp v26, v26, v26 quad_perm:[1,0,3,2] row_mask:0xf bank_mask:0xf
    s_nop 1
    v_add_f32_dpp v26, v26, v26 quad_perm:[2,3,0,1] row_mask:0xf bank_mask:0xf
    v_cvt_pk_bf16_f32 v26, v26, v26
    v_and_b32 v26, s98, v26
    v_mul_f32 v26, s96, v26
    v_cvt_pk_bf16_f32 v26, v26, v26
    v_and_b32 v26, s98, v26
    s_nop 1
    v_max_f32_dpp v27, v26, v26 row_ror:4 row_mask:0xf bank_mask:0xf
    s_nop 1
    v_max_f32_dpp v27, v27, v27 row_ror:8 row_mask:0xf bank_mask:0xf
    v_mov_b32 v28, v27
    s_nop 1
    v_permlane16_swap_b32 v27, v28
    v_max_f32 v27, v27, v28
    v_mov_b32 v28, v27
    s_nop 1
    v_permlane32_swap_b32 v27, v28
    v_max3_f32 v27, v27, v28, v16
    v_sub_f32 v28, v16, v27
    v_sub_f32 v29, v26, v27
    v_mul_f32 v28, s97, v28
    v_mul_f32 v29, s97, v29
    v_exp_f32 v28, v28
    v_exp_f32 v29, v29
    v_mov_b32 v16, v27
    v_fma_f32 v17, v17, v28, v29
    v_cvt_pk_bf16_f32 v29, v29, v29
    v_mul_f32 v12, v12, v28
    v_mul_f32 v13, v13, v28
    v_mul_f32 v14, v14, v28
    v_mul_f32 v15, v15, v28
    v_and_b32_dpp v32, v29, v8 row_newbcast:0 row_mask:0xf bank_mask:0xf
    v_and_b32_dpp v33, v29, v9 row_newbcast:0 row_mask:0xf bank_mask:0xf
    v_and_b32_dpp v34, v29, v10 row_newbcast:0 row_mask:0xf bank_mask:0xf
    v_and_b32_dpp v35, v29, v11 row_newbcast:0 row_mask:0xf bank_mask:0xf
    v_and_b32_dpp v36, v29, v8 row_newbcast:8 row_mask:0xf bank_mask:0xf
    v_and_b32_dpp v37, v29, v9 row_newbcast:8 row_mask:0xf bank_mask:0xf
    v_and_b32_dpp v38, v29, v10 row_newbcast:8 row_mask:0xf bank_mask:0xf
    v_and_b32_dpp v39, v29, v11 row_newbcast:8 row_mask:0xf bank_mask:0xf
    v_and_b32_dpp v40, v29, v8 row_newbcast:4 row_mask:0xf bank_mask:0xf
    v_and_b32_dpp v41, v29, v9 row_newbcast:4 row_mask:0xf bank_mask:0xf
    v_and_b32_dpp v42, v29, v10 row_newbcast:4 row_mask:0xf bank_mask:0xf
    v_and_b32_dpp v43, v29, v11 row_newbcast:4 row_mask:0xf bank_mask:0xf
    v_and_b32_dpp v44, v29, v8 row_newbcast:12 row_mask:0xf bank_mask:0xf
    v_and_b32_dpp v45, v29, v9 row_newbcast:12 row_mask:0xf bank_mask:0xf
    v_and_b32_dpp v46, v29, v10 row_newbcast:12 row_mask:0xf bank_mask:0xf
    v_and_b32_dpp v47, v29, v11 row_newbcast:12 row_mask:0xf bank_mask:0xf
    v_mfma_f32_16x16x32_bf16 v[12:15], v[32:35], a[160:163], v[12:15]
    v_mfma_f32_16x16x32_bf16 v[12:15], v[36:39], a[164:167], v[12:15]
    v_mfma_f32_16x16x32_bf16 v[12:15], v[40:43], a[168:171], v[12:15]
    v_mfma_f32_16x16x32_bf16 v[12:15], v[44:47], a[172:175], v[12:15]
    v_dot2_f32_bf16 v20, v240, v4, 0
    v_dot2_f32_bf16 v21, v244, v4, 0
    v_dot2_f32_bf16 v22, v248, v4, 0
    v_dot2_f32_bf16 v23, v252, v4, 0
    v_dot2_f32_bf16 v20, v241, v5, v20
    v_dot2_f32_bf16 v21, v245, v5, v21
    v_dot2_f32_bf16 v22, v249, v5, v22
    v_dot2_f32_bf16 v23, v253, v5, v23
    v_dot2_f32_bf16 v20, v242, v6, v20
    v_dot2_f32_bf16 v21, v246, v6, v21
    v_dot2_f32_bf16 v22, v250, v6, v22
    v_dot2_f32_bf16 v23, v254, v6, v23
    v_dot2_f32_bf16 v20, v243, v7, v20
    v_dot2_f32_bf16 v21, v247, v7, v21
    v_dot2_f32_bf16 v22, v251, v7, v22
    v_dot2_f32_bf16 v23, v255, v7, v23
    v_add_f32_dpp v24, v20, v20 row_ror:8 row_mask:0xf bank_mask:0x3
    s_nop 0
    v_add_f32_dpp v25, v22, v22 row_ror:8 row_mask:0xf bank_mask:0x3
    v_add_f32_dpp v24, v21, v21 row_ror:8 row_mask:0xf bank_mask:0xc
    v_add_f32_dpp v25, v23, v23 row_ror:8 row_mask:0xf bank_mask:0xc
    s_nop 0
    v_add_f32_dpp v26, v24, v24 row_shl:4 row_mask:0xf bank_mask:0x5
    v_add_f32_dpp v26, v25, v25 row_shr:4 row_mask:0xf bank_mask:0xa
    s_nop 1
    v_add_f32_dpp v26, v26, v26 quad_perm:[1,0,3,2] row_mask:0xf bank_mask:0xf
    s_nop 1
    v_add_f32_dpp v26, v26, v26 quad_perm:[2,3,0,1] row_mask:0xf bank_mask:0xf
    v_cvt_pk_bf16_f32 v26, v26, v26
    v_and_b32 v26, s98, v26
    v_mul_f32 v26, s96, v26
    v_cvt_pk_bf16_f32 v26, v26, v26
    v_and_b32 v26, s98, v26
    s_nop 1
    v_max_f32_dpp v27, v26, v26 row_ror:4 row_mask:0xf bank_mask:0xf
    s_nop 1
    v_max_f32_dpp v27, v27, v27 row_ror:8 row_mask:0xf bank_mask:0xf
    v_mov_b32 v28, v27
    s_nop 1
    v_permlane16_swap_b32 v27, v28
    v_max_f32 v27, v27, v28
    v_mov_b32 v28, v27
    s_nop 1
    v_permlane32_swap_b32 v27, v28
    v_max3_f32 v27, v27, v28, v16
    v_sub_f32 v28, v16, v27
    v_sub_f32 v29, v26, v27
    v_mul_f32 v28, s97, v28
    v_mul_f32 v29, s97, v29
    v_exp_f32 v28, v28
    v_exp_f32 v29, v29
    v_mov_b32 v16, v27
    v_fma_f32 v17, v17, v28, v29
    v_cvt_pk_bf16_f32 v29, v29, v29
    v_mul_f32 v12, v12, v28
    v_mul_f32 v13, v13, v28
    v_mul_f32 v14, v14, v28
    v_mul_f32 v15, v15, v28
    v_and_b32_dpp v32, v29, v8 row_newbcast:0 row_mask:0xf bank_mask:0xf
    v_and_b32_dpp v33, v29, v9 row_newbcast:0 row_mask:0xf bank_mask:0xf
    v_and_b32_dpp v34, v29, v10 row_newbcast:0 row_mask:0xf bank_mask:0xf
    v_and_b32_dpp v35, v29, v11 row_newbcast:0 row_mask:0xf bank_mask:0xf
    v_and_b32_dpp v36, v29, v8 row_newbcast:8 row_mask:0xf bank_mask:0xf
    v_and_b32_dpp v37, v29, v9 row_newbcast:8 row_mask:0xf bank_mask:0xf
    v_and_b32_dpp v38, v29, v10 row_newbcast:8 row_mask:0xf bank_mask:0xf
    v_and_b32_dpp v39, v29, v11 row_newbcast:8 row_mask:0xf bank_mask:0xf
    v_and_b32_dpp v40, v29, v8 row_newbcast:4 row_mask:0xf bank_mask:0xf
    v_and_b32_dpp v41, v29, v9 row_newbcast:4 row_mask:0xf bank_mask:0xf
    v_and_b32_dpp v42, v29, v10 row_newbcast:4 row_mask:0xf bank_mask:0xf
    v_and_b32_dpp v43, v29, v11 row_newbcast:4 row_mask:0xf bank_mask:0xf
    v_and_b32_dpp v44, v29, v8 row_newbcast:12 row_mask:0xf bank_mask:0xf
    v_and_b32_dpp v45, v29, v9 row_newbcast:12 row_mask:0xf bank_mask:0xf
    v_and_b32_dpp v46, v29, v10 row_newbcast:12 row_mask:0xf bank_mask:0xf
    v_and_b32_dpp v47, v29, v11 row_newbcast:12 row_mask:0xf bank_mask:0xf
    v_mfma_f32_16x16x32_bf16 v[12:15], v[32:35], a[176:179], v[12:15]
    v_mfma_f32_16x16x32_bf16 v[12:15], v[36:39], a[180:183], v[12:15]
    v_mfma_f32_16x16x32_bf16 v[12:15], v[40:43], a[184:187], v[12:15]
    v_mfma_f32_16x16x32_bf16 v[12:15], v[44:47], a[188:191], v[12:15]
    s_mov_b32 s56, 0
    s_branch L_aback1
L_aflag:
    s_sleep 2
    global_load_dword v57, v58, s[28:29] sc1
    s_waitcnt vmcnt(0)
    v_cmp_gt_u32 vcc, 2, v57
    s_cbranch_vccz L_aflag_ok
    s_sub_u32 s101, s101, 1
    s_cbranch_scc0 L_aflag
    s_mov_b32 s101, 0
    s_branch L_aflag_ok
L_roleA_end:
L_roleH:
    s_mov_b32 s101, 100000
    s_getpc_b64 s[56:57]
L_pc_12:
    s_sub_u32 s56, s56, L_pc_12-L_roleH
    s_subb_u32 s57, s57, 0
    v_lshlrev_b32 v5, 7, v0
    v_min_u32 v6, L_roleH_end-L_roleH-4, v5
    global_load_dword v122, v6, s[56:57]
    v_mov_b32 v20, -1
    v_mov_b32 v21, -1
    v_mov_b32 v22, -1
    v_mov_b32 v23, -1
    v_mul_u32_u24 v7, 73728, v4
    v_lshrrev_b32 v5, 3, v3
    v_lshl_add_u32 v6, v5, 13, v7
    v_and_b32 v5, 7, v3
    v_lshl_add_u32 v6, v5, 4, v6
    v_lshl_add_u32 v7, v3, 3, v7
    v_add_u32 v7, 65536, v7
    s_lshl_b32 s56, s52, 7
    s_add_u32 s56, s56, 4718592
    s_lshl_b32 s54, s3, 14
    s_add_u32 s54, s54, s56
    s_add_u32 s55, s54, 4096
    s_and_b32 s57, s3, 1
    s_lshl_b32 s57, s57, 12
    s_add_u32 s56, s56, s57
    s_waitcnt lgkmcnt(0)
    s_mov_b32 s44, s30
    s_mov_b32 s45, s31
    s_mov_b32 s46, 536870912
    s_mov_b32 s47, 0x20000
    buffer_store_dwordx4 v[20:23], v6, s[44:47], s54 offen sc1
    buffer_store_dwordx4 v[20:23], v6, s[44:47], s55 offen sc1
    buffer_store_dwordx2 v[20:21], v7, s[44:47], s56 offen sc1
    v_lshrrev_b32 v5, 2, v3
    v_lshlrev_b32 v5, 15, v5
    v_lshl_add_u32 v5, v4, 4, v5
    v_and_b32 v6, 3, v3
    v_lshl_add_u32 v5, v6, 6, v5
    s_lshl_b32 s54, s52, 10
    s_lshl_b32 s55, s3, 8
    s_add_u32 s54, s54, s55
    s_add_u32 s54, s54, 1048576
    buffer_store_dwordx4 v[20:23], v5, s[44:47], s54 offen sc1
    v_bfe_u32 v6, v1, 2, 2
    v_lshlrev_b32 v6, 6, v6
    v_and_b32 v5, 48, v1
    v_add_u32 v6, v6, v5
    v_and_b32 v5, 3, v1
    v_lshl_add_u32 v6, v5, 29, v6
    s_lshl_b32 s54, s52, 10
    s_lshl_b32 s55, s3, 8
    s_add_u32 s54, s54, s55
    s_add_u32 s54, s54, 5439488
    buffer_store_dwordx4 v[20:23], v6, s[44:47], s54 offen sc1
    v_mov_b32 v7, 536870912
    v_cmp_gt_u32 vcc, 32, v1
    s_nop 1
    v_cndmask_b32 v123, v7, v2, vcc
    s_lshl_b32 s98, s52, 12
    s_lshl_b32 s54, s3, 9
    s_add_u32 s98, s98, s54
    s_add_u32 s98, s98, 5242880
    buffer_store_dwordx4 v[20:23], v123, s[44:47], s98 offen sc1
    s_mov_b32 s40, s10
    s_mov_b32 s41, s11
    s_mov_b32 s42, 4718592
    s_mov_b32 s43, 0x20000
    s_mov_b32 s48, s4
    s_mov_b32 s49, s5
    s_mov_b32 s50, 4608
    s_mov_b32 s51, 0x20000
    v_lshrrev_b32 v5, 3, v3
    v_mul_u32_u24 v5, 1152, v5
    v_mul_u32_u24 v6, 36, v4
    v_add_u32 v5, v5, v6
    s_mul_i32 s54, s3, 144
    buffer_load_dwordx4 v[24:27], v5, s[48:51], s54 offen offset:0
    buffer_load_dwordx4 v[28:31], v5, s[48:51], s54 offen offset:16
    buffer_load_dword v32, v5, s[48:51], s54 offen offset:32
    buffer_load_dwordx4 v[36:39], v5, s[48:51], s54 offen offset:2304
    buffer_load_dwordx4 v[40:43], v5, s[48:51], s54 offen offset:2320
    buffer_load_dword v44, v5, s[48:51], s54 offen offset:2336
    v_mul_u32_u24 v120, 147456, v4
    v_lshl_add_u32 v120, v3, 4, v120
    s_mul_i32 s61, s3, 589824
    s_lshl_b32 s54, s52, 8
    s_add_u32 s61, s61, s54
    buffer_load_dwordx4 a[0:3], v120, s[40:43], s61 offen nt
    s_add_u32 s61, s61, 8192
    buffer_load_dwordx4 a[4:7], v120, s[40:43], s61 offen nt
    s_add_u32 s61, s61, 8192
    buffer_load_dwordx4 a[8:11], v120, s[40:43], s61 offen nt
    s_add_u32 s61, s61, 8192
    buffer_load_dwordx4 a[12:15], v120, s[40:43], s61 offen nt
    s_add_u32 s61, s61, 8192
    buffer_load_dwordx4 a[16:19], v120, s[40:43], s61 offen nt
    s_add_u32 s61, s61, 8192
    buffer_load_dwordx4 a[20:23], v120, s[40:43], s61 offen nt
    s_add_u32 s61, s61, 8192
    buffer_load_dwordx4 a[24:27], v120, s[40:43], s61 offen nt
    s_add_u32 s61, s61, 8192
    buffer_load_dwordx4 a[28:31], v120, s[40:43], s61 offen nt
    s_add_u32 s61, s61, 8192
    buffer_load_dwordx4 a[32:35], v120, s[40:43], s61 offen nt
    s_add_u32 s61, s61, 8192
    buffer_load_dwordx4 a[36:39], v120, s[40:43], s61 offen nt
    s_add_u32 s61, s61, 8192
    buffer_load_dwordx4 a[40:43], v120, s[40:43], s61 offen nt
    s_add_u32 s61, s61, 8192
    buffer_load_dwordx4 a[44:47], v120, s[40:43], s61 offen nt
    s_add_u32 s61, s61, 8192
    buffer_load_dwordx4 a[48:51], v120, s[40:43], s61 offen nt
    s_add_u32 s61, s61, 8192
    buffer_load_dwordx4 a[52:55], v120, s[40:43], s61 offen nt
    s_add_u32 s61, s61, 8192
    buffer_load_dwordx4 a[56:59], v120, s[40:43], s61 offen nt
    s_add_u32 s61, s61, 8192
    buffer_load_dwordx4 a[60:63], v120, s[40:43], s61 offen nt
    s_add_u32 s61, s61, 8192
    buffer_load_dwordx4 a[64:67], v120, s[40:43], s61 offen nt
    s_add_u32 s61, s61, 8192
    buffer_load_dwordx4 a[68:71], v120, s[40:43], s61 offen nt
    s_add_u32 s61, s61, 8192
    s_mov_b32 s32, s18
    s_mov_b32 s33, s19
    s_mov_b32 s34, 4718592
    s_mov_b32 s35, 0x20000
    s_mov_b32 s36, s14
    s_mov_b32 s37, s15
    s_mov_b32 s38, 4608
    s_mov_b32 s39, 0x20000
    v_lshrrev_b32 v5, 3, v3
    v_mul_u32_u24 v5, 1152, v5
    v_mul_u32_u24 v6, 72, v4
    v_add_u32 v5, v5, v6
    s_mul_i32 s54, s3, 288
    buffer_load_dwordx4 v[48:51], v5, s[36:39], s54 offen offset:0
    buffer_load_dwordx4 v[52:55], v5, s[36:39], s54 offen offset:16
    buffer_load_dwordx4 v[56:59], v5, s[36:39], s54 offen offset:32
    buffer_load_dwordx4 v[60:63], v5, s[36:39], s54 offen offset:48
    buffer_load_dwordx2 v[64:65], v5, s[36:39], s54 offen offset:64
    buffer_load_dwordx4 v[68:71], v5, s[36:39], s54 offen offset:2304
    buffer_load_dwordx4 v[72:75], v5, s[36:39], s54 offen offset:2320
    buffer_load_dwordx4 v[76:79], v5, s[36:39], s54 offen offset:2336
    buffer_load_dwordx4 v[80:83], v5, s[36:39], s54 offen offset:2352
    buffer_load_dwordx2 v[84:85], v5, s[36:39], s54 offen offset:2368
    v_mul_u32_u24 v120, 294912, v4
    v_lshl_add_u32 v120, v3, 4, v120
    s_mul_i32 s61, s3, 1179648
    s_lshl_b32 s54, s52, 8
    s_add_u32 s61, s61, s54
    buffer_load_dwordx4 a[112:115], v120, s[32:35], s61 offen nt
    s_add_u32 s61, s61, 8192
    buffer_load_dwordx4 a[116:119], v120, s[32:35], s61 offen nt
    s_add_u32 s61, s61, 8192
    buffer_load_dwordx4 a[120:123], v120, s[32:35], s61 offen nt
    s_add_u32 s61, s61, 8192
    buffer_load_dwordx4 a[124:127], v120, s[32:35], s61 offen nt
    s_add_u32 s61, s61, 8192
    buffer_load_dwordx4 a[128:131], v120, s[32:35], s61 offen nt
    s_add_u32 s61, s61, 8192
    buffer_load_dwordx4 a[132:135], v120, s[32:35], s61 offen nt
    s_add_u32 s61, s61, 8192
    buffer_load_dwordx4 a[136:139], v120, s[32:35], s61 offen nt
    s_add_u32 s61, s61, 8192
    buffer_load_dwordx4 a[140:143], v120, s[32:35], s61 offen nt
    s_add_u32 s61, s61, 8192
    buffer_load_dwordx4 a[144:147], v120, s[32:35], s61 offen nt
    s_add_u32 s61, s61, 8192
    s_mov_b32 s36, s20
    s_mov_b32 s37, s21
    s_mov_b32 s38, 4194304
    s_mov_b32 s39, 0x20000
    s_mov_b32 s40, s22
    s_mov_b32 s41, s23
    s_mov_b32 s42, 4194304
    s_mov_b32 s43, 0x20000
    v_lshlrev_b32 v5, 2, v4
    v_xor_b32 v5, v5, v3
    v_lshlrev_b32 v6, 13, v4
    v_xor_b32 v7, 0, v5
    v_lshl_add_u32 v88, v7, 4, v6
    v_xor_b32 v7, 1, v5
    v_lshl_add_u32 v89, v7, 4, v6
    v_xor_b32 v7, 2, v5
    v_lshl_add_u32 v90, v7, 4, v6
    v_xor_b32 v7, 3, v5
    v_lshl_add_u32 v91, v7, 4, v6
    s_lshl_b32 s62, s3, 20
    s_lshl_b32 s54, s52, 8
    s_add_u32 s62, s62, s54
    s_mov_b32 s60, s62
    s_lshl_b32 s63, s3, 15
    v_lshlrev_b32 v121, 18, v4
    v_lshl_add_u32 v121, v3, 4, v121
    v_lshrrev_b32 v5, 2, v3
    v_and_b32 v6, 3, v3
    v_lshl_add_u32 v7, v5, 3, v6
    v_lshlrev_b32 v92, 8, v7
    v_lshl_or_b32 v5, v6, 2, v5
    v_xor_b32 v5, v5, v4
    v_lshl_add_u32 v92, v5, 4, v92
    v_add_u32 v92, s63, v92
    v_xor_b32 v93, 64, v92
    v_xor_b32 v94, 128, v92
    v_xor_b32 v95, 192, v92
    v_and_b32 v5, 1, v3
    v_cmp_eq_u32 vcc, 1, v5
    v_mov_b32 v5, 0x0c0c0100
    v_mov_b32 v6, 0x01000c0c
    v_cndmask_b32 v5, v5, v6, vcc
    v_mov_b32 v6, 0x0c0c0302
    v_mov_b32 v7, 0x03020c0c
    v_cndmask_b32 v6, v6, v7, vcc
    v_bfe_u32 v7, v3, 1, 2
    v_mov_b32 v16, 0x0c0c0c0c
    v_cmp_eq_u32 vcc, 0, v7
    s_nop 1
    v_cndmask_b32 v8, v16, v5, vcc
    v_cndmask_b32 v9, v16, v6, vcc
    v_cmp_eq_u32 vcc, 1, v7
    s_nop 1
    v_cndmask_b32 v10, v16, v5, vcc
    v_cndmask_b32 v11, v16, v6, vcc
    v_cmp_eq_u32 vcc, 2, v7
    s_nop 1
    v_cndmask_b32 v12, v16, v5, vcc
    v_cndmask_b32 v13, v16, v6, vcc
    v_cmp_eq_u32 vcc, 3, v7
    s_nop 1
    v_cndmask_b32 v14, v16, v5, vcc
    v_cndmask_b32 v15, v16, v6, vcc
    s_waitcnt vmcnt(43)
    s_barrier
    s_cmp_lg_u32 s3, 0
    s_cbranch_scc1 L_nosig_13
    s_lshl_b32 s54, s52, 2
    v_mov_b32 v5, s54
    v_mov_b32 v6, 1
    s_mov_b64 exec, 1
    global_atomic_add v5, v6, s[28:29]
    s_mov_b64 exec, -1
L_nosig_13:
    s_waitcnt vmcnt(28)
    buffer_load_dwordx4 a[148:151], v120, s[32:35], s61 offen nt
    s_add_u32 s61, s61, 8192
    buffer_load_dwordx4 a[152:155], v120, s[32:35], s61 offen nt
    s_add_u32 s61, s61, 8192
    buffer_load_dwordx4 a[156:159], v120, s[32:35], s61 offen nt
    s_add_u32 s61, s61, 8192
    buffer_load_dwordx4 a[160:163], v120, s[32:35], s61 offen nt
    s_add_u32 s61, s61, 8192
    buffer_load_dwordx4 a[164:167], v120, s[32:35], s61 offen nt
    s_add_u32 s61, s61, 8192
    buffer_load_dwordx4 a[168:171], v120, s[32:35], s61 offen nt
    s_add_u32 s61, s61, 8192
    buffer_load_dwordx4 a[172:175], v120, s[32:35], s61 offen nt
    s_add_u32 s61, s61, 8192
    buffer_load_dwordx4 a[176:179], v120, s[32:35], s61 offen nt
    s_add_u32 s61, s61, 8192
    buffer_load_dwordx4 a[180:183], v120, s[32:35], s61 offen nt
    s_add_u32 s61, s61, 8192
    buffer_load_dwordx4 a[184:187], v120, s[32:35], s61 offen nt
    s_add_u32 s61, s61, 8192
    v_perm_b32 v96, v24, v24, v8
    v_perm_b32 v97, v24, v24, v10
    v_perm_b32 v98, v24, v24, v12
    v_perm_b32 v99, v24, v24, v14
    s_nop 1
    v_mfma_f32_16x16x32_bf16 v[112:115], v[96:99], a[0:3], 0
    v_perm_b32 v100, v36, v36, v8
    v_perm_b32 v101, v36, v36, v10
    v_perm_b32 v102, v36, v36, v12
    v_perm_b32 v103, v36, v36, v14
    s_nop 1
    v_mfma_f32_16x16x32_bf16 v[116:119], v[100:103], a[0:3], 0
    v_perm_b32 v104, v24, v24, v9
    v_perm_b32 v105, v24, v24, v11
    v_perm_b32 v106, v24, v24, v13
    v_perm_b32 v107, v24, v24, v15
    s_nop 1
    v_mfma_f32_16x16x32_bf16 v[112:115], v[104:107], a[4:7], v[112:115]
    v_perm_b32 v108, v36, v36, v9
    v_perm_b32 v109, v36, v36, v11
    v_perm_b32 v110, v36, v36, v13
    v_perm_b32 v111, v36, v36, v15
    s_nop 1
    v_mfma_f32_16x16x32_bf16 v[116:119], v[108:111], a[4:7], v[116:119]
    v_perm_b32 v96, v25, v25, v8
    v_perm_b32 v97, v25, v25, v10
    v_perm_b32 v98, v25, v25, v12
    v_perm_b32 v99, v25, v25, v14
    s_nop 1
    v_mfma_f32_16x16x32_bf16 v[112:115], v[96:99], a[8:11], v[112:115]
    v_perm_b32 v100, v37, v37, v8
    v_perm_b32 v101, v37, v37, v10
    v_perm_b32 v102, v37, v37, v12
    v_perm_b32 v103, v37, v37, v14
    s_nop 1
    v_mfma_f32_16x16x32_bf16 v[116:119], v[100:103], a[8:11], v[116:119]
    v_perm_b32 v104, v25, v25, v9
    v_perm_b32 v105, v25, v25, v11
    v_perm_b32 v106, v25, v25, v13
    v_perm_b32 v107, v25, v25, v15
    s_nop 1
    v_mfma_f32_16x16x32_bf16 v[112:115], v[104:107], a[12:15], v[112:115]
    v_perm_b32 v108, v37, v37, v9
    v_perm_b32 v109, v37, v37, v11
    v_perm_b32 v110, v37, v37, v13
    v_perm_b32 v111, v37, v37, v15
    s_nop 1
    v_mfma_f32_16x16x32_bf16 v[116:119], v[108:111], a[12:15], v[116:119]
    v_perm_b32 v96, v26, v26, v8
    v_perm_b32 v97, v26, v26, v10
    v_perm_b32 v98, v26, v26, v12
    v_perm_b32 v99, v26, v26, v14
    s_nop 1
    v_mfma_f32_16x16x32_bf16 v[112:115], v[96:99], a[16:19], v[112:115]
    v_perm_b32 v100, v38, v38, v8
    v_perm_b32 v101, v38, v38, v10
    v_perm_b32 v102, v38, v38, v12
    v_perm_b32 v103, v38, v38, v14
    s_nop 1
    v_mfma_f32_16x16x32_bf16 v[116:119], v[100:103], a[16:19], v[116:119]
    v_perm_b32 v104, v26, v26, v9
    v_perm_b32 v105, v26, v26, v11
    v_perm_b32 v106, v26, v26, v13
    v_perm_b32 v107, v26, v26, v15
    s_nop 1
    v_mfma_f32_16x16x32_bf16 v[112:115], v[104:107], a[20:23], v[112:115]
    v_perm_b32 v108, v38, v38, v9
    v_perm_b32 v109, v38, v38, v11
    v_perm_b32 v110, v38, v38, v13
    v_perm_b32 v111, v38, v38, v15
    s_nop 1
    v_mfma_f32_16x16x32_bf16 v[116:119], v[108:111], a[20:23], v[116:119]
    v_perm_b32 v96, v27, v27, v8
    v_perm_b32 v97, v27, v27, v10
    v_perm_b32 v98, v27, v27, v12
    v_perm_b32 v99, v27, v27, v14
    s_nop 1
    v_mfma_f32_16x16x32_bf16 v[112:115], v[96:99], a[24:27], v[112:115]
    v_perm_b32 v100, v39, v39, v8
    v_perm_b32 v101, v39, v39, v10
    v_perm_b32 v102, v39, v39, v12
    v_perm_b32 v103, v39, v39, v14
    s_nop 1
    v_mfma_f32_16x16x32_bf16 v[116:119], v[100:103], a[24:27], v[116:119]
    v_perm_b32 v104, v27, v27, v9
    v_perm_b32 v105, v27, v27, v11
    v_perm_b32 v106, v27, v27, v13
    v_perm_b32 v107, v27, v27, v15
    s_nop 1
    v_mfma_f32_16x16x32_bf16 v[112:115], v[104:107], a[28:31], v[112:115]
    v_perm_b32 v108, v39, v39, v9
    v_perm_b32 v109, v39, v39, v11
    v_perm_b32 v110, v39, v39, v13
    v_perm_b32 v111, v39, v39, v15
    s_nop 1
    v_mfma_f32_16x16x32_bf16 v[116:119], v[108:111], a[28:31], v[116:119]
    v_perm_b32 v96, v28, v28, v8
    v_perm_b32 v97, v28, v28, v10
    v_perm_b32 v98, v28, v28, v12
    v_perm_b32 v99, v28, v28, v14
    s_nop 1
    v_mfma_f32_16x16x32_bf16 v[112:115], v[96:99], a[32:35], v[112:115]
    v_perm_b32 v100, v40, v40, v8
    v_perm_b32 v101, v40, v40, v10
    v_perm_b32 v102, v40, v40, v12
    v_perm_b32 v103, v40, v40, v14
    s_nop 1
    v_mfma_f32_16x16x32_bf16 v[116:119], v[100:103], a[32:35], v[116:119]
    s_waitcnt vmcnt(29)
    buffer_load_dwordx4 a[188:191], v120, s[32:35], s61 offen nt
    s_add_u32 s61, s61, 8192
    buffer_load_dwordx4 a[192:195], v120, s[32:35], s61 offen nt
    s_add_u32 s61, s61, 8192
    buffer_load_dwordx4 a[196:199], v120, s[32:35], s61 offen nt
    s_add_u32 s61, s61, 8192
    buffer_load_dwordx4 a[200:203], v120, s[32:35], s61 offen nt
    s_add_u32 s61, s61, 8192
    buffer_load_dwordx4 a[204:207], v120, s[32:35], s61 offen nt
    s_add_u32 s61, s61, 8192
    buffer_load_dwordx4 a[208:211], v120, s[32:35], s61 offen nt
    s_add_u32 s61, s61, 8192
    buffer_load_dwordx4 a[212:215], v120, s[32:35], s61 offen nt
    s_add_u32 s61, s61, 8192
    buffer_load_dwordx4 a[216:219], v120, s[32:35], s61 offen nt
    s_add_u32 s61, s61, 8192
    buffer_load_dwordx4 a[220:223], v120, s[32:35], s61 offen nt
    s_add_u32 s61, s61, 8192
    v_perm_b32 v104, v28, v28, v9
    v_perm_b32 v105, v28, v28, v11
    v_perm_b32 v106, v28, v28, v13
    v_perm_b32 v107, v28, v28, v15
    s_nop 1
    v_mfma_f32_16x16x32_bf16 v[112:115], v[104:107], a[36:39], v[112:115]
    v_perm_b32 v108, v40, v40, v9
    v_perm_b32 v109, v40, v40, v11
    v_perm_b32 v110, v40, v40, v13
    v_perm_b32 v111, v40, v40, v15
    s_nop 1
    v_mfma_f32_16x16x32_bf16 v[116:119], v[108:111], a[36:39], v[116:119]
    v_perm_b32 v96, v29, v29, v8
    v_perm_b32 v97, v29, v29, v10
    v_perm_b32 v98, v29, v29, v12
    v_perm_b32 v99, v29, v29, v14
    s_nop 1
    v_mfma_f32_16x16x32_bf16 v[112:115], v[96:99], a[40:43], v[112:115]
    v_perm_b32 v100, v41, v41, v8
    v_perm_b32 v101, v41, v41, v10
    v_perm_b32 v102, v41, v41, v12
    v_perm_b32 v103, v41, v41, v14
    s_nop 1
    v_mfma_f32_16x16x32_bf16 v[116:119], v[100:103], a[40:43], v[116:119]
    v_perm_b32 v104, v29, v29, v9
    v_perm_b32 v105, v29, v29, v11
    v_perm_b32 v106, v29, v29, v13
    v_perm_b32 v107, v29, v29, v15
    s_nop 1
    v_mfma_f32_16x16x32_bf16 v[112:115], v[104:107], a[44:47], v[112:115]
    v_perm_b32 v108, v41, v41, v9
    v_perm_b32 v109, v41, v41, v11
    v_perm_b32 v110, v41, v41, v13
    v_perm_b32 v111, v41, v41, v15
    s_nop 1
    v_mfma_f32_16x16x32_bf16 v[116:119], v[108:111], a[44:47], v[116:119]
    v_perm_b32 v96, v30, v30, v8
    v_perm_b32 v97, v30, v30, v10
    v_perm_b32 v98, v30, v30, v12
    v_perm_b32 v99, v30, v30, v14
    s_nop 1
    v_mfma_f32_16x16x32_bf16 v[112:115], v[96:99], a[48:51], v[112:115]
    v_perm_b32 v100, v42, v42, v8
    v_perm_b32 v101, v42, v42, v10
    v_perm_b32 v102, v42, v42, v12
    v_perm_b32 v103, v42, v42, v14
    s_nop 1
    v_mfma_f32_16x16x32_bf16 v[116:119], v[100:103], a[48:51], v[116:119]
    v_perm_b32 v104, v30, v30, v9
    v_perm_b32 v105, v30, v30, v11
    v_perm_b32 v106, v30, v30, v13
    v_perm_b32 v107, v30, v30, v15
    s_nop 1
    v_mfma_f32_16x16x32_bf16 v[112:115], v[104:107], a[52:55], v[112:115]
    v_perm_b32 v108, v42, v42, v9
    v_perm_b32 v109, v42, v42, v11
    v_perm_b32 v110, v42, v42, v13
    v_perm_b32 v111, v42, v42, v15
    s_nop 1
    v_mfma_f32_16x16x32_bf16 v[116:119], v[108:111], a[52:55], v[116:119]
    v_perm_b32 v96, v31, v31, v8
    v_perm_b32 v97, v31, v31, v10
    v_perm_b32 v98, v31, v31, v12
    v_perm_b32 v99, v31, v31, v14
    s_nop 1
    v_mfma_f32_16x16x32_bf16 v[112:115], v[96:99], a[56:59], v[112:115]
    v_perm_b32 v100, v43, v43, v8
    v_perm_b32 v101, v43, v43, v10
    v_perm_b32 v102, v43, v43, v12
    v_perm_b32 v103, v43, v43, v14
    s_nop 1
    v_mfma_f32_16x16x32_bf16 v[116:119], v[100:103], a[56:59], v[116:119]
    v_perm_b32 v104, v31, v31, v9
    v_perm_b32 v105, v31, v31, v11
    v_perm_b32 v106, v31, v31, v13
    v_perm_b32 v107, v31, v31, v15
    s_nop 1
    v_mfma_f32_16x16x32_bf16 v[112:115], v[104:107], a[60:63], v[112:115]
    v_perm_b32 v108, v43, v43, v9
    v_perm_b32 v109, v43, v43, v11
    v_perm_b32 v110, v43, v43, v13
    v_perm_b32 v111, v43, v43, v15
    s_nop 1
    v_mfma_f32_16x16x32_bf16 v[116:119], v[108:111], a[60:63], v[116:119]
    v_perm_b32 v96, v32, v32, v8
    v_perm_b32 v97, v32, v32, v10
    v_perm_b32 v98, v32, v32, v12
    v_perm_b32 v99, v32, v32, v14
    s_nop 1
    v_mfma_f32_16x16x32_bf16 v[112:115], v[96:99], a[64:67], v[112:115]
    v_perm_b32 v100, v44, v44, v8
    v_perm_b32 v101, v44, v44, v10
    v_perm_b32 v102, v44, v44, v12
    v_perm_b32 v103, v44, v44, v14
    s_nop 1
    v_mfma_f32_16x16x32_bf16 v[116:119], v[100:103], a[64:67], v[116:119]
    v_perm_b32 v104, v32, v32, v9
    v_perm_b32 v105, v32, v32, v11
    v_perm_b32 v106, v32, v32, v13
    v_perm_b32 v107, v32, v32, v15
    s_nop 1
    v_mfma_f32_16x16x32_bf16 v[112:115], v[104:107], a[68:71], v[112:115]
    v_perm_b32 v108, v44, v44, v9
    v_perm_b32 v109, v44, v44, v11
    v_perm_b32 v110, v44, v44, v13
    v_perm_b32 v111, v44, v44, v15
    s_nop 1
    v_mfma_f32_16x16x32_bf16 v[116:119], v[108:111], a[68:71], v[116:119]
    v_lshrrev_b32 v5, 1, v4
    v_lshlrev_b32 v5, 9, v5
    v_lshl_add_u32 v5, v3, 5, v5
    v_and_b32 v6, 1, v4
    v_lshl_add_u32 v5, v6, 4, v5
    s_lshl_b32 s54, s3, 11
    s_add_u32 s54, s54, 139264
    v_add_u32 v5, s54, v5
    ds_write_b128 v5, v[112:115]
    ds_write_b128 v5, v[116:119] offset:1024
    s_waitcnt lgkmcnt(0)
    s_barrier
    s_lshl_b32 s54, s3, 9
    s_add_u32 s54, s54, 139264
    v_add_u32 v5, s54, v2
    ds_read_b128 v[96:99], v5 offset:0
    ds_read_b128 v[100:103], v5 offset:2048
    ds_read_b128 v[104:107], v5 offset:4096
    ds_read_b128 v[108:111], v5 offset:6144
    s_waitcnt lgkmcnt(0)
    v_add_f32 v96, v96, v100
    v_add_f32 v104, v104, v108
    v_add_f32 v97, v97, v101
    v_add_f32 v105, v105, v109
    v_add_f32 v98, v98, v102
    v_add_f32 v106, v106, v110
    v_add_f32 v99, v99, v103
    v_add_f32 v107, v107, v111
    v_add_f32 v96, v96, v104
    v_add_f32 v97, v97, v105
    v_add_f32 v98, v98, v106
    v_add_f32 v99, v99, v107
    v_min_u32 v124, -2, v96
    v_min_u32 v125, -2, v97
    v_min_u32 v126, -2, v98
    v_min_u32 v127, -2, v99
    buffer_store_dwordx4 v[124:127], v123, s[44:47], s98 offen sc1
    s_waitcnt vmcnt(20)
    buffer_load_dwordx4 a[224:227], v120, s[32:35], s61 offen nt
    s_add_u32 s61, s61, 8192
    buffer_load_dwordx4 a[228:231], v120, s[32:35], s61 offen nt
    s_add_u32 s61, s61, 8192
    buffer_load_dwordx4 a[232:235], v120, s[32:35], s61 offen nt
    s_add_u32 s61, s61, 8192
    buffer_load_dwordx4 a[236:239], v120, s[32:35], s61 offen nt
    s_add_u32 s61, s61, 8192
    buffer_load_dwordx4 a[240:243], v120, s[32:35], s61 offen nt
    s_add_u32 s61, s61, 8192
    buffer_load_dwordx4 a[244:247], v120, s[32:35], s61 offen nt
    s_add_u32 s61, s61, 8192
    buffer_load_dwordx4 a[248:251], v120, s[32:35], s61 offen nt
    s_add_u32 s61, s61, 8192
    buffer_load_dwordx4 a[252:255], v120, s[32:35], s61 offen nt
    s_add_u32 s61, s61, 8192
    s_add_u32 m0, s63, 0
    s_nop 0
    buffer_load_dwordx4 v88, s[36:39], s60 offen nt lds
    s_add_u32 s60, s60, 32768
    v_perm_b32 v96, v48, v48, v8
    v_perm_b32 v97, v48, v48, v10
    v_perm_b32 v98, v48, v48, v12
    v_perm_b32 v99, v48, v48, v14
    s_nop 1
    v_mfma_f32_16x16x32_bf16 v[112:115], v[96:99], a[112:115], 0
    v_perm_b32 v100, v68, v68, v8
    v_perm_b32 v101, v68, v68, v10
    v_perm_b32 v102, v68, v68, v12
    v_perm_b32 v103, v68, v68, v14
    s_nop 1
    v_mfma_f32_16x16x32_bf16 v[116:119], v[100:103], a[112:115], 0
    v_perm_b32 v104, v48, v48, v9
    v_perm_b32 v105, v48, v48, v11
    v_perm_b32 v106, v48, v48, v13
    v_perm_b32 v107, v48, v48, v15
    s_nop 1
    v_mfma_f32_16x16x32_bf16 v[112:115], v[104:107], a[116:119], v[112:115]
    v_perm_b32 v108, v68, v68, v9
    v_perm_b32 v109, v68, v68, v11
    v_perm_b32 v110, v68, v68, v13
    v_perm_b32 v111, v68, v68, v15
    s_nop 1
    v_mfma_f32_16x16x32_bf16 v[116:119], v[108:111], a[116:119], v[116:119]
    v_perm_b32 v96, v49, v49, v8
    v_perm_b32 v97, v49, v49, v10
    v_perm_b32 v98, v49, v49, v12
    v_perm_b32 v99, v49, v49, v14
    s_nop 1
    v_mfma_f32_16x16x32_bf16 v[112:115], v[96:99], a[120:123], v[112:115]
    v_perm_b32 v100, v69, v69, v8
    v_perm_b32 v101, v69, v69, v10
    v_perm_b32 v102, v69, v69, v12
    v_perm_b32 v103, v69, v69, v14
    s_nop 1
    v_mfma_f32_16x16x32_bf16 v[116:119], v[100:103], a[120:123], v[116:119]
    v_perm_b32 v104, v49, v49, v9
    v_perm_b32 v105, v49, v49, v11
    v_perm_b32 v106, v49, v49, v13
    v_perm_b32 v107, v49, v49, v15
    s_nop 1
    v_mfma_f32_16x16x32_bf16 v[112:115], v[104:107], a[124:127], v[112:115]
    v_perm_b32 v108, v69, v69, v9
    v_perm_b32 v109, v69, v69, v11
    v_perm_b32 v110, v69, v69, v13
    v_perm_b32 v111, v69, v69, v15
    s_nop 1
    v_mfma_f32_16x16x32_bf16 v[116:119], v[108:111], a[124:127], v[116:119]
    v_perm_b32 v96, v50, v50, v8
    v_perm_b32 v97, v50, v50, v10
    v_perm_b32 v98, v50, v50, v12
    v_perm_b32 v99, v50, v50, v14
    s_nop 1
    v_mfma_f32_16x16x32_bf16 v[112:115], v[96:99], a[128:131], v[112:115]
    v_perm_b32 v100, v70, v70, v8
    v_perm_b32 v101, v70, v70, v10
    v_perm_b32 v102, v70, v70, v12
    v_perm_b32 v103, v70, v70, v14
    s_nop 1
    v_mfma_f32_16x16x32_bf16 v[116:119], v[100:103], a[128:131], v[116:119]
    v_perm_b32 v104, v50, v50, v9
    v_perm_b32 v105, v50, v50, v11
    v_perm_b32 v106, v50, v50, v13
    v_perm_b32 v107, v50, v50, v15
    s_nop 1
    v_mfma_f32_16x16x32_bf16 v[112:115], v[104:107], a[132:135], v[112:115]
    v_perm_b32 v108, v70, v70, v9
    v_perm_b32 v109, v70, v70, v11
    v_perm_b32 v110, v70, v70, v13
    v_perm_b32 v111, v70, v70, v15
    s_nop 1
    v_mfma_f32_16x16x32_bf16 v[116:119], v[108:111], a[132:135], v[116:119]
    v_perm_b32 v96, v51, v51, v8
    v_perm_b32 v97, v51, v51, v10
    v_perm_b32 v98, v51, v51, v12
    v_perm_b32 v99, v51, v51, v14
    s_nop 1
    v_mfma_f32_16x16x32_bf16 v[112:115], v[96:99], a[136:139], v[112:115]
    v_perm_b32 v100, v71, v71, v8
    v_perm_b32 v101, v71, v71, v10
    v_perm_b32 v102, v71, v71, v12
    v_perm_b32 v103, v71, v71, v14
    s_nop 1
    v_mfma_f32_16x16x32_bf16 v[116:119], v[100:103], a[136:139], v[116:119]
    v_perm_b32 v104, v51, v51, v9
    v_perm_b32 v105, v51, v51, v11
    v_perm_b32 v106, v51, v51, v13
    v_perm_b32 v107, v51, v51, v15
    s_nop 1
    v_mfma_f32_16x16x32_bf16 v[112:115], v[104:107], a[140:143], v[112:115]
    v_perm_b32 v108, v71, v71, v9
    v_perm_b32 v109, v71, v71, v11
    v_perm_b32 v110, v71, v71, v13
    v_perm_b32 v111, v71, v71, v15
    s_nop 1
    v_mfma_f32_16x16x32_bf16 v[116:119], v[108:111], a[140:143], v[116:119]
    v_perm_b32 v96, v52, v52, v8
    v_perm_b32 v97, v52, v52, v10
    v_perm_b32 v98, v52, v52, v12
    v_perm_b32 v99, v52, v52, v14
    s_nop 1
    v_mfma_f32_16x16x32_bf16 v[112:115], v[96:99], a[144:147], v[112:115]
    v_perm_b32 v100, v72, v72, v8
    v_perm_b32 v101, v72, v72, v10
    v_perm_b32 v102, v72, v72, v12
    v_perm_b32 v103, v72, v72, v14
    s_nop 1
    v_mfma_f32_16x16x32_bf16 v[116:119], v[100:103], a[144:147], v[116:119]
    s_waitcnt vmcnt(20)
    s_add_u32 m0, s63, 1024
    s_nop 0
    buffer_load_dwordx4 v88, s[36:39], s60 offen nt lds
    s_add_u32 s60, s60, 32768
    s_add_u32 m0, s63, 2048
    s_nop 0
    buffer_load_dwordx4 v89, s[36:39], s60 offen nt lds
    s_add_u32 s60, s60, 32768
    s_add_u32 m0, s63, 3072
    s_nop 0
    buffer_load_dwordx4 v89, s[36:39], s60 offen nt lds
    s_add_u32 s60, s60, 32768
    s_add_u32 m0, s63, 4096
    s_nop 0
    buffer_load_dwordx4 v90, s[36:39], s60 offen nt lds
    s_add_u32 s60, s60, 32768
    s_add_u32 m0, s63, 5120
    s_nop 0
    buffer_load_dwordx4 v90, s[36:39], s60 offen nt lds
    s_add_u32 s60, s60, 32768
    s_add_u32 m0, s63, 6144
    s_nop 0
    buffer_load_dwordx4 v91, s[36:39], s60 offen nt lds
    s_add_u32 s60, s60, 32768
    s_add_u32 m0, s63, 7168
    s_nop 0
    buffer_load_dwordx4 v91, s[36:39], s60 offen nt lds
    s_add_u32 s60, s60, 32768
    s_add_u32 m0, s63, 8192
    s_nop 0
    buffer_load_dwordx4 v88, s[36:39], s60 offen nt lds
    s_add_u32 s60, s60, 32768
    s_add_u32 m0, s63, 9216
    s_nop 0
    buffer_load_dwordx4 v88, s[36:39], s60 offen nt lds
    s_add_u32 s60, s60, 32768
    v_perm_b32 v104, v52, v52, v9
    v_perm_b32 v105, v52, v52, v11
    v_perm_b32 v106, v52, v52, v13
    v_perm_b32 v107, v52, v52, v15
    s_nop 1
    v_mfma_f32_16x16x32_bf16 v[112:115], v[104:107], a[148:151], v[112:115]
    v_perm_b32 v108, v72, v72, v9
    v_perm_b32 v109, v72, v72, v11
    v_perm_b32 v110, v72, v72, v13
    v_perm_b32 v111, v72, v72, v15
    s_nop 1
    v_mfma_f32_16x16x32_bf16 v[116:119], v[108:111], a[148:151], v[116:119]
    v_perm_b32 v96, v53, v53, v8
    v_perm_b32 v97, v53, v53, v10
    v_perm_b32 v98, v53, v53, v12
    v_perm_b32 v99, v53, v53, v14
    s_nop 1
    v_mfma_f32_16x16x32_bf16 v[112:115], v[96:99], a[152:155], v[112:115]
    v_perm_b32 v100, v73, v73, v8
    v_perm_b32 v101, v73, v73, v10
    v_perm_b32 v102, v73, v73, v12
    v_perm_b32 v103, v73, v73, v14
    s_nop 1
    v_mfma_f32_16x16x32_bf16 v[116:119], v[100:103], a[152:155], v[116:119]
    v_perm_b32 v104, v53, v53, v9
    v_perm_b32 v105, v53, v53, v11
    v_perm_b32 v106, v53, v53, v13
    v_perm_b32 v107, v53, v53, v15
    s_nop 1
    v_mfma_f32_16x16x32_bf16 v[112:115], v[104:107], a[156:159], v[112:115]
    v_perm_b32 v108, v73, v73, v9
    v_perm_b32 v109, v73, v73, v11
    v_perm_b32 v110, v73, v73, v13
    v_perm_b32 v111, v73, v73, v15
    s_nop 1
    v_mfma_f32_16x16x32_bf16 v[116:119], v[108:111], a[156:159], v[116:119]
    v_perm_b32 v96, v54, v54, v8
    v_perm_b32 v97, v54, v54, v10
    v_perm_b32 v98, v54, v54, v12
    v_perm_b32 v99, v54, v54, v14
    s_nop 1
    v_mfma_f32_16x16x32_bf16 v[112:115], v[96:99], a[160:163], v[112:115]
    v_perm_b32 v100, v74, v74, v8
    v_perm_b32 v101, v74, v74, v10
    v_perm_b32 v102, v74, v74, v12
    v_perm_b32 v103, v74, v74, v14
    s_nop 1
    v_mfma_f32_16x16x32_bf16 v[116:119], v[100:103], a[160:163], v[116:119]
    v_perm_b32 v104, v54, v54, v9
    v_perm_b32 v105, v54, v54, v11
    v_perm_b32 v106, v54, v54, v13
    v_perm_b32 v107, v54, v54, v15
    s_nop 1
    v_mfma_f32_16x16x32_bf16 v[112:115], v[104:107], a[164:167], v[112:115]
    v_perm_b32 v108, v74, v74, v9
    v_perm_b32 v109, v74, v74, v11
    v_perm_b32 v110, v74, v74, v13
    v_perm_b32 v111, v74, v74, v15
    s_nop 1
    v_mfma_f32_16x16x32_bf16 v[116:119], v[108:111], a[164:167], v[116:119]
    v_perm_b32 v96, v55, v55, v8
    v_perm_b32 v97, v55, v55, v10
    v_perm_b32 v98, v55, v55, v12
    v_perm_b32 v99, v55, v55, v14
    s_nop 1
    v_mfma_f32_16x16x32_bf16 v[112:115], v[96:99], a[168:171], v[112:115]
    v_perm_b32 v100, v75, v75, v8
    v_perm_b32 v101, v75, v75, v10
    v_perm_b32 v102, v75, v75, v12
    v_perm_b32 v103, v75, v75, v14
    s_nop 1
    v_mfma_f32_16x16x32_bf16 v[116:119], v[100:103], a[168:171], v[116:119]
    v_perm_b32 v104, v55, v55, v9
    v_perm_b32 v105, v55, v55, v11
    v_perm_b32 v106, v55, v55, v13
    v_perm_b32 v107, v55, v55, v15
    s_nop 1
    v_mfma_f32_16x16x32_bf16 v[112:115], v[104:107], a[172:175], v[112:115]
    v_perm_b32 v108, v75, v75, v9
    v_perm_b32 v109, v75, v75, v11
    v_perm_b32 v110, v75, v75, v13
    v_perm_b32 v111, v75, v75, v15
    s_nop 1
    v_mfma_f32_16x16x32_bf16 v[116:119], v[108:111], a[172:175], v[116:119]
    v_perm_b32 v96, v56, v56, v8
    v_perm_b32 v97, v56, v56, v10
    v_perm_b32 v98, v56, v56, v12
    v_perm_b32 v99, v56, v56, v14
    s_nop 1
    v_mfma_f32_16x16x32_bf16 v[112:115], v[96:99], a[176:179], v[112:115]
    v_perm_b32 v100, v76, v76, v8
    v_perm_b32 v101, v76, v76, v10
    v_perm_b32 v102, v76, v76, v12
    v_perm_b32 v103, v76, v76, v14
    s_nop 1
    v_mfma_f32_16x16x32_bf16 v[116:119], v[100:103], a[176:179], v[116:119]
    v_perm_b32 v104, v56, v56, v9
    v_perm_b32 v105, v56, v56, v11
    v_perm_b32 v106, v56, v56, v13
    v_perm_b32 v107, v56, v56, v15
    s_nop 1
    v_mfma_f32_16x16x32_bf16 v[112:115], v[104:107], a[180:183], v[112:115]
    v_perm_b32 v108, v76, v76, v9
    v_perm_b32 v109, v76, v76, v11
    v_perm_b32 v110, v76, v76, v13
    v_perm_b32 v111, v76, v76, v15
    s_nop 1
    v_mfma_f32_16x16x32_bf16 v[116:119], v[108:111], a[180:183], v[116:119]
    s_waitcnt vmcnt(20)
    s_add_u32 m0, s63, 10240
    s_nop 0
    buffer_load_dwordx4 v89, s[36:39], s60 offen nt lds
    s_add_u32 s60, s60, 32768
    s_add_u32 m0, s63, 11264
    s_nop 0
    buffer_load_dwordx4 v89, s[36:39], s60 offen nt lds
    s_add_u32 s60, s60, 32768
    s_add_u32 m0, s63, 12288
    s_nop 0
    buffer_load_dwordx4 v90, s[36:39], s60 offen nt lds
    s_add_u32 s60, s60, 32768
    s_add_u32 m0, s63, 13312
    s_nop 0
    buffer_load_dwordx4 v90, s[36:39], s60 offen nt lds
    s_add_u32 s60, s60, 32768
    s_add_u32 m0, s63, 14336
    s_nop 0
    buffer_load_dwordx4 v91, s[36:39], s60 offen nt lds
    s_add_u32 s60, s60, 32768
    s_add_u32 m0, s63, 15360
    s_nop 0
    buffer_load_dwordx4 v91, s[36:39], s60 offen nt lds
    s_add_u32 s60, s60, 32768
    s_add_u32 m0, s63, 16384
    s_nop 0
    buffer_load_dwordx4 v88, s[36:39], s60 offen nt lds
    s_add_u32 s60, s60, 32768
    s_add_u32 m0, s63, 17408
    s_nop 0
    buffer_load_dwordx4 v88, s[36:39], s60 offen nt lds
    s_add_u32 s60, s60, 32768
    s_add_u32 m0, s63, 18432
    s_nop 0
    buffer_load_dwordx4 v89, s[36:39], s60 offen nt lds
    s_add_u32 s60, s60, 32768
    v_perm_b32 v96, v57, v57, v8
    v_perm_b32 v97, v57, v57, v10
    v_perm_b32 v98, v57, v57, v12
    v_perm_b32 v99, v57, v57, v14
    s_nop 1
    v_mfma_f32_16x16x32_bf16 v[112:115], v[96:99], a[184:187], v[112:115]
    v_perm_b32 v100, v77, v77, v8
    v_perm_b32 v101, v77, v77, v10
    v_perm_b32 v102, v77, v77, v12
    v_perm_b32 v103, v77, v77, v14
    s_nop 1
    v_mfma_f32_16x16x32_bf16 v[116:119], v[100:103], a[184:187], v[116:119]
    v_perm_b32 v104, v57, v57, v9
    v_perm_b32 v105, v57, v57, v11
    v_perm_b32 v106, v57, v57, v13
    v_perm_b32 v107, v57, v57, v15
    s_nop 1
    v_mfma_f32_16x16x32_bf16 v[112:115], v[104:107], a[188:191], v[112:115]
    v_perm_b32 v108, v77, v77, v9
    v_perm_b32 v109, v77, v77, v11
    v_perm_b32 v110, v77, v77, v13
    v_perm_b32 v111, v77, v77, v15
    s_nop 1
    v_mfma_f32_16x16x32_bf16 v[116:119], v[108:111], a[188:191], v[116:119]
    v_perm_b32 v96, v58, v58, v8
    v_perm_b32 v97, v58, v58, v10
    v_perm_b32 v98, v58, v58, v12
    v_perm_b32 v99, v58, v58, v14
    s_nop 1
    v_mfma_f32_16x16x32_bf16 v[112:115], v[96:99], a[192:195], v[112:115]
    v_perm_b32 v100, v78, v78, v8
    v_perm_b32 v101, v78, v78, v10
    v_perm_b32 v102, v78, v78, v12
    v_perm_b32 v103, v78, v78, v14
    s_nop 1
    v_mfma_f32_16x16x32_bf16 v[116:119], v[100:103], a[192:195], v[116:119]
    v_perm_b32 v104, v58, v58, v9
    v_perm_b32 v105, v58, v58, v11
    v_perm_b32 v106, v58, v58, v13
    v_perm_b32 v107, v58, v58, v15
    s_nop 1
    v_mfma_f32_16x16x32_bf16 v[112:115], v[104:107], a[196:199], v[112:115]
    v_perm_b32 v108, v78, v78, v9
    v_perm_b32 v109, v78, v78, v11
    v_perm_b32 v110, v78, v78, v13
    v_perm_b32 v111, v78, v78, v15
    s_nop 1
    v_mfma_f32_16x16x32_bf16 v[116:119], v[108:111], a[196:199], v[116:119]
    v_perm_b32 v96, v59, v59, v8
    v_perm_b32 v97, v59, v59, v10
    v_perm_b32 v98, v59, v59, v12
    v_perm_b32 v99, v59, v59, v14
    s_nop 1
    v_mfma_f32_16x16x32_bf16 v[112:115], v[96:99], a[200:203], v[112:115]
    v_perm_b32 v100, v79, v79, v8
    v_perm_b32 v101, v79, v79, v10
    v_perm_b32 v102, v79, v79, v12
    v_perm_b32 v103, v79, v79, v14
    s_nop 1
    v_mfma_f32_16x16x32_bf16 v[116:119], v[100:103], a[200:203], v[116:119]
    v_perm_b32 v104, v59, v59, v9
    v_perm_b32 v105, v59, v59, v11
    v_perm_b32 v106, v59, v59, v13
    v_perm_b32 v107, v59, v59, v15
    s_nop 1
    v_mfma_f32_16x16x32_bf16 v[112:115], v[104:107], a[204:207], v[112:115]
    v_perm_b32 v108, v79, v79, v9
    v_perm_b32 v109, v79, v79, v11
    v_perm_b32 v110, v79, v79, v13
    v_perm_b32 v111, v79, v79, v15
    s_nop 1
    v_mfma_f32_16x16x32_bf16 v[116:119], v[108:111], a[204:207], v[116:119]
    v_perm_b32 v96, v60, v60, v8
    v_perm_b32 v97, v60, v60, v10
    v_perm_b32 v98, v60, v60, v12
    v_perm_b32 v99, v60, v60, v14
    s_nop 1
    v_mfma_f32_16x16x32_bf16 v[112:115], v[96:99], a[208:211], v[112:115]
    v_perm_b32 v100, v80, v80, v8
    v_perm_b32 v101, v80, v80, v10
    v_perm_b32 v102, v80, v80, v12
    v_perm_b32 v103, v80, v80, v14
    s_nop 1
    v_mfma_f32_16x16x32_bf16 v[116:119], v[100:103], a[208:211], v[116:119]
    v_perm_b32 v104, v60, v60, v9
    v_perm_b32 v105, v60, v60, v11
    v_perm_b32 v106, v60, v60, v13
    v_perm_b32 v107, v60, v60, v15
    s_nop 1
    v_mfma_f32_16x16x32_bf16 v[112:115], v[104:107], a[212:215], v[112:115]
    v_perm_b32 v108, v80, v80, v9
    v_perm_b32 v109, v80, v80, v11
    v_perm_b32 v110, v80, v80, v13
    v_perm_b32 v111, v80, v80, v15
    s_nop 1
    v_mfma_f32_16x16x32_bf16 v[116:119], v[108:111], a[212:215], v[116:119]
    v_perm_b32 v96, v61, v61, v8
    v_perm_b32 v97, v61, v61, v10
    v_perm_b32 v98, v61, v61, v12
    v_perm_b32 v99, v61, v61, v14
    s_nop 1
    v_mfma_f32_16x16x32_bf16 v[112:115], v[96:99], a[216:219], v[112:115]
    v_perm_b32 v100, v81, v81, v8
    v_perm_b32 v101, v81, v81, v10
    v_perm_b32 v102, v81, v81, v12
    v_perm_b32 v103, v81, v81, v14
    s_nop 1
    v_mfma_f32_16x16x32_bf16 v[116:119], v[100:103], a[216:219], v[116:119]
    s_waitcnt vmcnt(19)
    s_add_u32 m0, s63, 19456
    s_nop 0
    buffer_load_dwordx4 v89, s[36:39], s60 offen nt lds
    s_add_u32 s60, s60, 32768
    s_add_u32 m0, s63, 20480
    s_nop 0
    buffer_load_dwordx4 v90, s[36:39], s60 offen nt lds
    s_add_u32 s60, s60, 32768
    s_add_u32 m0, s63, 21504
    s_nop 0
    buffer_load_dwordx4 v90, s[36:39], s60 offen nt lds
    s_add_u32 s60, s60, 32768
    s_add_u32 m0, s63, 22528
    s_nop 0
    buffer_load_dwordx4 v91, s[36:39], s60 offen nt lds
    s_add_u32 s60, s60, 32768
    s_add_u32 m0, s63, 23552
    s_nop 0
    buffer_load_dwordx4 v91, s[36:39], s60 offen nt lds
    s_add_u32 s60, s60, 32768
    s_add_u32 m0, s63, 24576
    s_nop 0
    buffer_load_dwordx4 v88, s[36:39], s60 offen nt lds
    s_add_u32 s60, s60, 32768
    s_add_u32 m0, s63, 25600
    s_nop 0
    buffer_load_dwordx4 v88, s[36:39], s60 offen nt lds
    s_add_u32 s60, s60, 32768
    s_add_u32 m0, s63, 26624
    s_nop 0
    buffer_load_dwordx4 v89, s[36:39], s60 offen nt lds
    s_add_u32 s60, s60, 32768
    s_add_u32 m0, s63, 27648
    s_nop 0
    buffer_load_dwordx4 v89, s[36:39], s60 offen nt lds
    s_add_u32 s60, s60, 32768
    v_perm_b32 v104, v61, v61, v9
    v_perm_b32 v105, v61, v61, v11
    v_perm_b32 v106, v61, v61, v13
    v_perm_b32 v107, v61, v61, v15
    s_nop 1
    v_mfma_f32_16x16x32_bf16 v[112:115], v[104:107], a[220:223], v[112:115]
    v_perm_b32 v108, v81, v81, v9
    v_perm_b32 v109, v81, v81, v11
    v_perm_b32 v110, v81, v81, v13
    v_perm_b32 v111, v81, v81, v15
    s_nop 1
    v_mfma_f32_16x16x32_bf16 v[116:119], v[108:111], a[220:223], v[116:119]
    v_perm_b32 v96, v62, v62, v8
    v_perm_b32 v97, v62, v62, v10
    v_perm_b32 v98, v62, v62, v12
    v_perm_b32 v99, v62, v62, v14
    s_nop 1
    v_mfma_f32_16x16x32_bf16 v[112:115], v[96:99], a[224:227], v[112:115]
    v_perm_b32 v100, v82, v82, v8
    v_perm_b32 v101, v82, v82, v10
    v_perm_b32 v102, v82, v82, v12
    v_perm_b32 v103, v82, v82, v14
    s_nop 1
    v_mfma_f32_16x16x32_bf16 v[116:119], v[100:103], a[224:227], v[116:119]
    v_perm_b32 v104, v62, v62, v9
    v_perm_b32 v105, v62, v62, v11
    v_perm_b32 v106, v62, v62, v13
    v_perm_b32 v107, v62, v62, v15
    s_nop 1
    v_mfma_f32_16x16x32_bf16 v[112:115], v[104:107], a[228:231], v[112:115]
    v_perm_b32 v108, v82, v82, v9
    v_perm_b32 v109, v82, v82, v11
    v_perm_b32 v110, v82, v82, v13
    v_perm_b32 v111, v82, v82, v15
    s_nop 1
    v_mfma_f32_16x16x32_bf16 v[116:119], v[108:111], a[228:231], v[116:119]
    v_perm_b32 v96, v63, v63, v8
    v_perm_b32 v97, v63, v63, v10
    v_perm_b32 v98, v63, v63, v12
    v_perm_b32 v99, v63, v63, v14
    s_nop 1
    v_mfma_f32_16x16x32_bf16 v[112:115], v[96:99], a[232:235], v[112:115]
    v_perm_b32 v100, v83, v83, v8
    v_perm_b32 v101, v83, v83, v10
    v_perm_b32 v102, v83, v83, v12
    v_perm_b32 v103, v83, v83, v14
    s_nop 1
    v_mfma_f32_16x16x32_bf16 v[116:119], v[100:103], a[232:235], v[116:119]
    v_perm_b32 v104, v63, v63, v9
    v_perm_b32 v105, v63, v63, v11
    v_perm_b32 v106, v63, v63, v13
    v_perm_b32 v107, v63, v63, v15
    s_nop 1
    v_mfma_f32_16x16x32_bf16 v[112:115], v[104:107], a[236:239], v[112:115]
    v_perm_b32 v108, v83, v83, v9
    v_perm_b32 v109, v83, v83, v11
    v_perm_b32 v110, v83, v83, v13
    v_perm_b32 v111, v83, v83, v15
    s_nop 1
    v_mfma_f32_16x16x32_bf16 v[116:119], v[108:111], a[236:239], v[116:119]
    v_perm_b32 v96, v64, v64, v8
    v_perm_b32 v97, v64, v64, v10
    v_perm_b32 v98, v64, v64, v12
    v_perm_b32 v99, v64, v64, v14
    s_nop 1
    v_mfma_f32_16x16x32_bf16 v[112:115], v[96:99], a[240:243], v[112:115]
    v_perm_b32 v100, v84, v84, v8
    v_perm_b32 v101, v84, v84, v10
    v_perm_b32 v102, v84, v84, v12
    v_perm_b32 v103, v84, v84, v14
    s_nop 1
    v_mfma_f32_16x16x32_bf16 v[116:119], v[100:103], a[240:243], v[116:119]
    v_perm_b32 v104, v64, v64, v9
    v_perm_b32 v105, v64, v64, v11
    v_perm_b32 v106, v64, v64, v13
    v_perm_b32 v107, v64, v64, v15
    s_nop 1
    v_mfma_f32_16x16x32_bf16 v[112:115], v[104:107], a[244:247], v[112:115]
    v_perm_b32 v108, v84, v84, v9
    v_perm_b32 v109, v84, v84, v11
    v_perm_b32 v110, v84, v84, v13
    v_perm_b32 v111, v84, v84, v15
    s_nop 1
    v_mfma_f32_16x16x32_bf16 v[116:119], v[108:111], a[244:247], v[116:119]
    v_perm_b32 v96, v65, v65, v8
    v_perm_b32 v97, v65, v65, v10
    v_perm_b32 v98, v65, v65, v12
    v_perm_b32 v99, v65, v65, v14
    s_nop 1
    v_mfma_f32_16x16x32_bf16 v[112:115], v[96:99], a[248:251], v[112:115]
    v_perm_b32 v100, v85, v85, v8
    v_perm_b32 v101, v85, v85, v10
    v_perm_b32 v102, v85, v85, v12
    v_perm_b32 v103, v85, v85, v14
    s_nop 1
    v_mfma_f32_16x16x32_bf16 v[116:119], v[100:103], a[248:251], v[116:119]
    v_perm_b32 v104, v65, v65, v9
    v_perm_b32 v105, v65, v65, v11
    v_perm_b32 v106, v65, v65, v13
    v_perm_b32 v107, v65, v65, v15
    s_nop 1
    v_mfma_f32_16x16x32_bf16 v[112:115], v[104:107], a[252:255], v[112:115]
    v_perm_b32 v108, v85, v85, v9
    v_perm_b32 v109, v85, v85, v11
    v_perm_b32 v110, v85, v85, v13
    v_perm_b32 v111, v85, v85, v15
    s_nop 1
    v_mfma_f32_16x16x32_bf16 v[116:119], v[108:111], a[252:255], v[116:119]
    v_lshrrev_b32 v5, 1, v4
    v_lshlrev_b32 v5, 9, v5
    v_lshl_add_u32 v5, v3, 5, v5
    v_and_b32 v6, 1, v4
    v_lshl_add_u32 v5, v6, 4, v5
    s_lshl_b32 s54, s3, 11
    s_add_u32 s54, s54, 131072
    v_add_u32 v5, s54, v5
    ds_write_b128 v5, v[112:115]
    ds_write_b128 v5, v[116:119] offset:1024
    s_waitcnt lgkmcnt(0)
    s_barrier
    s_add_u32 m0, s63, 28672
    s_nop 0
    buffer_load_dwordx4 v90, s[36:39], s60 offen nt lds
    s_add_u32 s60, s60, 32768
    s_add_u32 m0, s63, 29696
    s_nop 0
    buffer_load_dwordx4 v90, s[36:39], s60 offen nt lds
    s_add_u32 s60, s60, 32768
    s_add_u32 m0, s63, 30720
    s_nop 0
    buffer_load_dwordx4 v91, s[36:39], s60 offen nt lds
    s_add_u32 s60, s60, 32768
    s_add_u32 m0, s63, 31744
    s_nop 0
    buffer_load_dwordx4 v91, s[36:39], s60 offen nt lds
    s_add_u32 s60, s60, 32768
    v_lshrrev_b32 v5, 2, v3
    v_lshlrev_b32 v5, 9, v5
    v_lshl_add_u32 v5, v4, 5, v5
    v_add_u32 v5, 131072, v5
    ds_read_b128 v[48:51], v5 offset:0
    ds_read_b128 v[52:55], v5 offset:16
    ds_read_b128 v[56:59], v5 offset:2048
    ds_read_b128 v[60:63], v5 offset:2064
    ds_read_b128 v[64:67], v5 offset:4096
    ds_read_b128 v[68:71], v5 offset:4112
    ds_read_b128 v[72:75], v5 offset:6144
    ds_read_b128 v[76:79], v5 offset:6160
    s_waitcnt lgkmcnt(0)
    v_add_f32 v48, v48, v56
    v_add_f32 v64, v64, v72
    v_add_f32 v49, v49, v57
    v_add_f32 v65, v65, v73
    v_add_f32 v50, v50, v58
    v_add_f32 v66, v66, v74
    v_add_f32 v51, v51, v59
    v_add_f32 v67, v67, v75
    v_add_f32 v52, v52, v60
    v_add_f32 v68, v68, v76
    v_add_f32 v53, v53, v61
    v_add_f32 v69, v69, v77
    v_add_f32 v54, v54, v62
    v_add_f32 v70, v70, v78
    v_add_f32 v55, v55, v63
    v_add_f32 v71, v71, v79
    v_add_f32 v48, v48, v64
    v_add_f32 v49, v49, v65
    v_add_f32 v50, v50, v66
    v_add_f32 v51, v51, v67
    v_add_f32 v52, v52, v68
    v_add_f32 v53, v53, v69
    v_add_f32 v54, v54, v70
    v_add_f32 v55, v55, v71
    v_cvt_pk_bf16_f32 v96, v48, v49
    v_cvt_pk_bf16_f32 v97, v50, v51
    v_cvt_pk_bf16_f32 v98, v52, v53
    v_cvt_pk_bf16_f32 v99, v54, v55
    ds_read_b128 v[48:51], v5 offset:128
    ds_read_b128 v[52:55], v5 offset:144
    ds_read_b128 v[56:59], v5 offset:2176
    ds_read_b128 v[60:63], v5 offset:2192
    ds_read_b128 v[64:67], v5 offset:4224
    ds_read_b128 v[68:71], v5 offset:4240
    ds_read_b128 v[72:75], v5 offset:6272
    ds_read_b128 v[76:79], v5 offset:6288
    s_waitcnt lgkmcnt(0)
    v_add_f32 v48, v48, v56
    v_add_f32 v64, v64, v72
    v_add_f32 v49, v49, v57
    v_add_f32 v65, v65, v73
    v_add_f32 v50, v50, v58
    v_add_f32 v66, v66, v74
    v_add_f32 v51, v51, v59
    v_add_f32 v67, v67, v75
    v_add_f32 v52, v52, v60
    v_add_f32 v68, v68, v76
    v_add_f32 v53, v53, v61
    v_add_f32 v69, v69, v77
    v_add_f32 v54, v54, v62
    v_add_f32 v70, v70, v78
    v_add_f32 v55, v55, v63
    v_add_f32 v71, v71, v79
    v_add_f32 v48, v48, v64
    v_add_f32 v49, v49, v65
    v_add_f32 v50, v50, v66
    v_add_f32 v51, v51, v67
    v_add_f32 v52, v52, v68
    v_add_f32 v53, v53, v69
    v_add_f32 v54, v54, v70
    v_add_f32 v55, v55, v71
    v_cvt_pk_bf16_f32 v100, v48, v49
    v_cvt_pk_bf16_f32 v101, v50, v51
    v_cvt_pk_bf16_f32 v102, v52, v53
    v_cvt_pk_bf16_f32 v103, v54, v55
    ds_read_b128 v[48:51], v5 offset:256
    ds_read_b128 v[52:55], v5 offset:272
    ds_read_b128 v[56:59], v5 offset:2304
    ds_read_b128 v[60:63], v5 offset:2320
    ds_read_b128 v[64:67], v5 offset:4352
    ds_read_b128 v[68:71], v5 offset:4368
    ds_read_b128 v[72:75], v5 offset:6400
    ds_read_b128 v[76:79], v5 offset:6416
    s_waitcnt lgkmcnt(0)
    v_add_f32 v48, v48, v56
    v_add_f32 v64, v64, v72
    v_add_f32 v49, v49, v57
    v_add_f32 v65, v65, v73
    v_add_f32 v50, v50, v58
    v_add_f32 v66, v66, v74
    v_add_f32 v51, v51, v59
    v_add_f32 v67, v67, v75
    v_add_f32 v52, v52, v60
    v_add_f32 v68, v68, v76
    v_add_f32 v53, v53, v61
    v_add_f32 v69, v69, v77
    v_add_f32 v54, v54, v62
    v_add_f32 v70, v70, v78
    v_add_f32 v55, v55, v63
    v_add_f32 v71, v71, v79
    v_add_f32 v48, v48, v64
    v_add_f32 v49, v49, v65
    v_add_f32 v50, v50, v66
    v_add_f32 v51, v51, v67
    v_add_f32 v52, v52, v68
    v_add_f32 v53, v53, v69
    v_add_f32 v54, v54, v70
    v_add_f32 v55, v55, v71
    v_cvt_pk_bf16_f32 v104, v48, v49
    v_cvt_pk_bf16_f32 v105, v50, v51
    v_cvt_pk_bf16_f32 v106, v52, v53
    v_cvt_pk_bf16_f32 v107, v54, v55
    ds_read_b128 v[48:51], v5 offset:384
    ds_read_b128 v[52:55], v5 offset:400
    ds_read_b128 v[56:59], v5 offset:2432
    ds_read_b128 v[60:63], v5 offset:2448
    ds_read_b128 v[64:67], v5 offset:4480
    ds_read_b128 v[68:71], v5 offset:4496
    ds_read_b128 v[72:75], v5 offset:6528
    ds_read_b128 v[76:79], v5 offset:6544
    s_waitcnt lgkmcnt(0)
    v_add_f32 v48, v48, v56
    v_add_f32 v64, v64, v72
    v_add_f32 v49, v49, v57
    v_add_f32 v65, v65, v73
    v_add_f32 v50, v50, v58
    v_add_f32 v66, v66, v74
    v_add_f32 v51, v51, v59
    v_add_f32 v67, v67, v75
    v_add_f32 v52, v52, v60
    v_add_f32 v68, v68, v76
    v_add_f32 v53, v53, v61
    v_add_f32 v69, v69, v77
    v_add_f32 v54, v54, v62
    v_add_f32 v70, v70, v78
    v_add_f32 v55, v55, v63
    v_add_f32 v71, v71, v79
    v_add_f32 v48, v48, v64
    v_add_f32 v49, v49, v65
    v_add_f32 v50, v50, v66
    v_add_f32 v51, v51, v67
    v_add_f32 v52, v52, v68
    v_add_f32 v53, v53, v69
    v_add_f32 v54, v54, v70
    v_add_f32 v55, v55, v71
    v_cvt_pk_bf16_f32 v108, v48, v49
    v_cvt_pk_bf16_f32 v109, v50, v51
    v_cvt_pk_bf16_f32 v110, v52, v53
    v_cvt_pk_bf16_f32 v111, v54, v55
    s_waitcnt vmcnt(24)
    ds_read_b128 v[128:131], v92 offset:0
    ds_read_b128 v[132:135], v93 offset:0
    ds_read_b128 v[136:139], v94 offset:0
    ds_read_b128 v[140:143], v95 offset:0
    ds_read_b128 v[144:147], v92 offset:1024
    ds_read_b128 v[148:151], v93 offset:1024
    ds_read_b128 v[152:155], v94 offset:1024
    ds_read_b128 v[156:159], v95 offset:1024
    s_waitcnt lgkmcnt(7)
    v_mfma_f32_16x16x32_bf16 v[48:51], v[128:131], v[96:99], 0
    s_waitcnt lgkmcnt(6)
    v_mfma_f32_16x16x32_bf16 v[48:51], v[132:135], v[100:103], v[48:51]
    s_waitcnt lgkmcnt(5)
    v_mfma_f32_16x16x32_bf16 v[48:51], v[136:139], v[104:107], v[48:51]
    s_waitcnt lgkmcnt(4)
    v_mfma_f32_16x16x32_bf16 v[48:51], v[140:143], v[108:111], v[48:51]
    s_waitcnt lgkmcnt(3)
    v_mfma_f32_16x16x32_bf16 v[52:55], v[144:147], v[96:99], 0
    s_waitcnt lgkmcnt(2)
    v_mfma_f32_16x16x32_bf16 v[52:55], v[148:151], v[100:103], v[52:55]
    s_waitcnt lgkmcnt(1)
    v_mfma_f32_16x16x32_bf16 v[52:55], v[152:155], v[104:107], v[52:55]
    s_waitcnt lgkmcnt(0)
    v_mfma_f32_16x16x32_bf16 v[52:55], v[156:159], v[108:111], v[52:55]
    s_waitcnt vmcnt(16)
    ds_read_b128 v[160:163], v92 offset:8192
    ds_read_b128 v[164:167], v93 offset:8192
    ds_read_b128 v[168:171], v94 offset:8192
    ds_read_b128 v[172:175], v95 offset:8192
    ds_read_b128 v[176:179], v92 offset:9216
    ds_read_b128 v[180:183], v93 offset:9216
    ds_read_b128 v[184:187], v94 offset:9216
    ds_read_b128 v[188:191], v95 offset:9216
    s_waitcnt lgkmcnt(7)
    v_mfma_f32_16x16x32_bf16 v[56:59], v[160:163], v[96:99], 0
    s_waitcnt lgkmcnt(6)
    v_mfma_f32_16x16x32_bf16 v[56:59], v[164:167], v[100:103], v[56:59]
    s_waitcnt lgkmcnt(5)
    v_mfma_f32_16x16x32_bf16 v[56:59], v[168:171], v[104:107], v[56:59]
    s_waitcnt lgkmcnt(4)
    v_mfma_f32_16x16x32_bf16 v[56:59], v[172:175], v[108:111], v[56:59]
    s_waitcnt lgkmcnt(3)
    v_mfma_f32_16x16x32_bf16 v[60:63], v[176:179], v[96:99], 0
    s_waitcnt lgkmcnt(2)
    v_mfma_f32_16x16x32_bf16 v[60:63], v[180:183], v[100:103], v[60:63]
    s_waitcnt lgkmcnt(1)
    v_mfma_f32_16x16x32_bf16 v[60:63], v[184:187], v[104:107], v[60:63]
    s_waitcnt lgkmcnt(0)
    v_mfma_f32_16x16x32_bf16 v[60:63], v[188:191], v[108:111], v[60:63]
    s_waitcnt vmcnt(8)
    ds_read_b128 v[128:131], v92 offset:16384
    ds_read_b128 v[132:135], v93 offset:16384
    ds_read_b128 v[136:139], v94 offset:16384
    ds_read_b128 v[140:143], v95 offset:16384
    ds_read_b128 v[144:147], v92 offset:17408
    ds_read_b128 v[148:151], v93 offset:17408
    ds_read_b128 v[152:155], v94 offset:17408
    ds_read_b128 v[156:159], v95 offset:17408
    s_waitcnt lgkmcnt(7)
    v_mfma_f32_16x16x32_bf16 v[64:67], v[128:131], v[96:99], 0
    s_waitcnt lgkmcnt(6)
    v_mfma_f32_16x16x32_bf16 v[64:67], v[132:135], v[100:103], v[64:67]
    s_waitcnt lgkmcnt(5)
    v_mfma_f32_16x16x32_bf16 v[64:67], v[136:139], v[104:107], v[64:67]
    s_waitcnt lgkmcnt(4)
    v_mfma_f32_16x16x32_bf16 v[64:67], v[140:143], v[108:111], v[64:67]
    s_waitcnt lgkmcnt(3)
    v_mfma_f32_16x16x32_bf16 v[68:71], v[144:147], v[96:99], 0
    s_waitcnt lgkmcnt(2)
    v_mfma_f32_16x16x32_bf16 v[68:71], v[148:151], v[100:103], v[68:71]
    s_waitcnt lgkmcnt(1)
    v_mfma_f32_16x16x32_bf16 v[68:71], v[152:155], v[104:107], v[68:71]
    s_waitcnt lgkmcnt(0)
    v_mfma_f32_16x16x32_bf16 v[68:71], v[156:159], v[108:111], v[68:71]
    s_waitcnt vmcnt(0)
    ds_read_b128 v[160:163], v92 offset:24576
    ds_read_b128 v[164:167], v93 offset:24576
    ds_read_b128 v[168:171], v94 offset:24576
    ds_read_b128 v[172:175], v95 offset:24576
    ds_read_b128 v[176:179], v92 offset:25600
    ds_read_b128 v[180:183], v93 offset:25600
    ds_read_b128 v[184:187], v94 offset:25600
    ds_read_b128 v[188:191], v95 offset:25600
    s_waitcnt lgkmcnt(7)
    v_mfma_f32_16x16x32_bf16 v[72:75], v[160:163], v[96:99], 0
    s_waitcnt lgkmcnt(6)
    v_mfma_f32_16x16x32_bf16 v[72:75], v[164:167], v[100:103], v[72:75]
    s_waitcnt lgkmcnt(5)
    v_mfma_f32_16x16x32_bf16 v[72:75], v[168:171], v[104:107], v[72:75]
    s_waitcnt lgkmcnt(4)
    v_mfma_f32_16x16x32_bf16 v[72:75], v[172:175], v[108:111], v[72:75]
    s_waitcnt lgkmcnt(3)
    v_mfma_f32_16x16x32_bf16 v[76:79], v[176:179], v[96:99], 0
    s_waitcnt lgkmcnt(2)
    v_mfma_f32_16x16x32_bf16 v[76:79], v[180:183], v[100:103], v[76:79]
    s_waitcnt lgkmcnt(1)
    v_mfma_f32_16x16x32_bf16 v[76:79], v[184:187], v[104:107], v[76:79]
    s_waitcnt lgkmcnt(0)
    v_mfma_f32_16x16x32_bf16 v[76:79], v[188:191], v[108:111], v[76:79]
    s_mov_b32 s96, 1040356334
    v_and_b32 v6, 3, v3
    v_cmp_eq_u32 vcc, 1, v6
    s_nop 1
    v_cndmask_b32 v48, v48, v56, vcc
    v_cndmask_b32 v49, v49, v57, vcc
    v_cndmask_b32 v50, v50, v58, vcc
    v_cndmask_b32 v51, v51, v59, vcc
    v_cndmask_b32 v52, v52, v60, vcc
    v_cndmask_b32 v53, v53, v61, vcc
    v_cndmask_b32 v54, v54, v62, vcc
    v_cndmask_b32 v55, v55, v63, vcc
    v_cmp_eq_u32 vcc, 2, v6
    s_nop 1
    v_cndmask_b32 v48, v48, v64, vcc
    v_cndmask_b32 v49, v49, v65, vcc
    v_cndmask_b32 v50, v50, v66, vcc
    v_cndmask_b32 v51, v51, v67, vcc
    v_cndmask_b32 v52, v52, v68, vcc
    v_cndmask_b32 v53, v53, v69, vcc
    v_cndmask_b32 v54, v54, v70, vcc
    v_cndmask_b32 v55, v55, v71, vcc
    v_cmp_eq_u32 vcc, 3, v6
    s_nop 1
    v_cndmask_b32 v48, v48, v72, vcc
    v_cndmask_b32 v49, v49, v73, vcc
    v_cndmask_b32 v50, v50, v74, vcc
    v_cndmask_b32 v51, v51, v75, vcc
    v_cndmask_b32 v52, v52, v76, vcc
    v_cndmask_b32 v53, v53, v77, vcc
    v_cndmask_b32 v54, v54, v78, vcc
    v_cndmask_b32 v55, v55, v79, vcc
    v_mul_f32 v48, s96, v48
    v_mul_f32 v49, s96, v49
    v_mul_f32 v50, s96, v50
    v_mul_f32 v51, s96, v51
    v_mul_f32 v52, s96, v52
    v_mul_f32 v53, s96, v53
    v_mul_f32 v54, s96, v54
    v_mul_f32 v55, s96, v55
    v_cvt_pk_bf16_f32 v24, v48, v49
    v_cvt_pk_bf16_f32 v25, v50, v51
    v_cvt_pk_bf16_f32 v26, v52, v53
    v_cvt_pk_bf16_f32 v27, v54, v55
    v_min_u32 v24, -2, v24
    v_min_u32 v25, -2, v25
    v_min_u32 v26, -2, v26
    v_min_u32 v27, -2, v27
    v_lshrrev_b32 v5, 2, v3
    v_lshlrev_b32 v5, 15, v5
    v_lshl_add_u32 v5, v4, 4, v5
    v_and_b32 v6, 3, v3
    v_lshl_add_u32 v5, v6, 6, v5
    s_lshl_b32 s54, s52, 10
    s_lshl_b32 s55, s3, 8
    s_add_u32 s54, s54, s55
    s_add_u32 s54, s54, 1048576
    buffer_store_dwordx4 v[24:27], v5, s[44:47], s54 offen sc1
    buffer_load_dwordx4 a[0:3], v121, s[40:43], s62 offen nt
    s_add_u32 s62, s62, 8192
    buffer_load_dwordx4 a[4:7], v121, s[40:43], s62 offen nt
    s_add_u32 s62, s62, 8192
    buffer_load_dwordx4 a[8:11], v121, s[40:43], s62 offen nt
    s_add_u32 s62, s62, 8192
    buffer_load_dwordx4 a[12:15], v121, s[40:43], s62 offen nt
    s_add_u32 s62, s62, 8192
    buffer_load_dwordx4 a[16:19], v121, s[40:43], s62 offen nt
    s_add_u32 s62, s62, 8192
    buffer_load_dwordx4 a[20:23], v121, s[40:43], s62 offen nt
    s_add_u32 s62, s62, 8192
    buffer_load_dwordx4 a[24:27], v121, s[40:43], s62 offen nt
    s_add_u32 s62, s62, 8192
    buffer_load_dwordx4 a[28:31], v121, s[40:43], s62 offen nt
    s_add_u32 s62, s62, 8192
    buffer_load_dwordx4 a[32:35], v121, s[40:43], s62 offen nt
    s_add_u32 s62, s62, 8192
    buffer_load_dwordx4 a[36:39], v121, s[40:43], s62 offen nt
    s_add_u32 s62, s62, 8192
    buffer_load_dwordx4 a[40:43], v121, s[40:43], s62 offen nt
    s_add_u32 s62, s62, 8192
    buffer_load_dwordx4 a[44:47], v121, s[40:43], s62 offen nt
    s_add_u32 s62, s62, 8192
    buffer_load_dwordx4 a[48:51], v121, s[40:43], s62 offen nt
    s_add_u32 s62, s62, 8192
    buffer_load_dwordx4 a[52:55], v121, s[40:43], s62 offen nt
    s_add_u32 s62, s62, 8192
    buffer_load_dwordx4 a[56:59], v121, s[40:43], s62 offen nt
    s_add_u32 s62, s62, 8192
    buffer_load_dwordx4 a[60:63], v121, s[40:43], s62 offen nt
    s_add_u32 s62, s62, 8192
    buffer_load_dwordx4 a[64:67], v121, s[40:43], s62 offen nt
    s_add_u32 s62, s62, 8192
    buffer_load_dwordx4 a[68:71], v121, s[40:43], s62 offen nt
    s_add_u32 s62, s62, 8192
    buffer_load_dwordx4 a[72:75], v121, s[40:43], s62 offen nt
    s_add_u32 s62, s62, 8192
    buffer_load_dwordx4 a[76:79], v121, s[40:43], s62 offen nt
    s_add_u32 s62, s62, 8192
    buffer_load_dwordx4 a[80:83], v121, s[40:43], s62 offen nt
    s_add_u32 s62, s62, 8192
    buffer_load_dwordx4 a[84:87], v121, s[40:43], s62 offen nt
    s_add_u32 s62, s62, 8192
    buffer_load_dwordx4 a[88:91], v121, s[40:43], s62 offen nt
    s_add_u32 s62, s62, 8192
    buffer_load_dwordx4 a[92:95], v121, s[40:43], s62 offen nt
    s_add_u32 s62, s62, 8192
    buffer_load_dwordx4 a[96:99], v121, s[40:43], s62 offen nt
    s_add_u32 s62, s62, 8192
    buffer_load_dwordx4 a[100:103], v121, s[40:43], s62 offen nt
    s_add_u32 s62, s62, 8192
    buffer_load_dwordx4 a[104:107], v121, s[40:43], s62 offen nt
    s_add_u32 s62, s62, 8192
    buffer_load_dwordx4 a[108:111], v121, s[40:43], s62 offen nt
    s_add_u32 s62, s62, 8192
    buffer_load_dwordx4 a[112:115], v121, s[40:43], s62 offen nt
    s_add_u32 s62, s62, 8192
    buffer_load_dwordx4 a[116:119], v121, s[40:43], s62 offen nt
    s_add_u32 s62, s62, 8192
    buffer_load_dwordx4 a[120:123], v121, s[40:43], s62 offen nt
    s_add_u32 s62, s62, 8192
    buffer_load_dwordx4 a[124:127], v121, s[40:43], s62 offen nt
    s_add_u32 s62, s62, 8192
    v_and_b32 v16, 31, v1
    v_lshlrev_b32 v16, 2, v16
    global_load_dword v17, v16, s[28:29] sc1
    s_waitcnt vmcnt(0)
    s_barrier
L_flags_14:
    v_cmp_gt_u32 vcc, 2, v17
    s_cbranch_vccz L_flagsok_15
    s_sleep 2
    global_load_dword v17, v16, s[28:29] sc1
    s_waitcnt vmcnt(0)
    s_sub_u32 s101, s101, 1
    s_cbranch_scc0 L_flags_14
    s_mov_b32 s101, 0
L_flagsok_15:
    s_lshl_b32 s58, s3, 18
    s_lshl_b32 s54, s52, 10
    s_add_u32 s58, s58, s54
    s_add_u32 s58, s58, 2097152
    s_lshl_b32 s59, s3, 11
    s_lshl_b32 s54, s52, 3
    s_add_u32 s59, s59, s54
    s_add_u32 s59, s59, 3145728
    s_mov_b32 s98, 0xffff0000
    v_and_b32 v5, 7, v1
    v_lshlrev_b32 v5, 8, v5
L_blight_16:
    buffer_load_dwordx2 v[232:233], v5, s[44:47], s59 offen sc1
    s_waitcnt vmcnt(0)
    v_max_u32 v6, v232, v233
    v_cmp_eq_u32 vcc, -1, v6
    s_cbranch_vccz L_bheavy_17
    s_sleep 2
    s_sub_u32 s101, s101, 1
    s_cbranch_scc0 L_blight_16
    s_mov_b32 s101, 0
L_bheavy_17:
    buffer_load_dwordx4 v[16:19], v2, s[44:47], s58 offen sc1 nt
    s_add_u32 s58, s58, 32768
    buffer_load_dwordx4 v[20:23], v2, s[44:47], s58 offen sc1 nt
    s_add_u32 s58, s58, 32768
    buffer_load_dwordx4 v[24:27], v2, s[44:47], s58 offen sc1 nt
    s_add_u32 s58, s58, 32768
    buffer_load_dwordx4 v[28:31], v2, s[44:47], s58 offen sc1 nt
    s_add_u32 s58, s58, 32768
    buffer_load_dwordx4 v[32:35], v2, s[44:47], s58 offen sc1 nt
    s_add_u32 s58, s58, 32768
    buffer_load_dwordx4 v[36:39], v2, s[44:47], s58 offen sc1 nt
    s_add_u32 s58, s58, 32768
    buffer_load_dwordx4 v[40:43], v2, s[44:47], s58 offen sc1 nt
    s_add_u32 s58, s58, 32768
    buffer_load_dwordx4 v[44:47], v2, s[44:47], s58 offen sc1 nt
    s_add_u32 s58, s58, 32768
    v_max_f32_dpp v234, v232, v232 row_ror:1 row_mask:0xf bank_mask:0xf
    s_nop 1
    v_max_f32_dpp v234, v234, v234 row_ror:2 row_mask:0xf bank_mask:0xf
    s_nop 1
    v_max_f32_dpp v234, v234, v234 row_ror:4 row_mask:0xf bank_mask:0xf
    v_sub_f32 v232, v232, v234
    v_exp_f32 v232, v232
    s_nop 0
    v_mul_f32 v232, v232, v233
    s_nop 1
    v_add_f32_dpp v234, v232, v232 row_ror:1 row_mask:0xf bank_mask:0xf
    s_nop 1
    v_add_f32_dpp v234, v234, v234 row_ror:2 row_mask:0xf bank_mask:0xf
    s_nop 1
    v_add_f32_dpp v234, v234, v234 row_ror:4 row_mask:0xf bank_mask:0xf
    v_rcp_f32 v234, v234
    s_nop 0
    v_mul_f32 v232, v232, v234
    s_waitcnt vmcnt(7)
    v_lshlrev_b32 v240, 16, v16
    v_and_b32 v16, s98, v16
    v_lshlrev_b32 v241, 16, v17
    v_and_b32 v17, s98, v17
    v_lshlrev_b32 v242, 16, v18
    v_and_b32 v18, s98, v18
    v_lshlrev_b32 v243, 16, v19
    v_and_b32 v19, s98, v19
    v_mul_f32_dpp v224, v232, v240 row_newbcast:0 row_mask:0xf bank_mask:0xf
    v_mul_f32_dpp v225, v232, v16 row_newbcast:0 row_mask:0xf bank_mask:0xf
    v_mul_f32_dpp v226, v232, v241 row_newbcast:0 row_mask:0xf bank_mask:0xf
    v_mul_f32_dpp v227, v232, v17 row_newbcast:0 row_mask:0xf bank_mask:0xf
    v_mul_f32_dpp v228, v232, v242 row_newbcast:0 row_mask:0xf bank_mask:0xf
    v_mul_f32_dpp v229, v232, v18 row_newbcast:0 row_mask:0xf bank_mask:0xf
    v_mul_f32_dpp v230, v232, v243 row_newbcast:0 row_mask:0xf bank_mask:0xf
    v_mul_f32_dpp v231, v232, v19 row_newbcast:0 row_mask:0xf bank_mask:0xf
    s_waitcnt vmcnt(6)
    v_lshlrev_b32 v240, 16, v20
    v_and_b32 v20, s98, v20
    v_lshlrev_b32 v241, 16, v21
    v_and_b32 v21, s98, v21
    v_lshlrev_b32 v242, 16, v22
    v_and_b32 v22, s98, v22
    v_lshlrev_b32 v243, 16, v23
    v_and_b32 v23, s98, v23
    v_fmac_f32_dpp v224, v232, v240 row_newbcast:1 row_mask:0xf bank_mask:0xf
    v_fmac_f32_dpp v225, v232, v20 row_newbcast:1 row_mask:0xf bank_mask:0xf
    v_fmac_f32_dpp v226, v232, v241 row_newbcast:1 row_mask:0xf bank_mask:0xf
    v_fmac_f32_dpp v227, v232, v21 row_newbcast:1 row_mask:0xf bank_mask:0xf
    v_fmac_f32_dpp v228, v232, v242 row_newbcast:1 row_mask:0xf bank_mask:0xf
    v_fmac_f32_dpp v229, v232, v22 row_newbcast:1 row_mask:0xf bank_mask:0xf
    v_fmac_f32_dpp v230, v232, v243 row_newbcast:1 row_mask:0xf bank_mask:0xf
    v_fmac_f32_dpp v231, v232, v23 row_newbcast:1 row_mask:0xf bank_mask:0xf
    s_waitcnt vmcnt(5)
    v_lshlrev_b32 v240, 16, v24
    v_and_b32 v24, s98, v24
    v_lshlrev_b32 v241, 16, v25
    v_and_b32 v25, s98, v25
    v_lshlrev_b32 v242, 16, v26
    v_and_b32 v26, s98, v26
    v_lshlrev_b32 v243, 16, v27
    v_and_b32 v27, s98, v27
    v_fmac_f32_dpp v224, v232, v240 row_newbcast:2 row_mask:0xf bank_mask:0xf
    v_fmac_f32_dpp v225, v232, v24 row_newbcast:2 row_mask:0xf bank_mask:0xf
    v_fmac_f32_dpp v226, v232, v241 row_newbcast:2 row_mask:0xf bank_mask:0xf
    v_fmac_f32_dpp v227, v232, v25 row_newbcast:2 row_mask:0xf bank_mask:0xf
    v_fmac_f32_dpp v228, v232, v242 row_newbcast:2 row_mask:0xf bank_mask:0xf
    v_fmac_f32_dpp v229, v232, v26 row_newbcast:2 row_mask:0xf bank_mask:0xf
    v_fmac_f32_dpp v230, v232, v243 row_newbcast:2 row_mask:0xf bank_mask:0xf
    v_fmac_f32_dpp v231, v232, v27 row_newbcast:2 row_mask:0xf bank_mask:0xf
    s_waitcnt vmcnt(4)
    v_lshlrev_b32 v240, 16, v28
    v_and_b32 v28, s98, v28
    v_lshlrev_b32 v241, 16, v29
    v_and_b32 v29, s98, v29
    v_lshlrev_b32 v242, 16, v30
    v_and_b32 v30, s98, v30
    v_lshlrev_b32 v243, 16, v31
    v_and_b32 v31, s98, v31
    v_fmac_f32_dpp v224, v232, v240 row_newbcast:3 row_mask:0xf bank_mask:0xf
    v_fmac_f32_dpp v225, v232, v28 row_newbcast:3 row_mask:0xf bank_mask:0xf
    v_fmac_f32_dpp v226, v232, v241 row_newbcast:3 row_mask:0xf bank_mask:0xf
    v_fmac_f32_dpp v227, v232, v29 row_newbcast:3 row_mask:0xf bank_mask:0xf
    v_fmac_f32_dpp v228, v232, v242 row_newbcast:3 row_mask:0xf bank_mask:0xf
    v_fmac_f32_dpp v229, v232, v30 row_newbcast:3 row_mask:0xf bank_mask:0xf
    v_fmac_f32_dpp v230, v232, v243 row_newbcast:3 row_mask:0xf bank_mask:0xf
    v_fmac_f32_dpp v231, v232, v31 row_newbcast:3 row_mask:0xf bank_mask:0xf
    s_waitcnt vmcnt(3)
    v_lshlrev_b32 v240, 16, v32
    v_and_b32 v32, s98, v32
    v_lshlrev_b32 v241, 16, v33
    v_and_b32 v33, s98, v33
    v_lshlrev_b32 v242, 16, v34
    v_and_b32 v34, s98, v34
    v_lshlrev_b32 v243, 16, v35
    v_and_b32 v35, s98, v35
    v_fmac_f32_dpp v224, v232, v240 row_newbcast:4 row_mask:0xf bank_mask:0xf
    v_fmac_f32_dpp v225, v232, v32 row_newbcast:4 row_mask:0xf bank_mask:0xf
    v_fmac_f32_dpp v226, v232, v241 row_newbcast:4 row_mask:0xf bank_mask:0xf
    v_fmac_f32_dpp v227, v232, v33 row_newbcast:4 row_mask:0xf bank_mask:0xf
    v_fmac_f32_dpp v228, v232, v242 row_newbcast:4 row_mask:0xf bank_mask:0xf
    v_fmac_f32_dpp v229, v232, v34 row_newbcast:4 row_mask:0xf bank_mask:0xf
    v_fmac_f32_dpp v230, v232, v243 row_newbcast:4 row_mask:0xf bank_mask:0xf
    v_fmac_f32_dpp v231, v232, v35 row_newbcast:4 row_mask:0xf bank_mask:0xf
    s_waitcnt vmcnt(2)
    v_lshlrev_b32 v240, 16, v36
    v_and_b32 v36, s98, v36
    v_lshlrev_b32 v241, 16, v37
    v_and_b32 v37, s98, v37
    v_lshlrev_b32 v242, 16, v38
    v_and_b32 v38, s98, v38
    v_lshlrev_b32 v243, 16, v39
    v_and_b32 v39, s98, v39
    v_fmac_f32_dpp v224, v232, v240 row_newbcast:5 row_mask:0xf bank_mask:0xf
    v_fmac_f32_dpp v225, v232, v36 row_newbcast:5 row_mask:0xf bank_mask:0xf
    v_fmac_f32_dpp v226, v232, v241 row_newbcast:5 row_mask:0xf bank_mask:0xf
    v_fmac_f32_dpp v227, v232, v37 row_newbcast:5 row_mask:0xf bank_mask:0xf
    v_fmac_f32_dpp v228, v232, v242 row_newbcast:5 row_mask:0xf bank_mask:0xf
    v_fmac_f32_dpp v229, v232, v38 row_newbcast:5 row_mask:0xf bank_mask:0xf
    v_fmac_f32_dpp v230, v232, v243 row_newbcast:5 row_mask:0xf bank_mask:0xf
    v_fmac_f32_dpp v231, v232, v39 row_newbcast:5 row_mask:0xf bank_mask:0xf
    s_waitcnt vmcnt(1)
    v_lshlrev_b32 v240, 16, v40
    v_and_b32 v40, s98, v40
    v_lshlrev_b32 v241, 16, v41
    v_and_b32 v41, s98, v41
    v_lshlrev_b32 v242, 16, v42
    v_and_b32 v42, s98, v42
    v_lshlrev_b32 v243, 16, v43
    v_and_b32 v43, s98, v43
    v_fmac_f32_dpp v224, v232, v240 row_newbcast:6 row_mask:0xf bank_mask:0xf
    v_fmac_f32_dpp v225, v232, v40 row_newbcast:6 row_mask:0xf bank_mask:0xf
    v_fmac_f32_dpp v226, v232, v241 row_newbcast:6 row_mask:0xf bank_mask:0xf
    v_fmac_f32_dpp v227, v232, v41 row_newbcast:6 row_mask:0xf bank_mask:0xf
    v_fmac_f32_dpp v228, v232, v242 row_newbcast:6 row_mask:0xf bank_mask:0xf
    v_fmac_f32_dpp v229, v232, v42 row_newbcast:6 row_mask:0xf bank_mask:0xf
    v_fmac_f32_dpp v230, v232, v243 row_newbcast:6 row_mask:0xf bank_mask:0xf
    v_fmac_f32_dpp v231, v232, v43 row_newbcast:6 row_mask:0xf bank_mask:0xf
    s_waitcnt vmcnt(0)
    v_lshlrev_b32 v240, 16, v44
    v_and_b32 v44, s98, v44
    v_lshlrev_b32 v241, 16, v45
    v_and_b32 v45, s98, v45
    v_lshlrev_b32 v242, 16, v46
    v_and_b32 v46, s98, v46
    v_lshlrev_b32 v243, 16, v47
    v_and_b32 v47, s98, v47
    v_fmac_f32_dpp v224, v232, v240 row_newbcast:7 row_mask:0xf bank_mask:0xf
    v_fmac_f32_dpp v225, v232, v44 row_newbcast:7 row_mask:0xf bank_mask:0xf
    v_fmac_f32_dpp v226, v232, v241 row_newbcast:7 row_mask:0xf bank_mask:0xf
    v_fmac_f32_dpp v227, v232, v45 row_newbcast:7 row_mask:0xf bank_mask:0xf
    v_fmac_f32_dpp v228, v232, v242 row_newbcast:7 row_mask:0xf bank_mask:0xf
    v_fmac_f32_dpp v229, v232, v46 row_newbcast:7 row_mask:0xf bank_mask:0xf
    v_fmac_f32_dpp v230, v232, v243 row_newbcast:7 row_mask:0xf bank_mask:0xf
    v_fmac_f32_dpp v231, v232, v47 row_newbcast:7 row_mask:0xf bank_mask:0xf
    v_cvt_pk_bf16_f32 v244, v224, v225
    v_cvt_pk_bf16_f32 v245, v226, v227
    v_cvt_pk_bf16_f32 v246, v228, v229
    v_cvt_pk_bf16_f32 v247, v230, v231
    s_lshl_b32 s54, s3, 10
    v_add_u32 v5, s54, v2
    ds_write_b128 v5, v[244:247]
    v_lshrrev_b32 v5, 3, v3
    v_lshlrev_b32 v5, 10, v5
    v_lshl_add_u32 v5, v4, 6, v5
    s_lshl_b32 s54, s3, 8
    v_add_u32 v5, s54, v5
    s_waitcnt lgkmcnt(0)
    s_barrier
    ds_read_b128 v[16:19], v5 offset:0
    ds_read_b128 v[20:23], v5 offset:16
    ds_read_b128 v[24:27], v5 offset:32
    ds_read_b128 v[28:31], v5 offset:48
    ds_read_b128 v[32:35], v5 offset:2048
    ds_read_b128 v[36:39], v5 offset:2064
    ds_read_b128 v[40:43], v5 offset:2080
    ds_read_b128 v[44:47], v5 offset:2096
    s_waitcnt lgkmcnt(0)
    v_perm_b32 v48, v16, v16, v8
    v_perm_b32 v49, v16, v16, v10
    v_perm_b32 v50, v16, v16, v12
    v_perm_b32 v51, v16, v16, v14
    s_nop 1
    v_mfma_f32_16x16x32_bf16 v[224:227], v[48:51], a[0:3], 0
    v_perm_b32 v52, v32, v32, v8
    v_perm_b32 v53, v32, v32, v10
    v_perm_b32 v54, v32, v32, v12
    v_perm_b32 v55, v32, v32, v14
    s_nop 1
    v_mfma_f32_16x16x32_bf16 v[228:231], v[52:55], a[0:3], 0
    v_perm_b32 v56, v16, v16, v9
    v_perm_b32 v57, v16, v16, v11
    v_perm_b32 v58, v16, v16, v13
    v_perm_b32 v59, v16, v16, v15
    s_nop 1
    v_mfma_f32_16x16x32_bf16 v[224:227], v[56:59], a[4:7], v[224:227]
    v_perm_b32 v60, v32, v32, v9
    v_perm_b32 v61, v32, v32, v11
    v_perm_b32 v62, v32, v32, v13
    v_perm_b32 v63, v32, v32, v15
    s_nop 1
    v_mfma_f32_16x16x32_bf16 v[228:231], v[60:63], a[4:7], v[228:231]
    v_perm_b32 v48, v17, v17, v8
    v_perm_b32 v49, v17, v17, v10
    v_perm_b32 v50, v17, v17, v12
    v_perm_b32 v51, v17, v17, v14
    s_nop 1
    v_mfma_f32_16x16x32_bf16 v[224:227], v[48:51], a[8:11], v[224:227]
    v_perm_b32 v52, v33, v33, v8
    v_perm_b32 v53, v33, v33, v10
    v_perm_b32 v54, v33, v33, v12
    v_perm_b32 v55, v33, v33, v14
    s_nop 1
    v_mfma_f32_16x16x32_bf16 v[228:231], v[52:55], a[8:11], v[228:231]
    v_perm_b32 v56, v17, v17, v9
    v_perm_b32 v57, v17, v17, v11
    v_perm_b32 v58, v17, v17, v13
    v_perm_b32 v59, v17, v17, v15
    s_nop 1
    v_mfma_f32_16x16x32_bf16 v[224:227], v[56:59], a[12:15], v[224:227]
    v_perm_b32 v60, v33, v33, v9
    v_perm_b32 v61, v33, v33, v11
    v_perm_b32 v62, v33, v33, v13
    v_perm_b32 v63, v33, v33, v15
    s_nop 1
    v_mfma_f32_16x16x32_bf16 v[228:231], v[60:63], a[12:15], v[228:231]
    v_perm_b32 v48, v18, v18, v8
    v_perm_b32 v49, v18, v18, v10
    v_perm_b32 v50, v18, v18, v12
    v_perm_b32 v51, v18, v18, v14
    s_nop 1
    v_mfma_f32_16x16x32_bf16 v[224:227], v[48:51], a[16:19], v[224:227]
    v_perm_b32 v52, v34, v34, v8
    v_perm_b32 v53, v34, v34, v10
    v_perm_b32 v54, v34, v34, v12
    v_perm_b32 v55, v34, v34, v14
    s_nop 1
    v_mfma_f32_16x16x32_bf16 v[228:231], v[52:55], a[16:19], v[228:231]
    v_perm_b32 v56, v18, v18, v9
    v_perm_b32 v57, v18, v18, v11
    v_perm_b32 v58, v18, v18, v13
    v_perm_b32 v59, v18, v18, v15
    s_nop 1
    v_mfma_f32_16x16x32_bf16 v[224:227], v[56:59], a[20:23], v[224:227]
    v_perm_b32 v60, v34, v34, v9
    v_perm_b32 v61, v34, v34, v11
    v_perm_b32 v62, v34, v34, v13
    v_perm_b32 v63, v34, v34, v15
    s_nop 1
    v_mfma_f32_16x16x32_bf16 v[228:231], v[60:63], a[20:23], v[228:231]
    v_perm_b32 v48, v19, v19, v8
    v_perm_b32 v49, v19, v19, v10
    v_perm_b32 v50, v19, v19, v12
    v_perm_b32 v51, v19, v19, v14
    s_nop 1
    v_mfma_f32_16x16x32_bf16 v[224:227], v[48:51], a[24:27], v[224:227]
    v_perm_b32 v52, v35, v35, v8
    v_perm_b32 v53, v35, v35, v10
    v_perm_b32 v54, v35, v35, v12
    v_perm_b32 v55, v35, v35, v14
    s_nop 1
    v_mfma_f32_16x16x32_bf16 v[228:231], v[52:55], a[24:27], v[228:231]
    v_perm_b32 v56, v19, v19, v9
    v_perm_b32 v57, v19, v19, v11
    v_perm_b32 v58, v19, v19, v13
    v_perm_b32 v59, v19, v19, v15
    s_nop 1
    v_mfma_f32_16x16x32_bf16 v[224:227], v[56:59], a[28:31], v[224:227]
    v_perm_b32 v60, v35, v35, v9
    v_perm_b32 v61, v35, v35, v11
    v_perm_b32 v62, v35, v35, v13
    v_perm_b32 v63, v35, v35, v15
    s_nop 1
    v_mfma_f32_16x16x32_bf16 v[228:231], v[60:63], a[28:31], v[228:231]
    v_perm_b32 v48, v20, v20, v8
    v_perm_b32 v49, v20, v20, v10
    v_perm_b32 v50, v20, v20, v12
    v_perm_b32 v51, v20, v20, v14
    s_nop 1
    v_mfma_f32_16x16x32_bf16 v[224:227], v[48:51], a[32:35], v[224:227]
    v_perm_b32 v52, v36, v36, v8
    v_perm_b32 v53, v36, v36, v10
    v_perm_b32 v54, v36, v36, v12
    v_perm_b32 v55, v36, v36, v14
    s_nop 1
    v_mfma_f32_16x16x32_bf16 v[228:231], v[52:55], a[32:35], v[228:231]
    v_perm_b32 v56, v20, v20, v9
    v_perm_b32 v57, v20, v20, v11
    v_perm_b32 v58, v20, v20, v13
    v_perm_b32 v59, v20, v20, v15
    s_nop 1
    v_mfma_f32_16x16x32_bf16 v[224:227], v[56:59], a[36:39], v[224:227]
    v_perm_b32 v60, v36, v36, v9
    v_perm_b32 v61, v36, v36, v11
    v_perm_b32 v62, v36, v36, v13
    v_perm_b32 v63, v36, v36, v15
    s_nop 1
    v_mfma_f32_16x16x32_bf16 v[228:231], v[60:63], a[36:39], v[228:231]
    v_perm_b32 v48, v21, v21, v8
    v_perm_b32 v49, v21, v21, v10
    v_perm_b32 v50, v21, v21, v12
    v_perm_b32 v51, v21, v21, v14
    s_nop 1
    v_mfma_f32_16x16x32_bf16 v[224:227], v[48:51], a[40:43], v[224:227]
    v_perm_b32 v52, v37, v37, v8
    v_perm_b32 v53, v37, v37, v10
    v_perm_b32 v54, v37, v37, v12
    v_perm_b32 v55, v37, v37, v14
    s_nop 1
    v_mfma_f32_16x16x32_bf16 v[228:231], v[52:55], a[40:43], v[228:231]
    v_perm_b32 v56, v21, v21, v9
    v_perm_b32 v57, v21, v21, v11
    v_perm_b32 v58, v21, v21, v13
    v_perm_b32 v59, v21, v21, v15
    s_nop 1
    v_mfma_f32_16x16x32_bf16 v[224:227], v[56:59], a[44:47], v[224:227]
    v_perm_b32 v60, v37, v37, v9
    v_perm_b32 v61, v37, v37, v11
    v_perm_b32 v62, v37, v37, v13
    v_perm_b32 v63, v37, v37, v15
    s_nop 1
    v_mfma_f32_16x16x32_bf16 v[228:231], v[60:63], a[44:47], v[228:231]
    v_perm_b32 v48, v22, v22, v8
    v_perm_b32 v49, v22, v22, v10
    v_perm_b32 v50, v22, v22, v12
    v_perm_b32 v51, v22, v22, v14
    s_nop 1
    v_mfma_f32_16x16x32_bf16 v[224:227], v[48:51], a[48:51], v[224:227]
    v_perm_b32 v52, v38, v38, v8
    v_perm_b32 v53, v38, v38, v10
    v_perm_b32 v54, v38, v38, v12
    v_perm_b32 v55, v38, v38, v14
    s_nop 1
    v_mfma_f32_16x16x32_bf16 v[228:231], v[52:55], a[48:51], v[228:231]
    v_perm_b32 v56, v22, v22, v9
    v_perm_b32 v57, v22, v22, v11
    v_perm_b32 v58, v22, v22, v13
    v_perm_b32 v59, v22, v22, v15
    s_nop 1
    v_mfma_f32_16x16x32_bf16 v[224:227], v[56:59], a[52:55], v[224:227]
    v_perm_b32 v60, v38, v38, v9
    v_perm_b32 v61, v38, v38, v11
    v_perm_b32 v62, v38, v38, v13
    v_perm_b32 v63, v38, v38, v15
    s_nop 1
    v_mfma_f32_16x16x32_bf16 v[228:231], v[60:63], a[52:55], v[228:231]
    v_perm_b32 v48, v23, v23, v8
    v_perm_b32 v49, v23, v23, v10
    v_perm_b32 v50, v23, v23, v12
    v_perm_b32 v51, v23, v23, v14
    s_nop 1
    v_mfma_f32_16x16x32_bf16 v[224:227], v[48:51], a[56:59], v[224:227]
    v_perm_b32 v52, v39, v39, v8
    v_perm_b32 v53, v39, v39, v10
    v_perm_b32 v54, v39, v39, v12
    v_perm_b32 v55, v39, v39, v14
    s_nop 1
    v_mfma_f32_16x16x32_bf16 v[228:231], v[52:55], a[56:59], v[228:231]
    v_perm_b32 v56, v23, v23, v9
    v_perm_b32 v57, v23, v23, v11
    v_perm_b32 v58, v23, v23, v13
    v_perm_b32 v59, v23, v23, v15
    s_nop 1
    v_mfma_f32_16x16x32_bf16 v[224:227], v[56:59], a[60:63], v[224:227]
    v_perm_b32 v60, v39, v39, v9
    v_perm_b32 v61, v39, v39, v11
    v_perm_b32 v62, v39, v39, v13
    v_perm_b32 v63, v39, v39, v15
    s_nop 1
    v_mfma_f32_16x16x32_bf16 v[228:231], v[60:63], a[60:63], v[228:231]
    v_perm_b32 v48, v24, v24, v8
    v_perm_b32 v49, v24, v24, v10
    v_perm_b32 v50, v24, v24, v12
    v_perm_b32 v51, v24, v24, v14
    s_nop 1
    v_mfma_f32_16x16x32_bf16 v[224:227], v[48:51], a[64:67], v[224:227]
    v_perm_b32 v52, v40, v40, v8
    v_perm_b32 v53, v40, v40, v10
    v_perm_b32 v54, v40, v40, v12
    v_perm_b32 v55, v40, v40, v14
    s_nop 1
    v_mfma_f32_16x16x32_bf16 v[228:231], v[52:55], a[64:67], v[228:231]
    v_perm_b32 v56, v24, v24, v9
    v_perm_b32 v57, v24, v24, v11
    v_perm_b32 v58, v24, v24, v13
    v_perm_b32 v59, v24, v24, v15
    s_nop 1
    v_mfma_f32_16x16x32_bf16 v[224:227], v[56:59], a[68:71], v[224:227]
    v_perm_b32 v60, v40, v40, v9
    v_perm_b32 v61, v40, v40, v11
    v_perm_b32 v62, v40, v40, v13
    v_perm_b32 v63, v40, v40, v15
    s_nop 1
    v_mfma_f32_16x16x32_bf16 v[228:231], v[60:63], a[68:71], v[228:231]
    v_perm_b32 v48, v25, v25, v8
    v_perm_b32 v49, v25, v25, v10
    v_perm_b32 v50, v25, v25, v12
    v_perm_b32 v51, v25, v25, v14
    s_nop 1
    v_mfma_f32_16x16x32_bf16 v[224:227], v[48:51], a[72:75], v[224:227]
    v_perm_b32 v52, v41, v41, v8
    v_perm_b32 v53, v41, v41, v10
    v_perm_b32 v54, v41, v41, v12
    v_perm_b32 v55, v41, v41, v14
    s_nop 1
    v_mfma_f32_16x16x32_bf16 v[228:231], v[52:55], a[72:75], v[228:231]
    v_perm_b32 v56, v25, v25, v9
    v_perm_b32 v57, v25, v25, v11
    v_perm_b32 v58, v25, v25, v13
    v_perm_b32 v59, v25, v25, v15
    s_nop 1
    v_mfma_f32_16x16x32_bf16 v[224:227], v[56:59], a[76:79], v[224:227]
    v_perm_b32 v60, v41, v41, v9
    v_perm_b32 v61, v41, v41, v11
    v_perm_b32 v62, v41, v41, v13
    v_perm_b32 v63, v41, v41, v15
    s_nop 1
    v_mfma_f32_16x16x32_bf16 v[228:231], v[60:63], a[76:79], v[228:231]
    v_perm_b32 v48, v26, v26, v8
    v_perm_b32 v49, v26, v26, v10
    v_perm_b32 v50, v26, v26, v12
    v_perm_b32 v51, v26, v26, v14
    s_nop 1
    v_mfma_f32_16x16x32_bf16 v[224:227], v[48:51], a[80:83], v[224:227]
    v_perm_b32 v52, v42, v42, v8
    v_perm_b32 v53, v42, v42, v10
    v_perm_b32 v54, v42, v42, v12
    v_perm_b32 v55, v42, v42, v14
    s_nop 1
    v_mfma_f32_16x16x32_bf16 v[228:231], v[52:55], a[80:83], v[228:231]
    v_perm_b32 v56, v26, v26, v9
    v_perm_b32 v57, v26, v26, v11
    v_perm_b32 v58, v26, v26, v13
    v_perm_b32 v59, v26, v26, v15
    s_nop 1
    v_mfma_f32_16x16x32_bf16 v[224:227], v[56:59], a[84:87], v[224:227]
    v_perm_b32 v60, v42, v42, v9
    v_perm_b32 v61, v42, v42, v11
    v_perm_b32 v62, v42, v42, v13
    v_perm_b32 v63, v42, v42, v15
    s_nop 1
    v_mfma_f32_16x16x32_bf16 v[228:231], v[60:63], a[84:87], v[228:231]
    v_perm_b32 v48, v27, v27, v8
    v_perm_b32 v49, v27, v27, v10
    v_perm_b32 v50, v27, v27, v12
    v_perm_b32 v51, v27, v27, v14
    s_nop 1
    v_mfma_f32_16x16x32_bf16 v[224:227], v[48:51], a[88:91], v[224:227]
    v_perm_b32 v52, v43, v43, v8
    v_perm_b32 v53, v43, v43, v10
    v_perm_b32 v54, v43, v43, v12
    v_perm_b32 v55, v43, v43, v14
    s_nop 1
    v_mfma_f32_16x16x32_bf16 v[228:231], v[52:55], a[88:91], v[228:231]
    v_perm_b32 v56, v27, v27, v9
    v_perm_b32 v57, v27, v27, v11
    v_perm_b32 v58, v27, v27, v13
    v_perm_b32 v59, v27, v27, v15
    s_nop 1
    v_mfma_f32_16x16x32_bf16 v[224:227], v[56:59], a[92:95], v[224:227]
    v_perm_b32 v60, v43, v43, v9
    v_perm_b32 v61, v43, v43, v11
    v_perm_b32 v62, v43, v43, v13
    v_perm_b32 v63, v43, v43, v15
    s_nop 1
    v_mfma_f32_16x16x32_bf16 v[228:231], v[60:63], a[92:95], v[228:231]
    v_perm_b32 v48, v28, v28, v8
    v_perm_b32 v49, v28, v28, v10
    v_perm_b32 v50, v28, v28, v12
    v_perm_b32 v51, v28, v28, v14
    s_nop 1
    v_mfma_f32_16x16x32_bf16 v[224:227], v[48:51], a[96:99], v[224:227]
    v_perm_b32 v52, v44, v44, v8
    v_perm_b32 v53, v44, v44, v10
    v_perm_b32 v54, v44, v44, v12
    v_perm_b32 v55, v44, v44, v14
    s_nop 1
    v_mfma_f32_16x16x32_bf16 v[228:231], v[52:55], a[96:99], v[228:231]
    v_perm_b32 v56, v28, v28, v9
    v_perm_b32 v57, v28, v28, v11
    v_perm_b32 v58, v28, v28, v13
    v_perm_b32 v59, v28, v28, v15
    s_nop 1
    v_mfma_f32_16x16x32_bf16 v[224:227], v[56:59], a[100:103], v[224:227]
    v_perm_b32 v60, v44, v44, v9
    v_perm_b32 v61, v44, v44, v11
    v_perm_b32 v62, v44, v44, v13
    v_perm_b32 v63, v44, v44, v15
    s_nop 1
    v_mfma_f32_16x16x32_bf16 v[228:231], v[60:63], a[100:103], v[228:231]
    v_perm_b32 v48, v29, v29, v8
    v_perm_b32 v49, v29, v29, v10
    v_perm_b32 v50, v29, v29, v12
    v_perm_b32 v51, v29, v29, v14
    s_nop 1
    v_mfma_f32_16x16x32_bf16 v[224:227], v[48:51], a[104:107], v[224:227]
    v_perm_b32 v52, v45, v45, v8
    v_perm_b32 v53, v45, v45, v10
    v_perm_b32 v54, v45, v45, v12
    v_perm_b32 v55, v45, v45, v14
    s_nop 1
    v_mfma_f32_16x16x32_bf16 v[228:231], v[52:55], a[104:107], v[228:231]
    v_perm_b32 v56, v29, v29, v9
    v_perm_b32 v57, v29, v29, v11
    v_perm_b32 v58, v29, v29, v13
    v_perm_b32 v59, v29, v29, v15
    s_nop 1
    v_mfma_f32_16x16x32_bf16 v[224:227], v[56:59], a[108:111], v[224:227]
    v_perm_b32 v60, v45, v45, v9
    v_perm_b32 v61, v45, v45, v11
    v_perm_b32 v62, v45, v45, v13
    v_perm_b32 v63, v45, v45, v15
    s_nop 1
    v_mfma_f32_16x16x32_bf16 v[228:231], v[60:63], a[108:111], v[228:231]
    v_perm_b32 v48, v30, v30, v8
    v_perm_b32 v49, v30, v30, v10
    v_perm_b32 v50, v30, v30, v12
    v_perm_b32 v51, v30, v30, v14
    s_nop 1
    v_mfma_f32_16x16x32_bf16 v[224:227], v[48:51], a[112:115], v[224:227]
    v_perm_b32 v52, v46, v46, v8
    v_perm_b32 v53, v46, v46, v10
    v_perm_b32 v54, v46, v46, v12
    v_perm_b32 v55, v46, v46, v14
    s_nop 1
    v_mfma_f32_16x16x32_bf16 v[228:231], v[52:55], a[112:115], v[228:231]
    v_perm_b32 v56, v30, v30, v9
    v_perm_b32 v57, v30, v30, v11
    v_perm_b32 v58, v30, v30, v13
    v_perm_b32 v59, v30, v30, v15
    s_nop 1
    v_mfma_f32_16x16x32_bf16 v[224:227], v[56:59], a[116:119], v[224:227]
    v_perm_b32 v60, v46, v46, v9
    v_perm_b32 v61, v46, v46, v11
    v_perm_b32 v62, v46, v46, v13
    v_perm_b32 v63, v46, v46, v15
    s_nop 1
    v_mfma_f32_16x16x32_bf16 v[228:231], v[60:63], a[116:119], v[228:231]
    v_perm_b32 v48, v31, v31, v8
    v_perm_b32 v49, v31, v31, v10
    v_perm_b32 v50, v31, v31, v12
    v_perm_b32 v51, v31, v31, v14
    s_nop 1
    v_mfma_f32_16x16x32_bf16 v[224:227], v[48:51], a[120:123], v[224:227]
    v_perm_b32 v52, v47, v47, v8
    v_perm_b32 v53, v47, v47, v10
    v_perm_b32 v54, v47, v47, v12
    v_perm_b32 v55, v47, v47, v14
    s_nop 1
    v_mfma_f32_16x16x32_bf16 v[228:231], v[52:55], a[120:123], v[228:231]
    v_perm_b32 v56, v31, v31, v9
    v_perm_b32 v57, v31, v31, v11
    v_perm_b32 v58, v31, v31, v13
    v_perm_b32 v59, v31, v31, v15
    s_nop 1
    v_mfma_f32_16x16x32_bf16 v[224:227], v[56:59], a[124:127], v[224:227]
    v_perm_b32 v60, v47, v47, v9
    v_perm_b32 v61, v47, v47, v11
    v_perm_b32 v62, v47, v47, v13
    v_perm_b32 v63, v47, v47, v15
    s_nop 1
    v_mfma_f32_16x16x32_bf16 v[228:231], v[60:63], a[124:127], v[228:231]
    v_lshrrev_b32 v5, 1, v4
    v_lshlrev_b32 v5, 9, v5
    v_lshl_add_u32 v5, v3, 5, v5
    v_and_b32 v6, 1, v4
    v_lshl_add_u32 v5, v6, 4, v5
    s_lshl_b32 s54, s3, 11
    s_add_u32 s54, s54, 131072
    v_add_u32 v5, s54, v5
    ds_write_b128 v5, v[224:227]
    ds_write_b128 v5, v[228:231] offset:1024
    s_waitcnt lgkmcnt(0)
    s_barrier
    v_lshrrev_b32 v5, 2, v3
    v_lshlrev_b32 v5, 9, v5
    v_lshl_add_u32 v5, v4, 5, v5
    s_lshl_b32 s54, s3, 7
    s_add_u32 s54, s54, 131072
    v_add_u32 v5, s54, v5
    ds_read_b128 v[16:19], v5 offset:0
    ds_read_b128 v[20:23], v5 offset:16
    ds_read_b128 v[24:27], v5 offset:2048
    ds_read_b128 v[28:31], v5 offset:2064
    ds_read_b128 v[32:35], v5 offset:4096
    ds_read_b128 v[36:39], v5 offset:4112
    ds_read_b128 v[40:43], v5 offset:6144
    ds_read_b128 v[44:47], v5 offset:6160
    s_waitcnt lgkmcnt(0)
    v_add_f32 v16, v16, v24
    v_add_f32 v32, v32, v40
    v_add_f32 v17, v17, v25
    v_add_f32 v33, v33, v41
    v_add_f32 v18, v18, v26
    v_add_f32 v34, v34, v42
    v_add_f32 v19, v19, v27
    v_add_f32 v35, v35, v43
    v_add_f32 v20, v20, v28
    v_add_f32 v36, v36, v44
    v_add_f32 v21, v21, v29
    v_add_f32 v37, v37, v45
    v_add_f32 v22, v22, v30
    v_add_f32 v38, v38, v46
    v_add_f32 v23, v23, v31
    v_add_f32 v39, v39, v47
    v_add_f32 v16, v16, v32
    v_add_f32 v17, v17, v33
    v_add_f32 v18, v18, v34
    v_add_f32 v19, v19, v35
    v_add_f32 v20, v20, v36
    v_add_f32 v21, v21, v37
    v_add_f32 v22, v22, v38
    v_add_f32 v23, v23, v39
    v_cvt_pk_bf16_f32 v64, v16, v17
    v_cvt_pk_bf16_f32 v65, v18, v19
    v_cvt_pk_bf16_f32 v66, v20, v21
    v_cvt_pk_bf16_f32 v67, v22, v23
    v_min_u32 v64, -2, v64
    v_min_u32 v65, -2, v65
    v_min_u32 v66, -2, v66
    v_min_u32 v67, -2, v67
    v_bfe_u32 v6, v1, 2, 2
    v_lshlrev_b32 v6, 6, v6
    v_and_b32 v5, 48, v1
    v_add_u32 v6, v6, v5
    v_and_b32 v5, 3, v1
    v_lshl_add_u32 v6, v5, 29, v6
    s_lshl_b32 s54, s52, 10
    s_lshl_b32 s55, s3, 8
    s_add_u32 s54, s54, s55
    s_add_u32 s54, s54, 5439488
    buffer_store_dwordx4 v[64:67], v6, s[44:47], s54 offen sc1
    s_mov_b32 s48, s26
    s_mov_b32 s49, s27
    s_mov_b32 s50, 9216
    s_mov_b32 s51, 0x20000
    s_lshl_b32 s54, s3, 5
    s_add_u32 s54, s54, s53
    s_cmp_ge_u32 s54, 72
    s_cbranch_scc1 L_nored_18
    v_mov_b32 v48, -1
    v_mov_b32 v49, -1
    v_mov_b32 v50, -1
    v_mov_b32 v51, -1
    v_mov_b32 v52, -1
    v_mov_b32 v53, -1
    v_mov_b32 v54, -1
    v_mov_b32 v55, -1
    v_mov_b32 v56, -1
    v_mov_b32 v57, -1
    v_mov_b32 v58, -1
    v_mov_b32 v59, -1
    v_mov_b32 v60, -1
    v_mov_b32 v61, -1
    v_mov_b32 v62, -1
    v_mov_b32 v63, -1
    s_lshl_b32 s55, s54, 12
    s_add_u32 s55, s55, 4718592
    s_mul_hi_u32 s56, s54, 238609295
    s_add_u32 s56, s56, 1
    s_mul_i32 s56, s56, 1152
    s_lshl_b32 s57, s54, 6
    s_add_u32 s56, s56, s57
    v_lshlrev_b32 v5, 3, v3
    v_lshl_add_u32 v5, v4, 1, v5
    v_mov_b32 v6, 0x4000
    v_cmp_gt_u32 vcc, 8, v3
    s_nop 1
    v_cndmask_b32 v5, v6, v5, vcc
    s_mov_b64 s[4:5], -1
    s_mov_b64 s[6:7], -1
    s_mov_b64 s[8:9], -1
    s_mov_b64 s[10:11], -1
L_mpoll_19:
    s_mov_b64 exec, s[4:5]
    buffer_load_dwordx4 v[48:51], v2, s[44:47], s55 offen offset:0 sc1
    s_mov_b64 exec, s[6:7]
    buffer_load_dwordx4 v[52:55], v2, s[44:47], s55 offen offset:1024 sc1
    s_mov_b64 exec, s[8:9]
    buffer_load_dwordx4 v[56:59], v2, s[44:47], s55 offen offset:2048 sc1
    s_mov_b64 exec, s[10:11]
    buffer_load_dwordx4 v[60:63], v2, s[44:47], s55 offen offset:3072 sc1
    s_mov_b64 exec, -1
    s_waitcnt vmcnt(4)
    v_max3_u32 v32, v48, v49, v50
    v_max3_u32 v33, v52, v53, v54
    v_max3_u32 v34, v56, v57, v58
    v_max3_u32 v35, v60, v61, v62
    v_max_u32 v32, v32, v51
    v_max_u32 v33, v33, v55
    v_max_u32 v34, v34, v59
    v_max_u32 v35, v35, v63
    v_cmp_eq_u32 s[4:5], -1, v32
    v_cmp_eq_u32 s[6:7], -1, v33
    v_cmp_eq_u32 s[8:9], -1, v34
    v_cmp_eq_u32 s[10:11], -1, v35
    s_or_b64 vcc, s[4:5], s[6:7]
    s_or_b64 vcc, vcc, s[8:9]
    s_or_b64 vcc, vcc, s[10:11]
    s_cbranch_scc0 L_mpollok_20
    s_and_b64 vcc, s[4:5], s[6:7]
    s_and_b64 vcc, vcc, s[8:9]
    s_and_b64 vcc, vcc, s[10:11]
    s_cmp_eq_u64 vcc, -1
    s_cbranch_scc0 L_mpoll_19_b
    s_sleep 4
L_mpoll_19_b:
    s_sub_u32 s101, s101, 1
    s_cbranch_scc0 L_mpoll_19
    s_mov_b32 s101, 0
L_mpollok_20:
    v_add_f32 v16, v48, v52
    v_add_f32 v24, v56, v60
    v_add_f32 v18, v50, v54
    v_add_f32 v26, v58, v62
    v_add_f32 v17, v49, v53
    v_add_f32 v25, v57, v61
    v_add_f32 v19, v51, v55
    v_add_f32 v27, v59, v63
    v_add_f32 v16, v16, v24
    v_add_f32 v18, v18, v26
    v_add_f32 v17, v17, v25
    v_add_f32 v19, v19, v27
    v_permlane32_swap_b32 v16, v18
    s_nop 0
    v_permlane32_swap_b32 v17, v19
    v_add_f32 v16, v16, v18
    v_add_f32 v17, v17, v19
    s_nop 1
    v_permlane16_swap_b32 v16, v17
    v_add_f32 v16, v16, v17
    s_nop 1
    v_add_f32_dpp v16, v16, v16 row_ror:8 row_mask:0xf bank_mask:0xf
    v_cvt_pk_bf16_f32 v16, v16, v16
    buffer_store_short v16, v5, s[48:51], s56 offen
L_nored_18:
    s_endpgm
L_roleH_end:
L_roleC:
    s_mov_b32 s101, 100000
    s_getpc_b64 s[56:57]
L_pc_21:
    s_sub_u32 s56, s56, L_pc_21-L_roleC
    s_subb_u32 s57, s57, 0
    v_lshlrev_b32 v5, 7, v0
    v_min_u32 v6, L_roleC_end-L_roleC-4, v5
    global_load_dword v122, v6, s[56:57]
    v_add_u32 v5, 32768, v5
    v_min_u32 v6, L_roleC_end-L_roleC-4, v5
    global_load_dword v122, v6, s[56:57]
    v_mov_b32 v20, -1
    v_mov_b32 v21, -1
    v_mov_b32 v22, -1
    v_mov_b32 v23, -1
    v_mul_u32_u24 v7, 73728, v4
    v_lshrrev_b32 v5, 3, v3
    v_lshl_add_u32 v6, v5, 13, v7
    v_and_b32 v5, 7, v3
    v_lshl_add_u32 v6, v5, 4, v6
    v_lshl_add_u32 v7, v3, 3, v7
    v_add_u32 v7, 65536, v7
    s_lshl_b32 s56, s52, 7
    s_add_u32 s56, s56, 4194304
    s_lshl_b32 s54, s3, 14
    s_add_u32 s54, s54, s56
    s_add_u32 s55, s54, 4096
    s_and_b32 s57, s3, 1
    s_lshl_b32 s57, s57, 12
    s_add_u32 s56, s56, s57
    s_waitcnt lgkmcnt(0)
    s_mov_b32 s44, s30
    s_mov_b32 s45, s31
    s_mov_b32 s46, 536870912
    s_mov_b32 s47, 0x20000
    buffer_store_dwordx4 v[20:23], v6, s[44:47], s54 offen sc1
    buffer_store_dwordx4 v[20:23], v6, s[44:47], s55 offen sc1
    buffer_store_dwordx2 v[20:21], v7, s[44:47], s56 offen sc1
    v_mov_b32 v7, 536870912
    v_cmp_gt_u32 vcc, 32, v1
    s_nop 1
    v_cndmask_b32 v123, v7, v2, vcc
    s_lshl_b32 s98, s52, 12
    s_lshl_b32 s54, s3, 9
    s_add_u32 s98, s98, s54
    s_add_u32 s98, s98, 5244928
    buffer_store_dwordx4 v[20:23], v123, s[44:47], s98 offen sc1
    s_lshl_b32 s58, s52, 2
    s_add_u32 s58, s58, s3
    s_lshl_b32 s58, s58, 13
    s_add_u32 s58, s58, 8388608
    s_add_u32 s59, s58, 4096
    v_min_u32 v6, 1, v3
    v_lshl_add_u32 v6, v6, 2, v4
    v_lshlrev_b32 v6, 4, v6
    s_lshr_b32 s55, s52, 2
    s_add_u32 s55, s55, s3
    s_and_b32 s55, s55, 3
    s_and_b32 s54, s52, 3
    s_cmp_eq_u32 s54, s55
    s_mov_b32 s56, 255
    s_cselect_b32 s56, 16777215, s56
    s_mov_b32 s57, 0
    s_cbranch_scc0 L_cclr
    buffer_store_dwordx4 v[20:23], v2, s[44:47], s58 offen offset:2048 sc1
    buffer_store_dwordx4 v[20:23], v2, s[44:47], s58 offen offset:3072 sc1
    buffer_store_dwordx4 v[20:23], v2, s[44:47], s59 offen offset:0 sc1
    buffer_store_dwordx4 v[20:23], v2, s[44:47], s59 offen offset:1024 sc1
    s_lshl_b32 s55, s52, 2
    s_add_u32 s55, s55, s3
    s_lshl_b32 s55, s55, 7
    s_add_u32 s55, s55, 5373952
    v_mov_b32 v5, 0
    s_mov_b64 exec, 1
    buffer_store_dword v5, v5, s[44:47], s55 offen sc1
    s_lshl_b32 s55, s53, 8
    s_add_u32 s55, s55, 3145728
    s_mov_b64 exec, 0xffff
    buffer_store_dwordx4 v[20:23], v2, s[44:47], s55 offen sc1
    s_mov_b64 exec, -1
L_cclr:
    buffer_store_dwordx4 v[20:23], v2, s[44:47], s58 offen offset:0 sc1
    buffer_store_dwordx4 v[20:23], v2, s[44:47], s58 offen offset:1024 sc1
    s_mov_b64 exec, s[56:57]
    buffer_store_dwordx4 v[20:23], v2, s[44:47], s59 offen offset:2048 sc1
    s_mov_b64 exec, -1
    s_mov_b32 s40, s10
    s_mov_b32 s41, s11
    s_mov_b32 s42, 4718592
    s_mov_b32 s43, 0x20000
    s_mov_b32 s48, s4
    s_mov_b32 s49, s5
    s_mov_b32 s50, 4608
    s_mov_b32 s51, 0x20000
    s_mov_b32 s32, s16
    s_mov_b32 s33, s17
    s_mov_b32 s34, 16777216
    s_mov_b32 s35, 0x20000
    v_lshrrev_b32 v5, 3, v3
    v_mul_u32_u24 v5, 1152, v5
    v_mul_u32_u24 v6, 36, v4
    v_add_u32 v5, v5, v6
    s_mul_i32 s54, s3, 144
    s_add_u32 s54, s54, 576
    buffer_load_dwordx4 v[48:51], v5, s[48:51], s54 offen offset:0
    buffer_load_dwordx4 v[52:55], v5, s[48:51], s54 offen offset:16
    buffer_load_dword v56, v5, s[48:51], s54 offen offset:32
    buffer_load_dwordx4 v[60:63], v5, s[48:51], s54 offen offset:2304
    buffer_load_dwordx4 v[64:67], v5, s[48:51], s54 offen offset:2320
    buffer_load_dword v68, v5, s[48:51], s54 offen offset:2336
    v_mul_u32_u24 v120, 147456, v4
    v_lshl_add_u32 v120, v3, 4, v120
    s_mul_i32 s61, s3, 589824
    s_lshl_b32 s54, s52, 8
    s_add_u32 s61, s61, s54
    s_add_u32 s61, s61, 2359296
    buffer_load_dwordx4 a[0:3], v120, s[40:43], s61 offen nt
    s_add_u32 s61, s61, 8192
    buffer_load_dwordx4 a[4:7], v120, s[40:43], s61 offen nt
    s_add_u32 s61, s61, 8192
    buffer_load_dwordx4 a[8:11], v120, s[40:43], s61 offen nt
    s_add_u32 s61, s61, 8192
    buffer_load_dwordx4 a[12:15], v120, s[40:43], s61 offen nt
    s_add_u32 s61, s61, 8192
    buffer_load_dwordx4 a[16:19], v120, s[40:43], s61 offen nt
    s_add_u32 s61, s61, 8192
    buffer_load_dwordx4 a[20:23], v120, s[40:43], s61 offen nt
    s_add_u32 s61, s61, 8192
    buffer_load_dwordx4 a[24:27], v120, s[40:43], s61 offen nt
    s_add_u32 s61, s61, 8192
    buffer_load_dwordx4 a[28:31], v120, s[40:43], s61 offen nt
    s_add_u32 s61, s61, 8192
    buffer_load_dwordx4 a[32:35], v120, s[40:43], s61 offen nt
    s_add_u32 s61, s61, 8192
    buffer_load_dwordx4 a[36:39], v120, s[40:43], s61 offen nt
    s_add_u32 s61, s61, 8192
    buffer_load_dwordx4 a[40:43], v120, s[40:43], s61 offen nt
    s_add_u32 s61, s61, 8192
    buffer_load_dwordx4 a[44:47], v120, s[40:43], s61 offen nt
    s_add_u32 s61, s61, 8192
    buffer_load_dwordx4 a[48:51], v120, s[40:43], s61 offen nt
    s_add_u32 s61, s61, 8192
    buffer_load_dwordx4 a[52:55], v120, s[40:43], s61 offen nt
    s_add_u32 s61, s61, 8192
    buffer_load_dwordx4 a[56:59], v120, s[40:43], s61 offen nt
    s_add_u32 s61, s61, 8192
    buffer_load_dwordx4 a[60:63], v120, s[40:43], s61 offen nt
    s_add_u32 s61, s61, 8192
    buffer_load_dwordx4 a[64:67], v120, s[40:43], s61 offen nt
    s_add_u32 s61, s61, 8192
    buffer_load_dwordx4 a[68:71], v120, s[40:43], s61 offen nt
    s_add_u32 s61, s61, 8192
    v_and_b32 v5, 1, v3
    v_cmp_eq_u32 vcc, 1, v5
    v_mov_b32 v5, 0x0c0c0100
    v_mov_b32 v6, 0x01000c0c
    v_cndmask_b32 v5, v5, v6, vcc
    v_mov_b32 v6, 0x0c0c0302
    v_mov_b32 v7, 0x03020c0c
    v_cndmask_b32 v6, v6, v7, vcc
    v_bfe_u32 v7, v3, 1, 2
    v_mov_b32 v16, 0x0c0c0c0c
    v_cmp_eq_u32 vcc, 0, v7
    s_nop 1
    v_cndmask_b32 v8, v16, v5, vcc
    v_cndmask_b32 v9, v16, v6, vcc
    v_cmp_eq_u32 vcc, 1, v7
    s_nop 1
    v_cndmask_b32 v10, v16, v5, vcc
    v_cndmask_b32 v11, v16, v6, vcc
    v_cmp_eq_u32 vcc, 2, v7
    s_nop 1
    v_cndmask_b32 v12, v16, v5, vcc
    v_cndmask_b32 v13, v16, v6, vcc
    v_cmp_eq_u32 vcc, 3, v7
    s_nop 1
    v_cndmask_b32 v14, v16, v5, vcc
    v_cndmask_b32 v15, v16, v6, vcc
    s_waitcnt vmcnt(24)
    s_barrier
    s_cmp_lg_u32 s3, 0
    s_cbranch_scc1 L_nosig_22
    s_lshl_b32 s54, s52, 2
    v_mov_b32 v5, s54
    v_mov_b32 v6, 1
    s_mov_b64 exec, 1
    global_atomic_add v5, v6, s[28:29]
    s_mov_b64 exec, -1
L_nosig_22:
    v_lshlrev_b32 v5, 2, v4
    v_xor_b32 v5, v5, v3
    v_lshlrev_b32 v6, 10, v4
    v_xor_b32 v7, 0, v5
    v_lshl_add_u32 v20, v7, 4, v6
    v_xor_b32 v7, 1, v5
    v_lshl_add_u32 v21, v7, 4, v6
    v_add_u32 v21, 4096, v21
    v_xor_b32 v7, 2, v5
    v_lshl_add_u32 v22, v7, 4, v6
    v_add_u32 v22, 8192, v22
    v_xor_b32 v7, 3, v5
    v_lshl_add_u32 v23, v7, 4, v6
    v_add_u32 v23, 12288, v23
    s_lshl_b32 s58, s53, 19
    s_lshl_b32 s54, s3, 8
    s_add_u32 s58, s58, s54
    s_lshl_b32 s63, s3, 15
    s_mov_b32 s59, s63
    s_add_u32 m0, s59, 0
    s_add_u32 s54, s58, 0
    buffer_load_dwordx4 v20, s[32:35], s54 offen nt lds
    s_add_u32 m0, s59, 1024
    s_add_u32 s54, s58, 0
    buffer_load_dwordx4 v21, s[32:35], s54 offen nt lds
    s_add_u32 m0, s59, 2048
    s_add_u32 s54, s58, 0
    buffer_load_dwordx4 v22, s[32:35], s54 offen nt lds
    s_add_u32 m0, s59, 3072
    s_add_u32 s54, s58, 0
    buffer_load_dwordx4 v23, s[32:35], s54 offen nt lds
    s_add_u32 m0, s59, 4096
    s_add_u32 s54, s58, 16384
    buffer_load_dwordx4 v20, s[32:35], s54 offen nt lds
    s_add_u32 m0, s59, 5120
    s_add_u32 s54, s58, 16384
    buffer_load_dwordx4 v21, s[32:35], s54 offen nt lds
    s_add_u32 m0, s59, 6144
    s_add_u32 s54, s58, 16384
    buffer_load_dwordx4 v22, s[32:35], s54 offen nt lds
    s_add_u32 m0, s59, 7168
    s_add_u32 s54, s58, 16384
    buffer_load_dwordx4 v23, s[32:35], s54 offen nt lds
    s_add_u32 s58, s58, 32768
    s_add_u32 s59, s59, 8192
    s_waitcnt vmcnt(17)
    v_perm_b32 v96, v48, v48, v8
    v_perm_b32 v97, v48, v48, v10
    v_perm_b32 v98, v48, v48, v12
    v_perm_b32 v99, v48, v48, v14
    s_nop 1
    v_mfma_f32_16x16x32_bf16 v[112:115], v[96:99], a[0:3], 0
    v_perm_b32 v100, v60, v60, v8
    v_perm_b32 v101, v60, v60, v10
    v_perm_b32 v102, v60, v60, v12
    v_perm_b32 v103, v60, v60, v14
    s_nop 1
    v_mfma_f32_16x16x32_bf16 v[116:119], v[100:103], a[0:3], 0
    v_perm_b32 v104, v48, v48, v9
    v_perm_b32 v105, v48, v48, v11
    v_perm_b32 v106, v48, v48, v13
    v_perm_b32 v107, v48, v48, v15
    s_nop 1
    v_mfma_f32_16x16x32_bf16 v[112:115], v[104:107], a[4:7], v[112:115]
    v_perm_b32 v108, v60, v60, v9
    v_perm_b32 v109, v60, v60, v11
    v_perm_b32 v110, v60, v60, v13
    v_perm_b32 v111, v60, v60, v15
    s_nop 1
    v_mfma_f32_16x16x32_bf16 v[116:119], v[108:111], a[4:7], v[116:119]
    v_perm_b32 v96, v49, v49, v8
    v_perm_b32 v97, v49, v49, v10
    v_perm_b32 v98, v49, v49, v12
    v_perm_b32 v99, v49, v49, v14
    s_nop 1
    v_mfma_f32_16x16x32_bf16 v[112:115], v[96:99], a[8:11], v[112:115]
    v_perm_b32 v100, v61, v61, v8
    v_perm_b32 v101, v61, v61, v10
    v_perm_b32 v102, v61, v61, v12
    v_perm_b32 v103, v61, v61, v14
    s_nop 1
    v_mfma_f32_16x16x32_bf16 v[116:119], v[100:103], a[8:11], v[116:119]
    v_perm_b32 v104, v49, v49, v9
    v_perm_b32 v105, v49, v49, v11
    v_perm_b32 v106, v49, v49, v13
    v_perm_b32 v107, v49, v49, v15
    s_nop 1
    v_mfma_f32_16x16x32_bf16 v[112:115], v[104:107], a[12:15], v[112:115]
    v_perm_b32 v108, v61, v61, v9
    v_perm_b32 v109, v61, v61, v11
    v_perm_b32 v110, v61, v61, v13
    v_perm_b32 v111, v61, v61, v15
    s_nop 1
    v_mfma_f32_16x16x32_bf16 v[116:119], v[108:111], a[12:15], v[116:119]
    v_perm_b32 v96, v50, v50, v8
    v_perm_b32 v97, v50, v50, v10
    v_perm_b32 v98, v50, v50, v12
    v_perm_b32 v99, v50, v50, v14
    s_nop 1
    v_mfma_f32_16x16x32_bf16 v[112:115], v[96:99], a[16:19], v[112:115]
    v_perm_b32 v100, v62, v62, v8
    v_perm_b32 v101, v62, v62, v10
    v_perm_b32 v102, v62, v62, v12
    v_perm_b32 v103, v62, v62, v14
    s_nop 1
    v_mfma_f32_16x16x32_bf16 v[116:119], v[100:103], a[16:19], v[116:119]
    v_perm_b32 v104, v50, v50, v9
    v_perm_b32 v105, v50, v50, v11
    v_perm_b32 v106, v50, v50, v13
    v_perm_b32 v107, v50, v50, v15
    s_nop 1
    v_mfma_f32_16x16x32_bf16 v[112:115], v[104:107], a[20:23], v[112:115]
    v_perm_b32 v108, v62, v62, v9
    v_perm_b32 v109, v62, v62, v11
    v_perm_b32 v110, v62, v62, v13
    v_perm_b32 v111, v62, v62, v15
    s_nop 1
    v_mfma_f32_16x16x32_bf16 v[116:119], v[108:111], a[20:23], v[116:119]
    v_perm_b32 v96, v51, v51, v8
    v_perm_b32 v97, v51, v51, v10
    v_perm_b32 v98, v51, v51, v12
    v_perm_b32 v99, v51, v51, v14
    s_nop 1
    v_mfma_f32_16x16x32_bf16 v[112:115], v[96:99], a[24:27], v[112:115]
    v_perm_b32 v100, v63, v63, v8
    v_perm_b32 v101, v63, v63, v10
    v_perm_b32 v102, v63, v63, v12
    v_perm_b32 v103, v63, v63, v14
    s_nop 1
    v_mfma_f32_16x16x32_bf16 v[116:119], v[100:103], a[24:27], v[116:119]
    v_perm_b32 v104, v51, v51, v9
    v_perm_b32 v105, v51, v51, v11
    v_perm_b32 v106, v51, v51, v13
    v_perm_b32 v107, v51, v51, v15
    s_nop 1
    v_mfma_f32_16x16x32_bf16 v[112:115], v[104:107], a[28:31], v[112:115]
    v_perm_b32 v108, v63, v63, v9
    v_perm_b32 v109, v63, v63, v11
    v_perm_b32 v110, v63, v63, v13
    v_perm_b32 v111, v63, v63, v15
    s_nop 1
    v_mfma_f32_16x16x32_bf16 v[116:119], v[108:111], a[28:31], v[116:119]
    v_perm_b32 v96, v52, v52, v8
    v_perm_b32 v97, v52, v52, v10
    v_perm_b32 v98, v52, v52, v12
    v_perm_b32 v99, v52, v52, v14
    s_nop 1
    v_mfma_f32_16x16x32_bf16 v[112:115], v[96:99], a[32:35], v[112:115]
    v_perm_b32 v100, v64, v64, v8
    v_perm_b32 v101, v64, v64, v10
    v_perm_b32 v102, v64, v64, v12
    v_perm_b32 v103, v64, v64, v14
    s_nop 1
    v_mfma_f32_16x16x32_bf16 v[116:119], v[100:103], a[32:35], v[116:119]
    s_waitcnt vmcnt(8)
    v_perm_b32 v104, v52, v52, v9
    v_perm_b32 v105, v52, v52, v11
    v_perm_b32 v106, v52, v52, v13
    v_perm_b32 v107, v52, v52, v15
    s_nop 1
    v_mfma_f32_16x16x32_bf16 v[112:115], v[104:107], a[36:39], v[112:115]
    v_perm_b32 v108, v64, v64, v9
    v_perm_b32 v109, v64, v64, v11
    v_perm_b32 v110, v64, v64, v13
    v_perm_b32 v111, v64, v64, v15
    s_nop 1
    v_mfma_f32_16x16x32_bf16 v[116:119], v[108:111], a[36:39], v[116:119]
    v_perm_b32 v96, v53, v53, v8
    v_perm_b32 v97, v53, v53, v10
    v_perm_b32 v98, v53, v53, v12
    v_perm_b32 v99, v53, v53, v14
    s_nop 1
    v_mfma_f32_16x16x32_bf16 v[112:115], v[96:99], a[40:43], v[112:115]
    v_perm_b32 v100, v65, v65, v8
    v_perm_b32 v101, v65, v65, v10
    v_perm_b32 v102, v65, v65, v12
    v_perm_b32 v103, v65, v65, v14
    s_nop 1
    v_mfma_f32_16x16x32_bf16 v[116:119], v[100:103], a[40:43], v[116:119]
    v_perm_b32 v104, v53, v53, v9
    v_perm_b32 v105, v53, v53, v11
    v_perm_b32 v106, v53, v53, v13
    v_perm_b32 v107, v53, v53, v15
    s_nop 1
    v_mfma_f32_16x16x32_bf16 v[112:115], v[104:107], a[44:47], v[112:115]
    v_perm_b32 v108, v65, v65, v9
    v_perm_b32 v109, v65, v65, v11
    v_perm_b32 v110, v65, v65, v13
    v_perm_b32 v111, v65, v65, v15
    s_nop 1
    v_mfma_f32_16x16x32_bf16 v[116:119], v[108:111], a[44:47], v[116:119]
    v_perm_b32 v96, v54, v54, v8
    v_perm_b32 v97, v54, v54, v10
    v_perm_b32 v98, v54, v54, v12
    v_perm_b32 v99, v54, v54, v14
    s_nop 1
    v_mfma_f32_16x16x32_bf16 v[112:115], v[96:99], a[48:51], v[112:115]
    v_perm_b32 v100, v66, v66, v8
    v_perm_b32 v101, v66, v66, v10
    v_perm_b32 v102, v66, v66, v12
    v_perm_b32 v103, v66, v66, v14
    s_nop 1
    v_mfma_f32_16x16x32_bf16 v[116:119], v[100:103], a[48:51], v[116:119]
    v_perm_b32 v104, v54, v54, v9
    v_perm_b32 v105, v54, v54, v11
    v_perm_b32 v106, v54, v54, v13
    v_perm_b32 v107, v54, v54, v15
    s_nop 1
    v_mfma_f32_16x16x32_bf16 v[112:115], v[104:107], a[52:55], v[112:115]
    v_perm_b32 v108, v66, v66, v9
    v_perm_b32 v109, v66, v66, v11
    v_perm_b32 v110, v66, v66, v13
    v_perm_b32 v111, v66, v66, v15
    s_nop 1
    v_mfma_f32_16x16x32_bf16 v[116:119], v[108:111], a[52:55], v[116:119]
    v_perm_b32 v96, v55, v55, v8
    v_perm_b32 v97, v55, v55, v10
    v_perm_b32 v98, v55, v55, v12
    v_perm_b32 v99, v55, v55, v14
    s_nop 1
    v_mfma_f32_16x16x32_bf16 v[112:115], v[96:99], a[56:59], v[112:115]
    v_perm_b32 v100, v67, v67, v8
    v_perm_b32 v101, v67, v67, v10
    v_perm_b32 v102, v67, v67, v12
    v_perm_b32 v103, v67, v67, v14
    s_nop 1
    v_mfma_f32_16x16x32_bf16 v[116:119], v[100:103], a[56:59], v[116:119]
    v_perm_b32 v104, v55, v55, v9
    v_perm_b32 v105, v55, v55, v11
    v_perm_b32 v106, v55, v55, v13
    v_perm_b32 v107, v55, v55, v15
    s_nop 1
    v_mfma_f32_16x16x32_bf16 v[112:115], v[104:107], a[60:63], v[112:115]
    v_perm_b32 v108, v67, v67, v9
    v_perm_b32 v109, v67, v67, v11
    v_perm_b32 v110, v67, v67, v13
    v_perm_b32 v111, v67, v67, v15
    s_nop 1
    v_mfma_f32_16x16x32_bf16 v[116:119], v[108:111], a[60:63], v[116:119]
    v_perm_b32 v96, v56, v56, v8
    v_perm_b32 v97, v56, v56, v10
    v_perm_b32 v98, v56, v56, v12
    v_perm_b32 v99, v56, v56, v14
    s_nop 1
    v_mfma_f32_16x16x32_bf16 v[112:115], v[96:99], a[64:67], v[112:115]
    v_perm_b32 v100, v68, v68, v8
    v_perm_b32 v101, v68, v68, v10
    v_perm_b32 v102, v68, v68, v12
    v_perm_b32 v103, v68, v68, v14
    s_nop 1
    v_mfma_f32_16x16x32_bf16 v[116:119], v[100:103], a[64:67], v[116:119]
    v_perm_b32 v104, v56, v56, v9
    v_perm_b32 v105, v56, v56, v11
    v_perm_b32 v106, v56, v56, v13
    v_perm_b32 v107, v56, v56, v15
    s_nop 1
    v_mfma_f32_16x16x32_bf16 v[112:115], v[104:107], a[68:71], v[112:115]
    v_perm_b32 v108, v68, v68, v9
    v_perm_b32 v109, v68, v68, v11
    v_perm_b32 v110, v68, v68, v13
    v_perm_b32 v111, v68, v68, v15
    s_nop 1
    v_mfma_f32_16x16x32_bf16 v[116:119], v[108:111], a[68:71], v[116:119]
    v_lshrrev_b32 v5, 1, v4
    v_lshlrev_b32 v5, 9, v5
    v_lshl_add_u32 v5, v3, 5, v5
    v_and_b32 v6, 1, v4
    v_lshl_add_u32 v5, v6, 4, v5
    s_lshl_b32 s54, s3, 11
    s_add_u32 s54, s54, 139264
    v_add_u32 v5, s54, v5
    ds_write_b128 v5, v[112:115]
    ds_write_b128 v5, v[116:119] offset:1024
    s_waitcnt lgkmcnt(0)
    s_barrier
    s_lshl_b32 s54, s3, 9
    s_add_u32 s54, s54, 139264
    v_add_u32 v5, s54, v2
    ds_read_b128 v[96:99], v5 offset:0
    ds_read_b128 v[100:103], v5 offset:2048
    ds_read_b128 v[104:107], v5 offset:4096
    ds_read_b128 v[108:111], v5 offset:6144
    s_waitcnt lgkmcnt(0)
    v_add_f32 v96, v96, v100
    v_add_f32 v104, v104, v108
    v_add_f32 v97, v97, v101
    v_add_f32 v105, v105, v109
    v_add_f32 v98, v98, v102
    v_add_f32 v106, v106, v110
    v_add_f32 v99, v99, v103
    v_add_f32 v107, v107, v111
    v_add_f32 v96, v96, v104
    v_add_f32 v97, v97, v105
    v_add_f32 v98, v98, v106
    v_add_f32 v99, v99, v107
    v_min_u32 v124, -2, v96
    v_min_u32 v125, -2, v97
    v_min_u32 v126, -2, v98
    v_min_u32 v127, -2, v99
    buffer_store_dwordx4 v[124:127], v123, s[44:47], s98 offen sc1
    s_add_u32 m0, s59, 0
    s_add_u32 s54, s58, 0
    buffer_load_dwordx4 v20, s[32:35], s54 offen nt lds
    s_add_u32 m0, s59, 1024
    s_add_u32 s54, s58, 0
    buffer_load_dwordx4 v21, s[32:35], s54 offen nt lds
    s_add_u32 m0, s59, 2048
    s_add_u32 s54, s58, 0
    buffer_load_dwordx4 v22, s[32:35], s54 offen nt lds
    s_add_u32 m0, s59, 3072
    s_add_u32 s54, s58, 0
    buffer_load_dwordx4 v23, s[32:35], s54 offen nt lds
    s_add_u32 m0, s59, 4096
    s_add_u32 s54, s58, 16384
    buffer_load_dwordx4 v20, s[32:35], s54 offen nt lds
    s_add_u32 m0, s59, 5120
    s_add_u32 s54, s58, 16384
    buffer_load_dwordx4 v21, s[32:35], s54 offen nt lds
    s_add_u32 m0, s59, 6144
    s_add_u32 s54, s58, 16384
    buffer_load_dwordx4 v22, s[32:35], s54 offen nt lds
    s_add_u32 m0, s59, 7168
    s_add_u32 s54, s58, 16384
    buffer_load_dwordx4 v23, s[32:35], s54 offen nt lds
    s_add_u32 s58, s58, 32768
    s_add_u32 s59, s59, 8192
    s_add_u32 m0, s59, 0
    s_add_u32 s54, s58, 0
    buffer_load_dwordx4 v20, s[32:35], s54 offen nt lds
    s_add_u32 m0, s59, 1024
    s_add_u32 s54, s58, 0
    buffer_load_dwordx4 v21, s[32:35], s54 offen nt lds
    s_add_u32 m0, s59, 2048
    s_add_u32 s54, s58, 0
    buffer_load_dwordx4 v22, s[32:35], s54 offen nt lds
    s_add_u32 m0, s59, 3072
    s_add_u32 s54, s58, 0
    buffer_load_dwordx4 v23, s[32:35], s54 offen nt lds
    s_add_u32 m0, s59, 4096
    s_add_u32 s54, s58, 16384
    buffer_load_dwordx4 v20, s[32:35], s54 offen nt lds
    s_add_u32 m0, s59, 5120
    s_add_u32 s54, s58, 16384
    buffer_load_dwordx4 v21, s[32:35], s54 offen nt lds
    s_add_u32 m0, s59, 6144
    s_add_u32 s54, s58, 16384
    buffer_load_dwordx4 v22, s[32:35], s54 offen nt lds
    s_add_u32 m0, s59, 7168
    s_add_u32 s54, s58, 16384
    buffer_load_dwordx4 v23, s[32:35], s54 offen nt lds
    s_add_u32 s58, s58, 32768
    s_add_u32 s59, s59, 8192
    s_add_u32 m0, s59, 0
    s_add_u32 s54, s58, 0
    buffer_load_dwordx4 v20, s[32:35], s54 offen nt lds
    s_add_u32 m0, s59, 1024
    s_add_u32 s54, s58, 0
    buffer_load_dwordx4 v21, s[32:35], s54 offen nt lds
    s_add_u32 m0, s59, 2048
    s_add_u32 s54, s58, 0
    buffer_load_dwordx4 v22, s[32:35], s54 offen nt lds
    s_add_u32 m0, s59, 3072
    s_add_u32 s54, s58, 0
    buffer_load_dwordx4 v23, s[32:35], s54 offen nt lds
    s_add_u32 m0, s59, 4096
    s_add_u32 s54, s58, 16384
    buffer_load_dwordx4 v20, s[32:35], s54 offen nt lds
    s_add_u32 m0, s59, 5120
    s_add_u32 s54, s58, 16384
    buffer_load_dwordx4 v21, s[32:35], s54 offen nt lds
    s_add_u32 m0, s59, 6144
    s_add_u32 s54, s58, 16384
    buffer_load_dwordx4 v22, s[32:35], s54 offen nt lds
    s_add_u32 m0, s59, 7168
    s_add_u32 s54, s58, 16384
    buffer_load_dwordx4 v23, s[32:35], s54 offen nt lds
    s_add_u32 s58, s58, 32768
    s_add_u32 s59, s59, 8192
    s_waitcnt vmcnt(40)
    buffer_load_dwordx4 a[96:99], v20, s[32:35], s58 offen nt
    buffer_load_dwordx4 a[100:103], v21, s[32:35], s58 offen nt
    buffer_load_dwordx4 a[104:107], v22, s[32:35], s58 offen nt
    buffer_load_dwordx4 a[108:111], v23, s[32:35], s58 offen nt
    s_add_u32 s58, s58, 16384
    buffer_load_dwordx4 a[112:115], v20, s[32:35], s58 offen nt
    buffer_load_dwordx4 a[116:119], v21, s[32:35], s58 offen nt
    buffer_load_dwordx4 a[120:123], v22, s[32:35], s58 offen nt
    buffer_load_dwordx4 a[124:127], v23, s[32:35], s58 offen nt
    s_add_u32 s58, s58, 16384
    s_waitcnt vmcnt(40)
    buffer_load_dwordx4 a[128:131], v20, s[32:35], s58 offen nt
    buffer_load_dwordx4 a[132:135], v21, s[32:35], s58 offen nt
    buffer_load_dwordx4 a[136:139], v22, s[32:35], s58 offen nt
    buffer_load_dwordx4 a[140:143], v23, s[32:35], s58 offen nt
    s_add_u32 s58, s58, 16384
    buffer_load_dwordx4 a[144:147], v20, s[32:35], s58 offen nt
    buffer_load_dwordx4 a[148:151], v21, s[32:35], s58 offen nt
    buffer_load_dwordx4 a[152:155], v22, s[32:35], s58 offen nt
    buffer_load_dwordx4 a[156:159], v23, s[32:35], s58 offen nt
    s_add_u32 s58, s58, 16384
    s_waitcnt vmcnt(40)
    buffer_load_dwordx4 a[160:163], v20, s[32:35], s58 offen nt
    buffer_load_dwordx4 a[164:167], v21, s[32:35], s58 offen nt
    buffer_load_dwordx4 a[168:171], v22, s[32:35], s58 offen nt
    buffer_load_dwordx4 a[172:175], v23, s[32:35], s58 offen nt
    s_add_u32 s58, s58, 16384
    buffer_load_dwordx4 a[176:179], v20, s[32:35], s58 offen nt
    buffer_load_dwordx4 a[180:183], v21, s[32:35], s58 offen nt
    buffer_load_dwordx4 a[184:187], v22, s[32:35], s58 offen nt
    buffer_load_dwordx4 a[188:191], v23, s[32:35], s58 offen nt
    s_add_u32 s58, s58, 16384
    s_waitcnt vmcnt(40)
    buffer_load_dwordx4 a[192:195], v20, s[32:35], s58 offen nt
    buffer_load_dwordx4 a[196:199], v21, s[32:35], s58 offen nt
    buffer_load_dwordx4 a[200:203], v22, s[32:35], s58 offen nt
    buffer_load_dwordx4 a[204:207], v23, s[32:35], s58 offen nt
    s_add_u32 s58, s58, 16384
    buffer_load_dwordx4 a[208:211], v20, s[32:35], s58 offen nt
    buffer_load_dwordx4 a[212:215], v21, s[32:35], s58 offen nt
    buffer_load_dwordx4 a[216:219], v22, s[32:35], s58 offen nt
    buffer_load_dwordx4 a[220:223], v23, s[32:35], s58 offen nt
    s_add_u32 s58, s58, 16384
    s_waitcnt vmcnt(40)
    v_and_b32 v27, 31, v1
    v_lshlrev_b32 v27, 2, v27
    global_load_dword v18, v27, s[28:29] sc1
    buffer_load_dwordx4 a[224:227], v20, s[32:35], s58 offen nt
    buffer_load_dwordx4 a[228:231], v21, s[32:35], s58 offen nt
    buffer_load_dwordx4 a[232:235], v22, s[32:35], s58 offen nt
    buffer_load_dwordx4 a[236:239], v23, s[32:35], s58 offen nt
    s_add_u32 s58, s58, 16384
    buffer_load_dwordx4 a[240:243], v20, s[32:35], s58 offen nt
    buffer_load_dwordx4 a[244:247], v21, s[32:35], s58 offen nt
    buffer_load_dwordx4 a[248:251], v22, s[32:35], s58 offen nt
    buffer_load_dwordx4 a[252:255], v23, s[32:35], s58 offen nt
    s_add_u32 s58, s58, 16384
    s_waitcnt vmcnt(40)
    buffer_load_dwordx4 v[224:227], v20, s[32:35], s58 offen nt
    buffer_load_dwordx4 v[228:231], v21, s[32:35], s58 offen nt
    buffer_load_dwordx4 v[232:235], v22, s[32:35], s58 offen nt
    buffer_load_dwordx4 v[236:239], v23, s[32:35], s58 offen nt
    s_add_u32 s58, s58, 16384
    buffer_load_dwordx4 v[240:243], v20, s[32:35], s58 offen nt
    buffer_load_dwordx4 v[244:247], v21, s[32:35], s58 offen nt
    buffer_load_dwordx4 v[248:251], v22, s[32:35], s58 offen nt
    buffer_load_dwordx4 v[252:255], v23, s[32:35], s58 offen nt
    s_add_u32 s58, s58, 16384
    s_mov_b32 s36, s12
    s_mov_b32 s37, s13
    s_mov_b32 s38, 4718592
    s_mov_b32 s39, 0x20000
    v_mul_u32_u24 v49, 9216, v4
    v_lshl_add_u32 v48, v3, 4, v49
    v_lshl_add_u32 v49, v3, 2, v49
    s_mul_i32 s100, s52, 147456
    s_lshl_b32 s54, s3, 8
    s_add_u32 s99, s100, s54
    s_and_b32 s54, s3, 1
    s_lshl_b32 s54, s54, 6
    s_add_u32 s100, s100, s54
    s_add_u32 s100, s100, 1024
    v_add_u32 v26, s63, v2
    v_and_b32 v24, 31, v1
    v_lshrrev_b32 v25, 5, v1
    v_lshlrev_b32 v19, 10, v24
    v_lshl_add_u32 v19, v25, 4, v19
    s_lshr_b32 s96, s53, 3
    s_lshl_b32 s96, s96, 15
    s_lshl_b32 s55, s3, 8
    s_add_u32 s96, s96, s55
    s_add_u32 s96, s96, 1048576
    v_and_b32 v5, 3, v24
    v_lshlrev_b32 v5, 2, v5
    v_bfe_u32 v6, v24, 2, 2
    v_or_b32 v5, v5, v6
    v_xor_b32 v5, v5, v25
    v_lshlrev_b32 v32, 8, v24
    v_lshl_add_u32 v32, v5, 4, v32
    v_add_u32 v32, s63, v32
    v_bfe_u32 v5, v1, 2, 2
    v_lshl_add_u32 v6, v25, 2, v5
    v_lshlrev_b32 v40, 8, v6
    v_and_b32 v6, 1, v1
    v_lshl_add_u32 v40, v6, 3, v40
    v_bfe_u32 v6, v1, 4, 1
    v_lshlrev_b32 v6, 1, v6
    v_bfe_u32 v7, v1, 1, 1
    v_or_b32 v6, v6, v7
    v_xor_b32 v6, v6, v25
    v_lshl_or_b32 v6, v5, 2, v6
    v_lshl_add_u32 v40, v6, 4, v40
    v_add_u32 v40, s63, v40
    v_xor_b32 v33, 32, v32
    v_xor_b32 v41, 32, v40
    v_xor_b32 v34, 64, v32
    v_xor_b32 v42, 64, v40
    v_xor_b32 v35, 96, v32
    v_xor_b32 v43, 96, v40
    v_xor_b32 v36, 128, v32
    v_xor_b32 v44, 128, v40
    v_xor_b32 v37, 160, v32
    v_xor_b32 v45, 160, v40
    v_xor_b32 v38, 192, v32
    v_xor_b32 v46, 192, v40
    v_xor_b32 v39, 224, v32
    v_xor_b32 v47, 224, v40
    s_lshl_b32 s54, s3, 12
    s_add_u32 s54, s54, 131072
    v_add_u32 v28, s54, v2
    v_xor_b32 v29, 4096, v28
    v_xor_b32 v30, 8192, v28
    v_xor_b32 v31, 12288, v28
    v_mov_b32 v64, 0
    v_mov_b32 v65, 0
    v_mov_b32 v66, 0
    v_mov_b32 v67, 0
    v_mov_b32 v68, 0
    v_mov_b32 v69, 0
    v_mov_b32 v70, 0
    v_mov_b32 v71, 0
    v_mov_b32 v72, 0
    v_mov_b32 v73, 0
    v_mov_b32 v74, 0
    v_mov_b32 v75, 0
    v_mov_b32 v76, 0
    v_mov_b32 v77, 0
    v_mov_b32 v78, 0
    v_mov_b32 v79, 0
    v_mov_b32 v80, 0
    v_mov_b32 v81, 0
    v_mov_b32 v82, 0
    v_mov_b32 v83, 0
    v_mov_b32 v84, 0
    v_mov_b32 v85, 0
    v_mov_b32 v86, 0
    v_mov_b32 v87, 0
    v_mov_b32 v88, 0
    v_mov_b32 v89, 0
    v_mov_b32 v90, 0
    v_mov_b32 v91, 0
    v_mov_b32 v92, 0
    v_mov_b32 v93, 0
    v_mov_b32 v94, 0
    v_mov_b32 v95, 0
    v_mov_b32 v96, 0
    v_mov_b32 v97, 0
    v_mov_b32 v98, 0
    v_mov_b32 v99, 0
    v_mov_b32 v100, 0
    v_mov_b32 v101, 0
    v_mov_b32 v102, 0
    v_mov_b32 v103, 0
    v_mov_b32 v104, 0
    v_mov_b32 v105, 0
    v_mov_b32 v106, 0
    v_mov_b32 v107, 0
    v_mov_b32 v108, 0
    v_mov_b32 v109, 0
    v_mov_b32 v110, 0
    v_mov_b32 v111, 0
    v_mov_b32 v112, 0
    v_mov_b32 v113, 0
    v_mov_b32 v114, 0
    v_mov_b32 v115, 0
    v_mov_b32 v116, 0
    v_mov_b32 v117, 0
    v_mov_b32 v118, 0
    v_mov_b32 v119, 0
    v_mov_b32 v120, 0
    v_mov_b32 v121, 0
    v_mov_b32 v122, 0
    v_mov_b32 v123, 0
    v_mov_b32 v124, 0
    v_mov_b32 v125, 0
    v_mov_b32 v126, 0
    v_mov_b32 v127, 0
    v_mov_b32 v216, 0xff800000
    v_mov_b32 v217, 0
    s_waitcnt vmcnt(0)
L_flags_23:
    v_cmp_gt_u32 vcc, 2, v18
    s_cbranch_vccz L_flagsok_24
    s_sleep 2
    global_load_dword v18, v27, s[28:29] sc1
    s_waitcnt vmcnt(0)
    s_sub_u32 s101, s101, 1
    s_cbranch_scc0 L_flags_23
    s_mov_b32 s101, 0
L_flagsok_24:
    s_barrier
    ds_read_b128 a[32:35], v32 offset:0
    ds_read_b128 a[36:39], v33 offset:0
    ds_read_b128 a[40:43], v34 offset:0
    ds_read_b128 a[44:47], v35 offset:0
    ds_read_b128 a[48:51], v36 offset:0
    ds_read_b128 a[52:55], v37 offset:0
    ds_read_b128 a[56:59], v38 offset:0
    ds_read_b128 a[60:63], v39 offset:0
L_qpoll_25:
    buffer_load_dwordx4 v[128:131], v19, s[44:47], s96 offen offset:0 sc1
    buffer_load_dwordx4 v[132:135], v19, s[44:47], s96 offen offset:32 sc1
    buffer_load_dwordx4 v[136:139], v19, s[44:47], s96 offen offset:64 sc1
    buffer_load_dwordx4 v[140:143], v19, s[44:47], s96 offen offset:96 sc1
    buffer_load_dwordx4 v[144:147], v19, s[44:47], s96 offen offset:128 sc1
    buffer_load_dwordx4 v[148:151], v19, s[44:47], s96 offen offset:160 sc1
    buffer_load_dwordx4 v[152:155], v19, s[44:47], s96 offen offset:192 sc1
    buffer_load_dwordx4 v[156:159], v19, s[44:47], s96 offen offset:224 sc1
    s_waitcnt vmcnt(0)
    v_max3_u32 v5, v128, v129, v130
    v_max3_u32 v6, v144, v145, v146
    v_max3_u32 v5, v5, v131, v132
    v_max3_u32 v6, v6, v147, v148
    v_max3_u32 v5, v5, v133, v134
    v_max3_u32 v6, v6, v149, v150
    v_max3_u32 v5, v5, v135, v136
    v_max3_u32 v6, v6, v151, v152
    v_max3_u32 v5, v5, v137, v138
    v_max3_u32 v6, v6, v153, v154
    v_max3_u32 v5, v5, v139, v140
    v_max3_u32 v6, v6, v155, v156
    v_max3_u32 v5, v5, v141, v142
    v_max3_u32 v6, v6, v157, v158
    v_max3_u32 v5, v5, v143, v159
    v_max_u32 v5, v5, v6
    v_cmp_eq_u32 vcc, -1, v5
    s_nop 0
    s_mov_b64 exec, vcc
    s_cbranch_execz L_qok_26
    s_sub_u32 s101, s101, 1
    s_cbranch_scc0 L_qpoll_25
    s_mov_b32 s101, 0
L_qok_26:
    s_mov_b64 exec, -1
    v_accvgpr_write_b32 a0, v128
    v_accvgpr_write_b32 a1, v129
    v_accvgpr_write_b32 a2, v130
    v_accvgpr_write_b32 a3, v131
    v_accvgpr_write_b32 a4, v132
    v_accvgpr_write_b32 a5, v133
    v_accvgpr_write_b32 a6, v134
    v_accvgpr_write_b32 a7, v135
    v_accvgpr_write_b32 a8, v136
    v_accvgpr_write_b32 a9, v137
    v_accvgpr_write_b32 a10, v138
    v_accvgpr_write_b32 a11, v139
    v_accvgpr_write_b32 a12, v140
    v_accvgpr_write_b32 a13, v141
    v_accvgpr_write_b32 a14, v142
    v_accvgpr_write_b32 a15, v143
    v_accvgpr_write_b32 a16, v144
    v_accvgpr_write_b32 a17, v145
    v_accvgpr_write_b32 a18, v146
    v_accvgpr_write_b32 a19, v147
    v_accvgpr_write_b32 a20, v148
    v_accvgpr_write_b32 a21, v149
    v_accvgpr_write_b32 a22, v150
    v_accvgpr_write_b32 a23, v151
    v_accvgpr_write_b32 a24, v152
    v_accvgpr_write_b32 a25, v153
    v_accvgpr_write_b32 a26, v154
    v_accvgpr_write_b32 a27, v155
    v_accvgpr_write_b32 a28, v156
    v_accvgpr_write_b32 a29, v157
    v_accvgpr_write_b32 a30, v158
    v_accvgpr_write_b32 a31, v159
    s_waitcnt lgkmcnt(0)
    v_mfma_f32_32x32x16_bf16 v[128:143], a[32:35], a[0:3], 0
    v_mfma_f32_32x32x16_bf16 v[128:143], a[36:39], a[4:7], v[128:143]
    v_mfma_f32_32x32x16_bf16 v[128:143], a[40:43], a[8:11], v[128:143]
    v_mfma_f32_32x32x16_bf16 v[128:143], a[44:47], a[12:15], v[128:143]
    v_mfma_f32_32x32x16_bf16 v[128:143], a[48:51], a[16:19], v[128:143]
    v_mfma_f32_32x32x16_bf16 v[128:143], a[52:55], a[20:23], v[128:143]
    v_mfma_f32_32x32x16_bf16 v[128:143], a[56:59], a[24:27], v[128:143]
    v_mfma_f32_32x32x16_bf16 v[128:143], a[60:63], a[28:31], v[128:143]
    s_nop 11
    ds_write_b128 v28, v[128:131] offset:0
    ds_write_b128 v28, v[132:135] offset:1024
    ds_write_b128 v28, v[136:139] offset:2048
    ds_write_b128 v28, v[140:143] offset:3072
    s_waitcnt lgkmcnt(0)
    s_barrier
    ds_read_b128 v[144:147], v29 offset:0
    ds_read_b128 v[148:151], v29 offset:1024
    ds_read_b128 v[152:155], v29 offset:2048
    ds_read_b128 v[156:159], v29 offset:3072
    ds_read_b128 v[160:163], v30 offset:0
    ds_read_b128 v[164:167], v30 offset:1024
    ds_read_b128 v[168:171], v30 offset:2048
    ds_read_b128 v[172:175], v30 offset:3072
    ds_read_b128 v[176:179], v31 offset:0
    ds_read_b128 v[180:183], v31 offset:1024
    ds_read_b128 v[184:187], v31 offset:2048
    ds_read_b128 v[188:191], v31 offset:3072
    ds_read_b128 a[32:35], v32 offset:8192
    ds_read_b128 a[36:39], v33 offset:8192
    ds_read_b128 a[40:43], v34 offset:8192
    ds_read_b128 a[44:47], v35 offset:8192
    ds_read_b128 a[48:51], v36 offset:8192
    ds_read_b128 a[52:55], v37 offset:8192
    ds_read_b128 a[56:59], v38 offset:8192
    ds_read_b128 a[60:63], v39 offset:8192
    s_waitcnt lgkmcnt(8)
    v_add_f32 v144, v144, v128
    v_add_f32 v145, v145, v129
    v_add_f32 v146, v146, v130
    v_add_f32 v147, v147, v131
    v_add_f32 v148, v148, v132
    v_add_f32 v149, v149, v133
    v_add_f32 v150, v150, v134
    v_add_f32 v151, v151, v135
    v_add_f32 v152, v152, v136
    v_add_f32 v153, v153, v137
    v_add_f32 v154, v154, v138
    v_add_f32 v155, v155, v139
    v_add_f32 v156, v156, v140
    v_add_f32 v157, v157, v141
    v_add_f32 v158, v158, v142
    v_add_f32 v159, v159, v143
    s_waitcnt lgkmcnt(0)
    v_mfma_f32_32x32x16_bf16 v[128:143], a[32:35], a[0:3], 0
    ds_read_b64_tr_b16 a[64:65], v40 offset:0
    ds_read_b64_tr_b16 a[66:67], v41 offset:2048
    v_add_f32 v160, v160, v176
    v_add_f32 v161, v161, v177
    v_add_f32 v162, v162, v178
    v_add_f32 v163, v163, v179
    v_add_f32 v164, v164, v180
    v_mfma_f32_32x32x16_bf16 v[128:143], a[36:39], a[4:7], v[128:143]
    ds_read_b64_tr_b16 a[72:73], v42 offset:0
    ds_read_b64_tr_b16 a[74:75], v43 offset:2048
    v_add_f32 v165, v165, v181
    v_add_f32 v166, v166, v182
    v_add_f32 v167, v167, v183
    v_add_f32 v168, v168, v184
    v_add_f32 v169, v169, v185
    v_mfma_f32_32x32x16_bf16 v[128:143], a[40:43], a[8:11], v[128:143]
    ds_read_b64_tr_b16 a[80:81], v44 offset:0
    ds_read_b64_tr_b16 a[82:83], v45 offset:2048
    v_add_f32 v170, v170, v186
    v_add_f32 v171, v171, v187
    v_add_f32 v172, v172, v188
    v_add_f32 v173, v173, v189
    v_add_f32 v174, v174, v190
    v_mfma_f32_32x32x16_bf16 v[128:143], a[44:47], a[12:15], v[128:143]
    ds_read_b64_tr_b16 a[88:89], v46 offset:0
    ds_read_b64_tr_b16 a[90:91], v47 offset:2048
    v_add_f32 v175, v175, v191
    v_add_f32 v144, v144, v160
    v_add_f32 v145, v145, v161
    v_add_f32 v146, v146, v162
    v_add_f32 v147, v147, v163
    v_mfma_f32_32x32x16_bf16 v[128:143], a[48:51], a[16:19], v[128:143]
    ds_read_b64_tr_b16 a[68:69], v40 offset:4096
    ds_read_b64_tr_b16 a[70:71], v41 offset:6144
    v_add_f32 v148, v148, v164
    v_add_f32 v149, v149, v165
    v_add_f32 v150, v150, v166
    v_add_f32 v151, v151, v167
    v_add_f32 v152, v152, v168
    v_mfma_f32_32x32x16_bf16 v[128:143], a[52:55], a[20:23], v[128:143]
    ds_read_b64_tr_b16 a[76:77], v42 offset:4096
    ds_read_b64_tr_b16 a[78:79], v43 offset:6144
    v_add_f32 v153, v153, v169
    v_add_f32 v154, v154, v170
    v_add_f32 v155, v155, v171
    v_add_f32 v156, v156, v172
    v_add_f32 v157, v157, v173
    v_mfma_f32_32x32x16_bf16 v[128:143], a[56:59], a[24:27], v[128:143]
    ds_read_b64_tr_b16 a[84:85], v44 offset:4096
    ds_read_b64_tr_b16 a[86:87], v45 offset:6144
    v_add_f32 v158, v158, v174
    v_add_f32 v159, v159, v175
    v_max3_f32 v218, v144, v145, v146
    v_max3_f32 v219, v147, v148, v149
    v_max3_f32 v220, v150, v151, v152
    v_mfma_f32_32x32x16_bf16 v[128:143], a[60:63], a[28:31], v[128:143]
    ds_read_b64_tr_b16 a[92:93], v46 offset:4096
    ds_read_b64_tr_b16 a[94:95], v47 offset:6144
    v_max3_f32 v221, v153, v154, v155
    v_max3_f32 v218, v218, v156, v157
    v_max3_f32 v219, v219, v158, v159
    v_max3_f32 v218, v218, v219, v220
    v_max_f32 v218, v218, v221
    v_mov_b32 v219, v218
    s_nop 1
    v_permlane32_swap_b32 v218, v219
    v_max3_f32 v218, v218, v219, v216
    v_sub_f32 v220, v216, v218
    v_mov_b32 v216, v218
    v_exp_f32 v220, v220
    v_sub_f32 v192, v144, v218
    v_sub_f32 v193, v145, v218
    v_sub_f32 v194, v146, v218
    v_sub_f32 v195, v147, v218
    v_sub_f32 v196, v148, v218
    v_sub_f32 v197, v149, v218
    v_sub_f32 v198, v150, v218
    v_sub_f32 v199, v151, v218
    v_sub_f32 v200, v152, v218
    v_sub_f32 v201, v153, v218
    v_sub_f32 v202, v154, v218
    v_sub_f32 v203, v155, v218
    v_sub_f32 v204, v156, v218
    v_sub_f32 v205, v157, v218
    v_sub_f32 v206, v158, v218
    v_sub_f32 v207, v159, v218
    ds_write_b128 v28, v[128:131] offset:16384
    v_exp_f32 v192, v192
    v_exp_f32 v193, v193
    v_exp_f32 v194, v194
    v_exp_f32 v195, v195
    ds_write_b128 v28, v[132:135] offset:17408
    v_exp_f32 v196, v196
    v_exp_f32 v197, v197
    v_exp_f32 v198, v198
    v_exp_f32 v199, v199
    ds_write_b128 v28, v[136:139] offset:18432
    v_exp_f32 v200, v200
    v_exp_f32 v201, v201
    v_exp_f32 v202, v202
    v_exp_f32 v203, v203
    ds_write_b128 v28, v[140:143] offset:19456
    v_exp_f32 v204, v204
    v_exp_f32 v205, v205
    v_exp_f32 v206, v206
    v_exp_f32 v207, v207
    v_mul_f32 v217, v217, v220
    v_cvt_pk_bf16_f32 v208, v192, v193
    v_cvt_pk_bf16_f32 v209, v194, v195
    v_cvt_pk_bf16_f32 v210, v196, v197
    v_cvt_pk_bf16_f32 v211, v198, v199
    v_cvt_pk_bf16_f32 v212, v200, v201
    v_cvt_pk_bf16_f32 v213, v202, v203
    v_cvt_pk_bf16_f32 v214, v204, v205
    v_cvt_pk_bf16_f32 v215, v206, v207
    v_mul_f32 v64, v64, v220
    v_mul_f32 v65, v65, v220
    v_mul_f32 v66, v66, v220
    v_mul_f32 v67, v67, v220
    v_mul_f32 v68, v68, v220
    v_mul_f32 v69, v69, v220
    v_mul_f32 v70, v70, v220
    v_mul_f32 v71, v71, v220
    v_mul_f32 v72, v72, v220
    v_mul_f32 v73, v73, v220
    v_mul_f32 v74, v74, v220
    v_mul_f32 v75, v75, v220
    v_mul_f32 v76, v76, v220
    v_mul_f32 v77, v77, v220
    v_mul_f32 v78, v78, v220
    v_mul_f32 v79, v79, v220
    s_waitcnt lgkmcnt(0)
    s_barrier
    v_mfma_f32_32x32x16_bf16 v[64:79], a[64:67], v[208:211], v[64:79]
    ds_read_b128 v[144:147], v29 offset:16384
    v_mul_f32 v80, v80, v220
    v_mul_f32 v81, v81, v220
    ds_read_b128 v[148:151], v29 offset:17408
    ds_write_b128 v26, a[96:99] offset:0
    buffer_load_dwordx4 a[96:99], v20, s[32:35], s58 offen nt
    v_mul_f32 v82, v82, v220
    v_mul_f32 v83, v83, v220
    ds_read_b128 v[152:155], v29 offset:18432
    v_mul_f32 v84, v84, v220
    v_mfma_f32_32x32x16_bf16 v[64:79], a[68:71], v[212:215], v[64:79]
    v_mul_f32 v85, v85, v220
    ds_read_b128 v[156:159], v29 offset:19456
    v_mul_f32 v86, v86, v220
    ds_write_b128 v26, a[100:103] offset:1024
    buffer_load_dwordx4 a[100:103], v21, s[32:35], s58 offen nt
    v_mul_f32 v87, v87, v220
    v_mul_f32 v88, v88, v220
    v_mul_f32 v89, v89, v220
    v_mul_f32 v90, v90, v220
    v_mul_f32 v91, v91, v220
    v_mul_f32 v92, v92, v220
    v_mul_f32 v93, v93, v220
    v_mul_f32 v94, v94, v220
    v_mul_f32 v95, v95, v220
    s_nop 1
    v_mfma_f32_32x32x16_bf16 v[80:95], a[72:75], v[208:211], v[80:95]
    ds_read_b128 v[160:163], v30 offset:16384
    v_mul_f32 v96, v96, v220
    v_mul_f32 v97, v97, v220
    ds_read_b128 v[164:167], v30 offset:17408
    ds_write_b128 v26, a[104:107] offset:2048
    buffer_load_dwordx4 a[104:107], v22, s[32:35], s58 offen nt
    v_mul_f32 v98, v98, v220
    v_mul_f32 v99, v99, v220
    ds_read_b128 v[168:171], v30 offset:18432
    v_mul_f32 v100, v100, v220
    v_mfma_f32_32x32x16_bf16 v[80:95], a[76:79], v[212:215], v[80:95]
    v_mul_f32 v101, v101, v220
    ds_read_b128 v[172:175], v30 offset:19456
    v_mul_f32 v102, v102, v220
    ds_write_b128 v26, a[108:111] offset:3072
    buffer_load_dwordx4 a[108:111], v23, s[32:35], s58 offen nt
    s_add_u32 s58, s58, 16384
    v_mul_f32 v103, v103, v220
    v_mul_f32 v104, v104, v220
    v_mul_f32 v105, v105, v220
    v_mul_f32 v106, v106, v220
    v_mul_f32 v107, v107, v220
    v_mul_f32 v108, v108, v220
    v_mul_f32 v109, v109, v220
    v_mul_f32 v110, v110, v220
    v_mul_f32 v111, v111, v220
    s_nop 1
    v_mfma_f32_32x32x16_bf16 v[96:111], a[80:83], v[208:211], v[96:111]
    ds_read_b128 v[176:179], v31 offset:16384
    v_mul_f32 v112, v112, v220
    v_mul_f32 v113, v113, v220
    ds_read_b128 v[180:183], v31 offset:17408
    ds_write_b128 v26, a[112:115] offset:4096
    buffer_load_dwordx4 a[112:115], v20, s[32:35], s58 offen nt
    v_mul_f32 v114, v114, v220
    v_mul_f32 v115, v115, v220
    ds_read_b128 v[184:187], v31 offset:18432
    v_mul_f32 v116, v116, v220
    v_mfma_f32_32x32x16_bf16 v[96:111], a[84:87], v[212:215], v[96:111]
    v_mul_f32 v117, v117, v220
    ds_read_b128 v[188:191], v31 offset:19456
    v_mul_f32 v118, v118, v220
    ds_write_b128 v26, a[116:119] offset:5120
    buffer_load_dwordx4 a[116:119], v21, s[32:35], s58 offen nt
    v_mul_f32 v119, v119, v220
    v_mul_f32 v120, v120, v220
    v_mul_f32 v121, v121, v220
    v_mul_f32 v122, v122, v220
    v_mul_f32 v123, v123, v220
    v_mul_f32 v124, v124, v220
    v_mul_f32 v125, v125, v220
    v_mul_f32 v126, v126, v220
    v_mul_f32 v127, v127, v220
    s_nop 1
    v_mfma_f32_32x32x16_bf16 v[112:127], a[88:91], v[208:211], v[112:127]
    v_add_f32 v192, v192, v200
    v_add_f32 v193, v193, v201
    v_add_f32 v194, v194, v202
    v_add_f32 v195, v195, v203
    ds_write_b128 v26, a[120:123] offset:6144
    buffer_load_dwordx4 a[120:123], v22, s[32:35], s58 offen nt
    v_add_f32 v196, v196, v204
    v_add_f32 v197, v197, v205
    v_add_f32 v198, v198, v206
    v_add_f32 v199, v199, v207
    v_mfma_f32_32x32x16_bf16 v[112:127], a[92:95], v[212:215], v[112:127]
    v_add_f32 v192, v192, v196
    v_add_f32 v193, v193, v197
    v_add_f32 v194, v194, v198
    ds_write_b128 v26, a[124:127] offset:7168
    buffer_load_dwordx4 a[124:127], v23, s[32:35], s58 offen nt
    s_add_u32 s58, s58, 16384
    v_add_f32 v195, v195, v199
    v_add_f32 v192, v192, v193
    v_add_f32 v194, v194, v195
    v_add_f32 v192, v192, v194
    v_add_f32 v217, v217, v192
    ds_read_b128 a[32:35], v32 offset:16384
    ds_read_b128 a[36:39], v33 offset:16384
    ds_read_b128 a[40:43], v34 offset:16384
    ds_read_b128 a[44:47], v35 offset:16384
    ds_read_b128 a[48:51], v36 offset:16384
    ds_read_b128 a[52:55], v37 offset:16384
    ds_read_b128 a[56:59], v38 offset:16384
    ds_read_b128 a[60:63], v39 offset:16384
    s_waitcnt lgkmcnt(8)
    v_add_f32 v144, v144, v128
    v_add_f32 v145, v145, v129
    v_add_f32 v146, v146, v130
    v_add_f32 v147, v147, v131
    v_add_f32 v148, v148, v132
    v_add_f32 v149, v149, v133
    v_add_f32 v150, v150, v134
    v_add_f32 v151, v151, v135
    v_add_f32 v152, v152, v136
    v_add_f32 v153, v153, v137
    v_add_f32 v154, v154, v138
    v_add_f32 v155, v155, v139
    v_add_f32 v156, v156, v140
    v_add_f32 v157, v157, v141
    v_add_f32 v158, v158, v142
    v_add_f32 v159, v159, v143
    s_waitcnt lgkmcnt(0)
    v_mfma_f32_32x32x16_bf16 v[128:143], a[32:35], a[0:3], 0
    ds_read_b64_tr_b16 a[64:65], v40 offset:8192
    ds_read_b64_tr_b16 a[66:67], v41 offset:10240
    v_add_f32 v160, v160, v176
    v_add_f32 v161, v161, v177
    v_add_f32 v162, v162, v178
    v_add_f32 v163, v163, v179
    v_add_f32 v164, v164, v180
    v_mfma_f32_32x32x16_bf16 v[128:143], a[36:39], a[4:7], v[128:143]
    ds_read_b64_tr_b16 a[72:73], v42 offset:8192
    ds_read_b64_tr_b16 a[74:75], v43 offset:10240
    v_add_f32 v165, v165, v181
    v_add_f32 v166, v166, v182
    v_add_f32 v167, v167, v183
    v_add_f32 v168, v168, v184
    v_add_f32 v169, v169, v185
    v_mfma_f32_32x32x16_bf16 v[128:143], a[40:43], a[8:11], v[128:143]
    ds_read_b64_tr_b16 a[80:81], v44 offset:8192
    ds_read_b64_tr_b16 a[82:83], v45 offset:10240
    v_add_f32 v170, v170, v186
    v_add_f32 v171, v171, v187
    v_add_f32 v172, v172, v188
    v_add_f32 v173, v173, v189
    v_add_f32 v174, v174, v190
    v_mfma_f32_32x32x16_bf16 v[128:143], a[44:47], a[12:15], v[128:143]
    ds_read_b64_tr_b16 a[88:89], v46 offset:8192
    ds_read_b64_tr_b16 a[90:91], v47 offset:10240
    v_add_f32 v175, v175, v191
    v_add_f32 v144, v144, v160
    v_add_f32 v145, v145, v161
    v_add_f32 v146, v146, v162
    v_add_f32 v147, v147, v163
    v_mfma_f32_32x32x16_bf16 v[128:143], a[48:51], a[16:19], v[128:143]
    ds_read_b64_tr_b16 a[68:69], v40 offset:12288
    ds_read_b64_tr_b16 a[70:71], v41 offset:14336
    v_add_f32 v148, v148, v164
    v_add_f32 v149, v149, v165
    v_add_f32 v150, v150, v166
    v_add_f32 v151, v151, v167
    v_add_f32 v152, v152, v168
    v_mfma_f32_32x32x16_bf16 v[128:143], a[52:55], a[20:23], v[128:143]
    ds_read_b64_tr_b16 a[76:77], v42 offset:12288
    ds_read_b64_tr_b16 a[78:79], v43 offset:14336
    v_add_f32 v153, v153, v169
    v_add_f32 v154, v154, v170
    v_add_f32 v155, v155, v171
    v_add_f32 v156, v156, v172
    v_add_f32 v157, v157, v173
    v_mfma_f32_32x32x16_bf16 v[128:143], a[56:59], a[24:27], v[128:143]
    ds_read_b64_tr_b16 a[84:85], v44 offset:12288
    ds_read_b64_tr_b16 a[86:87], v45 offset:14336
    v_add_f32 v158, v158, v174
    v_add_f32 v159, v159, v175
    v_max3_f32 v218, v144, v145, v146
    v_max3_f32 v219, v147, v148, v149
    v_max3_f32 v220, v150, v151, v152
    v_mfma_f32_32x32x16_bf16 v[128:143], a[60:63], a[28:31], v[128:143]
    ds_read_b64_tr_b16 a[92:93], v46 offset:12288
    ds_read_b64_tr_b16 a[94:95], v47 offset:14336
    v_max3_f32 v221, v153, v154, v155
    v_max3_f32 v218, v218, v156, v157
    v_max3_f32 v219, v219, v158, v159
    v_max3_f32 v218, v218, v219, v220
    v_max_f32 v218, v218, v221
    v_mov_b32 v219, v218
    s_nop 1
    v_permlane32_swap_b32 v218, v219
    v_max3_f32 v218, v218, v219, v216
    v_sub_f32 v220, v216, v218
    v_mov_b32 v216, v218
    v_exp_f32 v220, v220
    v_sub_f32 v192, v144, v218
    v_sub_f32 v193, v145, v218
    v_sub_f32 v194, v146, v218
    v_sub_f32 v195, v147, v218
    v_sub_f32 v196, v148, v218
    v_sub_f32 v197, v149, v218
    v_sub_f32 v198, v150, v218
    v_sub_f32 v199, v151, v218
    v_sub_f32 v200, v152, v218
    v_sub_f32 v201, v153, v218
    v_sub_f32 v202, v154, v218
    v_sub_f32 v203, v155, v218
    v_sub_f32 v204, v156, v218
    v_sub_f32 v205, v157, v218
    v_sub_f32 v206, v158, v218
    v_sub_f32 v207, v159, v218
    ds_write_b128 v28, v[128:131] offset:0
    v_exp_f32 v192, v192
    v_exp_f32 v193, v193
    v_exp_f32 v194, v194
    v_exp_f32 v195, v195
    ds_write_b128 v28, v[132:135] offset:1024
    v_exp_f32 v196, v196
    v_exp_f32 v197, v197
    v_exp_f32 v198, v198
    v_exp_f32 v199, v199
    ds_write_b128 v28, v[136:139] offset:2048
    v_exp_f32 v200, v200
    v_exp_f32 v201, v201
    v_exp_f32 v202, v202
    v_exp_f32 v203, v203
    ds_write_b128 v28, v[140:143] offset:3072
    v_exp_f32 v204, v204
    v_exp_f32 v205, v205
    v_exp_f32 v206, v206
    v_exp_f32 v207, v207
    v_mul_f32 v217, v217, v220
    v_cvt_pk_bf16_f32 v208, v192, v193
    v_cvt_pk_bf16_f32 v209, v194, v195
    v_cvt_pk_bf16_f32 v210, v196, v197
    v_cvt_pk_bf16_f32 v211, v198, v199
    v_cvt_pk_bf16_f32 v212, v200, v201
    v_cvt_pk_bf16_f32 v213, v202, v203
    v_cvt_pk_bf16_f32 v214, v204, v205
    v_cvt_pk_bf16_f32 v215, v206, v207
    v_mul_f32 v64, v64, v220
    v_mul_f32 v65, v65, v220
    v_mul_f32 v66, v66, v220
    v_mul_f32 v67, v67, v220
    v_mul_f32 v68, v68, v220
    v_mul_f32 v69, v69, v220
    v_mul_f32 v70, v70, v220
    v_mul_f32 v71, v71, v220
    v_mul_f32 v72, v72, v220
    v_mul_f32 v73, v73, v220
    v_mul_f32 v74, v74, v220
    v_mul_f32 v75, v75, v220
    v_mul_f32 v76, v76, v220
    v_mul_f32 v77, v77, v220
    v_mul_f32 v78, v78, v220
    v_mul_f32 v79, v79, v220
    s_waitcnt lgkmcnt(0)
    s_barrier
    v_mfma_f32_32x32x16_bf16 v[64:79], a[64:67], v[208:211], v[64:79]
    ds_read_b128 v[144:147], v29 offset:0
    v_mul_f32 v80, v80, v220
    v_mul_f32 v81, v81, v220
    ds_read_b128 v[148:151], v29 offset:1024
    ds_write_b128 v26, a[128:131] offset:8192
    buffer_load_dwordx4 a[128:131], v20, s[32:35], s58 offen nt
    v_mul_f32 v82, v82, v220
    v_mul_f32 v83, v83, v220
    ds_read_b128 v[152:155], v29 offset:2048
    v_mul_f32 v84, v84, v220
    v_mfma_f32_32x32x16_bf16 v[64:79], a[68:71], v[212:215], v[64:79]
    v_mul_f32 v85, v85, v220
    ds_read_b128 v[156:159], v29 offset:3072
    v_mul_f32 v86, v86, v220
    ds_write_b128 v26, a[132:135] offset:9216
    buffer_load_dwordx4 a[132:135], v21, s[32:35], s58 offen nt
    v_mul_f32 v87, v87, v220
    v_mul_f32 v88, v88, v220
    v_mul_f32 v89, v89, v220
    v_mul_f32 v90, v90, v220
    v_mul_f32 v91, v91, v220
    v_mul_f32 v92, v92, v220
    v_mul_f32 v93, v93, v220
    v_mul_f32 v94, v94, v220
    v_mul_f32 v95, v95, v220
    s_nop 1
    v_mfma_f32_32x32x16_bf16 v[80:95], a[72:75], v[208:211], v[80:95]
    ds_read_b128 v[160:163], v30 offset:0
    v_mul_f32 v96, v96, v220
    v_mul_f32 v97, v97, v220
    ds_read_b128 v[164:167], v30 offset:1024
    ds_write_b128 v26, a[136:139] offset:10240
    buffer_load_dwordx4 a[136:139], v22, s[32:35], s58 offen nt
    v_mul_f32 v98, v98, v220
    v_mul_f32 v99, v99, v220
    ds_read_b128 v[168:171], v30 offset:2048
    v_mul_f32 v100, v100, v220
    v_mfma_f32_32x32x16_bf16 v[80:95], a[76:79], v[212:215], v[80:95]
    v_mul_f32 v101, v101, v220
    ds_read_b128 v[172:175], v30 offset:3072
    v_mul_f32 v102, v102, v220
    ds_write_b128 v26, a[140:143] offset:11264
    buffer_load_dwordx4 a[140:143], v23, s[32:35], s58 offen nt
    s_add_u32 s58, s58, 16384
    v_mul_f32 v103, v103, v220
    v_mul_f32 v104, v104, v220
    v_mul_f32 v105, v105, v220
    v_mul_f32 v106, v106, v220
    v_mul_f32 v107, v107, v220
    v_mul_f32 v108, v108, v220
    v_mul_f32 v109, v109, v220
    v_mul_f32 v110, v110, v220
    v_mul_f32 v111, v111, v220
    s_nop 1
    v_mfma_f32_32x32x16_bf16 v[96:111], a[80:83], v[208:211], v[96:111]
    ds_read_b128 v[176:179], v31 offset:0
    v_mul_f32 v112, v112, v220
    v_mul_f32 v113, v113, v220
    ds_read_b128 v[180:183], v31 offset:1024
    ds_write_b128 v26, a[144:147] offset:12288
    buffer_load_dwordx4 a[144:147], v20, s[32:35], s58 offen nt
    v_mul_f32 v114, v114, v220
    v_mul_f32 v115, v115, v220
    ds_read_b128 v[184:187], v31 offset:2048
    v_mul_f32 v116, v116, v220
    v_mfma_f32_32x32x16_bf16 v[96:111], a[84:87], v[212:215], v[96:111]
    v_mul_f32 v117, v117, v220
    ds_read_b128 v[188:191], v31 offset:3072
    v_mul_f32 v118, v118, v220
    ds_write_b128 v26, a[148:151] offset:13312
    buffer_load_dwordx4 a[148:151], v21, s[32:35], s58 offen nt
    v_mul_f32 v119, v119, v220
    v_mul_f32 v120, v120, v220
    v_mul_f32 v121, v121, v220
    v_mul_f32 v122, v122, v220
    v_mul_f32 v123, v123, v220
    v_mul_f32 v124, v124, v220
    v_mul_f32 v125, v125, v220
    v_mul_f32 v126, v126, v220
    v_mul_f32 v127, v127, v220
    s_nop 1
    v_mfma_f32_32x32x16_bf16 v[112:127], a[88:91], v[208:211], v[112:127]
    v_add_f32 v192, v192, v200
    v_add_f32 v193, v193, v201
    v_add_f32 v194, v194, v202
    v_add_f32 v195, v195, v203
    ds_write_b128 v26, a[152:155] offset:14336
    buffer_load_dwordx4 a[152:155], v22, s[32:35], s58 offen nt
    v_add_f32 v196, v196, v204
    v_add_f32 v197, v197, v205
    v_add_f32 v198, v198, v206
    v_add_f32 v199, v199, v207
    v_mfma_f32_32x32x16_bf16 v[112:127], a[92:95], v[212:215], v[112:127]
    v_add_f32 v192, v192, v196
    v_add_f32 v193, v193, v197
    v_add_f32 v194, v194, v198
    ds_write_b128 v26, a[156:159] offset:15360
    buffer_load_dwordx4 a[156:159], v23, s[32:35], s58 offen nt
    s_add_u32 s58, s58, 16384
    v_add_f32 v195, v195, v199
    v_add_f32 v192, v192, v193
    v_add_f32 v194, v194, v195
    v_add_f32 v192, v192, v194
    v_add_f32 v217, v217, v192
    ds_read_b128 a[32:35], v32 offset:24576
    ds_read_b128 a[36:39], v33 offset:24576
    ds_read_b128 a[40:43], v34 offset:24576
    ds_read_b128 a[44:47], v35 offset:24576
    ds_read_b128 a[48:51], v36 offset:24576
    ds_read_b128 a[52:55], v37 offset:24576
    ds_read_b128 a[56:59], v38 offset:24576
    ds_read_b128 a[60:63], v39 offset:24576
    s_waitcnt lgkmcnt(8)
    v_add_f32 v144, v144, v128
    v_add_f32 v145, v145, v129
    v_add_f32 v146, v146, v130
    v_add_f32 v147, v147, v131
    v_add_f32 v148, v148, v132
    v_add_f32 v149, v149, v133
    v_add_f32 v150, v150, v134
    v_add_f32 v151, v151, v135
    v_add_f32 v152, v152, v136
    v_add_f32 v153, v153, v137
    v_add_f32 v154, v154, v138
    v_add_f32 v155, v155, v139
    v_add_f32 v156, v156, v140
    v_add_f32 v157, v157, v141
    v_add_f32 v158, v158, v142
    v_add_f32 v159, v159, v143
    s_waitcnt lgkmcnt(0)
    v_mfma_f32_32x32x16_bf16 v[128:143], a[32:35], a[0:3], 0
    ds_read_b64_tr_b16 a[64:65], v40 offset:16384
    ds_read_b64_tr_b16 a[66:67], v41 offset:18432
    v_add_f32 v160, v160, v176
    v_add_f32 v161, v161, v177
    v_add_f32 v162, v162, v178
    v_add_f32 v163, v163, v179
    v_add_f32 v164, v164, v180
    v_mfma_f32_32x32x16_bf16 v[128:143], a[36:39], a[4:7], v[128:143]
    ds_read_b64_tr_b16 a[72:73], v42 offset:16384
    ds_read_b64_tr_b16 a[74:75], v43 offset:18432
    v_add_f32 v165, v165, v181
    v_add_f32 v166, v166, v182
    v_add_f32 v167, v167, v183
    v_add_f32 v168, v168, v184
    v_add_f32 v169, v169, v185
    v_mfma_f32_32x32x16_bf16 v[128:143], a[40:43], a[8:11], v[128:143]
    ds_read_b64_tr_b16 a[80:81], v44 offset:16384
    ds_read_b64_tr_b16 a[82:83], v45 offset:18432
    v_add_f32 v170, v170, v186
    v_add_f32 v171, v171, v187
    v_add_f32 v172, v172, v188
    v_add_f32 v173, v173, v189
    v_add_f32 v174, v174, v190
    v_mfma_f32_32x32x16_bf16 v[128:143], a[44:47], a[12:15], v[128:143]
    ds_read_b64_tr_b16 a[88:89], v46 offset:16384
    ds_read_b64_tr_b16 a[90:91], v47 offset:18432
    v_add_f32 v175, v175, v191
    v_add_f32 v144, v144, v160
    v_add_f32 v145, v145, v161
    v_add_f32 v146, v146, v162
    v_add_f32 v147, v147, v163
    v_mfma_f32_32x32x16_bf16 v[128:143], a[48:51], a[16:19], v[128:143]
    ds_read_b64_tr_b16 a[68:69], v40 offset:20480
    ds_read_b64_tr_b16 a[70:71], v41 offset:22528
    v_add_f32 v148, v148, v164
    v_add_f32 v149, v149, v165
    v_add_f32 v150, v150, v166
    v_add_f32 v151, v151, v167
    v_add_f32 v152, v152, v168
    v_mfma_f32_32x32x16_bf16 v[128:143], a[52:55], a[20:23], v[128:143]
    ds_read_b64_tr_b16 a[76:77], v42 offset:20480
    ds_read_b64_tr_b16 a[78:79], v43 offset:22528
    v_add_f32 v153, v153, v169
    v_add_f32 v154, v154, v170
    v_add_f32 v155, v155, v171
    v_add_f32 v156, v156, v172
    v_add_f32 v157, v157, v173
    v_mfma_f32_32x32x16_bf16 v[128:143], a[56:59], a[24:27], v[128:143]
    ds_read_b64_tr_b16 a[84:85], v44 offset:20480
    ds_read_b64_tr_b16 a[86:87], v45 offset:22528
    v_add_f32 v158, v158, v174
    v_add_f32 v159, v159, v175
    v_max3_f32 v218, v144, v145, v146
    v_max3_f32 v219, v147, v148, v149
    v_max3_f32 v220, v150, v151, v152
    v_mfma_f32_32x32x16_bf16 v[128:143], a[60:63], a[28:31], v[128:143]
    ds_read_b64_tr_b16 a[92:93], v46 offset:20480
    ds_read_b64_tr_b16 a[94:95], v47 offset:22528
    v_max3_f32 v221, v153, v154, v155
    v_max3_f32 v218, v218, v156, v157
    v_max3_f32 v219, v219, v158, v159
    v_max3_f32 v218, v218, v219, v220
    v_max_f32 v218, v218, v221
    v_mov_b32 v219, v218
    s_nop 1
    v_permlane32_swap_b32 v218, v219
    v_max3_f32 v218, v218, v219, v216
    v_sub_f32 v220, v216, v218
    v_mov_b32 v216, v218
    v_exp_f32 v220, v220
    v_sub_f32 v192, v144, v218
    v_sub_f32 v193, v145, v218
    v_sub_f32 v194, v146, v218
    v_sub_f32 v195, v147, v218
    v_sub_f32 v196, v148, v218
    v_sub_f32 v197, v149, v218
    v_sub_f32 v198, v150, v218
    v_sub_f32 v199, v151, v218
    v_sub_f32 v200, v152, v218
    v_sub_f32 v201, v153, v218
    v_sub_f32 v202, v154, v218
    v_sub_f32 v203, v155, v218
    v_sub_f32 v204, v156, v218
    v_sub_f32 v205, v157, v218
    v_sub_f32 v206, v158, v218
    v_sub_f32 v207, v159, v218
    ds_write_b128 v28, v[128:131] offset:16384
    v_exp_f32 v192, v192
    v_exp_f32 v193, v193
    v_exp_f32 v194, v194
    v_exp_f32 v195, v195
    ds_write_b128 v28, v[132:135] offset:17408
    v_exp_f32 v196, v196
    v_exp_f32 v197, v197
    v_exp_f32 v198, v198
    v_exp_f32 v199, v199
    ds_write_b128 v28, v[136:139] offset:18432
    v_exp_f32 v200, v200
    v_exp_f32 v201, v201
    v_exp_f32 v202, v202
    v_exp_f32 v203, v203
    ds_write_b128 v28, v[140:143] offset:19456
    v_exp_f32 v204, v204
    v_exp_f32 v205, v205
    v_exp_f32 v206, v206
    v_exp_f32 v207, v207
    v_mul_f32 v217, v217, v220
    v_cvt_pk_bf16_f32 v208, v192, v193
    v_cvt_pk_bf16_f32 v209, v194, v195
    v_cvt_pk_bf16_f32 v210, v196, v197
    v_cvt_pk_bf16_f32 v211, v198, v199
    v_cvt_pk_bf16_f32 v212, v200, v201
    v_cvt_pk_bf16_f32 v213, v202, v203
    v_cvt_pk_bf16_f32 v214, v204, v205
    v_cvt_pk_bf16_f32 v215, v206, v207
    v_mul_f32 v64, v64, v220
    v_mul_f32 v65, v65, v220
    v_mul_f32 v66, v66, v220
    v_mul_f32 v67, v67, v220
    v_mul_f32 v68, v68, v220
    v_mul_f32 v69, v69, v220
    v_mul_f32 v70, v70, v220
    v_mul_f32 v71, v71, v220
    v_mul_f32 v72, v72, v220
    v_mul_f32 v73, v73, v220
    v_mul_f32 v74, v74, v220
    v_mul_f32 v75, v75, v220
    v_mul_f32 v76, v76, v220
    v_mul_f32 v77, v77, v220
    v_mul_f32 v78, v78, v220
    v_mul_f32 v79, v79, v220
    s_waitcnt lgkmcnt(0)
    s_barrier
    v_mfma_f32_32x32x16_bf16 v[64:79], a[64:67], v[208:211], v[64:79]
    ds_read_b128 v[144:147], v29 offset:16384
    v_mul_f32 v80, v80, v220
    v_mul_f32 v81, v81, v220
    ds_read_b128 v[148:151], v29 offset:17408
    ds_write_b128 v26, a[160:163] offset:16384
    buffer_load_dwordx4 a[160:163], v20, s[32:35], s58 offen nt
    v_mul_f32 v82, v82, v220
    v_mul_f32 v83, v83, v220
    ds_read_b128 v[152:155], v29 offset:18432
    v_mul_f32 v84, v84, v220
    v_mfma_f32_32x32x16_bf16 v[64:79], a[68:71], v[212:215], v[64:79]
    v_mul_f32 v85, v85, v220
    ds_read_b128 v[156:159], v29 offset:19456
    v_mul_f32 v86, v86, v220
    ds_write_b128 v26, a[164:167] offset:17408
    buffer_load_dwordx4 a[164:167], v21, s[32:35], s58 offen nt
    v_mul_f32 v87, v87, v220
    v_mul_f32 v88, v88, v220
    v_mul_f32 v89, v89, v220
    v_mul_f32 v90, v90, v220
    v_mul_f32 v91, v91, v220
    v_mul_f32 v92, v92, v220
    v_mul_f32 v93, v93, v220
    v_mul_f32 v94, v94, v220
    v_mul_f32 v95, v95, v220
    s_nop 1
    v_mfma_f32_32x32x16_bf16 v[80:95], a[72:75], v[208:211], v[80:95]
    ds_read_b128 v[160:163], v30 offset:16384
    v_mul_f32 v96, v96, v220
    v_mul_f32 v97, v97, v220
    ds_read_b128 v[164:167], v30 offset:17408
    ds_write_b128 v26, a[168:171] offset:18432
    buffer_load_dwordx4 a[168:171], v22, s[32:35], s58 offen nt
    v_mul_f32 v98, v98, v220
    v_mul_f32 v99, v99, v220
    ds_read_b128 v[168:171], v30 offset:18432
    v_mul_f32 v100, v100, v220
    v_mfma_f32_32x32x16_bf16 v[80:95], a[76:79], v[212:215], v[80:95]
    v_mul_f32 v101, v101, v220
    ds_read_b128 v[172:175], v30 offset:19456
    v_mul_f32 v102, v102, v220
    ds_write_b128 v26, a[172:175] offset:19456
    v_mul_f32 v103, v103, v220
    v_mul_f32 v104, v104, v220
    v_mul_f32 v105, v105, v220
    v_mul_f32 v106, v106, v220
    v_mul_f32 v107, v107, v220
    v_mul_f32 v108, v108, v220
    v_mul_f32 v109, v109, v220
    v_mul_f32 v110, v110, v220
    v_mul_f32 v111, v111, v220
    s_nop 1
    v_mfma_f32_32x32x16_bf16 v[96:111], a[80:83], v[208:211], v[96:111]
    ds_read_b128 v[176:179], v31 offset:16384
    v_mul_f32 v112, v112, v220
    v_mul_f32 v113, v113, v220
    ds_read_b128 v[180:183], v31 offset:17408
    ds_write_b128 v26, a[176:179] offset:20480
    buffer_load_dwordx4 a[172:175], v23, s[32:35], s58 offen nt
    s_add_u32 s58, s58, 16384
    v_mul_f32 v114, v114, v220
    v_mul_f32 v115, v115, v220
    ds_read_b128 v[184:187], v31 offset:18432
    v_mul_f32 v116, v116, v220
    v_mfma_f32_32x32x16_bf16 v[96:111], a[84:87], v[212:215], v[96:111]
    v_mul_f32 v117, v117, v220
    ds_read_b128 v[188:191], v31 offset:19456
    v_mul_f32 v118, v118, v220
    ds_write_b128 v26, a[180:183] offset:21504
    buffer_load_dwordx4 a[176:179], v20, s[32:35], s58 offen nt
    v_mul_f32 v119, v119, v220
    v_mul_f32 v120, v120, v220
    v_mul_f32 v121, v121, v220
    v_mul_f32 v122, v122, v220
    v_mul_f32 v123, v123, v220
    v_mul_f32 v124, v124, v220
    v_mul_f32 v125, v125, v220
    v_mul_f32 v126, v126, v220
    v_mul_f32 v127, v127, v220
    s_nop 1
    v_mfma_f32_32x32x16_bf16 v[112:127], a[88:91], v[208:211], v[112:127]
    v_add_f32 v192, v192, v200
    v_add_f32 v193, v193, v201
    v_add_f32 v194, v194, v202
    v_add_f32 v195, v195, v203
    ds_write_b128 v26, a[184:187] offset:22528
    buffer_load_dwordx4 a[180:183], v21, s[32:35], s58 offen nt
    v_add_f32 v196, v196, v204
    v_add_f32 v197, v197, v205
    v_add_f32 v198, v198, v206
    v_add_f32 v199, v199, v207
    v_mfma_f32_32x32x16_bf16 v[112:127], a[92:95], v[212:215], v[112:127]
    v_add_f32 v192, v192, v196
    v_add_f32 v193, v193, v197
    v_add_f32 v194, v194, v198
    ds_write_b128 v26, a[188:191] offset:23552
    v_add_f32 v195, v195, v199
    v_add_f32 v192, v192, v193
    v_add_f32 v194, v194, v195
    v_add_f32 v192, v192, v194
    v_add_f32 v217, v217, v192
    ds_read_b128 a[32:35], v32 offset:0
    ds_read_b128 a[36:39], v33 offset:0
    ds_read_b128 a[40:43], v34 offset:0
    ds_read_b128 a[44:47], v35 offset:0
    ds_read_b128 a[48:51], v36 offset:0
    ds_read_b128 a[52:55], v37 offset:0
    ds_read_b128 a[56:59], v38 offset:0
    ds_read_b128 a[60:63], v39 offset:0
    s_waitcnt lgkmcnt(8)
    v_add_f32 v144, v144, v128
    v_add_f32 v145, v145, v129
    v_add_f32 v146, v146, v130
    v_add_f32 v147, v147, v131
    buffer_load_dwordx4 a[184:187], v22, s[32:35], s58 offen nt
    v_add_f32 v148, v148, v132
    v_add_f32 v149, v149, v133
    v_add_f32 v150, v150, v134
    v_add_f32 v151, v151, v135
    v_add_f32 v152, v152, v136
    v_add_f32 v153, v153, v137
    v_add_f32 v154, v154, v138
    v_add_f32 v155, v155, v139
    v_add_f32 v156, v156, v140
    v_add_f32 v157, v157, v141
    v_add_f32 v158, v158, v142
    v_add_f32 v159, v159, v143
    s_waitcnt lgkmcnt(0)
    v_mfma_f32_32x32x16_bf16 v[128:143], a[32:35], a[0:3], 0
    ds_read_b64_tr_b16 a[64:65], v40 offset:24576
    ds_read_b64_tr_b16 a[66:67], v41 offset:26624
    v_add_f32 v160, v160, v176
    v_add_f32 v161, v161, v177
    v_add_f32 v162, v162, v178
    v_add_f32 v163, v163, v179
    v_add_f32 v164, v164, v180
    v_mfma_f32_32x32x16_bf16 v[128:143], a[36:39], a[4:7], v[128:143]
    ds_read_b64_tr_b16 a[72:73], v42 offset:24576
    ds_read_b64_tr_b16 a[74:75], v43 offset:26624
    v_add_f32 v165, v165, v181
    v_add_f32 v166, v166, v182
    v_add_f32 v167, v167, v183
    v_add_f32 v168, v168, v184
    v_add_f32 v169, v169, v185
    v_mfma_f32_32x32x16_bf16 v[128:143], a[40:43], a[8:11], v[128:143]
    ds_read_b64_tr_b16 a[80:81], v44 offset:24576
    ds_read_b64_tr_b16 a[82:83], v45 offset:26624
    v_add_f32 v170, v170, v186
    v_add_f32 v171, v171, v187
    v_add_f32 v172, v172, v188
    v_add_f32 v173, v173, v189
    v_add_f32 v174, v174, v190
    v_mfma_f32_32x32x16_bf16 v[128:143], a[44:47], a[12:15], v[128:143]
    ds_read_b64_tr_b16 a[88:89], v46 offset:24576
    ds_read_b64_tr_b16 a[90:91], v47 offset:26624
    v_add_f32 v175, v175, v191
    v_add_f32 v144, v144, v160
    v_add_f32 v145, v145, v161
    v_add_f32 v146, v146, v162
    v_add_f32 v147, v147, v163
    v_mfma_f32_32x32x16_bf16 v[128:143], a[48:51], a[16:19], v[128:143]
    ds_read_b64_tr_b16 a[68:69], v40 offset:28672
    ds_read_b64_tr_b16 a[70:71], v41 offset:30720
    v_add_f32 v148, v148, v164
    v_add_f32 v149, v149, v165
    v_add_f32 v150, v150, v166
    v_add_f32 v151, v151, v167
    v_add_f32 v152, v152, v168
    v_mfma_f32_32x32x16_bf16 v[128:143], a[52:55], a[20:23], v[128:143]
    ds_read_b64_tr_b16 a[76:77], v42 offset:28672
    ds_read_b64_tr_b16 a[78:79], v43 offset:30720
    v_add_f32 v153, v153, v169
    v_add_f32 v154, v154, v170
    v_add_f32 v155, v155, v171
    v_add_f32 v156, v156, v172
    v_add_f32 v157, v157, v173
    v_mfma_f32_32x32x16_bf16 v[128:143], a[56:59], a[24:27], v[128:143]
    ds_read_b64_tr_b16 a[84:85], v44 offset:28672
    ds_read_b64_tr_b16 a[86:87], v45 offset:30720
    v_add_f32 v158, v158, v174
    v_add_f32 v159, v159, v175
    v_max3_f32 v218, v144, v145, v146
    v_max3_f32 v219, v147, v148, v149
    v_max3_f32 v220, v150, v151, v152
    v_mfma_f32_32x32x16_bf16 v[128:143], a[60:63], a[28:31], v[128:143]
    ds_read_b64_tr_b16 a[92:93], v46 offset:28672
    ds_read_b64_tr_b16 a[94:95], v47 offset:30720
    v_max3_f32 v221, v153, v154, v155
    v_max3_f32 v218, v218, v156, v157
    v_max3_f32 v219, v219, v158, v159
    v_max3_f32 v218, v218, v219, v220
    v_max_f32 v218, v218, v221
    v_mov_b32 v219, v218
    s_nop 1
    v_permlane32_swap_b32 v218, v219
    v_max3_f32 v218, v218, v219, v216
    v_sub_f32 v220, v216, v218
    v_mov_b32 v216, v218
    v_exp_f32 v220, v220
    v_sub_f32 v192, v144, v218
    v_sub_f32 v193, v145, v218
    buffer_load_dwordx4 a[188:191], v23, s[32:35], s58 offen nt
    s_add_u32 s58, s58, 16384
    v_sub_f32 v194, v146, v218
    v_sub_f32 v195, v147, v218
    v_sub_f32 v196, v148, v218
    v_sub_f32 v197, v149, v218
    v_sub_f32 v198, v150, v218
    v_sub_f32 v199, v151, v218
    v_sub_f32 v200, v152, v218
    v_sub_f32 v201, v153, v218
    v_sub_f32 v202, v154, v218
    v_sub_f32 v203, v155, v218
    v_sub_f32 v204, v156, v218
    v_sub_f32 v205, v157, v218
    v_sub_f32 v206, v158, v218
    v_sub_f32 v207, v159, v218
    ds_write_b128 v28, v[128:131] offset:0
    v_exp_f32 v192, v192
    v_exp_f32 v193, v193
    v_exp_f32 v194, v194
    v_exp_f32 v195, v195
    ds_write_b128 v28, v[132:135] offset:1024
    v_exp_f32 v196, v196
    v_exp_f32 v197, v197
    v_exp_f32 v198, v198
    v_exp_f32 v199, v199
    ds_write_b128 v28, v[136:139] offset:2048
    v_exp_f32 v200, v200
    v_exp_f32 v201, v201
    v_exp_f32 v202, v202
    v_exp_f32 v203, v203
    ds_write_b128 v28, v[140:143] offset:3072
    v_exp_f32 v204, v204
    v_exp_f32 v205, v205
    v_exp_f32 v206, v206
    v_exp_f32 v207, v207
    v_mul_f32 v217, v217, v220
    v_cvt_pk_bf16_f32 v208, v192, v193
    v_cvt_pk_bf16_f32 v209, v194, v195
    v_cvt_pk_bf16_f32 v210, v196, v197
    v_cvt_pk_bf16_f32 v211, v198, v199
    v_cvt_pk_bf16_f32 v212, v200, v201
    v_cvt_pk_bf16_f32 v213, v202, v203
    v_cvt_pk_bf16_f32 v214, v204, v205
    v_cvt_pk_bf16_f32 v215, v206, v207
    v_mul_f32 v64, v64, v220
    v_mul_f32 v65, v65, v220
    v_mul_f32 v66, v66, v220
    v_mul_f32 v67, v67, v220
    v_mul_f32 v68, v68, v220
    v_mul_f32 v69, v69, v220
    v_mul_f32 v70, v70, v220
    v_mul_f32 v71, v71, v220
    v_mul_f32 v72, v72, v220
    v_mul_f32 v73, v73, v220
    v_mul_f32 v74, v74, v220
    v_mul_f32 v75, v75, v220
    v_mul_f32 v76, v76, v220
    v_mul_f32 v77, v77, v220
    v_mul_f32 v78, v78, v220
    v_mul_f32 v79, v79, v220
    s_waitcnt lgkmcnt(0)
    s_barrier
    v_mfma_f32_32x32x16_bf16 v[64:79], a[64:67], v[208:211], v[64:79]
    ds_read_b128 v[144:147], v29 offset:0
    v_mul_f32 v80, v80, v220
    v_mul_f32 v81, v81, v220
    ds_read_b128 v[148:151], v29 offset:1024
    ds_write_b128 v26, a[192:195] offset:24576
    buffer_load_dwordx4 a[192:195], v20, s[32:35], s58 offen nt
    v_mul_f32 v82, v82, v220
    v_mul_f32 v83, v83, v220
    ds_read_b128 v[152:155], v29 offset:2048
    v_mul_f32 v84, v84, v220
    v_mfma_f32_32x32x16_bf16 v[64:79], a[68:71], v[212:215], v[64:79]
    v_mul_f32 v85, v85, v220
    ds_read_b128 v[156:159], v29 offset:3072
    v_mul_f32 v86, v86, v220
    ds_write_b128 v26, a[196:199] offset:25600
    v_mul_f32 v87, v87, v220
    v_mul_f32 v88, v88, v220
    v_mul_f32 v89, v89, v220
    v_mul_f32 v90, v90, v220
    v_mul_f32 v91, v91, v220
    v_mul_f32 v92, v92, v220
    v_mul_f32 v93, v93, v220
    v_mul_f32 v94, v94, v220
    v_mul_f32 v95, v95, v220
    s_nop 1
    v_mfma_f32_32x32x16_bf16 v[80:95], a[72:75], v[208:211], v[80:95]
    ds_read_b128 v[160:163], v30 offset:0
    v_mul_f32 v96, v96, v220
    v_mul_f32 v97, v97, v220
    ds_read_b128 v[164:167], v30 offset:1024
    ds_write_b128 v26, a[200:203] offset:26624
    buffer_load_dwordx4 a[196:199], v21, s[32:35], s58 offen nt
    v_mul_f32 v98, v98, v220
    v_mul_f32 v99, v99, v220
    ds_read_b128 v[168:171], v30 offset:2048
    v_mul_f32 v100, v100, v220
    v_mfma_f32_32x32x16_bf16 v[80:95], a[76:79], v[212:215], v[80:95]
    v_mul_f32 v101, v101, v220
    ds_read_b128 v[172:175], v30 offset:3072
    v_mul_f32 v102, v102, v220
    ds_write_b128 v26, a[204:207] offset:27648
    v_mul_f32 v103, v103, v220
    v_mul_f32 v104, v104, v220
    v_mul_f32 v105, v105, v220
    v_mul_f32 v106, v106, v220
    v_mul_f32 v107, v107, v220
    v_mul_f32 v108, v108, v220
    v_mul_f32 v109, v109, v220
    v_mul_f32 v110, v110, v220
    v_mul_f32 v111, v111, v220
    s_nop 1
    v_mfma_f32_32x32x16_bf16 v[96:111], a[80:83], v[208:211], v[96:111]
    ds_read_b128 v[176:179], v31 offset:0
    v_mul_f32 v112, v112, v220
    v_mul_f32 v113, v113, v220
    ds_read_b128 v[180:183], v31 offset:1024
    ds_write_b128 v26, a[208:211] offset:28672
    buffer_load_dwordx4 a[200:203], v22, s[32:35], s58 offen nt
    v_mul_f32 v114, v114, v220
    v_mul_f32 v115, v115, v220
    ds_read_b128 v[184:187], v31 offset:2048
    v_mul_f32 v116, v116, v220
    v_mfma_f32_32x32x16_bf16 v[96:111], a[84:87], v[212:215], v[96:111]
    v_mul_f32 v117, v117, v220
    ds_read_b128 v[188:191], v31 offset:3072
    v_mul_f32 v118, v118, v220
    ds_write_b128 v26, a[212:215] offset:29696
    v_mul_f32 v119, v119, v220
    v_mul_f32 v120, v120, v220
    v_mul_f32 v121, v121, v220
    v_mul_f32 v122, v122, v220
    v_mul_f32 v123, v123, v220
    v_mul_f32 v124, v124, v220
    v_mul_f32 v125, v125, v220
    v_mul_f32 v126, v126, v220
    v_mul_f32 v127, v127, v220
    s_nop 1
    v_mfma_f32_32x32x16_bf16 v[112:127], a[88:91], v[208:211], v[112:127]
    v_add_f32 v192, v192, v200
    v_add_f32 v193, v193, v201
    v_add_f32 v194, v194, v202
    v_add_f32 v195, v195, v203
    ds_write_b128 v26, a[216:219] offset:30720
    buffer_load_dwordx4 a[204:207], v23, s[32:35], s58 offen nt
    s_add_u32 s58, s58, 16384
    v_add_f32 v196, v196, v204
    v_add_f32 v197, v197, v205
    v_add_f32 v198, v198, v206
    v_add_f32 v199, v199, v207
    v_mfma_f32_32x32x16_bf16 v[112:127], a[92:95], v[212:215], v[112:127]
    v_add_f32 v192, v192, v196
    v_add_f32 v193, v193, v197
    v_add_f32 v194, v194, v198
    ds_write_b128 v26, a[220:223] offset:31744
    v_add_f32 v195, v195, v199
    v_add_f32 v192, v192, v193
    v_add_f32 v194, v194, v195
    v_add_f32 v192, v192, v194
    v_add_f32 v217, v217, v192
    ds_read_b128 a[32:35], v32 offset:8192
    ds_read_b128 a[36:39], v33 offset:8192
    ds_read_b128 a[40:43], v34 offset:8192
    ds_read_b128 a[44:47], v35 offset:8192
    ds_read_b128 a[48:51], v36 offset:8192
    ds_read_b128 a[52:55], v37 offset:8192
    ds_read_b128 a[56:59], v38 offset:8192
    ds_read_b128 a[60:63], v39 offset:8192
    s_waitcnt lgkmcnt(8)
    v_add_f32 v144, v144, v128
    v_add_f32 v145, v145, v129
    v_add_f32 v146, v146, v130
    v_add_f32 v147, v147, v131
    buffer_load_dwordx4 a[208:211], v20, s[32:35], s58 offen nt
    v_add_f32 v148, v148, v132
    v_add_f32 v149, v149, v133
    v_add_f32 v150, v150, v134
    v_add_f32 v151, v151, v135
    v_add_f32 v152, v152, v136
    v_add_f32 v153, v153, v137
    v_add_f32 v154, v154, v138
    v_add_f32 v155, v155, v139
    v_add_f32 v156, v156, v140
    v_add_f32 v157, v157, v141
    v_add_f32 v158, v158, v142
    v_add_f32 v159, v159, v143
    s_waitcnt lgkmcnt(0)
    v_mfma_f32_32x32x16_bf16 v[128:143], a[32:35], a[0:3], 0
    ds_read_b64_tr_b16 a[64:65], v40 offset:0
    ds_read_b64_tr_b16 a[66:67], v41 offset:2048
    v_add_f32 v160, v160, v176
    v_add_f32 v161, v161, v177
    v_add_f32 v162, v162, v178
    v_add_f32 v163, v163, v179
    v_add_f32 v164, v164, v180
    v_mfma_f32_32x32x16_bf16 v[128:143], a[36:39], a[4:7], v[128:143]
    ds_read_b64_tr_b16 a[72:73], v42 offset:0
    ds_read_b64_tr_b16 a[74:75], v43 offset:2048
    v_add_f32 v165, v165, v181
    v_add_f32 v166, v166, v182
    v_add_f32 v167, v167, v183
    v_add_f32 v168, v168, v184
    v_add_f32 v169, v169, v185
    v_mfma_f32_32x32x16_bf16 v[128:143], a[40:43], a[8:11], v[128:143]
    ds_read_b64_tr_b16 a[80:81], v44 offset:0
    ds_read_b64_tr_b16 a[82:83], v45 offset:2048
    v_add_f32 v170, v170, v186
    v_add_f32 v171, v171, v187
    v_add_f32 v172, v172, v188
    v_add_f32 v173, v173, v189
    v_add_f32 v174, v174, v190
    v_mfma_f32_32x32x16_bf16 v[128:143], a[44:47], a[12:15], v[128:143]
    ds_read_b64_tr_b16 a[88:89], v46 offset:0
    ds_read_b64_tr_b16 a[90:91], v47 offset:2048
    v_add_f32 v175, v175, v191
    v_add_f32 v144, v144, v160
    v_add_f32 v145, v145, v161
    v_add_f32 v146, v146, v162
    v_add_f32 v147, v147, v163
    v_mfma_f32_32x32x16_bf16 v[128:143], a[48:51], a[16:19], v[128:143]
    ds_read_b64_tr_b16 a[68:69], v40 offset:4096
    ds_read_b64_tr_b16 a[70:71], v41 offset:6144
    v_add_f32 v148, v148, v164
    v_add_f32 v149, v149, v165
    v_add_f32 v150, v150, v166
    v_add_f32 v151, v151, v167
    v_add_f32 v152, v152, v168
    v_mfma_f32_32x32x16_bf16 v[128:143], a[52:55], a[20:23], v[128:143]
    ds_read_b64_tr_b16 a[76:77], v42 offset:4096
    ds_read_b64_tr_b16 a[78:79], v43 offset:6144
    v_add_f32 v153, v153, v169
    v_add_f32 v154, v154, v170
    v_add_f32 v155, v155, v171
    v_add_f32 v156, v156, v172
    v_add_f32 v157, v157, v173
    v_mfma_f32_32x32x16_bf16 v[128:143], a[56:59], a[24:27], v[128:143]
    ds_read_b64_tr_b16 a[84:85], v44 offset:4096
    ds_read_b64_tr_b16 a[86:87], v45 offset:6144
    v_add_f32 v158, v158, v174
    v_add_f32 v159, v159, v175
    v_max3_f32 v218, v144, v145, v146
    v_max3_f32 v219, v147, v148, v149
    v_max3_f32 v220, v150, v151, v152
    v_mfma_f32_32x32x16_bf16 v[128:143], a[60:63], a[28:31], v[128:143]
    ds_read_b64_tr_b16 a[92:93], v46 offset:4096
    ds_read_b64_tr_b16 a[94:95], v47 offset:6144
    v_max3_f32 v221, v153, v154, v155
    v_max3_f32 v218, v218, v156, v157
    v_max3_f32 v219, v219, v158, v159
    v_max3_f32 v218, v218, v219, v220
    v_max_f32 v218, v218, v221
    v_mov_b32 v219, v218
    s_nop 1
    v_permlane32_swap_b32 v218, v219
    v_max3_f32 v218, v218, v219, v216
    v_sub_f32 v220, v216, v218
    v_mov_b32 v216, v218
    v_exp_f32 v220, v220
    v_sub_f32 v192, v144, v218
    v_sub_f32 v193, v145, v218
    buffer_load_dwordx4 a[212:215], v21, s[32:35], s58 offen nt
    v_sub_f32 v194, v146, v218
    v_sub_f32 v195, v147, v218
    v_sub_f32 v196, v148, v218
    v_sub_f32 v197, v149, v218
    v_sub_f32 v198, v150, v218
    buffer_load_dwordx4 a[216:219], v22, s[32:35], s58 offen nt
    v_sub_f32 v199, v151, v218
    v_sub_f32 v200, v152, v218
    v_sub_f32 v201, v153, v218
    v_sub_f32 v202, v154, v218
    v_sub_f32 v203, v155, v218
    v_sub_f32 v204, v156, v218
    v_sub_f32 v205, v157, v218
    v_sub_f32 v206, v158, v218
    v_sub_f32 v207, v159, v218
    ds_write_b128 v28, v[128:131] offset:16384
    v_exp_f32 v192, v192
    v_exp_f32 v193, v193
    v_exp_f32 v194, v194
    v_exp_f32 v195, v195
    ds_write_b128 v28, v[132:135] offset:17408
    v_exp_f32 v196, v196
    v_exp_f32 v197, v197
    v_exp_f32 v198, v198
    v_exp_f32 v199, v199
    ds_write_b128 v28, v[136:139] offset:18432
    v_exp_f32 v200, v200
    v_exp_f32 v201, v201
    v_exp_f32 v202, v202
    v_exp_f32 v203, v203
    ds_write_b128 v28, v[140:143] offset:19456
    v_exp_f32 v204, v204
    v_exp_f32 v205, v205
    v_exp_f32 v206, v206
    v_exp_f32 v207, v207
    v_mul_f32 v217, v217, v220
    v_cvt_pk_bf16_f32 v208, v192, v193
    v_cvt_pk_bf16_f32 v209, v194, v195
    v_cvt_pk_bf16_f32 v210, v196, v197
    v_cvt_pk_bf16_f32 v211, v198, v199
    v_cvt_pk_bf16_f32 v212, v200, v201
    v_cvt_pk_bf16_f32 v213, v202, v203
    v_cvt_pk_bf16_f32 v214, v204, v205
    v_cvt_pk_bf16_f32 v215, v206, v207
    v_mul_f32 v64, v64, v220
    v_mul_f32 v65, v65, v220
    v_mul_f32 v66, v66, v220
    v_mul_f32 v67, v67, v220
    v_mul_f32 v68, v68, v220
    v_mul_f32 v69, v69, v220
    v_mul_f32 v70, v70, v220
    v_mul_f32 v71, v71, v220
    v_mul_f32 v72, v72, v220
    v_mul_f32 v73, v73, v220
    v_mul_f32 v74, v74, v220
    v_mul_f32 v75, v75, v220
    v_mul_f32 v76, v76, v220
    v_mul_f32 v77, v77, v220
    v_mul_f32 v78, v78, v220
    v_mul_f32 v79, v79, v220
    s_waitcnt lgkmcnt(0)
    s_barrier
    v_mfma_f32_32x32x16_bf16 v[64:79], a[64:67], v[208:211], v[64:79]
    ds_read_b128 v[144:147], v29 offset:16384
    v_mul_f32 v80, v80, v220
    v_mul_f32 v81, v81, v220
    ds_read_b128 v[148:151], v29 offset:17408
    ds_write_b128 v26, a[224:227] offset:0
    buffer_load_dwordx4 a[220:223], v23, s[32:35], s58 offen nt
    s_add_u32 s58, s58, 16384
    v_mul_f32 v82, v82, v220
    v_mul_f32 v83, v83, v220
    ds_read_b128 v[152:155], v29 offset:18432
    v_mul_f32 v84, v84, v220
    v_mfma_f32_32x32x16_bf16 v[64:79], a[68:71], v[212:215], v[64:79]
    v_mul_f32 v85, v85, v220
    ds_read_b128 v[156:159], v29 offset:19456
    v_mul_f32 v86, v86, v220
    ds_write_b128 v26, a[228:231] offset:1024
    v_mul_f32 v87, v87, v220
    v_mul_f32 v88, v88, v220
    v_mul_f32 v89, v89, v220
    v_mul_f32 v90, v90, v220
    v_mul_f32 v91, v91, v220
    v_mul_f32 v92, v92, v220
    v_mul_f32 v93, v93, v220
    v_mul_f32 v94, v94, v220
    v_mul_f32 v95, v95, v220
    s_nop 1
    v_mfma_f32_32x32x16_bf16 v[80:95], a[72:75], v[208:211], v[80:95]
    ds_read_b128 v[160:163], v30 offset:16384
    v_mul_f32 v96, v96, v220
    v_mul_f32 v97, v97, v220
    ds_read_b128 v[164:167], v30 offset:17408
    ds_write_b128 v26, a[232:235] offset:2048
    buffer_load_dwordx4 a[224:227], v20, s[32:35], s58 offen nt
    v_mul_f32 v98, v98, v220
    v_mul_f32 v99, v99, v220
    ds_read_b128 v[168:171], v30 offset:18432
    v_mul_f32 v100, v100, v220
    v_mfma_f32_32x32x16_bf16 v[80:95], a[76:79], v[212:215], v[80:95]
    v_mul_f32 v101, v101, v220
    ds_read_b128 v[172:175], v30 offset:19456
    v_mul_f32 v102, v102, v220
    ds_write_b128 v26, a[236:239] offset:3072
    v_mul_f32 v103, v103, v220
    v_mul_f32 v104, v104, v220
    v_mul_f32 v105, v105, v220
    v_mul_f32 v106, v106, v220
    v_mul_f32 v107, v107, v220
    v_mul_f32 v108, v108, v220
    v_mul_f32 v109, v109, v220
    v_mul_f32 v110, v110, v220
    v_mul_f32 v111, v111, v220
    s_nop 1
    v_mfma_f32_32x32x16_bf16 v[96:111], a[80:83], v[208:211], v[96:111]
    ds_read_b128 v[176:179], v31 offset:16384
    v_mul_f32 v112, v112, v220
    v_mul_f32 v113, v113, v220
    ds_read_b128 v[180:183], v31 offset:17408
    ds_write_b128 v26, a[240:243] offset:4096
    v_mul_f32 v114, v114, v220
    v_mul_f32 v115, v115, v220
    ds_read_b128 v[184:187], v31 offset:18432
    v_mul_f32 v116, v116, v220
    v_mfma_f32_32x32x16_bf16 v[96:111], a[84:87], v[212:215], v[96:111]
    v_mul_f32 v117, v117, v220
    ds_read_b128 v[188:191], v31 offset:19456
    v_mul_f32 v118, v118, v220
    ds_write_b128 v26, a[244:247] offset:5120
    buffer_load_dwordx4 a[228:231], v21, s[32:35], s58 offen nt
    v_mul_f32 v119, v119, v220
    v_mul_f32 v120, v120, v220
    v_mul_f32 v121, v121, v220
    v_mul_f32 v122, v122, v220
    v_mul_f32 v123, v123, v220
    v_mul_f32 v124, v124, v220
    v_mul_f32 v125, v125, v220
    v_mul_f32 v126, v126, v220
    v_mul_f32 v127, v127, v220
    s_nop 1
    v_mfma_f32_32x32x16_bf16 v[112:127], a[88:91], v[208:211], v[112:127]
    v_add_f32 v192, v192, v200
    v_add_f32 v193, v193, v201
    v_add_f32 v194, v194, v202
    v_add_f32 v195, v195, v203
    ds_write_b128 v26, a[248:251] offset:6144
    v_add_f32 v196, v196, v204
    v_add_f32 v197, v197, v205
    v_add_f32 v198, v198, v206
    v_add_f32 v199, v199, v207
    v_mfma_f32_32x32x16_bf16 v[112:127], a[92:95], v[212:215], v[112:127]
    v_add_f32 v192, v192, v196
    v_add_f32 v193, v193, v197
    v_add_f32 v194, v194, v198
    ds_write_b128 v26, a[252:255] offset:7168
    v_add_f32 v195, v195, v199
    v_add_f32 v192, v192, v193
    v_add_f32 v194, v194, v195
    v_add_f32 v192, v192, v194
    v_add_f32 v217, v217, v192
    ds_read_b128 a[32:35], v32 offset:16384
    ds_read_b128 a[36:39], v33 offset:16384
    ds_read_b128 a[40:43], v34 offset:16384
    ds_read_b128 a[44:47], v35 offset:16384
    ds_read_b128 a[48:51], v36 offset:16384
    ds_read_b128 a[52:55], v37 offset:16384
    ds_read_b128 a[56:59], v38 offset:16384
    ds_read_b128 a[60:63], v39 offset:16384
    s_waitcnt lgkmcnt(8)
    v_add_f32 v144, v144, v128
    v_add_f32 v145, v145, v129
    v_add_f32 v146, v146, v130
    v_add_f32 v147, v147, v131
    buffer_load_dwordx4 a[232:235], v22, s[32:35], s58 offen nt
    v_add_f32 v148, v148, v132
    v_add_f32 v149, v149, v133
    v_add_f32 v150, v150, v134
    v_add_f32 v151, v151, v135
    v_add_f32 v152, v152, v136
    v_add_f32 v153, v153, v137
    v_add_f32 v154, v154, v138
    v_add_f32 v155, v155, v139
    v_add_f32 v156, v156, v140
    v_add_f32 v157, v157, v141
    v_add_f32 v158, v158, v142
    v_add_f32 v159, v159, v143
    s_waitcnt lgkmcnt(0)
    v_mfma_f32_32x32x16_bf16 v[128:143], a[32:35], a[0:3], 0
    ds_read_b64_tr_b16 a[64:65], v40 offset:8192
    ds_read_b64_tr_b16 a[66:67], v41 offset:10240
    v_add_f32 v160, v160, v176
    v_add_f32 v161, v161, v177
    v_add_f32 v162, v162, v178
    v_add_f32 v163, v163, v179
    v_add_f32 v164, v164, v180
    v_mfma_f32_32x32x16_bf16 v[128:143], a[36:39], a[4:7], v[128:143]
    ds_read_b64_tr_b16 a[72:73], v42 offset:8192
    ds_read_b64_tr_b16 a[74:75], v43 offset:10240
    v_add_f32 v165, v165, v181
    v_add_f32 v166, v166, v182
    v_add_f32 v167, v167, v183
    v_add_f32 v168, v168, v184
    v_add_f32 v169, v169, v185
    v_mfma_f32_32x32x16_bf16 v[128:143], a[40:43], a[8:11], v[128:143]
    ds_read_b64_tr_b16 a[80:81], v44 offset:8192
    ds_read_b64_tr_b16 a[82:83], v45 offset:10240
    v_add_f32 v170, v170, v186
    v_add_f32 v171, v171, v187
    v_add_f32 v172, v172, v188
    v_add_f32 v173, v173, v189
    v_add_f32 v174, v174, v190
    v_mfma_f32_32x32x16_bf16 v[128:143], a[44:47], a[12:15], v[128:143]
    ds_read_b64_tr_b16 a[88:89], v46 offset:8192
    ds_read_b64_tr_b16 a[90:91], v47 offset:10240
    v_add_f32 v175, v175, v191
    v_add_f32 v144, v144, v160
    v_add_f32 v145, v145, v161
    v_add_f32 v146, v146, v162
    v_add_f32 v147, v147, v163
    v_mfma_f32_32x32x16_bf16 v[128:143], a[48:51], a[16:19], v[128:143]
    ds_read_b64_tr_b16 a[68:69], v40 offset:12288
    ds_read_b64_tr_b16 a[70:71], v41 offset:14336
    v_add_f32 v148, v148, v164
    v_add_f32 v149, v149, v165
    v_add_f32 v150, v150, v166
    v_add_f32 v151, v151, v167
    v_add_f32 v152, v152, v168
    v_mfma_f32_32x32x16_bf16 v[128:143], a[52:55], a[20:23], v[128:143]
    ds_read_b64_tr_b16 a[76:77], v42 offset:12288
    ds_read_b64_tr_b16 a[78:79], v43 offset:14336
    v_add_f32 v153, v153, v169
    v_add_f32 v154, v154, v170
    v_add_f32 v155, v155, v171
    v_add_f32 v156, v156, v172
    v_add_f32 v157, v157, v173
    v_mfma_f32_32x32x16_bf16 v[128:143], a[56:59], a[24:27], v[128:143]
    ds_read_b64_tr_b16 a[84:85], v44 offset:12288
    ds_read_b64_tr_b16 a[86:87], v45 offset:14336
    v_add_f32 v158, v158, v174
    v_add_f32 v159, v159, v175
    v_max3_f32 v218, v144, v145, v146
    v_max3_f32 v219, v147, v148, v149
    v_max3_f32 v220, v150, v151, v152
    v_mfma_f32_32x32x16_bf16 v[128:143], a[60:63], a[28:31], v[128:143]
    ds_read_b64_tr_b16 a[92:93], v46 offset:12288
    ds_read_b64_tr_b16 a[94:95], v47 offset:14336
    v_max3_f32 v221, v153, v154, v155
    v_max3_f32 v218, v218, v156, v157
    v_max3_f32 v219, v219, v158, v159
    v_max3_f32 v218, v218, v219, v220
    v_max_f32 v218, v218, v221
    v_mov_b32 v219, v218
    s_nop 1
    v_permlane32_swap_b32 v218, v219
    v_max3_f32 v218, v218, v219, v216
    v_sub_f32 v220, v216, v218
    v_mov_b32 v216, v218
    v_exp_f32 v220, v220
    v_sub_f32 v192, v144, v218
    v_sub_f32 v193, v145, v218
    buffer_load_dwordx4 a[236:239], v23, s[32:35], s58 offen nt
    s_add_u32 s58, s58, 16384
    v_sub_f32 v194, v146, v218
    v_sub_f32 v195, v147, v218
    v_sub_f32 v196, v148, v218
    v_sub_f32 v197, v149, v218
    v_sub_f32 v198, v150, v218
    buffer_load_dwordx4 a[240:243], v20, s[32:35], s58 offen nt
    v_sub_f32 v199, v151, v218
    v_sub_f32 v200, v152, v218
    v_sub_f32 v201, v153, v218
    v_sub_f32 v202, v154, v218
    v_sub_f32 v203, v155, v218
    v_sub_f32 v204, v156, v218
    v_sub_f32 v205, v157, v218
    v_sub_f32 v206, v158, v218
    v_sub_f32 v207, v159, v218
    ds_write_b128 v28, v[128:131] offset:0
    v_exp_f32 v192, v192
    v_exp_f32 v193, v193
    v_exp_f32 v194, v194
    v_exp_f32 v195, v195
    ds_write_b128 v28, v[132:135] offset:1024
    v_exp_f32 v196, v196
    v_exp_f32 v197, v197
    v_exp_f32 v198, v198
    v_exp_f32 v199, v199
    ds_write_b128 v28, v[136:139] offset:2048
    v_exp_f32 v200, v200
    v_exp_f32 v201, v201
    v_exp_f32 v202, v202
    v_exp_f32 v203, v203
    ds_write_b128 v28, v[140:143] offset:3072
    v_exp_f32 v204, v204
    v_exp_f32 v205, v205
    v_exp_f32 v206, v206
    v_exp_f32 v207, v207
    v_mul_f32 v217, v217, v220
    v_cvt_pk_bf16_f32 v208, v192, v193
    v_cvt_pk_bf16_f32 v209, v194, v195
    v_cvt_pk_bf16_f32 v210, v196, v197
    v_cvt_pk_bf16_f32 v211, v198, v199
    v_cvt_pk_bf16_f32 v212, v200, v201
    v_cvt_pk_bf16_f32 v213, v202, v203
    v_cvt_pk_bf16_f32 v214, v204, v205
    v_cvt_pk_bf16_f32 v215, v206, v207
    v_mul_f32 v64, v64, v220
    v_mul_f32 v65, v65, v220
    v_mul_f32 v66, v66, v220
    v_mul_f32 v67, v67, v220
    v_mul_f32 v68, v68, v220
    v_mul_f32 v69, v69, v220
    v_mul_f32 v70, v70, v220
    v_mul_f32 v71, v71, v220
    v_mul_f32 v72, v72, v220
    v_mul_f32 v73, v73, v220
    v_mul_f32 v74, v74, v220
    v_mul_f32 v75, v75, v220
    v_mul_f32 v76, v76, v220
    v_mul_f32 v77, v77, v220
    v_mul_f32 v78, v78, v220
    v_mul_f32 v79, v79, v220
    s_waitcnt lgkmcnt(0)
    s_barrier
    v_mfma_f32_32x32x16_bf16 v[64:79], a[64:67], v[208:211], v[64:79]
    ds_read_b128 v[144:147], v29 offset:0
    v_mul_f32 v80, v80, v220
    v_mul_f32 v81, v81, v220
    ds_read_b128 v[148:151], v29 offset:1024
    ds_write_b128 v26, v[224:227] offset:8192
    buffer_load_dwordx4 a[244:247], v21, s[32:35], s58 offen nt
    v_mul_f32 v82, v82, v220
    v_mul_f32 v83, v83, v220
    ds_read_b128 v[152:155], v29 offset:2048
    v_mul_f32 v84, v84, v220
    v_mfma_f32_32x32x16_bf16 v[64:79], a[68:71], v[212:215], v[64:79]
    v_mul_f32 v85, v85, v220
    ds_read_b128 v[156:159], v29 offset:3072
    v_mul_f32 v86, v86, v220
    ds_write_b128 v26, v[228:231] offset:9216
    v_mul_f32 v87, v87, v220
    v_mul_f32 v88, v88, v220
    v_mul_f32 v89, v89, v220
    v_mul_f32 v90, v90, v220
    v_mul_f32 v91, v91, v220
    v_mul_f32 v92, v92, v220
    v_mul_f32 v93, v93, v220
    v_mul_f32 v94, v94, v220
    v_mul_f32 v95, v95, v220
    s_nop 1
    v_mfma_f32_32x32x16_bf16 v[80:95], a[72:75], v[208:211], v[80:95]
    ds_read_b128 v[160:163], v30 offset:0
    v_mul_f32 v96, v96, v220
    v_mul_f32 v97, v97, v220
    ds_read_b128 v[164:167], v30 offset:1024
    ds_write_b128 v26, v[232:235] offset:10240
    buffer_load_dwordx4 a[248:251], v22, s[32:35], s58 offen nt
    v_mul_f32 v98, v98, v220
    v_mul_f32 v99, v99, v220
    ds_read_b128 v[168:171], v30 offset:2048
    v_mul_f32 v100, v100, v220
    v_mfma_f32_32x32x16_bf16 v[80:95], a[76:79], v[212:215], v[80:95]
    v_mul_f32 v101, v101, v220
    ds_read_b128 v[172:175], v30 offset:3072
    v_mul_f32 v102, v102, v220
    ds_write_b128 v26, v[236:239] offset:11264
    v_mul_f32 v103, v103, v220
    v_mul_f32 v104, v104, v220
    v_mul_f32 v105, v105, v220
    v_mul_f32 v106, v106, v220
    v_mul_f32 v107, v107, v220
    v_mul_f32 v108, v108, v220
    v_mul_f32 v109, v109, v220
    v_mul_f32 v110, v110, v220
    v_mul_f32 v111, v111, v220
    s_nop 1
    v_mfma_f32_32x32x16_bf16 v[96:111], a[80:83], v[208:211], v[96:111]
    ds_read_b128 v[176:179], v31 offset:0
    v_mul_f32 v112, v112, v220
    v_mul_f32 v113, v113, v220
    ds_read_b128 v[180:183], v31 offset:1024
    ds_write_b128 v26, v[240:243] offset:12288
    v_mul_f32 v114, v114, v220
    v_mul_f32 v115, v115, v220
    ds_read_b128 v[184:187], v31 offset:2048
    v_mul_f32 v116, v116, v220
    v_mfma_f32_32x32x16_bf16 v[96:111], a[84:87], v[212:215], v[96:111]
    v_mul_f32 v117, v117, v220
    ds_read_b128 v[188:191], v31 offset:3072
    v_mul_f32 v118, v118, v220
    ds_write_b128 v26, v[244:247] offset:13312
    buffer_load_dwordx4 a[252:255], v23, s[32:35], s58 offen nt
    s_add_u32 s58, s58, 16384
    v_mul_f32 v119, v119, v220
    v_mul_f32 v120, v120, v220
    v_mul_f32 v121, v121, v220
    v_mul_f32 v122, v122, v220
    v_mul_f32 v123, v123, v220
    v_mul_f32 v124, v124, v220
    v_mul_f32 v125, v125, v220
    v_mul_f32 v126, v126, v220
    v_mul_f32 v127, v127, v220
    s_nop 1
    v_mfma_f32_32x32x16_bf16 v[112:127], a[88:91], v[208:211], v[112:127]
    v_add_f32 v192, v192, v200
    v_add_f32 v193, v193, v201
    v_add_f32 v194, v194, v202
    v_add_f32 v195, v195, v203
    ds_write_b128 v26, v[248:251] offset:14336
    v_add_f32 v196, v196, v204
    v_add_f32 v197, v197, v205
    v_add_f32 v198, v198, v206
    v_add_f32 v199, v199, v207
    v_mfma_f32_32x32x16_bf16 v[112:127], a[92:95], v[212:215], v[112:127]
    v_add_f32 v192, v192, v196
    v_add_f32 v193, v193, v197
    v_add_f32 v194, v194, v198
    ds_write_b128 v26, v[252:255] offset:15360
    v_add_f32 v195, v195, v199
    v_add_f32 v192, v192, v193
    v_add_f32 v194, v194, v195
    v_add_f32 v192, v192, v194
    v_add_f32 v217, v217, v192
    ds_read_b128 a[32:35], v32 offset:24576
    ds_read_b128 a[36:39], v33 offset:24576
    ds_read_b128 a[40:43], v34 offset:24576
    ds_read_b128 a[44:47], v35 offset:24576
    ds_read_b128 a[48:51], v36 offset:24576
    ds_read_b128 a[52:55], v37 offset:24576
    ds_read_b128 a[56:59], v38 offset:24576
    ds_read_b128 a[60:63], v39 offset:24576
    s_waitcnt lgkmcnt(8)
    v_add_f32 v144, v144, v128
    v_add_f32 v145, v145, v129
    v_add_f32 v146, v146, v130
    v_add_f32 v147, v147, v131
    buffer_load_dwordx4 v[224:227], v20, s[32:35], s58 offen nt
    v_add_f32 v148, v148, v132
    v_add_f32 v149, v149, v133
    v_add_f32 v150, v150, v134
    v_add_f32 v151, v151, v135
    v_add_f32 v152, v152, v136
    v_add_f32 v153, v153, v137
    v_add_f32 v154, v154, v138
    v_add_f32 v155, v155, v139
    v_add_f32 v156, v156, v140
    v_add_f32 v157, v157, v141
    v_add_f32 v158, v158, v142
    v_add_f32 v159, v159, v143
    s_waitcnt lgkmcnt(0)
    v_mfma_f32_32x32x16_bf16 v[128:143], a[32:35], a[0:3], 0
    ds_read_b64_tr_b16 a[64:65], v40 offset:16384
    ds_read_b64_tr_b16 a[66:67], v41 offset:18432
    v_add_f32 v160, v160, v176
    v_add_f32 v161, v161, v177
    v_add_f32 v162, v162, v178
    v_add_f32 v163, v163, v179
    v_add_f32 v164, v164, v180
    v_mfma_f32_32x32x16_bf16 v[128:143], a[36:39], a[4:7], v[128:143]
    ds_read_b64_tr_b16 a[72:73], v42 offset:16384
    ds_read_b64_tr_b16 a[74:75], v43 offset:18432
    v_add_f32 v165, v165, v181
    v_add_f32 v166, v166, v182
    v_add_f32 v167, v167, v183
    v_add_f32 v168, v168, v184
    v_add_f32 v169, v169, v185
    v_mfma_f32_32x32x16_bf16 v[128:143], a[40:43], a[8:11], v[128:143]
    ds_read_b64_tr_b16 a[80:81], v44 offset:16384
    ds_read_b64_tr_b16 a[82:83], v45 offset:18432
    v_add_f32 v170, v170, v186
    v_add_f32 v171, v171, v187
    v_add_f32 v172, v172, v188
    v_add_f32 v173, v173, v189
    v_add_f32 v174, v174, v190
    v_mfma_f32_32x32x16_bf16 v[128:143], a[44:47], a[12:15], v[128:143]
    ds_read_b64_tr_b16 a[88:89], v46 offset:16384
    ds_read_b64_tr_b16 a[90:91], v47 offset:18432
    v_add_f32 v175, v175, v191
    v_add_f32 v144, v144, v160
    v_add_f32 v145, v145, v161
    v_add_f32 v146, v146, v162
    v_add_f32 v147, v147, v163
    v_mfma_f32_32x32x16_bf16 v[128:143], a[48:51], a[16:19], v[128:143]
    ds_read_b64_tr_b16 a[68:69], v40 offset:20480
    ds_read_b64_tr_b16 a[70:71], v41 offset:22528
    v_add_f32 v148, v148, v164
    v_add_f32 v149, v149, v165
    v_add_f32 v150, v150, v166
    v_add_f32 v151, v151, v167
    v_add_f32 v152, v152, v168
    v_mfma_f32_32x32x16_bf16 v[128:143], a[52:55], a[20:23], v[128:143]
    ds_read_b64_tr_b16 a[76:77], v42 offset:20480
    ds_read_b64_tr_b16 a[78:79], v43 offset:22528
    v_add_f32 v153, v153, v169
    v_add_f32 v154, v154, v170
    v_add_f32 v155, v155, v171
    v_add_f32 v156, v156, v172
    v_add_f32 v157, v157, v173
    v_mfma_f32_32x32x16_bf16 v[128:143], a[56:59], a[24:27], v[128:143]
    ds_read_b64_tr_b16 a[84:85], v44 offset:20480
    ds_read_b64_tr_b16 a[86:87], v45 offset:22528
    v_add_f32 v158, v158, v174
    v_add_f32 v159, v159, v175
    v_max3_f32 v218, v144, v145, v146
    v_max3_f32 v219, v147, v148, v149
    v_max3_f32 v220, v150, v151, v152
    v_mfma_f32_32x32x16_bf16 v[128:143], a[60:63], a[28:31], v[128:143]
    ds_read_b64_tr_b16 a[92:93], v46 offset:20480
    ds_read_b64_tr_b16 a[94:95], v47 offset:22528
    v_max3_f32 v221, v153, v154, v155
    v_max3_f32 v218, v218, v156, v157
    v_max3_f32 v219, v219, v158, v159
    v_max3_f32 v218, v218, v219, v220
    v_max_f32 v218, v218, v221
    v_mov_b32 v219, v218
    s_nop 1
    v_permlane32_swap_b32 v218, v219
    v_max3_f32 v218, v218, v219, v216
    v_sub_f32 v220, v216, v218
    v_mov_b32 v216, v218
    v_exp_f32 v220, v220
    v_sub_f32 v192, v144, v218
    v_sub_f32 v193, v145, v218
    buffer_load_dwordx4 v[228:231], v21, s[32:35], s58 offen nt
    v_sub_f32 v194, v146, v218
    v_sub_f32 v195, v147, v218
    v_sub_f32 v196, v148, v218
    v_sub_f32 v197, v149, v218
    v_sub_f32 v198, v150, v218
    buffer_load_dwordx4 v[232:235], v22, s[32:35], s58 offen nt
    v_sub_f32 v199, v151, v218
    v_sub_f32 v200, v152, v218
    v_sub_f32 v201, v153, v218
    v_sub_f32 v202, v154, v218
    v_sub_f32 v203, v155, v218
    v_sub_f32 v204, v156, v218
    v_sub_f32 v205, v157, v218
    v_sub_f32 v206, v158, v218
    v_sub_f32 v207, v159, v218
    ds_write_b128 v28, v[128:131] offset:16384
    v_exp_f32 v192, v192
    v_exp_f32 v193, v193
    v_exp_f32 v194, v194
    v_exp_f32 v195, v195
    ds_write_b128 v28, v[132:135] offset:17408
    v_exp_f32 v196, v196
    v_exp_f32 v197, v197
    v_exp_f32 v198, v198
    v_exp_f32 v199, v199
    ds_write_b128 v28, v[136:139] offset:18432
    v_exp_f32 v200, v200
    v_exp_f32 v201, v201
    v_exp_f32 v202, v202
    v_exp_f32 v203, v203
    ds_write_b128 v28, v[140:143] offset:19456
    v_exp_f32 v204, v204
    v_exp_f32 v205, v205
    v_exp_f32 v206, v206
    v_exp_f32 v207, v207
    v_mul_f32 v217, v217, v220
    v_cvt_pk_bf16_f32 v208, v192, v193
    v_cvt_pk_bf16_f32 v209, v194, v195
    v_cvt_pk_bf16_f32 v210, v196, v197
    v_cvt_pk_bf16_f32 v211, v198, v199
    v_cvt_pk_bf16_f32 v212, v200, v201
    v_cvt_pk_bf16_f32 v213, v202, v203
    v_cvt_pk_bf16_f32 v214, v204, v205
    v_cvt_pk_bf16_f32 v215, v206, v207
    v_mul_f32 v64, v64, v220
    v_mul_f32 v65, v65, v220
    v_mul_f32 v66, v66, v220
    v_mul_f32 v67, v67, v220
    v_mul_f32 v68, v68, v220
    v_mul_f32 v69, v69, v220
    v_mul_f32 v70, v70, v220
    v_mul_f32 v71, v71, v220
    v_mul_f32 v72, v72, v220
    v_mul_f32 v73, v73, v220
    v_mul_f32 v74, v74, v220
    v_mul_f32 v75, v75, v220
    v_mul_f32 v76, v76, v220
    v_mul_f32 v77, v77, v220
    v_mul_f32 v78, v78, v220
    v_mul_f32 v79, v79, v220
    s_waitcnt lgkmcnt(0)
    s_barrier
    v_mfma_f32_32x32x16_bf16 v[64:79], a[64:67], v[208:211], v[64:79]
    ds_read_b128 v[144:147], v29 offset:16384
    v_mul_f32 v80, v80, v220
    v_mul_f32 v81, v81, v220
    ds_read_b128 v[148:151], v29 offset:17408
    buffer_load_dwordx4 v[236:239], v23, s[32:35], s58 offen nt
    s_add_u32 s58, s58, 16384
    v_mul_f32 v82, v82, v220
    v_mul_f32 v83, v83, v220
    ds_read_b128 v[152:155], v29 offset:18432
    v_mul_f32 v84, v84, v220
    v_mfma_f32_32x32x16_bf16 v[64:79], a[68:71], v[212:215], v[64:79]
    v_mul_f32 v85, v85, v220
    ds_read_b128 v[156:159], v29 offset:19456
    v_mul_f32 v86, v86, v220
    v_mul_f32 v87, v87, v220
    v_mul_f32 v88, v88, v220
    v_mul_f32 v89, v89, v220
    v_mul_f32 v90, v90, v220
    v_mul_f32 v91, v91, v220
    v_mul_f32 v92, v92, v220
    v_mul_f32 v93, v93, v220
    v_mul_f32 v94, v94, v220
    v_mul_f32 v95, v95, v220
    s_nop 1
    v_mfma_f32_32x32x16_bf16 v[80:95], a[72:75], v[208:211], v[80:95]
    ds_read_b128 v[160:163], v30 offset:16384
    v_mul_f32 v96, v96, v220
    v_mul_f32 v97, v97, v220
    ds_read_b128 v[164:167], v30 offset:17408
    buffer_load_dwordx4 v[240:243], v20, s[32:35], s58 offen nt
    v_mul_f32 v98, v98, v220
    v_mul_f32 v99, v99, v220
    ds_read_b128 v[168:171], v30 offset:18432
    v_mul_f32 v100, v100, v220
    v_mfma_f32_32x32x16_bf16 v[80:95], a[76:79], v[212:215], v[80:95]
    v_mul_f32 v101, v101, v220
    ds_read_b128 v[172:175], v30 offset:19456
    v_mul_f32 v102, v102, v220
    v_mul_f32 v103, v103, v220
    v_mul_f32 v104, v104, v220
    v_mul_f32 v105, v105, v220
    v_mul_f32 v106, v106, v220
    v_mul_f32 v107, v107, v220
    v_mul_f32 v108, v108, v220
    v_mul_f32 v109, v109, v220
    v_mul_f32 v110, v110, v220
    v_mul_f32 v111, v111, v220
    s_nop 1
    v_mfma_f32_32x32x16_bf16 v[96:111], a[80:83], v[208:211], v[96:111]
    ds_read_b128 v[176:179], v31 offset:16384
    v_mul_f32 v112, v112, v220
    v_mul_f32 v113, v113, v220
    ds_read_b128 v[180:183], v31 offset:17408
    v_mul_f32 v114, v114, v220
    v_mul_f32 v115, v115, v220
    ds_read_b128 v[184:187], v31 offset:18432
    v_mul_f32 v116, v116, v220
    v_mfma_f32_32x32x16_bf16 v[96:111], a[84:87], v[212:215], v[96:111]
    v_mul_f32 v117, v117, v220
    ds_read_b128 v[188:191], v31 offset:19456
    v_mul_f32 v118, v118, v220
    buffer_load_dwordx4 v[244:247], v21, s[32:35], s58 offen nt
    v_mul_f32 v119, v119, v220
    v_mul_f32 v120, v120, v220
    v_mul_f32 v121, v121, v220
    v_mul_f32 v122, v122, v220
    v_mul_f32 v123, v123, v220
    v_mul_f32 v124, v124, v220
    v_mul_f32 v125, v125, v220
    v_mul_f32 v126, v126, v220
    v_mul_f32 v127, v127, v220
    s_nop 1
    v_mfma_f32_32x32x16_bf16 v[112:127], a[88:91], v[208:211], v[112:127]
    v_add_f32 v192, v192, v200
    v_add_f32 v193, v193, v201
    v_add_f32 v194, v194, v202
    v_add_f32 v195, v195, v203
    v_add_f32 v196, v196, v204
    v_add_f32 v197, v197, v205
    v_add_f32 v198, v198, v206
    v_add_f32 v199, v199, v207
    v_mfma_f32_32x32x16_bf16 v[112:127], a[92:95], v[212:215], v[112:127]
    v_add_f32 v192, v192, v196
    v_add_f32 v193, v193, v197
    v_add_f32 v194, v194, v198
    v_add_f32 v195, v195, v199
    v_add_f32 v192, v192, v193
    v_add_f32 v194, v194, v195
    v_add_f32 v192, v192, v194
    v_add_f32 v217, v217, v192
    ds_read_b128 a[32:35], v32 offset:0
    ds_read_b128 a[36:39], v33 offset:0
    ds_read_b128 a[40:43], v34 offset:0
    ds_read_b128 a[44:47], v35 offset:0
    ds_read_b128 a[48:51], v36 offset:0
    ds_read_b128 a[52:55], v37 offset:0
    ds_read_b128 a[56:59], v38 offset:0
    ds_read_b128 a[60:63], v39 offset:0
    s_waitcnt lgkmcnt(8)
    v_add_f32 v144, v144, v128
    v_add_f32 v145, v145, v129
    v_add_f32 v146, v146, v130
    v_add_f32 v147, v147, v131
    buffer_load_dwordx4 v[248:251], v22, s[32:35], s58 offen nt
    v_add_f32 v148, v148, v132
    v_add_f32 v149, v149, v133
    v_add_f32 v150, v150, v134
    v_add_f32 v151, v151, v135
    v_add_f32 v152, v152, v136
    v_add_f32 v153, v153, v137
    v_add_f32 v154, v154, v138
    v_add_f32 v155, v155, v139
    v_add_f32 v156, v156, v140
    v_add_f32 v157, v157, v141
    v_add_f32 v158, v158, v142
    v_add_f32 v159, v159, v143
    s_waitcnt lgkmcnt(0)
    v_mfma_f32_32x32x16_bf16 v[128:143], a[32:35], a[0:3], 0
    ds_read_b64_tr_b16 a[64:65], v40 offset:24576
    ds_read_b64_tr_b16 a[66:67], v41 offset:26624
    v_add_f32 v160, v160, v176
    v_add_f32 v161, v161, v177
    v_add_f32 v162, v162, v178
    v_add_f32 v163, v163, v179
    v_add_f32 v164, v164, v180
    v_mfma_f32_32x32x16_bf16 v[128:143], a[36:39], a[4:7], v[128:143]
    ds_read_b64_tr_b16 a[72:73], v42 offset:24576
    ds_read_b64_tr_b16 a[74:75], v43 offset:26624
    v_add_f32 v165, v165, v181
    v_add_f32 v166, v166, v182
    v_add_f32 v167, v167, v183
    v_add_f32 v168, v168, v184
    v_add_f32 v169, v169, v185
    v_mfma_f32_32x32x16_bf16 v[128:143], a[40:43], a[8:11], v[128:143]
    ds_read_b64_tr_b16 a[80:81], v44 offset:24576
    ds_read_b64_tr_b16 a[82:83], v45 offset:26624
    v_add_f32 v170, v170, v186
    v_add_f32 v171, v171, v187
    v_add_f32 v172, v172, v188
    v_add_f32 v173, v173, v189
    v_add_f32 v174, v174, v190
    v_mfma_f32_32x32x16_bf16 v[128:143], a[44:47], a[12:15], v[128:143]
    ds_read_b64_tr_b16 a[88:89], v46 offset:24576
    ds_read_b64_tr_b16 a[90:91], v47 offset:26624
    v_add_f32 v175, v175, v191
    v_add_f32 v144, v144, v160
    v_add_f32 v145, v145, v161
    v_add_f32 v146, v146, v162
    v_add_f32 v147, v147, v163
    v_mfma_f32_32x32x16_bf16 v[128:143], a[48:51], a[16:19], v[128:143]
    ds_read_b64_tr_b16 a[68:69], v40 offset:28672
    ds_read_b64_tr_b16 a[70:71], v41 offset:30720
    v_add_f32 v148, v148, v164
    v_add_f32 v149, v149, v165
    v_add_f32 v150, v150, v166
    v_add_f32 v151, v151, v167
    v_add_f32 v152, v152, v168
    v_mfma_f32_32x32x16_bf16 v[128:143], a[52:55], a[20:23], v[128:143]
    ds_read_b64_tr_b16 a[76:77], v42 offset:28672
    ds_read_b64_tr_b16 a[78:79], v43 offset:30720
    v_add_f32 v153, v153, v169
    v_add_f32 v154, v154, v170
    v_add_f32 v155, v155, v171
    v_add_f32 v156, v156, v172
    v_add_f32 v157, v157, v173
    v_mfma_f32_32x32x16_bf16 v[128:143], a[56:59], a[24:27], v[128:143]
    ds_read_b64_tr_b16 a[84:85], v44 offset:28672
    ds_read_b64_tr_b16 a[86:87], v45 offset:30720
    v_add_f32 v158, v158, v174
    v_add_f32 v159, v159, v175
    v_max3_f32 v218, v144, v145, v146
    v_max3_f32 v219, v147, v148, v149
    v_max3_f32 v220, v150, v151, v152
    v_mfma_f32_32x32x16_bf16 v[128:143], a[60:63], a[28:31], v[128:143]
    ds_read_b64_tr_b16 a[92:93], v46 offset:28672
    ds_read_b64_tr_b16 a[94:95], v47 offset:30720
    v_max3_f32 v221, v153, v154, v155
    v_max3_f32 v218, v218, v156, v157
    v_max3_f32 v219, v219, v158, v159
    v_max3_f32 v218, v218, v219, v220
    v_max_f32 v218, v218, v221
    v_mov_b32 v219, v218
    s_nop 1
    v_permlane32_swap_b32 v218, v219
    v_max3_f32 v218, v218, v219, v216
    v_sub_f32 v220, v216, v218
    v_mov_b32 v216, v218
    v_exp_f32 v220, v220
    v_sub_f32 v192, v144, v218
    v_sub_f32 v193, v145, v218
    buffer_load_dwordx4 v[252:255], v23, s[32:35], s58 offen nt
    s_add_u32 s58, s58, 16384
    v_sub_f32 v194, v146, v218
    v_sub_f32 v195, v147, v218
    v_sub_f32 v196, v148, v218
    v_sub_f32 v197, v149, v218
    v_sub_f32 v198, v150, v218
    v_sub_f32 v199, v151, v218
    v_sub_f32 v200, v152, v218
    v_sub_f32 v201, v153, v218
    v_sub_f32 v202, v154, v218
    v_sub_f32 v203, v155, v218
    v_sub_f32 v204, v156, v218
    v_sub_f32 v205, v157, v218
    v_sub_f32 v206, v158, v218
    v_sub_f32 v207, v159, v218
    ds_write_b128 v28, v[128:131] offset:0
    v_exp_f32 v192, v192
    v_exp_f32 v193, v193
    v_exp_f32 v194, v194
    v_exp_f32 v195, v195
    ds_write_b128 v28, v[132:135] offset:1024
    v_exp_f32 v196, v196
    v_exp_f32 v197, v197
    v_exp_f32 v198, v198
    v_exp_f32 v199, v199
    ds_write_b128 v28, v[136:139] offset:2048
    v_exp_f32 v200, v200
    v_exp_f32 v201, v201
    v_exp_f32 v202, v202
    v_exp_f32 v203, v203
    ds_write_b128 v28, v[140:143] offset:3072
    v_exp_f32 v204, v204
    v_exp_f32 v205, v205
    v_exp_f32 v206, v206
    v_exp_f32 v207, v207
    v_mul_f32 v217, v217, v220
    v_cvt_pk_bf16_f32 v208, v192, v193
    v_cvt_pk_bf16_f32 v209, v194, v195
    v_cvt_pk_bf16_f32 v210, v196, v197
    v_cvt_pk_bf16_f32 v211, v198, v199
    v_cvt_pk_bf16_f32 v212, v200, v201
    v_cvt_pk_bf16_f32 v213, v202, v203
    v_cvt_pk_bf16_f32 v214, v204, v205
    v_cvt_pk_bf16_f32 v215, v206, v207
    v_mul_f32 v64, v64, v220
    v_mul_f32 v65, v65, v220
    v_mul_f32 v66, v66, v220
    v_mul_f32 v67, v67, v220
    v_mul_f32 v68, v68, v220
    v_mul_f32 v69, v69, v220
    v_mul_f32 v70, v70, v220
    v_mul_f32 v71, v71, v220
    v_mul_f32 v72, v72, v220
    v_mul_f32 v73, v73, v220
    v_mul_f32 v74, v74, v220
    v_mul_f32 v75, v75, v220
    v_mul_f32 v76, v76, v220
    v_mul_f32 v77, v77, v220
    v_mul_f32 v78, v78, v220
    v_mul_f32 v79, v79, v220
    s_waitcnt lgkmcnt(0)
    s_barrier
    v_mfma_f32_32x32x16_bf16 v[64:79], a[64:67], v[208:211], v[64:79]
    ds_read_b128 v[144:147], v29 offset:0
    v_mul_f32 v80, v80, v220
    v_mul_f32 v81, v81, v220
    ds_read_b128 v[148:151], v29 offset:1024
    v_mul_f32 v82, v82, v220
    v_mul_f32 v83, v83, v220
    ds_read_b128 v[152:155], v29 offset:2048
    v_mul_f32 v84, v84, v220
    v_mfma_f32_32x32x16_bf16 v[64:79], a[68:71], v[212:215], v[64:79]
    v_mul_f32 v85, v85, v220
    ds_read_b128 v[156:159], v29 offset:3072
    v_mul_f32 v86, v86, v220
    v_mul_f32 v87, v87, v220
    v_mul_f32 v88, v88, v220
    v_mul_f32 v89, v89, v220
    v_mul_f32 v90, v90, v220
    v_mul_f32 v91, v91, v220
    v_mul_f32 v92, v92, v220
    v_mul_f32 v93, v93, v220
    v_mul_f32 v94, v94, v220
    v_mul_f32 v95, v95, v220
    s_nop 1
    v_mfma_f32_32x32x16_bf16 v[80:95], a[72:75], v[208:211], v[80:95]
    ds_read_b128 v[160:163], v30 offset:0
    v_mul_f32 v96, v96, v220
    v_mul_f32 v97, v97, v220
    ds_read_b128 v[164:167], v30 offset:1024
    v_mul_f32 v98, v98, v220
    v_mul_f32 v99, v99, v220
    ds_read_b128 v[168:171], v30 offset:2048
    v_mul_f32 v100, v100, v220
    v_mfma_f32_32x32x16_bf16 v[80:95], a[76:79], v[212:215], v[80:95]
    v_mul_f32 v101, v101, v220
    ds_read_b128 v[172:175], v30 offset:3072
    v_mul_f32 v102, v102, v220
    v_mul_f32 v103, v103, v220
    v_mul_f32 v104, v104, v220
    v_mul_f32 v105, v105, v220
    v_mul_f32 v106, v106, v220
    v_mul_f32 v107, v107, v220
    v_mul_f32 v108, v108, v220
    v_mul_f32 v109, v109, v220
    v_mul_f32 v110, v110, v220
    v_mul_f32 v111, v111, v220
    s_nop 1
    v_mfma_f32_32x32x16_bf16 v[96:111], a[80:83], v[208:211], v[96:111]
    ds_read_b128 v[176:179], v31 offset:0
    v_mul_f32 v112, v112, v220
    v_mul_f32 v113, v113, v220
    ds_read_b128 v[180:183], v31 offset:1024
    v_mul_f32 v114, v114, v220
    v_mul_f32 v115, v115, v220
    ds_read_b128 v[184:187], v31 offset:2048
    v_mul_f32 v116, v116, v220
    v_mfma_f32_32x32x16_bf16 v[96:111], a[84:87], v[212:215], v[96:111]
    v_mul_f32 v117, v117, v220
    ds_read_b128 v[188:191], v31 offset:3072
    v_mul_f32 v118, v118, v220
    v_mul_f32 v119, v119, v220
    v_mul_f32 v120, v120, v220
    v_mul_f32 v121, v121, v220
    v_mul_f32 v122, v122, v220
    v_mul_f32 v123, v123, v220
    v_mul_f32 v124, v124, v220
    v_mul_f32 v125, v125, v220
    v_mul_f32 v126, v126, v220
    v_mul_f32 v127, v127, v220
    s_nop 1
    v_mfma_f32_32x32x16_bf16 v[112:127], a[88:91], v[208:211], v[112:127]
    v_add_f32 v192, v192, v200
    v_add_f32 v193, v193, v201
    v_add_f32 v194, v194, v202
    v_add_f32 v195, v195, v203
    v_add_f32 v196, v196, v204
    v_add_f32 v197, v197, v205
    v_add_f32 v198, v198, v206
    v_add_f32 v199, v199, v207
    v_mfma_f32_32x32x16_bf16 v[112:127], a[92:95], v[212:215], v[112:127]
    v_add_f32 v192, v192, v196
    v_add_f32 v193, v193, v197
    v_add_f32 v194, v194, v198
    v_add_f32 v195, v195, v199
    v_add_f32 v192, v192, v193
    v_add_f32 v194, v194, v195
    v_add_f32 v192, v192, v194
    v_add_f32 v217, v217, v192
    ds_read_b128 a[32:35], v32 offset:8192
    ds_read_b128 a[36:39], v33 offset:8192
    ds_read_b128 a[40:43], v34 offset:8192
    ds_read_b128 a[44:47], v35 offset:8192
    ds_read_b128 a[48:51], v36 offset:8192
    ds_read_b128 a[52:55], v37 offset:8192
    ds_read_b128 a[56:59], v38 offset:8192
    ds_read_b128 a[60:63], v39 offset:8192
    s_waitcnt lgkmcnt(8)
    v_add_f32 v144, v144, v128
    v_add_f32 v145, v145, v129
    v_add_f32 v146, v146, v130
    v_add_f32 v147, v147, v131
    v_add_f32 v148, v148, v132
    v_add_f32 v149, v149, v133
    v_add_f32 v150, v150, v134
    v_add_f32 v151, v151, v135
    v_add_f32 v152, v152, v136
    v_add_f32 v153, v153, v137
    v_add_f32 v154, v154, v138
    v_add_f32 v155, v155, v139
    v_add_f32 v156, v156, v140
    v_add_f32 v157, v157, v141
    v_add_f32 v158, v158, v142
    v_add_f32 v159, v159, v143
    s_waitcnt lgkmcnt(0)
    v_mfma_f32_32x32x16_bf16 v[128:143], a[32:35], a[0:3], 0
    ds_read_b64_tr_b16 a[64:65], v40 offset:0
    ds_read_b64_tr_b16 a[66:67], v41 offset:2048
    v_add_f32 v160, v160, v176
    v_add_f32 v161, v161, v177
    v_add_f32 v162, v162, v178
    v_add_f32 v163, v163, v179
    v_add_f32 v164, v164, v180
    v_mfma_f32_32x32x16_bf16 v[128:143], a[36:39], a[4:7], v[128:143]
    ds_read_b64_tr_b16 a[72:73], v42 offset:0
    ds_read_b64_tr_b16 a[74:75], v43 offset:2048
    v_add_f32 v165, v165, v181
    v_add_f32 v166, v166, v182
    v_add_f32 v167, v167, v183
    v_add_f32 v168, v168, v184
    v_add_f32 v169, v169, v185
    v_mfma_f32_32x32x16_bf16 v[128:143], a[40:43], a[8:11], v[128:143]
    ds_read_b64_tr_b16 a[80:81], v44 offset:0
    ds_read_b64_tr_b16 a[82:83], v45 offset:2048
    v_add_f32 v170, v170, v186
    v_add_f32 v171, v171, v187
    v_add_f32 v172, v172, v188
    v_add_f32 v173, v173, v189
    v_add_f32 v174, v174, v190
    v_mfma_f32_32x32x16_bf16 v[128:143], a[44:47], a[12:15], v[128:143]
    ds_read_b64_tr_b16 a[88:89], v46 offset:0
    ds_read_b64_tr_b16 a[90:91], v47 offset:2048
    v_add_f32 v175, v175, v191
    v_add_f32 v144, v144, v160
    v_add_f32 v145, v145, v161
    v_add_f32 v146, v146, v162
    v_add_f32 v147, v147, v163
    v_mfma_f32_32x32x16_bf16 v[128:143], a[48:51], a[16:19], v[128:143]
    ds_read_b64_tr_b16 a[68:69], v40 offset:4096
    ds_read_b64_tr_b16 a[70:71], v41 offset:6144
    v_add_f32 v148, v148, v164
    v_add_f32 v149, v149, v165
    v_add_f32 v150, v150, v166
    v_add_f32 v151, v151, v167
    v_add_f32 v152, v152, v168
    v_mfma_f32_32x32x16_bf16 v[128:143], a[52:55], a[20:23], v[128:143]
    ds_read_b64_tr_b16 a[76:77], v42 offset:4096
    ds_read_b64_tr_b16 a[78:79], v43 offset:6144
    v_add_f32 v153, v153, v169
    v_add_f32 v154, v154, v170
    v_add_f32 v155, v155, v171
    v_add_f32 v156, v156, v172
    v_add_f32 v157, v157, v173
    v_mfma_f32_32x32x16_bf16 v[128:143], a[56:59], a[24:27], v[128:143]
    ds_read_b64_tr_b16 a[84:85], v44 offset:4096
    ds_read_b64_tr_b16 a[86:87], v45 offset:6144
    v_add_f32 v158, v158, v174
    v_add_f32 v159, v159, v175
    v_max3_f32 v218, v144, v145, v146
    v_max3_f32 v219, v147, v148, v149
    v_max3_f32 v220, v150, v151, v152
    v_mfma_f32_32x32x16_bf16 v[128:143], a[60:63], a[28:31], v[128:143]
    ds_read_b64_tr_b16 a[92:93], v46 offset:4096
    ds_read_b64_tr_b16 a[94:95], v47 offset:6144
    v_max3_f32 v221, v153, v154, v155
    v_max3_f32 v218, v218, v156, v157
    v_max3_f32 v219, v219, v158, v159
    v_max3_f32 v218, v218, v219, v220
    v_max_f32 v218, v218, v221
    v_mov_b32 v219, v218
    s_nop 1
    v_permlane32_swap_b32 v218, v219
    v_max3_f32 v218, v218, v219, v216
    v_sub_f32 v220, v216, v218
    v_mov_b32 v216, v218
    v_exp_f32 v220, v220
    v_sub_f32 v192, v144, v218
    v_sub_f32 v193, v145, v218
    v_sub_f32 v194, v146, v218
    v_sub_f32 v195, v147, v218
    v_sub_f32 v196, v148, v218
    v_sub_f32 v197, v149, v218
    v_sub_f32 v198, v150, v218
    v_sub_f32 v199, v151, v218
    v_sub_f32 v200, v152, v218
    v_sub_f32 v201, v153, v218
    v_sub_f32 v202, v154, v218
    v_sub_f32 v203, v155, v218
    v_sub_f32 v204, v156, v218
    v_sub_f32 v205, v157, v218
    v_sub_f32 v206, v158, v218
    v_sub_f32 v207, v159, v218
    ds_write_b128 v28, v[128:131] offset:16384
    v_exp_f32 v192, v192
    v_exp_f32 v193, v193
    v_exp_f32 v194, v194
    v_exp_f32 v195, v195
    ds_write_b128 v28, v[132:135] offset:17408
    v_exp_f32 v196, v196
    v_exp_f32 v197, v197
    v_exp_f32 v198, v198
    v_exp_f32 v199, v199
    ds_write_b128 v28, v[136:139] offset:18432
    v_exp_f32 v200, v200
    v_exp_f32 v201, v201
    v_exp_f32 v202, v202
    v_exp_f32 v203, v203
    ds_write_b128 v28, v[140:143] offset:19456
    v_exp_f32 v204, v204
    v_exp_f32 v205, v205
    v_exp_f32 v206, v206
    v_exp_f32 v207, v207
    v_mul_f32 v217, v217, v220
    v_cvt_pk_bf16_f32 v208, v192, v193
    v_cvt_pk_bf16_f32 v209, v194, v195
    v_cvt_pk_bf16_f32 v210, v196, v197
    v_cvt_pk_bf16_f32 v211, v198, v199
    v_cvt_pk_bf16_f32 v212, v200, v201
    v_cvt_pk_bf16_f32 v213, v202, v203
    v_cvt_pk_bf16_f32 v214, v204, v205
    v_cvt_pk_bf16_f32 v215, v206, v207
    v_mul_f32 v64, v64, v220
    v_mul_f32 v65, v65, v220
    v_mul_f32 v66, v66, v220
    v_mul_f32 v67, v67, v220
    v_mul_f32 v68, v68, v220
    v_mul_f32 v69, v69, v220
    v_mul_f32 v70, v70, v220
    v_mul_f32 v71, v71, v220
    v_mul_f32 v72, v72, v220
    v_mul_f32 v73, v73, v220
    v_mul_f32 v74, v74, v220
    v_mul_f32 v75, v75, v220
    v_mul_f32 v76, v76, v220
    v_mul_f32 v77, v77, v220
    v_mul_f32 v78, v78, v220
    v_mul_f32 v79, v79, v220
    s_waitcnt lgkmcnt(0)
    s_barrier
    v_mfma_f32_32x32x16_bf16 v[64:79], a[64:67], v[208:211], v[64:79]
    ds_read_b128 v[144:147], v29 offset:16384
    v_mul_f32 v80, v80, v220
    v_mul_f32 v81, v81, v220
    ds_read_b128 v[148:151], v29 offset:17408
    s_waitcnt vmcnt(47)
    ds_write_b128 v26, a[96:99] offset:16384
    v_mul_f32 v82, v82, v220
    v_mul_f32 v83, v83, v220
    ds_read_b128 v[152:155], v29 offset:18432
    v_mul_f32 v84, v84, v220
    v_mfma_f32_32x32x16_bf16 v[64:79], a[68:71], v[212:215], v[64:79]
    v_mul_f32 v85, v85, v220
    ds_read_b128 v[156:159], v29 offset:19456
    v_mul_f32 v86, v86, v220
    s_waitcnt vmcnt(46)
    ds_write_b128 v26, a[100:103] offset:17408
    v_mul_f32 v87, v87, v220
    v_mul_f32 v88, v88, v220
    v_mul_f32 v89, v89, v220
    v_mul_f32 v90, v90, v220
    v_mul_f32 v91, v91, v220
    v_mul_f32 v92, v92, v220
    v_mul_f32 v93, v93, v220
    v_mul_f32 v94, v94, v220
    v_mul_f32 v95, v95, v220
    s_nop 1
    v_mfma_f32_32x32x16_bf16 v[80:95], a[72:75], v[208:211], v[80:95]
    ds_read_b128 v[160:163], v30 offset:16384
    v_mul_f32 v96, v96, v220
    v_mul_f32 v97, v97, v220
    ds_read_b128 v[164:167], v30 offset:17408
    s_waitcnt vmcnt(45)
    ds_write_b128 v26, a[104:107] offset:18432
    v_mul_f32 v98, v98, v220
    v_mul_f32 v99, v99, v220
    ds_read_b128 v[168:171], v30 offset:18432
    v_mul_f32 v100, v100, v220
    v_mfma_f32_32x32x16_bf16 v[80:95], a[76:79], v[212:215], v[80:95]
    v_mul_f32 v101, v101, v220
    ds_read_b128 v[172:175], v30 offset:19456
    v_mul_f32 v102, v102, v220
    s_waitcnt vmcnt(44)
    ds_write_b128 v26, a[108:111] offset:19456
    v_mul_f32 v103, v103, v220
    v_mul_f32 v104, v104, v220
    v_mul_f32 v105, v105, v220
    v_mul_f32 v106, v106, v220
    v_mul_f32 v107, v107, v220
    v_mul_f32 v108, v108, v220
    v_mul_f32 v109, v109, v220
    v_mul_f32 v110, v110, v220
    v_mul_f32 v111, v111, v220
    s_nop 1
    v_mfma_f32_32x32x16_bf16 v[96:111], a[80:83], v[208:211], v[96:111]
    ds_read_b128 v[176:179], v31 offset:16384
    v_mul_f32 v112, v112, v220
    v_mul_f32 v113, v113, v220
    ds_read_b128 v[180:183], v31 offset:17408
    s_waitcnt vmcnt(43)
    ds_write_b128 v26, a[112:115] offset:20480
    v_mul_f32 v114, v114, v220
    v_mul_f32 v115, v115, v220
    ds_read_b128 v[184:187], v31 offset:18432
    v_mul_f32 v116, v116, v220
    v_mfma_f32_32x32x16_bf16 v[96:111], a[84:87], v[212:215], v[96:111]
    v_mul_f32 v117, v117, v220
    ds_read_b128 v[188:191], v31 offset:19456
    v_mul_f32 v118, v118, v220
    s_waitcnt vmcnt(42)
    ds_write_b128 v26, a[116:119] offset:21504
    v_mul_f32 v119, v119, v220
    v_mul_f32 v120, v120, v220
    v_mul_f32 v121, v121, v220
    v_mul_f32 v122, v122, v220
    v_mul_f32 v123, v123, v220
    v_mul_f32 v124, v124, v220
    v_mul_f32 v125, v125, v220
    v_mul_f32 v126, v126, v220
    v_mul_f32 v127, v127, v220
    s_nop 1
    v_mfma_f32_32x32x16_bf16 v[112:127], a[88:91], v[208:211], v[112:127]
    v_add_f32 v192, v192, v200
    v_add_f32 v193, v193, v201
    v_add_f32 v194, v194, v202
    v_add_f32 v195, v195, v203
    s_waitcnt vmcnt(41)
    ds_write_b128 v26, a[120:123] offset:22528
    v_add_f32 v196, v196, v204
    v_add_f32 v197, v197, v205
    v_add_f32 v198, v198, v206
    v_add_f32 v199, v199, v207
    v_mfma_f32_32x32x16_bf16 v[112:127], a[92:95], v[212:215], v[112:127]
    v_add_f32 v192, v192, v196
    v_add_f32 v193, v193, v197
    v_add_f32 v194, v194, v198
    s_waitcnt vmcnt(40)
    ds_write_b128 v26, a[124:127] offset:23552
    v_add_f32 v195, v195, v199
    v_add_f32 v192, v192, v193
    v_add_f32 v194, v194, v195
    v_add_f32 v192, v192, v194
    v_add_f32 v217, v217, v192
    ds_read_b128 a[32:35], v32 offset:16384
    ds_read_b128 a[36:39], v33 offset:16384
    ds_read_b128 a[40:43], v34 offset:16384
    ds_read_b128 a[44:47], v35 offset:16384
    ds_read_b128 a[48:51], v36 offset:16384
    ds_read_b128 a[52:55], v37 offset:16384
    ds_read_b128 a[56:59], v38 offset:16384
    ds_read_b128 a[60:63], v39 offset:16384
    s_waitcnt lgkmcnt(8)
    v_add_f32 v144, v144, v128
    v_add_f32 v145, v145, v129
    v_add_f32 v146, v146, v130
    v_add_f32 v147, v147, v131
    v_add_f32 v148, v148, v132
    v_add_f32 v149, v149, v133
    v_add_f32 v150, v150, v134
    v_add_f32 v151, v151, v135
    v_add_f32 v152, v152, v136
    v_add_f32 v153, v153, v137
    v_add_f32 v154, v154, v138
    v_add_f32 v155, v155, v139
    v_add_f32 v156, v156, v140
    v_add_f32 v157, v157, v141
    v_add_f32 v158, v158, v142
    v_add_f32 v159, v159, v143
    s_waitcnt lgkmcnt(0)
    v_mfma_f32_32x32x16_bf16 v[128:143], a[32:35], a[0:3], 0
    ds_read_b64_tr_b16 a[64:65], v40 offset:8192
    ds_read_b64_tr_b16 a[66:67], v41 offset:10240
    v_add_f32 v160, v160, v176
    v_add_f32 v161, v161, v177
    v_add_f32 v162, v162, v178
    v_add_f32 v163, v163, v179
    v_add_f32 v164, v164, v180
    v_mfma_f32_32x32x16_bf16 v[128:143], a[36:39], a[4:7], v[128:143]
    ds_read_b64_tr_b16 a[72:73], v42 offset:8192
    ds_read_b64_tr_b16 a[74:75], v43 offset:10240
    v_add_f32 v165, v165, v181
    v_add_f32 v166, v166, v182
    v_add_f32 v167, v167, v183
    v_add_f32 v168, v168, v184
    v_add_f32 v169, v169, v185
    v_mfma_f32_32x32x16_bf16 v[128:143], a[40:43], a[8:11], v[128:143]
    ds_read_b64_tr_b16 a[80:81], v44 offset:8192
    ds_read_b64_tr_b16 a[82:83], v45 offset:10240
    v_add_f32 v170, v170, v186
    v_add_f32 v171, v171, v187
    v_add_f32 v172, v172, v188
    v_add_f32 v173, v173, v189
    v_add_f32 v174, v174, v190
    v_mfma_f32_32x32x16_bf16 v[128:143], a[44:47], a[12:15], v[128:143]
    ds_read_b64_tr_b16 a[88:89], v46 offset:8192
    ds_read_b64_tr_b16 a[90:91], v47 offset:10240
    v_add_f32 v175, v175, v191
    v_add_f32 v144, v144, v160
    v_add_f32 v145, v145, v161
    v_add_f32 v146, v146, v162
    v_add_f32 v147, v147, v163
    v_mfma_f32_32x32x16_bf16 v[128:143], a[48:51], a[16:19], v[128:143]
    ds_read_b64_tr_b16 a[68:69], v40 offset:12288
    ds_read_b64_tr_b16 a[70:71], v41 offset:14336
    v_add_f32 v148, v148, v164
    v_add_f32 v149, v149, v165
    v_add_f32 v150, v150, v166
    v_add_f32 v151, v151, v167
    v_add_f32 v152, v152, v168
    v_mfma_f32_32x32x16_bf16 v[128:143], a[52:55], a[20:23], v[128:143]
    ds_read_b64_tr_b16 a[76:77], v42 offset:12288
    ds_read_b64_tr_b16 a[78:79], v43 offset:14336
    v_add_f32 v153, v153, v169
    v_add_f32 v154, v154, v170
    v_add_f32 v155, v155, v171
    v_add_f32 v156, v156, v172
    v_add_f32 v157, v157, v173
    v_mfma_f32_32x32x16_bf16 v[128:143], a[56:59], a[24:27], v[128:143]
    ds_read_b64_tr_b16 a[84:85], v44 offset:12288
    ds_read_b64_tr_b16 a[86:87], v45 offset:14336
    v_add_f32 v158, v158, v174
    v_add_f32 v159, v159, v175
    v_max3_f32 v218, v144, v145, v146
    v_max3_f32 v219, v147, v148, v149
    v_max3_f32 v220, v150, v151, v152
    v_mfma_f32_32x32x16_bf16 v[128:143], a[60:63], a[28:31], v[128:143]
    ds_read_b64_tr_b16 a[92:93], v46 offset:12288
    ds_read_b64_tr_b16 a[94:95], v47 offset:14336
    v_max3_f32 v221, v153, v154, v155
    v_max3_f32 v218, v218, v156, v157
    v_max3_f32 v219, v219, v158, v159
    v_max3_f32 v218, v218, v219, v220
    v_max_f32 v218, v218, v221
    v_mov_b32 v219, v218
    s_nop 1
    v_permlane32_swap_b32 v218, v219
    v_max3_f32 v218, v218, v219, v216
    v_sub_f32 v220, v216, v218
    v_mov_b32 v216, v218
    v_exp_f32 v220, v220
    v_sub_f32 v192, v144, v218
    v_sub_f32 v193, v145, v218
    v_sub_f32 v194, v146, v218
    v_sub_f32 v195, v147, v218
    v_sub_f32 v196, v148, v218
    v_sub_f32 v197, v149, v218
    v_sub_f32 v198, v150, v218
    v_sub_f32 v199, v151, v218
    v_sub_f32 v200, v152, v218
    v_sub_f32 v201, v153, v218
    v_sub_f32 v202, v154, v218
    v_sub_f32 v203, v155, v218
    v_sub_f32 v204, v156, v218
    v_sub_f32 v205, v157, v218
    v_sub_f32 v206, v158, v218
    v_sub_f32 v207, v159, v218
    ds_write_b128 v28, v[128:131] offset:0
    v_exp_f32 v192, v192
    v_exp_f32 v193, v193
    v_exp_f32 v194, v194
    v_exp_f32 v195, v195
    ds_write_b128 v28, v[132:135] offset:1024
    v_exp_f32 v196, v196
    v_exp_f32 v197, v197
    v_exp_f32 v198, v198
    v_exp_f32 v199, v199
    ds_write_b128 v28, v[136:139] offset:2048
    v_exp_f32 v200, v200
    v_exp_f32 v201, v201
    v_exp_f32 v202, v202
    v_exp_f32 v203, v203
    ds_write_b128 v28, v[140:143] offset:3072
    v_exp_f32 v204, v204
    v_exp_f32 v205, v205
    v_exp_f32 v206, v206
    v_exp_f32 v207, v207
    v_mul_f32 v217, v217, v220
    v_cvt_pk_bf16_f32 v208, v192, v193
    v_cvt_pk_bf16_f32 v209, v194, v195
    v_cvt_pk_bf16_f32 v210, v196, v197
    v_cvt_pk_bf16_f32 v211, v198, v199
    v_cvt_pk_bf16_f32 v212, v200, v201
    v_cvt_pk_bf16_f32 v213, v202, v203
    v_cvt_pk_bf16_f32 v214, v204, v205
    v_cvt_pk_bf16_f32 v215, v206, v207
    v_mul_f32 v64, v64, v220
    v_mul_f32 v65, v65, v220
    v_mul_f32 v66, v66, v220
    v_mul_f32 v67, v67, v220
    v_mul_f32 v68, v68, v220
    v_mul_f32 v69, v69, v220
    v_mul_f32 v70, v70, v220
    v_mul_f32 v71, v71, v220
    v_mul_f32 v72, v72, v220
    v_mul_f32 v73, v73, v220
    v_mul_f32 v74, v74, v220
    v_mul_f32 v75, v75, v220
    v_mul_f32 v76, v76, v220
    v_mul_f32 v77, v77, v220
    v_mul_f32 v78, v78, v220
    v_mul_f32 v79, v79, v220
    s_waitcnt lgkmcnt(0)
    s_barrier
    v_mfma_f32_32x32x16_bf16 v[64:79], a[64:67], v[208:211], v[64:79]
    ds_read_b128 v[144:147], v29 offset:0
    v_mul_f32 v80, v80, v220
    v_mul_f32 v81, v81, v220
    ds_read_b128 v[148:151], v29 offset:1024
    s_waitcnt vmcnt(39)
    ds_write_b128 v26, a[128:131] offset:24576
    v_mul_f32 v82, v82, v220
    v_mul_f32 v83, v83, v220
    ds_read_b128 v[152:155], v29 offset:2048
    v_mul_f32 v84, v84, v220
    v_mfma_f32_32x32x16_bf16 v[64:79], a[68:71], v[212:215], v[64:79]
    v_mul_f32 v85, v85, v220
    ds_read_b128 v[156:159], v29 offset:3072
    v_mul_f32 v86, v86, v220
    s_waitcnt vmcnt(38)
    ds_write_b128 v26, a[132:135] offset:25600
    v_mul_f32 v87, v87, v220
    v_mul_f32 v88, v88, v220
    v_mul_f32 v89, v89, v220
    v_mul_f32 v90, v90, v220
    v_mul_f32 v91, v91, v220
    v_mul_f32 v92, v92, v220
    v_mul_f32 v93, v93, v220
    v_mul_f32 v94, v94, v220
    v_mul_f32 v95, v95, v220
    s_nop 1
    v_mfma_f32_32x32x16_bf16 v[80:95], a[72:75], v[208:211], v[80:95]
    ds_read_b128 v[160:163], v30 offset:0
    v_mul_f32 v96, v96, v220
    v_mul_f32 v97, v97, v220
    ds_read_b128 v[164:167], v30 offset:1024
    s_waitcnt vmcnt(37)
    ds_write_b128 v26, a[136:139] offset:26624
    v_mul_f32 v98, v98, v220
    v_mul_f32 v99, v99, v220
    ds_read_b128 v[168:171], v30 offset:2048
    v_mul_f32 v100, v100, v220
    v_mfma_f32_32x32x16_bf16 v[80:95], a[76:79], v[212:215], v[80:95]
    v_mul_f32 v101, v101, v220
    ds_read_b128 v[172:175], v30 offset:3072
    v_mul_f32 v102, v102, v220
    s_waitcnt vmcnt(36)
    ds_write_b128 v26, a[140:143] offset:27648
    v_mul_f32 v103, v103, v220
    v_mul_f32 v104, v104, v220
    v_mul_f32 v105, v105, v220
    v_mul_f32 v106, v106, v220
    v_mul_f32 v107, v107, v220
    v_mul_f32 v108, v108, v220
    v_mul_f32 v109, v109, v220
    v_mul_f32 v110, v110, v220
    v_mul_f32 v111, v111, v220
    s_nop 1
    v_mfma_f32_32x32x16_bf16 v[96:111], a[80:83], v[208:211], v[96:111]
    ds_read_b128 v[176:179], v31 offset:0
    v_mul_f32 v112, v112, v220
    v_mul_f32 v113, v113, v220
    ds_read_b128 v[180:183], v31 offset:1024
    s_waitcnt vmcnt(35)
    ds_write_b128 v26, a[144:147] offset:28672
    v_mul_f32 v114, v114, v220
    v_mul_f32 v115, v115, v220
    ds_read_b128 v[184:187], v31 offset:2048
    v_mul_f32 v116, v116, v220
    v_mfma_f32_32x32x16_bf16 v[96:111], a[84:87], v[212:215], v[96:111]
    v_mul_f32 v117, v117, v220
    ds_read_b128 v[188:191], v31 offset:3072
    v_mul_f32 v118, v118, v220
    s_waitcnt vmcnt(34)
    ds_write_b128 v26, a[148:151] offset:29696
    v_mul_f32 v119, v119, v220
    v_mul_f32 v120, v120, v220
    v_mul_f32 v121, v121, v220
    v_mul_f32 v122, v122, v220
    v_mul_f32 v123, v123, v220
    v_mul_f32 v124, v124, v220
    v_mul_f32 v125, v125, v220
    v_mul_f32 v126, v126, v220
    v_mul_f32 v127, v127, v220
    s_nop 1
    v_mfma_f32_32x32x16_bf16 v[112:127], a[88:91], v[208:211], v[112:127]
    v_add_f32 v192, v192, v200
    v_add_f32 v193, v193, v201
    v_add_f32 v194, v194, v202
    v_add_f32 v195, v195, v203
    s_waitcnt vmcnt(33)
    ds_write_b128 v26, a[152:155] offset:30720
    v_add_f32 v196, v196, v204
    v_add_f32 v197, v197, v205
    v_add_f32 v198, v198, v206
    v_add_f32 v199, v199, v207
    v_mfma_f32_32x32x16_bf16 v[112:127], a[92:95], v[212:215], v[112:127]
    v_add_f32 v192, v192, v196
    v_add_f32 v193, v193, v197
    v_add_f32 v194, v194, v198
    s_waitcnt vmcnt(32)
    ds_write_b128 v26, a[156:159] offset:31744
    v_add_f32 v195, v195, v199
    v_add_f32 v192, v192, v193
    v_add_f32 v194, v194, v195
    v_add_f32 v192, v192, v194
    v_add_f32 v217, v217, v192
    ds_read_b128 a[32:35], v32 offset:24576
    ds_read_b128 a[36:39], v33 offset:24576
    ds_read_b128 a[40:43], v34 offset:24576
    ds_read_b128 a[44:47], v35 offset:24576
    ds_read_b128 a[48:51], v36 offset:24576
    ds_read_b128 a[52:55], v37 offset:24576
    ds_read_b128 a[56:59], v38 offset:24576
    ds_read_b128 a[60:63], v39 offset:24576
    s_waitcnt lgkmcnt(8)
    v_add_f32 v144, v144, v128
    v_add_f32 v145, v145, v129
    v_add_f32 v146, v146, v130
    v_add_f32 v147, v147, v131
    v_add_f32 v148, v148, v132
    v_add_f32 v149, v149, v133
    v_add_f32 v150, v150, v134
    v_add_f32 v151, v151, v135
    v_add_f32 v152, v152, v136
    v_add_f32 v153, v153, v137
    v_add_f32 v154, v154, v138
    v_add_f32 v155, v155, v139
    v_add_f32 v156, v156, v140
    v_add_f32 v157, v157, v141
    v_add_f32 v158, v158, v142
    v_add_f32 v159, v159, v143
    s_waitcnt lgkmcnt(0)
    v_mfma_f32_32x32x16_bf16 v[128:143], a[32:35], a[0:3], 0
    ds_read_b64_tr_b16 a[64:65], v40 offset:16384
    ds_read_b64_tr_b16 a[66:67], v41 offset:18432
    v_add_f32 v160, v160, v176
    v_add_f32 v161, v161, v177
    v_add_f32 v162, v162, v178
    v_add_f32 v163, v163, v179
    v_add_f32 v164, v164, v180
    v_mfma_f32_32x32x16_bf16 v[128:143], a[36:39], a[4:7], v[128:143]
    ds_read_b64_tr_b16 a[72:73], v42 offset:16384
    ds_read_b64_tr_b16 a[74:75], v43 offset:18432
    v_add_f32 v165, v165, v181
    v_add_f32 v166, v166, v182
    v_add_f32 v167, v167, v183
    v_add_f32 v168, v168, v184
    v_add_f32 v169, v169, v185
    v_mfma_f32_32x32x16_bf16 v[128:143], a[40:43], a[8:11], v[128:143]
    ds_read_b64_tr_b16 a[80:81], v44 offset:16384
    ds_read_b64_tr_b16 a[82:83], v45 offset:18432
    v_add_f32 v170, v170, v186
    v_add_f32 v171, v171, v187
    v_add_f32 v172, v172, v188
    v_add_f32 v173, v173, v189
    v_add_f32 v174, v174, v190
    v_mfma_f32_32x32x16_bf16 v[128:143], a[44:47], a[12:15], v[128:143]
    ds_read_b64_tr_b16 a[88:89], v46 offset:16384
    ds_read_b64_tr_b16 a[90:91], v47 offset:18432
    v_add_f32 v175, v175, v191
    v_add_f32 v144, v144, v160
    v_add_f32 v145, v145, v161
    v_add_f32 v146, v146, v162
    v_add_f32 v147, v147, v163
    v_mfma_f32_32x32x16_bf16 v[128:143], a[48:51], a[16:19], v[128:143]
    ds_read_b64_tr_b16 a[68:69], v40 offset:20480
    ds_read_b64_tr_b16 a[70:71], v41 offset:22528
    v_add_f32 v148, v148, v164
    v_add_f32 v149, v149, v165
    v_add_f32 v150, v150, v166
    v_add_f32 v151, v151, v167
    v_add_f32 v152, v152, v168
    v_mfma_f32_32x32x16_bf16 v[128:143], a[52:55], a[20:23], v[128:143]
    ds_read_b64_tr_b16 a[76:77], v42 offset:20480
    ds_read_b64_tr_b16 a[78:79], v43 offset:22528
    v_add_f32 v153, v153, v169
    v_add_f32 v154, v154, v170
    v_add_f32 v155, v155, v171
    v_add_f32 v156, v156, v172
    v_add_f32 v157, v157, v173
    v_mfma_f32_32x32x16_bf16 v[128:143], a[56:59], a[24:27], v[128:143]
    ds_read_b64_tr_b16 a[84:85], v44 offset:20480
    ds_read_b64_tr_b16 a[86:87], v45 offset:22528
    v_add_f32 v158, v158, v174
    v_add_f32 v159, v159, v175
    v_max3_f32 v218, v144, v145, v146
    v_max3_f32 v219, v147, v148, v149
    v_max3_f32 v220, v150, v151, v152
    v_mfma_f32_32x32x16_bf16 v[128:143], a[60:63], a[28:31], v[128:143]
    ds_read_b64_tr_b16 a[92:93], v46 offset:20480
    ds_read_b64_tr_b16 a[94:95], v47 offset:22528
    v_max3_f32 v221, v153, v154, v155
    v_max3_f32 v218, v218, v156, v157
    v_max3_f32 v219, v219, v158, v159
    v_max3_f32 v218, v218, v219, v220
    v_max_f32 v218, v218, v221
    v_mov_b32 v219, v218
    s_nop 1
    v_permlane32_swap_b32 v218, v219
    v_max3_f32 v218, v218, v219, v216
    v_sub_f32 v220, v216, v218
    v_mov_b32 v216, v218
    v_exp_f32 v220, v220
    v_sub_f32 v192, v144, v218
    v_sub_f32 v193, v145, v218
    v_sub_f32 v194, v146, v218
    v_sub_f32 v195, v147, v218
    v_sub_f32 v196, v148, v218
    v_sub_f32 v197, v149, v218
    v_sub_f32 v198, v150, v218
    v_sub_f32 v199, v151, v218
    v_sub_f32 v200, v152, v218
    v_sub_f32 v201, v153, v218
    v_sub_f32 v202, v154, v218
    v_sub_f32 v203, v155, v218
    v_sub_f32 v204, v156, v218
    v_sub_f32 v205, v157, v218
    v_sub_f32 v206, v158, v218
    v_sub_f32 v207, v159, v218
    ds_write_b128 v28, v[128:131] offset:16384
    v_exp_f32 v192, v192
    v_exp_f32 v193, v193
    v_exp_f32 v194, v194
    v_exp_f32 v195, v195
    ds_write_b128 v28, v[132:135] offset:17408
    v_exp_f32 v196, v196
    v_exp_f32 v197, v197
    v_exp_f32 v198, v198
    v_exp_f32 v199, v199
    ds_write_b128 v28, v[136:139] offset:18432
    v_exp_f32 v200, v200
    v_exp_f32 v201, v201
    v_exp_f32 v202, v202
    v_exp_f32 v203, v203
    ds_write_b128 v28, v[140:143] offset:19456
    v_exp_f32 v204, v204
    v_exp_f32 v205, v205
    v_exp_f32 v206, v206
    v_exp_f32 v207, v207
    v_mul_f32 v217, v217, v220
    v_cvt_pk_bf16_f32 v208, v192, v193
    v_cvt_pk_bf16_f32 v209, v194, v195
    v_cvt_pk_bf16_f32 v210, v196, v197
    v_cvt_pk_bf16_f32 v211, v198, v199
    v_cvt_pk_bf16_f32 v212, v200, v201
    v_cvt_pk_bf16_f32 v213, v202, v203
    v_cvt_pk_bf16_f32 v214, v204, v205
    v_cvt_pk_bf16_f32 v215, v206, v207
    v_mul_f32 v64, v64, v220
    v_mul_f32 v65, v65, v220
    v_mul_f32 v66, v66, v220
    v_mul_f32 v67, v67, v220
    v_mul_f32 v68, v68, v220
    v_mul_f32 v69, v69, v220
    v_mul_f32 v70, v70, v220
    v_mul_f32 v71, v71, v220
    v_mul_f32 v72, v72, v220
    v_mul_f32 v73, v73, v220
    v_mul_f32 v74, v74, v220
    v_mul_f32 v75, v75, v220
    v_mul_f32 v76, v76, v220
    v_mul_f32 v77, v77, v220
    v_mul_f32 v78, v78, v220
    v_mul_f32 v79, v79, v220
    s_waitcnt lgkmcnt(0)
    s_barrier
    v_mfma_f32_32x32x16_bf16 v[64:79], a[64:67], v[208:211], v[64:79]
    ds_read_b128 v[144:147], v29 offset:16384
    v_mul_f32 v80, v80, v220
    v_mul_f32 v81, v81, v220
    ds_read_b128 v[148:151], v29 offset:17408
    s_waitcnt vmcnt(31)
    ds_write_b128 v26, a[160:163] offset:0
    v_mul_f32 v82, v82, v220
    v_mul_f32 v83, v83, v220
    ds_read_b128 v[152:155], v29 offset:18432
    v_mul_f32 v84, v84, v220
    v_mfma_f32_32x32x16_bf16 v[64:79], a[68:71], v[212:215], v[64:79]
    v_mul_f32 v85, v85, v220
    ds_read_b128 v[156:159], v29 offset:19456
    v_mul_f32 v86, v86, v220
    s_waitcnt vmcnt(30)
    ds_write_b128 v26, a[164:167] offset:1024
    v_mul_f32 v87, v87, v220
    v_mul_f32 v88, v88, v220
    v_mul_f32 v89, v89, v220
    v_mul_f32 v90, v90, v220
    v_mul_f32 v91, v91, v220
    v_mul_f32 v92, v92, v220
    v_mul_f32 v93, v93, v220
    v_mul_f32 v94, v94, v220
    v_mul_f32 v95, v95, v220
    s_nop 1
    v_mfma_f32_32x32x16_bf16 v[80:95], a[72:75], v[208:211], v[80:95]
    ds_read_b128 v[160:163], v30 offset:16384
    v_mul_f32 v96, v96, v220
    v_mul_f32 v97, v97, v220
    ds_read_b128 v[164:167], v30 offset:17408
    s_waitcnt vmcnt(29)
    ds_write_b128 v26, a[168:171] offset:2048
    v_mul_f32 v98, v98, v220
    v_mul_f32 v99, v99, v220
    ds_read_b128 v[168:171], v30 offset:18432
    v_mul_f32 v100, v100, v220
    v_mfma_f32_32x32x16_bf16 v[80:95], a[76:79], v[212:215], v[80:95]
    v_mul_f32 v101, v101, v220
    ds_read_b128 v[172:175], v30 offset:19456
    v_mul_f32 v102, v102, v220
    s_waitcnt vmcnt(28)
    ds_write_b128 v26, a[172:175] offset:3072
    v_mul_f32 v103, v103, v220
    v_mul_f32 v104, v104, v220
    v_mul_f32 v105, v105, v220
    v_mul_f32 v106, v106, v220
    v_mul_f32 v107, v107, v220
    v_mul_f32 v108, v108, v220
    v_mul_f32 v109, v109, v220
    v_mul_f32 v110, v110, v220
    v_mul_f32 v111, v111, v220
    s_nop 1
    v_mfma_f32_32x32x16_bf16 v[96:111], a[80:83], v[208:211], v[96:111]
    ds_read_b128 v[176:179], v31 offset:16384
    v_mul_f32 v112, v112, v220
    v_mul_f32 v113, v113, v220
    ds_read_b128 v[180:183], v31 offset:17408
    s_waitcnt vmcnt(27)
    ds_write_b128 v26, a[176:179] offset:4096
    v_mul_f32 v114, v114, v220
    v_mul_f32 v115, v115, v220
    ds_read_b128 v[184:187], v31 offset:18432
    v_mul_f32 v116, v116, v220
    v_mfma_f32_32x32x16_bf16 v[96:111], a[84:87], v[212:215], v[96:111]
    v_mul_f32 v117, v117, v220
    ds_read_b128 v[188:191], v31 offset:19456
    v_mul_f32 v118, v118, v220
    s_waitcnt vmcnt(26)
    ds_write_b128 v26, a[180:183] offset:5120
    v_mul_f32 v119, v119, v220
    v_mul_f32 v120, v120, v220
    v_mul_f32 v121, v121, v220
    v_mul_f32 v122, v122, v220
    v_mul_f32 v123, v123, v220
    v_mul_f32 v124, v124, v220
    v_mul_f32 v125, v125, v220
    v_mul_f32 v126, v126, v220
    v_mul_f32 v127, v127, v220
    s_nop 1
    v_mfma_f32_32x32x16_bf16 v[112:127], a[88:91], v[208:211], v[112:127]
    v_add_f32 v192, v192, v200
    v_add_f32 v193, v193, v201
    v_add_f32 v194, v194, v202
    v_add_f32 v195, v195, v203
    s_waitcnt vmcnt(25)
    ds_write_b128 v26, a[184:187] offset:6144
    v_add_f32 v196, v196, v204
    v_add_f32 v197, v197, v205
    v_add_f32 v198, v198, v206
    v_add_f32 v199, v199, v207
    v_mfma_f32_32x32x16_bf16 v[112:127], a[92:95], v[212:215], v[112:127]
    v_add_f32 v192, v192, v196
    v_add_f32 v193, v193, v197
    v_add_f32 v194, v194, v198
    s_waitcnt vmcnt(24)
    ds_write_b128 v26, a[188:191] offset:7168
    v_add_f32 v195, v195, v199
    v_add_f32 v192, v192, v193
    v_add_f32 v194, v194, v195
    v_add_f32 v192, v192, v194
    v_add_f32 v217, v217, v192
    ds_read_b128 a[32:35], v32 offset:0
    ds_read_b128 a[36:39], v33 offset:0
    ds_read_b128 a[40:43], v34 offset:0
    ds_read_b128 a[44:47], v35 offset:0
    ds_read_b128 a[48:51], v36 offset:0
    ds_read_b128 a[52:55], v37 offset:0
    ds_read_b128 a[56:59], v38 offset:0
    ds_read_b128 a[60:63], v39 offset:0
    s_waitcnt lgkmcnt(8)
    v_add_f32 v144, v144, v128
    v_add_f32 v145, v145, v129
    v_add_f32 v146, v146, v130
    v_add_f32 v147, v147, v131
    v_add_f32 v148, v148, v132
    v_add_f32 v149, v149, v133
    v_add_f32 v150, v150, v134
    v_add_f32 v151, v151, v135
    v_add_f32 v152, v152, v136
    v_add_f32 v153, v153, v137
    v_add_f32 v154, v154, v138
    v_add_f32 v155, v155, v139
    v_add_f32 v156, v156, v140
    v_add_f32 v157, v157, v141
    v_add_f32 v158, v158, v142
    v_add_f32 v159, v159, v143
    s_waitcnt lgkmcnt(0)
    v_mfma_f32_32x32x16_bf16 v[128:143], a[32:35], a[0:3], 0
    ds_read_b64_tr_b16 a[64:65], v40 offset:24576
    ds_read_b64_tr_b16 a[66:67], v41 offset:26624
    v_add_f32 v160, v160, v176
    v_add_f32 v161, v161, v177
    v_add_f32 v162, v162, v178
    v_add_f32 v163, v163, v179
    v_add_f32 v164, v164, v180
    v_mfma_f32_32x32x16_bf16 v[128:143], a[36:39], a[4:7], v[128:143]
    ds_read_b64_tr_b16 a[72:73], v42 offset:24576
    ds_read_b64_tr_b16 a[74:75], v43 offset:26624
    v_add_f32 v165, v165, v181
    v_add_f32 v166, v166, v182
    v_add_f32 v167, v167, v183
    v_add_f32 v168, v168, v184
    v_add_f32 v169, v169, v185
    v_mfma_f32_32x32x16_bf16 v[128:143], a[40:43], a[8:11], v[128:143]
    ds_read_b64_tr_b16 a[80:81], v44 offset:24576
    ds_read_b64_tr_b16 a[82:83], v45 offset:26624
    v_add_f32 v170, v170, v186
    v_add_f32 v171, v171, v187
    v_add_f32 v172, v172, v188
    v_add_f32 v173, v173, v189
    v_add_f32 v174, v174, v190
    v_mfma_f32_32x32x16_bf16 v[128:143], a[44:47], a[12:15], v[128:143]
    ds_read_b64_tr_b16 a[88:89], v46 offset:24576
    ds_read_b64_tr_b16 a[90:91], v47 offset:26624
    v_add_f32 v175, v175, v191
    v_add_f32 v144, v144, v160
    v_add_f32 v145, v145, v161
    v_add_f32 v146, v146, v162
    v_add_f32 v147, v147, v163
    v_mfma_f32_32x32x16_bf16 v[128:143], a[48:51], a[16:19], v[128:143]
    ds_read_b64_tr_b16 a[68:69], v40 offset:28672
    ds_read_b64_tr_b16 a[70:71], v41 offset:30720
    v_add_f32 v148, v148, v164
    v_add_f32 v149, v149, v165
    v_add_f32 v150, v150, v166
    v_add_f32 v151, v151, v167
    v_add_f32 v152, v152, v168
    v_mfma_f32_32x32x16_bf16 v[128:143], a[52:55], a[20:23], v[128:143]
    ds_read_b64_tr_b16 a[76:77], v42 offset:28672
    ds_read_b64_tr_b16 a[78:79], v43 offset:30720
    v_add_f32 v153, v153, v169
    v_add_f32 v154, v154, v170
    v_add_f32 v155, v155, v171
    v_add_f32 v156, v156, v172
    v_add_f32 v157, v157, v173
    v_mfma_f32_32x32x16_bf16 v[128:143], a[56:59], a[24:27], v[128:143]
    ds_read_b64_tr_b16 a[84:85], v44 offset:28672
    ds_read_b64_tr_b16 a[86:87], v45 offset:30720
    v_add_f32 v158, v158, v174
    v_add_f32 v159, v159, v175
    v_max3_f32 v218, v144, v145, v146
    v_max3_f32 v219, v147, v148, v149
    v_max3_f32 v220, v150, v151, v152
    v_mfma_f32_32x32x16_bf16 v[128:143], a[60:63], a[28:31], v[128:143]
    ds_read_b64_tr_b16 a[92:93], v46 offset:28672
    ds_read_b64_tr_b16 a[94:95], v47 offset:30720
    v_max3_f32 v221, v153, v154, v155
    v_max3_f32 v218, v218, v156, v157
    v_max3_f32 v219, v219, v158, v159
    v_max3_f32 v218, v218, v219, v220
    v_max_f32 v218, v218, v221
    v_mov_b32 v219, v218
    s_nop 1
    v_permlane32_swap_b32 v218, v219
    v_max3_f32 v218, v218, v219, v216
    v_sub_f32 v220, v216, v218
    v_mov_b32 v216, v218
    v_exp_f32 v220, v220
    v_sub_f32 v192, v144, v218
    v_sub_f32 v193, v145, v218
    v_sub_f32 v194, v146, v218
    v_sub_f32 v195, v147, v218
    v_sub_f32 v196, v148, v218
    v_sub_f32 v197, v149, v218
    v_sub_f32 v198, v150, v218
    v_sub_f32 v199, v151, v218
    v_sub_f32 v200, v152, v218
    v_sub_f32 v201, v153, v218
    v_sub_f32 v202, v154, v218
    v_sub_f32 v203, v155, v218
    v_sub_f32 v204, v156, v218
    v_sub_f32 v205, v157, v218
    v_sub_f32 v206, v158, v218
    v_sub_f32 v207, v159, v218
    ds_write_b128 v28, v[128:131] offset:0
    v_exp_f32 v192, v192
    v_exp_f32 v193, v193
    v_exp_f32 v194, v194
    v_exp_f32 v195, v195
    ds_write_b128 v28, v[132:135] offset:1024
    v_exp_f32 v196, v196
    v_exp_f32 v197, v197
    v_exp_f32 v198, v198
    v_exp_f32 v199, v199
    ds_write_b128 v28, v[136:139] offset:2048
    v_exp_f32 v200, v200
    v_exp_f32 v201, v201
    v_exp_f32 v202, v202
    v_exp_f32 v203, v203
    ds_write_b128 v28, v[140:143] offset:3072
    v_exp_f32 v204, v204
    v_exp_f32 v205, v205
    v_exp_f32 v206, v206
    v_exp_f32 v207, v207
    v_mul_f32 v217, v217, v220
    v_cvt_pk_bf16_f32 v208, v192, v193
    v_cvt_pk_bf16_f32 v209, v194, v195
    v_cvt_pk_bf16_f32 v210, v196, v197
    v_cvt_pk_bf16_f32 v211, v198, v199
    v_cvt_pk_bf16_f32 v212, v200, v201
    v_cvt_pk_bf16_f32 v213, v202, v203
    v_cvt_pk_bf16_f32 v214, v204, v205
    v_cvt_pk_bf16_f32 v215, v206, v207
    v_mul_f32 v64, v64, v220
    v_mul_f32 v65, v65, v220
    v_mul_f32 v66, v66, v220
    v_mul_f32 v67, v67, v220
    v_mul_f32 v68, v68, v220
    v_mul_f32 v69, v69, v220
    v_mul_f32 v70, v70, v220
    v_mul_f32 v71, v71, v220
    v_mul_f32 v72, v72, v220
    v_mul_f32 v73, v73, v220
    v_mul_f32 v74, v74, v220
    v_mul_f32 v75, v75, v220
    v_mul_f32 v76, v76, v220
    v_mul_f32 v77, v77, v220
    v_mul_f32 v78, v78, v220
    v_mul_f32 v79, v79, v220
    s_waitcnt lgkmcnt(0)
    s_barrier
    v_mfma_f32_32x32x16_bf16 v[64:79], a[64:67], v[208:211], v[64:79]
    ds_read_b128 v[144:147], v29 offset:0
    v_mul_f32 v80, v80, v220
    v_mul_f32 v81, v81, v220
    ds_read_b128 v[148:151], v29 offset:1024
    s_waitcnt vmcnt(23)
    ds_write_b128 v26, a[192:195] offset:8192
    v_mul_f32 v82, v82, v220
    v_mul_f32 v83, v83, v220
    ds_read_b128 v[152:155], v29 offset:2048
    v_mul_f32 v84, v84, v220
    v_mfma_f32_32x32x16_bf16 v[64:79], a[68:71], v[212:215], v[64:79]
    v_mul_f32 v85, v85, v220
    ds_read_b128 v[156:159], v29 offset:3072
    v_mul_f32 v86, v86, v220
    s_waitcnt vmcnt(22)
    ds_write_b128 v26, a[196:199] offset:9216
    v_mul_f32 v87, v87, v220
    v_mul_f32 v88, v88, v220
    v_mul_f32 v89, v89, v220
    v_mul_f32 v90, v90, v220
    v_mul_f32 v91, v91, v220
    v_mul_f32 v92, v92, v220
    v_mul_f32 v93, v93, v220
    v_mul_f32 v94, v94, v220
    v_mul_f32 v95, v95, v220
    s_nop 1
    v_mfma_f32_32x32x16_bf16 v[80:95], a[72:75], v[208:211], v[80:95]
    ds_read_b128 v[160:163], v30 offset:0
    v_mul_f32 v96, v96, v220
    v_mul_f32 v97, v97, v220
    ds_read_b128 v[164:167], v30 offset:1024
    s_waitcnt vmcnt(21)
    ds_write_b128 v26, a[200:203] offset:10240
    v_mul_f32 v98, v98, v220
    v_mul_f32 v99, v99, v220
    ds_read_b128 v[168:171], v30 offset:2048
    v_mul_f32 v100, v100, v220
    v_mfma_f32_32x32x16_bf16 v[80:95], a[76:79], v[212:215], v[80:95]
    v_mul_f32 v101, v101, v220
    ds_read_b128 v[172:175], v30 offset:3072
    v_mul_f32 v102, v102, v220
    s_waitcnt vmcnt(20)
    ds_write_b128 v26, a[204:207] offset:11264
    v_mul_f32 v103, v103, v220
    v_mul_f32 v104, v104, v220
    v_mul_f32 v105, v105, v220
    v_mul_f32 v106, v106, v220
    v_mul_f32 v107, v107, v220
    v_mul_f32 v108, v108, v220
    v_mul_f32 v109, v109, v220
    v_mul_f32 v110, v110, v220
    v_mul_f32 v111, v111, v220
    s_nop 1
    v_mfma_f32_32x32x16_bf16 v[96:111], a[80:83], v[208:211], v[96:111]
    ds_read_b128 v[176:179], v31 offset:0
    v_mul_f32 v112, v112, v220
    v_mul_f32 v113, v113, v220
    ds_read_b128 v[180:183], v31 offset:1024
    s_waitcnt vmcnt(19)
    ds_write_b128 v26, a[208:211] offset:12288
    v_mul_f32 v114, v114, v220
    v_mul_f32 v115, v115, v220
    ds_read_b128 v[184:187], v31 offset:2048
    v_mul_f32 v116, v116, v220
    v_mfma_f32_32x32x16_bf16 v[96:111], a[84:87], v[212:215], v[96:111]
    v_mul_f32 v117, v117, v220
    ds_read_b128 v[188:191], v31 offset:3072
    v_mul_f32 v118, v118, v220
    s_waitcnt vmcnt(18)
    ds_write_b128 v26, a[212:215] offset:13312
    v_mul_f32 v119, v119, v220
    v_mul_f32 v120, v120, v220
    v_mul_f32 v121, v121, v220
    v_mul_f32 v122, v122, v220
    v_mul_f32 v123, v123, v220
    v_mul_f32 v124, v124, v220
    v_mul_f32 v125, v125, v220
    v_mul_f32 v126, v126, v220
    v_mul_f32 v127, v127, v220
    s_nop 1
    v_mfma_f32_32x32x16_bf16 v[112:127], a[88:91], v[208:211], v[112:127]
    v_add_f32 v192, v192, v200
    v_add_f32 v193, v193, v201
    v_add_f32 v194, v194, v202
    v_add_f32 v195, v195, v203
    s_waitcnt vmcnt(17)
    ds_write_b128 v26, a[216:219] offset:14336
    v_add_f32 v196, v196, v204
    v_add_f32 v197, v197, v205
    v_add_f32 v198, v198, v206
    v_add_f32 v199, v199, v207
    v_mfma_f32_32x32x16_bf16 v[112:127], a[92:95], v[212:215], v[112:127]
    v_add_f32 v192, v192, v196
    v_add_f32 v193, v193, v197
    v_add_f32 v194, v194, v198
    s_waitcnt vmcnt(16)
    ds_write_b128 v26, a[220:223] offset:15360
    v_add_f32 v195, v195, v199
    v_add_f32 v192, v192, v193
    v_add_f32 v194, v194, v195
    v_add_f32 v192, v192, v194
    v_add_f32 v217, v217, v192
    ds_read_b128 a[32:35], v32 offset:8192
    ds_read_b128 a[36:39], v33 offset:8192
    ds_read_b128 a[40:43], v34 offset:8192
    ds_read_b128 a[44:47], v35 offset:8192
    ds_read_b128 a[48:51], v36 offset:8192
    ds_read_b128 a[52:55], v37 offset:8192
    ds_read_b128 a[56:59], v38 offset:8192
    ds_read_b128 a[60:63], v39 offset:8192
    s_waitcnt lgkmcnt(8)
    v_add_f32 v144, v144, v128
    v_add_f32 v145, v145, v129
    v_add_f32 v146, v146, v130
    v_add_f32 v147, v147, v131
    v_add_f32 v148, v148, v132
    v_add_f32 v149, v149, v133
    v_add_f32 v150, v150, v134
    v_add_f32 v151, v151, v135
    v_add_f32 v152, v152, v136
    v_add_f32 v153, v153, v137
    v_add_f32 v154, v154, v138
    v_add_f32 v155, v155, v139
    v_add_f32 v156, v156, v140
    v_add_f32 v157, v157, v141
    v_add_f32 v158, v158, v142
    v_add_f32 v159, v159, v143
    s_waitcnt lgkmcnt(0)
    v_mfma_f32_32x32x16_bf16 v[128:143], a[32:35], a[0:3], 0
    ds_read_b64_tr_b16 a[64:65], v40 offset:0
    ds_read_b64_tr_b16 a[66:67], v41 offset:2048
    v_add_f32 v160, v160, v176
    v_add_f32 v161, v161, v177
    v_add_f32 v162, v162, v178
    v_add_f32 v163, v163, v179
    v_add_f32 v164, v164, v180
    v_mfma_f32_32x32x16_bf16 v[128:143], a[36:39], a[4:7], v[128:143]
    ds_read_b64_tr_b16 a[72:73], v42 offset:0
    ds_read_b64_tr_b16 a[74:75], v43 offset:2048
    v_add_f32 v165, v165, v181
    v_add_f32 v166, v166, v182
    v_add_f32 v167, v167, v183
    v_add_f32 v168, v168, v184
    v_add_f32 v169, v169, v185
    v_mfma_f32_32x32x16_bf16 v[128:143], a[40:43], a[8:11], v[128:143]
    ds_read_b64_tr_b16 a[80:81], v44 offset:0
    ds_read_b64_tr_b16 a[82:83], v45 offset:2048
    v_add_f32 v170, v170, v186
    v_add_f32 v171, v171, v187
    v_add_f32 v172, v172, v188
    v_add_f32 v173, v173, v189
    v_add_f32 v174, v174, v190
    v_mfma_f32_32x32x16_bf16 v[128:143], a[44:47], a[12:15], v[128:143]
    ds_read_b64_tr_b16 a[88:89], v46 offset:0
    ds_read_b64_tr_b16 a[90:91], v47 offset:2048
    v_add_f32 v175, v175, v191
    v_add_f32 v144, v144, v160
    v_add_f32 v145, v145, v161
    v_add_f32 v146, v146, v162
    v_add_f32 v147, v147, v163
    v_mfma_f32_32x32x16_bf16 v[128:143], a[48:51], a[16:19], v[128:143]
    ds_read_b64_tr_b16 a[68:69], v40 offset:4096
    ds_read_b64_tr_b16 a[70:71], v41 offset:6144
    v_add_f32 v148, v148, v164
    v_add_f32 v149, v149, v165
    v_add_f32 v150, v150, v166
    v_add_f32 v151, v151, v167
    v_add_f32 v152, v152, v168
    v_mfma_f32_32x32x16_bf16 v[128:143], a[52:55], a[20:23], v[128:143]
    ds_read_b64_tr_b16 a[76:77], v42 offset:4096
    ds_read_b64_tr_b16 a[78:79], v43 offset:6144
    v_add_f32 v153, v153, v169
    v_add_f32 v154, v154, v170
    v_add_f32 v155, v155, v171
    v_add_f32 v156, v156, v172
    v_add_f32 v157, v157, v173
    v_mfma_f32_32x32x16_bf16 v[128:143], a[56:59], a[24:27], v[128:143]
    ds_read_b64_tr_b16 a[84:85], v44 offset:4096
    ds_read_b64_tr_b16 a[86:87], v45 offset:6144
    v_add_f32 v158, v158, v174
    v_add_f32 v159, v159, v175
    v_max3_f32 v218, v144, v145, v146
    v_max3_f32 v219, v147, v148, v149
    v_max3_f32 v220, v150, v151, v152
    v_mfma_f32_32x32x16_bf16 v[128:143], a[60:63], a[28:31], v[128:143]
    ds_read_b64_tr_b16 a[92:93], v46 offset:4096
    ds_read_b64_tr_b16 a[94:95], v47 offset:6144
    v_max3_f32 v221, v153, v154, v155
    v_max3_f32 v218, v218, v156, v157
    v_max3_f32 v219, v219, v158, v159
    v_max3_f32 v218, v218, v219, v220
    v_max_f32 v218, v218, v221
    v_mov_b32 v219, v218
    s_nop 1
    v_permlane32_swap_b32 v218, v219
    v_max3_f32 v218, v218, v219, v216
    v_sub_f32 v220, v216, v218
    v_mov_b32 v216, v218
    v_exp_f32 v220, v220
    v_sub_f32 v192, v144, v218
    v_sub_f32 v193, v145, v218
    v_sub_f32 v194, v146, v218
    v_sub_f32 v195, v147, v218
    v_sub_f32 v196, v148, v218
    v_sub_f32 v197, v149, v218
    v_sub_f32 v198, v150, v218
    v_sub_f32 v199, v151, v218
    v_sub_f32 v200, v152, v218
    v_sub_f32 v201, v153, v218
    v_sub_f32 v202, v154, v218
    v_sub_f32 v203, v155, v218
    v_sub_f32 v204, v156, v218
    v_sub_f32 v205, v157, v218
    v_sub_f32 v206, v158, v218
    v_sub_f32 v207, v159, v218
    ds_write_b128 v28, v[128:131] offset:16384
    v_exp_f32 v192, v192
    v_exp_f32 v193, v193
    v_exp_f32 v194, v194
    v_exp_f32 v195, v195
    ds_write_b128 v28, v[132:135] offset:17408
    v_exp_f32 v196, v196
    v_exp_f32 v197, v197
    v_exp_f32 v198, v198
    v_exp_f32 v199, v199
    ds_write_b128 v28, v[136:139] offset:18432
    v_exp_f32 v200, v200
    v_exp_f32 v201, v201
    v_exp_f32 v202, v202
    v_exp_f32 v203, v203
    ds_write_b128 v28, v[140:143] offset:19456
    v_exp_f32 v204, v204
    v_exp_f32 v205, v205
    v_exp_f32 v206, v206
    v_exp_f32 v207, v207
    v_mul_f32 v217, v217, v220
    v_cvt_pk_bf16_f32 v208, v192, v193
    v_cvt_pk_bf16_f32 v209, v194, v195
    v_cvt_pk_bf16_f32 v210, v196, v197
    v_cvt_pk_bf16_f32 v211, v198, v199
    v_cvt_pk_bf16_f32 v212, v200, v201
    v_cvt_pk_bf16_f32 v213, v202, v203
    v_cvt_pk_bf16_f32 v214, v204, v205
    v_cvt_pk_bf16_f32 v215, v206, v207
    v_mul_f32 v64, v64, v220
    v_mul_f32 v65, v65, v220
    v_mul_f32 v66, v66, v220
    v_mul_f32 v67, v67, v220
    v_mul_f32 v68, v68, v220
    v_mul_f32 v69, v69, v220
    v_mul_f32 v70, v70, v220
    v_mul_f32 v71, v71, v220
    v_mul_f32 v72, v72, v220
    v_mul_f32 v73, v73, v220
    v_mul_f32 v74, v74, v220
    v_mul_f32 v75, v75, v220
    v_mul_f32 v76, v76, v220
    v_mul_f32 v77, v77, v220
    v_mul_f32 v78, v78, v220
    v_mul_f32 v79, v79, v220
    s_waitcnt lgkmcnt(0)
    s_barrier
    v_mfma_f32_32x32x16_bf16 v[64:79], a[64:67], v[208:211], v[64:79]
    ds_read_b128 v[144:147], v29 offset:16384
    v_mul_f32 v80, v80, v220
    v_mul_f32 v81, v81, v220
    ds_read_b128 v[148:151], v29 offset:17408
    s_waitcnt vmcnt(15)
    ds_write_b128 v26, a[224:227] offset:16384
    v_mul_f32 v82, v82, v220
    v_mul_f32 v83, v83, v220
    ds_read_b128 v[152:155], v29 offset:18432
    v_mul_f32 v84, v84, v220
    v_mfma_f32_32x32x16_bf16 v[64:79], a[68:71], v[212:215], v[64:79]
    v_mul_f32 v85, v85, v220
    ds_read_b128 v[156:159], v29 offset:19456
    v_mul_f32 v86, v86, v220
    s_waitcnt vmcnt(14)
    ds_write_b128 v26, a[228:231] offset:17408
    v_mul_f32 v87, v87, v220
    v_mul_f32 v88, v88, v220
    v_mul_f32 v89, v89, v220
    v_mul_f32 v90, v90, v220
    v_mul_f32 v91, v91, v220
    v_mul_f32 v92, v92, v220
    v_mul_f32 v93, v93, v220
    v_mul_f32 v94, v94, v220
    v_mul_f32 v95, v95, v220
    s_nop 1
    v_mfma_f32_32x32x16_bf16 v[80:95], a[72:75], v[208:211], v[80:95]
    ds_read_b128 v[160:163], v30 offset:16384
    v_mul_f32 v96, v96, v220
    v_mul_f32 v97, v97, v220
    ds_read_b128 v[164:167], v30 offset:17408
    s_waitcnt vmcnt(13)
    ds_write_b128 v26, a[232:235] offset:18432
    v_mul_f32 v98, v98, v220
    v_mul_f32 v99, v99, v220
    ds_read_b128 v[168:171], v30 offset:18432
    v_mul_f32 v100, v100, v220
    v_mfma_f32_32x32x16_bf16 v[80:95], a[76:79], v[212:215], v[80:95]
    v_mul_f32 v101, v101, v220
    ds_read_b128 v[172:175], v30 offset:19456
    v_mul_f32 v102, v102, v220
    s_waitcnt vmcnt(12)
    ds_write_b128 v26, a[236:239] offset:19456
    v_mul_f32 v103, v103, v220
    v_mul_f32 v104, v104, v220
    v_mul_f32 v105, v105, v220
    v_mul_f32 v106, v106, v220
    v_mul_f32 v107, v107, v220
    v_mul_f32 v108, v108, v220
    v_mul_f32 v109, v109, v220
    v_mul_f32 v110, v110, v220
    v_mul_f32 v111, v111, v220
    s_nop 1
    v_mfma_f32_32x32x16_bf16 v[96:111], a[80:83], v[208:211], v[96:111]
    ds_read_b128 v[176:179], v31 offset:16384
    v_mul_f32 v112, v112, v220
    v_mul_f32 v113, v113, v220
    ds_read_b128 v[180:183], v31 offset:17408
    s_waitcnt vmcnt(11)
    ds_write_b128 v26, a[240:243] offset:20480
    v_mul_f32 v114, v114, v220
    v_mul_f32 v115, v115, v220
    ds_read_b128 v[184:187], v31 offset:18432
    v_mul_f32 v116, v116, v220
    v_mfma_f32_32x32x16_bf16 v[96:111], a[84:87], v[212:215], v[96:111]
    v_mul_f32 v117, v117, v220
    ds_read_b128 v[188:191], v31 offset:19456
    v_mul_f32 v118, v118, v220
    s_waitcnt vmcnt(10)
    ds_write_b128 v26, a[244:247] offset:21504
    v_mul_f32 v119, v119, v220
    v_mul_f32 v120, v120, v220
    v_mul_f32 v121, v121, v220
    v_mul_f32 v122, v122, v220
    v_mul_f32 v123, v123, v220
    v_mul_f32 v124, v124, v220
    v_mul_f32 v125, v125, v220
    v_mul_f32 v126, v126, v220
    v_mul_f32 v127, v127, v220
    s_nop 1
    v_mfma_f32_32x32x16_bf16 v[112:127], a[88:91], v[208:211], v[112:127]
    v_add_f32 v192, v192, v200
    v_add_f32 v193, v193, v201
    v_add_f32 v194, v194, v202
    v_add_f32 v195, v195, v203
    s_waitcnt vmcnt(9)
    ds_write_b128 v26, a[248:251] offset:22528
    v_add_f32 v196, v196, v204
    v_add_f32 v197, v197, v205
    v_add_f32 v198, v198, v206
    v_add_f32 v199, v199, v207
    v_mfma_f32_32x32x16_bf16 v[112:127], a[92:95], v[212:215], v[112:127]
    v_add_f32 v192, v192, v196
    v_add_f32 v193, v193, v197
    v_add_f32 v194, v194, v198
    s_waitcnt vmcnt(8)
    ds_write_b128 v26, a[252:255] offset:23552
    v_add_f32 v195, v195, v199
    v_add_f32 v192, v192, v193
    v_add_f32 v194, v194, v195
    v_add_f32 v192, v192, v194
    v_add_f32 v217, v217, v192
    ds_read_b128 a[32:35], v32 offset:16384
    ds_read_b128 a[36:39], v33 offset:16384
    ds_read_b128 a[40:43], v34 offset:16384
    ds_read_b128 a[44:47], v35 offset:16384
    ds_read_b128 a[48:51], v36 offset:16384
    ds_read_b128 a[52:55], v37 offset:16384
    ds_read_b128 a[56:59], v38 offset:16384
    ds_read_b128 a[60:63], v39 offset:16384
    s_waitcnt lgkmcnt(8)
    v_add_f32 v144, v144, v128
    v_add_f32 v145, v145, v129
    v_add_f32 v146, v146, v130
    v_add_f32 v147, v147, v131
    v_add_f32 v148, v148, v132
    v_add_f32 v149, v149, v133
    v_add_f32 v150, v150, v134
    v_add_f32 v151, v151, v135
    v_add_f32 v152, v152, v136
    v_add_f32 v153, v153, v137
    v_add_f32 v154, v154, v138
    v_add_f32 v155, v155, v139
    v_add_f32 v156, v156, v140
    v_add_f32 v157, v157, v141
    v_add_f32 v158, v158, v142
    v_add_f32 v159, v159, v143
    s_waitcnt lgkmcnt(0)
    v_mfma_f32_32x32x16_bf16 v[128:143], a[32:35], a[0:3], 0
    ds_read_b64_tr_b16 a[64:65], v40 offset:8192
    ds_read_b64_tr_b16 a[66:67], v41 offset:10240
    v_add_f32 v160, v160, v176
    v_add_f32 v161, v161, v177
    v_add_f32 v162, v162, v178
    v_add_f32 v163, v163, v179
    v_add_f32 v164, v164, v180
    v_mfma_f32_32x32x16_bf16 v[128:143], a[36:39], a[4:7], v[128:143]
    ds_read_b64_tr_b16 a[72:73], v42 offset:8192
    ds_read_b64_tr_b16 a[74:75], v43 offset:10240
    v_add_f32 v165, v165, v181
    v_add_f32 v166, v166, v182
    v_add_f32 v167, v167, v183
    v_add_f32 v168, v168, v184
    v_add_f32 v169, v169, v185
    v_mfma_f32_32x32x16_bf16 v[128:143], a[40:43], a[8:11], v[128:143]
    ds_read_b64_tr_b16 a[80:81], v44 offset:8192
    ds_read_b64_tr_b16 a[82:83], v45 offset:10240
    v_add_f32 v170, v170, v186
    v_add_f32 v171, v171, v187
    v_add_f32 v172, v172, v188
    v_add_f32 v173, v173, v189
    v_add_f32 v174, v174, v190
    v_mfma_f32_32x32x16_bf16 v[128:143], a[44:47], a[12:15], v[128:143]
    ds_read_b64_tr_b16 a[88:89], v46 offset:8192
    ds_read_b64_tr_b16 a[90:91], v47 offset:10240
    v_add_f32 v175, v175, v191
    v_add_f32 v144, v144, v160
    v_add_f32 v145, v145, v161
    v_add_f32 v146, v146, v162
    v_add_f32 v147, v147, v163
    v_mfma_f32_32x32x16_bf16 v[128:143], a[48:51], a[16:19], v[128:143]
    ds_read_b64_tr_b16 a[68:69], v40 offset:12288
    ds_read_b64_tr_b16 a[70:71], v41 offset:14336
    v_add_f32 v148, v148, v164
    v_add_f32 v149, v149, v165
    v_add_f32 v150, v150, v166
    v_add_f32 v151, v151, v167
    v_add_f32 v152, v152, v168
    v_mfma_f32_32x32x16_bf16 v[128:143], a[52:55], a[20:23], v[128:143]
    ds_read_b64_tr_b16 a[76:77], v42 offset:12288
    ds_read_b64_tr_b16 a[78:79], v43 offset:14336
    v_add_f32 v153, v153, v169
    v_add_f32 v154, v154, v170
    v_add_f32 v155, v155, v171
    v_add_f32 v156, v156, v172
    v_add_f32 v157, v157, v173
    v_mfma_f32_32x32x16_bf16 v[128:143], a[56:59], a[24:27], v[128:143]
    ds_read_b64_tr_b16 a[84:85], v44 offset:12288
    ds_read_b64_tr_b16 a[86:87], v45 offset:14336
    v_add_f32 v158, v158, v174
    v_add_f32 v159, v159, v175
    v_max3_f32 v218, v144, v145, v146
    v_max3_f32 v219, v147, v148, v149
    v_max3_f32 v220, v150, v151, v152
    v_mfma_f32_32x32x16_bf16 v[128:143], a[60:63], a[28:31], v[128:143]
    ds_read_b64_tr_b16 a[92:93], v46 offset:12288
    ds_read_b64_tr_b16 a[94:95], v47 offset:14336
    v_max3_f32 v221, v153, v154, v155
    v_max3_f32 v218, v218, v156, v157
    v_max3_f32 v219, v219, v158, v159
    v_max3_f32 v218, v218, v219, v220
    v_max_f32 v218, v218, v221
    v_mov_b32 v219, v218
    s_nop 1
    v_permlane32_swap_b32 v218, v219
    v_max3_f32 v218, v218, v219, v216
    v_sub_f32 v220, v216, v218
    v_mov_b32 v216, v218
    v_exp_f32 v220, v220
    v_sub_f32 v192, v144, v218
    v_sub_f32 v193, v145, v218
    v_sub_f32 v194, v146, v218
    v_sub_f32 v195, v147, v218
    v_sub_f32 v196, v148, v218
    v_sub_f32 v197, v149, v218
    v_sub_f32 v198, v150, v218
    v_sub_f32 v199, v151, v218
    v_sub_f32 v200, v152, v218
    v_sub_f32 v201, v153, v218
    v_sub_f32 v202, v154, v218
    v_sub_f32 v203, v155, v218
    v_sub_f32 v204, v156, v218
    v_sub_f32 v205, v157, v218
    v_sub_f32 v206, v158, v218
    v_sub_f32 v207, v159, v218
    ds_write_b128 v28, v[128:131] offset:0
    v_exp_f32 v192, v192
    v_exp_f32 v193, v193
    v_exp_f32 v194, v194
    v_exp_f32 v195, v195
    ds_write_b128 v28, v[132:135] offset:1024
    v_exp_f32 v196, v196
    v_exp_f32 v197, v197
    v_exp_f32 v198, v198
    v_exp_f32 v199, v199
    ds_write_b128 v28, v[136:139] offset:2048
    v_exp_f32 v200, v200
    v_exp_f32 v201, v201
    v_exp_f32 v202, v202
    v_exp_f32 v203, v203
    ds_write_b128 v28, v[140:143] offset:3072
    v_exp_f32 v204, v204
    v_exp_f32 v205, v205
    v_exp_f32 v206, v206
    v_exp_f32 v207, v207
    v_mul_f32 v217, v217, v220
    v_cvt_pk_bf16_f32 v208, v192, v193
    v_cvt_pk_bf16_f32 v209, v194, v195
    v_cvt_pk_bf16_f32 v210, v196, v197
    v_cvt_pk_bf16_f32 v211, v198, v199
    v_cvt_pk_bf16_f32 v212, v200, v201
    v_cvt_pk_bf16_f32 v213, v202, v203
    v_cvt_pk_bf16_f32 v214, v204, v205
    v_cvt_pk_bf16_f32 v215, v206, v207
    v_mul_f32 v64, v64, v220
    v_mul_f32 v65, v65, v220
    v_mul_f32 v66, v66, v220
    v_mul_f32 v67, v67, v220
    v_mul_f32 v68, v68, v220
    v_mul_f32 v69, v69, v220
    v_mul_f32 v70, v70, v220
    v_mul_f32 v71, v71, v220
    v_mul_f32 v72, v72, v220
    v_mul_f32 v73, v73, v220
    v_mul_f32 v74, v74, v220
    v_mul_f32 v75, v75, v220
    v_mul_f32 v76, v76, v220
    v_mul_f32 v77, v77, v220
    v_mul_f32 v78, v78, v220
    v_mul_f32 v79, v79, v220
    s_waitcnt lgkmcnt(0)
    s_barrier
    v_mfma_f32_32x32x16_bf16 v[64:79], a[64:67], v[208:211], v[64:79]
    ds_read_b128 v[144:147], v29 offset:0
    v_mul_f32 v80, v80, v220
    v_mul_f32 v81, v81, v220
    ds_read_b128 v[148:151], v29 offset:1024
    s_waitcnt vmcnt(7)
    ds_write_b128 v26, v[224:227] offset:24576
    v_mul_f32 v82, v82, v220
    v_mul_f32 v83, v83, v220
    ds_read_b128 v[152:155], v29 offset:2048
    v_mul_f32 v84, v84, v220
    v_mfma_f32_32x32x16_bf16 v[64:79], a[68:71], v[212:215], v[64:79]
    v_mul_f32 v85, v85, v220
    ds_read_b128 v[156:159], v29 offset:3072
    v_mul_f32 v86, v86, v220
    s_waitcnt vmcnt(6)
    ds_write_b128 v26, v[228:231] offset:25600
    v_mul_f32 v87, v87, v220
    v_mul_f32 v88, v88, v220
    v_mul_f32 v89, v89, v220
    v_mul_f32 v90, v90, v220
    v_mul_f32 v91, v91, v220
    v_mul_f32 v92, v92, v220
    v_mul_f32 v93, v93, v220
    v_mul_f32 v94, v94, v220
    v_mul_f32 v95, v95, v220
    s_nop 1
    v_mfma_f32_32x32x16_bf16 v[80:95], a[72:75], v[208:211], v[80:95]
    ds_read_b128 v[160:163], v30 offset:0
    v_mul_f32 v96, v96, v220
    v_mul_f32 v97, v97, v220
    ds_read_b128 v[164:167], v30 offset:1024
    s_waitcnt vmcnt(5)
    ds_write_b128 v26, v[232:235] offset:26624
    v_mul_f32 v98, v98, v220
    v_mul_f32 v99, v99, v220
    ds_read_b128 v[168:171], v30 offset:2048
    v_mul_f32 v100, v100, v220
    v_mfma_f32_32x32x16_bf16 v[80:95], a[76:79], v[212:215], v[80:95]
    v_mul_f32 v101, v101, v220
    ds_read_b128 v[172:175], v30 offset:3072
    v_mul_f32 v102, v102, v220
    s_waitcnt vmcnt(4)
    ds_write_b128 v26, v[236:239] offset:27648
    v_mul_f32 v103, v103, v220
    v_mul_f32 v104, v104, v220
    v_mul_f32 v105, v105, v220
    v_mul_f32 v106, v106, v220
    v_mul_f32 v107, v107, v220
    v_mul_f32 v108, v108, v220
    v_mul_f32 v109, v109, v220
    v_mul_f32 v110, v110, v220
    v_mul_f32 v111, v111, v220
    s_nop 1
    v_mfma_f32_32x32x16_bf16 v[96:111], a[80:83], v[208:211], v[96:111]
    ds_read_b128 v[176:179], v31 offset:0
    v_mul_f32 v112, v112, v220
    v_mul_f32 v113, v113, v220
    ds_read_b128 v[180:183], v31 offset:1024
    s_waitcnt vmcnt(3)
    ds_write_b128 v26, v[240:243] offset:28672
    v_mul_f32 v114, v114, v220
    v_mul_f32 v115, v115, v220
    ds_read_b128 v[184:187], v31 offset:2048
    v_mul_f32 v116, v116, v220
    v_mfma_f32_32x32x16_bf16 v[96:111], a[84:87], v[212:215], v[96:111]
    v_mul_f32 v117, v117, v220
    ds_read_b128 v[188:191], v31 offset:3072
    v_mul_f32 v118, v118, v220
    s_waitcnt vmcnt(2)
    ds_write_b128 v26, v[244:247] offset:29696
    v_mul_f32 v119, v119, v220
    v_mul_f32 v120, v120, v220
    v_mul_f32 v121, v121, v220
    v_mul_f32 v122, v122, v220
    v_mul_f32 v123, v123, v220
    v_mul_f32 v124, v124, v220
    v_mul_f32 v125, v125, v220
    v_mul_f32 v126, v126, v220
    v_mul_f32 v127, v127, v220
    s_nop 1
    v_mfma_f32_32x32x16_bf16 v[112:127], a[88:91], v[208:211], v[112:127]
    v_add_f32 v192, v192, v200
    v_add_f32 v193, v193, v201
    v_add_f32 v194, v194, v202
    v_add_f32 v195, v195, v203
    s_waitcnt vmcnt(1)
    ds_write_b128 v26, v[248:251] offset:30720
    v_add_f32 v196, v196, v204
    v_add_f32 v197, v197, v205
    v_add_f32 v198, v198, v206
    v_add_f32 v199, v199, v207
    v_mfma_f32_32x32x16_bf16 v[112:127], a[92:95], v[212:215], v[112:127]
    v_add_f32 v192, v192, v196
    v_add_f32 v193, v193, v197
    v_add_f32 v194, v194, v198
    s_waitcnt vmcnt(0)
    ds_write_b128 v26, v[252:255] offset:31744
    v_add_f32 v195, v195, v199
    v_add_f32 v192, v192, v193
    v_add_f32 v194, v194, v195
    v_add_f32 v192, v192, v194
    v_add_f32 v217, v217, v192
    ds_read_b128 a[32:35], v32 offset:24576
    ds_read_b128 a[36:39], v33 offset:24576
    ds_read_b128 a[40:43], v34 offset:24576
    ds_read_b128 a[44:47], v35 offset:24576
    ds_read_b128 a[48:51], v36 offset:24576
    ds_read_b128 a[52:55], v37 offset:24576
    ds_read_b128 a[56:59], v38 offset:24576
    ds_read_b128 a[60:63], v39 offset:24576
    s_waitcnt lgkmcnt(8)
    v_add_f32 v144, v144, v128
    v_add_f32 v145, v145, v129
    v_add_f32 v146, v146, v130
    v_add_f32 v147, v147, v131
    v_add_f32 v148, v148, v132
    v_add_f32 v149, v149, v133
    v_add_f32 v150, v150, v134
    v_add_f32 v151, v151, v135
    v_add_f32 v152, v152, v136
    v_add_f32 v153, v153, v137
    v_add_f32 v154, v154, v138
    v_add_f32 v155, v155, v139
    v_add_f32 v156, v156, v140
    v_add_f32 v157, v157, v141
    v_add_f32 v158, v158, v142
    v_add_f32 v159, v159, v143
    s_waitcnt lgkmcnt(0)
    v_mfma_f32_32x32x16_bf16 v[128:143], a[32:35], a[0:3], 0
    ds_read_b64_tr_b16 a[64:65], v40 offset:16384
    ds_read_b64_tr_b16 a[66:67], v41 offset:18432
    v_add_f32 v160, v160, v176
    v_add_f32 v161, v161, v177
    v_add_f32 v162, v162, v178
    v_add_f32 v163, v163, v179
    v_add_f32 v164, v164, v180
    v_mfma_f32_32x32x16_bf16 v[128:143], a[36:39], a[4:7], v[128:143]
    ds_read_b64_tr_b16 a[72:73], v42 offset:16384
    ds_read_b64_tr_b16 a[74:75], v43 offset:18432
    v_add_f32 v165, v165, v181
    v_add_f32 v166, v166, v182
    v_add_f32 v167, v167, v183
    v_add_f32 v168, v168, v184
    v_add_f32 v169, v169, v185
    v_mfma_f32_32x32x16_bf16 v[128:143], a[40:43], a[8:11], v[128:143]
    ds_read_b64_tr_b16 a[80:81], v44 offset:16384
    ds_read_b64_tr_b16 a[82:83], v45 offset:18432
    v_add_f32 v170, v170, v186
    v_add_f32 v171, v171, v187
    v_add_f32 v172, v172, v188
    v_add_f32 v173, v173, v189
    v_add_f32 v174, v174, v190
    v_mfma_f32_32x32x16_bf16 v[128:143], a[44:47], a[12:15], v[128:143]
    ds_read_b64_tr_b16 a[88:89], v46 offset:16384
    ds_read_b64_tr_b16 a[90:91], v47 offset:18432
    v_add_f32 v175, v175, v191
    v_add_f32 v144, v144, v160
    v_add_f32 v145, v145, v161
    v_add_f32 v146, v146, v162
    v_add_f32 v147, v147, v163
    v_mfma_f32_32x32x16_bf16 v[128:143], a[48:51], a[16:19], v[128:143]
    ds_read_b64_tr_b16 a[68:69], v40 offset:20480
    ds_read_b64_tr_b16 a[70:71], v41 offset:22528
    v_add_f32 v148, v148, v164
    v_add_f32 v149, v149, v165
    v_add_f32 v150, v150, v166
    v_add_f32 v151, v151, v167
    v_add_f32 v152, v152, v168
    v_mfma_f32_32x32x16_bf16 v[128:143], a[52:55], a[20:23], v[128:143]
    ds_read_b64_tr_b16 a[76:77], v42 offset:20480
    ds_read_b64_tr_b16 a[78:79], v43 offset:22528
    v_add_f32 v153, v153, v169
    v_add_f32 v154, v154, v170
    v_add_f32 v155, v155, v171
    v_add_f32 v156, v156, v172
    v_add_f32 v157, v157, v173
    v_mfma_f32_32x32x16_bf16 v[128:143], a[56:59], a[24:27], v[128:143]
    ds_read_b64_tr_b16 a[84:85], v44 offset:20480
    ds_read_b64_tr_b16 a[86:87], v45 offset:22528
    v_add_f32 v158, v158, v174
    v_add_f32 v159, v159, v175
    v_max3_f32 v218, v144, v145, v146
    v_max3_f32 v219, v147, v148, v149
    v_max3_f32 v220, v150, v151, v152
    v_mfma_f32_32x32x16_bf16 v[128:143], a[60:63], a[28:31], v[128:143]
    ds_read_b64_tr_b16 a[92:93], v46 offset:20480
    ds_read_b64_tr_b16 a[94:95], v47 offset:22528
    v_max3_f32 v221, v153, v154, v155
    v_max3_f32 v218, v218, v156, v157
    v_max3_f32 v219, v219, v158, v159
    v_max3_f32 v218, v218, v219, v220
    v_max_f32 v218, v218, v221
    v_mov_b32 v219, v218
    s_nop 1
    v_permlane32_swap_b32 v218, v219
    v_max3_f32 v218, v218, v219, v216
    v_sub_f32 v220, v216, v218
    v_mov_b32 v216, v218
    v_exp_f32 v220, v220
    v_sub_f32 v192, v144, v218
    v_sub_f32 v193, v145, v218
    v_sub_f32 v194, v146, v218
    v_sub_f32 v195, v147, v218
    v_sub_f32 v196, v148, v218
    v_sub_f32 v197, v149, v218
    v_sub_f32 v198, v150, v218
    v_sub_f32 v199, v151, v218
    v_sub_f32 v200, v152, v218
    v_sub_f32 v201, v153, v218
    v_sub_f32 v202, v154, v218
    v_sub_f32 v203, v155, v218
    v_sub_f32 v204, v156, v218
    v_sub_f32 v205, v157, v218
    v_sub_f32 v206, v158, v218
    v_sub_f32 v207, v159, v218
    ds_write_b128 v28, v[128:131] offset:16384
    v_exp_f32 v192, v192
    v_exp_f32 v193, v193
    v_exp_f32 v194, v194
    v_exp_f32 v195, v195
    ds_write_b128 v28, v[132:135] offset:17408
    v_exp_f32 v196, v196
    v_exp_f32 v197, v197
    v_exp_f32 v198, v198
    v_exp_f32 v199, v199
    ds_write_b128 v28, v[136:139] offset:18432
    v_exp_f32 v200, v200
    v_exp_f32 v201, v201
    v_exp_f32 v202, v202
    v_exp_f32 v203, v203
    ds_write_b128 v28, v[140:143] offset:19456
    v_exp_f32 v204, v204
    v_exp_f32 v205, v205
    v_exp_f32 v206, v206
    v_exp_f32 v207, v207
    v_mul_f32 v217, v217, v220
    v_cvt_pk_bf16_f32 v208, v192, v193
    v_cvt_pk_bf16_f32 v209, v194, v195
    v_cvt_pk_bf16_f32 v210, v196, v197
    v_cvt_pk_bf16_f32 v211, v198, v199
    v_cvt_pk_bf16_f32 v212, v200, v201
    v_cvt_pk_bf16_f32 v213, v202, v203
    v_cvt_pk_bf16_f32 v214, v204, v205
    v_cvt_pk_bf16_f32 v215, v206, v207
    v_mul_f32 v64, v64, v220
    v_mul_f32 v65, v65, v220
    v_mul_f32 v66, v66, v220
    v_mul_f32 v67, v67, v220
    v_mul_f32 v68, v68, v220
    v_mul_f32 v69, v69, v220
    v_mul_f32 v70, v70, v220
    v_mul_f32 v71, v71, v220
    v_mul_f32 v72, v72, v220
    v_mul_f32 v73, v73, v220
    v_mul_f32 v74, v74, v220
    v_mul_f32 v75, v75, v220
    v_mul_f32 v76, v76, v220
    v_mul_f32 v77, v77, v220
    v_mul_f32 v78, v78, v220
    v_mul_f32 v79, v79, v220
    s_waitcnt lgkmcnt(0)
    s_barrier
    v_mfma_f32_32x32x16_bf16 v[64:79], a[64:67], v[208:211], v[64:79]
    ds_read_b128 v[144:147], v29 offset:16384
    v_mul_f32 v80, v80, v220
    v_mul_f32 v81, v81, v220
    ds_read_b128 v[148:151], v29 offset:17408
    v_mul_f32 v82, v82, v220
    v_mul_f32 v83, v83, v220
    ds_read_b128 v[152:155], v29 offset:18432
    v_mul_f32 v84, v84, v220
    v_mfma_f32_32x32x16_bf16 v[64:79], a[68:71], v[212:215], v[64:79]
    v_mul_f32 v85, v85, v220
    ds_read_b128 v[156:159], v29 offset:19456
    v_mul_f32 v86, v86, v220
    v_mul_f32 v87, v87, v220
    v_mul_f32 v88, v88, v220
    v_mul_f32 v89, v89, v220
    v_mul_f32 v90, v90, v220
    v_mul_f32 v91, v91, v220
    v_mul_f32 v92, v92, v220
    v_mul_f32 v93, v93, v220
    v_mul_f32 v94, v94, v220
    v_mul_f32 v95, v95, v220
    s_nop 1
    v_mfma_f32_32x32x16_bf16 v[80:95], a[72:75], v[208:211], v[80:95]
    ds_read_b128 v[160:163], v30 offset:16384
    v_mul_f32 v96, v96, v220
    v_mul_f32 v97, v97, v220
    ds_read_b128 v[164:167], v30 offset:17408
    v_mul_f32 v98, v98, v220
    v_mul_f32 v99, v99, v220
    ds_read_b128 v[168:171], v30 offset:18432
    v_mul_f32 v100, v100, v220
    v_mfma_f32_32x32x16_bf16 v[80:95], a[76:79], v[212:215], v[80:95]
    v_mul_f32 v101, v101, v220
    ds_read_b128 v[172:175], v30 offset:19456
    v_mul_f32 v102, v102, v220
    v_mul_f32 v103, v103, v220
    v_mul_f32 v104, v104, v220
    v_mul_f32 v105, v105, v220
    v_mul_f32 v106, v106, v220
    v_mul_f32 v107, v107, v220
    v_mul_f32 v108, v108, v220
    v_mul_f32 v109, v109, v220
    v_mul_f32 v110, v110, v220
    v_mul_f32 v111, v111, v220
    s_nop 1
    v_mfma_f32_32x32x16_bf16 v[96:111], a[80:83], v[208:211], v[96:111]
    ds_read_b128 v[176:179], v31 offset:16384
    v_mul_f32 v112, v112, v220
    v_mul_f32 v113, v113, v220
    ds_read_b128 v[180:183], v31 offset:17408
    v_mul_f32 v114, v114, v220
    v_mul_f32 v115, v115, v220
    ds_read_b128 v[184:187], v31 offset:18432
    v_mul_f32 v116, v116, v220
    v_mfma_f32_32x32x16_bf16 v[96:111], a[84:87], v[212:215], v[96:111]
    v_mul_f32 v117, v117, v220
    ds_read_b128 v[188:191], v31 offset:19456
    v_mul_f32 v118, v118, v220
    v_mul_f32 v119, v119, v220
    v_mul_f32 v120, v120, v220
    v_mul_f32 v121, v121, v220
    v_mul_f32 v122, v122, v220
    v_mul_f32 v123, v123, v220
    v_mul_f32 v124, v124, v220
    v_mul_f32 v125, v125, v220
    v_mul_f32 v126, v126, v220
    v_mul_f32 v127, v127, v220
    s_nop 1
    v_mfma_f32_32x32x16_bf16 v[112:127], a[88:91], v[208:211], v[112:127]
    v_add_f32 v192, v192, v200
    v_add_f32 v193, v193, v201
    v_add_f32 v194, v194, v202
    v_add_f32 v195, v195, v203
    v_add_f32 v196, v196, v204
    v_add_f32 v197, v197, v205
    v_add_f32 v198, v198, v206
    v_add_f32 v199, v199, v207
    v_mfma_f32_32x32x16_bf16 v[112:127], a[92:95], v[212:215], v[112:127]
    v_add_f32 v192, v192, v196
    v_add_f32 v193, v193, v197
    v_add_f32 v194, v194, v198
    v_add_f32 v195, v195, v199
    v_add_f32 v192, v192, v193
    v_add_f32 v194, v194, v195
    v_add_f32 v192, v192, v194
    v_add_f32 v217, v217, v192
    s_waitcnt lgkmcnt(0)
    v_add_f32 v144, v144, v128
    v_add_f32 v145, v145, v129
    v_add_f32 v146, v146, v130
    v_add_f32 v147, v147, v131
    v_add_f32 v148, v148, v132
    v_add_f32 v149, v149, v133
    v_add_f32 v150, v150, v134
    v_add_f32 v151, v151, v135
    v_add_f32 v152, v152, v136
    v_add_f32 v153, v153, v137
    v_add_f32 v154, v154, v138
    v_add_f32 v155, v155, v139
    v_add_f32 v156, v156, v140
    v_add_f32 v157, v157, v141
    v_add_f32 v158, v158, v142
    v_add_f32 v159, v159, v143
    s_waitcnt lgkmcnt(0)
    ds_read_b64_tr_b16 a[64:65], v40 offset:24576
    ds_read_b64_tr_b16 a[66:67], v41 offset:26624
    v_add_f32 v160, v160, v176
    v_add_f32 v161, v161, v177
    v_add_f32 v162, v162, v178
    v_add_f32 v163, v163, v179
    v_add_f32 v164, v164, v180
    ds_read_b64_tr_b16 a[72:73], v42 offset:24576
    ds_read_b64_tr_b16 a[74:75], v43 offset:26624
    v_add_f32 v165, v165, v181
    v_add_f32 v166, v166, v182
    v_add_f32 v167, v167, v183
    v_add_f32 v168, v168, v184
    v_add_f32 v169, v169, v185
    ds_read_b64_tr_b16 a[80:81], v44 offset:24576
    ds_read_b64_tr_b16 a[82:83], v45 offset:26624
    v_add_f32 v170, v170, v186
    v_add_f32 v171, v171, v187
    v_add_f32 v172, v172, v188
    v_add_f32 v173, v173, v189
    v_add_f32 v174, v174, v190
    ds_read_b64_tr_b16 a[88:89], v46 offset:24576
    ds_read_b64_tr_b16 a[90:91], v47 offset:26624
    v_add_f32 v175, v175, v191
    v_add_f32 v144, v144, v160
    v_add_f32 v145, v145, v161
    v_add_f32 v146, v146, v162
    v_add_f32 v147, v147, v163
    ds_read_b64_tr_b16 a[68:69], v40 offset:28672
    ds_read_b64_tr_b16 a[70:71], v41 offset:30720
    v_add_f32 v148, v148, v164
    v_add_f32 v149, v149, v165
    v_add_f32 v150, v150, v166
    v_add_f32 v151, v151, v167
    v_add_f32 v152, v152, v168
    ds_read_b64_tr_b16 a[76:77], v42 offset:28672
    ds_read_b64_tr_b16 a[78:79], v43 offset:30720
    v_add_f32 v153, v153, v169
    v_add_f32 v154, v154, v170
    v_add_f32 v155, v155, v171
    v_add_f32 v156, v156, v172
    v_add_f32 v157, v157, v173
    ds_read_b64_tr_b16 a[84:85], v44 offset:28672
    ds_read_b64_tr_b16 a[86:87], v45 offset:30720
    v_add_f32 v158, v158, v174
    v_add_f32 v159, v159, v175
    v_max3_f32 v218, v144, v145, v146
    v_max3_f32 v219, v147, v148, v149
    v_max3_f32 v220, v150, v151, v152
    ds_read_b64_tr_b16 a[92:93], v46 offset:28672
    ds_read_b64_tr_b16 a[94:95], v47 offset:30720
    v_max3_f32 v221, v153, v154, v155
    v_max3_f32 v218, v218, v156, v157
    v_max3_f32 v219, v219, v158, v159
    v_max3_f32 v218, v218, v219, v220
    v_max_f32 v218, v218, v221
    v_mov_b32 v219, v218
    s_nop 1
    v_permlane32_swap_b32 v218, v219
    v_max3_f32 v218, v218, v219, v216
    v_sub_f32 v220, v216, v218
    v_mov_b32 v216, v218
    v_exp_f32 v220, v220
    v_sub_f32 v192, v144, v218
    v_sub_f32 v193, v145, v218
    v_sub_f32 v194, v146, v218
    v_sub_f32 v195, v147, v218
    v_sub_f32 v196, v148, v218
    v_sub_f32 v197, v149, v218
    v_sub_f32 v198, v150, v218
    v_sub_f32 v199, v151, v218
    v_sub_f32 v200, v152, v218
    v_sub_f32 v201, v153, v218
    v_sub_f32 v202, v154, v218
    v_sub_f32 v203, v155, v218
    v_sub_f32 v204, v156, v218
    v_sub_f32 v205, v157, v218
    v_sub_f32 v206, v158, v218
    v_sub_f32 v207, v159, v218
    v_exp_f32 v192, v192
    v_exp_f32 v193, v193
    v_exp_f32 v194, v194
    v_exp_f32 v195, v195
    v_exp_f32 v196, v196
    v_exp_f32 v197, v197
    v_exp_f32 v198, v198
    v_exp_f32 v199, v199
    v_exp_f32 v200, v200
    v_exp_f32 v201, v201
    v_exp_f32 v202, v202
    v_exp_f32 v203, v203
    v_exp_f32 v204, v204
    v_exp_f32 v205, v205
    v_exp_f32 v206, v206
    v_exp_f32 v207, v207
    v_mul_f32 v217, v217, v220
    v_cvt_pk_bf16_f32 v208, v192, v193
    v_cvt_pk_bf16_f32 v209, v194, v195
    v_cvt_pk_bf16_f32 v210, v196, v197
    v_cvt_pk_bf16_f32 v211, v198, v199
    v_cvt_pk_bf16_f32 v212, v200, v201
    v_cvt_pk_bf16_f32 v213, v202, v203
    v_cvt_pk_bf16_f32 v214, v204, v205
    v_cvt_pk_bf16_f32 v215, v206, v207
    v_mul_f32 v64, v64, v220
    v_mul_f32 v65, v65, v220
    v_mul_f32 v66, v66, v220
    v_mul_f32 v67, v67, v220
    v_mul_f32 v68, v68, v220
    v_mul_f32 v69, v69, v220
    v_mul_f32 v70, v70, v220
    v_mul_f32 v71, v71, v220
    v_mul_f32 v72, v72, v220
    v_mul_f32 v73, v73, v220
    v_mul_f32 v74, v74, v220
    v_mul_f32 v75, v75, v220
    v_mul_f32 v76, v76, v220
    v_mul_f32 v77, v77, v220
    v_mul_f32 v78, v78, v220
    v_mul_f32 v79, v79, v220
    s_waitcnt lgkmcnt(0)
    s_nop 0
    v_mfma_f32_32x32x16_bf16 v[64:79], a[64:67], v[208:211], v[64:79]
    v_mul_f32 v80, v80, v220
    v_mul_f32 v81, v81, v220
    v_mul_f32 v82, v82, v220
    v_mul_f32 v83, v83, v220
    v_mul_f32 v84, v84, v220
    v_mul_f32 v85, v85, v220
    v_mul_f32 v86, v86, v220
    v_mul_f32 v87, v87, v220
    v_mfma_f32_32x32x16_bf16 v[64:79], a[68:71], v[212:215], v[64:79]
    v_mul_f32 v88, v88, v220
    v_mul_f32 v89, v89, v220
    v_mul_f32 v90, v90, v220
    v_mul_f32 v91, v91, v220
    v_mul_f32 v92, v92, v220
    v_mul_f32 v93, v93, v220
    v_mul_f32 v94, v94, v220
    v_mul_f32 v95, v95, v220
    s_nop 1
    v_mfma_f32_32x32x16_bf16 v[80:95], a[72:75], v[208:211], v[80:95]
    v_mul_f32 v96, v96, v220
    v_mul_f32 v97, v97, v220
    v_mul_f32 v98, v98, v220
    v_mul_f32 v99, v99, v220
    v_mul_f32 v100, v100, v220
    v_mul_f32 v101, v101, v220
    v_mul_f32 v102, v102, v220
    v_mul_f32 v103, v103, v220
    v_mfma_f32_32x32x16_bf16 v[80:95], a[76:79], v[212:215], v[80:95]
    v_mul_f32 v104, v104, v220
    v_mul_f32 v105, v105, v220
    v_mul_f32 v106, v106, v220
    v_mul_f32 v107, v107, v220
    v_mul_f32 v108, v108, v220
    v_mul_f32 v109, v109, v220
    v_mul_f32 v110, v110, v220
    v_mul_f32 v111, v111, v220
    s_nop 1
    v_mfma_f32_32x32x16_bf16 v[96:111], a[80:83], v[208:211], v[96:111]
    v_mul_f32 v112, v112, v220
    v_mul_f32 v113, v113, v220
    v_mul_f32 v114, v114, v220
    v_mul_f32 v115, v115, v220
    v_mul_f32 v116, v116, v220
    v_mul_f32 v117, v117, v220
    v_mul_f32 v118, v118, v220
    v_mul_f32 v119, v119, v220
    v_mfma_f32_32x32x16_bf16 v[96:111], a[84:87], v[212:215], v[96:111]
    v_mul_f32 v120, v120, v220
    v_mul_f32 v121, v121, v220
    v_mul_f32 v122, v122, v220
    v_mul_f32 v123, v123, v220
    v_mul_f32 v124, v124, v220
    v_mul_f32 v125, v125, v220
    v_mul_f32 v126, v126, v220
    v_mul_f32 v127, v127, v220
    s_nop 1
    v_mfma_f32_32x32x16_bf16 v[112:127], a[88:91], v[208:211], v[112:127]
    v_add_f32 v192, v192, v200
    v_add_f32 v193, v193, v201
    v_add_f32 v194, v194, v202
    v_add_f32 v195, v195, v203
    v_add_f32 v196, v196, v204
    v_add_f32 v197, v197, v205
    v_add_f32 v198, v198, v206
    v_add_f32 v199, v199, v207
    v_mfma_f32_32x32x16_bf16 v[112:127], a[92:95], v[212:215], v[112:127]
    v_add_f32 v192, v192, v196
    v_add_f32 v193, v193, v197
    v_add_f32 v194, v194, v198
    v_add_f32 v195, v195, v199
    v_add_f32 v192, v192, v193
    v_add_f32 v194, v194, v195
    v_add_f32 v192, v192, v194
    v_add_f32 v217, v217, v192
    s_waitcnt lgkmcnt(0)
    v_mov_b32 v219, v217
    s_nop 1
    v_permlane32_swap_b32 v217, v219
    v_add_f32 v217, v217, v219
    v_rcp_f32 v220, v217
    v_mul_u32_u24 v5, 272, v24
    v_lshl_add_u32 v5, v25, 3, v5
    v_add_u32 v5, s63, v5
    v_mul_f32 v64, v64, v220
    v_mul_f32 v65, v65, v220
    v_mul_f32 v66, v66, v220
    v_mul_f32 v67, v67, v220
    v_mul_f32 v68, v68, v220
    v_mul_f32 v69, v69, v220
    v_mul_f32 v70, v70, v220
    v_mul_f32 v71, v71, v220
    v_mul_f32 v72, v72, v220
    v_mul_f32 v73, v73, v220
    v_mul_f32 v74, v74, v220
    v_mul_f32 v75, v75, v220
    v_mul_f32 v76, v76, v220
    v_mul_f32 v77, v77, v220
    v_mul_f32 v78, v78, v220
    v_mul_f32 v79, v79, v220
    v_mul_f32 v80, v80, v220
    v_mul_f32 v81, v81, v220
    v_mul_f32 v82, v82, v220
    v_mul_f32 v83, v83, v220
    v_mul_f32 v84, v84, v220
    v_mul_f32 v85, v85, v220
    v_mul_f32 v86, v86, v220
    v_mul_f32 v87, v87, v220
    v_mul_f32 v88, v88, v220
    v_mul_f32 v89, v89, v220
    v_mul_f32 v90, v90, v220
    v_mul_f32 v91, v91, v220
    v_mul_f32 v92, v92, v220
    v_mul_f32 v93, v93, v220
    v_mul_f32 v94, v94, v220
    v_mul_f32 v95, v95, v220
    v_mul_f32 v96, v96, v220
    v_mul_f32 v97, v97, v220
    v_mul_f32 v98, v98, v220
    v_mul_f32 v99, v99, v220
    v_mul_f32 v100, v100, v220
    v_mul_f32 v101, v101, v220
    v_mul_f32 v102, v102, v220
    v_mul_f32 v103, v103, v220
    v_mul_f32 v104, v104, v220
    v_mul_f32 v105, v105, v220
    v_mul_f32 v106, v106, v220
    v_mul_f32 v107, v107, v220
    v_mul_f32 v108, v108, v220
    v_mul_f32 v109, v109, v220
    v_mul_f32 v110, v110, v220
    v_mul_f32 v111, v111, v220
    v_mul_f32 v112, v112, v220
    v_mul_f32 v113, v113, v220
    v_mul_f32 v114, v114, v220
    v_mul_f32 v115, v115, v220
    v_mul_f32 v116, v116, v220
    v_mul_f32 v117, v117, v220
    v_mul_f32 v118, v118, v220
    v_mul_f32 v119, v119, v220
    v_mul_f32 v120, v120, v220
    v_mul_f32 v121, v121, v220
    v_mul_f32 v122, v122, v220
    v_mul_f32 v123, v123, v220
    v_mul_f32 v124, v124, v220
    v_mul_f32 v125, v125, v220
    v_mul_f32 v126, v126, v220
    v_mul_f32 v127, v127, v220
    v_cvt_pk_bf16_f32 v128, v64, v65
    v_cvt_pk_bf16_f32 v129, v66, v67
    v_cvt_pk_bf16_f32 v130, v68, v69
    v_cvt_pk_bf16_f32 v131, v70, v71
    v_cvt_pk_bf16_f32 v132, v72, v73
    v_cvt_pk_bf16_f32 v133, v74, v75
    v_cvt_pk_bf16_f32 v134, v76, v77
    v_cvt_pk_bf16_f32 v135, v78, v79
    v_cvt_pk_bf16_f32 v136, v80, v81
    v_cvt_pk_bf16_f32 v137, v82, v83
    v_cvt_pk_bf16_f32 v138, v84, v85
    v_cvt_pk_bf16_f32 v139, v86, v87
    v_cvt_pk_bf16_f32 v140, v88, v89
    v_cvt_pk_bf16_f32 v141, v90, v91
    v_cvt_pk_bf16_f32 v142, v92, v93
    v_cvt_pk_bf16_f32 v143, v94, v95
    v_cvt_pk_bf16_f32 v144, v96, v97
    v_cvt_pk_bf16_f32 v145, v98, v99
    v_cvt_pk_bf16_f32 v146, v100, v101
    v_cvt_pk_bf16_f32 v147, v102, v103
    v_cvt_pk_bf16_f32 v148, v104, v105
    v_cvt_pk_bf16_f32 v149, v106, v107
    v_cvt_pk_bf16_f32 v150, v108, v109
    v_cvt_pk_bf16_f32 v151, v110, v111
    v_cvt_pk_bf16_f32 v152, v112, v113
    v_cvt_pk_bf16_f32 v153, v114, v115
    v_cvt_pk_bf16_f32 v154, v116, v117
    v_cvt_pk_bf16_f32 v155, v118, v119
    v_cvt_pk_bf16_f32 v156, v120, v121
    v_cvt_pk_bf16_f32 v157, v122, v123
    v_cvt_pk_bf16_f32 v158, v124, v125
    v_cvt_pk_bf16_f32 v159, v126, v127
    v_min_u32 v216, -2, v216
    v_min_u32 v217, -2, v217
    s_nop 0
    v_mov_b32_dpp v218, v216 quad_perm:[1,1,3,3] row_mask:0xf bank_mask:0xf
    v_mov_b32_dpp v219, v217 quad_perm:[1,1,3,3] row_mask:0xf bank_mask:0xf
    ds_write_b64 v5, v[128:129] offset:0
    ds_write_b64 v5, v[130:131] offset:16
    ds_write_b64 v5, v[132:133] offset:32
    ds_write_b64 v5, v[134:135] offset:48
    ds_write_b64 v5, v[136:137] offset:64
    ds_write_b64 v5, v[138:139] offset:80
    ds_write_b64 v5, v[140:141] offset:96
    ds_write_b64 v5, v[142:143] offset:112
    ds_write_b64 v5, v[144:145] offset:128
    ds_write_b64 v5, v[146:147] offset:144
    ds_write_b64 v5, v[148:149] offset:160
    ds_write_b64 v5, v[150:151] offset:176
    ds_write_b64 v5, v[152:153] offset:192
    ds_write_b64 v5, v[154:155] offset:208
    ds_write_b64 v5, v[156:157] offset:224
    ds_write_b64 v5, v[158:159] offset:240
    v_mul_u32_u24 v6, 272, v4
    v_lshl_add_u32 v6, v3, 4, v6
    v_add_u32 v6, s63, v6
    s_waitcnt lgkmcnt(0)
    ds_read_b128 v[64:67], v6 offset:0
    ds_read_b128 v[68:71], v6 offset:1088
    ds_read_b128 v[72:75], v6 offset:2176
    ds_read_b128 v[76:79], v6 offset:3264
    ds_read_b128 v[80:83], v6 offset:4352
    ds_read_b128 v[84:87], v6 offset:5440
    ds_read_b128 v[88:91], v6 offset:6528
    ds_read_b128 v[92:95], v6 offset:7616
    v_lshlrev_b32 v7, 10, v4
    v_lshl_add_u32 v7, v3, 4, v7
    s_lshl_b32 s54, s53, 15
    s_lshl_b32 s55, s3, 8
    s_add_u32 s54, s54, s55
    s_add_u32 s54, s54, 2097152
    s_waitcnt lgkmcnt(7)
    buffer_store_dwordx4 v[64:67], v7, s[44:47], s54 offen sc1
    s_add_u32 s54, s54, 4096
    s_waitcnt lgkmcnt(6)
    buffer_store_dwordx4 v[68:71], v7, s[44:47], s54 offen sc1
    s_add_u32 s54, s54, 4096
    s_waitcnt lgkmcnt(5)
    buffer_store_dwordx4 v[72:75], v7, s[44:47], s54 offen sc1
    s_add_u32 s54, s54, 4096
    s_waitcnt lgkmcnt(4)
    buffer_store_dwordx4 v[76:79], v7, s[44:47], s54 offen sc1
    s_add_u32 s54, s54, 4096
    s_waitcnt lgkmcnt(3)
    buffer_store_dwordx4 v[80:83], v7, s[44:47], s54 offen sc1
    s_add_u32 s54, s54, 4096
    s_waitcnt lgkmcnt(2)
    buffer_store_dwordx4 v[84:87], v7, s[44:47], s54 offen sc1
    s_add_u32 s54, s54, 4096
    s_waitcnt lgkmcnt(1)
    buffer_store_dwordx4 v[88:91], v7, s[44:47], s54 offen sc1
    s_add_u32 s54, s54, 4096
    s_waitcnt lgkmcnt(0)
    buffer_store_dwordx4 v[92:95], v7, s[44:47], s54 offen sc1
    s_add_u32 s54, s54, 4096
    v_lshlrev_b32 v5, 3, v1
    s_lshl_b32 s54, s53, 8
    s_add_u32 s54, s54, 3145728
    s_cmp_eq_u32 s3, 0
    s_cselect_b32 s56, 0x55555555, 0
    s_mov_b32 s57, 0
    s_waitcnt vmcnt(0)
    s_barrier
    s_mov_b64 exec, s[56:57]
    buffer_store_dwordx4 v[216:219], v5, s[44:47], s54 offen sc1
    s_mov_b64 exec, -1
    s_mov_b32 s48, s26
    s_mov_b32 s49, s27
    s_mov_b32 s50, 9216
    s_mov_b32 s51, 0x20000
    s_lshl_b32 s54, s3, 5
    s_add_u32 s54, s54, s53
    s_cmp_ge_u32 s54, 72
    s_cbranch_scc1 L_nored_27
    s_waitcnt vmcnt(0)
    v_mov_b32 v48, -1
    v_mov_b32 v49, -1
    v_mov_b32 v50, -1
    v_mov_b32 v51, -1
    v_mov_b32 v52, -1
    v_mov_b32 v53, -1
    v_mov_b32 v54, -1
    v_mov_b32 v55, -1
    v_mov_b32 v56, -1
    v_mov_b32 v57, -1
    v_mov_b32 v58, -1
    v_mov_b32 v59, -1
    v_mov_b32 v60, -1
    v_mov_b32 v61, -1
    v_mov_b32 v62, -1
    v_mov_b32 v63, -1
    s_lshl_b32 s55, s54, 12
    s_add_u32 s55, s55, 4194304
    s_mul_hi_u32 s56, s54, 238609295
    s_add_u32 s56, s56, 0
    s_mul_i32 s56, s56, 1152
    s_lshl_b32 s57, s54, 6
    s_add_u32 s56, s56, s57
    v_lshlrev_b32 v5, 3, v3
    v_lshl_add_u32 v5, v4, 1, v5
    v_mov_b32 v6, 0x4000
    v_cmp_gt_u32 vcc, 8, v3
    s_nop 1
    v_cndmask_b32 v5, v6, v5, vcc
    s_mov_b64 s[4:5], -1
    s_mov_b64 s[6:7], -1
    s_mov_b64 s[8:9], -1
    s_mov_b64 s[10:11], -1
L_mpoll_28:
    s_mov_b64 exec, s[4:5]
    buffer_load_dwordx4 v[48:51], v2, s[44:47], s55 offen offset:0 sc1
    s_mov_b64 exec, s[6:7]
    buffer_load_dwordx4 v[52:55], v2, s[44:47], s55 offen offset:1024 sc1
    s_mov_b64 exec, s[8:9]
    buffer_load_dwordx4 v[56:59], v2, s[44:47], s55 offen offset:2048 sc1
    s_mov_b64 exec, s[10:11]
    buffer_load_dwordx4 v[60:63], v2, s[44:47], s55 offen offset:3072 sc1
    s_mov_b64 exec, -1
    s_waitcnt vmcnt(4)
    v_max3_u32 v32, v48, v49, v50
    v_max3_u32 v33, v52, v53, v54
    v_max3_u32 v34, v56, v57, v58
    v_max3_u32 v35, v60, v61, v62
    v_max_u32 v32, v32, v51
    v_max_u32 v33, v33, v55
    v_max_u32 v34, v34, v59
    v_max_u32 v35, v35, v63
    v_cmp_eq_u32 s[4:5], -1, v32
    v_cmp_eq_u32 s[6:7], -1, v33
    v_cmp_eq_u32 s[8:9], -1, v34
    v_cmp_eq_u32 s[10:11], -1, v35
    s_or_b64 vcc, s[4:5], s[6:7]
    s_or_b64 vcc, vcc, s[8:9]
    s_or_b64 vcc, vcc, s[10:11]
    s_cbranch_scc0 L_mpollok_29
    s_and_b64 vcc, s[4:5], s[6:7]
    s_and_b64 vcc, vcc, s[8:9]
    s_and_b64 vcc, vcc, s[10:11]
    s_cmp_eq_u64 vcc, -1
    s_cbranch_scc0 L_mpoll_28_b
    s_sleep 4
L_mpoll_28_b:
    s_sub_u32 s101, s101, 1
    s_cbranch_scc0 L_mpoll_28
    s_mov_b32 s101, 0
L_mpollok_29:
    v_add_f32 v16, v48, v52
    v_add_f32 v24, v56, v60
    v_add_f32 v18, v50, v54
    v_add_f32 v26, v58, v62
    v_add_f32 v17, v49, v53
    v_add_f32 v25, v57, v61
    v_add_f32 v19, v51, v55
    v_add_f32 v27, v59, v63
    v_add_f32 v16, v16, v24
    v_add_f32 v18, v18, v26
    v_add_f32 v17, v17, v25
    v_add_f32 v19, v19, v27
    v_permlane32_swap_b32 v16, v18
    s_nop 0
    v_permlane32_swap_b32 v17, v19
    v_add_f32 v16, v16, v18
    v_add_f32 v17, v17, v19
    s_nop 1
    v_permlane16_swap_b32 v16, v17
    v_add_f32 v16, v16, v17
    s_nop 1
    v_add_f32_dpp v16, v16, v16 row_ror:8 row_mask:0xf bank_mask:0xf
    v_cvt_pk_bf16_f32 v16, v16, v16
    buffer_store_short v16, v5, s[48:51], s56 offen
L_nored_27:
    s_endpgm
L_roleC_end:
L_exit:
    s_endpgm
.section .rodata,"a"
.p2align 6
.amdhsa_kernel concat_heads__mha_block_cached__compressed_kv_cla__decode_kernel
  .amdhsa_next_free_vgpr 512
  .amdhsa_next_free_sgpr 102
  .amdhsa_accum_offset 256
  .amdhsa_group_segment_fixed_size 0
  .amdhsa_kernarg_size 112
  .amdhsa_user_sgpr_count 2
  .amdhsa_user_sgpr_kernarg_segment_ptr 1
  .amdhsa_system_sgpr_workgroup_id_x 1
.end_amdhsa_kernel
```

```asm
; @launch grid=(256,1,1) block=(256,1,1) lds=163840
.amdgcn_target "amdgcn-amd-amdhsa--gfx950"
.text
.globl concat_heads__mha_block_cached__compressed_kv_cla__decode_kernel
.p2align 12
.p2align 8
.type concat_heads__mha_block_cached__compressed_kv_cla__decode_kernel,@function
concat_heads__mha_block_cached__compressed_kv_cla__decode_kernel:
    s_cmp_ge_u32 s2, 256
    s_cbranch_scc1 L_exit
    s_load_dwordx16 s[4:19], s[0:1], 0
    s_load_dwordx8 s[20:27], s[0:1], 64
    s_load_dwordx4 s[28:31], s[0:1], 96
    v_lshrrev_b32 v2, 6, v0
    v_and_b32 v1, 63, v0
    v_readfirstlane_b32 s3, v2
    v_and_b32 v3, 15, v0
    v_bfe_u32 v4, v0, 4, 2
    v_lshlrev_b32 v2, 4, v1
    s_and_b32 s52, s2, 31
    s_mov_b32 s53, s52
    s_cmp_lt_u32 s2, 32
    s_cbranch_scc1 L_roleH
    s_cmp_lt_u32 s2, 64
    s_cbranch_scc1 L_roleC
L_roleA:
    s_sub_u32 s54, s2, 64
    s_mul_hi_u32 s96, s54, 178956971
    s_mul_i32 s56, s96, 24
    s_sub_u32 s97, s54, s56
    s_lshr_b32 s55, s97, 3
    s_add_u32 s3, s3, s97
    s_add_u32 s3, s3, s55
    s_and_b32 s3, s3, 3
    s_add_u32 s56, s96, s3
    s_and_b32 s56, s56, 3
    s_lshr_b32 s55, s97, 3
    s_and_b32 s53, s97, 7
    s_lshl_b32 s96, s96, 2
    s_add_u32 s55, s55, s56
    s_add_u32 s55, s55, 1
    s_and_b32 s55, s55, 3
    s_add_u32 s52, s96, s55
    s_add_u32 s96, s96, s56
    s_lshl_b32 s100, s53, 11
    s_and_b32 s100, s100, 0x1800
    s_lshl_b32 s55, s53, 12
    s_and_b32 s55, s55, 0x4000
    s_or_b32 s100, s100, s55
    s_lshl_b32 s55, s3, 25
    s_or_b32 s100, s100, s55
    s_lshl_b32 s55, s52, 20
    s_or_b32 s100, s100, s55
    s_lshl_b32 s58, s52, 2
    s_add_u32 s58, s58, s3
    s_mul_i32 s58, s58, 5
    s_lshl_b32 s61, s58, 9
    s_and_b32 s61, s61, 0x600
    s_lshl_b32 s55, s58, 15
    s_and_b32 s55, s55, 0xe0000
    s_or_b32 s61, s61, s55
    s_mov_b32 s58, 393216
    s_mov_b32 s59, 1048576
    s_and_b32 s99, s96, 28
    s_add_u32 s99, s99, s3
    s_mul_i32 s99, s99, 37
    s_mov_b32 s63, s53
    s_getpc_b64 s[56:57]
L_pc_1:
    s_sub_u32 s56, s56, L_pc_1-L_roleA
    s_subb_u32 s57, s57, 0
    v_lshlrev_b32 v5, 7, v0
    v_min_u32 v6, L_roleA_end-L_roleA-4, v5
    global_load_dword v56, v6, s[56:57]
    s_mov_b32 s53, 536870912
    v_cmp_eq_u32 vcc, 0, v1
    v_lshlrev_b32 v0, 4, v3
    v_and_b32 v5, 1, v4
    v_lshl_add_u32 v0, v5, 8, v0
    v_lshrrev_b32 v5, 1, v4
    v_lshl_add_u32 v0, v5, 13, v0
    v_add_u32 v18, 32768, v0
    v_add_u32 v48, 65536, v0
    v_add_u32 v49, 98304, v0
    s_waitcnt lgkmcnt(0)
    s_mov_b32 s32, s6
    s_mov_b32 s33, s7
    s_mov_b32 s34, 134217728
    s_mov_b32 s35, 0x20000
    s_mov_b32 s36, s8
    s_mov_b32 s37, s9
    s_mov_b32 s38, 134217728
    s_mov_b32 s39, 0x20000
    s_mov_b32 s44, s30
    s_mov_b32 s45, s31
    s_mov_b32 s46, 536870912
    s_mov_b32 s47, 0x20000
    s_or_b32 s60, s61, s100
    s_or_b32 s61, s61, 0xfff1f9ff
    s_add_u32 s61, s61, 1
    s_and_b32 s61, s61, 0xe0600
    buffer_load_dwordx4 v[96:99], v0, s[32:35], s60 offen nt
    buffer_load_dwordx4 v[100:103], v18, s[32:35], s60 offen nt
    buffer_load_dwordx4 v[104:107], v48, s[32:35], s60 offen nt
    buffer_load_dwordx4 v[108:111], v49, s[32:35], s60 offen nt
    buffer_load_dwordx4 a[32:35], v0, s[36:39], s60 offen nt
    buffer_load_dwordx4 a[36:39], v18, s[36:39], s60 offen nt
    buffer_load_dwordx4 a[40:43], v48, s[36:39], s60 offen nt
    buffer_load_dwordx4 a[44:47], v49, s[36:39], s60 offen nt
    s_or_b32 s60, s61, s100
    s_or_b32 s61, s61, 0xfff1f9ff
    s_add_u32 s61, s61, 1
    s_and_b32 s61, s61, 0xe0600
    buffer_load_dwordx4 v[112:115], v0, s[32:35], s60 offen nt
    buffer_load_dwordx4 v[116:119], v18, s[32:35], s60 offen nt
    buffer_load_dwordx4 v[120:123], v48, s[32:35], s60 offen nt
    buffer_load_dwordx4 v[124:127], v49, s[32:35], s60 offen nt
    buffer_load_dwordx4 a[48:51], v0, s[36:39], s60 offen nt
    buffer_load_dwordx4 a[52:55], v18, s[36:39], s60 offen nt
    buffer_load_dwordx4 a[56:59], v48, s[36:39], s60 offen nt
    buffer_load_dwordx4 a[60:63], v49, s[36:39], s60 offen nt
    s_or_b32 s60, s61, s100
    s_or_b32 s61, s61, 0xfff1f9ff
    s_add_u32 s61, s61, 1
    s_and_b32 s61, s61, 0xe0600
    buffer_load_dwordx4 v[128:131], v0, s[32:35], s60 offen nt
    buffer_load_dwordx4 v[132:135], v18, s[32:35], s60 offen nt
    buffer_load_dwordx4 v[136:139], v48, s[32:35], s60 offen nt
    buffer_load_dwordx4 v[140:143], v49, s[32:35], s60 offen nt
    buffer_load_dwordx4 a[64:67], v0, s[36:39], s60 offen nt
    buffer_load_dwordx4 a[68:71], v18, s[36:39], s60 offen nt
    buffer_load_dwordx4 a[72:75], v48, s[36:39], s60 offen nt
    buffer_load_dwordx4 a[76:79], v49, s[36:39], s60 offen nt
    s_or_b32 s60, s61, s100
    s_or_b32 s61, s61, 0xfff1f9ff
    s_add_u32 s61, s61, 1
    s_and_b32 s61, s61, 0xe0600
    buffer_load_dwordx4 v[144:147], v0, s[32:35], s60 offen nt
    buffer_load_dwordx4 v[148:151], v18, s[32:35], s60 offen nt
    buffer_load_dwordx4 v[152:155], v48, s[32:35], s60 offen nt
    buffer_load_dwordx4 v[156:159], v49, s[32:35], s60 offen nt
    buffer_load_dwordx4 a[80:83], v0, s[36:39], s60 offen nt
    buffer_load_dwordx4 a[84:87], v18, s[36:39], s60 offen nt
    buffer_load_dwordx4 a[88:91], v48, s[36:39], s60 offen nt
    buffer_load_dwordx4 a[92:95], v49, s[36:39], s60 offen nt
    s_or_b32 s60, s61, s100
    s_or_b32 s61, s61, 0xfff1f9ff
    s_add_u32 s61, s61, 1
    s_and_b32 s61, s61, 0xe0600
    buffer_load_dwordx4 v[160:163], v0, s[32:35], s60 offen nt
    buffer_load_dwordx4 v[164:167], v18, s[32:35], s60 offen nt
    buffer_load_dwordx4 v[168:171], v48, s[32:35], s60 offen nt
    buffer_load_dwordx4 v[172:175], v49, s[32:35], s60 offen nt
    buffer_load_dwordx4 a[96:99], v0, s[36:39], s60 offen nt
    buffer_load_dwordx4 a[100:103], v18, s[36:39], s60 offen nt
    buffer_load_dwordx4 a[104:107], v48, s[36:39], s60 offen nt
    buffer_load_dwordx4 a[108:111], v49, s[36:39], s60 offen nt
    s_or_b32 s60, s61, s100
    s_or_b32 s61, s61, 0xfff1f9ff
    s_add_u32 s61, s61, 1
    s_and_b32 s61, s61, 0xe0600
    buffer_load_dwordx4 v[176:179], v0, s[32:35], s60 offen nt
    buffer_load_dwordx4 v[180:183], v18, s[32:35], s60 offen nt
    buffer_load_dwordx4 v[184:187], v48, s[32:35], s60 offen nt
    buffer_load_dwordx4 v[188:191], v49, s[32:35], s60 offen nt
    buffer_load_dwordx4 a[112:115], v0, s[36:39], s60 offen nt
    buffer_load_dwordx4 a[116:119], v18, s[36:39], s60 offen nt
    buffer_load_dwordx4 a[120:123], v48, s[36:39], s60 offen nt
    buffer_load_dwordx4 a[124:127], v49, s[36:39], s60 offen nt
    s_lshl_b32 s54, s52, 2
    s_lshl_b32 s55, s96, 2
    v_mov_b32 v58, s54
    v_mov_b32 v57, s55
    v_cndmask_b32 v58, v58, v57, vcc
    s_sub_u32 s23, s2, 64
    s_and_b32 s26, s23, 7
    s_lshr_b32 s23, s23, 3
    s_mul_i32 s27, s23, 43
    s_lshr_b32 s27, s27, 8
    s_lshl_b32 s26, s26, 2
    s_add_u32 s26, s26, s27
    s_mul_i32 s27, s27, 6
    s_sub_u32 s23, s23, s27
    s_lshl_b32 s27, s26, 2
    v_writelane_b32 v58, s27, 1
    s_load_dword s17, s[28:29], s27
    s_load_dword s18, s[28:29], s54
    s_load_dword s19, s[28:29], s55
    s_or_b32 s60, s61, s100
    s_or_b32 s61, s61, 0xfff1f9ff
    s_add_u32 s61, s61, 1
    s_and_b32 s61, s61, 0xe0600
    buffer_load_dwordx4 v[192:195], v0, s[32:35], s60 offen nt
    buffer_load_dwordx4 v[196:199], v18, s[32:35], s60 offen nt
    buffer_load_dwordx4 v[200:203], v48, s[32:35], s60 offen nt
    buffer_load_dwordx4 v[204:207], v49, s[32:35], s60 offen nt
    buffer_load_dwordx4 a[128:131], v0, s[36:39], s60 offen nt
    buffer_load_dwordx4 a[132:135], v18, s[36:39], s60 offen nt
    buffer_load_dwordx4 a[136:139], v48, s[36:39], s60 offen nt
    buffer_load_dwordx4 a[140:143], v49, s[36:39], s60 offen nt
    s_waitcnt vmcnt(48)
    s_or_b32 s60, s61, s100
    s_or_b32 s61, s61, 0xfff1f9ff
    s_add_u32 s61, s61, 1
    s_and_b32 s61, s61, 0xe0600
    buffer_load_dwordx4 v[208:211], v0, s[32:35], s60 offen nt
    buffer_load_dwordx4 v[212:215], v18, s[32:35], s60 offen nt
    buffer_load_dwordx4 v[216:219], v48, s[32:35], s60 offen nt
    buffer_load_dwordx4 v[220:223], v49, s[32:35], s60 offen nt
    buffer_load_dwordx4 a[144:147], v0, s[36:39], s60 offen nt
    buffer_load_dwordx4 a[148:151], v18, s[36:39], s60 offen nt
    buffer_load_dwordx4 a[152:155], v48, s[36:39], s60 offen nt
    buffer_load_dwordx4 a[156:159], v49, s[36:39], s60 offen nt
    s_waitcnt vmcnt(48)
    s_or_b32 s60, s61, s100
    s_or_b32 s61, s61, 0xfff1f9ff
    s_add_u32 s61, s61, 1
    s_and_b32 s61, s61, 0xe0600
    buffer_load_dwordx4 v[224:227], v0, s[32:35], s60 offen nt
    buffer_load_dwordx4 v[228:231], v18, s[32:35], s60 offen nt
    buffer_load_dwordx4 v[232:235], v48, s[32:35], s60 offen nt
    buffer_load_dwordx4 v[236:239], v49, s[32:35], s60 offen nt
    buffer_load_dwordx4 a[160:163], v0, s[36:39], s60 offen nt
    buffer_load_dwordx4 a[164:167], v18, s[36:39], s60 offen nt
    buffer_load_dwordx4 a[168:171], v48, s[36:39], s60 offen nt
    buffer_load_dwordx4 a[172:175], v49, s[36:39], s60 offen nt
    v_and_b32 v5, 1, v3
    v_cmp_eq_u32 vcc, 1, v5
    v_mov_b32 v5, 0xffff
    v_mov_b32 v6, 0xffff0000
    v_cndmask_b32 v5, v5, v6, vcc
    v_lshrrev_b32 v6, 1, v3
    v_cmp_eq_u32 vcc, 0, v6
    s_nop 1
    v_cndmask_b32 v8, 0, v5, vcc
    v_cmp_eq_u32 vcc, 1, v6
    s_nop 1
    v_cndmask_b32 v9, 0, v5, vcc
    v_cmp_eq_u32 vcc, 2, v6
    s_nop 1
    v_cndmask_b32 v10, 0, v5, vcc
    v_cmp_eq_u32 vcc, 3, v6
    s_nop 1
    v_cndmask_b32 v11, 0, v5, vcc
    s_bitcmp1_b32 s23, 0
    s_cselect_b32 s40, s24, s12
    s_cselect_b32 s41, s25, s13
    s_cselect_b32 s25, 524288, 0
    s_add_u32 s25, s25, 4194304
    s_mov_b32 s42, 4718592
    s_mov_b32 s43, 0x20000
    s_lshr_b32 s54, s23, 1
    s_mul_i32 s54, s54, 3
    s_add_u32 s54, s54, s3
    s_and_b32 s23, s23, 1
    s_mul_i32 s24, s26, 147456
    s_lshl_b32 s55, s54, 7
    s_add_u32 s24, s24, s55
    s_lshl_b32 s54, s54, 13
    s_lshl_b32 s55, s26, 7
    s_add_u32 s54, s54, s55
    s_add_u32 s25, s25, s54
    s_lshl_b32 s27, s26, 10
    s_add_u32 s27, s27, 5439488
    s_lshl_b32 s22, s26, 2
    s_add_u32 s22, s22, s3
    s_lshl_b32 s22, s22, 13
    s_add_u32 s22, s22, 8388608
    s_lshr_b32 s55, s26, 2
    s_add_u32 s55, s55, s3
    s_and_b32 s55, s55, 3
    s_and_b32 s54, s26, 3
    s_cmp_eq_u32 s54, s55
    s_cselect_b32 s54, 7, 1
    s_cselect_b32 s55, 5, 1
    s_cselect_b32 s26, 2, 0
    s_or_b32 s23, s23, s26
    v_and_b32 v30, s54, v3
    v_min_u32 v30, s55, v30
    v_lshl_add_u32 v30, v30, 2, v4
    v_lshlrev_b32 v30, 4, v30
    v_add_u32 v30, 6144, v30
    v_lshrrev_b32 v19, 3, v3
    v_lshl_add_u32 v19, v19, 2, v4
    v_mul_u32_u24 v19, 9216, v19
    v_and_b32 v5, 7, v3
    v_lshl_add_u32 v19, v5, 4, v19
    v_mov_b32 v12, 0
    v_mov_b32 v13, 0
    v_mov_b32 v14, 0
    v_mov_b32 v15, 0
    v_mov_b32 v16, 0xff800000
    v_mov_b32 v17, 0
    v_lshrrev_b32 v5, 1, v4
    v_lshlrev_b32 v59, 5, v3
    v_lshl_add_u32 v59, v5, 4, v59
    v_and_b32 v5, 1, v4
    v_lshl_add_u32 v59, v5, 11, v59
    s_lshl_b32 s54, s52, 2
    s_add_u32 s54, s54, s3
    s_lshl_b32 s54, s54, 13
    s_lshl_b32 s55, s96, 2
    s_add_u32 s55, s55, s3
    s_lshl_b32 s55, s55, 13
    v_cmp_eq_u32 vcc, 1, v5
    v_mov_b32 v6, s54
    v_mov_b32 v7, s55
    v_cndmask_b32 v6, v6, v7, vcc
    v_mov_b32 v20, s63
    v_mov_b32 v7, s97
    v_cndmask_b32 v7, v20, v7, vcc
    v_lshl_add_u32 v20, v7, 4, v3
    v_lshl_add_u32 v20, v20, 4, v6
    v_lshl_add_u32 v21, v7, 4, v6
    v_add_u32 v21, 6144, v21
    v_mov_b32 v7, s53
    v_cmp_eq_u32 vcc, 0, v3
    s_nop 1
    v_cndmask_b32 v21, v7, v21, vcc
    v_cmp_gt_u32 vcc, 32, v1
    s_nop 1
    v_cndmask_b32 v3, v21, v20, vcc
    s_mov_b32 s8, 919040
    s_mov_b32 s9, s100
    s_mov_b32 s10, 0xff000
    s_lshl_b32 s11, s3, 25
    s_lshl_b32 s54, s96, 20
    s_add_u32 s11, s11, s54
    s_and_b32 s57, s96, 28
    s_add_u32 s57, s57, s3
    s_mul_i32 s57, s57, 256
    s_add_u32 s57, s57, 16777216
    s_lshl_b32 s54, s3, 9
    s_add_u32 s54, s54, 5242880
    s_lshl_b32 s56, s52, 12
    s_add_u32 s56, s56, s54
    s_lshl_b32 s12, s96, 12
    s_add_u32 s12, s12, s54
    s_mov_b32 s13, 0
    s_add_u32 s15, s59, 65536
    s_sub_u32 s14, s15, 131072
    s_mov_b32 s96, 1035273459
    s_mov_b32 s97, 1069066811
    s_mov_b32 s98, 0xffff0000
    s_mov_b32 s62, 2
    s_mov_b32 s101, 100000
    s_waitcnt lgkmcnt(0)
    s_min_u32 s18, s18, s17
    s_min_u32 s18, s18, s19
    s_cmp_lt_u32 s18, 2
    s_cbranch_scc1 L_aflag
L_aflag_ok:
    s_mov_b32 s18, 20
    s_mov_b64 s[6:7], s[8:9]
    s_mov_b32 s63, 0
    s_cmp_eq_u32 s3, 3
    s_cselect_b32 s19, -1, 256
    buffer_load_dwordx4 v[60:63], v59, s[44:47], s56 offen sc1
    s_waitcnt vmcnt(49)
    s_or_b32 s60, s61, s100
    s_or_b32 s61, s61, 0xfff1f9ff
    s_add_u32 s61, s61, 1
    s_and_b32 s61, s61, 0xe0600
    buffer_load_dwordx4 v[240:243], v0, s[32:35], s60 offen nt
    buffer_load_dwordx4 v[244:247], v18, s[32:35], s60 offen nt
    buffer_load_dwordx4 v[248:251], v48, s[32:35], s60 offen nt
    buffer_load_dwordx4 v[252:255], v49, s[32:35], s60 offen nt
    buffer_load_dwordx4 a[176:179], v0, s[36:39], s60 offen nt
    buffer_load_dwordx4 a[180:183], v18, s[36:39], s60 offen nt
    buffer_load_dwordx4 a[184:187], v48, s[36:39], s60 offen nt
    buffer_load_dwordx4 a[188:191], v49, s[36:39], s60 offen nt
    s_waitcnt vmcnt(49)
    s_or_b32 s60, s61, s100
    s_or_b32 s61, s61, 0xfff1f9ff
    s_add_u32 s61, s61, 1
    s_and_b32 s61, s61, 0xe0600
    buffer_load_dwordx4 v[64:67], v0, s[32:35], s60 offen nt
    buffer_load_dwordx4 v[68:71], v18, s[32:35], s60 offen nt
    buffer_load_dwordx4 v[72:75], v48, s[32:35], s60 offen nt
    buffer_load_dwordx4 v[76:79], v49, s[32:35], s60 offen nt
    buffer_load_dwordx4 a[0:3], v0, s[36:39], s60 offen nt
    buffer_load_dwordx4 a[4:7], v18, s[36:39], s60 offen nt
    buffer_load_dwordx4 a[8:11], v48, s[36:39], s60 offen nt
    buffer_load_dwordx4 a[12:15], v49, s[36:39], s60 offen nt
    s_waitcnt vmcnt(49)
    s_or_b32 s60, s61, s100
    s_or_b32 s61, s61, 0xfff1f9ff
    s_add_u32 s61, s61, 1
    s_and_b32 s61, s61, 0xe0600
    buffer_load_dwordx4 v[80:83], v0, s[32:35], s60 offen nt
    buffer_load_dwordx4 v[84:87], v18, s[32:35], s60 offen nt
    buffer_load_dwordx4 v[88:91], v48, s[32:35], s60 offen nt
    buffer_load_dwordx4 v[92:95], v49, s[32:35], s60 offen nt
    buffer_load_dwordx4 a[16:19], v0, s[36:39], s60 offen nt
    buffer_load_dwordx4 a[20:23], v18, s[36:39], s60 offen nt
    buffer_load_dwordx4 a[24:27], v48, s[36:39], s60 offen nt
    buffer_load_dwordx4 a[28:31], v49, s[36:39], s60 offen nt
    s_waitcnt vmcnt(24)
L_aq1:
    v_max3_u32 v20, v60, v61, v62
    v_max_u32 v20, v20, v63
    v_cmp_eq_u32 vcc, -1, v20
    s_cbranch_vccz L_aq1_ok
    buffer_load_dwordx4 v[60:63], v59, s[44:47], s56 offen sc1
    s_waitcnt vmcnt(0)
    s_sub_u32 s101, s101, 1
    s_cbranch_scc0 L_aq1
    s_mov_b32 s101, 0
L_aq1_ok:
    v_mov_b32 v20, v60
    v_mov_b32 v21, v61
    v_mov_b32 v22, v62
    v_mov_b32 v23, v63
    v_permlane16_swap_b32 v60, v20
    v_permlane16_swap_b32 v61, v21
    v_permlane16_swap_b32 v62, v22
    v_permlane16_swap_b32 v63, v23
    v_add_f32 v60, v60, v20
    v_add_f32 v61, v61, v21
    v_add_f32 v62, v62, v22
    v_add_f32 v63, v63, v23
    v_cvt_pk_bf16_f32 v4, v60, v61
    v_cvt_pk_bf16_f32 v5, v62, v63
    v_mov_b32 v6, v4
    v_mov_b32 v7, v5
    s_nop 0
    v_permlane32_swap_b32 v4, v6
    v_permlane32_swap_b32 v5, v7
    s_mov_b32 s56, 1
L_aloop:
    s_waitcnt vmcnt(12)
    v_dot2_f32_bf16 v20, v64, v4, 0
    v_dot2_f32_bf16 v21, v68, v4, 0
    v_dot2_f32_bf16 v22, v72, v4, 0
    v_dot2_f32_bf16 v23, v76, v4, 0
    v_dot2_f32_bf16 v20, v65, v5, v20
    v_dot2_f32_bf16 v21, v69, v5, v21
    v_dot2_f32_bf16 v22, v73, v5, v22
    v_dot2_f32_bf16 v23, v77, v5, v23
    v_dot2_f32_bf16 v20, v66, v6, v20
    v_dot2_f32_bf16 v21, v70, v6, v21
    v_dot2_f32_bf16 v22, v74, v6, v22
    v_dot2_f32_bf16 v23, v78, v6, v23
    v_dot2_f32_bf16 v20, v67, v7, v20
    v_dot2_f32_bf16 v21, v71, v7, v21
    v_dot2_f32_bf16 v22, v75, v7, v22
    v_dot2_f32_bf16 v23, v79, v7, v23
    s_cmp_lg_u32 s18, 0
    s_cbranch_scc1 L_have_2
    s_waitcnt lgkmcnt(0)
    s_mov_b32 s17, s16
    s_mov_b32 s18, 1
    s_min_u32 s54, s16, 68
    s_cselect_b32 s18, 2, s18
    s_mul_i32 s54, s54, 1
    s_add_u32 s17, s17, s54
    s_min_u32 s54, s16, 28
    s_cselect_b32 s18, 4, s18
    s_mul_i32 s54, s54, 2
    s_add_u32 s17, s17, s54
    s_cmp_ge_u32 s17, s19
    s_cbranch_scc1 L_adrain0
    s_add_u32 s54, s17, s99
    s_lshl_b32 s61, s54, 9
    s_and_b32 s61, s61, 0x1e00
    s_lshl_b32 s55, s54, 10
    s_and_b32 s55, s55, 0x4000
    s_or_b32 s61, s61, s55
    s_lshl_b32 s55, s54, 12
    s_and_b32 s55, s55, 0xe0000
    s_or_b32 s61, s61, s55
    s_cmp_lt_u32 s17, 256
    s_cselect_b32 s7, s11, 0x8000000
    s_cselect_b32 s18, s18, 9
    s_cselect_b32 s63, 0, 1
    s_mov_b32 s6, 0xe5e00
L_have_2:
    s_or_b32 s60, s61, s7
    buffer_load_dwordx4 v[64:67], v0, s[32:35], s60 offen nt
    buffer_load_dwordx4 v[68:71], v18, s[32:35], s60 offen nt
    buffer_load_dwordx4 v[72:75], v48, s[32:35], s60 offen nt
    buffer_load_dwordx4 v[76:79], v49, s[32:35], s60 offen nt
    s_orn2_b32 s61, s61, s6
    s_add_u32 s61, s61, 1
    s_and_b32 s61, s61, s6
    s_add_u32 s58, s58, 32768
    s_sub_u32 s18, s18, 1
    s_sub_u32 s62, s62, s63
    v_add_f32_dpp v24, v20, v20 row_ror:8 row_mask:0xf bank_mask:0x3
    v_add_f32_dpp v25, v22, v22 row_ror:8 row_mask:0xf bank_mask:0x3
    v_add_f32_dpp v24, v21, v21 row_ror:8 row_mask:0xf bank_mask:0xc
    v_add_f32_dpp v25, v23, v23 row_ror:8 row_mask:0xf bank_mask:0xc
    s_nop 0
    v_add_f32_dpp v26, v24, v24 row_shl:4 row_mask:0xf bank_mask:0x5
    v_add_f32_dpp v26, v25, v25 row_shr:4 row_mask:0xf bank_mask:0xa
    s_nop 1
    v_add_f32_dpp v26, v26, v26 quad_perm:[1,0,3,2] row_mask:0xf bank_mask:0xf
    s_nop 1
    v_add_f32_dpp v26, v26, v26 quad_perm:[2,3,0,1] row_mask:0xf bank_mask:0xf
    v_cvt_pk_bf16_f32 v26, v26, v26
    v_and_b32 v26, s98, v26
    v_mul_f32 v26, s96, v26
    v_cvt_pk_bf16_f32 v26, v26, v26
    v_and_b32 v26, s98, v26
    s_nop 1
    v_max_f32_dpp v27, v26, v26 row_ror:4 row_mask:0xf bank_mask:0xf
    s_nop 1
    v_max_f32_dpp v27, v27, v27 row_ror:8 row_mask:0xf bank_mask:0xf
    v_mov_b32 v28, v27
    s_nop 1
    v_permlane16_swap_b32 v27, v28
    v_max_f32 v27, v27, v28
    v_mov_b32 v28, v27
    s_nop 1
    v_permlane32_swap_b32 v27, v28
    v_max3_f32 v27, v27, v28, v16
    v_sub_f32 v28, v16, v27
    v_sub_f32 v29, v26, v27
    v_mul_f32 v28, s97, v28
    v_mul_f32 v29, s97, v29
    v_exp_f32 v28, v28
    v_exp_f32 v29, v29
    v_mov_b32 v16, v27
    v_fma_f32 v17, v17, v28, v29
    v_cvt_pk_bf16_f32 v29, v29, v29
    v_mul_f32 v12, v12, v28
    v_mul_f32 v13, v13, v28
    v_mul_f32 v14, v14, v28
    v_mul_f32 v15, v15, v28
    s_waitcnt vmcnt(12)
    v_and_b32_dpp v32, v29, v8 row_newbcast:0 row_mask:0xf bank_mask:0xf
    v_and_b32_dpp v33, v29, v9 row_newbcast:0 row_mask:0xf bank_mask:0xf
    v_and_b32_dpp v34, v29, v10 row_newbcast:0 row_mask:0xf bank_mask:0xf
    v_and_b32_dpp v35, v29, v11 row_newbcast:0 row_mask:0xf bank_mask:0xf
    v_and_b32_dpp v36, v29, v8 row_newbcast:8 row_mask:0xf bank_mask:0xf
    v_and_b32_dpp v37, v29, v9 row_newbcast:8 row_mask:0xf bank_mask:0xf
    v_and_b32_dpp v38, v29, v10 row_newbcast:8 row_mask:0xf bank_mask:0xf
    v_and_b32_dpp v39, v29, v11 row_newbcast:8 row_mask:0xf bank_mask:0xf
    v_and_b32_dpp v40, v29, v8 row_newbcast:4 row_mask:0xf bank_mask:0xf
    v_and_b32_dpp v41, v29, v9 row_newbcast:4 row_mask:0xf bank_mask:0xf
    v_and_b32_dpp v42, v29, v10 row_newbcast:4 row_mask:0xf bank_mask:0xf
    v_and_b32_dpp v43, v29, v11 row_newbcast:4 row_mask:0xf bank_mask:0xf
    v_and_b32_dpp v44, v29, v8 row_newbcast:12 row_mask:0xf bank_mask:0xf
    v_and_b32_dpp v45, v29, v9 row_newbcast:12 row_mask:0xf bank_mask:0xf
    v_and_b32_dpp v46, v29, v10 row_newbcast:12 row_mask:0xf bank_mask:0xf
    v_and_b32_dpp v47, v29, v11 row_newbcast:12 row_mask:0xf bank_mask:0xf
    v_mfma_f32_16x16x32_bf16 v[12:15], v[32:35], a[0:3], v[12:15]
    v_mfma_f32_16x16x32_bf16 v[12:15], v[36:39], a[4:7], v[12:15]
    v_mfma_f32_16x16x32_bf16 v[12:15], v[40:43], a[8:11], v[12:15]
    v_mfma_f32_16x16x32_bf16 v[12:15], v[44:47], a[12:15], v[12:15]
    buffer_load_dwordx4 a[0:3], v0, s[36:39], s60 offen nt
    buffer_load_dwordx4 a[4:7], v18, s[36:39], s60 offen nt
    buffer_load_dwordx4 a[8:11], v48, s[36:39], s60 offen nt
    buffer_load_dwordx4 a[12:15], v49, s[36:39], s60 offen nt
    s_cmp_eq_u32 s18, 0
    s_cbranch_scc0 L_notk_3
    s_mov_b32 s16, 1
    s_atomic_add s16, s[30:31], s57 glc
L_notk_3:
    s_cmp_eq_u32 s62, 0
    s_cbranch_scc1 L_adone
    s_cmp_lg_u32 s56, 0
    s_cbranch_scc1 L_aext0
L_aback0:
    s_waitcnt vmcnt(12)
    v_dot2_f32_bf16 v20, v80, v4, 0
    v_dot2_f32_bf16 v21, v84, v4, 0
    v_dot2_f32_bf16 v22, v88, v4, 0
    v_dot2_f32_bf16 v23, v92, v4, 0
    v_dot2_f32_bf16 v20, v81, v5, v20
    v_dot2_f32_bf16 v21, v85, v5, v21
    v_dot2_f32_bf16 v22, v89, v5, v22
    v_dot2_f32_bf16 v23, v93, v5, v23
    v_dot2_f32_bf16 v20, v82, v6, v20
    v_dot2_f32_bf16 v21, v86, v6, v21
    v_dot2_f32_bf16 v22, v90, v6, v22
    v_dot2_f32_bf16 v23, v94, v6, v23
    v_dot2_f32_bf16 v20, v83, v7, v20
    v_dot2_f32_bf16 v21, v87, v7, v21
    v_dot2_f32_bf16 v22, v91, v7, v22
    v_dot2_f32_bf16 v23, v95, v7, v23
    s_cmp_lg_u32 s18, 0
    s_cbranch_scc1 L_have_4
    s_waitcnt lgkmcnt(0)
    s_mov_b32 s17, s16
    s_mov_b32 s18, 1
    s_min_u32 s54, s16, 68
    s_cselect_b32 s18, 2, s18
    s_mul_i32 s54, s54, 1
    s_add_u32 s17, s17, s54
    s_min_u32 s54, s16, 28
    s_cselect_b32 s18, 4, s18
    s_mul_i32 s54, s54, 2
    s_add_u32 s17, s17, s54
    s_cmp_ge_u32 s17, s19
    s_cbranch_scc1 L_adrain1
    s_add_u32 s54, s17, s99
    s_lshl_b32 s61, s54, 9
    s_and_b32 s61, s61, 0x1e00
    s_lshl_b32 s55, s54, 10
    s_and_b32 s55, s55, 0x4000
    s_or_b32 s61, s61, s55
    s_lshl_b32 s55, s54, 12
    s_and_b32 s55, s55, 0xe0000
    s_or_b32 s61, s61, s55
    s_cmp_lt_u32 s17, 256
    s_cselect_b32 s7, s11, 0x8000000
    s_cselect_b32 s18, s18, 9
    s_cselect_b32 s63, 0, 1
    s_mov_b32 s6, 0xe5e00
L_have_4:
    s_or_b32 s60, s61, s7
    buffer_load_dwordx4 v[80:83], v0, s[32:35], s60 offen nt
    buffer_load_dwordx4 v[84:87], v18, s[32:35], s60 offen nt
    buffer_load_dwordx4 v[88:91], v48, s[32:35], s60 offen nt
    buffer_load_dwordx4 v[92:95], v49, s[32:35], s60 offen nt
    s_orn2_b32 s61, s61, s6
    s_add_u32 s61, s61, 1
    s_and_b32 s61, s61, s6
    s_add_u32 s58, s58, 32768
    s_sub_u32 s18, s18, 1
    s_sub_u32 s62, s62, s63
    v_add_f32_dpp v24, v20, v20 row_ror:8 row_mask:0xf bank_mask:0x3
    v_add_f32_dpp v25, v22, v22 row_ror:8 row_mask:0xf bank_mask:0x3
    v_add_f32_dpp v24, v21, v21 row_ror:8 row_mask:0xf bank_mask:0xc
    v_add_f32_dpp v25, v23, v23 row_ror:8 row_mask:0xf bank_mask:0xc
    s_nop 0
    v_add_f32_dpp v26, v24, v24 row_shl:4 row_mask:0xf bank_mask:0x5
    v_add_f32_dpp v26, v25, v25 row_shr:4 row_mask:0xf bank_mask:0xa
    s_nop 1
    v_add_f32_dpp v26, v26, v26 quad_perm:[1,0,3,2] row_mask:0xf bank_mask:0xf
    s_nop 1
    v_add_f32_dpp v26, v26, v26 quad_perm:[2,3,0,1] row_mask:0xf bank_mask:0xf
    v_cvt_pk_bf16_f32 v26, v26, v26
    v_and_b32 v26, s98, v26
    v_mul_f32 v26, s96, v26
    v_cvt_pk_bf16_f32 v26, v26, v26
    v_and_b32 v26, s98, v26
    s_nop 1
    v_max_f32_dpp v27, v26, v26 row_ror:4 row_mask:0xf bank_mask:0xf
    s_nop 1
    v_max_f32_dpp v27, v27, v27 row_ror:8 row_mask:0xf bank_mask:0xf
    v_mov_b32 v28, v27
    s_nop 1
    v_permlane16_swap_b32 v27, v28
    v_max_f32 v27, v27, v28
    v_mov_b32 v28, v27
    s_nop 1
    v_permlane32_swap_b32 v27, v28
    v_max3_f32 v27, v27, v28, v16
    v_sub_f32 v28, v16, v27
    v_sub_f32 v29, v26, v27
    v_mul_f32 v28, s97, v28
    v_mul_f32 v29, s97, v29
    v_exp_f32 v28, v28
    v_exp_f32 v29, v29
    v_mov_b32 v16, v27
    v_fma_f32 v17, v17, v28, v29
    v_cvt_pk_bf16_f32 v29, v29, v29
    v_mul_f32 v12, v12, v28
    v_mul_f32 v13, v13, v28
    v_mul_f32 v14, v14, v28
    v_mul_f32 v15, v15, v28
    s_waitcnt vmcnt(12)
    v_and_b32_dpp v32, v29, v8 row_newbcast:0 row_mask:0xf bank_mask:0xf
    v_and_b32_dpp v33, v29, v9 row_newbcast:0 row_mask:0xf bank_mask:0xf
    v_and_b32_dpp v34, v29, v10 row_newbcast:0 row_mask:0xf bank_mask:0xf
    v_and_b32_dpp v35, v29, v11 row_newbcast:0 row_mask:0xf bank_mask:0xf
    v_and_b32_dpp v36, v29, v8 row_newbcast:8 row_mask:0xf bank_mask:0xf
    v_and_b32_dpp v37, v29, v9 row_newbcast:8 row_mask:0xf bank_mask:0xf
    v_and_b32_dpp v38, v29, v10 row_newbcast:8 row_mask:0xf bank_mask:0xf
    v_and_b32_dpp v39, v29, v11 row_newbcast:8 row_mask:0xf bank_mask:0xf
    v_and_b32_dpp v40, v29, v8 row_newbcast:4 row_mask:0xf bank_mask:0xf
    v_and_b32_dpp v41, v29, v9 row_newbcast:4 row_mask:0xf bank_mask:0xf
    v_and_b32_dpp v42, v29, v10 row_newbcast:4 row_mask:0xf bank_mask:0xf
    v_and_b32_dpp v43, v29, v11 row_newbcast:4 row_mask:0xf bank_mask:0xf
    v_and_b32_dpp v44, v29, v8 row_newbcast:12 row_mask:0xf bank_mask:0xf
    v_and_b32_dpp v45, v29, v9 row_newbcast:12 row_mask:0xf bank_mask:0xf
    v_and_b32_dpp v46, v29, v10 row_newbcast:12 row_mask:0xf bank_mask:0xf
    v_and_b32_dpp v47, v29, v11 row_newbcast:12 row_mask:0xf bank_mask:0xf
    v_mfma_f32_16x16x32_bf16 v[12:15], v[32:35], a[16:19], v[12:15]
    v_mfma_f32_16x16x32_bf16 v[12:15], v[36:39], a[20:23], v[12:15]
    v_mfma_f32_16x16x32_bf16 v[12:15], v[40:43], a[24:27], v[12:15]
    v_mfma_f32_16x16x32_bf16 v[12:15], v[44:47], a[28:31], v[12:15]
    buffer_load_dwordx4 a[16:19], v0, s[36:39], s60 offen nt
    buffer_load_dwordx4 a[20:23], v18, s[36:39], s60 offen nt
    buffer_load_dwordx4 a[24:27], v48, s[36:39], s60 offen nt
    buffer_load_dwordx4 a[28:31], v49, s[36:39], s60 offen nt
    s_cmp_eq_u32 s18, 0
    s_cbranch_scc0 L_notk_5
    s_mov_b32 s16, 1
    s_atomic_add s16, s[30:31], s57 glc
L_notk_5:
    s_cmp_eq_u32 s62, 0
    s_cbranch_scc1 L_adone
    s_cmp_lg_u32 s56, 0
    s_cbranch_scc1 L_aext1
L_aback1:
    s_cmp_lg_u32 s58, s14
    s_cbranch_scc1 L_aloop
    s_cmp_eq_u32 s14, s15
    s_cbranch_scc1 L_aswitch
    buffer_load_dwordx4 v[60:63], v59, s[44:47], s12 offen sc1
    s_mov_b32 s14, s15
    s_branch L_aloop
L_aswitch:
    s_nop 11
    v_add_f32_dpp v17, v17, v17 row_ror:4 row_mask:0xf bank_mask:0xf
    s_nop 1
    v_add_f32_dpp v17, v17, v17 row_ror:8 row_mask:0xf bank_mask:0xf
    v_mov_b32 v28, v17
    s_nop 1
    v_permlane16_swap_b32 v17, v28
    v_add_f32 v17, v17, v28
    v_mov_b32 v28, v17
    s_nop 1
    v_permlane32_swap_b32 v17, v28
    v_add_f32 v51, v17, v28
    v_mov_b32 v50, v16
    v_cvt_pk_bf16_f32 v52, v12, v13
    v_cvt_pk_bf16_f32 v53, v14, v15
    v_mov_b32 v12, 0
    v_mov_b32 v13, 0
    v_mov_b32 v14, 0
    v_mov_b32 v15, 0
    v_mov_b32 v16, 0xff800000
    v_mov_b32 v17, 0
    s_mov_b32 s13, 1
    s_cmp_eq_u32 s62, 0
    s_cbranch_scc1 L_adone
L_aq2:
    v_max3_u32 v20, v60, v61, v62
    v_max_u32 v20, v20, v63
    v_cmp_eq_u32 vcc, -1, v20
    s_cbranch_vccz L_aq2_ok
    buffer_load_dwordx4 v[60:63], v59, s[44:47], s12 offen sc1
    s_waitcnt vmcnt(0)
    s_sub_u32 s101, s101, 1
    s_cbranch_scc0 L_aq2
    s_mov_b32 s101, 0
L_aq2_ok:
    v_mov_b32 v20, v60
    v_mov_b32 v21, v61
    v_mov_b32 v22, v62
    v_mov_b32 v23, v63
    v_permlane16_swap_b32 v60, v20
    v_permlane16_swap_b32 v61, v21
    v_permlane16_swap_b32 v62, v22
    v_permlane16_swap_b32 v63, v23
    v_add_f32 v60, v60, v20
    v_add_f32 v61, v61, v21
    v_add_f32 v62, v62, v22
    v_add_f32 v63, v63, v23
    v_cvt_pk_bf16_f32 v4, v60, v61
    v_cvt_pk_bf16_f32 v5, v62, v63
    v_mov_b32 v6, v4
    v_mov_b32 v7, v5
    s_nop 0
    v_permlane32_swap_b32 v4, v6
    v_permlane32_swap_b32 v5, v7
    s_cmp_lg_u32 s62, 3
    s_cbranch_scc1 L_aloop
    s_branch L_alast0
L_adrain1:
    buffer_load_dwordx4 v[128:131], v19, s[40:43], s24 offen offset:0 nt
    buffer_load_dwordx4 v[132:135], v19, s[40:43], s24 offen offset:1152 nt
    buffer_load_dwordx4 v[136:139], v19, s[40:43], s24 offen offset:2304 nt
    buffer_load_dwordx4 v[140:143], v19, s[40:43], s24 offen offset:3456 nt
    s_add_u32 s24, s24, 4608
    buffer_load_dwordx4 v[144:147], v19, s[40:43], s24 offen offset:0 nt
    buffer_load_dwordx4 v[148:151], v19, s[40:43], s24 offen offset:1152 nt
    buffer_load_dwordx4 v[152:155], v19, s[40:43], s24 offen offset:2304 nt
    buffer_load_dwordx4 v[156:159], v19, s[40:43], s24 offen offset:3456 nt
    s_add_u32 s24, s24, 69120
    v_add_f32_dpp v24, v20, v20 row_ror:8 row_mask:0xf bank_mask:0x3
    v_add_f32_dpp v25, v22, v22 row_ror:8 row_mask:0xf bank_mask:0x3
    v_add_f32_dpp v24, v21, v21 row_ror:8 row_mask:0xf bank_mask:0xc
    v_add_f32_dpp v25, v23, v23 row_ror:8 row_mask:0xf bank_mask:0xc
    s_nop 0
    v_add_f32_dpp v26, v24, v24 row_shl:4 row_mask:0xf bank_mask:0x5
    v_add_f32_dpp v26, v25, v25 row_shr:4 row_mask:0xf bank_mask:0xa
    s_nop 1
    v_add_f32_dpp v26, v26, v26 quad_perm:[1,0,3,2] row_mask:0xf bank_mask:0xf
    s_nop 1
    v_add_f32_dpp v26, v26, v26 quad_perm:[2,3,0,1] row_mask:0xf bank_mask:0xf
    v_cvt_pk_bf16_f32 v26, v26, v26
    v_and_b32 v26, s98, v26
    v_mul_f32 v26, s96, v26
    v_cvt_pk_bf16_f32 v26, v26, v26
    v_and_b32 v26, s98, v26
    s_nop 1
    v_max_f32_dpp v27, v26, v26 row_ror:4 row_mask:0xf bank_mask:0xf
    s_nop 1
    v_max_f32_dpp v27, v27, v27 row_ror:8 row_mask:0xf bank_mask:0xf
    v_mov_b32 v28, v27
    s_nop 1
    v_permlane16_swap_b32 v27, v28
    v_max_f32 v27, v27, v28
    v_mov_b32 v28, v27
    s_nop 1
    v_permlane32_swap_b32 v27, v28
    v_max3_f32 v27, v27, v28, v16
    v_sub_f32 v28, v16, v27
    v_sub_f32 v29, v26, v27
    v_mul_f32 v28, s97, v28
    v_mul_f32 v29, s97, v29
    v_exp_f32 v28, v28
    v_exp_f32 v29, v29
    v_mov_b32 v16, v27
    v_fma_f32 v17, v17, v28, v29
    v_cvt_pk_bf16_f32 v29, v29, v29
    v_mul_f32 v12, v12, v28
    v_mul_f32 v13, v13, v28
    v_mul_f32 v14, v14, v28
    v_mul_f32 v15, v15, v28
    s_waitcnt vmcnt(16)
    v_and_b32_dpp v32, v29, v8 row_newbcast:0 row_mask:0xf bank_mask:0xf
    v_and_b32_dpp v33, v29, v9 row_newbcast:0 row_mask:0xf bank_mask:0xf
    v_and_b32_dpp v34, v29, v10 row_newbcast:0 row_mask:0xf bank_mask:0xf
    v_and_b32_dpp v35, v29, v11 row_newbcast:0 row_mask:0xf bank_mask:0xf
    v_and_b32_dpp v36, v29, v8 row_newbcast:8 row_mask:0xf bank_mask:0xf
    v_and_b32_dpp v37, v29, v9 row_newbcast:8 row_mask:0xf bank_mask:0xf
    v_and_b32_dpp v38, v29, v10 row_newbcast:8 row_mask:0xf bank_mask:0xf
    v_and_b32_dpp v39, v29, v11 row_newbcast:8 row_mask:0xf bank_mask:0xf
    v_and_b32_dpp v40, v29, v8 row_newbcast:4 row_mask:0xf bank_mask:0xf
    v_and_b32_dpp v41, v29, v9 row_newbcast:4 row_mask:0xf bank_mask:0xf
    v_and_b32_dpp v42, v29, v10 row_newbcast:4 row_mask:0xf bank_mask:0xf
    v_and_b32_dpp v43, v29, v11 row_newbcast:4 row_mask:0xf bank_mask:0xf
    v_and_b32_dpp v44, v29, v8 row_newbcast:12 row_mask:0xf bank_mask:0xf
    v_and_b32_dpp v45, v29, v9 row_newbcast:12 row_mask:0xf bank_mask:0xf
    v_and_b32_dpp v46, v29, v10 row_newbcast:12 row_mask:0xf bank_mask:0xf
    v_and_b32_dpp v47, v29, v11 row_newbcast:12 row_mask:0xf bank_mask:0xf
    v_mfma_f32_16x16x32_bf16 v[12:15], v[32:35], a[16:19], v[12:15]
    v_mfma_f32_16x16x32_bf16 v[12:15], v[36:39], a[20:23], v[12:15]
    v_mfma_f32_16x16x32_bf16 v[12:15], v[40:43], a[24:27], v[12:15]
    v_mfma_f32_16x16x32_bf16 v[12:15], v[44:47], a[28:31], v[12:15]
    s_mov_b32 s62, 3
    s_cmp_eq_u32 s13, 0
    s_cbranch_scc1 L_aswitch
L_alast0:
    s_waitcnt vmcnt(12)
    v_dot2_f32_bf16 v20, v64, v4, 0
    v_dot2_f32_bf16 v21, v68, v4, 0
    v_dot2_f32_bf16 v22, v72, v4, 0
    v_dot2_f32_bf16 v23, v76, v4, 0
    v_dot2_f32_bf16 v20, v65, v5, v20
    v_dot2_f32_bf16 v21, v69, v5, v21
    v_dot2_f32_bf16 v22, v73, v5, v22
    v_dot2_f32_bf16 v23, v77, v5, v23
    v_dot2_f32_bf16 v20, v66, v6, v20
    v_dot2_f32_bf16 v21, v70, v6, v21
    v_dot2_f32_bf16 v22, v74, v6, v22
    v_dot2_f32_bf16 v23, v78, v6, v23
    v_dot2_f32_bf16 v20, v67, v7, v20
    v_dot2_f32_bf16 v21, v71, v7, v21
    v_dot2_f32_bf16 v22, v75, v7, v22
    v_dot2_f32_bf16 v23, v79, v7, v23
    buffer_load_dwordx4 v[160:163], v19, s[40:43], s24 offen offset:0 nt
    buffer_load_dwordx4 v[164:167], v19, s[40:43], s24 offen offset:1152 nt
    buffer_load_dwordx4 v[168:171], v19, s[40:43], s24 offen offset:2304 nt
    buffer_load_dwordx4 v[172:175], v19, s[40:43], s24 offen offset:3456 nt
    s_add_u32 s24, s24, 4608
    buffer_load_dwordx4 v[176:179], v19, s[40:43], s24 offen offset:0 nt
    buffer_load_dwordx4 v[180:183], v19, s[40:43], s24 offen offset:1152 nt
    buffer_load_dwordx4 v[184:187], v19, s[40:43], s24 offen offset:2304 nt
    buffer_load_dwordx4 v[188:191], v19, s[40:43], s24 offen offset:3456 nt
    v_add_f32_dpp v24, v20, v20 row_ror:8 row_mask:0xf bank_mask:0x3
    v_add_f32_dpp v25, v22, v22 row_ror:8 row_mask:0xf bank_mask:0x3
    v_add_f32_dpp v24, v21, v21 row_ror:8 row_mask:0xf bank_mask:0xc
    v_add_f32_dpp v25, v23, v23 row_ror:8 row_mask:0xf bank_mask:0xc
    s_nop 0
    v_add_f32_dpp v26, v24, v24 row_shl:4 row_mask:0xf bank_mask:0x5
    v_add_f32_dpp v26, v25, v25 row_shr:4 row_mask:0xf bank_mask:0xa
    s_nop 1
    v_add_f32_dpp v26, v26, v26 quad_perm:[1,0,3,2] row_mask:0xf bank_mask:0xf
    s_nop 1
    v_add_f32_dpp v26, v26, v26 quad_perm:[2,3,0,1] row_mask:0xf bank_mask:0xf
    v_cvt_pk_bf16_f32 v26, v26, v26
    v_and_b32 v26, s98, v26
    v_mul_f32 v26, s96, v26
    v_cvt_pk_bf16_f32 v26, v26, v26
    v_and_b32 v26, s98, v26
    s_nop 1
    v_max_f32_dpp v27, v26, v26 row_ror:4 row_mask:0xf bank_mask:0xf
    s_nop 1
    v_max_f32_dpp v27, v27, v27 row_ror:8 row_mask:0xf bank_mask:0xf
    v_mov_b32 v28, v27
    s_nop 1
    v_permlane16_swap_b32 v27, v28
    v_max_f32 v27, v27, v28
    v_mov_b32 v28, v27
    s_nop 1
    v_permlane32_swap_b32 v27, v28
    v_max3_f32 v27, v27, v28, v16
    v_sub_f32 v28, v16, v27
    v_sub_f32 v29, v26, v27
    v_mul_f32 v28, s97, v28
    v_mul_f32 v29, s97, v29
    v_exp_f32 v28, v28
    v_exp_f32 v29, v29
    v_mov_b32 v16, v27
    v_fma_f32 v17, v17, v28, v29
    v_cvt_pk_bf16_f32 v29, v29, v29
    v_mul_f32 v12, v12, v28
    v_mul_f32 v13, v13, v28
    v_mul_f32 v14, v14, v28
    v_mul_f32 v15, v15, v28
    s_waitcnt vmcnt(16)
    v_and_b32_dpp v32, v29, v8 row_newbcast:0 row_mask:0xf bank_mask:0xf
    v_and_b32_dpp v33, v29, v9 row_newbcast:0 row_mask:0xf bank_mask:0xf
    v_and_b32_dpp v34, v29, v10 row_newbcast:0 row_mask:0xf bank_mask:0xf
    v_and_b32_dpp v35, v29, v11 row_newbcast:0 row_mask:0xf bank_mask:0xf
    v_and_b32_dpp v36, v29, v8 row_newbcast:8 row_mask:0xf bank_mask:0xf
    v_and_b32_dpp v37, v29, v9 row_newbcast:8 row_mask:0xf bank_mask:0xf
    v_and_b32_dpp v38, v29, v10 row_newbcast:8 row_mask:0xf bank_mask:0xf
    v_and_b32_dpp v39, v29, v11 row_newbcast:8 row_mask:0xf bank_mask:0xf
    v_and_b32_dpp v40, v29, v8 row_newbcast:4 row_mask:0xf bank_mask:0xf
    v_and_b32_dpp v41, v29, v9 row_newbcast:4 row_mask:0xf bank_mask:0xf
    v_and_b32_dpp v42, v29, v10 row_newbcast:4 row_mask:0xf bank_mask:0xf
    v_and_b32_dpp v43, v29, v11 row_newbcast:4 row_mask:0xf bank_mask:0xf
    v_and_b32_dpp v44, v29, v8 row_newbcast:12 row_mask:0xf bank_mask:0xf
    v_and_b32_dpp v45, v29, v9 row_newbcast:12 row_mask:0xf bank_mask:0xf
    v_and_b32_dpp v46, v29, v10 row_newbcast:12 row_mask:0xf bank_mask:0xf
    v_and_b32_dpp v47, v29, v11 row_newbcast:12 row_mask:0xf bank_mask:0xf
    v_mfma_f32_16x16x32_bf16 v[12:15], v[32:35], a[0:3], v[12:15]
    v_mfma_f32_16x16x32_bf16 v[12:15], v[36:39], a[4:7], v[12:15]
    v_mfma_f32_16x16x32_bf16 v[12:15], v[40:43], a[8:11], v[12:15]
    v_mfma_f32_16x16x32_bf16 v[12:15], v[44:47], a[12:15], v[12:15]
    s_nop 3
    s_branch L_adone2
L_adrain0:
    buffer_load_dwordx4 v[128:131], v19, s[40:43], s24 offen offset:0 nt
    buffer_load_dwordx4 v[132:135], v19, s[40:43], s24 offen offset:1152 nt
    buffer_load_dwordx4 v[136:139], v19, s[40:43], s24 offen offset:2304 nt
    buffer_load_dwordx4 v[140:143], v19, s[40:43], s24 offen offset:3456 nt
    s_add_u32 s24, s24, 4608
    buffer_load_dwordx4 v[144:147], v19, s[40:43], s24 offen offset:0 nt
    buffer_load_dwordx4 v[148:151], v19, s[40:43], s24 offen offset:1152 nt
    buffer_load_dwordx4 v[152:155], v19, s[40:43], s24 offen offset:2304 nt
    buffer_load_dwordx4 v[156:159], v19, s[40:43], s24 offen offset:3456 nt
    s_add_u32 s24, s24, 69120
    v_add_f32_dpp v24, v20, v20 row_ror:8 row_mask:0xf bank_mask:0x3
    v_add_f32_dpp v25, v22, v22 row_ror:8 row_mask:0xf bank_mask:0x3
    v_add_f32_dpp v24, v21, v21 row_ror:8 row_mask:0xf bank_mask:0xc
    v_add_f32_dpp v25, v23, v23 row_ror:8 row_mask:0xf bank_mask:0xc
    s_nop 0
    v_add_f32_dpp v26, v24, v24 row_shl:4 row_mask:0xf bank_mask:0x5
    v_add_f32_dpp v26, v25, v25 row_shr:4 row_mask:0xf bank_mask:0xa
    s_nop 1
    v_add_f32_dpp v26, v26, v26 quad_perm:[1,0,3,2] row_mask:0xf bank_mask:0xf
    s_nop 1
    v_add_f32_dpp v26, v26, v26 quad_perm:[2,3,0,1] row_mask:0xf bank_mask:0xf
    v_cvt_pk_bf16_f32 v26, v26, v26
    v_and_b32 v26, s98, v26
    v_mul_f32 v26, s96, v26
    v_cvt_pk_bf16_f32 v26, v26, v26
    v_and_b32 v26, s98, v26
    s_nop 1
    v_max_f32_dpp v27, v26, v26 row_ror:4 row_mask:0xf bank_mask:0xf
    s_nop 1
    v_max_f32_dpp v27, v27, v27 row_ror:8 row_mask:0xf bank_mask:0xf
    v_mov_b32 v28, v27
    s_nop 1
    v_permlane16_swap_b32 v27, v28
    v_max_f32 v27, v27, v28
    v_mov_b32 v28, v27
    s_nop 1
    v_permlane32_swap_b32 v27, v28
    v_max3_f32 v27, v27, v28, v16
    v_sub_f32 v28, v16, v27
    v_sub_f32 v29, v26, v27
    v_mul_f32 v28, s97, v28
    v_mul_f32 v29, s97, v29
    v_exp_f32 v28, v28
    v_exp_f32 v29, v29
    v_mov_b32 v16, v27
    v_fma_f32 v17, v17, v28, v29
    v_cvt_pk_bf16_f32 v29, v29, v29
    v_mul_f32 v12, v12, v28
    v_mul_f32 v13, v13, v28
    v_mul_f32 v14, v14, v28
    v_mul_f32 v15, v15, v28
    s_waitcnt vmcnt(16)
    v_and_b32_dpp v32, v29, v8 row_newbcast:0 row_mask:0xf bank_mask:0xf
    v_and_b32_dpp v33, v29, v9 row_newbcast:0 row_mask:0xf bank_mask:0xf
    v_and_b32_dpp v34, v29, v10 row_newbcast:0 row_mask:0xf bank_mask:0xf
    v_and_b32_dpp v35, v29, v11 row_newbcast:0 row_mask:0xf bank_mask:0xf
    v_and_b32_dpp v36, v29, v8 row_newbcast:8 row_mask:0xf bank_mask:0xf
    v_and_b32_dpp v37, v29, v9 row_newbcast:8 row_mask:0xf bank_mask:0xf
    v_and_b32_dpp v38, v29, v10 row_newbcast:8 row_mask:0xf bank_mask:0xf
    v_and_b32_dpp v39, v29, v11 row_newbcast:8 row_mask:0xf bank_mask:0xf
    v_and_b32_dpp v40, v29, v8 row_newbcast:4 row_mask:0xf bank_mask:0xf
    v_and_b32_dpp v41, v29, v9 row_newbcast:4 row_mask:0xf bank_mask:0xf
    v_and_b32_dpp v42, v29, v10 row_newbcast:4 row_mask:0xf bank_mask:0xf
    v_and_b32_dpp v43, v29, v11 row_newbcast:4 row_mask:0xf bank_mask:0xf
    v_and_b32_dpp v44, v29, v8 row_newbcast:12 row_mask:0xf bank_mask:0xf
    v_and_b32_dpp v45, v29, v9 row_newbcast:12 row_mask:0xf bank_mask:0xf
    v_and_b32_dpp v46, v29, v10 row_newbcast:12 row_mask:0xf bank_mask:0xf
    v_and_b32_dpp v47, v29, v11 row_newbcast:12 row_mask:0xf bank_mask:0xf
    v_mfma_f32_16x16x32_bf16 v[12:15], v[32:35], a[0:3], v[12:15]
    v_mfma_f32_16x16x32_bf16 v[12:15], v[36:39], a[4:7], v[12:15]
    v_mfma_f32_16x16x32_bf16 v[12:15], v[40:43], a[8:11], v[12:15]
    v_mfma_f32_16x16x32_bf16 v[12:15], v[44:47], a[12:15], v[12:15]
    s_waitcnt vmcnt(12)
    v_dot2_f32_bf16 v20, v80, v4, 0
    v_dot2_f32_bf16 v21, v84, v4, 0
    v_dot2_f32_bf16 v22, v88, v4, 0
    v_dot2_f32_bf16 v23, v92, v4, 0
    v_dot2_f32_bf16 v20, v81, v5, v20
    v_dot2_f32_bf16 v21, v85, v5, v21
    v_dot2_f32_bf16 v22, v89, v5, v22
    v_dot2_f32_bf16 v23, v93, v5, v23
    v_dot2_f32_bf16 v20, v82, v6, v20
    v_dot2_f32_bf16 v21, v86, v6, v21
    v_dot2_f32_bf16 v22, v90, v6, v22
    v_dot2_f32_bf16 v23, v94, v6, v23
    v_dot2_f32_bf16 v20, v83, v7, v20
    v_dot2_f32_bf16 v21, v87, v7, v21
    v_dot2_f32_bf16 v22, v91, v7, v22
    v_dot2_f32_bf16 v23, v95, v7, v23
    buffer_load_dwordx4 v[160:163], v19, s[40:43], s24 offen offset:0 nt
    buffer_load_dwordx4 v[164:167], v19, s[40:43], s24 offen offset:1152 nt
    buffer_load_dwordx4 v[168:171], v19, s[40:43], s24 offen offset:2304 nt
    buffer_load_dwordx4 v[172:175], v19, s[40:43], s24 offen offset:3456 nt
    s_add_u32 s24, s24, 4608
    buffer_load_dwordx4 v[176:179], v19, s[40:43], s24 offen offset:0 nt
    buffer_load_dwordx4 v[180:183], v19, s[40:43], s24 offen offset:1152 nt
    buffer_load_dwordx4 v[184:187], v19, s[40:43], s24 offen offset:2304 nt
    buffer_load_dwordx4 v[188:191], v19, s[40:43], s24 offen offset:3456 nt
    v_add_f32_dpp v24, v20, v20 row_ror:8 row_mask:0xf bank_mask:0x3
    v_add_f32_dpp v25, v22, v22 row_ror:8 row_mask:0xf bank_mask:0x3
    v_add_f32_dpp v24, v21, v21 row_ror:8 row_mask:0xf bank_mask:0xc
    v_add_f32_dpp v25, v23, v23 row_ror:8 row_mask:0xf bank_mask:0xc
    s_nop 0
    v_add_f32_dpp v26, v24, v24 row_shl:4 row_mask:0xf bank_mask:0x5
    v_add_f32_dpp v26, v25, v25 row_shr:4 row_mask:0xf bank_mask:0xa
    s_nop 1
    v_add_f32_dpp v26, v26, v26 quad_perm:[1,0,3,2] row_mask:0xf bank_mask:0xf
    s_nop 1
    v_add_f32_dpp v26, v26, v26 quad_perm:[2,3,0,1] row_mask:0xf bank_mask:0xf
    v_cvt_pk_bf16_f32 v26, v26, v26
    v_and_b32 v26, s98, v26
    v_mul_f32 v26, s96, v26
    v_cvt_pk_bf16_f32 v26, v26, v26
    v_and_b32 v26, s98, v26
    s_nop 1
    v_max_f32_dpp v27, v26, v26 row_ror:4 row_mask:0xf bank_mask:0xf
    s_nop 1
    v_max_f32_dpp v27, v27, v27 row_ror:8 row_mask:0xf bank_mask:0xf
    v_mov_b32 v28, v27
    s_nop 1
    v_permlane16_swap_b32 v27, v28
    v_max_f32 v27, v27, v28
    v_mov_b32 v28, v27
    s_nop 1
    v_permlane32_swap_b32 v27, v28
    v_max3_f32 v27, v27, v28, v16
    v_sub_f32 v28, v16, v27
    v_sub_f32 v29, v26, v27
    v_mul_f32 v28, s97, v28
    v_mul_f32 v29, s97, v29
    v_exp_f32 v28, v28
    v_exp_f32 v29, v29
    v_mov_b32 v16, v27
    v_fma_f32 v17, v17, v28, v29
    v_cvt_pk_bf16_f32 v29, v29, v29
    v_mul_f32 v12, v12, v28
    v_mul_f32 v13, v13, v28
    v_mul_f32 v14, v14, v28
    v_mul_f32 v15, v15, v28
    s_waitcnt vmcnt(16)
    v_and_b32_dpp v32, v29, v8 row_newbcast:0 row_mask:0xf bank_mask:0xf
    v_and_b32_dpp v33, v29, v9 row_newbcast:0 row_mask:0xf bank_mask:0xf
    v_and_b32_dpp v34, v29, v10 row_newbcast:0 row_mask:0xf bank_mask:0xf
    v_and_b32_dpp v35, v29, v11 row_newbcast:0 row_mask:0xf bank_mask:0xf
    v_and_b32_dpp v36, v29, v8 row_newbcast:8 row_mask:0xf bank_mask:0xf
    v_and_b32_dpp v37, v29, v9 row_newbcast:8 row_mask:0xf bank_mask:0xf
    v_and_b32_dpp v38, v29, v10 row_newbcast:8 row_mask:0xf bank_mask:0xf
    v_and_b32_dpp v39, v29, v11 row_newbcast:8 row_mask:0xf bank_mask:0xf
    v_and_b32_dpp v40, v29, v8 row_newbcast:4 row_mask:0xf bank_mask:0xf
    v_and_b32_dpp v41, v29, v9 row_newbcast:4 row_mask:0xf bank_mask:0xf
    v_and_b32_dpp v42, v29, v10 row_newbcast:4 row_mask:0xf bank_mask:0xf
    v_and_b32_dpp v43, v29, v11 row_newbcast:4 row_mask:0xf bank_mask:0xf
    v_and_b32_dpp v44, v29, v8 row_newbcast:12 row_mask:0xf bank_mask:0xf
    v_and_b32_dpp v45, v29, v9 row_newbcast:12 row_mask:0xf bank_mask:0xf
    v_and_b32_dpp v46, v29, v10 row_newbcast:12 row_mask:0xf bank_mask:0xf
    v_and_b32_dpp v47, v29, v11 row_newbcast:12 row_mask:0xf bank_mask:0xf
    v_mfma_f32_16x16x32_bf16 v[12:15], v[32:35], a[16:19], v[12:15]
    v_mfma_f32_16x16x32_bf16 v[12:15], v[36:39], a[20:23], v[12:15]
    v_mfma_f32_16x16x32_bf16 v[12:15], v[40:43], a[24:27], v[12:15]
    v_mfma_f32_16x16x32_bf16 v[12:15], v[44:47], a[28:31], v[12:15]
    s_mov_b32 s62, 0
L_adone:
    s_cmp_eq_u32 s13, 0
    s_cbranch_scc1 L_aswitch
L_adone2:
    v_add_f32_dpp v17, v17, v17 row_ror:4 row_mask:0xf bank_mask:0xf
    s_nop 1
    v_add_f32_dpp v17, v17, v17 row_ror:8 row_mask:0xf bank_mask:0xf
    v_mov_b32 v28, v17
    s_nop 1
    v_permlane16_swap_b32 v17, v28
    v_add_f32 v17, v17, v28
    v_mov_b32 v28, v17
    s_nop 1
    v_permlane32_swap_b32 v17, v28
    v_add_f32 v17, v17, v28
    v_cvt_pk_bf16_f32 v54, v12, v13
    v_cvt_pk_bf16_f32 v55, v14, v15
    v_cmp_gt_u32 vcc, 48, v1
    s_nop 1
    v_cndmask_b32 v16, v16, v50, vcc
    v_cndmask_b32 v17, v17, v51, vcc
    v_permlane16_swap_b32 v52, v54
    v_permlane16_swap_b32 v53, v55
    v_cmp_gt_u32 vcc, 32, v1
    s_nop 1
    v_cndmask_b32 v52, v16, v52, vcc
    v_cndmask_b32 v53, v17, v53, vcc
    v_cndmask_b32 v54, v16, v54, vcc
    v_cndmask_b32 v55, v17, v55, vcc
    v_min_u32 v52, -2, v52
    v_min_u32 v53, -2, v53
    v_min_u32 v54, -2, v54
    v_min_u32 v55, -2, v55
    s_mov_b32 s54, 8388608
    buffer_store_dwordx4 v[52:55], v3, s[44:47], s54 offen sc1
    s_mov_b32 s58, s22
    s_add_u32 s59, s22, 4096
    s_cmp_eq_u32 s23, 2
    s_cbranch_scc1 L_eshared
    s_cmp_lg_u32 s23, 0
    s_cbranch_scc1 L_epiB
    buffer_load_dwordx4 v[40:43], v30, s[44:47], s58 offen sc1
    buffer_load_dwordx4 v[192:195], v2, s[44:47], s58 offen offset:0 sc1
    buffer_load_dwordx4 v[196:199], v2, s[44:47], s58 offen offset:1024 sc1
    v_and_b32 v3, 15, v1
    v_lshrrev_b32 v4, 4, v1
    s_mov_b32 s60, 0x05040100
    s_mov_b32 s61, 0x07060302
    v_mul_u32_u24 v0, 73728, v4
    v_bfe_u32 v5, v1, 2, 1
    v_lshl_add_u32 v0, v5, 12, v0
    v_and_b32 v5, 3, v1
    v_lshl_add_u32 v0, v5, 5, v0
    v_bfe_u32 v5, v1, 3, 1
    v_lshl_add_u32 v0, v5, 4, v0
    s_lshl_b32 s54, s3, 9
    v_lshl_add_u32 v5, v3, 4, s54
    v_and_b32 v6, 1, v4
    v_lshl_add_u32 v5, v6, 3, v5
    v_lshrrev_b32 v6, 1, v4
    v_lshl_add_u32 v5, v6, 8, v5
    v_lshrrev_b32 v7, 2, v3
    v_lshlrev_b32 v7, 9, v7
    v_lshl_add_u32 v7, v4, 4, v7
    v_and_b32 v6, 1, v1
    v_lshl_add_u32 v7, v6, 6, v7
    v_and_b32 v6, 1, v3
    v_cmp_gt_u32 s[20:21], 2, v6
    s_waitcnt vmcnt(17)
    v_perm_b32 v64, v132, v128, s60
    v_perm_b32 v68, v132, v128, s61
    v_perm_b32 v72, v133, v129, s60
    v_perm_b32 v76, v133, v129, s61
    v_perm_b32 v80, v134, v130, s60
    v_perm_b32 v84, v134, v130, s61
    v_perm_b32 v88, v135, v131, s60
    v_perm_b32 v92, v135, v131, s61
    s_waitcnt vmcnt(15)
    v_perm_b32 v65, v140, v136, s60
    v_perm_b32 v69, v140, v136, s61
    v_perm_b32 v73, v141, v137, s60
    v_perm_b32 v77, v141, v137, s61
    v_perm_b32 v81, v142, v138, s60
    v_perm_b32 v85, v142, v138, s61
    v_perm_b32 v89, v143, v139, s60
    v_perm_b32 v93, v143, v139, s61
    s_waitcnt vmcnt(13)
    v_perm_b32 v66, v148, v144, s60
    v_perm_b32 v70, v148, v144, s61
    v_perm_b32 v74, v149, v145, s60
    v_perm_b32 v78, v149, v145, s61
    v_perm_b32 v82, v150, v146, s60
    v_perm_b32 v86, v150, v146, s61
    v_perm_b32 v90, v151, v147, s60
    v_perm_b32 v94, v151, v147, s61
    s_waitcnt vmcnt(11)
    v_perm_b32 v67, v156, v152, s60
    v_perm_b32 v71, v156, v152, s61
    v_perm_b32 v75, v157, v153, s60
    v_perm_b32 v79, v157, v153, s61
    v_perm_b32 v83, v158, v154, s60
    v_perm_b32 v87, v158, v154, s61
    v_perm_b32 v91, v159, v155, s60
    v_perm_b32 v95, v159, v155, s61
    s_waitcnt vmcnt(9)
    v_perm_b32 v96, v164, v160, s60
    v_perm_b32 v100, v164, v160, s61
    v_perm_b32 v104, v165, v161, s60
    v_perm_b32 v108, v165, v161, s61
    v_perm_b32 v112, v166, v162, s60
    v_perm_b32 v116, v166, v162, s61
    v_perm_b32 v120, v167, v163, s60
    v_perm_b32 v124, v167, v163, s61
    s_waitcnt vmcnt(7)
    v_perm_b32 v97, v172, v168, s60
    v_perm_b32 v101, v172, v168, s61
    v_perm_b32 v105, v173, v169, s60
    v_perm_b32 v109, v173, v169, s61
    v_perm_b32 v113, v174, v170, s60
    v_perm_b32 v117, v174, v170, s61
    v_perm_b32 v121, v175, v171, s60
    v_perm_b32 v125, v175, v171, s61
    s_waitcnt vmcnt(5)
    v_perm_b32 v98, v180, v176, s60
    v_perm_b32 v102, v180, v176, s61
    v_perm_b32 v106, v181, v177, s60
    v_perm_b32 v110, v181, v177, s61
    v_perm_b32 v114, v182, v178, s60
    v_perm_b32 v118, v182, v178, s61
    v_perm_b32 v122, v183, v179, s60
    v_perm_b32 v126, v183, v179, s61
    s_waitcnt vmcnt(3)
    v_perm_b32 v99, v188, v184, s60
    v_perm_b32 v103, v188, v184, s61
    v_perm_b32 v107, v189, v185, s60
    v_perm_b32 v111, v189, v185, s61
    v_perm_b32 v115, v190, v186, s60
    v_perm_b32 v119, v190, v186, s61
    v_perm_b32 v123, v191, v187, s60
    v_perm_b32 v127, v191, v187, s61
    s_waitcnt vmcnt(0)
    s_branch L_mpoll_8_c
L_mpoll_8:
    s_mov_b64 exec, s[4:5]
    buffer_load_dwordx4 v[40:43], v30, s[44:47], s58 offen sc1
    s_mov_b64 exec, s[6:7]
    buffer_load_dwordx4 v[192:195], v2, s[44:47], s58 offen offset:0 sc1
    s_mov_b64 exec, s[8:9]
    buffer_load_dwordx4 v[196:199], v2, s[44:47], s58 offen offset:1024 sc1
    s_mov_b64 exec, -1
    s_waitcnt vmcnt(3)
L_mpoll_8_c:
    v_max3_u32 v236, v40, v41, v42
    v_max3_u32 v237, v192, v193, v194
    v_max3_u32 v238, v196, v197, v198
    v_max_u32 v236, v236, v43
    v_max_u32 v237, v237, v195
    v_max_u32 v238, v238, v199
    v_cmp_eq_u32 s[4:5], -1, v236
    v_cmp_eq_u32 s[6:7], -1, v237
    v_cmp_eq_u32 s[8:9], -1, v238
    s_or_b64 vcc, s[4:5], s[6:7]
    s_or_b64 vcc, vcc, s[8:9]
    s_cbranch_scc0 L_mpollok_9
    s_sub_u32 s101, s101, 1
    s_cbranch_scc0 L_mpoll_8
    s_mov_b32 s101, 0
L_mpollok_9:
    v_max_f32_dpp v44, v40, v40 row_ror:1 row_mask:0xf bank_mask:0xf
    v_cndmask_b32 v47, 0, v41, s[20:21]
    v_mov_b32 v45, v44
    s_nop 1
    v_permlane16_swap_b32 v44, v45
    v_max_f32 v44, v44, v45
    v_mov_b32 v45, v44
    s_nop 1
    v_permlane32_swap_b32 v44, v45
    v_max_f32 v44, v44, v45
    v_sub_f32 v45, v40, v44
    v_mul_f32 v45, s97, v45
    v_exp_f32 v45, v45
    s_nop 0
    v_cvt_pk_bf16_f32 v46, v45, v45
    v_and_b32 v45, s98, v46
    v_mul_f32 v47, v47, v45
    v_and_b32_dpp v232, v46, v8 row_newbcast:0 row_mask:0xf bank_mask:0xf
    v_and_b32_dpp v233, v46, v9 row_newbcast:0 row_mask:0xf bank_mask:0xf
    v_add_f32_dpp v47, v47, v47 row_ror:1 row_mask:0xf bank_mask:0xf
    v_and_b32_dpp v234, v46, v10 row_newbcast:0 row_mask:0xf bank_mask:0xf
    v_and_b32_dpp v235, v46, v11 row_newbcast:0 row_mask:0xf bank_mask:0xf
    v_and_b32_dpp v236, v46, v8 row_newbcast:1 row_mask:0xf bank_mask:0xf
    v_mov_b32 v45, v47
    v_and_b32_dpp v237, v46, v9 row_newbcast:1 row_mask:0xf bank_mask:0xf
    v_and_b32_dpp v238, v46, v10 row_newbcast:1 row_mask:0xf bank_mask:0xf
    v_and_b32_dpp v239, v46, v11 row_newbcast:1 row_mask:0xf bank_mask:0xf
    v_permlane16_swap_b32 v47, v45
    v_mfma_f32_16x16x32_bf16 v[228:231], v[232:235], v[192:195], 0
    v_add_f32 v47, v47, v45
    v_mfma_f32_16x16x32_bf16 v[228:231], v[236:239], v[196:199], v[228:231]
    v_mov_b32 v45, v47
    s_nop 1
    v_permlane32_swap_b32 v47, v45
    v_add_f32 v47, v47, v45
    v_rcp_f32 v47, v47
    s_nop 1
    v_mul_f32 v228, v228, v47
    v_mul_f32 v229, v229, v47
    v_mul_f32 v230, v230, v47
    v_mul_f32 v231, v231, v47
    v_cvt_pk_bf16_f32 v224, v228, v229
    v_cvt_pk_bf16_f32 v225, v230, v231
    s_branch L_emerged
L_eshared:
    buffer_load_dwordx4 v[40:43], v30, s[44:47], s58 offen sc1
    buffer_load_dwordx4 v[192:195], v2, s[44:47], s58 offen offset:0 sc1
    buffer_load_dwordx4 v[196:199], v2, s[44:47], s58 offen offset:1024 sc1
    buffer_load_dwordx4 v[200:203], v2, s[44:47], s58 offen offset:2048 sc1
    buffer_load_dwordx4 v[204:207], v2, s[44:47], s58 offen offset:3072 sc1
    buffer_load_dwordx4 v[208:211], v2, s[44:47], s59 offen offset:0 sc1
    buffer_load_dwordx4 v[212:215], v2, s[44:47], s59 offen offset:1024 sc1
    v_and_b32 v3, 15, v1
    v_lshrrev_b32 v4, 4, v1
    s_mov_b32 s60, 0x05040100
    s_mov_b32 s61, 0x07060302
    v_mul_u32_u24 v0, 73728, v4
    v_bfe_u32 v5, v1, 2, 1
    v_lshl_add_u32 v0, v5, 12, v0
    v_and_b32 v5, 3, v1
    v_lshl_add_u32 v0, v5, 5, v0
    v_bfe_u32 v5, v1, 3, 1
    v_lshl_add_u32 v0, v5, 4, v0
    s_lshl_b32 s54, s3, 9
    v_lshl_add_u32 v5, v3, 4, s54
    v_and_b32 v6, 1, v4
    v_lshl_add_u32 v5, v6, 3, v5
    v_lshrrev_b32 v6, 1, v4
    v_lshl_add_u32 v5, v6, 8, v5
    v_lshrrev_b32 v7, 2, v3
    v_lshlrev_b32 v7, 9, v7
    v_lshl_add_u32 v7, v4, 4, v7
    v_and_b32 v6, 1, v1
    v_lshl_add_u32 v7, v6, 6, v7
    v_and_b32 v6, 7, v3
    v_cmp_gt_u32 s[20:21], 6, v6
    s_waitcnt vmcnt(21)
    v_perm_b32 v64, v132, v128, s60
    v_perm_b32 v68, v132, v128, s61
    v_perm_b32 v72, v133, v129, s60
    v_perm_b32 v76, v133, v129, s61
    v_perm_b32 v80, v134, v130, s60
    v_perm_b32 v84, v134, v130, s61
    v_perm_b32 v88, v135, v131, s60
    v_perm_b32 v92, v135, v131, s61
    s_waitcnt vmcnt(19)
    v_perm_b32 v65, v140, v136, s60
    v_perm_b32 v69, v140, v136, s61
    v_perm_b32 v73, v141, v137, s60
    v_perm_b32 v77, v141, v137, s61
    v_perm_b32 v81, v142, v138, s60
    v_perm_b32 v85, v142, v138, s61
    v_perm_b32 v89, v143, v139, s60
    v_perm_b32 v93, v143, v139, s61
    s_waitcnt vmcnt(17)
    v_perm_b32 v66, v148, v144, s60
    v_perm_b32 v70, v148, v144, s61
    v_perm_b32 v74, v149, v145, s60
    v_perm_b32 v78, v149, v145, s61
    v_perm_b32 v82, v150, v146, s60
    v_perm_b32 v86, v150, v146, s61
    v_perm_b32 v90, v151, v147, s60
    v_perm_b32 v94, v151, v147, s61
    s_waitcnt vmcnt(15)
    v_perm_b32 v67, v156, v152, s60
    v_perm_b32 v71, v156, v152, s61
    v_perm_b32 v75, v157, v153, s60
    v_perm_b32 v79, v157, v153, s61
    v_perm_b32 v83, v158, v154, s60
    v_perm_b32 v87, v158, v154, s61
    v_perm_b32 v91, v159, v155, s60
    v_perm_b32 v95, v159, v155, s61
    s_waitcnt vmcnt(13)
    v_perm_b32 v96, v164, v160, s60
    v_perm_b32 v100, v164, v160, s61
    v_perm_b32 v104, v165, v161, s60
    v_perm_b32 v108, v165, v161, s61
    v_perm_b32 v112, v166, v162, s60
    v_perm_b32 v116, v166, v162, s61
    v_perm_b32 v120, v167, v163, s60
    v_perm_b32 v124, v167, v163, s61
    s_waitcnt vmcnt(11)
    v_perm_b32 v97, v172, v168, s60
    v_perm_b32 v101, v172, v168, s61
    v_perm_b32 v105, v173, v169, s60
    v_perm_b32 v109, v173, v169, s61
    v_perm_b32 v113, v174, v170, s60
    v_perm_b32 v117, v174, v170, s61
    v_perm_b32 v121, v175, v171, s60
    v_perm_b32 v125, v175, v171, s61
    s_waitcnt vmcnt(9)
    v_perm_b32 v98, v180, v176, s60
    v_perm_b32 v102, v180, v176, s61
    v_perm_b32 v106, v181, v177, s60
    v_perm_b32 v110, v181, v177, s61
    v_perm_b32 v114, v182, v178, s60
    v_perm_b32 v118, v182, v178, s61
    v_perm_b32 v122, v183, v179, s60
    v_perm_b32 v126, v183, v179, s61
    s_waitcnt vmcnt(7)
    v_perm_b32 v99, v188, v184, s60
    v_perm_b32 v103, v188, v184, s61
    v_perm_b32 v107, v189, v185, s60
    v_perm_b32 v111, v189, v185, s61
    v_perm_b32 v115, v190, v186, s60
    v_perm_b32 v119, v190, v186, s61
    v_perm_b32 v123, v191, v187, s60
    v_perm_b32 v127, v191, v187, s61
    s_waitcnt vmcnt(0)
    s_branch L_mpoll_12_c
L_mpoll_12:
    s_mov_b64 exec, s[4:5]
    buffer_load_dwordx4 v[40:43], v30, s[44:47], s58 offen sc1
    s_mov_b64 exec, s[6:7]
    buffer_load_dwordx4 v[192:195], v2, s[44:47], s58 offen offset:0 sc1
    s_mov_b64 exec, s[8:9]
    buffer_load_dwordx4 v[196:199], v2, s[44:47], s58 offen offset:1024 sc1
    s_mov_b64 exec, s[10:11]
    buffer_load_dwordx4 v[200:203], v2, s[44:47], s58 offen offset:2048 sc1
    s_mov_b64 exec, s[12:13]
    buffer_load_dwordx4 v[204:207], v2, s[44:47], s58 offen offset:3072 sc1
    s_mov_b64 exec, s[14:15]
    buffer_load_dwordx4 v[208:211], v2, s[44:47], s59 offen offset:0 sc1
    s_mov_b64 exec, s[16:17]
    buffer_load_dwordx4 v[212:215], v2, s[44:47], s59 offen offset:1024 sc1
    s_mov_b64 exec, -1
    s_waitcnt vmcnt(7)
L_mpoll_12_c:
    v_max3_u32 v236, v40, v41, v42
    v_max3_u32 v237, v192, v193, v194
    v_max3_u32 v238, v196, v197, v198
    v_max3_u32 v239, v200, v201, v202
    v_max3_u32 v240, v204, v205, v206
    v_max3_u32 v241, v208, v209, v210
    v_max3_u32 v242, v212, v213, v214
    v_max_u32 v236, v236, v43
    v_max_u32 v237, v237, v195
    v_max_u32 v238, v238, v199
    v_max_u32 v239, v239, v203
    v_max_u32 v240, v240, v207
    v_max_u32 v241, v241, v211
    v_max_u32 v242, v242, v215
    v_cmp_eq_u32 s[4:5], -1, v236
    v_cmp_eq_u32 s[6:7], -1, v237
    v_cmp_eq_u32 s[8:9], -1, v238
    v_cmp_eq_u32 s[10:11], -1, v239
    v_cmp_eq_u32 s[12:13], -1, v240
    v_cmp_eq_u32 s[14:15], -1, v241
    v_cmp_eq_u32 s[16:17], -1, v242
    s_or_b64 vcc, s[4:5], s[6:7]
    s_or_b64 vcc, vcc, s[8:9]
    s_or_b64 vcc, vcc, s[10:11]
    s_or_b64 vcc, vcc, s[12:13]
    s_or_b64 vcc, vcc, s[14:15]
    s_or_b64 vcc, vcc, s[16:17]
    s_cbranch_scc0 L_mpollok_13
    s_sub_u32 s101, s101, 1
    s_cbranch_scc0 L_mpoll_12
    s_mov_b32 s101, 0
L_mpollok_13:
    v_max_f32_dpp v44, v40, v40 row_ror:1 row_mask:0xf bank_mask:0xf
    v_cndmask_b32 v47, 0, v41, s[20:21]
    s_nop 0
    v_max_f32_dpp v44, v44, v44 row_ror:2 row_mask:0xf bank_mask:0xf
    s_nop 1
    v_max_f32_dpp v44, v44, v44 row_ror:4 row_mask:0xf bank_mask:0xf
    v_mov_b32 v45, v44
    s_nop 1
    v_permlane16_swap_b32 v44, v45
    v_max_f32 v44, v44, v45
    v_mov_b32 v45, v44
    s_nop 1
    v_permlane32_swap_b32 v44, v45
    v_max_f32 v44, v44, v45
    v_sub_f32 v45, v40, v44
    v_mul_f32 v45, s97, v45
    v_exp_f32 v45, v45
    s_nop 0
    v_cvt_pk_bf16_f32 v46, v45, v45
    v_and_b32 v45, s98, v46
    v_mul_f32 v47, v47, v45
    v_and_b32_dpp v232, v46, v8 row_newbcast:0 row_mask:0xf bank_mask:0xf
    v_and_b32_dpp v233, v46, v9 row_newbcast:0 row_mask:0xf bank_mask:0xf
    v_add_f32_dpp v47, v47, v47 row_ror:1 row_mask:0xf bank_mask:0xf
    v_and_b32_dpp v234, v46, v10 row_newbcast:0 row_mask:0xf bank_mask:0xf
    v_and_b32_dpp v235, v46, v11 row_newbcast:0 row_mask:0xf bank_mask:0xf
    v_and_b32_dpp v236, v46, v8 row_newbcast:1 row_mask:0xf bank_mask:0xf
    v_and_b32_dpp v237, v46, v9 row_newbcast:1 row_mask:0xf bank_mask:0xf
    v_add_f32_dpp v47, v47, v47 row_ror:2 row_mask:0xf bank_mask:0xf
    v_and_b32_dpp v238, v46, v10 row_newbcast:1 row_mask:0xf bank_mask:0xf
    v_and_b32_dpp v239, v46, v11 row_newbcast:1 row_mask:0xf bank_mask:0xf
    v_mfma_f32_16x16x32_bf16 v[228:231], v[232:235], v[192:195], 0
    v_and_b32_dpp v240, v46, v8 row_newbcast:2 row_mask:0xf bank_mask:0xf
    v_add_f32_dpp v47, v47, v47 row_ror:4 row_mask:0xf bank_mask:0xf
    v_and_b32_dpp v241, v46, v9 row_newbcast:2 row_mask:0xf bank_mask:0xf
    v_and_b32_dpp v242, v46, v10 row_newbcast:2 row_mask:0xf bank_mask:0xf
    v_and_b32_dpp v243, v46, v11 row_newbcast:2 row_mask:0xf bank_mask:0xf
    v_mfma_f32_16x16x32_bf16 v[228:231], v[236:239], v[196:199], v[228:231]
    v_mov_b32 v45, v47
    v_and_b32_dpp v244, v46, v8 row_newbcast:3 row_mask:0xf bank_mask:0xf
    v_and_b32_dpp v245, v46, v9 row_newbcast:3 row_mask:0xf bank_mask:0xf
    v_and_b32_dpp v246, v46, v10 row_newbcast:3 row_mask:0xf bank_mask:0xf
    v_and_b32_dpp v247, v46, v11 row_newbcast:3 row_mask:0xf bank_mask:0xf
    v_permlane16_swap_b32 v47, v45
    v_mfma_f32_16x16x32_bf16 v[228:231], v[240:243], v[200:203], v[228:231]
    v_and_b32_dpp v248, v46, v8 row_newbcast:4 row_mask:0xf bank_mask:0xf
    v_and_b32_dpp v249, v46, v9 row_newbcast:4 row_mask:0xf bank_mask:0xf
    v_and_b32_dpp v250, v46, v10 row_newbcast:4 row_mask:0xf bank_mask:0xf
    v_add_f32 v47, v47, v45
    v_and_b32_dpp v251, v46, v11 row_newbcast:4 row_mask:0xf bank_mask:0xf
    v_mfma_f32_16x16x32_bf16 v[228:231], v[244:247], v[204:207], v[228:231]
    v_and_b32_dpp v252, v46, v8 row_newbcast:5 row_mask:0xf bank_mask:0xf
    v_and_b32_dpp v253, v46, v9 row_newbcast:5 row_mask:0xf bank_mask:0xf
    v_mov_b32 v45, v47
    v_and_b32_dpp v254, v46, v10 row_newbcast:5 row_mask:0xf bank_mask:0xf
    v_and_b32_dpp v255, v46, v11 row_newbcast:5 row_mask:0xf bank_mask:0xf
    v_mfma_f32_16x16x32_bf16 v[228:231], v[248:251], v[208:211], v[228:231]
    v_permlane32_swap_b32 v47, v45
    v_add_f32 v47, v47, v45
    v_mfma_f32_16x16x32_bf16 v[228:231], v[252:255], v[212:215], v[228:231]
    v_rcp_f32 v47, v47
    s_nop 6
    v_mul_f32 v228, v228, v47
    v_mul_f32 v229, v229, v47
    v_mul_f32 v230, v230, v47
    v_mul_f32 v231, v231, v47
    v_cvt_pk_bf16_f32 v224, v228, v229
    v_cvt_pk_bf16_f32 v225, v230, v231
L_emerged:
    ds_write_b64 v5, v[224:225]
    s_cmp_eq_u32 s3, 3
    s_waitcnt lgkmcnt(0)
    s_barrier
    s_cbranch_scc1 L_eendA
    ds_read_b128 v[48:51], v7 offset:0
    ds_read_b128 v[52:55], v7 offset:128
    s_waitcnt lgkmcnt(1)
    v_mfma_f32_16x16x32_bf16 v[224:227], v[48:51], v[64:67], 0
    v_mfma_f32_16x16x32_bf16 v[228:231], v[48:51], v[68:71], 0
    v_mfma_f32_16x16x32_bf16 v[232:235], v[48:51], v[72:75], 0
    v_mfma_f32_16x16x32_bf16 v[236:239], v[48:51], v[76:79], 0
    v_mfma_f32_16x16x32_bf16 v[240:243], v[48:51], v[80:83], 0
    v_mfma_f32_16x16x32_bf16 v[244:247], v[48:51], v[84:87], 0
    v_mfma_f32_16x16x32_bf16 v[248:251], v[48:51], v[88:91], 0
    v_mfma_f32_16x16x32_bf16 v[252:255], v[48:51], v[92:95], 0
    s_waitcnt lgkmcnt(0)
    v_mfma_f32_16x16x32_bf16 v[224:227], v[52:55], v[96:99], v[224:227]
    s_nop 1
    v_mfma_f32_16x16x32_bf16 v[228:231], v[52:55], v[100:103], v[228:231]
    s_nop 1
    v_mfma_f32_16x16x32_bf16 v[232:235], v[52:55], v[104:107], v[232:235]
    s_nop 1
    v_mfma_f32_16x16x32_bf16 v[236:239], v[52:55], v[108:111], v[236:239]
    s_nop 0
    v_add_f32_dpp v56, v225, v224 row_ror:8 row_mask:0xf bank_mask:0x3
    v_mfma_f32_16x16x32_bf16 v[240:243], v[52:55], v[112:115], v[240:243]
    s_nop 0
    v_add_f32_dpp v57, v229, v228 row_ror:8 row_mask:0xf bank_mask:0x3
    v_mfma_f32_16x16x32_bf16 v[244:247], v[52:55], v[116:119], v[244:247]
    s_nop 0
    v_add_f32_dpp v58, v233, v232 row_ror:8 row_mask:0xf bank_mask:0x3
    v_mfma_f32_16x16x32_bf16 v[248:251], v[52:55], v[120:123], v[248:251]
    s_nop 0
    v_add_f32_dpp v59, v237, v236 row_ror:8 row_mask:0xf bank_mask:0x3
    v_mfma_f32_16x16x32_bf16 v[252:255], v[52:55], v[124:127], v[252:255]
    s_nop 0
    v_add_f32_dpp v56, v240, v241 row_ror:8 row_mask:0xf bank_mask:0xc
    v_add_f32_dpp v57, v244, v245 row_ror:8 row_mask:0xf bank_mask:0xc
    v_min_u32 v56, -2, v56
    s_nop 0
    v_add_f32_dpp v58, v248, v249 row_ror:8 row_mask:0xf bank_mask:0xc
    v_min_u32 v57, -2, v57
    s_nop 0
    v_add_f32_dpp v59, v252, v253 row_ror:8 row_mask:0xf bank_mask:0xc
    v_min_u32 v58, -2, v58
    v_min_u32 v59, -2, v59
    buffer_store_dwordx4 v[56:59], v0, s[44:47], s25 offen sc1
L_eendA:
    s_endpgm
L_epiB:
    s_cmp_eq_u32 s3, 3
    s_cbranch_scc1 L_eendB
    v_bfe_u32 v6, v1, 2, 2
    v_lshlrev_b32 v6, 6, v6
    v_and_b32 v5, 48, v1
    v_add_u32 v6, v6, v5
    v_and_b32 v5, 1, v1
    v_lshl_add_u32 v6, v5, 8, v6
    buffer_load_dwordx4 v[48:51], v6, s[44:47], s27 offen offset:0 sc1
    buffer_load_dwordx4 v[52:55], v6, s[44:47], s27 offen offset:512 sc1
    v_and_b32 v3, 15, v1
    v_lshrrev_b32 v4, 4, v1
    s_mov_b32 s60, 0x05040100
    s_mov_b32 s61, 0x07060302
    v_mul_u32_u24 v0, 73728, v4
    v_bfe_u32 v5, v1, 2, 1
    v_lshl_add_u32 v0, v5, 12, v0
    v_and_b32 v5, 3, v1
    v_lshl_add_u32 v0, v5, 5, v0
    v_bfe_u32 v5, v1, 3, 1
    v_lshl_add_u32 v0, v5, 4, v0
    s_waitcnt vmcnt(16)
    v_perm_b32 v64, v132, v128, s60
    v_perm_b32 v68, v132, v128, s61
    v_perm_b32 v72, v133, v129, s60
    v_perm_b32 v76, v133, v129, s61
    v_perm_b32 v80, v134, v130, s60
    v_perm_b32 v84, v134, v130, s61
    v_perm_b32 v88, v135, v131, s60
    v_perm_b32 v92, v135, v131, s61
    s_waitcnt vmcnt(14)
    v_perm_b32 v65, v140, v136, s60
    v_perm_b32 v69, v140, v136, s61
    v_perm_b32 v73, v141, v137, s60
    v_perm_b32 v77, v141, v137, s61
    v_perm_b32 v81, v142, v138, s60
    v_perm_b32 v85, v142, v138, s61
    v_perm_b32 v89, v143, v139, s60
    v_perm_b32 v93, v143, v139, s61
    s_waitcnt vmcnt(12)
    v_perm_b32 v66, v148, v144, s60
    v_perm_b32 v70, v148, v144, s61
    v_perm_b32 v74, v149, v145, s60
    v_perm_b32 v78, v149, v145, s61
    v_perm_b32 v82, v150, v146, s60
    v_perm_b32 v86, v150, v146, s61
    v_perm_b32 v90, v151, v147, s60
    v_perm_b32 v94, v151, v147, s61
    s_waitcnt vmcnt(10)
    v_perm_b32 v67, v156, v152, s60
    v_perm_b32 v71, v156, v152, s61
    v_perm_b32 v75, v157, v153, s60
    v_perm_b32 v79, v157, v153, s61
    v_perm_b32 v83, v158, v154, s60
    v_perm_b32 v87, v158, v154, s61
    v_perm_b32 v91, v159, v155, s60
    v_perm_b32 v95, v159, v155, s61
    s_waitcnt vmcnt(8)
    v_perm_b32 v96, v164, v160, s60
    v_perm_b32 v100, v164, v160, s61
    v_perm_b32 v104, v165, v161, s60
    v_perm_b32 v108, v165, v161, s61
    v_perm_b32 v112, v166, v162, s60
    v_perm_b32 v116, v166, v162, s61
    v_perm_b32 v120, v167, v163, s60
    v_perm_b32 v124, v167, v163, s61
    s_waitcnt vmcnt(6)
    v_perm_b32 v97, v172, v168, s60
    v_perm_b32 v101, v172, v168, s61
    v_perm_b32 v105, v173, v169, s60
    v_perm_b32 v109, v173, v169, s61
    v_perm_b32 v113, v174, v170, s60
    v_perm_b32 v117, v174, v170, s61
    v_perm_b32 v121, v175, v171, s60
    v_perm_b32 v125, v175, v171, s61
    s_waitcnt vmcnt(4)
    v_perm_b32 v98, v180, v176, s60
    v_perm_b32 v102, v180, v176, s61
    v_perm_b32 v106, v181, v177, s60
    v_perm_b32 v110, v181, v177, s61
    v_perm_b32 v114, v182, v178, s60
    v_perm_b32 v118, v182, v178, s61
    v_perm_b32 v122, v183, v179, s60
    v_perm_b32 v126, v183, v179, s61
    s_waitcnt vmcnt(2)
    v_perm_b32 v99, v188, v184, s60
    v_perm_b32 v103, v188, v184, s61
    v_perm_b32 v107, v189, v185, s60
    v_perm_b32 v111, v189, v185, s61
    v_perm_b32 v115, v190, v186, s60
    v_perm_b32 v119, v190, v186, s61
    v_perm_b32 v123, v191, v187, s60
    v_perm_b32 v127, v191, v187, s61
    s_waitcnt vmcnt(0)
    s_branch L_mpoll_14_c
L_mpoll_14:
    s_mov_b64 exec, s[4:5]
    buffer_load_dwordx4 v[48:51], v6, s[44:47], s27 offen offset:0 sc1
    s_mov_b64 exec, s[6:7]
    buffer_load_dwordx4 v[52:55], v6, s[44:47], s27 offen offset:512 sc1
    s_mov_b64 exec, -1
    s_waitcnt vmcnt(0)
L_mpoll_14_c:
    v_max3_u32 v236, v48, v49, v50
    v_max3_u32 v237, v52, v53, v54
    v_max_u32 v236, v236, v51
    v_max_u32 v237, v237, v55
    v_cmp_eq_u32 s[4:5], -1, v236
    v_cmp_eq_u32 s[6:7], -1, v237
    s_nop 0
    s_or_b64 vcc, s[4:5], s[6:7]
    s_cbranch_scc0 L_mpollok_15
    s_sub_u32 s101, s101, 1
    s_cbranch_scc0 L_mpoll_14
    s_mov_b32 s101, 0
L_mpollok_15:
    v_mfma_f32_16x16x32_bf16 v[224:227], v[48:51], v[64:67], 0
    v_mfma_f32_16x16x32_bf16 v[228:231], v[48:51], v[68:71], 0
    v_mfma_f32_16x16x32_bf16 v[232:235], v[48:51], v[72:75], 0
    v_mfma_f32_16x16x32_bf16 v[236:239], v[48:51], v[76:79], 0
    v_mfma_f32_16x16x32_bf16 v[240:243], v[48:51], v[80:83], 0
    v_mfma_f32_16x16x32_bf16 v[244:247], v[48:51], v[84:87], 0
    v_mfma_f32_16x16x32_bf16 v[248:251], v[48:51], v[88:91], 0
    v_mfma_f32_16x16x32_bf16 v[252:255], v[48:51], v[92:95], 0
    v_mfma_f32_16x16x32_bf16 v[224:227], v[52:55], v[96:99], v[224:227]
    s_nop 1
    v_mfma_f32_16x16x32_bf16 v[228:231], v[52:55], v[100:103], v[228:231]
    s_nop 1
    v_mfma_f32_16x16x32_bf16 v[232:235], v[52:55], v[104:107], v[232:235]
    s_nop 1
    v_mfma_f32_16x16x32_bf16 v[236:239], v[52:55], v[108:111], v[236:239]
    s_nop 0
    v_add_f32_dpp v56, v225, v224 row_ror:8 row_mask:0xf bank_mask:0x3
    v_mfma_f32_16x16x32_bf16 v[240:243], v[52:55], v[112:115], v[240:243]
    s_nop 0
    v_add_f32_dpp v57, v229, v228 row_ror:8 row_mask:0xf bank_mask:0x3
    v_mfma_f32_16x16x32_bf16 v[244:247], v[52:55], v[116:119], v[244:247]
    s_nop 0
    v_add_f32_dpp v58, v233, v232 row_ror:8 row_mask:0xf bank_mask:0x3
    v_mfma_f32_16x16x32_bf16 v[248:251], v[52:55], v[120:123], v[248:251]
    s_nop 0
    v_add_f32_dpp v59, v237, v236 row_ror:8 row_mask:0xf bank_mask:0x3
    v_mfma_f32_16x16x32_bf16 v[252:255], v[52:55], v[124:127], v[252:255]
    s_nop 0
    v_add_f32_dpp v56, v240, v241 row_ror:8 row_mask:0xf bank_mask:0xc
    v_add_f32_dpp v57, v244, v245 row_ror:8 row_mask:0xf bank_mask:0xc
    v_min_u32 v56, -2, v56
    s_nop 0
    v_add_f32_dpp v58, v248, v249 row_ror:8 row_mask:0xf bank_mask:0xc
    v_min_u32 v57, -2, v57
    s_nop 0
    v_add_f32_dpp v59, v252, v253 row_ror:8 row_mask:0xf bank_mask:0xc
    v_min_u32 v58, -2, v58
    v_min_u32 v59, -2, v59
    buffer_store_dwordx4 v[56:59], v0, s[44:47], s25 offen sc1
L_eendB:
    s_endpgm
L_aext0:
    s_cmp_lg_u32 s56, 1
    s_cbranch_scc1 L_aext2
    v_dot2_f32_bf16 v20, v96, v4, 0
    v_dot2_f32_bf16 v21, v100, v4, 0
    v_dot2_f32_bf16 v22, v104, v4, 0
    v_dot2_f32_bf16 v23, v108, v4, 0
    v_dot2_f32_bf16 v20, v97, v5, v20
    v_dot2_f32_bf16 v21, v101, v5, v21
    v_dot2_f32_bf16 v22, v105, v5, v22
    v_dot2_f32_bf16 v23, v109, v5, v23
    v_dot2_f32_bf16 v20, v98, v6, v20
    v_dot2_f32_bf16 v21, v102, v6, v21
    v_dot2_f32_bf16 v22, v106, v6, v22
    v_dot2_f32_bf16 v23, v110, v6, v23
    v_dot2_f32_bf16 v20, v99, v7, v20
    v_dot2_f32_bf16 v21, v103, v7, v21
    v_dot2_f32_bf16 v22, v107, v7, v22
    v_dot2_f32_bf16 v23, v111, v7, v23
    v_add_f32_dpp v24, v20, v20 row_ror:8 row_mask:0xf bank_mask:0x3
    s_nop 0
    v_add_f32_dpp v25, v22, v22 row_ror:8 row_mask:0xf bank_mask:0x3
    v_add_f32_dpp v24, v21, v21 row_ror:8 row_mask:0xf bank_mask:0xc
    v_add_f32_dpp v25, v23, v23 row_ror:8 row_mask:0xf bank_mask:0xc
    s_nop 0
    v_add_f32_dpp v26, v24, v24 row_shl:4 row_mask:0xf bank_mask:0x5
    v_add_f32_dpp v26, v25, v25 row_shr:4 row_mask:0xf bank_mask:0xa
    s_nop 1
    v_add_f32_dpp v26, v26, v26 quad_perm:[1,0,3,2] row_mask:0xf bank_mask:0xf
    s_nop 1
    v_add_f32_dpp v26, v26, v26 quad_perm:[2,3,0,1] row_mask:0xf bank_mask:0xf
    v_cvt_pk_bf16_f32 v26, v26, v26
    v_and_b32 v26, s98, v26
    v_mul_f32 v26, s96, v26
    v_cvt_pk_bf16_f32 v26, v26, v26
    v_and_b32 v26, s98, v26
    s_nop 1
    v_max_f32_dpp v27, v26, v26 row_ror:4 row_mask:0xf bank_mask:0xf
    s_nop 1
    v_max_f32_dpp v27, v27, v27 row_ror:8 row_mask:0xf bank_mask:0xf
    v_mov_b32 v28, v27
    s_nop 1
    v_permlane16_swap_b32 v27, v28
    v_max_f32 v27, v27, v28
    v_mov_b32 v28, v27
    s_nop 1
    v_permlane32_swap_b32 v27, v28
    v_max3_f32 v27, v27, v28, v16
    v_sub_f32 v28, v16, v27
    v_sub_f32 v29, v26, v27
    v_mul_f32 v28, s97, v28
    v_mul_f32 v29, s97, v29
    v_exp_f32 v28, v28
    v_exp_f32 v29, v29
    v_mov_b32 v16, v27
    v_fma_f32 v17, v17, v28, v29
    v_cvt_pk_bf16_f32 v29, v29, v29
    v_mul_f32 v12, v12, v28
    v_mul_f32 v13, v13, v28
    v_mul_f32 v14, v14, v28
    v_mul_f32 v15, v15, v28
    v_and_b32_dpp v32, v29, v8 row_newbcast:0 row_mask:0xf bank_mask:0xf
    v_and_b32_dpp v33, v29, v9 row_newbcast:0 row_mask:0xf bank_mask:0xf
    v_and_b32_dpp v34, v29, v10 row_newbcast:0 row_mask:0xf bank_mask:0xf
    v_and_b32_dpp v35, v29, v11 row_newbcast:0 row_mask:0xf bank_mask:0xf
    v_and_b32_dpp v36, v29, v8 row_newbcast:8 row_mask:0xf bank_mask:0xf
    v_and_b32_dpp v37, v29, v9 row_newbcast:8 row_mask:0xf bank_mask:0xf
    v_and_b32_dpp v38, v29, v10 row_newbcast:8 row_mask:0xf bank_mask:0xf
    v_and_b32_dpp v39, v29, v11 row_newbcast:8 row_mask:0xf bank_mask:0xf
    v_and_b32_dpp v40, v29, v8 row_newbcast:4 row_mask:0xf bank_mask:0xf
    v_and_b32_dpp v41, v29, v9 row_newbcast:4 row_mask:0xf bank_mask:0xf
    v_and_b32_dpp v42, v29, v10 row_newbcast:4 row_mask:0xf bank_mask:0xf
    v_and_b32_dpp v43, v29, v11 row_newbcast:4 row_mask:0xf bank_mask:0xf
    v_and_b32_dpp v44, v29, v8 row_newbcast:12 row_mask:0xf bank_mask:0xf
    v_and_b32_dpp v45, v29, v9 row_newbcast:12 row_mask:0xf bank_mask:0xf
    v_and_b32_dpp v46, v29, v10 row_newbcast:12 row_mask:0xf bank_mask:0xf
    v_and_b32_dpp v47, v29, v11 row_newbcast:12 row_mask:0xf bank_mask:0xf
    v_mfma_f32_16x16x32_bf16 v[12:15], v[32:35], a[32:35], v[12:15]
    v_mfma_f32_16x16x32_bf16 v[12:15], v[36:39], a[36:39], v[12:15]
    v_mfma_f32_16x16x32_bf16 v[12:15], v[40:43], a[40:43], v[12:15]
    v_mfma_f32_16x16x32_bf16 v[12:15], v[44:47], a[44:47], v[12:15]
    s_mov_b32 s56, 2
    s_branch L_aback0
L_aext1:
    s_cmp_lg_u32 s56, 2
    s_cbranch_scc1 L_aext3
    v_dot2_f32_bf16 v20, v112, v4, 0
    v_dot2_f32_bf16 v21, v116, v4, 0
    v_dot2_f32_bf16 v22, v120, v4, 0
    v_dot2_f32_bf16 v23, v124, v4, 0
    v_dot2_f32_bf16 v20, v113, v5, v20
    v_dot2_f32_bf16 v21, v117, v5, v21
    v_dot2_f32_bf16 v22, v121, v5, v22
    v_dot2_f32_bf16 v23, v125, v5, v23
    v_dot2_f32_bf16 v20, v114, v6, v20
    v_dot2_f32_bf16 v21, v118, v6, v21
    v_dot2_f32_bf16 v22, v122, v6, v22
    v_dot2_f32_bf16 v23, v126, v6, v23
    v_dot2_f32_bf16 v20, v115, v7, v20
    v_dot2_f32_bf16 v21, v119, v7, v21
    v_dot2_f32_bf16 v22, v123, v7, v22
    v_dot2_f32_bf16 v23, v127, v7, v23
    v_add_f32_dpp v24, v20, v20 row_ror:8 row_mask:0xf bank_mask:0x3
    s_nop 0
    v_add_f32_dpp v25, v22, v22 row_ror:8 row_mask:0xf bank_mask:0x3
    v_add_f32_dpp v24, v21, v21 row_ror:8 row_mask:0xf bank_mask:0xc
    v_add_f32_dpp v25, v23, v23 row_ror:8 row_mask:0xf bank_mask:0xc
    s_nop 0
    v_add_f32_dpp v26, v24, v24 row_shl:4 row_mask:0xf bank_mask:0x5
    v_add_f32_dpp v26, v25, v25 row_shr:4 row_mask:0xf bank_mask:0xa
    s_nop 1
    v_add_f32_dpp v26, v26, v26 quad_perm:[1,0,3,2] row_mask:0xf bank_mask:0xf
    s_nop 1
    v_add_f32_dpp v26, v26, v26 quad_perm:[2,3,0,1] row_mask:0xf bank_mask:0xf
    v_cvt_pk_bf16_f32 v26, v26, v26
    v_and_b32 v26, s98, v26
    v_mul_f32 v26, s96, v26
    v_cvt_pk_bf16_f32 v26, v26, v26
    v_and_b32 v26, s98, v26
    s_nop 1
    v_max_f32_dpp v27, v26, v26 row_ror:4 row_mask:0xf bank_mask:0xf
    s_nop 1
    v_max_f32_dpp v27, v27, v27 row_ror:8 row_mask:0xf bank_mask:0xf
    v_mov_b32 v28, v27
    s_nop 1
    v_permlane16_swap_b32 v27, v28
    v_max_f32 v27, v27, v28
    v_mov_b32 v28, v27
    s_nop 1
    v_permlane32_swap_b32 v27, v28
    v_max3_f32 v27, v27, v28, v16
    v_sub_f32 v28, v16, v27
    v_sub_f32 v29, v26, v27
    v_mul_f32 v28, s97, v28
    v_mul_f32 v29, s97, v29
    v_exp_f32 v28, v28
    v_exp_f32 v29, v29
    v_mov_b32 v16, v27
    v_fma_f32 v17, v17, v28, v29
    v_cvt_pk_bf16_f32 v29, v29, v29
    v_mul_f32 v12, v12, v28
    v_mul_f32 v13, v13, v28
    v_mul_f32 v14, v14, v28
    v_mul_f32 v15, v15, v28
    v_and_b32_dpp v32, v29, v8 row_newbcast:0 row_mask:0xf bank_mask:0xf
    v_and_b32_dpp v33, v29, v9 row_newbcast:0 row_mask:0xf bank_mask:0xf
    v_and_b32_dpp v34, v29, v10 row_newbcast:0 row_mask:0xf bank_mask:0xf
    v_and_b32_dpp v35, v29, v11 row_newbcast:0 row_mask:0xf bank_mask:0xf
    v_and_b32_dpp v36, v29, v8 row_newbcast:8 row_mask:0xf bank_mask:0xf
    v_and_b32_dpp v37, v29, v9 row_newbcast:8 row_mask:0xf bank_mask:0xf
    v_and_b32_dpp v38, v29, v10 row_newbcast:8 row_mask:0xf bank_mask:0xf
    v_and_b32_dpp v39, v29, v11 row_newbcast:8 row_mask:0xf bank_mask:0xf
    v_and_b32_dpp v40, v29, v8 row_newbcast:4 row_mask:0xf bank_mask:0xf
    v_and_b32_dpp v41, v29, v9 row_newbcast:4 row_mask:0xf bank_mask:0xf
    v_and_b32_dpp v42, v29, v10 row_newbcast:4 row_mask:0xf bank_mask:0xf
    v_and_b32_dpp v43, v29, v11 row_newbcast:4 row_mask:0xf bank_mask:0xf
    v_and_b32_dpp v44, v29, v8 row_newbcast:12 row_mask:0xf bank_mask:0xf
    v_and_b32_dpp v45, v29, v9 row_newbcast:12 row_mask:0xf bank_mask:0xf
    v_and_b32_dpp v46, v29, v10 row_newbcast:12 row_mask:0xf bank_mask:0xf
    v_and_b32_dpp v47, v29, v11 row_newbcast:12 row_mask:0xf bank_mask:0xf
    v_mfma_f32_16x16x32_bf16 v[12:15], v[32:35], a[48:51], v[12:15]
    v_mfma_f32_16x16x32_bf16 v[12:15], v[36:39], a[52:55], v[12:15]
    v_mfma_f32_16x16x32_bf16 v[12:15], v[40:43], a[56:59], v[12:15]
    v_mfma_f32_16x16x32_bf16 v[12:15], v[44:47], a[60:63], v[12:15]
    s_mov_b32 s56, 3
    s_branch L_aback1
L_aext2:
    s_cmp_lg_u32 s56, 3
    s_cbranch_scc1 L_aext4
    v_dot2_f32_bf16 v20, v128, v4, 0
    v_dot2_f32_bf16 v21, v132, v4, 0
    v_dot2_f32_bf16 v22, v136, v4, 0
    v_dot2_f32_bf16 v23, v140, v4, 0
    v_dot2_f32_bf16 v20, v129, v5, v20
    v_dot2_f32_bf16 v21, v133, v5, v21
    v_dot2_f32_bf16 v22, v137, v5, v22
    v_dot2_f32_bf16 v23, v141, v5, v23
    v_dot2_f32_bf16 v20, v130, v6, v20
    v_dot2_f32_bf16 v21, v134, v6, v21
    v_dot2_f32_bf16 v22, v138, v6, v22
    v_dot2_f32_bf16 v23, v142, v6, v23
    v_dot2_f32_bf16 v20, v131, v7, v20
    v_dot2_f32_bf16 v21, v135, v7, v21
    v_dot2_f32_bf16 v22, v139, v7, v22
    v_dot2_f32_bf16 v23, v143, v7, v23
    v_add_f32_dpp v24, v20, v20 row_ror:8 row_mask:0xf bank_mask:0x3
    s_nop 0
    v_add_f32_dpp v25, v22, v22 row_ror:8 row_mask:0xf bank_mask:0x3
    v_add_f32_dpp v24, v21, v21 row_ror:8 row_mask:0xf bank_mask:0xc
    v_add_f32_dpp v25, v23, v23 row_ror:8 row_mask:0xf bank_mask:0xc
    s_nop 0
    v_add_f32_dpp v26, v24, v24 row_shl:4 row_mask:0xf bank_mask:0x5
    v_add_f32_dpp v26, v25, v25 row_shr:4 row_mask:0xf bank_mask:0xa
    s_nop 1
    v_add_f32_dpp v26, v26, v26 quad_perm:[1,0,3,2] row_mask:0xf bank_mask:0xf
    s_nop 1
    v_add_f32_dpp v26, v26, v26 quad_perm:[2,3,0,1] row_mask:0xf bank_mask:0xf
    v_cvt_pk_bf16_f32 v26, v26, v26
    v_and_b32 v26, s98, v26
    v_mul_f32 v26, s96, v26
    v_cvt_pk_bf16_f32 v26, v26, v26
    v_and_b32 v26, s98, v26
    s_nop 1
    v_max_f32_dpp v27, v26, v26 row_ror:4 row_mask:0xf bank_mask:0xf
    s_nop 1
    v_max_f32_dpp v27, v27, v27 row_ror:8 row_mask:0xf bank_mask:0xf
    v_mov_b32 v28, v27
    s_nop 1
    v_permlane16_swap_b32 v27, v28
    v_max_f32 v27, v27, v28
    v_mov_b32 v28, v27
    s_nop 1
    v_permlane32_swap_b32 v27, v28
    v_max3_f32 v27, v27, v28, v16
    v_sub_f32 v28, v16, v27
    v_sub_f32 v29, v26, v27
    v_mul_f32 v28, s97, v28
    v_mul_f32 v29, s97, v29
    v_exp_f32 v28, v28
    v_exp_f32 v29, v29
    v_mov_b32 v16, v27
    v_fma_f32 v17, v17, v28, v29
    v_cvt_pk_bf16_f32 v29, v29, v29
    v_mul_f32 v12, v12, v28
    v_mul_f32 v13, v13, v28
    v_mul_f32 v14, v14, v28
    v_mul_f32 v15, v15, v28
    v_and_b32_dpp v32, v29, v8 row_newbcast:0 row_mask:0xf bank_mask:0xf
    v_and_b32_dpp v33, v29, v9 row_newbcast:0 row_mask:0xf bank_mask:0xf
    v_and_b32_dpp v34, v29, v10 row_newbcast:0 row_mask:0xf bank_mask:0xf
    v_and_b32_dpp v35, v29, v11 row_newbcast:0 row_mask:0xf bank_mask:0xf
    v_and_b32_dpp v36, v29, v8 row_newbcast:8 row_mask:0xf bank_mask:0xf
    v_and_b32_dpp v37, v29, v9 row_newbcast:8 row_mask:0xf bank_mask:0xf
    v_and_b32_dpp v38, v29, v10 row_newbcast:8 row_mask:0xf bank_mask:0xf
    v_and_b32_dpp v39, v29, v11 row_newbcast:8 row_mask:0xf bank_mask:0xf
    v_and_b32_dpp v40, v29, v8 row_newbcast:4 row_mask:0xf bank_mask:0xf
    v_and_b32_dpp v41, v29, v9 row_newbcast:4 row_mask:0xf bank_mask:0xf
    v_and_b32_dpp v42, v29, v10 row_newbcast:4 row_mask:0xf bank_mask:0xf
    v_and_b32_dpp v43, v29, v11 row_newbcast:4 row_mask:0xf bank_mask:0xf
    v_and_b32_dpp v44, v29, v8 row_newbcast:12 row_mask:0xf bank_mask:0xf
    v_and_b32_dpp v45, v29, v9 row_newbcast:12 row_mask:0xf bank_mask:0xf
    v_and_b32_dpp v46, v29, v10 row_newbcast:12 row_mask:0xf bank_mask:0xf
    v_and_b32_dpp v47, v29, v11 row_newbcast:12 row_mask:0xf bank_mask:0xf
    v_mfma_f32_16x16x32_bf16 v[12:15], v[32:35], a[64:67], v[12:15]
    v_mfma_f32_16x16x32_bf16 v[12:15], v[36:39], a[68:71], v[12:15]
    v_mfma_f32_16x16x32_bf16 v[12:15], v[40:43], a[72:75], v[12:15]
    v_mfma_f32_16x16x32_bf16 v[12:15], v[44:47], a[76:79], v[12:15]
    s_mov_b32 s56, 4
    s_branch L_aback0
L_aext3:
    s_cmp_lg_u32 s56, 4
    s_cbranch_scc1 L_aext5
    v_dot2_f32_bf16 v20, v144, v4, 0
    v_dot2_f32_bf16 v21, v148, v4, 0
    v_dot2_f32_bf16 v22, v152, v4, 0
    v_dot2_f32_bf16 v23, v156, v4, 0
    v_dot2_f32_bf16 v20, v145, v5, v20
    v_dot2_f32_bf16 v21, v149, v5, v21
    v_dot2_f32_bf16 v22, v153, v5, v22
    v_dot2_f32_bf16 v23, v157, v5, v23
    v_dot2_f32_bf16 v20, v146, v6, v20
    v_dot2_f32_bf16 v21, v150, v6, v21
    v_dot2_f32_bf16 v22, v154, v6, v22
    v_dot2_f32_bf16 v23, v158, v6, v23
    v_dot2_f32_bf16 v20, v147, v7, v20
    v_dot2_f32_bf16 v21, v151, v7, v21
    v_dot2_f32_bf16 v22, v155, v7, v22
    v_dot2_f32_bf16 v23, v159, v7, v23
    v_add_f32_dpp v24, v20, v20 row_ror:8 row_mask:0xf bank_mask:0x3
    s_nop 0
    v_add_f32_dpp v25, v22, v22 row_ror:8 row_mask:0xf bank_mask:0x3
    v_add_f32_dpp v24, v21, v21 row_ror:8 row_mask:0xf bank_mask:0xc
    v_add_f32_dpp v25, v23, v23 row_ror:8 row_mask:0xf bank_mask:0xc
    s_nop 0
    v_add_f32_dpp v26, v24, v24 row_shl:4 row_mask:0xf bank_mask:0x5
    v_add_f32_dpp v26, v25, v25 row_shr:4 row_mask:0xf bank_mask:0xa
    s_nop 1
    v_add_f32_dpp v26, v26, v26 quad_perm:[1,0,3,2] row_mask:0xf bank_mask:0xf
    s_nop 1
    v_add_f32_dpp v26, v26, v26 quad_perm:[2,3,0,1] row_mask:0xf bank_mask:0xf
    v_cvt_pk_bf16_f32 v26, v26, v26
    v_and_b32 v26, s98, v26
    v_mul_f32 v26, s96, v26
    v_cvt_pk_bf16_f32 v26, v26, v26
    v_and_b32 v26, s98, v26
    s_nop 1
    v_max_f32_dpp v27, v26, v26 row_ror:4 row_mask:0xf bank_mask:0xf
    s_nop 1
    v_max_f32_dpp v27, v27, v27 row_ror:8 row_mask:0xf bank_mask:0xf
    v_mov_b32 v28, v27
    s_nop 1
    v_permlane16_swap_b32 v27, v28
    v_max_f32 v27, v27, v28
    v_mov_b32 v28, v27
    s_nop 1
    v_permlane32_swap_b32 v27, v28
    v_max3_f32 v27, v27, v28, v16
    v_sub_f32 v28, v16, v27
    v_sub_f32 v29, v26, v27
    v_mul_f32 v28, s97, v28
    v_mul_f32 v29, s97, v29
    v_exp_f32 v28, v28
    v_exp_f32 v29, v29
    v_mov_b32 v16, v27
    v_fma_f32 v17, v17, v28, v29
    v_cvt_pk_bf16_f32 v29, v29, v29
    v_mul_f32 v12, v12, v28
    v_mul_f32 v13, v13, v28
    v_mul_f32 v14, v14, v28
    v_mul_f32 v15, v15, v28
    v_and_b32_dpp v32, v29, v8 row_newbcast:0 row_mask:0xf bank_mask:0xf
    v_and_b32_dpp v33, v29, v9 row_newbcast:0 row_mask:0xf bank_mask:0xf
    v_and_b32_dpp v34, v29, v10 row_newbcast:0 row_mask:0xf bank_mask:0xf
    v_and_b32_dpp v35, v29, v11 row_newbcast:0 row_mask:0xf bank_mask:0xf
    v_and_b32_dpp v36, v29, v8 row_newbcast:8 row_mask:0xf bank_mask:0xf
    v_and_b32_dpp v37, v29, v9 row_newbcast:8 row_mask:0xf bank_mask:0xf
    v_and_b32_dpp v38, v29, v10 row_newbcast:8 row_mask:0xf bank_mask:0xf
    v_and_b32_dpp v39, v29, v11 row_newbcast:8 row_mask:0xf bank_mask:0xf
    v_and_b32_dpp v40, v29, v8 row_newbcast:4 row_mask:0xf bank_mask:0xf
    v_and_b32_dpp v41, v29, v9 row_newbcast:4 row_mask:0xf bank_mask:0xf
    v_and_b32_dpp v42, v29, v10 row_newbcast:4 row_mask:0xf bank_mask:0xf
    v_and_b32_dpp v43, v29, v11 row_newbcast:4 row_mask:0xf bank_mask:0xf
    v_and_b32_dpp v44, v29, v8 row_newbcast:12 row_mask:0xf bank_mask:0xf
    v_and_b32_dpp v45, v29, v9 row_newbcast:12 row_mask:0xf bank_mask:0xf
    v_and_b32_dpp v46, v29, v10 row_newbcast:12 row_mask:0xf bank_mask:0xf
    v_and_b32_dpp v47, v29, v11 row_newbcast:12 row_mask:0xf bank_mask:0xf
    v_mfma_f32_16x16x32_bf16 v[12:15], v[32:35], a[80:83], v[12:15]
    v_mfma_f32_16x16x32_bf16 v[12:15], v[36:39], a[84:87], v[12:15]
    v_mfma_f32_16x16x32_bf16 v[12:15], v[40:43], a[88:91], v[12:15]
    v_mfma_f32_16x16x32_bf16 v[12:15], v[44:47], a[92:95], v[12:15]
    s_mov_b32 s56, 5
    s_branch L_aback1
L_aext4:
    s_cmp_lg_u32 s56, 5
    s_cbranch_scc1 L_aext6
    v_dot2_f32_bf16 v20, v160, v4, 0
    v_dot2_f32_bf16 v21, v164, v4, 0
    v_dot2_f32_bf16 v22, v168, v4, 0
    v_dot2_f32_bf16 v23, v172, v4, 0
    v_dot2_f32_bf16 v20, v161, v5, v20
    v_dot2_f32_bf16 v21, v165, v5, v21
    v_dot2_f32_bf16 v22, v169, v5, v22
    v_dot2_f32_bf16 v23, v173, v5, v23
    v_dot2_f32_bf16 v20, v162, v6, v20
    v_dot2_f32_bf16 v21, v166, v6, v21
    v_dot2_f32_bf16 v22, v170, v6, v22
    v_dot2_f32_bf16 v23, v174, v6, v23
    v_dot2_f32_bf16 v20, v163, v7, v20
    v_dot2_f32_bf16 v21, v167, v7, v21
    v_dot2_f32_bf16 v22, v171, v7, v22
    v_dot2_f32_bf16 v23, v175, v7, v23
    v_add_f32_dpp v24, v20, v20 row_ror:8 row_mask:0xf bank_mask:0x3
    s_nop 0
    v_add_f32_dpp v25, v22, v22 row_ror:8 row_mask:0xf bank_mask:0x3
    v_add_f32_dpp v24, v21, v21 row_ror:8 row_mask:0xf bank_mask:0xc
    v_add_f32_dpp v25, v23, v23 row_ror:8 row_mask:0xf bank_mask:0xc
    s_nop 0
    v_add_f32_dpp v26, v24, v24 row_shl:4 row_mask:0xf bank_mask:0x5
    v_add_f32_dpp v26, v25, v25 row_shr:4 row_mask:0xf bank_mask:0xa
    s_nop 1
    v_add_f32_dpp v26, v26, v26 quad_perm:[1,0,3,2] row_mask:0xf bank_mask:0xf
    s_nop 1
    v_add_f32_dpp v26, v26, v26 quad_perm:[2,3,0,1] row_mask:0xf bank_mask:0xf
    v_cvt_pk_bf16_f32 v26, v26, v26
    v_and_b32 v26, s98, v26
    v_mul_f32 v26, s96, v26
    v_cvt_pk_bf16_f32 v26, v26, v26
    v_and_b32 v26, s98, v26
    s_nop 1
    v_max_f32_dpp v27, v26, v26 row_ror:4 row_mask:0xf bank_mask:0xf
    s_nop 1
    v_max_f32_dpp v27, v27, v27 row_ror:8 row_mask:0xf bank_mask:0xf
    v_mov_b32 v28, v27
    s_nop 1
    v_permlane16_swap_b32 v27, v28
    v_max_f32 v27, v27, v28
    v_mov_b32 v28, v27
    s_nop 1
    v_permlane32_swap_b32 v27, v28
    v_max3_f32 v27, v27, v28, v16
    v_sub_f32 v28, v16, v27
    v_sub_f32 v29, v26, v27
    v_mul_f32 v28, s97, v28
    v_mul_f32 v29, s97, v29
    v_exp_f32 v28, v28
    v_exp_f32 v29, v29
    v_mov_b32 v16, v27
    v_fma_f32 v17, v17, v28, v29
    v_cvt_pk_bf16_f32 v29, v29, v29
    v_mul_f32 v12, v12, v28
    v_mul_f32 v13, v13, v28
    v_mul_f32 v14, v14, v28
    v_mul_f32 v15, v15, v28
    v_and_b32_dpp v32, v29, v8 row_newbcast:0 row_mask:0xf bank_mask:0xf
    v_and_b32_dpp v33, v29, v9 row_newbcast:0 row_mask:0xf bank_mask:0xf
    v_and_b32_dpp v34, v29, v10 row_newbcast:0 row_mask:0xf bank_mask:0xf
    v_and_b32_dpp v35, v29, v11 row_newbcast:0 row_mask:0xf bank_mask:0xf
    v_and_b32_dpp v36, v29, v8 row_newbcast:8 row_mask:0xf bank_mask:0xf
    v_and_b32_dpp v37, v29, v9 row_newbcast:8 row_mask:0xf bank_mask:0xf
    v_and_b32_dpp v38, v29, v10 row_newbcast:8 row_mask:0xf bank_mask:0xf
    v_and_b32_dpp v39, v29, v11 row_newbcast:8 row_mask:0xf bank_mask:0xf
    v_and_b32_dpp v40, v29, v8 row_newbcast:4 row_mask:0xf bank_mask:0xf
    v_and_b32_dpp v41, v29, v9 row_newbcast:4 row_mask:0xf bank_mask:0xf
    v_and_b32_dpp v42, v29, v10 row_newbcast:4 row_mask:0xf bank_mask:0xf
    v_and_b32_dpp v43, v29, v11 row_newbcast:4 row_mask:0xf bank_mask:0xf
    v_and_b32_dpp v44, v29, v8 row_newbcast:12 row_mask:0xf bank_mask:0xf
    v_and_b32_dpp v45, v29, v9 row_newbcast:12 row_mask:0xf bank_mask:0xf
    v_and_b32_dpp v46, v29, v10 row_newbcast:12 row_mask:0xf bank_mask:0xf
    v_and_b32_dpp v47, v29, v11 row_newbcast:12 row_mask:0xf bank_mask:0xf
    v_mfma_f32_16x16x32_bf16 v[12:15], v[32:35], a[96:99], v[12:15]
    v_mfma_f32_16x16x32_bf16 v[12:15], v[36:39], a[100:103], v[12:15]
    v_mfma_f32_16x16x32_bf16 v[12:15], v[40:43], a[104:107], v[12:15]
    v_mfma_f32_16x16x32_bf16 v[12:15], v[44:47], a[108:111], v[12:15]
    s_mov_b32 s56, 6
    s_branch L_aback0
L_aext5:
    s_cmp_lg_u32 s56, 6
    s_cbranch_scc1 L_aext7
    v_dot2_f32_bf16 v20, v176, v4, 0
    v_dot2_f32_bf16 v21, v180, v4, 0
    v_dot2_f32_bf16 v22, v184, v4, 0
    v_dot2_f32_bf16 v23, v188, v4, 0
    v_dot2_f32_bf16 v20, v177, v5, v20
    v_dot2_f32_bf16 v21, v181, v5, v21
    v_dot2_f32_bf16 v22, v185, v5, v22
    v_dot2_f32_bf16 v23, v189, v5, v23
    v_dot2_f32_bf16 v20, v178, v6, v20
    v_dot2_f32_bf16 v21, v182, v6, v21
    v_dot2_f32_bf16 v22, v186, v6, v22
    v_dot2_f32_bf16 v23, v190, v6, v23
    v_dot2_f32_bf16 v20, v179, v7, v20
    v_dot2_f32_bf16 v21, v183, v7, v21
    v_dot2_f32_bf16 v22, v187, v7, v22
    v_dot2_f32_bf16 v23, v191, v7, v23
    v_add_f32_dpp v24, v20, v20 row_ror:8 row_mask:0xf bank_mask:0x3
    s_nop 0
    v_add_f32_dpp v25, v22, v22 row_ror:8 row_mask:0xf bank_mask:0x3
    v_add_f32_dpp v24, v21, v21 row_ror:8 row_mask:0xf bank_mask:0xc
    v_add_f32_dpp v25, v23, v23 row_ror:8 row_mask:0xf bank_mask:0xc
    s_nop 0
    v_add_f32_dpp v26, v24, v24 row_shl:4 row_mask:0xf bank_mask:0x5
    v_add_f32_dpp v26, v25, v25 row_shr:4 row_mask:0xf bank_mask:0xa
    s_nop 1
    v_add_f32_dpp v26, v26, v26 quad_perm:[1,0,3,2] row_mask:0xf bank_mask:0xf
    s_nop 1
    v_add_f32_dpp v26, v26, v26 quad_perm:[2,3,0,1] row_mask:0xf bank_mask:0xf
    v_cvt_pk_bf16_f32 v26, v26, v26
    v_and_b32 v26, s98, v26
    v_mul_f32 v26, s96, v26
    v_cvt_pk_bf16_f32 v26, v26, v26
    v_and_b32 v26, s98, v26
    s_nop 1
    v_max_f32_dpp v27, v26, v26 row_ror:4 row_mask:0xf bank_mask:0xf
    s_nop 1
    v_max_f32_dpp v27, v27, v27 row_ror:8 row_mask:0xf bank_mask:0xf
    v_mov_b32 v28, v27
    s_nop 1
    v_permlane16_swap_b32 v27, v28
    v_max_f32 v27, v27, v28
    v_mov_b32 v28, v27
    s_nop 1
    v_permlane32_swap_b32 v27, v28
    v_max3_f32 v27, v27, v28, v16
    v_sub_f32 v28, v16, v27
    v_sub_f32 v29, v26, v27
    v_mul_f32 v28, s97, v28
    v_mul_f32 v29, s97, v29
    v_exp_f32 v28, v28
    v_exp_f32 v29, v29
    v_mov_b32 v16, v27
    v_fma_f32 v17, v17, v28, v29
    v_cvt_pk_bf16_f32 v29, v29, v29
    v_mul_f32 v12, v12, v28
    v_mul_f32 v13, v13, v28
    v_mul_f32 v14, v14, v28
    v_mul_f32 v15, v15, v28
    v_and_b32_dpp v32, v29, v8 row_newbcast:0 row_mask:0xf bank_mask:0xf
    v_and_b32_dpp v33, v29, v9 row_newbcast:0 row_mask:0xf bank_mask:0xf
    v_and_b32_dpp v34, v29, v10 row_newbcast:0 row_mask:0xf bank_mask:0xf
    v_and_b32_dpp v35, v29, v11 row_newbcast:0 row_mask:0xf bank_mask:0xf
    v_and_b32_dpp v36, v29, v8 row_newbcast:8 row_mask:0xf bank_mask:0xf
    v_and_b32_dpp v37, v29, v9 row_newbcast:8 row_mask:0xf bank_mask:0xf
    v_and_b32_dpp v38, v29, v10 row_newbcast:8 row_mask:0xf bank_mask:0xf
    v_and_b32_dpp v39, v29, v11 row_newbcast:8 row_mask:0xf bank_mask:0xf
    v_and_b32_dpp v40, v29, v8 row_newbcast:4 row_mask:0xf bank_mask:0xf
    v_and_b32_dpp v41, v29, v9 row_newbcast:4 row_mask:0xf bank_mask:0xf
    v_and_b32_dpp v42, v29, v10 row_newbcast:4 row_mask:0xf bank_mask:0xf
    v_and_b32_dpp v43, v29, v11 row_newbcast:4 row_mask:0xf bank_mask:0xf
    v_and_b32_dpp v44, v29, v8 row_newbcast:12 row_mask:0xf bank_mask:0xf
    v_and_b32_dpp v45, v29, v9 row_newbcast:12 row_mask:0xf bank_mask:0xf
    v_and_b32_dpp v46, v29, v10 row_newbcast:12 row_mask:0xf bank_mask:0xf
    v_and_b32_dpp v47, v29, v11 row_newbcast:12 row_mask:0xf bank_mask:0xf
    v_mfma_f32_16x16x32_bf16 v[12:15], v[32:35], a[112:115], v[12:15]
    v_mfma_f32_16x16x32_bf16 v[12:15], v[36:39], a[116:119], v[12:15]
    v_mfma_f32_16x16x32_bf16 v[12:15], v[40:43], a[120:123], v[12:15]
    v_mfma_f32_16x16x32_bf16 v[12:15], v[44:47], a[124:127], v[12:15]
    s_mov_b32 s56, 7
    s_branch L_aback1
L_aext6:
    s_cmp_lg_u32 s56, 7
    s_cbranch_scc1 L_aext8
    v_dot2_f32_bf16 v20, v192, v4, 0
    v_dot2_f32_bf16 v21, v196, v4, 0
    v_dot2_f32_bf16 v22, v200, v4, 0
    v_dot2_f32_bf16 v23, v204, v4, 0
    v_dot2_f32_bf16 v20, v193, v5, v20
    v_dot2_f32_bf16 v21, v197, v5, v21
    v_dot2_f32_bf16 v22, v201, v5, v22
    v_dot2_f32_bf16 v23, v205, v5, v23
    v_dot2_f32_bf16 v20, v194, v6, v20
    v_dot2_f32_bf16 v21, v198, v6, v21
    v_dot2_f32_bf16 v22, v202, v6, v22
    v_dot2_f32_bf16 v23, v206, v6, v23
    v_dot2_f32_bf16 v20, v195, v7, v20
    v_dot2_f32_bf16 v21, v199, v7, v21
    v_dot2_f32_bf16 v22, v203, v7, v22
    v_dot2_f32_bf16 v23, v207, v7, v23
    v_add_f32_dpp v24, v20, v20 row_ror:8 row_mask:0xf bank_mask:0x3
    s_nop 0
    v_add_f32_dpp v25, v22, v22 row_ror:8 row_mask:0xf bank_mask:0x3
    v_add_f32_dpp v24, v21, v21 row_ror:8 row_mask:0xf bank_mask:0xc
    v_add_f32_dpp v25, v23, v23 row_ror:8 row_mask:0xf bank_mask:0xc
    s_nop 0
    v_add_f32_dpp v26, v24, v24 row_shl:4 row_mask:0xf bank_mask:0x5
    v_add_f32_dpp v26, v25, v25 row_shr:4 row_mask:0xf bank_mask:0xa
    s_nop 1
    v_add_f32_dpp v26, v26, v26 quad_perm:[1,0,3,2] row_mask:0xf bank_mask:0xf
    s_nop 1
    v_add_f32_dpp v26, v26, v26 quad_perm:[2,3,0,1] row_mask:0xf bank_mask:0xf
    v_cvt_pk_bf16_f32 v26, v26, v26
    v_and_b32 v26, s98, v26
    v_mul_f32 v26, s96, v26
    v_cvt_pk_bf16_f32 v26, v26, v26
    v_and_b32 v26, s98, v26
    s_nop 1
    v_max_f32_dpp v27, v26, v26 row_ror:4 row_mask:0xf bank_mask:0xf
    s_nop 1
    v_max_f32_dpp v27, v27, v27 row_ror:8 row_mask:0xf bank_mask:0xf
    v_mov_b32 v28, v27
    s_nop 1
    v_permlane16_swap_b32 v27, v28
    v_max_f32 v27, v27, v28
    v_mov_b32 v28, v27
    s_nop 1
    v_permlane32_swap_b32 v27, v28
    v_max3_f32 v27, v27, v28, v16
    v_sub_f32 v28, v16, v27
    v_sub_f32 v29, v26, v27
    v_mul_f32 v28, s97, v28
    v_mul_f32 v29, s97, v29
    v_exp_f32 v28, v28
    v_exp_f32 v29, v29
    v_mov_b32 v16, v27
    v_fma_f32 v17, v17, v28, v29
    v_cvt_pk_bf16_f32 v29, v29, v29
    v_mul_f32 v12, v12, v28
    v_mul_f32 v13, v13, v28
    v_mul_f32 v14, v14, v28
    v_mul_f32 v15, v15, v28
    v_and_b32_dpp v32, v29, v8 row_newbcast:0 row_mask:0xf bank_mask:0xf
    v_and_b32_dpp v33, v29, v9 row_newbcast:0 row_mask:0xf bank_mask:0xf
    v_and_b32_dpp v34, v29, v10 row_newbcast:0 row_mask:0xf bank_mask:0xf
    v_and_b32_dpp v35, v29, v11 row_newbcast:0 row_mask:0xf bank_mask:0xf
    v_and_b32_dpp v36, v29, v8 row_newbcast:8 row_mask:0xf bank_mask:0xf
    v_and_b32_dpp v37, v29, v9 row_newbcast:8 row_mask:0xf bank_mask:0xf
    v_and_b32_dpp v38, v29, v10 row_newbcast:8 row_mask:0xf bank_mask:0xf
    v_and_b32_dpp v39, v29, v11 row_newbcast:8 row_mask:0xf bank_mask:0xf
    v_and_b32_dpp v40, v29, v8 row_newbcast:4 row_mask:0xf bank_mask:0xf
    v_and_b32_dpp v41, v29, v9 row_newbcast:4 row_mask:0xf bank_mask:0xf
    v_and_b32_dpp v42, v29, v10 row_newbcast:4 row_mask:0xf bank_mask:0xf
    v_and_b32_dpp v43, v29, v11 row_newbcast:4 row_mask:0xf bank_mask:0xf
    v_and_b32_dpp v44, v29, v8 row_newbcast:12 row_mask:0xf bank_mask:0xf
    v_and_b32_dpp v45, v29, v9 row_newbcast:12 row_mask:0xf bank_mask:0xf
    v_and_b32_dpp v46, v29, v10 row_newbcast:12 row_mask:0xf bank_mask:0xf
    v_and_b32_dpp v47, v29, v11 row_newbcast:12 row_mask:0xf bank_mask:0xf
    v_mfma_f32_16x16x32_bf16 v[12:15], v[32:35], a[128:131], v[12:15]
    v_mfma_f32_16x16x32_bf16 v[12:15], v[36:39], a[132:135], v[12:15]
    v_mfma_f32_16x16x32_bf16 v[12:15], v[40:43], a[136:139], v[12:15]
    v_mfma_f32_16x16x32_bf16 v[12:15], v[44:47], a[140:143], v[12:15]
    s_mov_b32 s56, 8
    s_branch L_aback0
L_aext7:
    s_cmp_lg_u32 s56, 8
    s_cbranch_scc1 L_aext9
    v_dot2_f32_bf16 v20, v208, v4, 0
    v_dot2_f32_bf16 v21, v212, v4, 0
    v_dot2_f32_bf16 v22, v216, v4, 0
    v_dot2_f32_bf16 v23, v220, v4, 0
    v_dot2_f32_bf16 v20, v209, v5, v20
    v_dot2_f32_bf16 v21, v213, v5, v21
    v_dot2_f32_bf16 v22, v217, v5, v22
    v_dot2_f32_bf16 v23, v221, v5, v23
    v_dot2_f32_bf16 v20, v210, v6, v20
    v_dot2_f32_bf16 v21, v214, v6, v21
    v_dot2_f32_bf16 v22, v218, v6, v22
    v_dot2_f32_bf16 v23, v222, v6, v23
    v_dot2_f32_bf16 v20, v211, v7, v20
    v_dot2_f32_bf16 v21, v215, v7, v21
    v_dot2_f32_bf16 v22, v219, v7, v22
    v_dot2_f32_bf16 v23, v223, v7, v23
    v_add_f32_dpp v24, v20, v20 row_ror:8 row_mask:0xf bank_mask:0x3
    s_nop 0
    v_add_f32_dpp v25, v22, v22 row_ror:8 row_mask:0xf bank_mask:0x3
    v_add_f32_dpp v24, v21, v21 row_ror:8 row_mask:0xf bank_mask:0xc
    v_add_f32_dpp v25, v23, v23 row_ror:8 row_mask:0xf bank_mask:0xc
    s_nop 0
    v_add_f32_dpp v26, v24, v24 row_shl:4 row_mask:0xf bank_mask:0x5
    v_add_f32_dpp v26, v25, v25 row_shr:4 row_mask:0xf bank_mask:0xa
    s_nop 1
    v_add_f32_dpp v26, v26, v26 quad_perm:[1,0,3,2] row_mask:0xf bank_mask:0xf
    s_nop 1
    v_add_f32_dpp v26, v26, v26 quad_perm:[2,3,0,1] row_mask:0xf bank_mask:0xf
    v_cvt_pk_bf16_f32 v26, v26, v26
    v_and_b32 v26, s98, v26
    v_mul_f32 v26, s96, v26
    v_cvt_pk_bf16_f32 v26, v26, v26
    v_and_b32 v26, s98, v26
    s_nop 1
    v_max_f32_dpp v27, v26, v26 row_ror:4 row_mask:0xf bank_mask:0xf
    s_nop 1
    v_max_f32_dpp v27, v27, v27 row_ror:8 row_mask:0xf bank_mask:0xf
    v_mov_b32 v28, v27
    s_nop 1
    v_permlane16_swap_b32 v27, v28
    v_max_f32 v27, v27, v28
    v_mov_b32 v28, v27
    s_nop 1
    v_permlane32_swap_b32 v27, v28
    v_max3_f32 v27, v27, v28, v16
    v_sub_f32 v28, v16, v27
    v_sub_f32 v29, v26, v27
    v_mul_f32 v28, s97, v28
    v_mul_f32 v29, s97, v29
    v_exp_f32 v28, v28
    v_exp_f32 v29, v29
    v_mov_b32 v16, v27
    v_fma_f32 v17, v17, v28, v29
    v_cvt_pk_bf16_f32 v29, v29, v29
    v_mul_f32 v12, v12, v28
    v_mul_f32 v13, v13, v28
    v_mul_f32 v14, v14, v28
    v_mul_f32 v15, v15, v28
    v_and_b32_dpp v32, v29, v8 row_newbcast:0 row_mask:0xf bank_mask:0xf
    v_and_b32_dpp v33, v29, v9 row_newbcast:0 row_mask:0xf bank_mask:0xf
    v_and_b32_dpp v34, v29, v10 row_newbcast:0 row_mask:0xf bank_mask:0xf
    v_and_b32_dpp v35, v29, v11 row_newbcast:0 row_mask:0xf bank_mask:0xf
    v_and_b32_dpp v36, v29, v8 row_newbcast:8 row_mask:0xf bank_mask:0xf
    v_and_b32_dpp v37, v29, v9 row_newbcast:8 row_mask:0xf bank_mask:0xf
    v_and_b32_dpp v38, v29, v10 row_newbcast:8 row_mask:0xf bank_mask:0xf
    v_and_b32_dpp v39, v29, v11 row_newbcast:8 row_mask:0xf bank_mask:0xf
    v_and_b32_dpp v40, v29, v8 row_newbcast:4 row_mask:0xf bank_mask:0xf
    v_and_b32_dpp v41, v29, v9 row_newbcast:4 row_mask:0xf bank_mask:0xf
    v_and_b32_dpp v42, v29, v10 row_newbcast:4 row_mask:0xf bank_mask:0xf
    v_and_b32_dpp v43, v29, v11 row_newbcast:4 row_mask:0xf bank_mask:0xf
    v_and_b32_dpp v44, v29, v8 row_newbcast:12 row_mask:0xf bank_mask:0xf
    v_and_b32_dpp v45, v29, v9 row_newbcast:12 row_mask:0xf bank_mask:0xf
    v_and_b32_dpp v46, v29, v10 row_newbcast:12 row_mask:0xf bank_mask:0xf
    v_and_b32_dpp v47, v29, v11 row_newbcast:12 row_mask:0xf bank_mask:0xf
    v_mfma_f32_16x16x32_bf16 v[12:15], v[32:35], a[144:147], v[12:15]
    v_mfma_f32_16x16x32_bf16 v[12:15], v[36:39], a[148:151], v[12:15]
    v_mfma_f32_16x16x32_bf16 v[12:15], v[40:43], a[152:155], v[12:15]
    v_mfma_f32_16x16x32_bf16 v[12:15], v[44:47], a[156:159], v[12:15]
    s_mov_b32 s56, 9
    s_branch L_aback1
L_aext8:
    v_dot2_f32_bf16 v20, v224, v4, 0
    v_dot2_f32_bf16 v21, v228, v4, 0
    v_dot2_f32_bf16 v22, v232, v4, 0
    v_dot2_f32_bf16 v23, v236, v4, 0
    v_dot2_f32_bf16 v20, v225, v5, v20
    v_dot2_f32_bf16 v21, v229, v5, v21
    v_dot2_f32_bf16 v22, v233, v5, v22
    v_dot2_f32_bf16 v23, v237, v5, v23
    v_dot2_f32_bf16 v20, v226, v6, v20
    v_dot2_f32_bf16 v21, v230, v6, v21
    v_dot2_f32_bf16 v22, v234, v6, v22
    v_dot2_f32_bf16 v23, v238, v6, v23
    v_dot2_f32_bf16 v20, v227, v7, v20
    v_dot2_f32_bf16 v21, v231, v7, v21
    v_dot2_f32_bf16 v22, v235, v7, v22
    v_dot2_f32_bf16 v23, v239, v7, v23
    v_add_f32_dpp v24, v20, v20 row_ror:8 row_mask:0xf bank_mask:0x3
    s_nop 0
    v_add_f32_dpp v25, v22, v22 row_ror:8 row_mask:0xf bank_mask:0x3
    v_add_f32_dpp v24, v21, v21 row_ror:8 row_mask:0xf bank_mask:0xc
    v_add_f32_dpp v25, v23, v23 row_ror:8 row_mask:0xf bank_mask:0xc
    s_nop 0
    v_add_f32_dpp v26, v24, v24 row_shl:4 row_mask:0xf bank_mask:0x5
    v_add_f32_dpp v26, v25, v25 row_shr:4 row_mask:0xf bank_mask:0xa
    s_nop 1
    v_add_f32_dpp v26, v26, v26 quad_perm:[1,0,3,2] row_mask:0xf bank_mask:0xf
    s_nop 1
    v_add_f32_dpp v26, v26, v26 quad_perm:[2,3,0,1] row_mask:0xf bank_mask:0xf
    v_cvt_pk_bf16_f32 v26, v26, v26
    v_and_b32 v26, s98, v26
    v_mul_f32 v26, s96, v26
    v_cvt_pk_bf16_f32 v26, v26, v26
    v_and_b32 v26, s98, v26
    s_nop 1
    v_max_f32_dpp v27, v26, v26 row_ror:4 row_mask:0xf bank_mask:0xf
    s_nop 1
    v_max_f32_dpp v27, v27, v27 row_ror:8 row_mask:0xf bank_mask:0xf
    v_mov_b32 v28, v27
    s_nop 1
    v_permlane16_swap_b32 v27, v28
    v_max_f32 v27, v27, v28
    v_mov_b32 v28, v27
    s_nop 1
    v_permlane32_swap_b32 v27, v28
    v_max3_f32 v27, v27, v28, v16
    v_sub_f32 v28, v16, v27
    v_sub_f32 v29, v26, v27
    v_mul_f32 v28, s97, v28
    v_mul_f32 v29, s97, v29
    v_exp_f32 v28, v28
    v_exp_f32 v29, v29
    v_mov_b32 v16, v27
    v_fma_f32 v17, v17, v28, v29
    v_cvt_pk_bf16_f32 v29, v29, v29
    v_mul_f32 v12, v12, v28
    v_mul_f32 v13, v13, v28
    v_mul_f32 v14, v14, v28
    v_mul_f32 v15, v15, v28
    v_and_b32_dpp v32, v29, v8 row_newbcast:0 row_mask:0xf bank_mask:0xf
    v_and_b32_dpp v33, v29, v9 row_newbcast:0 row_mask:0xf bank_mask:0xf
    v_and_b32_dpp v34, v29, v10 row_newbcast:0 row_mask:0xf bank_mask:0xf
    v_and_b32_dpp v35, v29, v11 row_newbcast:0 row_mask:0xf bank_mask:0xf
    v_and_b32_dpp v36, v29, v8 row_newbcast:8 row_mask:0xf bank_mask:0xf
    v_and_b32_dpp v37, v29, v9 row_newbcast:8 row_mask:0xf bank_mask:0xf
    v_and_b32_dpp v38, v29, v10 row_newbcast:8 row_mask:0xf bank_mask:0xf
    v_and_b32_dpp v39, v29, v11 row_newbcast:8 row_mask:0xf bank_mask:0xf
    v_and_b32_dpp v40, v29, v8 row_newbcast:4 row_mask:0xf bank_mask:0xf
    v_and_b32_dpp v41, v29, v9 row_newbcast:4 row_mask:0xf bank_mask:0xf
    v_and_b32_dpp v42, v29, v10 row_newbcast:4 row_mask:0xf bank_mask:0xf
    v_and_b32_dpp v43, v29, v11 row_newbcast:4 row_mask:0xf bank_mask:0xf
    v_and_b32_dpp v44, v29, v8 row_newbcast:12 row_mask:0xf bank_mask:0xf
    v_and_b32_dpp v45, v29, v9 row_newbcast:12 row_mask:0xf bank_mask:0xf
    v_and_b32_dpp v46, v29, v10 row_newbcast:12 row_mask:0xf bank_mask:0xf
    v_and_b32_dpp v47, v29, v11 row_newbcast:12 row_mask:0xf bank_mask:0xf
    v_mfma_f32_16x16x32_bf16 v[12:15], v[32:35], a[160:163], v[12:15]
    v_mfma_f32_16x16x32_bf16 v[12:15], v[36:39], a[164:167], v[12:15]
    v_mfma_f32_16x16x32_bf16 v[12:15], v[40:43], a[168:171], v[12:15]
    v_mfma_f32_16x16x32_bf16 v[12:15], v[44:47], a[172:175], v[12:15]
    s_mov_b32 s56, 10
    s_branch L_aback0
L_aext9:
    v_dot2_f32_bf16 v20, v240, v4, 0
    v_dot2_f32_bf16 v21, v244, v4, 0
    v_dot2_f32_bf16 v22, v248, v4, 0
    v_dot2_f32_bf16 v23, v252, v4, 0
    v_dot2_f32_bf16 v20, v241, v5, v20
    v_dot2_f32_bf16 v21, v245, v5, v21
    v_dot2_f32_bf16 v22, v249, v5, v22
    v_dot2_f32_bf16 v23, v253, v5, v23
    v_dot2_f32_bf16 v20, v242, v6, v20
    v_dot2_f32_bf16 v21, v246, v6, v21
    v_dot2_f32_bf16 v22, v250, v6, v22
    v_dot2_f32_bf16 v23, v254, v6, v23
    v_dot2_f32_bf16 v20, v243, v7, v20
    v_dot2_f32_bf16 v21, v247, v7, v21
    v_dot2_f32_bf16 v22, v251, v7, v22
    v_dot2_f32_bf16 v23, v255, v7, v23
    v_add_f32_dpp v24, v20, v20 row_ror:8 row_mask:0xf bank_mask:0x3
    s_nop 0
    v_add_f32_dpp v25, v22, v22 row_ror:8 row_mask:0xf bank_mask:0x3
    v_add_f32_dpp v24, v21, v21 row_ror:8 row_mask:0xf bank_mask:0xc
    v_add_f32_dpp v25, v23, v23 row_ror:8 row_mask:0xf bank_mask:0xc
    s_nop 0
    v_add_f32_dpp v26, v24, v24 row_shl:4 row_mask:0xf bank_mask:0x5
    v_add_f32_dpp v26, v25, v25 row_shr:4 row_mask:0xf bank_mask:0xa
    s_nop 1
    v_add_f32_dpp v26, v26, v26 quad_perm:[1,0,3,2] row_mask:0xf bank_mask:0xf
    s_nop 1
    v_add_f32_dpp v26, v26, v26 quad_perm:[2,3,0,1] row_mask:0xf bank_mask:0xf
    v_cvt_pk_bf16_f32 v26, v26, v26
    v_and_b32 v26, s98, v26
    v_mul_f32 v26, s96, v26
    v_cvt_pk_bf16_f32 v26, v26, v26
    v_and_b32 v26, s98, v26
    s_nop 1
    v_max_f32_dpp v27, v26, v26 row_ror:4 row_mask:0xf bank_mask:0xf
    s_nop 1
    v_max_f32_dpp v27, v27, v27 row_ror:8 row_mask:0xf bank_mask:0xf
    v_mov_b32 v28, v27
    s_nop 1
    v_permlane16_swap_b32 v27, v28
    v_max_f32 v27, v27, v28
    v_mov_b32 v28, v27
    s_nop 1
    v_permlane32_swap_b32 v27, v28
    v_max3_f32 v27, v27, v28, v16
    v_sub_f32 v28, v16, v27
    v_sub_f32 v29, v26, v27
    v_mul_f32 v28, s97, v28
    v_mul_f32 v29, s97, v29
    v_exp_f32 v28, v28
    v_exp_f32 v29, v29
    v_mov_b32 v16, v27
    v_fma_f32 v17, v17, v28, v29
    v_cvt_pk_bf16_f32 v29, v29, v29
    v_mul_f32 v12, v12, v28
    v_mul_f32 v13, v13, v28
    v_mul_f32 v14, v14, v28
    v_mul_f32 v15, v15, v28
    v_and_b32_dpp v32, v29, v8 row_newbcast:0 row_mask:0xf bank_mask:0xf
    v_and_b32_dpp v33, v29, v9 row_newbcast:0 row_mask:0xf bank_mask:0xf
    v_and_b32_dpp v34, v29, v10 row_newbcast:0 row_mask:0xf bank_mask:0xf
    v_and_b32_dpp v35, v29, v11 row_newbcast:0 row_mask:0xf bank_mask:0xf
    v_and_b32_dpp v36, v29, v8 row_newbcast:8 row_mask:0xf bank_mask:0xf
    v_and_b32_dpp v37, v29, v9 row_newbcast:8 row_mask:0xf bank_mask:0xf
    v_and_b32_dpp v38, v29, v10 row_newbcast:8 row_mask:0xf bank_mask:0xf
    v_and_b32_dpp v39, v29, v11 row_newbcast:8 row_mask:0xf bank_mask:0xf
    v_and_b32_dpp v40, v29, v8 row_newbcast:4 row_mask:0xf bank_mask:0xf
    v_and_b32_dpp v41, v29, v9 row_newbcast:4 row_mask:0xf bank_mask:0xf
    v_and_b32_dpp v42, v29, v10 row_newbcast:4 row_mask:0xf bank_mask:0xf
    v_and_b32_dpp v43, v29, v11 row_newbcast:4 row_mask:0xf bank_mask:0xf
    v_and_b32_dpp v44, v29, v8 row_newbcast:12 row_mask:0xf bank_mask:0xf
    v_and_b32_dpp v45, v29, v9 row_newbcast:12 row_mask:0xf bank_mask:0xf
    v_and_b32_dpp v46, v29, v10 row_newbcast:12 row_mask:0xf bank_mask:0xf
    v_and_b32_dpp v47, v29, v11 row_newbcast:12 row_mask:0xf bank_mask:0xf
    v_mfma_f32_16x16x32_bf16 v[12:15], v[32:35], a[176:179], v[12:15]
    v_mfma_f32_16x16x32_bf16 v[12:15], v[36:39], a[180:183], v[12:15]
    v_mfma_f32_16x16x32_bf16 v[12:15], v[40:43], a[184:187], v[12:15]
    v_mfma_f32_16x16x32_bf16 v[12:15], v[44:47], a[188:191], v[12:15]
    s_mov_b32 s56, 0
    s_branch L_aback1
L_aflag:
    s_sleep 2
    global_load_dword v57, v58, s[28:29] sc1
    s_waitcnt vmcnt(0)
    v_cmp_gt_u32 vcc, 2, v57
    s_cbranch_vccz L_aflag_ok
    s_sub_u32 s101, s101, 1
    s_cbranch_scc0 L_aflag
    s_mov_b32 s101, 0
    s_branch L_aflag_ok
L_roleA_end:
L_roleH:
    s_mov_b32 s101, 100000
    s_getpc_b64 s[56:57]
L_pc_16:
    s_sub_u32 s56, s56, L_pc_16-L_roleH
    s_subb_u32 s57, s57, 0
    v_lshlrev_b32 v5, 7, v0
    v_min_u32 v6, L_roleH_end-L_roleH-4, v5
    global_load_dword v122, v6, s[56:57]
    v_mov_b32 v20, -1
    v_mov_b32 v21, -1
    v_mov_b32 v22, -1
    v_mov_b32 v23, -1
    v_mul_u32_u24 v7, 73728, v4
    v_lshrrev_b32 v5, 3, v3
    v_lshl_add_u32 v6, v5, 13, v7
    v_and_b32 v5, 7, v3
    v_lshl_add_u32 v6, v5, 4, v6
    v_lshl_add_u32 v7, v3, 3, v7
    v_add_u32 v7, 65536, v7
    s_lshl_b32 s56, s52, 7
    s_add_u32 s56, s56, 4718592
    s_lshl_b32 s54, s3, 14
    s_add_u32 s54, s54, s56
    s_add_u32 s55, s54, 4096
    s_and_b32 s57, s3, 1
    s_lshl_b32 s57, s57, 12
    s_add_u32 s56, s56, s57
    s_waitcnt lgkmcnt(0)
    s_mov_b32 s44, s30
    s_mov_b32 s45, s31
    s_mov_b32 s46, 536870912
    s_mov_b32 s47, 0x20000
    buffer_store_dwordx4 v[20:23], v6, s[44:47], s54 offen sc1
    buffer_store_dwordx4 v[20:23], v6, s[44:47], s55 offen sc1
    buffer_store_dwordx2 v[20:21], v7, s[44:47], s56 offen sc1
    v_lshrrev_b32 v5, 2, v3
    v_lshlrev_b32 v5, 15, v5
    v_lshl_add_u32 v5, v4, 4, v5
    v_and_b32 v6, 3, v3
    v_lshl_add_u32 v5, v6, 6, v5
    s_lshl_b32 s54, s52, 10
    s_lshl_b32 s55, s3, 8
    s_add_u32 s54, s54, s55
    s_add_u32 s54, s54, 1048576
    buffer_store_dwordx4 v[20:23], v5, s[44:47], s54 offen sc1
    v_bfe_u32 v6, v1, 2, 2
    v_lshlrev_b32 v6, 6, v6
    v_and_b32 v5, 48, v1
    v_add_u32 v6, v6, v5
    v_and_b32 v5, 3, v1
    v_lshl_add_u32 v6, v5, 29, v6
    s_lshl_b32 s54, s52, 10
    s_lshl_b32 s55, s3, 8
    s_add_u32 s54, s54, s55
    s_add_u32 s54, s54, 5439488
    buffer_store_dwordx4 v[20:23], v6, s[44:47], s54 offen sc1
    v_mov_b32 v7, 536870912
    v_cmp_gt_u32 vcc, 32, v1
    s_nop 1
    v_cndmask_b32 v123, v7, v2, vcc
    s_lshl_b32 s98, s52, 12
    s_lshl_b32 s54, s3, 9
    s_add_u32 s98, s98, s54
    s_add_u32 s98, s98, 5242880
    buffer_store_dwordx4 v[20:23], v123, s[44:47], s98 offen sc1
    s_mov_b32 s40, s10
    s_mov_b32 s41, s11
    s_mov_b32 s42, 4718592
    s_mov_b32 s43, 0x20000
    s_mov_b32 s48, s4
    s_mov_b32 s49, s5
    s_mov_b32 s50, 4608
    s_mov_b32 s51, 0x20000
    v_lshrrev_b32 v5, 3, v3
    v_mul_u32_u24 v5, 1152, v5
    v_mul_u32_u24 v6, 36, v4
    v_add_u32 v5, v5, v6
    s_mul_i32 s54, s3, 144
    buffer_load_dwordx4 v[24:27], v5, s[48:51], s54 offen offset:0
    buffer_load_dwordx4 v[28:31], v5, s[48:51], s54 offen offset:16
    buffer_load_dword v32, v5, s[48:51], s54 offen offset:32
    buffer_load_dwordx4 v[36:39], v5, s[48:51], s54 offen offset:2304
    buffer_load_dwordx4 v[40:43], v5, s[48:51], s54 offen offset:2320
    buffer_load_dword v44, v5, s[48:51], s54 offen offset:2336
    v_mul_u32_u24 v120, 147456, v4
    v_lshl_add_u32 v120, v3, 4, v120
    s_mul_i32 s61, s3, 589824
    s_lshl_b32 s54, s52, 8
    s_add_u32 s61, s61, s54
    buffer_load_dwordx4 a[0:3], v120, s[40:43], s61 offen nt
    s_add_u32 s61, s61, 8192
    buffer_load_dwordx4 a[4:7], v120, s[40:43], s61 offen nt
    s_add_u32 s61, s61, 8192
    buffer_load_dwordx4 a[8:11], v120, s[40:43], s61 offen nt
    s_add_u32 s61, s61, 8192
    buffer_load_dwordx4 a[12:15], v120, s[40:43], s61 offen nt
    s_add_u32 s61, s61, 8192
    buffer_load_dwordx4 a[16:19], v120, s[40:43], s61 offen nt
    s_add_u32 s61, s61, 8192
    buffer_load_dwordx4 a[20:23], v120, s[40:43], s61 offen nt
    s_add_u32 s61, s61, 8192
    buffer_load_dwordx4 a[24:27], v120, s[40:43], s61 offen nt
    s_add_u32 s61, s61, 8192
    buffer_load_dwordx4 a[28:31], v120, s[40:43], s61 offen nt
    s_add_u32 s61, s61, 8192
    buffer_load_dwordx4 a[32:35], v120, s[40:43], s61 offen nt
    s_add_u32 s61, s61, 8192
    buffer_load_dwordx4 a[36:39], v120, s[40:43], s61 offen nt
    s_add_u32 s61, s61, 8192
    buffer_load_dwordx4 a[40:43], v120, s[40:43], s61 offen nt
    s_add_u32 s61, s61, 8192
    buffer_load_dwordx4 a[44:47], v120, s[40:43], s61 offen nt
    s_add_u32 s61, s61, 8192
    buffer_load_dwordx4 a[48:51], v120, s[40:43], s61 offen nt
    s_add_u32 s61, s61, 8192
    buffer_load_dwordx4 a[52:55], v120, s[40:43], s61 offen nt
    s_add_u32 s61, s61, 8192
    buffer_load_dwordx4 a[56:59], v120, s[40:43], s61 offen nt
    s_add_u32 s61, s61, 8192
    buffer_load_dwordx4 a[60:63], v120, s[40:43], s61 offen nt
    s_add_u32 s61, s61, 8192
    buffer_load_dwordx4 a[64:67], v120, s[40:43], s61 offen nt
    s_add_u32 s61, s61, 8192
    buffer_load_dwordx4 a[68:71], v120, s[40:43], s61 offen nt
    s_add_u32 s61, s61, 8192
    s_mov_b32 s32, s18
    s_mov_b32 s33, s19
    s_mov_b32 s34, 4718592
    s_mov_b32 s35, 0x20000
    s_mov_b32 s36, s14
    s_mov_b32 s37, s15
    s_mov_b32 s38, 4608
    s_mov_b32 s39, 0x20000
    v_lshrrev_b32 v5, 3, v3
    v_mul_u32_u24 v5, 1152, v5
    v_mul_u32_u24 v6, 72, v4
    v_add_u32 v5, v5, v6
    s_mul_i32 s54, s3, 288
    buffer_load_dwordx4 v[48:51], v5, s[36:39], s54 offen offset:0
    buffer_load_dwordx4 v[52:55], v5, s[36:39], s54 offen offset:16
    buffer_load_dwordx4 v[56:59], v5, s[36:39], s54 offen offset:32
    buffer_load_dwordx4 v[60:63], v5, s[36:39], s54 offen offset:48
    buffer_load_dwordx2 v[64:65], v5, s[36:39], s54 offen offset:64
    buffer_load_dwordx4 v[68:71], v5, s[36:39], s54 offen offset:2304
    buffer_load_dwordx4 v[72:75], v5, s[36:39], s54 offen offset:2320
    buffer_load_dwordx4 v[76:79], v5, s[36:39], s54 offen offset:2336
    buffer_load_dwordx4 v[80:83], v5, s[36:39], s54 offen offset:2352
    buffer_load_dwordx2 v[84:85], v5, s[36:39], s54 offen offset:2368
    v_mul_u32_u24 v120, 294912, v4
    v_lshl_add_u32 v120, v3, 4, v120
    s_mul_i32 s61, s3, 1179648
    s_lshl_b32 s54, s52, 8
    s_add_u32 s61, s61, s54
    buffer_load_dwordx4 a[112:115], v120, s[32:35], s61 offen nt
    s_add_u32 s61, s61, 8192
    buffer_load_dwordx4 a[116:119], v120, s[32:35], s61 offen nt
    s_add_u32 s61, s61, 8192
    buffer_load_dwordx4 a[120:123], v120, s[32:35], s61 offen nt
    s_add_u32 s61, s61, 8192
    buffer_load_dwordx4 a[124:127], v120, s[32:35], s61 offen nt
    s_add_u32 s61, s61, 8192
    buffer_load_dwordx4 a[128:131], v120, s[32:35], s61 offen nt
    s_add_u32 s61, s61, 8192
    buffer_load_dwordx4 a[132:135], v120, s[32:35], s61 offen nt
    s_add_u32 s61, s61, 8192
    buffer_load_dwordx4 a[136:139], v120, s[32:35], s61 offen nt
    s_add_u32 s61, s61, 8192
    buffer_load_dwordx4 a[140:143], v120, s[32:35], s61 offen nt
    s_add_u32 s61, s61, 8192
    buffer_load_dwordx4 a[144:147], v120, s[32:35], s61 offen nt
    s_add_u32 s61, s61, 8192
    s_mov_b32 s36, s20
    s_mov_b32 s37, s21
    s_mov_b32 s38, 4194304
    s_mov_b32 s39, 0x20000
    s_mov_b32 s40, s22
    s_mov_b32 s41, s23
    s_mov_b32 s42, 4194304
    s_mov_b32 s43, 0x20000
    v_lshlrev_b32 v5, 2, v4
    v_xor_b32 v5, v5, v3
    v_lshlrev_b32 v6, 13, v4
    v_xor_b32 v7, 0, v5
    v_lshl_add_u32 v88, v7, 4, v6
    v_xor_b32 v7, 1, v5
    v_lshl_add_u32 v89, v7, 4, v6
    v_xor_b32 v7, 2, v5
    v_lshl_add_u32 v90, v7, 4, v6
    v_xor_b32 v7, 3, v5
    v_lshl_add_u32 v91, v7, 4, v6
    s_lshl_b32 s62, s3, 20
    s_lshl_b32 s54, s52, 8
    s_add_u32 s62, s62, s54
    s_mov_b32 s60, s62
    s_lshl_b32 s63, s3, 15
    v_lshlrev_b32 v121, 18, v4
    v_lshl_add_u32 v121, v3, 4, v121
    v_lshrrev_b32 v5, 2, v3
    v_and_b32 v6, 3, v3
    v_lshl_add_u32 v7, v5, 3, v6
    v_lshlrev_b32 v92, 8, v7
    v_lshl_or_b32 v5, v6, 2, v5
    v_xor_b32 v5, v5, v4
    v_lshl_add_u32 v92, v5, 4, v92
    v_add_u32 v92, s63, v92
    v_xor_b32 v93, 64, v92
    v_xor_b32 v94, 128, v92
    v_xor_b32 v95, 192, v92
    v_and_b32 v5, 1, v3
    v_cmp_eq_u32 vcc, 1, v5
    v_mov_b32 v5, 0x0c0c0100
    v_mov_b32 v6, 0x01000c0c
    v_cndmask_b32 v5, v5, v6, vcc
    v_mov_b32 v6, 0x0c0c0302
    v_mov_b32 v7, 0x03020c0c
    v_cndmask_b32 v6, v6, v7, vcc
    v_bfe_u32 v7, v3, 1, 2
    v_mov_b32 v16, 0x0c0c0c0c
    v_cmp_eq_u32 vcc, 0, v7
    s_nop 1
    v_cndmask_b32 v8, v16, v5, vcc
    v_cndmask_b32 v9, v16, v6, vcc
    v_cmp_eq_u32 vcc, 1, v7
    s_nop 1
    v_cndmask_b32 v10, v16, v5, vcc
    v_cndmask_b32 v11, v16, v6, vcc
    v_cmp_eq_u32 vcc, 2, v7
    s_nop 1
    v_cndmask_b32 v12, v16, v5, vcc
    v_cndmask_b32 v13, v16, v6, vcc
    v_cmp_eq_u32 vcc, 3, v7
    s_nop 1
    v_cndmask_b32 v14, v16, v5, vcc
    v_cndmask_b32 v15, v16, v6, vcc
    s_waitcnt vmcnt(43)
    s_barrier
    s_cmp_lg_u32 s3, 0
    s_cbranch_scc1 L_nosig_17
    s_lshl_b32 s54, s52, 2
    v_mov_b32 v5, s54
    v_mov_b32 v6, 1
    s_mov_b64 exec, 1
    global_atomic_add v5, v6, s[28:29]
    s_mov_b64 exec, -1
L_nosig_17:
    s_waitcnt vmcnt(28)
    buffer_load_dwordx4 a[148:151], v120, s[32:35], s61 offen nt
    s_add_u32 s61, s61, 8192
    buffer_load_dwordx4 a[152:155], v120, s[32:35], s61 offen nt
    s_add_u32 s61, s61, 8192
    buffer_load_dwordx4 a[156:159], v120, s[32:35], s61 offen nt
    s_add_u32 s61, s61, 8192
    buffer_load_dwordx4 a[160:163], v120, s[32:35], s61 offen nt
    s_add_u32 s61, s61, 8192
    buffer_load_dwordx4 a[164:167], v120, s[32:35], s61 offen nt
    s_add_u32 s61, s61, 8192
    buffer_load_dwordx4 a[168:171], v120, s[32:35], s61 offen nt
    s_add_u32 s61, s61, 8192
    buffer_load_dwordx4 a[172:175], v120, s[32:35], s61 offen nt
    s_add_u32 s61, s61, 8192
    buffer_load_dwordx4 a[176:179], v120, s[32:35], s61 offen nt
    s_add_u32 s61, s61, 8192
    buffer_load_dwordx4 a[180:183], v120, s[32:35], s61 offen nt
    s_add_u32 s61, s61, 8192
    buffer_load_dwordx4 a[184:187], v120, s[32:35], s61 offen nt
    s_add_u32 s61, s61, 8192
    v_perm_b32 v96, v24, v24, v8
    v_perm_b32 v97, v24, v24, v10
    v_perm_b32 v98, v24, v24, v12
    v_perm_b32 v99, v24, v24, v14
    s_nop 1
    v_mfma_f32_16x16x32_bf16 v[112:115], v[96:99], a[0:3], 0
    v_perm_b32 v100, v36, v36, v8
    v_perm_b32 v101, v36, v36, v10
    v_perm_b32 v102, v36, v36, v12
    v_perm_b32 v103, v36, v36, v14
    s_nop 1
    v_mfma_f32_16x16x32_bf16 v[116:119], v[100:103], a[0:3], 0
    v_perm_b32 v104, v24, v24, v9
    v_perm_b32 v105, v24, v24, v11
    v_perm_b32 v106, v24, v24, v13
    v_perm_b32 v107, v24, v24, v15
    s_nop 1
    v_mfma_f32_16x16x32_bf16 v[112:115], v[104:107], a[4:7], v[112:115]
    v_perm_b32 v108, v36, v36, v9
    v_perm_b32 v109, v36, v36, v11
    v_perm_b32 v110, v36, v36, v13
    v_perm_b32 v111, v36, v36, v15
    s_nop 1
    v_mfma_f32_16x16x32_bf16 v[116:119], v[108:111], a[4:7], v[116:119]
    v_perm_b32 v96, v25, v25, v8
    v_perm_b32 v97, v25, v25, v10
    v_perm_b32 v98, v25, v25, v12
    v_perm_b32 v99, v25, v25, v14
    s_nop 1
    v_mfma_f32_16x16x32_bf16 v[112:115], v[96:99], a[8:11], v[112:115]
    v_perm_b32 v100, v37, v37, v8
    v_perm_b32 v101, v37, v37, v10
    v_perm_b32 v102, v37, v37, v12
    v_perm_b32 v103, v37, v37, v14
    s_nop 1
    v_mfma_f32_16x16x32_bf16 v[116:119], v[100:103], a[8:11], v[116:119]
    v_perm_b32 v104, v25, v25, v9
    v_perm_b32 v105, v25, v25, v11
    v_perm_b32 v106, v25, v25, v13
    v_perm_b32 v107, v25, v25, v15
    s_nop 1
    v_mfma_f32_16x16x32_bf16 v[112:115], v[104:107], a[12:15], v[112:115]
    v_perm_b32 v108, v37, v37, v9
    v_perm_b32 v109, v37, v37, v11
    v_perm_b32 v110, v37, v37, v13
    v_perm_b32 v111, v37, v37, v15
    s_nop 1
    v_mfma_f32_16x16x32_bf16 v[116:119], v[108:111], a[12:15], v[116:119]
    v_perm_b32 v96, v26, v26, v8
    v_perm_b32 v97, v26, v26, v10
    v_perm_b32 v98, v26, v26, v12
    v_perm_b32 v99, v26, v26, v14
    s_nop 1
    v_mfma_f32_16x16x32_bf16 v[112:115], v[96:99], a[16:19], v[112:115]
    v_perm_b32 v100, v38, v38, v8
    v_perm_b32 v101, v38, v38, v10
    v_perm_b32 v102, v38, v38, v12
    v_perm_b32 v103, v38, v38, v14
    s_nop 1
    v_mfma_f32_16x16x32_bf16 v[116:119], v[100:103], a[16:19], v[116:119]
    v_perm_b32 v104, v26, v26, v9
    v_perm_b32 v105, v26, v26, v11
    v_perm_b32 v106, v26, v26, v13
    v_perm_b32 v107, v26, v26, v15
    s_nop 1
    v_mfma_f32_16x16x32_bf16 v[112:115], v[104:107], a[20:23], v[112:115]
    v_perm_b32 v108, v38, v38, v9
    v_perm_b32 v109, v38, v38, v11
    v_perm_b32 v110, v38, v38, v13
    v_perm_b32 v111, v38, v38, v15
    s_nop 1
    v_mfma_f32_16x16x32_bf16 v[116:119], v[108:111], a[20:23], v[116:119]
    v_perm_b32 v96, v27, v27, v8
    v_perm_b32 v97, v27, v27, v10
    v_perm_b32 v98, v27, v27, v12
    v_perm_b32 v99, v27, v27, v14
    s_nop 1
    v_mfma_f32_16x16x32_bf16 v[112:115], v[96:99], a[24:27], v[112:115]
    v_perm_b32 v100, v39, v39, v8
    v_perm_b32 v101, v39, v39, v10
    v_perm_b32 v102, v39, v39, v12
    v_perm_b32 v103, v39, v39, v14
    s_nop 1
    v_mfma_f32_16x16x32_bf16 v[116:119], v[100:103], a[24:27], v[116:119]
    v_perm_b32 v104, v27, v27, v9
    v_perm_b32 v105, v27, v27, v11
    v_perm_b32 v106, v27, v27, v13
    v_perm_b32 v107, v27, v27, v15
    s_nop 1
    v_mfma_f32_16x16x32_bf16 v[112:115], v[104:107], a[28:31], v[112:115]
    v_perm_b32 v108, v39, v39, v9
    v_perm_b32 v109, v39, v39, v11
    v_perm_b32 v110, v39, v39, v13
    v_perm_b32 v111, v39, v39, v15
    s_nop 1
    v_mfma_f32_16x16x32_bf16 v[116:119], v[108:111], a[28:31], v[116:119]
    v_perm_b32 v96, v28, v28, v8
    v_perm_b32 v97, v28, v28, v10
    v_perm_b32 v98, v28, v28, v12
    v_perm_b32 v99, v28, v28, v14
    s_nop 1
    v_mfma_f32_16x16x32_bf16 v[112:115], v[96:99], a[32:35], v[112:115]
    v_perm_b32 v100, v40, v40, v8
    v_perm_b32 v101, v40, v40, v10
    v_perm_b32 v102, v40, v40, v12
    v_perm_b32 v103, v40, v40, v14
    s_nop 1
    v_mfma_f32_16x16x32_bf16 v[116:119], v[100:103], a[32:35], v[116:119]
    s_waitcnt vmcnt(29)
    buffer_load_dwordx4 a[188:191], v120, s[32:35], s61 offen nt
    s_add_u32 s61, s61, 8192
    buffer_load_dwordx4 a[192:195], v120, s[32:35], s61 offen nt
    s_add_u32 s61, s61, 8192
    buffer_load_dwordx4 a[196:199], v120, s[32:35], s61 offen nt
    s_add_u32 s61, s61, 8192
    buffer_load_dwordx4 a[200:203], v120, s[32:35], s61 offen nt
    s_add_u32 s61, s61, 8192
    buffer_load_dwordx4 a[204:207], v120, s[32:35], s61 offen nt
    s_add_u32 s61, s61, 8192
    buffer_load_dwordx4 a[208:211], v120, s[32:35], s61 offen nt
    s_add_u32 s61, s61, 8192
    buffer_load_dwordx4 a[212:215], v120, s[32:35], s61 offen nt
    s_add_u32 s61, s61, 8192
    buffer_load_dwordx4 a[216:219], v120, s[32:35], s61 offen nt
    s_add_u32 s61, s61, 8192
    buffer_load_dwordx4 a[220:223], v120, s[32:35], s61 offen nt
    s_add_u32 s61, s61, 8192
    v_perm_b32 v104, v28, v28, v9
    v_perm_b32 v105, v28, v28, v11
    v_perm_b32 v106, v28, v28, v13
    v_perm_b32 v107, v28, v28, v15
    s_nop 1
    v_mfma_f32_16x16x32_bf16 v[112:115], v[104:107], a[36:39], v[112:115]
    v_perm_b32 v108, v40, v40, v9
    v_perm_b32 v109, v40, v40, v11
    v_perm_b32 v110, v40, v40, v13
    v_perm_b32 v111, v40, v40, v15
    s_nop 1
    v_mfma_f32_16x16x32_bf16 v[116:119], v[108:111], a[36:39], v[116:119]
    v_perm_b32 v96, v29, v29, v8
    v_perm_b32 v97, v29, v29, v10
    v_perm_b32 v98, v29, v29, v12
    v_perm_b32 v99, v29, v29, v14
    s_nop 1
    v_mfma_f32_16x16x32_bf16 v[112:115], v[96:99], a[40:43], v[112:115]
    v_perm_b32 v100, v41, v41, v8
    v_perm_b32 v101, v41, v41, v10
    v_perm_b32 v102, v41, v41, v12
    v_perm_b32 v103, v41, v41, v14
    s_nop 1
    v_mfma_f32_16x16x32_bf16 v[116:119], v[100:103], a[40:43], v[116:119]
    v_perm_b32 v104, v29, v29, v9
    v_perm_b32 v105, v29, v29, v11
    v_perm_b32 v106, v29, v29, v13
    v_perm_b32 v107, v29, v29, v15
    s_nop 1
    v_mfma_f32_16x16x32_bf16 v[112:115], v[104:107], a[44:47], v[112:115]
    v_perm_b32 v108, v41, v41, v9
    v_perm_b32 v109, v41, v41, v11
    v_perm_b32 v110, v41, v41, v13
    v_perm_b32 v111, v41, v41, v15
    s_nop 1
    v_mfma_f32_16x16x32_bf16 v[116:119], v[108:111], a[44:47], v[116:119]
    v_perm_b32 v96, v30, v30, v8
    v_perm_b32 v97, v30, v30, v10
    v_perm_b32 v98, v30, v30, v12
    v_perm_b32 v99, v30, v30, v14
    s_nop 1
    v_mfma_f32_16x16x32_bf16 v[112:115], v[96:99], a[48:51], v[112:115]
    v_perm_b32 v100, v42, v42, v8
    v_perm_b32 v101, v42, v42, v10
    v_perm_b32 v102, v42, v42, v12
    v_perm_b32 v103, v42, v42, v14
    s_nop 1
    v_mfma_f32_16x16x32_bf16 v[116:119], v[100:103], a[48:51], v[116:119]
    v_perm_b32 v104, v30, v30, v9
    v_perm_b32 v105, v30, v30, v11
    v_perm_b32 v106, v30, v30, v13
    v_perm_b32 v107, v30, v30, v15
    s_nop 1
    v_mfma_f32_16x16x32_bf16 v[112:115], v[104:107], a[52:55], v[112:115]
    v_perm_b32 v108, v42, v42, v9
    v_perm_b32 v109, v42, v42, v11
    v_perm_b32 v110, v42, v42, v13
    v_perm_b32 v111, v42, v42, v15
    s_nop 1
    v_mfma_f32_16x16x32_bf16 v[116:119], v[108:111], a[52:55], v[116:119]
    v_perm_b32 v96, v31, v31, v8
    v_perm_b32 v97, v31, v31, v10
    v_perm_b32 v98, v31, v31, v12
    v_perm_b32 v99, v31, v31, v14
    s_nop 1
    v_mfma_f32_16x16x32_bf16 v[112:115], v[96:99], a[56:59], v[112:115]
    v_perm_b32 v100, v43, v43, v8
    v_perm_b32 v101, v43, v43, v10
    v_perm_b32 v102, v43, v43, v12
    v_perm_b32 v103, v43, v43, v14
    s_nop 1
    v_mfma_f32_16x16x32_bf16 v[116:119], v[100:103], a[56:59], v[116:119]
    v_perm_b32 v104, v31, v31, v9
    v_perm_b32 v105, v31, v31, v11
    v_perm_b32 v106, v31, v31, v13
    v_perm_b32 v107, v31, v31, v15
    s_nop 1
    v_mfma_f32_16x16x32_bf16 v[112:115], v[104:107], a[60:63], v[112:115]
    v_perm_b32 v108, v43, v43, v9
    v_perm_b32 v109, v43, v43, v11
    v_perm_b32 v110, v43, v43, v13
    v_perm_b32 v111, v43, v43, v15
    s_nop 1
    v_mfma_f32_16x16x32_bf16 v[116:119], v[108:111], a[60:63], v[116:119]
    v_perm_b32 v96, v32, v32, v8
    v_perm_b32 v97, v32, v32, v10
    v_perm_b32 v98, v32, v32, v12
    v_perm_b32 v99, v32, v32, v14
    s_nop 1
    v_mfma_f32_16x16x32_bf16 v[112:115], v[96:99], a[64:67], v[112:115]
    v_perm_b32 v100, v44, v44, v8
    v_perm_b32 v101, v44, v44, v10
    v_perm_b32 v102, v44, v44, v12
    v_perm_b32 v103, v44, v44, v14
    s_nop 1
    v_mfma_f32_16x16x32_bf16 v[116:119], v[100:103], a[64:67], v[116:119]
    v_perm_b32 v104, v32, v32, v9
    v_perm_b32 v105, v32, v32, v11
    v_perm_b32 v106, v32, v32, v13
    v_perm_b32 v107, v32, v32, v15
    s_nop 1
    v_mfma_f32_16x16x32_bf16 v[112:115], v[104:107], a[68:71], v[112:115]
    v_perm_b32 v108, v44, v44, v9
    v_perm_b32 v109, v44, v44, v11
    v_perm_b32 v110, v44, v44, v13
    v_perm_b32 v111, v44, v44, v15
    s_nop 1
    v_mfma_f32_16x16x32_bf16 v[116:119], v[108:111], a[68:71], v[116:119]
    v_lshrrev_b32 v5, 1, v4
    v_lshlrev_b32 v5, 9, v5
    v_lshl_add_u32 v5, v3, 5, v5
    v_and_b32 v6, 1, v4
    v_lshl_add_u32 v5, v6, 4, v5
    s_lshl_b32 s54, s3, 11
    s_add_u32 s54, s54, 139264
    v_add_u32 v5, s54, v5
    ds_write_b128 v5, v[112:115]
    ds_write_b128 v5, v[116:119] offset:1024
    s_waitcnt lgkmcnt(0)
    s_barrier
    s_lshl_b32 s54, s3, 9
    s_add_u32 s54, s54, 139264
    v_add_u32 v5, s54, v2
    ds_read_b128 v[96:99], v5 offset:0
    ds_read_b128 v[100:103], v5 offset:2048
    ds_read_b128 v[104:107], v5 offset:4096
    ds_read_b128 v[108:111], v5 offset:6144
    s_waitcnt lgkmcnt(0)
    v_add_f32 v96, v96, v100
    v_add_f32 v104, v104, v108
    v_add_f32 v97, v97, v101
    v_add_f32 v105, v105, v109
    v_add_f32 v98, v98, v102
    v_add_f32 v106, v106, v110
    v_add_f32 v99, v99, v103
    v_add_f32 v107, v107, v111
    v_add_f32 v96, v96, v104
    v_add_f32 v97, v97, v105
    v_add_f32 v98, v98, v106
    v_add_f32 v99, v99, v107
    v_min_u32 v124, -2, v96
    v_min_u32 v125, -2, v97
    v_min_u32 v126, -2, v98
    v_min_u32 v127, -2, v99
    buffer_store_dwordx4 v[124:127], v123, s[44:47], s98 offen sc1
    s_waitcnt vmcnt(20)
    buffer_load_dwordx4 a[224:227], v120, s[32:35], s61 offen nt
    s_add_u32 s61, s61, 8192
    buffer_load_dwordx4 a[228:231], v120, s[32:35], s61 offen nt
    s_add_u32 s61, s61, 8192
    buffer_load_dwordx4 a[232:235], v120, s[32:35], s61 offen nt
    s_add_u32 s61, s61, 8192
    buffer_load_dwordx4 a[236:239], v120, s[32:35], s61 offen nt
    s_add_u32 s61, s61, 8192
    buffer_load_dwordx4 a[240:243], v120, s[32:35], s61 offen nt
    s_add_u32 s61, s61, 8192
    buffer_load_dwordx4 a[244:247], v120, s[32:35], s61 offen nt
    s_add_u32 s61, s61, 8192
    buffer_load_dwordx4 a[248:251], v120, s[32:35], s61 offen nt
    s_add_u32 s61, s61, 8192
    buffer_load_dwordx4 a[252:255], v120, s[32:35], s61 offen nt
    s_add_u32 s61, s61, 8192
    s_add_u32 m0, s63, 0
    s_nop 0
    buffer_load_dwordx4 v88, s[36:39], s60 offen nt lds
    s_add_u32 s60, s60, 32768
    v_perm_b32 v96, v48, v48, v8
    v_perm_b32 v97, v48, v48, v10
    v_perm_b32 v98, v48, v48, v12
    v_perm_b32 v99, v48, v48, v14
    s_nop 1
    v_mfma_f32_16x16x32_bf16 v[112:115], v[96:99], a[112:115], 0
    v_perm_b32 v100, v68, v68, v8
    v_perm_b32 v101, v68, v68, v10
    v_perm_b32 v102, v68, v68, v12
    v_perm_b32 v103, v68, v68, v14
    s_nop 1
    v_mfma_f32_16x16x32_bf16 v[116:119], v[100:103], a[112:115], 0
    v_perm_b32 v104, v48, v48, v9
    v_perm_b32 v105, v48, v48, v11
    v_perm_b32 v106, v48, v48, v13
    v_perm_b32 v107, v48, v48, v15
    s_nop 1
    v_mfma_f32_16x16x32_bf16 v[112:115], v[104:107], a[116:119], v[112:115]
    v_perm_b32 v108, v68, v68, v9
    v_perm_b32 v109, v68, v68, v11
    v_perm_b32 v110, v68, v68, v13
    v_perm_b32 v111, v68, v68, v15
    s_nop 1
    v_mfma_f32_16x16x32_bf16 v[116:119], v[108:111], a[116:119], v[116:119]
    v_perm_b32 v96, v49, v49, v8
    v_perm_b32 v97, v49, v49, v10
    v_perm_b32 v98, v49, v49, v12
    v_perm_b32 v99, v49, v49, v14
    s_nop 1
    v_mfma_f32_16x16x32_bf16 v[112:115], v[96:99], a[120:123], v[112:115]
    v_perm_b32 v100, v69, v69, v8
    v_perm_b32 v101, v69, v69, v10
    v_perm_b32 v102, v69, v69, v12
    v_perm_b32 v103, v69, v69, v14
    s_nop 1
    v_mfma_f32_16x16x32_bf16 v[116:119], v[100:103], a[120:123], v[116:119]
    v_perm_b32 v104, v49, v49, v9
    v_perm_b32 v105, v49, v49, v11
    v_perm_b32 v106, v49, v49, v13
    v_perm_b32 v107, v49, v49, v15
    s_nop 1
    v_mfma_f32_16x16x32_bf16 v[112:115], v[104:107], a[124:127], v[112:115]
    v_perm_b32 v108, v69, v69, v9
    v_perm_b32 v109, v69, v69, v11
    v_perm_b32 v110, v69, v69, v13
    v_perm_b32 v111, v69, v69, v15
    s_nop 1
    v_mfma_f32_16x16x32_bf16 v[116:119], v[108:111], a[124:127], v[116:119]
    v_perm_b32 v96, v50, v50, v8
    v_perm_b32 v97, v50, v50, v10
    v_perm_b32 v98, v50, v50, v12
    v_perm_b32 v99, v50, v50, v14
    s_nop 1
    v_mfma_f32_16x16x32_bf16 v[112:115], v[96:99], a[128:131], v[112:115]
    v_perm_b32 v100, v70, v70, v8
    v_perm_b32 v101, v70, v70, v10
    v_perm_b32 v102, v70, v70, v12
    v_perm_b32 v103, v70, v70, v14
    s_nop 1
    v_mfma_f32_16x16x32_bf16 v[116:119], v[100:103], a[128:131], v[116:119]
    v_perm_b32 v104, v50, v50, v9
    v_perm_b32 v105, v50, v50, v11
    v_perm_b32 v106, v50, v50, v13
    v_perm_b32 v107, v50, v50, v15
    s_nop 1
    v_mfma_f32_16x16x32_bf16 v[112:115], v[104:107], a[132:135], v[112:115]
    v_perm_b32 v108, v70, v70, v9
    v_perm_b32 v109, v70, v70, v11
    v_perm_b32 v110, v70, v70, v13
    v_perm_b32 v111, v70, v70, v15
    s_nop 1
    v_mfma_f32_16x16x32_bf16 v[116:119], v[108:111], a[132:135], v[116:119]
    v_perm_b32 v96, v51, v51, v8
    v_perm_b32 v97, v51, v51, v10
    v_perm_b32 v98, v51, v51, v12
    v_perm_b32 v99, v51, v51, v14
    s_nop 1
    v_mfma_f32_16x16x32_bf16 v[112:115], v[96:99], a[136:139], v[112:115]
    v_perm_b32 v100, v71, v71, v8
    v_perm_b32 v101, v71, v71, v10
    v_perm_b32 v102, v71, v71, v12
    v_perm_b32 v103, v71, v71, v14
    s_nop 1
    v_mfma_f32_16x16x32_bf16 v[116:119], v[100:103], a[136:139], v[116:119]
    v_perm_b32 v104, v51, v51, v9
    v_perm_b32 v105, v51, v51, v11
    v_perm_b32 v106, v51, v51, v13
    v_perm_b32 v107, v51, v51, v15
    s_nop 1
    v_mfma_f32_16x16x32_bf16 v[112:115], v[104:107], a[140:143], v[112:115]
    v_perm_b32 v108, v71, v71, v9
    v_perm_b32 v109, v71, v71, v11
    v_perm_b32 v110, v71, v71, v13
    v_perm_b32 v111, v71, v71, v15
    s_nop 1
    v_mfma_f32_16x16x32_bf16 v[116:119], v[108:111], a[140:143], v[116:119]
    v_perm_b32 v96, v52, v52, v8
    v_perm_b32 v97, v52, v52, v10
    v_perm_b32 v98, v52, v52, v12
    v_perm_b32 v99, v52, v52, v14
    s_nop 1
    v_mfma_f32_16x16x32_bf16 v[112:115], v[96:99], a[144:147], v[112:115]
    v_perm_b32 v100, v72, v72, v8
    v_perm_b32 v101, v72, v72, v10
    v_perm_b32 v102, v72, v72, v12
    v_perm_b32 v103, v72, v72, v14
    s_nop 1
    v_mfma_f32_16x16x32_bf16 v[116:119], v[100:103], a[144:147], v[116:119]
    s_waitcnt vmcnt(20)
    s_add_u32 m0, s63, 1024
    s_nop 0
    buffer_load_dwordx4 v88, s[36:39], s60 offen nt lds
    s_add_u32 s60, s60, 32768
    s_add_u32 m0, s63, 2048
    s_nop 0
    buffer_load_dwordx4 v89, s[36:39], s60 offen nt lds
    s_add_u32 s60, s60, 32768
    s_add_u32 m0, s63, 3072
    s_nop 0
    buffer_load_dwordx4 v89, s[36:39], s60 offen nt lds
    s_add_u32 s60, s60, 32768
    s_add_u32 m0, s63, 4096
    s_nop 0
    buffer_load_dwordx4 v90, s[36:39], s60 offen nt lds
    s_add_u32 s60, s60, 32768
    s_add_u32 m0, s63, 5120
    s_nop 0
    buffer_load_dwordx4 v90, s[36:39], s60 offen nt lds
    s_add_u32 s60, s60, 32768
    s_add_u32 m0, s63, 6144
    s_nop 0
    buffer_load_dwordx4 v91, s[36:39], s60 offen nt lds
    s_add_u32 s60, s60, 32768
    s_add_u32 m0, s63, 7168
    s_nop 0
    buffer_load_dwordx4 v91, s[36:39], s60 offen nt lds
    s_add_u32 s60, s60, 32768
    s_add_u32 m0, s63, 8192
    s_nop 0
    buffer_load_dwordx4 v88, s[36:39], s60 offen nt lds
    s_add_u32 s60, s60, 32768
    s_add_u32 m0, s63, 9216
    s_nop 0
    buffer_load_dwordx4 v88, s[36:39], s60 offen nt lds
    s_add_u32 s60, s60, 32768
    v_perm_b32 v104, v52, v52, v9
    v_perm_b32 v105, v52, v52, v11
    v_perm_b32 v106, v52, v52, v13
    v_perm_b32 v107, v52, v52, v15
    s_nop 1
    v_mfma_f32_16x16x32_bf16 v[112:115], v[104:107], a[148:151], v[112:115]
    v_perm_b32 v108, v72, v72, v9
    v_perm_b32 v109, v72, v72, v11
    v_perm_b32 v110, v72, v72, v13
    v_perm_b32 v111, v72, v72, v15
    s_nop 1
    v_mfma_f32_16x16x32_bf16 v[116:119], v[108:111], a[148:151], v[116:119]
    v_perm_b32 v96, v53, v53, v8
    v_perm_b32 v97, v53, v53, v10
    v_perm_b32 v98, v53, v53, v12
    v_perm_b32 v99, v53, v53, v14
    s_nop 1
    v_mfma_f32_16x16x32_bf16 v[112:115], v[96:99], a[152:155], v[112:115]
    v_perm_b32 v100, v73, v73, v8
    v_perm_b32 v101, v73, v73, v10
    v_perm_b32 v102, v73, v73, v12
    v_perm_b32 v103, v73, v73, v14
    s_nop 1
    v_mfma_f32_16x16x32_bf16 v[116:119], v[100:103], a[152:155], v[116:119]
    v_perm_b32 v104, v53, v53, v9
    v_perm_b32 v105, v53, v53, v11
    v_perm_b32 v106, v53, v53, v13
    v_perm_b32 v107, v53, v53, v15
    s_nop 1
    v_mfma_f32_16x16x32_bf16 v[112:115], v[104:107], a[156:159], v[112:115]
    v_perm_b32 v108, v73, v73, v9
    v_perm_b32 v109, v73, v73, v11
    v_perm_b32 v110, v73, v73, v13
    v_perm_b32 v111, v73, v73, v15
    s_nop 1
    v_mfma_f32_16x16x32_bf16 v[116:119], v[108:111], a[156:159], v[116:119]
    v_perm_b32 v96, v54, v54, v8
    v_perm_b32 v97, v54, v54, v10
    v_perm_b32 v98, v54, v54, v12
    v_perm_b32 v99, v54, v54, v14
    s_nop 1
    v_mfma_f32_16x16x32_bf16 v[112:115], v[96:99], a[160:163], v[112:115]
    v_perm_b32 v100, v74, v74, v8
    v_perm_b32 v101, v74, v74, v10
    v_perm_b32 v102, v74, v74, v12
    v_perm_b32 v103, v74, v74, v14
    s_nop 1
    v_mfma_f32_16x16x32_bf16 v[116:119], v[100:103], a[160:163], v[116:119]
    v_perm_b32 v104, v54, v54, v9
    v_perm_b32 v105, v54, v54, v11
    v_perm_b32 v106, v54, v54, v13
    v_perm_b32 v107, v54, v54, v15
    s_nop 1
    v_mfma_f32_16x16x32_bf16 v[112:115], v[104:107], a[164:167], v[112:115]
    v_perm_b32 v108, v74, v74, v9
    v_perm_b32 v109, v74, v74, v11
    v_perm_b32 v110, v74, v74, v13
    v_perm_b32 v111, v74, v74, v15
    s_nop 1
    v_mfma_f32_16x16x32_bf16 v[116:119], v[108:111], a[164:167], v[116:119]
    v_perm_b32 v96, v55, v55, v8
    v_perm_b32 v97, v55, v55, v10
    v_perm_b32 v98, v55, v55, v12
    v_perm_b32 v99, v55, v55, v14
    s_nop 1
    v_mfma_f32_16x16x32_bf16 v[112:115], v[96:99], a[168:171], v[112:115]
    v_perm_b32 v100, v75, v75, v8
    v_perm_b32 v101, v75, v75, v10
    v_perm_b32 v102, v75, v75, v12
    v_perm_b32 v103, v75, v75, v14
    s_nop 1
    v_mfma_f32_16x16x32_bf16 v[116:119], v[100:103], a[168:171], v[116:119]
    v_perm_b32 v104, v55, v55, v9
    v_perm_b32 v105, v55, v55, v11
    v_perm_b32 v106, v55, v55, v13
    v_perm_b32 v107, v55, v55, v15
    s_nop 1
    v_mfma_f32_16x16x32_bf16 v[112:115], v[104:107], a[172:175], v[112:115]
    v_perm_b32 v108, v75, v75, v9
    v_perm_b32 v109, v75, v75, v11
    v_perm_b32 v110, v75, v75, v13
    v_perm_b32 v111, v75, v75, v15
    s_nop 1
    v_mfma_f32_16x16x32_bf16 v[116:119], v[108:111], a[172:175], v[116:119]
    v_perm_b32 v96, v56, v56, v8
    v_perm_b32 v97, v56, v56, v10
    v_perm_b32 v98, v56, v56, v12
    v_perm_b32 v99, v56, v56, v14
    s_nop 1
    v_mfma_f32_16x16x32_bf16 v[112:115], v[96:99], a[176:179], v[112:115]
    v_perm_b32 v100, v76, v76, v8
    v_perm_b32 v101, v76, v76, v10
    v_perm_b32 v102, v76, v76, v12
    v_perm_b32 v103, v76, v76, v14
    s_nop 1
    v_mfma_f32_16x16x32_bf16 v[116:119], v[100:103], a[176:179], v[116:119]
    v_perm_b32 v104, v56, v56, v9
    v_perm_b32 v105, v56, v56, v11
    v_perm_b32 v106, v56, v56, v13
    v_perm_b32 v107, v56, v56, v15
    s_nop 1
    v_mfma_f32_16x16x32_bf16 v[112:115], v[104:107], a[180:183], v[112:115]
    v_perm_b32 v108, v76, v76, v9
    v_perm_b32 v109, v76, v76, v11
    v_perm_b32 v110, v76, v76, v13
    v_perm_b32 v111, v76, v76, v15
    s_nop 1
    v_mfma_f32_16x16x32_bf16 v[116:119], v[108:111], a[180:183], v[116:119]
    s_waitcnt vmcnt(20)
    s_add_u32 m0, s63, 10240
    s_nop 0
    buffer_load_dwordx4 v89, s[36:39], s60 offen nt lds
    s_add_u32 s60, s60, 32768
    s_add_u32 m0, s63, 11264
    s_nop 0
    buffer_load_dwordx4 v89, s[36:39], s60 offen nt lds
    s_add_u32 s60, s60, 32768
    s_add_u32 m0, s63, 12288
    s_nop 0
    buffer_load_dwordx4 v90, s[36:39], s60 offen nt lds
    s_add_u32 s60, s60, 32768
    s_add_u32 m0, s63, 13312
    s_nop 0
    buffer_load_dwordx4 v90, s[36:39], s60 offen nt lds
    s_add_u32 s60, s60, 32768
    s_add_u32 m0, s63, 14336
    s_nop 0
    buffer_load_dwordx4 v91, s[36:39], s60 offen nt lds
    s_add_u32 s60, s60, 32768
    s_add_u32 m0, s63, 15360
    s_nop 0
    buffer_load_dwordx4 v91, s[36:39], s60 offen nt lds
    s_add_u32 s60, s60, 32768
    s_add_u32 m0, s63, 16384
    s_nop 0
    buffer_load_dwordx4 v88, s[36:39], s60 offen nt lds
    s_add_u32 s60, s60, 32768
    s_add_u32 m0, s63, 17408
    s_nop 0
    buffer_load_dwordx4 v88, s[36:39], s60 offen nt lds
    s_add_u32 s60, s60, 32768
    s_add_u32 m0, s63, 18432
    s_nop 0
    buffer_load_dwordx4 v89, s[36:39], s60 offen nt lds
    s_add_u32 s60, s60, 32768
    v_perm_b32 v96, v57, v57, v8
    v_perm_b32 v97, v57, v57, v10
    v_perm_b32 v98, v57, v57, v12
    v_perm_b32 v99, v57, v57, v14
    s_nop 1
    v_mfma_f32_16x16x32_bf16 v[112:115], v[96:99], a[184:187], v[112:115]
    v_perm_b32 v100, v77, v77, v8
    v_perm_b32 v101, v77, v77, v10
    v_perm_b32 v102, v77, v77, v12
    v_perm_b32 v103, v77, v77, v14
    s_nop 1
    v_mfma_f32_16x16x32_bf16 v[116:119], v[100:103], a[184:187], v[116:119]
    v_perm_b32 v104, v57, v57, v9
    v_perm_b32 v105, v57, v57, v11
    v_perm_b32 v106, v57, v57, v13
    v_perm_b32 v107, v57, v57, v15
    s_nop 1
    v_mfma_f32_16x16x32_bf16 v[112:115], v[104:107], a[188:191], v[112:115]
    v_perm_b32 v108, v77, v77, v9
    v_perm_b32 v109, v77, v77, v11
    v_perm_b32 v110, v77, v77, v13
    v_perm_b32 v111, v77, v77, v15
    s_nop 1
    v_mfma_f32_16x16x32_bf16 v[116:119], v[108:111], a[188:191], v[116:119]
    v_perm_b32 v96, v58, v58, v8
    v_perm_b32 v97, v58, v58, v10
    v_perm_b32 v98, v58, v58, v12
    v_perm_b32 v99, v58, v58, v14
    s_nop 1
    v_mfma_f32_16x16x32_bf16 v[112:115], v[96:99], a[192:195], v[112:115]
    v_perm_b32 v100, v78, v78, v8
    v_perm_b32 v101, v78, v78, v10
    v_perm_b32 v102, v78, v78, v12
    v_perm_b32 v103, v78, v78, v14
    s_nop 1
    v_mfma_f32_16x16x32_bf16 v[116:119], v[100:103], a[192:195], v[116:119]
    v_perm_b32 v104, v58, v58, v9
    v_perm_b32 v105, v58, v58, v11
    v_perm_b32 v106, v58, v58, v13
    v_perm_b32 v107, v58, v58, v15
    s_nop 1
    v_mfma_f32_16x16x32_bf16 v[112:115], v[104:107], a[196:199], v[112:115]
    v_perm_b32 v108, v78, v78, v9
    v_perm_b32 v109, v78, v78, v11
    v_perm_b32 v110, v78, v78, v13
    v_perm_b32 v111, v78, v78, v15
    s_nop 1
    v_mfma_f32_16x16x32_bf16 v[116:119], v[108:111], a[196:199], v[116:119]
    v_perm_b32 v96, v59, v59, v8
    v_perm_b32 v97, v59, v59, v10
    v_perm_b32 v98, v59, v59, v12
    v_perm_b32 v99, v59, v59, v14
    s_nop 1
    v_mfma_f32_16x16x32_bf16 v[112:115], v[96:99], a[200:203], v[112:115]
    v_perm_b32 v100, v79, v79, v8
    v_perm_b32 v101, v79, v79, v10
    v_perm_b32 v102, v79, v79, v12
    v_perm_b32 v103, v79, v79, v14
    s_nop 1
    v_mfma_f32_16x16x32_bf16 v[116:119], v[100:103], a[200:203], v[116:119]
    v_perm_b32 v104, v59, v59, v9
    v_perm_b32 v105, v59, v59, v11
    v_perm_b32 v106, v59, v59, v13
    v_perm_b32 v107, v59, v59, v15
    s_nop 1
    v_mfma_f32_16x16x32_bf16 v[112:115], v[104:107], a[204:207], v[112:115]
    v_perm_b32 v108, v79, v79, v9
    v_perm_b32 v109, v79, v79, v11
    v_perm_b32 v110, v79, v79, v13
    v_perm_b32 v111, v79, v79, v15
    s_nop 1
    v_mfma_f32_16x16x32_bf16 v[116:119], v[108:111], a[204:207], v[116:119]
    v_perm_b32 v96, v60, v60, v8
    v_perm_b32 v97, v60, v60, v10
    v_perm_b32 v98, v60, v60, v12
    v_perm_b32 v99, v60, v60, v14
    s_nop 1
    v_mfma_f32_16x16x32_bf16 v[112:115], v[96:99], a[208:211], v[112:115]
    v_perm_b32 v100, v80, v80, v8
    v_perm_b32 v101, v80, v80, v10
    v_perm_b32 v102, v80, v80, v12
    v_perm_b32 v103, v80, v80, v14
    s_nop 1
    v_mfma_f32_16x16x32_bf16 v[116:119], v[100:103], a[208:211], v[116:119]
    v_perm_b32 v104, v60, v60, v9
    v_perm_b32 v105, v60, v60, v11
    v_perm_b32 v106, v60, v60, v13
    v_perm_b32 v107, v60, v60, v15
    s_nop 1
    v_mfma_f32_16x16x32_bf16 v[112:115], v[104:107], a[212:215], v[112:115]
    v_perm_b32 v108, v80, v80, v9
    v_perm_b32 v109, v80, v80, v11
    v_perm_b32 v110, v80, v80, v13
    v_perm_b32 v111, v80, v80, v15
    s_nop 1
    v_mfma_f32_16x16x32_bf16 v[116:119], v[108:111], a[212:215], v[116:119]
    v_perm_b32 v96, v61, v61, v8
    v_perm_b32 v97, v61, v61, v10
    v_perm_b32 v98, v61, v61, v12
    v_perm_b32 v99, v61, v61, v14
    s_nop 1
    v_mfma_f32_16x16x32_bf16 v[112:115], v[96:99], a[216:219], v[112:115]
    v_perm_b32 v100, v81, v81, v8
    v_perm_b32 v101, v81, v81, v10
    v_perm_b32 v102, v81, v81, v12
    v_perm_b32 v103, v81, v81, v14
    s_nop 1
    v_mfma_f32_16x16x32_bf16 v[116:119], v[100:103], a[216:219], v[116:119]
    s_waitcnt vmcnt(19)
    s_add_u32 m0, s63, 19456
    s_nop 0
    buffer_load_dwordx4 v89, s[36:39], s60 offen nt lds
    s_add_u32 s60, s60, 32768
    s_add_u32 m0, s63, 20480
    s_nop 0
    buffer_load_dwordx4 v90, s[36:39], s60 offen nt lds
    s_add_u32 s60, s60, 32768
    s_add_u32 m0, s63, 21504
    s_nop 0
    buffer_load_dwordx4 v90, s[36:39], s60 offen nt lds
    s_add_u32 s60, s60, 32768
    s_add_u32 m0, s63, 22528
    s_nop 0
    buffer_load_dwordx4 v91, s[36:39], s60 offen nt lds
    s_add_u32 s60, s60, 32768
    s_add_u32 m0, s63, 23552
    s_nop 0
    buffer_load_dwordx4 v91, s[36:39], s60 offen nt lds
    s_add_u32 s60, s60, 32768
    s_add_u32 m0, s63, 24576
    s_nop 0
    buffer_load_dwordx4 v88, s[36:39], s60 offen nt lds
    s_add_u32 s60, s60, 32768
    s_add_u32 m0, s63, 25600
    s_nop 0
    buffer_load_dwordx4 v88, s[36:39], s60 offen nt lds
    s_add_u32 s60, s60, 32768
    s_add_u32 m0, s63, 26624
    s_nop 0
    buffer_load_dwordx4 v89, s[36:39], s60 offen nt lds
    s_add_u32 s60, s60, 32768
    s_add_u32 m0, s63, 27648
    s_nop 0
    buffer_load_dwordx4 v89, s[36:39], s60 offen nt lds
    s_add_u32 s60, s60, 32768
    v_perm_b32 v104, v61, v61, v9
    v_perm_b32 v105, v61, v61, v11
    v_perm_b32 v106, v61, v61, v13
    v_perm_b32 v107, v61, v61, v15
    s_nop 1
    v_mfma_f32_16x16x32_bf16 v[112:115], v[104:107], a[220:223], v[112:115]
    v_perm_b32 v108, v81, v81, v9
    v_perm_b32 v109, v81, v81, v11
    v_perm_b32 v110, v81, v81, v13
    v_perm_b32 v111, v81, v81, v15
    s_nop 1
    v_mfma_f32_16x16x32_bf16 v[116:119], v[108:111], a[220:223], v[116:119]
    v_perm_b32 v96, v62, v62, v8
    v_perm_b32 v97, v62, v62, v10
    v_perm_b32 v98, v62, v62, v12
    v_perm_b32 v99, v62, v62, v14
    s_nop 1
    v_mfma_f32_16x16x32_bf16 v[112:115], v[96:99], a[224:227], v[112:115]
    v_perm_b32 v100, v82, v82, v8
    v_perm_b32 v101, v82, v82, v10
    v_perm_b32 v102, v82, v82, v12
    v_perm_b32 v103, v82, v82, v14
    s_nop 1
    v_mfma_f32_16x16x32_bf16 v[116:119], v[100:103], a[224:227], v[116:119]
    v_perm_b32 v104, v62, v62, v9
    v_perm_b32 v105, v62, v62, v11
    v_perm_b32 v106, v62, v62, v13
    v_perm_b32 v107, v62, v62, v15
    s_nop 1
    v_mfma_f32_16x16x32_bf16 v[112:115], v[104:107], a[228:231], v[112:115]
    v_perm_b32 v108, v82, v82, v9
    v_perm_b32 v109, v82, v82, v11
    v_perm_b32 v110, v82, v82, v13
    v_perm_b32 v111, v82, v82, v15
    s_nop 1
    v_mfma_f32_16x16x32_bf16 v[116:119], v[108:111], a[228:231], v[116:119]
    v_perm_b32 v96, v63, v63, v8
    v_perm_b32 v97, v63, v63, v10
    v_perm_b32 v98, v63, v63, v12
    v_perm_b32 v99, v63, v63, v14
    s_nop 1
    v_mfma_f32_16x16x32_bf16 v[112:115], v[96:99], a[232:235], v[112:115]
    v_perm_b32 v100, v83, v83, v8
    v_perm_b32 v101, v83, v83, v10
    v_perm_b32 v102, v83, v83, v12
    v_perm_b32 v103, v83, v83, v14
    s_nop 1
    v_mfma_f32_16x16x32_bf16 v[116:119], v[100:103], a[232:235], v[116:119]
    v_perm_b32 v104, v63, v63, v9
    v_perm_b32 v105, v63, v63, v11
    v_perm_b32 v106, v63, v63, v13
    v_perm_b32 v107, v63, v63, v15
    s_nop 1
    v_mfma_f32_16x16x32_bf16 v[112:115], v[104:107], a[236:239], v[112:115]
    v_perm_b32 v108, v83, v83, v9
    v_perm_b32 v109, v83, v83, v11
    v_perm_b32 v110, v83, v83, v13
    v_perm_b32 v111, v83, v83, v15
    s_nop 1
    v_mfma_f32_16x16x32_bf16 v[116:119], v[108:111], a[236:239], v[116:119]
    v_perm_b32 v96, v64, v64, v8
    v_perm_b32 v97, v64, v64, v10
    v_perm_b32 v98, v64, v64, v12
    v_perm_b32 v99, v64, v64, v14
    s_nop 1
    v_mfma_f32_16x16x32_bf16 v[112:115], v[96:99], a[240:243], v[112:115]
    v_perm_b32 v100, v84, v84, v8
    v_perm_b32 v101, v84, v84, v10
    v_perm_b32 v102, v84, v84, v12
    v_perm_b32 v103, v84, v84, v14
    s_nop 1
    v_mfma_f32_16x16x32_bf16 v[116:119], v[100:103], a[240:243], v[116:119]
    v_perm_b32 v104, v64, v64, v9
    v_perm_b32 v105, v64, v64, v11
    v_perm_b32 v106, v64, v64, v13
    v_perm_b32 v107, v64, v64, v15
    s_nop 1
    v_mfma_f32_16x16x32_bf16 v[112:115], v[104:107], a[244:247], v[112:115]
    v_perm_b32 v108, v84, v84, v9
    v_perm_b32 v109, v84, v84, v11
    v_perm_b32 v110, v84, v84, v13
    v_perm_b32 v111, v84, v84, v15
    s_nop 1
    v_mfma_f32_16x16x32_bf16 v[116:119], v[108:111], a[244:247], v[116:119]
    v_perm_b32 v96, v65, v65, v8
    v_perm_b32 v97, v65, v65, v10
    v_perm_b32 v98, v65, v65, v12
    v_perm_b32 v99, v65, v65, v14
    s_nop 1
    v_mfma_f32_16x16x32_bf16 v[112:115], v[96:99], a[248:251], v[112:115]
    v_perm_b32 v100, v85, v85, v8
    v_perm_b32 v101, v85, v85, v10
    v_perm_b32 v102, v85, v85, v12
    v_perm_b32 v103, v85, v85, v14
    s_nop 1
    v_mfma_f32_16x16x32_bf16 v[116:119], v[100:103], a[248:251], v[116:119]
    v_perm_b32 v104, v65, v65, v9
    v_perm_b32 v105, v65, v65, v11
    v_perm_b32 v106, v65, v65, v13
    v_perm_b32 v107, v65, v65, v15
    s_nop 1
    v_mfma_f32_16x16x32_bf16 v[112:115], v[104:107], a[252:255], v[112:115]
    v_perm_b32 v108, v85, v85, v9
    v_perm_b32 v109, v85, v85, v11
    v_perm_b32 v110, v85, v85, v13
    v_perm_b32 v111, v85, v85, v15
    s_nop 1
    v_mfma_f32_16x16x32_bf16 v[116:119], v[108:111], a[252:255], v[116:119]
    v_lshrrev_b32 v5, 1, v4
    v_lshlrev_b32 v5, 9, v5
    v_lshl_add_u32 v5, v3, 5, v5
    v_and_b32 v6, 1, v4
    v_lshl_add_u32 v5, v6, 4, v5
    s_lshl_b32 s54, s3, 11
    s_add_u32 s54, s54, 131072
    v_add_u32 v5, s54, v5
    ds_write_b128 v5, v[112:115]
    ds_write_b128 v5, v[116:119] offset:1024
    s_waitcnt lgkmcnt(0)
    s_barrier
    s_add_u32 m0, s63, 28672
    s_nop 0
    buffer_load_dwordx4 v90, s[36:39], s60 offen nt lds
    s_add_u32 s60, s60, 32768
    s_add_u32 m0, s63, 29696
    s_nop 0
    buffer_load_dwordx4 v90, s[36:39], s60 offen nt lds
    s_add_u32 s60, s60, 32768
    s_add_u32 m0, s63, 30720
    s_nop 0
    buffer_load_dwordx4 v91, s[36:39], s60 offen nt lds
    s_add_u32 s60, s60, 32768
    s_add_u32 m0, s63, 31744
    s_nop 0
    buffer_load_dwordx4 v91, s[36:39], s60 offen nt lds
    s_add_u32 s60, s60, 32768
    v_lshrrev_b32 v5, 2, v3
    v_lshlrev_b32 v5, 9, v5
    v_lshl_add_u32 v5, v4, 5, v5
    v_add_u32 v5, 131072, v5
    ds_read_b128 v[48:51], v5 offset:0
    ds_read_b128 v[52:55], v5 offset:16
    ds_read_b128 v[56:59], v5 offset:2048
    ds_read_b128 v[60:63], v5 offset:2064
    ds_read_b128 v[64:67], v5 offset:4096
    ds_read_b128 v[68:71], v5 offset:4112
    ds_read_b128 v[72:75], v5 offset:6144
    ds_read_b128 v[76:79], v5 offset:6160
    s_waitcnt lgkmcnt(0)
    v_add_f32 v48, v48, v56
    v_add_f32 v64, v64, v72
    v_add_f32 v49, v49, v57
    v_add_f32 v65, v65, v73
    v_add_f32 v50, v50, v58
    v_add_f32 v66, v66, v74
    v_add_f32 v51, v51, v59
    v_add_f32 v67, v67, v75
    v_add_f32 v52, v52, v60
    v_add_f32 v68, v68, v76
    v_add_f32 v53, v53, v61
    v_add_f32 v69, v69, v77
    v_add_f32 v54, v54, v62
    v_add_f32 v70, v70, v78
    v_add_f32 v55, v55, v63
    v_add_f32 v71, v71, v79
    v_add_f32 v48, v48, v64
    v_add_f32 v49, v49, v65
    v_add_f32 v50, v50, v66
    v_add_f32 v51, v51, v67
    v_add_f32 v52, v52, v68
    v_add_f32 v53, v53, v69
    v_add_f32 v54, v54, v70
    v_add_f32 v55, v55, v71
    v_cvt_pk_bf16_f32 v96, v48, v49
    v_cvt_pk_bf16_f32 v97, v50, v51
    v_cvt_pk_bf16_f32 v98, v52, v53
    v_cvt_pk_bf16_f32 v99, v54, v55
    ds_read_b128 v[48:51], v5 offset:128
    ds_read_b128 v[52:55], v5 offset:144
    ds_read_b128 v[56:59], v5 offset:2176
    ds_read_b128 v[60:63], v5 offset:2192
    ds_read_b128 v[64:67], v5 offset:4224
    ds_read_b128 v[68:71], v5 offset:4240
    ds_read_b128 v[72:75], v5 offset:6272
    ds_read_b128 v[76:79], v5 offset:6288
    s_waitcnt lgkmcnt(0)
    v_add_f32 v48, v48, v56
    v_add_f32 v64, v64, v72
    v_add_f32 v49, v49, v57
    v_add_f32 v65, v65, v73
    v_add_f32 v50, v50, v58
    v_add_f32 v66, v66, v74
    v_add_f32 v51, v51, v59
    v_add_f32 v67, v67, v75
    v_add_f32 v52, v52, v60
    v_add_f32 v68, v68, v76
    v_add_f32 v53, v53, v61
    v_add_f32 v69, v69, v77
    v_add_f32 v54, v54, v62
    v_add_f32 v70, v70, v78
    v_add_f32 v55, v55, v63
    v_add_f32 v71, v71, v79
    v_add_f32 v48, v48, v64
    v_add_f32 v49, v49, v65
    v_add_f32 v50, v50, v66
    v_add_f32 v51, v51, v67
    v_add_f32 v52, v52, v68
    v_add_f32 v53, v53, v69
    v_add_f32 v54, v54, v70
    v_add_f32 v55, v55, v71
    v_cvt_pk_bf16_f32 v100, v48, v49
    v_cvt_pk_bf16_f32 v101, v50, v51
    v_cvt_pk_bf16_f32 v102, v52, v53
    v_cvt_pk_bf16_f32 v103, v54, v55
    ds_read_b128 v[48:51], v5 offset:256
    ds_read_b128 v[52:55], v5 offset:272
    ds_read_b128 v[56:59], v5 offset:2304
    ds_read_b128 v[60:63], v5 offset:2320
    ds_read_b128 v[64:67], v5 offset:4352
    ds_read_b128 v[68:71], v5 offset:4368
    ds_read_b128 v[72:75], v5 offset:6400
    ds_read_b128 v[76:79], v5 offset:6416
    s_waitcnt lgkmcnt(0)
    v_add_f32 v48, v48, v56
    v_add_f32 v64, v64, v72
    v_add_f32 v49, v49, v57
    v_add_f32 v65, v65, v73
    v_add_f32 v50, v50, v58
    v_add_f32 v66, v66, v74
    v_add_f32 v51, v51, v59
    v_add_f32 v67, v67, v75
    v_add_f32 v52, v52, v60
    v_add_f32 v68, v68, v76
    v_add_f32 v53, v53, v61
    v_add_f32 v69, v69, v77
    v_add_f32 v54, v54, v62
    v_add_f32 v70, v70, v78
    v_add_f32 v55, v55, v63
    v_add_f32 v71, v71, v79
    v_add_f32 v48, v48, v64
    v_add_f32 v49, v49, v65
    v_add_f32 v50, v50, v66
    v_add_f32 v51, v51, v67
    v_add_f32 v52, v52, v68
    v_add_f32 v53, v53, v69
    v_add_f32 v54, v54, v70
    v_add_f32 v55, v55, v71
    v_cvt_pk_bf16_f32 v104, v48, v49
    v_cvt_pk_bf16_f32 v105, v50, v51
    v_cvt_pk_bf16_f32 v106, v52, v53
    v_cvt_pk_bf16_f32 v107, v54, v55
    ds_read_b128 v[48:51], v5 offset:384
    ds_read_b128 v[52:55], v5 offset:400
    ds_read_b128 v[56:59], v5 offset:2432
    ds_read_b128 v[60:63], v5 offset:2448
    ds_read_b128 v[64:67], v5 offset:4480
    ds_read_b128 v[68:71], v5 offset:4496
    ds_read_b128 v[72:75], v5 offset:6528
    ds_read_b128 v[76:79], v5 offset:6544
    s_waitcnt lgkmcnt(0)
    v_add_f32 v48, v48, v56
    v_add_f32 v64, v64, v72
    v_add_f32 v49, v49, v57
    v_add_f32 v65, v65, v73
    v_add_f32 v50, v50, v58
    v_add_f32 v66, v66, v74
    v_add_f32 v51, v51, v59
    v_add_f32 v67, v67, v75
    v_add_f32 v52, v52, v60
    v_add_f32 v68, v68, v76
    v_add_f32 v53, v53, v61
    v_add_f32 v69, v69, v77
    v_add_f32 v54, v54, v62
    v_add_f32 v70, v70, v78
    v_add_f32 v55, v55, v63
    v_add_f32 v71, v71, v79
    v_add_f32 v48, v48, v64
    v_add_f32 v49, v49, v65
    v_add_f32 v50, v50, v66
    v_add_f32 v51, v51, v67
    v_add_f32 v52, v52, v68
    v_add_f32 v53, v53, v69
    v_add_f32 v54, v54, v70
    v_add_f32 v55, v55, v71
    v_cvt_pk_bf16_f32 v108, v48, v49
    v_cvt_pk_bf16_f32 v109, v50, v51
    v_cvt_pk_bf16_f32 v110, v52, v53
    v_cvt_pk_bf16_f32 v111, v54, v55
    s_waitcnt vmcnt(24)
    ds_read_b128 v[128:131], v92 offset:0
    ds_read_b128 v[132:135], v93 offset:0
    ds_read_b128 v[136:139], v94 offset:0
    ds_read_b128 v[140:143], v95 offset:0
    ds_read_b128 v[144:147], v92 offset:1024
    ds_read_b128 v[148:151], v93 offset:1024
    ds_read_b128 v[152:155], v94 offset:1024
    ds_read_b128 v[156:159], v95 offset:1024
    s_waitcnt lgkmcnt(7)
    v_mfma_f32_16x16x32_bf16 v[48:51], v[128:131], v[96:99], 0
    s_waitcnt lgkmcnt(6)
    v_mfma_f32_16x16x32_bf16 v[48:51], v[132:135], v[100:103], v[48:51]
    s_waitcnt lgkmcnt(5)
    v_mfma_f32_16x16x32_bf16 v[48:51], v[136:139], v[104:107], v[48:51]
    s_waitcnt lgkmcnt(4)
    v_mfma_f32_16x16x32_bf16 v[48:51], v[140:143], v[108:111], v[48:51]
    s_waitcnt lgkmcnt(3)
    v_mfma_f32_16x16x32_bf16 v[52:55], v[144:147], v[96:99], 0
    s_waitcnt lgkmcnt(2)
    v_mfma_f32_16x16x32_bf16 v[52:55], v[148:151], v[100:103], v[52:55]
    s_waitcnt lgkmcnt(1)
    v_mfma_f32_16x16x32_bf16 v[52:55], v[152:155], v[104:107], v[52:55]
    s_waitcnt lgkmcnt(0)
    v_mfma_f32_16x16x32_bf16 v[52:55], v[156:159], v[108:111], v[52:55]
    s_waitcnt vmcnt(16)
    ds_read_b128 v[160:163], v92 offset:8192
    ds_read_b128 v[164:167], v93 offset:8192
    ds_read_b128 v[168:171], v94 offset:8192
    ds_read_b128 v[172:175], v95 offset:8192
    ds_read_b128 v[176:179], v92 offset:9216
    ds_read_b128 v[180:183], v93 offset:9216
    ds_read_b128 v[184:187], v94 offset:9216
    ds_read_b128 v[188:191], v95 offset:9216
    s_waitcnt lgkmcnt(7)
    v_mfma_f32_16x16x32_bf16 v[56:59], v[160:163], v[96:99], 0
    s_waitcnt lgkmcnt(6)
    v_mfma_f32_16x16x32_bf16 v[56:59], v[164:167], v[100:103], v[56:59]
    s_waitcnt lgkmcnt(5)
    v_mfma_f32_16x16x32_bf16 v[56:59], v[168:171], v[104:107], v[56:59]
    s_waitcnt lgkmcnt(4)
    v_mfma_f32_16x16x32_bf16 v[56:59], v[172:175], v[108:111], v[56:59]
    s_waitcnt lgkmcnt(3)
    v_mfma_f32_16x16x32_bf16 v[60:63], v[176:179], v[96:99], 0
    s_waitcnt lgkmcnt(2)
    v_mfma_f32_16x16x32_bf16 v[60:63], v[180:183], v[100:103], v[60:63]
    s_waitcnt lgkmcnt(1)
    v_mfma_f32_16x16x32_bf16 v[60:63], v[184:187], v[104:107], v[60:63]
    s_waitcnt lgkmcnt(0)
    v_mfma_f32_16x16x32_bf16 v[60:63], v[188:191], v[108:111], v[60:63]
    s_waitcnt vmcnt(8)
    ds_read_b128 v[128:131], v92 offset:16384
    ds_read_b128 v[132:135], v93 offset:16384
    ds_read_b128 v[136:139], v94 offset:16384
    ds_read_b128 v[140:143], v95 offset:16384
    ds_read_b128 v[144:147], v92 offset:17408
    ds_read_b128 v[148:151], v93 offset:17408
    ds_read_b128 v[152:155], v94 offset:17408
    ds_read_b128 v[156:159], v95 offset:17408
    s_waitcnt lgkmcnt(7)
    v_mfma_f32_16x16x32_bf16 v[64:67], v[128:131], v[96:99], 0
    s_waitcnt lgkmcnt(6)
    v_mfma_f32_16x16x32_bf16 v[64:67], v[132:135], v[100:103], v[64:67]
    s_waitcnt lgkmcnt(5)
    v_mfma_f32_16x16x32_bf16 v[64:67], v[136:139], v[104:107], v[64:67]
    s_waitcnt lgkmcnt(4)
    v_mfma_f32_16x16x32_bf16 v[64:67], v[140:143], v[108:111], v[64:67]
    s_waitcnt lgkmcnt(3)
    v_mfma_f32_16x16x32_bf16 v[68:71], v[144:147], v[96:99], 0
    s_waitcnt lgkmcnt(2)
    v_mfma_f32_16x16x32_bf16 v[68:71], v[148:151], v[100:103], v[68:71]
    s_waitcnt lgkmcnt(1)
    v_mfma_f32_16x16x32_bf16 v[68:71], v[152:155], v[104:107], v[68:71]
    s_waitcnt lgkmcnt(0)
    v_mfma_f32_16x16x32_bf16 v[68:71], v[156:159], v[108:111], v[68:71]
    s_waitcnt vmcnt(0)
    ds_read_b128 v[160:163], v92 offset:24576
    ds_read_b128 v[164:167], v93 offset:24576
    ds_read_b128 v[168:171], v94 offset:24576
    ds_read_b128 v[172:175], v95 offset:24576
    ds_read_b128 v[176:179], v92 offset:25600
    ds_read_b128 v[180:183], v93 offset:25600
    ds_read_b128 v[184:187], v94 offset:25600
    ds_read_b128 v[188:191], v95 offset:25600
    s_waitcnt lgkmcnt(7)
    v_mfma_f32_16x16x32_bf16 v[72:75], v[160:163], v[96:99], 0
    s_waitcnt lgkmcnt(6)
    v_mfma_f32_16x16x32_bf16 v[72:75], v[164:167], v[100:103], v[72:75]
    s_waitcnt lgkmcnt(5)
    v_mfma_f32_16x16x32_bf16 v[72:75], v[168:171], v[104:107], v[72:75]
    s_waitcnt lgkmcnt(4)
    v_mfma_f32_16x16x32_bf16 v[72:75], v[172:175], v[108:111], v[72:75]
    s_waitcnt lgkmcnt(3)
    v_mfma_f32_16x16x32_bf16 v[76:79], v[176:179], v[96:99], 0
    s_waitcnt lgkmcnt(2)
    v_mfma_f32_16x16x32_bf16 v[76:79], v[180:183], v[100:103], v[76:79]
    s_waitcnt lgkmcnt(1)
    v_mfma_f32_16x16x32_bf16 v[76:79], v[184:187], v[104:107], v[76:79]
    s_waitcnt lgkmcnt(0)
    v_mfma_f32_16x16x32_bf16 v[76:79], v[188:191], v[108:111], v[76:79]
    s_mov_b32 s96, 1040356334
    v_and_b32 v6, 3, v3
    v_cmp_eq_u32 vcc, 1, v6
    s_nop 1
    v_cndmask_b32 v48, v48, v56, vcc
    v_cndmask_b32 v49, v49, v57, vcc
    v_cndmask_b32 v50, v50, v58, vcc
    v_cndmask_b32 v51, v51, v59, vcc
    v_cndmask_b32 v52, v52, v60, vcc
    v_cndmask_b32 v53, v53, v61, vcc
    v_cndmask_b32 v54, v54, v62, vcc
    v_cndmask_b32 v55, v55, v63, vcc
    v_cmp_eq_u32 vcc, 2, v6
    s_nop 1
    v_cndmask_b32 v48, v48, v64, vcc
    v_cndmask_b32 v49, v49, v65, vcc
    v_cndmask_b32 v50, v50, v66, vcc
    v_cndmask_b32 v51, v51, v67, vcc
    v_cndmask_b32 v52, v52, v68, vcc
    v_cndmask_b32 v53, v53, v69, vcc
    v_cndmask_b32 v54, v54, v70, vcc
    v_cndmask_b32 v55, v55, v71, vcc
    v_cmp_eq_u32 vcc, 3, v6
    s_nop 1
    v_cndmask_b32 v48, v48, v72, vcc
    v_cndmask_b32 v49, v49, v73, vcc
    v_cndmask_b32 v50, v50, v74, vcc
    v_cndmask_b32 v51, v51, v75, vcc
    v_cndmask_b32 v52, v52, v76, vcc
    v_cndmask_b32 v53, v53, v77, vcc
    v_cndmask_b32 v54, v54, v78, vcc
    v_cndmask_b32 v55, v55, v79, vcc
    v_mul_f32 v48, s96, v48
    v_mul_f32 v49, s96, v49
    v_mul_f32 v50, s96, v50
    v_mul_f32 v51, s96, v51
    v_mul_f32 v52, s96, v52
    v_mul_f32 v53, s96, v53
    v_mul_f32 v54, s96, v54
    v_mul_f32 v55, s96, v55
    v_cvt_pk_bf16_f32 v24, v48, v49
    v_cvt_pk_bf16_f32 v25, v50, v51
    v_cvt_pk_bf16_f32 v26, v52, v53
    v_cvt_pk_bf16_f32 v27, v54, v55
    v_min_u32 v24, -2, v24
    v_min_u32 v25, -2, v25
    v_min_u32 v26, -2, v26
    v_min_u32 v27, -2, v27
    v_lshrrev_b32 v5, 2, v3
    v_lshlrev_b32 v5, 15, v5
    v_lshl_add_u32 v5, v4, 4, v5
    v_and_b32 v6, 3, v3
    v_lshl_add_u32 v5, v6, 6, v5
    s_lshl_b32 s54, s52, 10
    s_lshl_b32 s55, s3, 8
    s_add_u32 s54, s54, s55
    s_add_u32 s54, s54, 1048576
    buffer_store_dwordx4 v[24:27], v5, s[44:47], s54 offen sc1
    buffer_load_dwordx4 a[0:3], v121, s[40:43], s62 offen nt
    s_add_u32 s62, s62, 8192
    buffer_load_dwordx4 a[4:7], v121, s[40:43], s62 offen nt
    s_add_u32 s62, s62, 8192
    buffer_load_dwordx4 a[8:11], v121, s[40:43], s62 offen nt
    s_add_u32 s62, s62, 8192
    buffer_load_dwordx4 a[12:15], v121, s[40:43], s62 offen nt
    s_add_u32 s62, s62, 8192
    buffer_load_dwordx4 a[16:19], v121, s[40:43], s62 offen nt
    s_add_u32 s62, s62, 8192
    buffer_load_dwordx4 a[20:23], v121, s[40:43], s62 offen nt
    s_add_u32 s62, s62, 8192
    buffer_load_dwordx4 a[24:27], v121, s[40:43], s62 offen nt
    s_add_u32 s62, s62, 8192
    buffer_load_dwordx4 a[28:31], v121, s[40:43], s62 offen nt
    s_add_u32 s62, s62, 8192
    buffer_load_dwordx4 a[32:35], v121, s[40:43], s62 offen nt
    s_add_u32 s62, s62, 8192
    buffer_load_dwordx4 a[36:39], v121, s[40:43], s62 offen nt
    s_add_u32 s62, s62, 8192
    buffer_load_dwordx4 a[40:43], v121, s[40:43], s62 offen nt
    s_add_u32 s62, s62, 8192
    buffer_load_dwordx4 a[44:47], v121, s[40:43], s62 offen nt
    s_add_u32 s62, s62, 8192
    buffer_load_dwordx4 a[48:51], v121, s[40:43], s62 offen nt
    s_add_u32 s62, s62, 8192
    buffer_load_dwordx4 a[52:55], v121, s[40:43], s62 offen nt
    s_add_u32 s62, s62, 8192
    buffer_load_dwordx4 a[56:59], v121, s[40:43], s62 offen nt
    s_add_u32 s62, s62, 8192
    buffer_load_dwordx4 a[60:63], v121, s[40:43], s62 offen nt
    s_add_u32 s62, s62, 8192
    buffer_load_dwordx4 a[64:67], v121, s[40:43], s62 offen nt
    s_add_u32 s62, s62, 8192
    buffer_load_dwordx4 a[68:71], v121, s[40:43], s62 offen nt
    s_add_u32 s62, s62, 8192
    buffer_load_dwordx4 a[72:75], v121, s[40:43], s62 offen nt
    s_add_u32 s62, s62, 8192
    buffer_load_dwordx4 a[76:79], v121, s[40:43], s62 offen nt
    s_add_u32 s62, s62, 8192
    buffer_load_dwordx4 a[80:83], v121, s[40:43], s62 offen nt
    s_add_u32 s62, s62, 8192
    buffer_load_dwordx4 a[84:87], v121, s[40:43], s62 offen nt
    s_add_u32 s62, s62, 8192
    buffer_load_dwordx4 a[88:91], v121, s[40:43], s62 offen nt
    s_add_u32 s62, s62, 8192
    buffer_load_dwordx4 a[92:95], v121, s[40:43], s62 offen nt
    s_add_u32 s62, s62, 8192
    buffer_load_dwordx4 a[96:99], v121, s[40:43], s62 offen nt
    s_add_u32 s62, s62, 8192
    buffer_load_dwordx4 a[100:103], v121, s[40:43], s62 offen nt
    s_add_u32 s62, s62, 8192
    buffer_load_dwordx4 a[104:107], v121, s[40:43], s62 offen nt
    s_add_u32 s62, s62, 8192
    buffer_load_dwordx4 a[108:111], v121, s[40:43], s62 offen nt
    s_add_u32 s62, s62, 8192
    buffer_load_dwordx4 a[112:115], v121, s[40:43], s62 offen nt
    s_add_u32 s62, s62, 8192
    buffer_load_dwordx4 a[116:119], v121, s[40:43], s62 offen nt
    s_add_u32 s62, s62, 8192
    buffer_load_dwordx4 a[120:123], v121, s[40:43], s62 offen nt
    s_add_u32 s62, s62, 8192
    buffer_load_dwordx4 a[124:127], v121, s[40:43], s62 offen nt
    s_add_u32 s62, s62, 8192
    v_and_b32 v16, 31, v1
    v_lshlrev_b32 v16, 2, v16
    global_load_dword v17, v16, s[28:29] sc1
    s_waitcnt vmcnt(0)
    s_barrier
L_flags_18:
    v_cmp_gt_u32 vcc, 2, v17
    s_cbranch_vccz L_flagsok_19
    s_sleep 2
    global_load_dword v17, v16, s[28:29] sc1
    s_waitcnt vmcnt(0)
    s_sub_u32 s101, s101, 1
    s_cbranch_scc0 L_flags_18
    s_mov_b32 s101, 0
L_flagsok_19:
    s_lshl_b32 s58, s3, 18
    s_lshl_b32 s54, s52, 10
    s_add_u32 s58, s58, s54
    s_add_u32 s58, s58, 2097152
    s_lshl_b32 s59, s3, 11
    s_lshl_b32 s54, s52, 3
    s_add_u32 s59, s59, s54
    s_add_u32 s59, s59, 3145728
    s_mov_b32 s98, 0xffff0000
    v_and_b32 v5, 7, v1
    v_lshlrev_b32 v5, 8, v5
L_blight_20:
    buffer_load_dwordx2 v[232:233], v5, s[44:47], s59 offen sc1
    s_waitcnt vmcnt(0)
    v_max_u32 v6, v232, v233
    v_cmp_eq_u32 vcc, -1, v6
    s_cbranch_vccz L_bheavy_21
    s_sleep 2
    s_sub_u32 s101, s101, 1
    s_cbranch_scc0 L_blight_20
    s_mov_b32 s101, 0
L_bheavy_21:
    buffer_load_dwordx4 v[16:19], v2, s[44:47], s58 offen sc1 nt
    s_add_u32 s58, s58, 32768
    buffer_load_dwordx4 v[20:23], v2, s[44:47], s58 offen sc1 nt
    s_add_u32 s58, s58, 32768
    buffer_load_dwordx4 v[24:27], v2, s[44:47], s58 offen sc1 nt
    s_add_u32 s58, s58, 32768
    buffer_load_dwordx4 v[28:31], v2, s[44:47], s58 offen sc1 nt
    s_add_u32 s58, s58, 32768
    buffer_load_dwordx4 v[32:35], v2, s[44:47], s58 offen sc1 nt
    s_add_u32 s58, s58, 32768
    buffer_load_dwordx4 v[36:39], v2, s[44:47], s58 offen sc1 nt
    s_add_u32 s58, s58, 32768
    buffer_load_dwordx4 v[40:43], v2, s[44:47], s58 offen sc1 nt
    s_add_u32 s58, s58, 32768
    buffer_load_dwordx4 v[44:47], v2, s[44:47], s58 offen sc1 nt
    s_add_u32 s58, s58, 32768
    v_max_f32_dpp v234, v232, v232 row_ror:1 row_mask:0xf bank_mask:0xf
    s_nop 1
    v_max_f32_dpp v234, v234, v234 row_ror:2 row_mask:0xf bank_mask:0xf
    s_nop 1
    v_max_f32_dpp v234, v234, v234 row_ror:4 row_mask:0xf bank_mask:0xf
    v_sub_f32 v232, v232, v234
    v_exp_f32 v232, v232
    s_nop 0
    v_mul_f32 v232, v232, v233
    s_nop 1
    v_add_f32_dpp v234, v232, v232 row_ror:1 row_mask:0xf bank_mask:0xf
    s_nop 1
    v_add_f32_dpp v234, v234, v234 row_ror:2 row_mask:0xf bank_mask:0xf
    s_nop 1
    v_add_f32_dpp v234, v234, v234 row_ror:4 row_mask:0xf bank_mask:0xf
    v_rcp_f32 v234, v234
    s_nop 0
    v_mul_f32 v232, v232, v234
    s_waitcnt vmcnt(7)
    v_lshlrev_b32 v240, 16, v16
    v_and_b32 v16, s98, v16
    v_lshlrev_b32 v241, 16, v17
    v_and_b32 v17, s98, v17
    v_lshlrev_b32 v242, 16, v18
    v_and_b32 v18, s98, v18
    v_lshlrev_b32 v243, 16, v19
    v_and_b32 v19, s98, v19
    v_mul_f32_dpp v224, v232, v240 row_newbcast:0 row_mask:0xf bank_mask:0xf
    v_mul_f32_dpp v225, v232, v16 row_newbcast:0 row_mask:0xf bank_mask:0xf
    v_mul_f32_dpp v226, v232, v241 row_newbcast:0 row_mask:0xf bank_mask:0xf
    v_mul_f32_dpp v227, v232, v17 row_newbcast:0 row_mask:0xf bank_mask:0xf
    v_mul_f32_dpp v228, v232, v242 row_newbcast:0 row_mask:0xf bank_mask:0xf
    v_mul_f32_dpp v229, v232, v18 row_newbcast:0 row_mask:0xf bank_mask:0xf
    v_mul_f32_dpp v230, v232, v243 row_newbcast:0 row_mask:0xf bank_mask:0xf
    v_mul_f32_dpp v231, v232, v19 row_newbcast:0 row_mask:0xf bank_mask:0xf
    s_waitcnt vmcnt(6)
    v_lshlrev_b32 v240, 16, v20
    v_and_b32 v20, s98, v20
    v_lshlrev_b32 v241, 16, v21
    v_and_b32 v21, s98, v21
    v_lshlrev_b32 v242, 16, v22
    v_and_b32 v22, s98, v22
    v_lshlrev_b32 v243, 16, v23
    v_and_b32 v23, s98, v23
    v_fmac_f32_dpp v224, v232, v240 row_newbcast:1 row_mask:0xf bank_mask:0xf
    v_fmac_f32_dpp v225, v232, v20 row_newbcast:1 row_mask:0xf bank_mask:0xf
    v_fmac_f32_dpp v226, v232, v241 row_newbcast:1 row_mask:0xf bank_mask:0xf
    v_fmac_f32_dpp v227, v232, v21 row_newbcast:1 row_mask:0xf bank_mask:0xf
    v_fmac_f32_dpp v228, v232, v242 row_newbcast:1 row_mask:0xf bank_mask:0xf
    v_fmac_f32_dpp v229, v232, v22 row_newbcast:1 row_mask:0xf bank_mask:0xf
    v_fmac_f32_dpp v230, v232, v243 row_newbcast:1 row_mask:0xf bank_mask:0xf
    v_fmac_f32_dpp v231, v232, v23 row_newbcast:1 row_mask:0xf bank_mask:0xf
    s_waitcnt vmcnt(5)
    v_lshlrev_b32 v240, 16, v24
    v_and_b32 v24, s98, v24
    v_lshlrev_b32 v241, 16, v25
    v_and_b32 v25, s98, v25
    v_lshlrev_b32 v242, 16, v26
    v_and_b32 v26, s98, v26
    v_lshlrev_b32 v243, 16, v27
    v_and_b32 v27, s98, v27
    v_fmac_f32_dpp v224, v232, v240 row_newbcast:2 row_mask:0xf bank_mask:0xf
    v_fmac_f32_dpp v225, v232, v24 row_newbcast:2 row_mask:0xf bank_mask:0xf
    v_fmac_f32_dpp v226, v232, v241 row_newbcast:2 row_mask:0xf bank_mask:0xf
    v_fmac_f32_dpp v227, v232, v25 row_newbcast:2 row_mask:0xf bank_mask:0xf
    v_fmac_f32_dpp v228, v232, v242 row_newbcast:2 row_mask:0xf bank_mask:0xf
    v_fmac_f32_dpp v229, v232, v26 row_newbcast:2 row_mask:0xf bank_mask:0xf
    v_fmac_f32_dpp v230, v232, v243 row_newbcast:2 row_mask:0xf bank_mask:0xf
    v_fmac_f32_dpp v231, v232, v27 row_newbcast:2 row_mask:0xf bank_mask:0xf
    s_waitcnt vmcnt(4)
    v_lshlrev_b32 v240, 16, v28
    v_and_b32 v28, s98, v28
    v_lshlrev_b32 v241, 16, v29
    v_and_b32 v29, s98, v29
    v_lshlrev_b32 v242, 16, v30
    v_and_b32 v30, s98, v30
    v_lshlrev_b32 v243, 16, v31
    v_and_b32 v31, s98, v31
    v_fmac_f32_dpp v224, v232, v240 row_newbcast:3 row_mask:0xf bank_mask:0xf
    v_fmac_f32_dpp v225, v232, v28 row_newbcast:3 row_mask:0xf bank_mask:0xf
    v_fmac_f32_dpp v226, v232, v241 row_newbcast:3 row_mask:0xf bank_mask:0xf
    v_fmac_f32_dpp v227, v232, v29 row_newbcast:3 row_mask:0xf bank_mask:0xf
    v_fmac_f32_dpp v228, v232, v242 row_newbcast:3 row_mask:0xf bank_mask:0xf
    v_fmac_f32_dpp v229, v232, v30 row_newbcast:3 row_mask:0xf bank_mask:0xf
    v_fmac_f32_dpp v230, v232, v243 row_newbcast:3 row_mask:0xf bank_mask:0xf
    v_fmac_f32_dpp v231, v232, v31 row_newbcast:3 row_mask:0xf bank_mask:0xf
    s_waitcnt vmcnt(3)
    v_lshlrev_b32 v240, 16, v32
    v_and_b32 v32, s98, v32
    v_lshlrev_b32 v241, 16, v33
    v_and_b32 v33, s98, v33
    v_lshlrev_b32 v242, 16, v34
    v_and_b32 v34, s98, v34
    v_lshlrev_b32 v243, 16, v35
    v_and_b32 v35, s98, v35
    v_fmac_f32_dpp v224, v232, v240 row_newbcast:4 row_mask:0xf bank_mask:0xf
    v_fmac_f32_dpp v225, v232, v32 row_newbcast:4 row_mask:0xf bank_mask:0xf
    v_fmac_f32_dpp v226, v232, v241 row_newbcast:4 row_mask:0xf bank_mask:0xf
    v_fmac_f32_dpp v227, v232, v33 row_newbcast:4 row_mask:0xf bank_mask:0xf
    v_fmac_f32_dpp v228, v232, v242 row_newbcast:4 row_mask:0xf bank_mask:0xf
    v_fmac_f32_dpp v229, v232, v34 row_newbcast:4 row_mask:0xf bank_mask:0xf
    v_fmac_f32_dpp v230, v232, v243 row_newbcast:4 row_mask:0xf bank_mask:0xf
    v_fmac_f32_dpp v231, v232, v35 row_newbcast:4 row_mask:0xf bank_mask:0xf
    s_waitcnt vmcnt(2)
    v_lshlrev_b32 v240, 16, v36
    v_and_b32 v36, s98, v36
    v_lshlrev_b32 v241, 16, v37
    v_and_b32 v37, s98, v37
    v_lshlrev_b32 v242, 16, v38
    v_and_b32 v38, s98, v38
    v_lshlrev_b32 v243, 16, v39
    v_and_b32 v39, s98, v39
    v_fmac_f32_dpp v224, v232, v240 row_newbcast:5 row_mask:0xf bank_mask:0xf
    v_fmac_f32_dpp v225, v232, v36 row_newbcast:5 row_mask:0xf bank_mask:0xf
    v_fmac_f32_dpp v226, v232, v241 row_newbcast:5 row_mask:0xf bank_mask:0xf
    v_fmac_f32_dpp v227, v232, v37 row_newbcast:5 row_mask:0xf bank_mask:0xf
    v_fmac_f32_dpp v228, v232, v242 row_newbcast:5 row_mask:0xf bank_mask:0xf
    v_fmac_f32_dpp v229, v232, v38 row_newbcast:5 row_mask:0xf bank_mask:0xf
    v_fmac_f32_dpp v230, v232, v243 row_newbcast:5 row_mask:0xf bank_mask:0xf
    v_fmac_f32_dpp v231, v232, v39 row_newbcast:5 row_mask:0xf bank_mask:0xf
    s_waitcnt vmcnt(1)
    v_lshlrev_b32 v240, 16, v40
    v_and_b32 v40, s98, v40
    v_lshlrev_b32 v241, 16, v41
    v_and_b32 v41, s98, v41
    v_lshlrev_b32 v242, 16, v42
    v_and_b32 v42, s98, v42
    v_lshlrev_b32 v243, 16, v43
    v_and_b32 v43, s98, v43
    v_fmac_f32_dpp v224, v232, v240 row_newbcast:6 row_mask:0xf bank_mask:0xf
    v_fmac_f32_dpp v225, v232, v40 row_newbcast:6 row_mask:0xf bank_mask:0xf
    v_fmac_f32_dpp v226, v232, v241 row_newbcast:6 row_mask:0xf bank_mask:0xf
    v_fmac_f32_dpp v227, v232, v41 row_newbcast:6 row_mask:0xf bank_mask:0xf
    v_fmac_f32_dpp v228, v232, v242 row_newbcast:6 row_mask:0xf bank_mask:0xf
    v_fmac_f32_dpp v229, v232, v42 row_newbcast:6 row_mask:0xf bank_mask:0xf
    v_fmac_f32_dpp v230, v232, v243 row_newbcast:6 row_mask:0xf bank_mask:0xf
    v_fmac_f32_dpp v231, v232, v43 row_newbcast:6 row_mask:0xf bank_mask:0xf
    s_waitcnt vmcnt(0)
    v_lshlrev_b32 v240, 16, v44
    v_and_b32 v44, s98, v44
    v_lshlrev_b32 v241, 16, v45
    v_and_b32 v45, s98, v45
    v_lshlrev_b32 v242, 16, v46
    v_and_b32 v46, s98, v46
    v_lshlrev_b32 v243, 16, v47
    v_and_b32 v47, s98, v47
    v_fmac_f32_dpp v224, v232, v240 row_newbcast:7 row_mask:0xf bank_mask:0xf
    v_fmac_f32_dpp v225, v232, v44 row_newbcast:7 row_mask:0xf bank_mask:0xf
    v_fmac_f32_dpp v226, v232, v241 row_newbcast:7 row_mask:0xf bank_mask:0xf
    v_fmac_f32_dpp v227, v232, v45 row_newbcast:7 row_mask:0xf bank_mask:0xf
    v_fmac_f32_dpp v228, v232, v242 row_newbcast:7 row_mask:0xf bank_mask:0xf
    v_fmac_f32_dpp v229, v232, v46 row_newbcast:7 row_mask:0xf bank_mask:0xf
    v_fmac_f32_dpp v230, v232, v243 row_newbcast:7 row_mask:0xf bank_mask:0xf
    v_fmac_f32_dpp v231, v232, v47 row_newbcast:7 row_mask:0xf bank_mask:0xf
    v_cvt_pk_bf16_f32 v244, v224, v225
    v_cvt_pk_bf16_f32 v245, v226, v227
    v_cvt_pk_bf16_f32 v246, v228, v229
    v_cvt_pk_bf16_f32 v247, v230, v231
    s_lshl_b32 s54, s3, 10
    v_add_u32 v5, s54, v2
    ds_write_b128 v5, v[244:247]
    v_lshrrev_b32 v5, 3, v3
    v_lshlrev_b32 v5, 10, v5
    v_lshl_add_u32 v5, v4, 6, v5
    s_lshl_b32 s54, s3, 8
    v_add_u32 v5, s54, v5
    s_waitcnt lgkmcnt(0)
    s_barrier
    ds_read_b128 v[16:19], v5 offset:0
    ds_read_b128 v[20:23], v5 offset:16
    ds_read_b128 v[24:27], v5 offset:32
    ds_read_b128 v[28:31], v5 offset:48
    ds_read_b128 v[32:35], v5 offset:2048
    ds_read_b128 v[36:39], v5 offset:2064
    ds_read_b128 v[40:43], v5 offset:2080
    ds_read_b128 v[44:47], v5 offset:2096
    s_waitcnt lgkmcnt(0)
    v_perm_b32 v48, v16, v16, v8
    v_perm_b32 v49, v16, v16, v10
    v_perm_b32 v50, v16, v16, v12
    v_perm_b32 v51, v16, v16, v14
    s_nop 1
    v_mfma_f32_16x16x32_bf16 v[224:227], v[48:51], a[0:3], 0
    v_perm_b32 v52, v32, v32, v8
    v_perm_b32 v53, v32, v32, v10
    v_perm_b32 v54, v32, v32, v12
    v_perm_b32 v55, v32, v32, v14
    s_nop 1
    v_mfma_f32_16x16x32_bf16 v[228:231], v[52:55], a[0:3], 0
    v_perm_b32 v56, v16, v16, v9
    v_perm_b32 v57, v16, v16, v11
    v_perm_b32 v58, v16, v16, v13
    v_perm_b32 v59, v16, v16, v15
    s_nop 1
    v_mfma_f32_16x16x32_bf16 v[224:227], v[56:59], a[4:7], v[224:227]
    v_perm_b32 v60, v32, v32, v9
    v_perm_b32 v61, v32, v32, v11
    v_perm_b32 v62, v32, v32, v13
    v_perm_b32 v63, v32, v32, v15
    s_nop 1
    v_mfma_f32_16x16x32_bf16 v[228:231], v[60:63], a[4:7], v[228:231]
    v_perm_b32 v48, v17, v17, v8
    v_perm_b32 v49, v17, v17, v10
    v_perm_b32 v50, v17, v17, v12
    v_perm_b32 v51, v17, v17, v14
    s_nop 1
    v_mfma_f32_16x16x32_bf16 v[224:227], v[48:51], a[8:11], v[224:227]
    v_perm_b32 v52, v33, v33, v8
    v_perm_b32 v53, v33, v33, v10
    v_perm_b32 v54, v33, v33, v12
    v_perm_b32 v55, v33, v33, v14
    s_nop 1
    v_mfma_f32_16x16x32_bf16 v[228:231], v[52:55], a[8:11], v[228:231]
    v_perm_b32 v56, v17, v17, v9
    v_perm_b32 v57, v17, v17, v11
    v_perm_b32 v58, v17, v17, v13
    v_perm_b32 v59, v17, v17, v15
    s_nop 1
    v_mfma_f32_16x16x32_bf16 v[224:227], v[56:59], a[12:15], v[224:227]
    v_perm_b32 v60, v33, v33, v9
    v_perm_b32 v61, v33, v33, v11
    v_perm_b32 v62, v33, v33, v13
    v_perm_b32 v63, v33, v33, v15
    s_nop 1
    v_mfma_f32_16x16x32_bf16 v[228:231], v[60:63], a[12:15], v[228:231]
    v_perm_b32 v48, v18, v18, v8
    v_perm_b32 v49, v18, v18, v10
    v_perm_b32 v50, v18, v18, v12
    v_perm_b32 v51, v18, v18, v14
    s_nop 1
    v_mfma_f32_16x16x32_bf16 v[224:227], v[48:51], a[16:19], v[224:227]
    v_perm_b32 v52, v34, v34, v8
    v_perm_b32 v53, v34, v34, v10
    v_perm_b32 v54, v34, v34, v12
    v_perm_b32 v55, v34, v34, v14
    s_nop 1
    v_mfma_f32_16x16x32_bf16 v[228:231], v[52:55], a[16:19], v[228:231]
    v_perm_b32 v56, v18, v18, v9
    v_perm_b32 v57, v18, v18, v11
    v_perm_b32 v58, v18, v18, v13
    v_perm_b32 v59, v18, v18, v15
    s_nop 1
    v_mfma_f32_16x16x32_bf16 v[224:227], v[56:59], a[20:23], v[224:227]
    v_perm_b32 v60, v34, v34, v9
    v_perm_b32 v61, v34, v34, v11
    v_perm_b32 v62, v34, v34, v13
    v_perm_b32 v63, v34, v34, v15
    s_nop 1
    v_mfma_f32_16x16x32_bf16 v[228:231], v[60:63], a[20:23], v[228:231]
    v_perm_b32 v48, v19, v19, v8
    v_perm_b32 v49, v19, v19, v10
    v_perm_b32 v50, v19, v19, v12
    v_perm_b32 v51, v19, v19, v14
    s_nop 1
    v_mfma_f32_16x16x32_bf16 v[224:227], v[48:51], a[24:27], v[224:227]
    v_perm_b32 v52, v35, v35, v8
    v_perm_b32 v53, v35, v35, v10
    v_perm_b32 v54, v35, v35, v12
    v_perm_b32 v55, v35, v35, v14
    s_nop 1
    v_mfma_f32_16x16x32_bf16 v[228:231], v[52:55], a[24:27], v[228:231]
    v_perm_b32 v56, v19, v19, v9
    v_perm_b32 v57, v19, v19, v11
    v_perm_b32 v58, v19, v19, v13
    v_perm_b32 v59, v19, v19, v15
    s_nop 1
    v_mfma_f32_16x16x32_bf16 v[224:227], v[56:59], a[28:31], v[224:227]
    v_perm_b32 v60, v35, v35, v9
    v_perm_b32 v61, v35, v35, v11
    v_perm_b32 v62, v35, v35, v13
    v_perm_b32 v63, v35, v35, v15
    s_nop 1
    v_mfma_f32_16x16x32_bf16 v[228:231], v[60:63], a[28:31], v[228:231]
    v_perm_b32 v48, v20, v20, v8
    v_perm_b32 v49, v20, v20, v10
    v_perm_b32 v50, v20, v20, v12
    v_perm_b32 v51, v20, v20, v14
    s_nop 1
    v_mfma_f32_16x16x32_bf16 v[224:227], v[48:51], a[32:35], v[224:227]
    v_perm_b32 v52, v36, v36, v8
    v_perm_b32 v53, v36, v36, v10
    v_perm_b32 v54, v36, v36, v12
    v_perm_b32 v55, v36, v36, v14
    s_nop 1
    v_mfma_f32_16x16x32_bf16 v[228:231], v[52:55], a[32:35], v[228:231]
    v_perm_b32 v56, v20, v20, v9
    v_perm_b32 v57, v20, v20, v11
    v_perm_b32 v58, v20, v20, v13
    v_perm_b32 v59, v20, v20, v15
    s_nop 1
    v_mfma_f32_16x16x32_bf16 v[224:227], v[56:59], a[36:39], v[224:227]
    v_perm_b32 v60, v36, v36, v9
    v_perm_b32 v61, v36, v36, v11
    v_perm_b32 v62, v36, v36, v13
    v_perm_b32 v63, v36, v36, v15
    s_nop 1
    v_mfma_f32_16x16x32_bf16 v[228:231], v[60:63], a[36:39], v[228:231]
    v_perm_b32 v48, v21, v21, v8
    v_perm_b32 v49, v21, v21, v10
    v_perm_b32 v50, v21, v21, v12
    v_perm_b32 v51, v21, v21, v14
    s_nop 1
    v_mfma_f32_16x16x32_bf16 v[224:227], v[48:51], a[40:43], v[224:227]
    v_perm_b32 v52, v37, v37, v8
    v_perm_b32 v53, v37, v37, v10
    v_perm_b32 v54, v37, v37, v12
    v_perm_b32 v55, v37, v37, v14
    s_nop 1
    v_mfma_f32_16x16x32_bf16 v[228:231], v[52:55], a[40:43], v[228:231]
    v_perm_b32 v56, v21, v21, v9
    v_perm_b32 v57, v21, v21, v11
    v_perm_b32 v58, v21, v21, v13
    v_perm_b32 v59, v21, v21, v15
    s_nop 1
    v_mfma_f32_16x16x32_bf16 v[224:227], v[56:59], a[44:47], v[224:227]
    v_perm_b32 v60, v37, v37, v9
    v_perm_b32 v61, v37, v37, v11
    v_perm_b32 v62, v37, v37, v13
    v_perm_b32 v63, v37, v37, v15
    s_nop 1
    v_mfma_f32_16x16x32_bf16 v[228:231], v[60:63], a[44:47], v[228:231]
    v_perm_b32 v48, v22, v22, v8
    v_perm_b32 v49, v22, v22, v10
    v_perm_b32 v50, v22, v22, v12
    v_perm_b32 v51, v22, v22, v14
    s_nop 1
    v_mfma_f32_16x16x32_bf16 v[224:227], v[48:51], a[48:51], v[224:227]
    v_perm_b32 v52, v38, v38, v8
    v_perm_b32 v53, v38, v38, v10
    v_perm_b32 v54, v38, v38, v12
    v_perm_b32 v55, v38, v38, v14
    s_nop 1
    v_mfma_f32_16x16x32_bf16 v[228:231], v[52:55], a[48:51], v[228:231]
    v_perm_b32 v56, v22, v22, v9
    v_perm_b32 v57, v22, v22, v11
    v_perm_b32 v58, v22, v22, v13
    v_perm_b32 v59, v22, v22, v15
    s_nop 1
    v_mfma_f32_16x16x32_bf16 v[224:227], v[56:59], a[52:55], v[224:227]
    v_perm_b32 v60, v38, v38, v9
    v_perm_b32 v61, v38, v38, v11
    v_perm_b32 v62, v38, v38, v13
    v_perm_b32 v63, v38, v38, v15
    s_nop 1
    v_mfma_f32_16x16x32_bf16 v[228:231], v[60:63], a[52:55], v[228:231]
    v_perm_b32 v48, v23, v23, v8
    v_perm_b32 v49, v23, v23, v10
    v_perm_b32 v50, v23, v23, v12
    v_perm_b32 v51, v23, v23, v14
    s_nop 1
    v_mfma_f32_16x16x32_bf16 v[224:227], v[48:51], a[56:59], v[224:227]
    v_perm_b32 v52, v39, v39, v8
    v_perm_b32 v53, v39, v39, v10
    v_perm_b32 v54, v39, v39, v12
    v_perm_b32 v55, v39, v39, v14
    s_nop 1
    v_mfma_f32_16x16x32_bf16 v[228:231], v[52:55], a[56:59], v[228:231]
    v_perm_b32 v56, v23, v23, v9
    v_perm_b32 v57, v23, v23, v11
    v_perm_b32 v58, v23, v23, v13
    v_perm_b32 v59, v23, v23, v15
    s_nop 1
    v_mfma_f32_16x16x32_bf16 v[224:227], v[56:59], a[60:63], v[224:227]
    v_perm_b32 v60, v39, v39, v9
    v_perm_b32 v61, v39, v39, v11
    v_perm_b32 v62, v39, v39, v13
    v_perm_b32 v63, v39, v39, v15
    s_nop 1
    v_mfma_f32_16x16x32_bf16 v[228:231], v[60:63], a[60:63], v[228:231]
    v_perm_b32 v48, v24, v24, v8
    v_perm_b32 v49, v24, v24, v10
    v_perm_b32 v50, v24, v24, v12
    v_perm_b32 v51, v24, v24, v14
    s_nop 1
    v_mfma_f32_16x16x32_bf16 v[224:227], v[48:51], a[64:67], v[224:227]
    v_perm_b32 v52, v40, v40, v8
    v_perm_b32 v53, v40, v40, v10
    v_perm_b32 v54, v40, v40, v12
    v_perm_b32 v55, v40, v40, v14
    s_nop 1
    v_mfma_f32_16x16x32_bf16 v[228:231], v[52:55], a[64:67], v[228:231]
    v_perm_b32 v56, v24, v24, v9
    v_perm_b32 v57, v24, v24, v11
    v_perm_b32 v58, v24, v24, v13
    v_perm_b32 v59, v24, v24, v15
    s_nop 1
    v_mfma_f32_16x16x32_bf16 v[224:227], v[56:59], a[68:71], v[224:227]
    v_perm_b32 v60, v40, v40, v9
    v_perm_b32 v61, v40, v40, v11
    v_perm_b32 v62, v40, v40, v13
    v_perm_b32 v63, v40, v40, v15
    s_nop 1
    v_mfma_f32_16x16x32_bf16 v[228:231], v[60:63], a[68:71], v[228:231]
    v_perm_b32 v48, v25, v25, v8
    v_perm_b32 v49, v25, v25, v10
    v_perm_b32 v50, v25, v25, v12
    v_perm_b32 v51, v25, v25, v14
    s_nop 1
    v_mfma_f32_16x16x32_bf16 v[224:227], v[48:51], a[72:75], v[224:227]
    v_perm_b32 v52, v41, v41, v8
    v_perm_b32 v53, v41, v41, v10
    v_perm_b32 v54, v41, v41, v12
    v_perm_b32 v55, v41, v41, v14
    s_nop 1
    v_mfma_f32_16x16x32_bf16 v[228:231], v[52:55], a[72:75], v[228:231]
    v_perm_b32 v56, v25, v25, v9
    v_perm_b32 v57, v25, v25, v11
    v_perm_b32 v58, v25, v25, v13
    v_perm_b32 v59, v25, v25, v15
    s_nop 1
    v_mfma_f32_16x16x32_bf16 v[224:227], v[56:59], a[76:79], v[224:227]
    v_perm_b32 v60, v41, v41, v9
    v_perm_b32 v61, v41, v41, v11
    v_perm_b32 v62, v41, v41, v13
    v_perm_b32 v63, v41, v41, v15
    s_nop 1
    v_mfma_f32_16x16x32_bf16 v[228:231], v[60:63], a[76:79], v[228:231]
    v_perm_b32 v48, v26, v26, v8
    v_perm_b32 v49, v26, v26, v10
    v_perm_b32 v50, v26, v26, v12
    v_perm_b32 v51, v26, v26, v14
    s_nop 1
    v_mfma_f32_16x16x32_bf16 v[224:227], v[48:51], a[80:83], v[224:227]
    v_perm_b32 v52, v42, v42, v8
    v_perm_b32 v53, v42, v42, v10
    v_perm_b32 v54, v42, v42, v12
    v_perm_b32 v55, v42, v42, v14
    s_nop 1
    v_mfma_f32_16x16x32_bf16 v[228:231], v[52:55], a[80:83], v[228:231]
    v_perm_b32 v56, v26, v26, v9
    v_perm_b32 v57, v26, v26, v11
    v_perm_b32 v58, v26, v26, v13
    v_perm_b32 v59, v26, v26, v15
    s_nop 1
    v_mfma_f32_16x16x32_bf16 v[224:227], v[56:59], a[84:87], v[224:227]
    v_perm_b32 v60, v42, v42, v9
    v_perm_b32 v61, v42, v42, v11
    v_perm_b32 v62, v42, v42, v13
    v_perm_b32 v63, v42, v42, v15
    s_nop 1
    v_mfma_f32_16x16x32_bf16 v[228:231], v[60:63], a[84:87], v[228:231]
    v_perm_b32 v48, v27, v27, v8
    v_perm_b32 v49, v27, v27, v10
    v_perm_b32 v50, v27, v27, v12
    v_perm_b32 v51, v27, v27, v14
    s_nop 1
    v_mfma_f32_16x16x32_bf16 v[224:227], v[48:51], a[88:91], v[224:227]
    v_perm_b32 v52, v43, v43, v8
    v_perm_b32 v53, v43, v43, v10
    v_perm_b32 v54, v43, v43, v12
    v_perm_b32 v55, v43, v43, v14
    s_nop 1
    v_mfma_f32_16x16x32_bf16 v[228:231], v[52:55], a[88:91], v[228:231]
    v_perm_b32 v56, v27, v27, v9
    v_perm_b32 v57, v27, v27, v11
    v_perm_b32 v58, v27, v27, v13
    v_perm_b32 v59, v27, v27, v15
    s_nop 1
    v_mfma_f32_16x16x32_bf16 v[224:227], v[56:59], a[92:95], v[224:227]
    v_perm_b32 v60, v43, v43, v9
    v_perm_b32 v61, v43, v43, v11
    v_perm_b32 v62, v43, v43, v13
    v_perm_b32 v63, v43, v43, v15
    s_nop 1
    v_mfma_f32_16x16x32_bf16 v[228:231], v[60:63], a[92:95], v[228:231]
    v_perm_b32 v48, v28, v28, v8
    v_perm_b32 v49, v28, v28, v10
    v_perm_b32 v50, v28, v28, v12
    v_perm_b32 v51, v28, v28, v14
    s_nop 1
    v_mfma_f32_16x16x32_bf16 v[224:227], v[48:51], a[96:99], v[224:227]
    v_perm_b32 v52, v44, v44, v8
    v_perm_b32 v53, v44, v44, v10
    v_perm_b32 v54, v44, v44, v12
    v_perm_b32 v55, v44, v44, v14
    s_nop 1
    v_mfma_f32_16x16x32_bf16 v[228:231], v[52:55], a[96:99], v[228:231]
    v_perm_b32 v56, v28, v28, v9
    v_perm_b32 v57, v28, v28, v11
    v_perm_b32 v58, v28, v28, v13
    v_perm_b32 v59, v28, v28, v15
    s_nop 1
    v_mfma_f32_16x16x32_bf16 v[224:227], v[56:59], a[100:103], v[224:227]
    v_perm_b32 v60, v44, v44, v9
    v_perm_b32 v61, v44, v44, v11
    v_perm_b32 v62, v44, v44, v13
    v_perm_b32 v63, v44, v44, v15
    s_nop 1
    v_mfma_f32_16x16x32_bf16 v[228:231], v[60:63], a[100:103], v[228:231]
    v_perm_b32 v48, v29, v29, v8
    v_perm_b32 v49, v29, v29, v10
    v_perm_b32 v50, v29, v29, v12
    v_perm_b32 v51, v29, v29, v14
    s_nop 1
    v_mfma_f32_16x16x32_bf16 v[224:227], v[48:51], a[104:107], v[224:227]
    v_perm_b32 v52, v45, v45, v8
    v_perm_b32 v53, v45, v45, v10
    v_perm_b32 v54, v45, v45, v12
    v_perm_b32 v55, v45, v45, v14
    s_nop 1
    v_mfma_f32_16x16x32_bf16 v[228:231], v[52:55], a[104:107], v[228:231]
    v_perm_b32 v56, v29, v29, v9
    v_perm_b32 v57, v29, v29, v11
    v_perm_b32 v58, v29, v29, v13
    v_perm_b32 v59, v29, v29, v15
    s_nop 1
    v_mfma_f32_16x16x32_bf16 v[224:227], v[56:59], a[108:111], v[224:227]
    v_perm_b32 v60, v45, v45, v9
    v_perm_b32 v61, v45, v45, v11
    v_perm_b32 v62, v45, v45, v13
    v_perm_b32 v63, v45, v45, v15
    s_nop 1
    v_mfma_f32_16x16x32_bf16 v[228:231], v[60:63], a[108:111], v[228:231]
    v_perm_b32 v48, v30, v30, v8
    v_perm_b32 v49, v30, v30, v10
    v_perm_b32 v50, v30, v30, v12
    v_perm_b32 v51, v30, v30, v14
    s_nop 1
    v_mfma_f32_16x16x32_bf16 v[224:227], v[48:51], a[112:115], v[224:227]
    v_perm_b32 v52, v46, v46, v8
    v_perm_b32 v53, v46, v46, v10
    v_perm_b32 v54, v46, v46, v12
    v_perm_b32 v55, v46, v46, v14
    s_nop 1
    v_mfma_f32_16x16x32_bf16 v[228:231], v[52:55], a[112:115], v[228:231]
    v_perm_b32 v56, v30, v30, v9
    v_perm_b32 v57, v30, v30, v11
    v_perm_b32 v58, v30, v30, v13
    v_perm_b32 v59, v30, v30, v15
    s_nop 1
    v_mfma_f32_16x16x32_bf16 v[224:227], v[56:59], a[116:119], v[224:227]
    v_perm_b32 v60, v46, v46, v9
    v_perm_b32 v61, v46, v46, v11
    v_perm_b32 v62, v46, v46, v13
    v_perm_b32 v63, v46, v46, v15
    s_nop 1
    v_mfma_f32_16x16x32_bf16 v[228:231], v[60:63], a[116:119], v[228:231]
    v_perm_b32 v48, v31, v31, v8
    v_perm_b32 v49, v31, v31, v10
    v_perm_b32 v50, v31, v31, v12
    v_perm_b32 v51, v31, v31, v14
    s_nop 1
    v_mfma_f32_16x16x32_bf16 v[224:227], v[48:51], a[120:123], v[224:227]
    v_perm_b32 v52, v47, v47, v8
    v_perm_b32 v53, v47, v47, v10
    v_perm_b32 v54, v47, v47, v12
    v_perm_b32 v55, v47, v47, v14
    s_nop 1
    v_mfma_f32_16x16x32_bf16 v[228:231], v[52:55], a[120:123], v[228:231]
    v_perm_b32 v56, v31, v31, v9
    v_perm_b32 v57, v31, v31, v11
    v_perm_b32 v58, v31, v31, v13
    v_perm_b32 v59, v31, v31, v15
    s_nop 1
    v_mfma_f32_16x16x32_bf16 v[224:227], v[56:59], a[124:127], v[224:227]
    v_perm_b32 v60, v47, v47, v9
    v_perm_b32 v61, v47, v47, v11
    v_perm_b32 v62, v47, v47, v13
    v_perm_b32 v63, v47, v47, v15
    s_nop 1
    v_mfma_f32_16x16x32_bf16 v[228:231], v[60:63], a[124:127], v[228:231]
    v_lshrrev_b32 v5, 1, v4
    v_lshlrev_b32 v5, 9, v5
    v_lshl_add_u32 v5, v3, 5, v5
    v_and_b32 v6, 1, v4
    v_lshl_add_u32 v5, v6, 4, v5
    s_lshl_b32 s54, s3, 11
    s_add_u32 s54, s54, 131072
    v_add_u32 v5, s54, v5
    ds_write_b128 v5, v[224:227]
    ds_write_b128 v5, v[228:231] offset:1024
    s_waitcnt lgkmcnt(0)
    s_barrier
    v_lshrrev_b32 v5, 2, v3
    v_lshlrev_b32 v5, 9, v5
    v_lshl_add_u32 v5, v4, 5, v5
    s_lshl_b32 s54, s3, 7
    s_add_u32 s54, s54, 131072
    v_add_u32 v5, s54, v5
    ds_read_b128 v[16:19], v5 offset:0
    ds_read_b128 v[20:23], v5 offset:16
    ds_read_b128 v[24:27], v5 offset:2048
    ds_read_b128 v[28:31], v5 offset:2064
    ds_read_b128 v[32:35], v5 offset:4096
    ds_read_b128 v[36:39], v5 offset:4112
    ds_read_b128 v[40:43], v5 offset:6144
    ds_read_b128 v[44:47], v5 offset:6160
    s_waitcnt lgkmcnt(0)
    v_add_f32 v16, v16, v24
    v_add_f32 v32, v32, v40
    v_add_f32 v17, v17, v25
    v_add_f32 v33, v33, v41
    v_add_f32 v18, v18, v26
    v_add_f32 v34, v34, v42
    v_add_f32 v19, v19, v27
    v_add_f32 v35, v35, v43
    v_add_f32 v20, v20, v28
    v_add_f32 v36, v36, v44
    v_add_f32 v21, v21, v29
    v_add_f32 v37, v37, v45
    v_add_f32 v22, v22, v30
    v_add_f32 v38, v38, v46
    v_add_f32 v23, v23, v31
    v_add_f32 v39, v39, v47
    v_add_f32 v16, v16, v32
    v_add_f32 v17, v17, v33
    v_add_f32 v18, v18, v34
    v_add_f32 v19, v19, v35
    v_add_f32 v20, v20, v36
    v_add_f32 v21, v21, v37
    v_add_f32 v22, v22, v38
    v_add_f32 v23, v23, v39
    v_cvt_pk_bf16_f32 v64, v16, v17
    v_cvt_pk_bf16_f32 v65, v18, v19
    v_cvt_pk_bf16_f32 v66, v20, v21
    v_cvt_pk_bf16_f32 v67, v22, v23
    v_min_u32 v64, -2, v64
    v_min_u32 v65, -2, v65
    v_min_u32 v66, -2, v66
    v_min_u32 v67, -2, v67
    v_bfe_u32 v6, v1, 2, 2
    v_lshlrev_b32 v6, 6, v6
    v_and_b32 v5, 48, v1
    v_add_u32 v6, v6, v5
    v_and_b32 v5, 3, v1
    v_lshl_add_u32 v6, v5, 29, v6
    s_lshl_b32 s54, s52, 10
    s_lshl_b32 s55, s3, 8
    s_add_u32 s54, s54, s55
    s_add_u32 s54, s54, 5439488
    buffer_store_dwordx4 v[64:67], v6, s[44:47], s54 offen sc1
    s_mov_b32 s48, s26
    s_mov_b32 s49, s27
    s_mov_b32 s50, 9216
    s_mov_b32 s51, 0x20000
    s_lshl_b32 s54, s3, 5
    s_add_u32 s54, s54, s53
    s_cmp_ge_u32 s54, 72
    s_cbranch_scc1 L_nored_22
    v_mov_b32 v48, -1
    v_mov_b32 v49, -1
    v_mov_b32 v50, -1
    v_mov_b32 v51, -1
    v_mov_b32 v52, -1
    v_mov_b32 v53, -1
    v_mov_b32 v54, -1
    v_mov_b32 v55, -1
    v_mov_b32 v56, -1
    v_mov_b32 v57, -1
    v_mov_b32 v58, -1
    v_mov_b32 v59, -1
    v_mov_b32 v60, -1
    v_mov_b32 v61, -1
    v_mov_b32 v62, -1
    v_mov_b32 v63, -1
    s_lshl_b32 s55, s54, 12
    s_add_u32 s55, s55, 4718592
    s_mul_hi_u32 s56, s54, 238609295
    s_add_u32 s56, s56, 1
    s_mul_i32 s56, s56, 1152
    s_lshl_b32 s57, s54, 6
    s_add_u32 s56, s56, s57
    v_lshlrev_b32 v5, 3, v3
    v_lshl_add_u32 v5, v4, 1, v5
    v_mov_b32 v6, 0x4000
    v_cmp_gt_u32 vcc, 8, v3
    s_nop 1
    v_cndmask_b32 v5, v6, v5, vcc
    s_mov_b64 s[4:5], -1
    s_mov_b64 s[6:7], -1
    s_mov_b64 s[8:9], -1
    s_mov_b64 s[10:11], -1
L_mpoll_23:
    s_mov_b64 exec, s[4:5]
    buffer_load_dwordx4 v[48:51], v2, s[44:47], s55 offen offset:0 sc1
    s_mov_b64 exec, s[6:7]
    buffer_load_dwordx4 v[52:55], v2, s[44:47], s55 offen offset:1024 sc1
    s_mov_b64 exec, s[8:9]
    buffer_load_dwordx4 v[56:59], v2, s[44:47], s55 offen offset:2048 sc1
    s_mov_b64 exec, s[10:11]
    buffer_load_dwordx4 v[60:63], v2, s[44:47], s55 offen offset:3072 sc1
    s_mov_b64 exec, -1
    s_waitcnt vmcnt(4)
    v_max3_u32 v32, v48, v49, v50
    v_max3_u32 v33, v52, v53, v54
    v_max3_u32 v34, v56, v57, v58
    v_max3_u32 v35, v60, v61, v62
    v_max_u32 v32, v32, v51
    v_max_u32 v33, v33, v55
    v_max_u32 v34, v34, v59
    v_max_u32 v35, v35, v63
    v_cmp_eq_u32 s[4:5], -1, v32
    v_cmp_eq_u32 s[6:7], -1, v33
    v_cmp_eq_u32 s[8:9], -1, v34
    v_cmp_eq_u32 s[10:11], -1, v35
    s_or_b64 vcc, s[4:5], s[6:7]
    s_or_b64 vcc, vcc, s[8:9]
    s_or_b64 vcc, vcc, s[10:11]
    s_cbranch_scc0 L_mpollok_24
    s_and_b64 vcc, s[4:5], s[6:7]
    s_and_b64 vcc, vcc, s[8:9]
    s_and_b64 vcc, vcc, s[10:11]
    s_cmp_eq_u64 vcc, -1
    s_cbranch_scc0 L_mpoll_23_b
    s_sleep 4
L_mpoll_23_b:
    s_sub_u32 s101, s101, 1
    s_cbranch_scc0 L_mpoll_23
    s_mov_b32 s101, 0
L_mpollok_24:
    v_add_f32 v16, v48, v52
    v_add_f32 v24, v56, v60
    v_add_f32 v18, v50, v54
    v_add_f32 v26, v58, v62
    v_add_f32 v17, v49, v53
    v_add_f32 v25, v57, v61
    v_add_f32 v19, v51, v55
    v_add_f32 v27, v59, v63
    v_add_f32 v16, v16, v24
    v_add_f32 v18, v18, v26
    v_add_f32 v17, v17, v25
    v_add_f32 v19, v19, v27
    v_permlane32_swap_b32 v16, v18
    s_nop 0
    v_permlane32_swap_b32 v17, v19
    v_add_f32 v16, v16, v18
    v_add_f32 v17, v17, v19
    s_nop 1
    v_permlane16_swap_b32 v16, v17
    v_add_f32 v16, v16, v17
    s_nop 1
    v_add_f32_dpp v16, v16, v16 row_ror:8 row_mask:0xf bank_mask:0xf
    v_cvt_pk_bf16_f32 v16, v16, v16
    buffer_store_short v16, v5, s[48:51], s56 offen
L_nored_22:
    s_endpgm
L_roleH_end:
L_roleC:
    s_mov_b32 s101, 100000
    s_getpc_b64 s[56:57]
L_pc_25:
    s_sub_u32 s56, s56, L_pc_25-L_roleC
    s_subb_u32 s57, s57, 0
    v_lshlrev_b32 v5, 7, v0
    v_min_u32 v6, L_roleC_end-L_roleC-4, v5
    global_load_dword v122, v6, s[56:57]
    v_add_u32 v5, 32768, v5
    v_min_u32 v6, L_roleC_end-L_roleC-4, v5
    global_load_dword v122, v6, s[56:57]
    v_mov_b32 v20, -1
    v_mov_b32 v21, -1
    v_mov_b32 v22, -1
    v_mov_b32 v23, -1
    v_mul_u32_u24 v7, 73728, v4
    v_lshrrev_b32 v5, 3, v3
    v_lshl_add_u32 v6, v5, 13, v7
    v_and_b32 v5, 7, v3
    v_lshl_add_u32 v6, v5, 4, v6
    v_lshl_add_u32 v7, v3, 3, v7
    v_add_u32 v7, 65536, v7
    s_lshl_b32 s56, s52, 7
    s_add_u32 s56, s56, 4194304
    s_lshl_b32 s54, s3, 14
    s_add_u32 s54, s54, s56
    s_add_u32 s55, s54, 4096
    s_and_b32 s57, s3, 1
    s_lshl_b32 s57, s57, 12
    s_add_u32 s56, s56, s57
    s_waitcnt lgkmcnt(0)
    s_mov_b32 s44, s30
    s_mov_b32 s45, s31
    s_mov_b32 s46, 536870912
    s_mov_b32 s47, 0x20000
    buffer_store_dwordx4 v[20:23], v6, s[44:47], s54 offen sc1
    buffer_store_dwordx4 v[20:23], v6, s[44:47], s55 offen sc1
    buffer_store_dwordx2 v[20:21], v7, s[44:47], s56 offen sc1
    v_mov_b32 v7, 536870912
    v_cmp_gt_u32 vcc, 32, v1
    s_nop 1
    v_cndmask_b32 v123, v7, v2, vcc
    s_lshl_b32 s98, s52, 12
    s_lshl_b32 s54, s3, 9
    s_add_u32 s98, s98, s54
    s_add_u32 s98, s98, 5244928
    buffer_store_dwordx4 v[20:23], v123, s[44:47], s98 offen sc1
    s_lshl_b32 s58, s52, 2
    s_add_u32 s58, s58, s3
    s_lshl_b32 s58, s58, 13
    s_add_u32 s58, s58, 8388608
    s_add_u32 s59, s58, 4096
    v_min_u32 v6, 1, v3
    v_lshl_add_u32 v6, v6, 2, v4
    v_lshlrev_b32 v6, 4, v6
    s_lshr_b32 s55, s52, 2
    s_add_u32 s55, s55, s3
    s_and_b32 s55, s55, 3
    s_and_b32 s54, s52, 3
    s_cmp_eq_u32 s54, s55
    s_mov_b32 s56, 255
    s_cselect_b32 s56, 16777215, s56
    s_mov_b32 s57, 0
    s_cbranch_scc0 L_cclr
    buffer_store_dwordx4 v[20:23], v2, s[44:47], s58 offen offset:2048 sc1
    buffer_store_dwordx4 v[20:23], v2, s[44:47], s58 offen offset:3072 sc1
    buffer_store_dwordx4 v[20:23], v2, s[44:47], s59 offen offset:0 sc1
    buffer_store_dwordx4 v[20:23], v2, s[44:47], s59 offen offset:1024 sc1
    s_and_b32 s55, s52, 28
    s_add_u32 s55, s55, s3
    s_mul_i32 s55, s55, 256
    s_add_u32 s55, s55, 16777216
    v_mov_b32 v5, 0
    s_mov_b64 exec, 1
    buffer_store_dword v5, v5, s[44:47], s55 offen sc1
    s_lshl_b32 s55, s53, 8
    s_add_u32 s55, s55, 3145728
    s_mov_b64 exec, 0xffff
    buffer_store_dwordx4 v[20:23], v2, s[44:47], s55 offen sc1
    s_mov_b64 exec, -1
L_cclr:
    buffer_store_dwordx4 v[20:23], v2, s[44:47], s58 offen offset:0 sc1
    buffer_store_dwordx4 v[20:23], v2, s[44:47], s58 offen offset:1024 sc1
    s_mov_b64 exec, s[56:57]
    buffer_store_dwordx4 v[20:23], v2, s[44:47], s59 offen offset:2048 sc1
    s_mov_b64 exec, -1
    s_mov_b32 s40, s10
    s_mov_b32 s41, s11
    s_mov_b32 s42, 4718592
    s_mov_b32 s43, 0x20000
    s_mov_b32 s48, s4
    s_mov_b32 s49, s5
    s_mov_b32 s50, 4608
    s_mov_b32 s51, 0x20000
    s_mov_b32 s32, s16
    s_mov_b32 s33, s17
    s_mov_b32 s34, 16777216
    s_mov_b32 s35, 0x20000
    v_lshrrev_b32 v5, 3, v3
    v_mul_u32_u24 v5, 1152, v5
    v_mul_u32_u24 v6, 36, v4
    v_add_u32 v5, v5, v6
    s_mul_i32 s54, s3, 144
    s_add_u32 s54, s54, 576
    buffer_load_dwordx4 v[48:51], v5, s[48:51], s54 offen offset:0
    buffer_load_dwordx4 v[52:55], v5, s[48:51], s54 offen offset:16
    buffer_load_dword v56, v5, s[48:51], s54 offen offset:32
    buffer_load_dwordx4 v[60:63], v5, s[48:51], s54 offen offset:2304
    buffer_load_dwordx4 v[64:67], v5, s[48:51], s54 offen offset:2320
    buffer_load_dword v68, v5, s[48:51], s54 offen offset:2336
    v_mul_u32_u24 v120, 147456, v4
    v_lshl_add_u32 v120, v3, 4, v120
    s_mul_i32 s61, s3, 589824
    s_lshl_b32 s54, s52, 8
    s_add_u32 s61, s61, s54
    s_add_u32 s61, s61, 2359296
    buffer_load_dwordx4 a[0:3], v120, s[40:43], s61 offen nt
    s_add_u32 s61, s61, 8192
    buffer_load_dwordx4 a[4:7], v120, s[40:43], s61 offen nt
    s_add_u32 s61, s61, 8192
    buffer_load_dwordx4 a[8:11], v120, s[40:43], s61 offen nt
    s_add_u32 s61, s61, 8192
    buffer_load_dwordx4 a[12:15], v120, s[40:43], s61 offen nt
    s_add_u32 s61, s61, 8192
    buffer_load_dwordx4 a[16:19], v120, s[40:43], s61 offen nt
    s_add_u32 s61, s61, 8192
    buffer_load_dwordx4 a[20:23], v120, s[40:43], s61 offen nt
    s_add_u32 s61, s61, 8192
    buffer_load_dwordx4 a[24:27], v120, s[40:43], s61 offen nt
    s_add_u32 s61, s61, 8192
    buffer_load_dwordx4 a[28:31], v120, s[40:43], s61 offen nt
    s_add_u32 s61, s61, 8192
    buffer_load_dwordx4 a[32:35], v120, s[40:43], s61 offen nt
    s_add_u32 s61, s61, 8192
    buffer_load_dwordx4 a[36:39], v120, s[40:43], s61 offen nt
    s_add_u32 s61, s61, 8192
    buffer_load_dwordx4 a[40:43], v120, s[40:43], s61 offen nt
    s_add_u32 s61, s61, 8192
    buffer_load_dwordx4 a[44:47], v120, s[40:43], s61 offen nt
    s_add_u32 s61, s61, 8192
    buffer_load_dwordx4 a[48:51], v120, s[40:43], s61 offen nt
    s_add_u32 s61, s61, 8192
    buffer_load_dwordx4 a[52:55], v120, s[40:43], s61 offen nt
    s_add_u32 s61, s61, 8192
    buffer_load_dwordx4 a[56:59], v120, s[40:43], s61 offen nt
    s_add_u32 s61, s61, 8192
    buffer_load_dwordx4 a[60:63], v120, s[40:43], s61 offen nt
    s_add_u32 s61, s61, 8192
    buffer_load_dwordx4 a[64:67], v120, s[40:43], s61 offen nt
    s_add_u32 s61, s61, 8192
    buffer_load_dwordx4 a[68:71], v120, s[40:43], s61 offen nt
    s_add_u32 s61, s61, 8192
    v_and_b32 v5, 1, v3
    v_cmp_eq_u32 vcc, 1, v5
    v_mov_b32 v5, 0x0c0c0100
    v_mov_b32 v6, 0x01000c0c
    v_cndmask_b32 v5, v5, v6, vcc
    v_mov_b32 v6, 0x0c0c0302
    v_mov_b32 v7, 0x03020c0c
    v_cndmask_b32 v6, v6, v7, vcc
    v_bfe_u32 v7, v3, 1, 2
    v_mov_b32 v16, 0x0c0c0c0c
    v_cmp_eq_u32 vcc, 0, v7
    s_nop 1
    v_cndmask_b32 v8, v16, v5, vcc
    v_cndmask_b32 v9, v16, v6, vcc
    v_cmp_eq_u32 vcc, 1, v7
    s_nop 1
    v_cndmask_b32 v10, v16, v5, vcc
    v_cndmask_b32 v11, v16, v6, vcc
    v_cmp_eq_u32 vcc, 2, v7
    s_nop 1
    v_cndmask_b32 v12, v16, v5, vcc
    v_cndmask_b32 v13, v16, v6, vcc
    v_cmp_eq_u32 vcc, 3, v7
    s_nop 1
    v_cndmask_b32 v14, v16, v5, vcc
    v_cndmask_b32 v15, v16, v6, vcc
    s_waitcnt vmcnt(24)
    s_barrier
    s_cmp_lg_u32 s3, 0
    s_cbranch_scc1 L_nosig_26
    s_lshl_b32 s54, s52, 2
    v_mov_b32 v5, s54
    v_mov_b32 v6, 1
    s_mov_b64 exec, 1
    global_atomic_add v5, v6, s[28:29]
    s_mov_b64 exec, -1
L_nosig_26:
    v_lshlrev_b32 v5, 2, v4
    v_xor_b32 v5, v5, v3
    v_lshlrev_b32 v6, 10, v4
    v_xor_b32 v7, 0, v5
    v_lshl_add_u32 v20, v7, 4, v6
    v_xor_b32 v7, 1, v5
    v_lshl_add_u32 v21, v7, 4, v6
    v_add_u32 v21, 4096, v21
    v_xor_b32 v7, 2, v5
    v_lshl_add_u32 v22, v7, 4, v6
    v_add_u32 v22, 8192, v22
    v_xor_b32 v7, 3, v5
    v_lshl_add_u32 v23, v7, 4, v6
    v_add_u32 v23, 12288, v23
    s_lshl_b32 s58, s53, 19
    s_lshl_b32 s54, s3, 8
    s_add_u32 s58, s58, s54
    s_lshl_b32 s63, s3, 15
    s_mov_b32 s59, s63
    s_add_u32 m0, s59, 0
    s_add_u32 s54, s58, 0
    buffer_load_dwordx4 v20, s[32:35], s54 offen nt lds
    s_add_u32 m0, s59, 1024
    s_add_u32 s54, s58, 0
    buffer_load_dwordx4 v21, s[32:35], s54 offen nt lds
    s_add_u32 m0, s59, 2048
    s_add_u32 s54, s58, 0
    buffer_load_dwordx4 v22, s[32:35], s54 offen nt lds
    s_add_u32 m0, s59, 3072
    s_add_u32 s54, s58, 0
    buffer_load_dwordx4 v23, s[32:35], s54 offen nt lds
    s_add_u32 m0, s59, 4096
    s_add_u32 s54, s58, 16384
    buffer_load_dwordx4 v20, s[32:35], s54 offen nt lds
    s_add_u32 m0, s59, 5120
    s_add_u32 s54, s58, 16384
    buffer_load_dwordx4 v21, s[32:35], s54 offen nt lds
    s_add_u32 m0, s59, 6144
    s_add_u32 s54, s58, 16384
    buffer_load_dwordx4 v22, s[32:35], s54 offen nt lds
    s_add_u32 m0, s59, 7168
    s_add_u32 s54, s58, 16384
    buffer_load_dwordx4 v23, s[32:35], s54 offen nt lds
    s_add_u32 s58, s58, 32768
    s_add_u32 s59, s59, 8192
    s_waitcnt vmcnt(17)
    v_perm_b32 v96, v48, v48, v8
    v_perm_b32 v97, v48, v48, v10
    v_perm_b32 v98, v48, v48, v12
    v_perm_b32 v99, v48, v48, v14
    s_nop 1
    v_mfma_f32_16x16x32_bf16 v[112:115], v[96:99], a[0:3], 0
    v_perm_b32 v100, v60, v60, v8
    v_perm_b32 v101, v60, v60, v10
    v_perm_b32 v102, v60, v60, v12
    v_perm_b32 v103, v60, v60, v14
    s_nop 1
    v_mfma_f32_16x16x32_bf16 v[116:119], v[100:103], a[0:3], 0
    v_perm_b32 v104, v48, v48, v9
    v_perm_b32 v105, v48, v48, v11
    v_perm_b32 v106, v48, v48, v13
    v_perm_b32 v107, v48, v48, v15
    s_nop 1
    v_mfma_f32_16x16x32_bf16 v[112:115], v[104:107], a[4:7], v[112:115]
    v_perm_b32 v108, v60, v60, v9
    v_perm_b32 v109, v60, v60, v11
    v_perm_b32 v110, v60, v60, v13
    v_perm_b32 v111, v60, v60, v15
    s_nop 1
    v_mfma_f32_16x16x32_bf16 v[116:119], v[108:111], a[4:7], v[116:119]
    v_perm_b32 v96, v49, v49, v8
    v_perm_b32 v97, v49, v49, v10
    v_perm_b32 v98, v49, v49, v12
    v_perm_b32 v99, v49, v49, v14
    s_nop 1
    v_mfma_f32_16x16x32_bf16 v[112:115], v[96:99], a[8:11], v[112:115]
    v_perm_b32 v100, v61, v61, v8
    v_perm_b32 v101, v61, v61, v10
    v_perm_b32 v102, v61, v61, v12
    v_perm_b32 v103, v61, v61, v14
    s_nop 1
    v_mfma_f32_16x16x32_bf16 v[116:119], v[100:103], a[8:11], v[116:119]
    v_perm_b32 v104, v49, v49, v9
    v_perm_b32 v105, v49, v49, v11
    v_perm_b32 v106, v49, v49, v13
    v_perm_b32 v107, v49, v49, v15
    s_nop 1
    v_mfma_f32_16x16x32_bf16 v[112:115], v[104:107], a[12:15], v[112:115]
    v_perm_b32 v108, v61, v61, v9
    v_perm_b32 v109, v61, v61, v11
    v_perm_b32 v110, v61, v61, v13
    v_perm_b32 v111, v61, v61, v15
    s_nop 1
    v_mfma_f32_16x16x32_bf16 v[116:119], v[108:111], a[12:15], v[116:119]
    v_perm_b32 v96, v50, v50, v8
    v_perm_b32 v97, v50, v50, v10
    v_perm_b32 v98, v50, v50, v12
    v_perm_b32 v99, v50, v50, v14
    s_nop 1
    v_mfma_f32_16x16x32_bf16 v[112:115], v[96:99], a[16:19], v[112:115]
    v_perm_b32 v100, v62, v62, v8
    v_perm_b32 v101, v62, v62, v10
    v_perm_b32 v102, v62, v62, v12
    v_perm_b32 v103, v62, v62, v14
    s_nop 1
    v_mfma_f32_16x16x32_bf16 v[116:119], v[100:103], a[16:19], v[116:119]
    v_perm_b32 v104, v50, v50, v9
    v_perm_b32 v105, v50, v50, v11
    v_perm_b32 v106, v50, v50, v13
    v_perm_b32 v107, v50, v50, v15
    s_nop 1
    v_mfma_f32_16x16x32_bf16 v[112:115], v[104:107], a[20:23], v[112:115]
    v_perm_b32 v108, v62, v62, v9
    v_perm_b32 v109, v62, v62, v11
    v_perm_b32 v110, v62, v62, v13
    v_perm_b32 v111, v62, v62, v15
    s_nop 1
    v_mfma_f32_16x16x32_bf16 v[116:119], v[108:111], a[20:23], v[116:119]
    v_perm_b32 v96, v51, v51, v8
    v_perm_b32 v97, v51, v51, v10
    v_perm_b32 v98, v51, v51, v12
    v_perm_b32 v99, v51, v51, v14
    s_nop 1
    v_mfma_f32_16x16x32_bf16 v[112:115], v[96:99], a[24:27], v[112:115]
    v_perm_b32 v100, v63, v63, v8
    v_perm_b32 v101, v63, v63, v10
    v_perm_b32 v102, v63, v63, v12
    v_perm_b32 v103, v63, v63, v14
    s_nop 1
    v_mfma_f32_16x16x32_bf16 v[116:119], v[100:103], a[24:27], v[116:119]
    v_perm_b32 v104, v51, v51, v9
    v_perm_b32 v105, v51, v51, v11
    v_perm_b32 v106, v51, v51, v13
    v_perm_b32 v107, v51, v51, v15
    s_nop 1
    v_mfma_f32_16x16x32_bf16 v[112:115], v[104:107], a[28:31], v[112:115]
    v_perm_b32 v108, v63, v63, v9
    v_perm_b32 v109, v63, v63, v11
    v_perm_b32 v110, v63, v63, v13
    v_perm_b32 v111, v63, v63, v15
    s_nop 1
    v_mfma_f32_16x16x32_bf16 v[116:119], v[108:111], a[28:31], v[116:119]
    v_perm_b32 v96, v52, v52, v8
    v_perm_b32 v97, v52, v52, v10
    v_perm_b32 v98, v52, v52, v12
    v_perm_b32 v99, v52, v52, v14
    s_nop 1
    v_mfma_f32_16x16x32_bf16 v[112:115], v[96:99], a[32:35], v[112:115]
    v_perm_b32 v100, v64, v64, v8
    v_perm_b32 v101, v64, v64, v10
    v_perm_b32 v102, v64, v64, v12
    v_perm_b32 v103, v64, v64, v14
    s_nop 1
    v_mfma_f32_16x16x32_bf16 v[116:119], v[100:103], a[32:35], v[116:119]
    s_waitcnt vmcnt(8)
    v_perm_b32 v104, v52, v52, v9
    v_perm_b32 v105, v52, v52, v11
    v_perm_b32 v106, v52, v52, v13
    v_perm_b32 v107, v52, v52, v15
    s_nop 1
    v_mfma_f32_16x16x32_bf16 v[112:115], v[104:107], a[36:39], v[112:115]
    v_perm_b32 v108, v64, v64, v9
    v_perm_b32 v109, v64, v64, v11
    v_perm_b32 v110, v64, v64, v13
    v_perm_b32 v111, v64, v64, v15
    s_nop 1
    v_mfma_f32_16x16x32_bf16 v[116:119], v[108:111], a[36:39], v[116:119]
    v_perm_b32 v96, v53, v53, v8
    v_perm_b32 v97, v53, v53, v10
    v_perm_b32 v98, v53, v53, v12
    v_perm_b32 v99, v53, v53, v14
    s_nop 1
    v_mfma_f32_16x16x32_bf16 v[112:115], v[96:99], a[40:43], v[112:115]
    v_perm_b32 v100, v65, v65, v8
    v_perm_b32 v101, v65, v65, v10
    v_perm_b32 v102, v65, v65, v12
    v_perm_b32 v103, v65, v65, v14
    s_nop 1
    v_mfma_f32_16x16x32_bf16 v[116:119], v[100:103], a[40:43], v[116:119]
    v_perm_b32 v104, v53, v53, v9
    v_perm_b32 v105, v53, v53, v11
    v_perm_b32 v106, v53, v53, v13
    v_perm_b32 v107, v53, v53, v15
    s_nop 1
    v_mfma_f32_16x16x32_bf16 v[112:115], v[104:107], a[44:47], v[112:115]
    v_perm_b32 v108, v65, v65, v9
    v_perm_b32 v109, v65, v65, v11
    v_perm_b32 v110, v65, v65, v13
    v_perm_b32 v111, v65, v65, v15
    s_nop 1
    v_mfma_f32_16x16x32_bf16 v[116:119], v[108:111], a[44:47], v[116:119]
    v_perm_b32 v96, v54, v54, v8
    v_perm_b32 v97, v54, v54, v10
    v_perm_b32 v98, v54, v54, v12
    v_perm_b32 v99, v54, v54, v14
    s_nop 1
    v_mfma_f32_16x16x32_bf16 v[112:115], v[96:99], a[48:51], v[112:115]
    v_perm_b32 v100, v66, v66, v8
    v_perm_b32 v101, v66, v66, v10
    v_perm_b32 v102, v66, v66, v12
    v_perm_b32 v103, v66, v66, v14
    s_nop 1
    v_mfma_f32_16x16x32_bf16 v[116:119], v[100:103], a[48:51], v[116:119]
    v_perm_b32 v104, v54, v54, v9
    v_perm_b32 v105, v54, v54, v11
    v_perm_b32 v106, v54, v54, v13
    v_perm_b32 v107, v54, v54, v15
    s_nop 1
    v_mfma_f32_16x16x32_bf16 v[112:115], v[104:107], a[52:55], v[112:115]
    v_perm_b32 v108, v66, v66, v9
    v_perm_b32 v109, v66, v66, v11
    v_perm_b32 v110, v66, v66, v13
    v_perm_b32 v111, v66, v66, v15
    s_nop 1
    v_mfma_f32_16x16x32_bf16 v[116:119], v[108:111], a[52:55], v[116:119]
    v_perm_b32 v96, v55, v55, v8
    v_perm_b32 v97, v55, v55, v10
    v_perm_b32 v98, v55, v55, v12
    v_perm_b32 v99, v55, v55, v14
    s_nop 1
    v_mfma_f32_16x16x32_bf16 v[112:115], v[96:99], a[56:59], v[112:115]
    v_perm_b32 v100, v67, v67, v8
    v_perm_b32 v101, v67, v67, v10
    v_perm_b32 v102, v67, v67, v12
    v_perm_b32 v103, v67, v67, v14
    s_nop 1
    v_mfma_f32_16x16x32_bf16 v[116:119], v[100:103], a[56:59], v[116:119]
    v_perm_b32 v104, v55, v55, v9
    v_perm_b32 v105, v55, v55, v11
    v_perm_b32 v106, v55, v55, v13
    v_perm_b32 v107, v55, v55, v15
    s_nop 1
    v_mfma_f32_16x16x32_bf16 v[112:115], v[104:107], a[60:63], v[112:115]
    v_perm_b32 v108, v67, v67, v9
    v_perm_b32 v109, v67, v67, v11
    v_perm_b32 v110, v67, v67, v13
    v_perm_b32 v111, v67, v67, v15
    s_nop 1
    v_mfma_f32_16x16x32_bf16 v[116:119], v[108:111], a[60:63], v[116:119]
    v_perm_b32 v96, v56, v56, v8
    v_perm_b32 v97, v56, v56, v10
    v_perm_b32 v98, v56, v56, v12
    v_perm_b32 v99, v56, v56, v14
    s_nop 1
    v_mfma_f32_16x16x32_bf16 v[112:115], v[96:99], a[64:67], v[112:115]
    v_perm_b32 v100, v68, v68, v8
    v_perm_b32 v101, v68, v68, v10
    v_perm_b32 v102, v68, v68, v12
    v_perm_b32 v103, v68, v68, v14
    s_nop 1
    v_mfma_f32_16x16x32_bf16 v[116:119], v[100:103], a[64:67], v[116:119]
    v_perm_b32 v104, v56, v56, v9
    v_perm_b32 v105, v56, v56, v11
    v_perm_b32 v106, v56, v56, v13
    v_perm_b32 v107, v56, v56, v15
    s_nop 1
    v_mfma_f32_16x16x32_bf16 v[112:115], v[104:107], a[68:71], v[112:115]
    v_perm_b32 v108, v68, v68, v9
    v_perm_b32 v109, v68, v68, v11
    v_perm_b32 v110, v68, v68, v13
    v_perm_b32 v111, v68, v68, v15
    s_nop 1
    v_mfma_f32_16x16x32_bf16 v[116:119], v[108:111], a[68:71], v[116:119]
    v_lshrrev_b32 v5, 1, v4
    v_lshlrev_b32 v5, 9, v5
    v_lshl_add_u32 v5, v3, 5, v5
    v_and_b32 v6, 1, v4
    v_lshl_add_u32 v5, v6, 4, v5
    s_lshl_b32 s54, s3, 11
    s_add_u32 s54, s54, 139264
    v_add_u32 v5, s54, v5
    ds_write_b128 v5, v[112:115]
    ds_write_b128 v5, v[116:119] offset:1024
    s_waitcnt lgkmcnt(0)
    s_barrier
    s_lshl_b32 s54, s3, 9
    s_add_u32 s54, s54, 139264
    v_add_u32 v5, s54, v2
    ds_read_b128 v[96:99], v5 offset:0
    ds_read_b128 v[100:103], v5 offset:2048
    ds_read_b128 v[104:107], v5 offset:4096
    ds_read_b128 v[108:111], v5 offset:6144
    s_waitcnt lgkmcnt(0)
    v_add_f32 v96, v96, v100
    v_add_f32 v104, v104, v108
    v_add_f32 v97, v97, v101
    v_add_f32 v105, v105, v109
    v_add_f32 v98, v98, v102
    v_add_f32 v106, v106, v110
    v_add_f32 v99, v99, v103
    v_add_f32 v107, v107, v111
    v_add_f32 v96, v96, v104
    v_add_f32 v97, v97, v105
    v_add_f32 v98, v98, v106
    v_add_f32 v99, v99, v107
    v_min_u32 v124, -2, v96
    v_min_u32 v125, -2, v97
    v_min_u32 v126, -2, v98
    v_min_u32 v127, -2, v99
    buffer_store_dwordx4 v[124:127], v123, s[44:47], s98 offen sc1
    s_add_u32 m0, s59, 0
    s_add_u32 s54, s58, 0
    buffer_load_dwordx4 v20, s[32:35], s54 offen nt lds
    s_add_u32 m0, s59, 1024
    s_add_u32 s54, s58, 0
    buffer_load_dwordx4 v21, s[32:35], s54 offen nt lds
    s_add_u32 m0, s59, 2048
    s_add_u32 s54, s58, 0
    buffer_load_dwordx4 v22, s[32:35], s54 offen nt lds
    s_add_u32 m0, s59, 3072
    s_add_u32 s54, s58, 0
    buffer_load_dwordx4 v23, s[32:35], s54 offen nt lds
    s_add_u32 m0, s59, 4096
    s_add_u32 s54, s58, 16384
    buffer_load_dwordx4 v20, s[32:35], s54 offen nt lds
    s_add_u32 m0, s59, 5120
    s_add_u32 s54, s58, 16384
    buffer_load_dwordx4 v21, s[32:35], s54 offen nt lds
    s_add_u32 m0, s59, 6144
    s_add_u32 s54, s58, 16384
    buffer_load_dwordx4 v22, s[32:35], s54 offen nt lds
    s_add_u32 m0, s59, 7168
    s_add_u32 s54, s58, 16384
    buffer_load_dwordx4 v23, s[32:35], s54 offen nt lds
    s_add_u32 s58, s58, 32768
    s_add_u32 s59, s59, 8192
    s_add_u32 m0, s59, 0
    s_add_u32 s54, s58, 0
    buffer_load_dwordx4 v20, s[32:35], s54 offen nt lds
    s_add_u32 m0, s59, 1024
    s_add_u32 s54, s58, 0
    buffer_load_dwordx4 v21, s[32:35], s54 offen nt lds
    s_add_u32 m0, s59, 2048
    s_add_u32 s54, s58, 0
    buffer_load_dwordx4 v22, s[32:35], s54 offen nt lds
    s_add_u32 m0, s59, 3072
    s_add_u32 s54, s58, 0
    buffer_load_dwordx4 v23, s[32:35], s54 offen nt lds
    s_add_u32 m0, s59, 4096
    s_add_u32 s54, s58, 16384
    buffer_load_dwordx4 v20, s[32:35], s54 offen nt lds
    s_add_u32 m0, s59, 5120
    s_add_u32 s54, s58, 16384
    buffer_load_dwordx4 v21, s[32:35], s54 offen nt lds
    s_add_u32 m0, s59, 6144
    s_add_u32 s54, s58, 16384
    buffer_load_dwordx4 v22, s[32:35], s54 offen nt lds
    s_add_u32 m0, s59, 7168
    s_add_u32 s54, s58, 16384
    buffer_load_dwordx4 v23, s[32:35], s54 offen nt lds
    s_add_u32 s58, s58, 32768
    s_add_u32 s59, s59, 8192
    s_add_u32 m0, s59, 0
    s_add_u32 s54, s58, 0
    buffer_load_dwordx4 v20, s[32:35], s54 offen nt lds
    s_add_u32 m0, s59, 1024
    s_add_u32 s54, s58, 0
    buffer_load_dwordx4 v21, s[32:35], s54 offen nt lds
    s_add_u32 m0, s59, 2048
    s_add_u32 s54, s58, 0
    buffer_load_dwordx4 v22, s[32:35], s54 offen nt lds
    s_add_u32 m0, s59, 3072
    s_add_u32 s54, s58, 0
    buffer_load_dwordx4 v23, s[32:35], s54 offen nt lds
    s_add_u32 m0, s59, 4096
    s_add_u32 s54, s58, 16384
    buffer_load_dwordx4 v20, s[32:35], s54 offen nt lds
    s_add_u32 m0, s59, 5120
    s_add_u32 s54, s58, 16384
    buffer_load_dwordx4 v21, s[32:35], s54 offen nt lds
    s_add_u32 m0, s59, 6144
    s_add_u32 s54, s58, 16384
    buffer_load_dwordx4 v22, s[32:35], s54 offen nt lds
    s_add_u32 m0, s59, 7168
    s_add_u32 s54, s58, 16384
    buffer_load_dwordx4 v23, s[32:35], s54 offen nt lds
    s_add_u32 s58, s58, 32768
    s_add_u32 s59, s59, 8192
    s_waitcnt vmcnt(40)
    buffer_load_dwordx4 a[96:99], v20, s[32:35], s58 offen nt
    buffer_load_dwordx4 a[100:103], v21, s[32:35], s58 offen nt
    buffer_load_dwordx4 a[104:107], v22, s[32:35], s58 offen nt
    buffer_load_dwordx4 a[108:111], v23, s[32:35], s58 offen nt
    s_add_u32 s58, s58, 16384
    buffer_load_dwordx4 a[112:115], v20, s[32:35], s58 offen nt
    buffer_load_dwordx4 a[116:119], v21, s[32:35], s58 offen nt
    buffer_load_dwordx4 a[120:123], v22, s[32:35], s58 offen nt
    buffer_load_dwordx4 a[124:127], v23, s[32:35], s58 offen nt
    s_add_u32 s58, s58, 16384
    s_waitcnt vmcnt(40)
    buffer_load_dwordx4 a[128:131], v20, s[32:35], s58 offen nt
    buffer_load_dwordx4 a[132:135], v21, s[32:35], s58 offen nt
    buffer_load_dwordx4 a[136:139], v22, s[32:35], s58 offen nt
    buffer_load_dwordx4 a[140:143], v23, s[32:35], s58 offen nt
    s_add_u32 s58, s58, 16384
    buffer_load_dwordx4 a[144:147], v20, s[32:35], s58 offen nt
    buffer_load_dwordx4 a[148:151], v21, s[32:35], s58 offen nt
    buffer_load_dwordx4 a[152:155], v22, s[32:35], s58 offen nt
    buffer_load_dwordx4 a[156:159], v23, s[32:35], s58 offen nt
    s_add_u32 s58, s58, 16384
    s_waitcnt vmcnt(40)
    buffer_load_dwordx4 a[160:163], v20, s[32:35], s58 offen nt
    buffer_load_dwordx4 a[164:167], v21, s[32:35], s58 offen nt
    buffer_load_dwordx4 a[168:171], v22, s[32:35], s58 offen nt
    buffer_load_dwordx4 a[172:175], v23, s[32:35], s58 offen nt
    s_add_u32 s58, s58, 16384
    buffer_load_dwordx4 a[176:179], v20, s[32:35], s58 offen nt
    buffer_load_dwordx4 a[180:183], v21, s[32:35], s58 offen nt
    buffer_load_dwordx4 a[184:187], v22, s[32:35], s58 offen nt
    buffer_load_dwordx4 a[188:191], v23, s[32:35], s58 offen nt
    s_add_u32 s58, s58, 16384
    s_waitcnt vmcnt(40)
    buffer_load_dwordx4 a[192:195], v20, s[32:35], s58 offen nt
    buffer_load_dwordx4 a[196:199], v21, s[32:35], s58 offen nt
    buffer_load_dwordx4 a[200:203], v22, s[32:35], s58 offen nt
    buffer_load_dwordx4 a[204:207], v23, s[32:35], s58 offen nt
    s_add_u32 s58, s58, 16384
    buffer_load_dwordx4 a[208:211], v20, s[32:35], s58 offen nt
    buffer_load_dwordx4 a[212:215], v21, s[32:35], s58 offen nt
    buffer_load_dwordx4 a[216:219], v22, s[32:35], s58 offen nt
    buffer_load_dwordx4 a[220:223], v23, s[32:35], s58 offen nt
    s_add_u32 s58, s58, 16384
    s_waitcnt vmcnt(40)
    v_and_b32 v27, 31, v1
    v_lshlrev_b32 v27, 2, v27
    global_load_dword v18, v27, s[28:29] sc1
    buffer_load_dwordx4 a[224:227], v20, s[32:35], s58 offen nt
    buffer_load_dwordx4 a[228:231], v21, s[32:35], s58 offen nt
    buffer_load_dwordx4 a[232:235], v22, s[32:35], s58 offen nt
    buffer_load_dwordx4 a[236:239], v23, s[32:35], s58 offen nt
    s_add_u32 s58, s58, 16384
    buffer_load_dwordx4 a[240:243], v20, s[32:35], s58 offen nt
    buffer_load_dwordx4 a[244:247], v21, s[32:35], s58 offen nt
    buffer_load_dwordx4 a[248:251], v22, s[32:35], s58 offen nt
    buffer_load_dwordx4 a[252:255], v23, s[32:35], s58 offen nt
    s_add_u32 s58, s58, 16384
    s_waitcnt vmcnt(40)
    buffer_load_dwordx4 v[224:227], v20, s[32:35], s58 offen nt
    buffer_load_dwordx4 v[228:231], v21, s[32:35], s58 offen nt
    buffer_load_dwordx4 v[232:235], v22, s[32:35], s58 offen nt
    buffer_load_dwordx4 v[236:239], v23, s[32:35], s58 offen nt
    s_add_u32 s58, s58, 16384
    buffer_load_dwordx4 v[240:243], v20, s[32:35], s58 offen nt
    buffer_load_dwordx4 v[244:247], v21, s[32:35], s58 offen nt
    buffer_load_dwordx4 v[248:251], v22, s[32:35], s58 offen nt
    buffer_load_dwordx4 v[252:255], v23, s[32:35], s58 offen nt
    s_add_u32 s58, s58, 16384
    s_mov_b32 s36, s12
    s_mov_b32 s37, s13
    s_mov_b32 s38, 4718592
    s_mov_b32 s39, 0x20000
    v_mul_u32_u24 v49, 9216, v4
    v_lshl_add_u32 v48, v3, 4, v49
    v_lshl_add_u32 v49, v3, 2, v49
    s_mul_i32 s100, s52, 147456
    s_lshl_b32 s54, s3, 8
    s_add_u32 s99, s100, s54
    s_and_b32 s54, s3, 1
    s_lshl_b32 s54, s54, 6
    s_add_u32 s100, s100, s54
    s_add_u32 s100, s100, 1024
    v_add_u32 v26, s63, v2
    v_and_b32 v24, 31, v1
    v_lshrrev_b32 v25, 5, v1
    v_lshlrev_b32 v19, 10, v24
    v_lshl_add_u32 v19, v25, 4, v19
    s_lshr_b32 s96, s53, 3
    s_lshl_b32 s96, s96, 15
    s_lshl_b32 s55, s3, 8
    s_add_u32 s96, s96, s55
    s_add_u32 s96, s96, 1048576
    v_and_b32 v5, 3, v24
    v_lshlrev_b32 v5, 2, v5
    v_bfe_u32 v6, v24, 2, 2
    v_or_b32 v5, v5, v6
    v_xor_b32 v5, v5, v25
    v_lshlrev_b32 v32, 8, v24
    v_lshl_add_u32 v32, v5, 4, v32
    v_add_u32 v32, s63, v32
    v_bfe_u32 v5, v1, 2, 2
    v_lshl_add_u32 v6, v25, 2, v5
    v_lshlrev_b32 v40, 8, v6
    v_and_b32 v6, 1, v1
    v_lshl_add_u32 v40, v6, 3, v40
    v_bfe_u32 v6, v1, 4, 1
    v_lshlrev_b32 v6, 1, v6
    v_bfe_u32 v7, v1, 1, 1
    v_or_b32 v6, v6, v7
    v_xor_b32 v6, v6, v25
    v_lshl_or_b32 v6, v5, 2, v6
    v_lshl_add_u32 v40, v6, 4, v40
    v_add_u32 v40, s63, v40
    v_xor_b32 v33, 32, v32
    v_xor_b32 v41, 32, v40
    v_xor_b32 v34, 64, v32
    v_xor_b32 v42, 64, v40
    v_xor_b32 v35, 96, v32
    v_xor_b32 v43, 96, v40
    v_xor_b32 v36, 128, v32
    v_xor_b32 v44, 128, v40
    v_xor_b32 v37, 160, v32
    v_xor_b32 v45, 160, v40
    v_xor_b32 v38, 192, v32
    v_xor_b32 v46, 192, v40
    v_xor_b32 v39, 224, v32
    v_xor_b32 v47, 224, v40
    s_lshl_b32 s54, s3, 12
    s_add_u32 s54, s54, 131072
    v_add_u32 v28, s54, v2
    v_xor_b32 v29, 4096, v28
    v_xor_b32 v30, 8192, v28
    v_xor_b32 v31, 12288, v28
    v_mov_b32 v64, 0
    v_mov_b32 v65, 0
    v_mov_b32 v66, 0
    v_mov_b32 v67, 0
    v_mov_b32 v68, 0
    v_mov_b32 v69, 0
    v_mov_b32 v70, 0
    v_mov_b32 v71, 0
    v_mov_b32 v72, 0
    v_mov_b32 v73, 0
    v_mov_b32 v74, 0
    v_mov_b32 v75, 0
    v_mov_b32 v76, 0
    v_mov_b32 v77, 0
    v_mov_b32 v78, 0
    v_mov_b32 v79, 0
    v_mov_b32 v80, 0
    v_mov_b32 v81, 0
    v_mov_b32 v82, 0
    v_mov_b32 v83, 0
    v_mov_b32 v84, 0
    v_mov_b32 v85, 0
    v_mov_b32 v86, 0
    v_mov_b32 v87, 0
    v_mov_b32 v88, 0
    v_mov_b32 v89, 0
    v_mov_b32 v90, 0
    v_mov_b32 v91, 0
    v_mov_b32 v92, 0
    v_mov_b32 v93, 0
    v_mov_b32 v94, 0
    v_mov_b32 v95, 0
    v_mov_b32 v96, 0
    v_mov_b32 v97, 0
    v_mov_b32 v98, 0
    v_mov_b32 v99, 0
    v_mov_b32 v100, 0
    v_mov_b32 v101, 0
    v_mov_b32 v102, 0
    v_mov_b32 v103, 0
    v_mov_b32 v104, 0
    v_mov_b32 v105, 0
    v_mov_b32 v106, 0
    v_mov_b32 v107, 0
    v_mov_b32 v108, 0
    v_mov_b32 v109, 0
    v_mov_b32 v110, 0
    v_mov_b32 v111, 0
    v_mov_b32 v112, 0
    v_mov_b32 v113, 0
    v_mov_b32 v114, 0
    v_mov_b32 v115, 0
    v_mov_b32 v116, 0
    v_mov_b32 v117, 0
    v_mov_b32 v118, 0
    v_mov_b32 v119, 0
    v_mov_b32 v120, 0
    v_mov_b32 v121, 0
    v_mov_b32 v122, 0
    v_mov_b32 v123, 0
    v_mov_b32 v124, 0
    v_mov_b32 v125, 0
    v_mov_b32 v126, 0
    v_mov_b32 v127, 0
    v_mov_b32 v216, 0xff800000
    v_mov_b32 v217, 0
    s_waitcnt vmcnt(0)
L_flags_27:
    v_cmp_gt_u32 vcc, 2, v18
    s_cbranch_vccz L_flagsok_28
    s_sleep 2
    global_load_dword v18, v27, s[28:29] sc1
    s_waitcnt vmcnt(0)
    s_sub_u32 s101, s101, 1
    s_cbranch_scc0 L_flags_27
    s_mov_b32 s101, 0
L_flagsok_28:
    s_barrier
    ds_read_b128 a[32:35], v32 offset:0
    ds_read_b128 a[36:39], v33 offset:0
    ds_read_b128 a[40:43], v34 offset:0
    ds_read_b128 a[44:47], v35 offset:0
    ds_read_b128 a[48:51], v36 offset:0
    ds_read_b128 a[52:55], v37 offset:0
    ds_read_b128 a[56:59], v38 offset:0
    ds_read_b128 a[60:63], v39 offset:0
L_qpoll_29:
    buffer_load_dwordx4 v[128:131], v19, s[44:47], s96 offen offset:0 sc1
    buffer_load_dwordx4 v[132:135], v19, s[44:47], s96 offen offset:32 sc1
    buffer_load_dwordx4 v[136:139], v19, s[44:47], s96 offen offset:64 sc1
    buffer_load_dwordx4 v[140:143], v19, s[44:47], s96 offen offset:96 sc1
    buffer_load_dwordx4 v[144:147], v19, s[44:47], s96 offen offset:128 sc1
    buffer_load_dwordx4 v[148:151], v19, s[44:47], s96 offen offset:160 sc1
    buffer_load_dwordx4 v[152:155], v19, s[44:47], s96 offen offset:192 sc1
    buffer_load_dwordx4 v[156:159], v19, s[44:47], s96 offen offset:224 sc1
    s_waitcnt vmcnt(0)
    v_max3_u32 v5, v128, v129, v130
    v_max3_u32 v6, v144, v145, v146
    v_max3_u32 v5, v5, v131, v132
    v_max3_u32 v6, v6, v147, v148
    v_max3_u32 v5, v5, v133, v134
    v_max3_u32 v6, v6, v149, v150
    v_max3_u32 v5, v5, v135, v136
    v_max3_u32 v6, v6, v151, v152
    v_max3_u32 v5, v5, v137, v138
    v_max3_u32 v6, v6, v153, v154
    v_max3_u32 v5, v5, v139, v140
    v_max3_u32 v6, v6, v155, v156
    v_max3_u32 v5, v5, v141, v142
    v_max3_u32 v6, v6, v157, v158
    v_max3_u32 v5, v5, v143, v159
    v_max_u32 v5, v5, v6
    v_cmp_eq_u32 vcc, -1, v5
    s_nop 0
    s_mov_b64 exec, vcc
    s_cbranch_execz L_qok_30
    s_sub_u32 s101, s101, 1
    s_cbranch_scc0 L_qpoll_29
    s_mov_b32 s101, 0
L_qok_30:
    s_mov_b64 exec, -1
    v_accvgpr_write_b32 a0, v128
    v_accvgpr_write_b32 a1, v129
    v_accvgpr_write_b32 a2, v130
    v_accvgpr_write_b32 a3, v131
    v_accvgpr_write_b32 a4, v132
    v_accvgpr_write_b32 a5, v133
    v_accvgpr_write_b32 a6, v134
    v_accvgpr_write_b32 a7, v135
    v_accvgpr_write_b32 a8, v136
    v_accvgpr_write_b32 a9, v137
    v_accvgpr_write_b32 a10, v138
    v_accvgpr_write_b32 a11, v139
    v_accvgpr_write_b32 a12, v140
    v_accvgpr_write_b32 a13, v141
    v_accvgpr_write_b32 a14, v142
    v_accvgpr_write_b32 a15, v143
    v_accvgpr_write_b32 a16, v144
    v_accvgpr_write_b32 a17, v145
    v_accvgpr_write_b32 a18, v146
    v_accvgpr_write_b32 a19, v147
    v_accvgpr_write_b32 a20, v148
    v_accvgpr_write_b32 a21, v149
    v_accvgpr_write_b32 a22, v150
    v_accvgpr_write_b32 a23, v151
    v_accvgpr_write_b32 a24, v152
    v_accvgpr_write_b32 a25, v153
    v_accvgpr_write_b32 a26, v154
    v_accvgpr_write_b32 a27, v155
    v_accvgpr_write_b32 a28, v156
    v_accvgpr_write_b32 a29, v157
    v_accvgpr_write_b32 a30, v158
    v_accvgpr_write_b32 a31, v159
    s_waitcnt lgkmcnt(0)
    v_mfma_f32_32x32x16_bf16 v[128:143], a[32:35], a[0:3], 0
    v_mfma_f32_32x32x16_bf16 v[128:143], a[36:39], a[4:7], v[128:143]
    v_mfma_f32_32x32x16_bf16 v[128:143], a[40:43], a[8:11], v[128:143]
    v_mfma_f32_32x32x16_bf16 v[128:143], a[44:47], a[12:15], v[128:143]
    v_mfma_f32_32x32x16_bf16 v[128:143], a[48:51], a[16:19], v[128:143]
    v_mfma_f32_32x32x16_bf16 v[128:143], a[52:55], a[20:23], v[128:143]
    v_mfma_f32_32x32x16_bf16 v[128:143], a[56:59], a[24:27], v[128:143]
    v_mfma_f32_32x32x16_bf16 v[128:143], a[60:63], a[28:31], v[128:143]
    s_nop 11
    ds_write_b128 v28, v[128:131] offset:0
    ds_write_b128 v28, v[132:135] offset:1024
    ds_write_b128 v28, v[136:139] offset:2048
    ds_write_b128 v28, v[140:143] offset:3072
    s_waitcnt lgkmcnt(0)
    s_barrier
    ds_read_b128 v[144:147], v29 offset:0
    ds_read_b128 v[148:151], v29 offset:1024
    ds_read_b128 v[152:155], v29 offset:2048
    ds_read_b128 v[156:159], v29 offset:3072
    ds_read_b128 v[160:163], v30 offset:0
    ds_read_b128 v[164:167], v30 offset:1024
    ds_read_b128 v[168:171], v30 offset:2048
    ds_read_b128 v[172:175], v30 offset:3072
    ds_read_b128 v[176:179], v31 offset:0
    ds_read_b128 v[180:183], v31 offset:1024
    ds_read_b128 v[184:187], v31 offset:2048
    ds_read_b128 v[188:191], v31 offset:3072
    ds_read_b128 a[32:35], v32 offset:8192
    ds_read_b128 a[36:39], v33 offset:8192
    ds_read_b128 a[40:43], v34 offset:8192
    ds_read_b128 a[44:47], v35 offset:8192
    ds_read_b128 a[48:51], v36 offset:8192
    ds_read_b128 a[52:55], v37 offset:8192
    ds_read_b128 a[56:59], v38 offset:8192
    ds_read_b128 a[60:63], v39 offset:8192
    s_waitcnt lgkmcnt(8)
    v_add_f32 v144, v144, v128
    v_add_f32 v145, v145, v129
    v_add_f32 v146, v146, v130
    v_add_f32 v147, v147, v131
    v_add_f32 v148, v148, v132
    v_add_f32 v149, v149, v133
    v_add_f32 v150, v150, v134
    v_add_f32 v151, v151, v135
    v_add_f32 v152, v152, v136
    v_add_f32 v153, v153, v137
    v_add_f32 v154, v154, v138
    v_add_f32 v155, v155, v139
    v_add_f32 v156, v156, v140
    v_add_f32 v157, v157, v141
    v_add_f32 v158, v158, v142
    v_add_f32 v159, v159, v143
    s_waitcnt lgkmcnt(0)
    v_mfma_f32_32x32x16_bf16 v[128:143], a[32:35], a[0:3], 0
    ds_read_b64_tr_b16 a[64:65], v40 offset:0
    ds_read_b64_tr_b16 a[66:67], v41 offset:2048
    v_add_f32 v160, v160, v176
    v_add_f32 v161, v161, v177
    v_add_f32 v162, v162, v178
    v_add_f32 v163, v163, v179
    v_add_f32 v164, v164, v180
    v_mfma_f32_32x32x16_bf16 v[128:143], a[36:39], a[4:7], v[128:143]
    ds_read_b64_tr_b16 a[72:73], v42 offset:0
    ds_read_b64_tr_b16 a[74:75], v43 offset:2048
    v_add_f32 v165, v165, v181
    v_add_f32 v166, v166, v182
    v_add_f32 v167, v167, v183
    v_add_f32 v168, v168, v184
    v_add_f32 v169, v169, v185
    v_mfma_f32_32x32x16_bf16 v[128:143], a[40:43], a[8:11], v[128:143]
    ds_read_b64_tr_b16 a[80:81], v44 offset:0
    ds_read_b64_tr_b16 a[82:83], v45 offset:2048
    v_add_f32 v170, v170, v186
    v_add_f32 v171, v171, v187
    v_add_f32 v172, v172, v188
    v_add_f32 v173, v173, v189
    v_add_f32 v174, v174, v190
    v_mfma_f32_32x32x16_bf16 v[128:143], a[44:47], a[12:15], v[128:143]
    ds_read_b64_tr_b16 a[88:89], v46 offset:0
    ds_read_b64_tr_b16 a[90:91], v47 offset:2048
    v_add_f32 v175, v175, v191
    v_add_f32 v144, v144, v160
    v_add_f32 v145, v145, v161
    v_add_f32 v146, v146, v162
    v_add_f32 v147, v147, v163
    v_mfma_f32_32x32x16_bf16 v[128:143], a[48:51], a[16:19], v[128:143]
    ds_read_b64_tr_b16 a[68:69], v40 offset:4096
    ds_read_b64_tr_b16 a[70:71], v41 offset:6144
    v_add_f32 v148, v148, v164
    v_add_f32 v149, v149, v165
    v_add_f32 v150, v150, v166
    v_add_f32 v151, v151, v167
    v_add_f32 v152, v152, v168
    v_mfma_f32_32x32x16_bf16 v[128:143], a[52:55], a[20:23], v[128:143]
    ds_read_b64_tr_b16 a[76:77], v42 offset:4096
    ds_read_b64_tr_b16 a[78:79], v43 offset:6144
    v_add_f32 v153, v153, v169
    v_add_f32 v154, v154, v170
    v_add_f32 v155, v155, v171
    v_add_f32 v156, v156, v172
    v_add_f32 v157, v157, v173
    v_mfma_f32_32x32x16_bf16 v[128:143], a[56:59], a[24:27], v[128:143]
    ds_read_b64_tr_b16 a[84:85], v44 offset:4096
    ds_read_b64_tr_b16 a[86:87], v45 offset:6144
    v_add_f32 v158, v158, v174
    v_add_f32 v159, v159, v175
    v_max3_f32 v218, v144, v145, v146
    v_max3_f32 v219, v147, v148, v149
    v_max3_f32 v220, v150, v151, v152
    v_mfma_f32_32x32x16_bf16 v[128:143], a[60:63], a[28:31], v[128:143]
    ds_read_b64_tr_b16 a[92:93], v46 offset:4096
    ds_read_b64_tr_b16 a[94:95], v47 offset:6144
    v_max3_f32 v221, v153, v154, v155
    v_max3_f32 v218, v218, v156, v157
    v_max3_f32 v219, v219, v158, v159
    v_max3_f32 v218, v218, v219, v220
    v_max_f32 v218, v218, v221
    v_mov_b32 v219, v218
    s_nop 1
    v_permlane32_swap_b32 v218, v219
    v_max3_f32 v218, v218, v219, v216
    v_sub_f32 v220, v216, v218
    v_mov_b32 v216, v218
    v_exp_f32 v220, v220
    v_sub_f32 v192, v144, v218
    v_sub_f32 v193, v145, v218
    v_sub_f32 v194, v146, v218
    v_sub_f32 v195, v147, v218
    v_sub_f32 v196, v148, v218
    v_sub_f32 v197, v149, v218
    v_sub_f32 v198, v150, v218
    v_sub_f32 v199, v151, v218
    v_sub_f32 v200, v152, v218
    v_sub_f32 v201, v153, v218
    v_sub_f32 v202, v154, v218
    v_sub_f32 v203, v155, v218
    v_sub_f32 v204, v156, v218
    v_sub_f32 v205, v157, v218
    v_sub_f32 v206, v158, v218
    v_sub_f32 v207, v159, v218
    ds_write_b128 v28, v[128:131] offset:16384
    v_exp_f32 v192, v192
    v_exp_f32 v193, v193
    v_exp_f32 v194, v194
    v_exp_f32 v195, v195
    ds_write_b128 v28, v[132:135] offset:17408
    v_exp_f32 v196, v196
    v_exp_f32 v197, v197
    v_exp_f32 v198, v198
    v_exp_f32 v199, v199
    ds_write_b128 v28, v[136:139] offset:18432
    v_exp_f32 v200, v200
    v_exp_f32 v201, v201
    v_exp_f32 v202, v202
    v_exp_f32 v203, v203
    ds_write_b128 v28, v[140:143] offset:19456
    v_exp_f32 v204, v204
    v_exp_f32 v205, v205
    v_exp_f32 v206, v206
    v_exp_f32 v207, v207
    v_mul_f32 v217, v217, v220
    v_cvt_pk_bf16_f32 v208, v192, v193
    v_cvt_pk_bf16_f32 v209, v194, v195
    v_cvt_pk_bf16_f32 v210, v196, v197
    v_cvt_pk_bf16_f32 v211, v198, v199
    v_cvt_pk_bf16_f32 v212, v200, v201
    v_cvt_pk_bf16_f32 v213, v202, v203
    v_cvt_pk_bf16_f32 v214, v204, v205
    v_cvt_pk_bf16_f32 v215, v206, v207
    v_mul_f32 v64, v64, v220
    v_mul_f32 v65, v65, v220
    v_mul_f32 v66, v66, v220
    v_mul_f32 v67, v67, v220
    v_mul_f32 v68, v68, v220
    v_mul_f32 v69, v69, v220
    v_mul_f32 v70, v70, v220
    v_mul_f32 v71, v71, v220
    v_mul_f32 v72, v72, v220
    v_mul_f32 v73, v73, v220
    v_mul_f32 v74, v74, v220
    v_mul_f32 v75, v75, v220
    v_mul_f32 v76, v76, v220
    v_mul_f32 v77, v77, v220
    v_mul_f32 v78, v78, v220
    v_mul_f32 v79, v79, v220
    s_waitcnt lgkmcnt(0)
    s_barrier
    v_mfma_f32_32x32x16_bf16 v[64:79], a[64:67], v[208:211], v[64:79]
    ds_read_b128 v[144:147], v29 offset:16384
    v_mul_f32 v80, v80, v220
    v_mul_f32 v81, v81, v220
    ds_read_b128 v[148:151], v29 offset:17408
    ds_write_b128 v26, a[96:99] offset:0
    buffer_load_dwordx4 a[96:99], v20, s[32:35], s58 offen nt
    v_mul_f32 v82, v82, v220
    v_mul_f32 v83, v83, v220
    ds_read_b128 v[152:155], v29 offset:18432
    v_mul_f32 v84, v84, v220
    v_mfma_f32_32x32x16_bf16 v[64:79], a[68:71], v[212:215], v[64:79]
    v_mul_f32 v85, v85, v220
    ds_read_b128 v[156:159], v29 offset:19456
    v_mul_f32 v86, v86, v220
    ds_write_b128 v26, a[100:103] offset:1024
    buffer_load_dwordx4 a[100:103], v21, s[32:35], s58 offen nt
    v_mul_f32 v87, v87, v220
    v_mul_f32 v88, v88, v220
    v_mul_f32 v89, v89, v220
    v_mul_f32 v90, v90, v220
    v_mul_f32 v91, v91, v220
    v_mul_f32 v92, v92, v220
    v_mul_f32 v93, v93, v220
    v_mul_f32 v94, v94, v220
    v_mul_f32 v95, v95, v220
    s_nop 1
    v_mfma_f32_32x32x16_bf16 v[80:95], a[72:75], v[208:211], v[80:95]
    ds_read_b128 v[160:163], v30 offset:16384
    v_mul_f32 v96, v96, v220
    v_mul_f32 v97, v97, v220
    ds_read_b128 v[164:167], v30 offset:17408
    ds_write_b128 v26, a[104:107] offset:2048
    buffer_load_dwordx4 a[104:107], v22, s[32:35], s58 offen nt
    v_mul_f32 v98, v98, v220
    v_mul_f32 v99, v99, v220
    ds_read_b128 v[168:171], v30 offset:18432
    v_mul_f32 v100, v100, v220
    v_mfma_f32_32x32x16_bf16 v[80:95], a[76:79], v[212:215], v[80:95]
    v_mul_f32 v101, v101, v220
    ds_read_b128 v[172:175], v30 offset:19456
    v_mul_f32 v102, v102, v220
    ds_write_b128 v26, a[108:111] offset:3072
    buffer_load_dwordx4 a[108:111], v23, s[32:35], s58 offen nt
    s_add_u32 s58, s58, 16384
    v_mul_f32 v103, v103, v220
    v_mul_f32 v104, v104, v220
    v_mul_f32 v105, v105, v220
    v_mul_f32 v106, v106, v220
    v_mul_f32 v107, v107, v220
    v_mul_f32 v108, v108, v220
    v_mul_f32 v109, v109, v220
    v_mul_f32 v110, v110, v220
    v_mul_f32 v111, v111, v220
    s_nop 1
    v_mfma_f32_32x32x16_bf16 v[96:111], a[80:83], v[208:211], v[96:111]
    ds_read_b128 v[176:179], v31 offset:16384
    v_mul_f32 v112, v112, v220
    v_mul_f32 v113, v113, v220
    ds_read_b128 v[180:183], v31 offset:17408
    ds_write_b128 v26, a[112:115] offset:4096
    buffer_load_dwordx4 a[112:115], v20, s[32:35], s58 offen nt
    v_mul_f32 v114, v114, v220
    v_mul_f32 v115, v115, v220
    ds_read_b128 v[184:187], v31 offset:18432
    v_mul_f32 v116, v116, v220
    v_mfma_f32_32x32x16_bf16 v[96:111], a[84:87], v[212:215], v[96:111]
    v_mul_f32 v117, v117, v220
    ds_read_b128 v[188:191], v31 offset:19456
    v_mul_f32 v118, v118, v220
    ds_write_b128 v26, a[116:119] offset:5120
    buffer_load_dwordx4 a[116:119], v21, s[32:35], s58 offen nt
    v_mul_f32 v119, v119, v220
    v_mul_f32 v120, v120, v220
    v_mul_f32 v121, v121, v220
    v_mul_f32 v122, v122, v220
    v_mul_f32 v123, v123, v220
    v_mul_f32 v124, v124, v220
    v_mul_f32 v125, v125, v220
    v_mul_f32 v126, v126, v220
    v_mul_f32 v127, v127, v220
    s_nop 1
    v_mfma_f32_32x32x16_bf16 v[112:127], a[88:91], v[208:211], v[112:127]
    v_add_f32 v192, v192, v200
    v_add_f32 v193, v193, v201
    v_add_f32 v194, v194, v202
    v_add_f32 v195, v195, v203
    ds_write_b128 v26, a[120:123] offset:6144
    buffer_load_dwordx4 a[120:123], v22, s[32:35], s58 offen nt
    v_add_f32 v196, v196, v204
    v_add_f32 v197, v197, v205
    v_add_f32 v198, v198, v206
    v_add_f32 v199, v199, v207
    v_mfma_f32_32x32x16_bf16 v[112:127], a[92:95], v[212:215], v[112:127]
    v_add_f32 v192, v192, v196
    v_add_f32 v193, v193, v197
    v_add_f32 v194, v194, v198
    ds_write_b128 v26, a[124:127] offset:7168
    buffer_load_dwordx4 a[124:127], v23, s[32:35], s58 offen nt
    s_add_u32 s58, s58, 16384
    v_add_f32 v195, v195, v199
    v_add_f32 v192, v192, v193
    v_add_f32 v194, v194, v195
    v_add_f32 v192, v192, v194
    v_add_f32 v217, v217, v192
    ds_read_b128 a[32:35], v32 offset:16384
    ds_read_b128 a[36:39], v33 offset:16384
    ds_read_b128 a[40:43], v34 offset:16384
    ds_read_b128 a[44:47], v35 offset:16384
    ds_read_b128 a[48:51], v36 offset:16384
    ds_read_b128 a[52:55], v37 offset:16384
    ds_read_b128 a[56:59], v38 offset:16384
    ds_read_b128 a[60:63], v39 offset:16384
    s_waitcnt lgkmcnt(8)
    v_add_f32 v144, v144, v128
    v_add_f32 v145, v145, v129
    v_add_f32 v146, v146, v130
    v_add_f32 v147, v147, v131
    v_add_f32 v148, v148, v132
    v_add_f32 v149, v149, v133
    v_add_f32 v150, v150, v134
    v_add_f32 v151, v151, v135
    v_add_f32 v152, v152, v136
    v_add_f32 v153, v153, v137
    v_add_f32 v154, v154, v138
    v_add_f32 v155, v155, v139
    v_add_f32 v156, v156, v140
    v_add_f32 v157, v157, v141
    v_add_f32 v158, v158, v142
    v_add_f32 v159, v159, v143
    s_waitcnt lgkmcnt(0)
    v_mfma_f32_32x32x16_bf16 v[128:143], a[32:35], a[0:3], 0
    ds_read_b64_tr_b16 a[64:65], v40 offset:8192
    ds_read_b64_tr_b16 a[66:67], v41 offset:10240
    v_add_f32 v160, v160, v176
    v_add_f32 v161, v161, v177
    v_add_f32 v162, v162, v178
    v_add_f32 v163, v163, v179
    v_add_f32 v164, v164, v180
    v_mfma_f32_32x32x16_bf16 v[128:143], a[36:39], a[4:7], v[128:143]
    ds_read_b64_tr_b16 a[72:73], v42 offset:8192
    ds_read_b64_tr_b16 a[74:75], v43 offset:10240
    v_add_f32 v165, v165, v181
    v_add_f32 v166, v166, v182
    v_add_f32 v167, v167, v183
    v_add_f32 v168, v168, v184
    v_add_f32 v169, v169, v185
    v_mfma_f32_32x32x16_bf16 v[128:143], a[40:43], a[8:11], v[128:143]
    ds_read_b64_tr_b16 a[80:81], v44 offset:8192
    ds_read_b64_tr_b16 a[82:83], v45 offset:10240
    v_add_f32 v170, v170, v186
    v_add_f32 v171, v171, v187
    v_add_f32 v172, v172, v188
    v_add_f32 v173, v173, v189
    v_add_f32 v174, v174, v190
    v_mfma_f32_32x32x16_bf16 v[128:143], a[44:47], a[12:15], v[128:143]
    ds_read_b64_tr_b16 a[88:89], v46 offset:8192
    ds_read_b64_tr_b16 a[90:91], v47 offset:10240
    v_add_f32 v175, v175, v191
    v_add_f32 v144, v144, v160
    v_add_f32 v145, v145, v161
    v_add_f32 v146, v146, v162
    v_add_f32 v147, v147, v163
    v_mfma_f32_32x32x16_bf16 v[128:143], a[48:51], a[16:19], v[128:143]
    ds_read_b64_tr_b16 a[68:69], v40 offset:12288
    ds_read_b64_tr_b16 a[70:71], v41 offset:14336
    v_add_f32 v148, v148, v164
    v_add_f32 v149, v149, v165
    v_add_f32 v150, v150, v166
    v_add_f32 v151, v151, v167
    v_add_f32 v152, v152, v168
    v_mfma_f32_32x32x16_bf16 v[128:143], a[52:55], a[20:23], v[128:143]
    ds_read_b64_tr_b16 a[76:77], v42 offset:12288
    ds_read_b64_tr_b16 a[78:79], v43 offset:14336
    v_add_f32 v153, v153, v169
    v_add_f32 v154, v154, v170
    v_add_f32 v155, v155, v171
    v_add_f32 v156, v156, v172
    v_add_f32 v157, v157, v173
    v_mfma_f32_32x32x16_bf16 v[128:143], a[56:59], a[24:27], v[128:143]
    ds_read_b64_tr_b16 a[84:85], v44 offset:12288
    ds_read_b64_tr_b16 a[86:87], v45 offset:14336
    v_add_f32 v158, v158, v174
    v_add_f32 v159, v159, v175
    v_max3_f32 v218, v144, v145, v146
    v_max3_f32 v219, v147, v148, v149
    v_max3_f32 v220, v150, v151, v152
    v_mfma_f32_32x32x16_bf16 v[128:143], a[60:63], a[28:31], v[128:143]
    ds_read_b64_tr_b16 a[92:93], v46 offset:12288
    ds_read_b64_tr_b16 a[94:95], v47 offset:14336
    v_max3_f32 v221, v153, v154, v155
    v_max3_f32 v218, v218, v156, v157
    v_max3_f32 v219, v219, v158, v159
    v_max3_f32 v218, v218, v219, v220
    v_max_f32 v218, v218, v221
    v_mov_b32 v219, v218
    s_nop 1
    v_permlane32_swap_b32 v218, v219
    v_max3_f32 v218, v218, v219, v216
    v_sub_f32 v220, v216, v218
    v_mov_b32 v216, v218
    v_exp_f32 v220, v220
    v_sub_f32 v192, v144, v218
    v_sub_f32 v193, v145, v218
    v_sub_f32 v194, v146, v218
    v_sub_f32 v195, v147, v218
    v_sub_f32 v196, v148, v218
    v_sub_f32 v197, v149, v218
    v_sub_f32 v198, v150, v218
    v_sub_f32 v199, v151, v218
    v_sub_f32 v200, v152, v218
    v_sub_f32 v201, v153, v218
    v_sub_f32 v202, v154, v218
    v_sub_f32 v203, v155, v218
    v_sub_f32 v204, v156, v218
    v_sub_f32 v205, v157, v218
    v_sub_f32 v206, v158, v218
    v_sub_f32 v207, v159, v218
    ds_write_b128 v28, v[128:131] offset:0
    v_exp_f32 v192, v192
    v_exp_f32 v193, v193
    v_exp_f32 v194, v194
    v_exp_f32 v195, v195
    ds_write_b128 v28, v[132:135] offset:1024
    v_exp_f32 v196, v196
    v_exp_f32 v197, v197
    v_exp_f32 v198, v198
    v_exp_f32 v199, v199
    ds_write_b128 v28, v[136:139] offset:2048
    v_exp_f32 v200, v200
    v_exp_f32 v201, v201
    v_exp_f32 v202, v202
    v_exp_f32 v203, v203
    ds_write_b128 v28, v[140:143] offset:3072
    v_exp_f32 v204, v204
    v_exp_f32 v205, v205
    v_exp_f32 v206, v206
    v_exp_f32 v207, v207
    v_mul_f32 v217, v217, v220
    v_cvt_pk_bf16_f32 v208, v192, v193
    v_cvt_pk_bf16_f32 v209, v194, v195
    v_cvt_pk_bf16_f32 v210, v196, v197
    v_cvt_pk_bf16_f32 v211, v198, v199
    v_cvt_pk_bf16_f32 v212, v200, v201
    v_cvt_pk_bf16_f32 v213, v202, v203
    v_cvt_pk_bf16_f32 v214, v204, v205
    v_cvt_pk_bf16_f32 v215, v206, v207
    v_mul_f32 v64, v64, v220
    v_mul_f32 v65, v65, v220
    v_mul_f32 v66, v66, v220
    v_mul_f32 v67, v67, v220
    v_mul_f32 v68, v68, v220
    v_mul_f32 v69, v69, v220
    v_mul_f32 v70, v70, v220
    v_mul_f32 v71, v71, v220
    v_mul_f32 v72, v72, v220
    v_mul_f32 v73, v73, v220
    v_mul_f32 v74, v74, v220
    v_mul_f32 v75, v75, v220
    v_mul_f32 v76, v76, v220
    v_mul_f32 v77, v77, v220
    v_mul_f32 v78, v78, v220
    v_mul_f32 v79, v79, v220
    s_waitcnt lgkmcnt(0)
    s_barrier
    v_mfma_f32_32x32x16_bf16 v[64:79], a[64:67], v[208:211], v[64:79]
    ds_read_b128 v[144:147], v29 offset:0
    v_mul_f32 v80, v80, v220
    v_mul_f32 v81, v81, v220
    ds_read_b128 v[148:151], v29 offset:1024
    ds_write_b128 v26, a[128:131] offset:8192
    buffer_load_dwordx4 a[128:131], v20, s[32:35], s58 offen nt
    v_mul_f32 v82, v82, v220
    v_mul_f32 v83, v83, v220
    ds_read_b128 v[152:155], v29 offset:2048
    v_mul_f32 v84, v84, v220
    v_mfma_f32_32x32x16_bf16 v[64:79], a[68:71], v[212:215], v[64:79]
    v_mul_f32 v85, v85, v220
    ds_read_b128 v[156:159], v29 offset:3072
    v_mul_f32 v86, v86, v220
    ds_write_b128 v26, a[132:135] offset:9216
    buffer_load_dwordx4 a[132:135], v21, s[32:35], s58 offen nt
    v_mul_f32 v87, v87, v220
    v_mul_f32 v88, v88, v220
    v_mul_f32 v89, v89, v220
    v_mul_f32 v90, v90, v220
    v_mul_f32 v91, v91, v220
    v_mul_f32 v92, v92, v220
    v_mul_f32 v93, v93, v220
    v_mul_f32 v94, v94, v220
    v_mul_f32 v95, v95, v220
    s_nop 1
    v_mfma_f32_32x32x16_bf16 v[80:95], a[72:75], v[208:211], v[80:95]
    ds_read_b128 v[160:163], v30 offset:0
    v_mul_f32 v96, v96, v220
    v_mul_f32 v97, v97, v220
    ds_read_b128 v[164:167], v30 offset:1024
    ds_write_b128 v26, a[136:139] offset:10240
    buffer_load_dwordx4 a[136:139], v22, s[32:35], s58 offen nt
    v_mul_f32 v98, v98, v220
    v_mul_f32 v99, v99, v220
    ds_read_b128 v[168:171], v30 offset:2048
    v_mul_f32 v100, v100, v220
    v_mfma_f32_32x32x16_bf16 v[80:95], a[76:79], v[212:215], v[80:95]
    v_mul_f32 v101, v101, v220
    ds_read_b128 v[172:175], v30 offset:3072
    v_mul_f32 v102, v102, v220
    ds_write_b128 v26, a[140:143] offset:11264
    buffer_load_dwordx4 a[140:143], v23, s[32:35], s58 offen nt
    s_add_u32 s58, s58, 16384
    v_mul_f32 v103, v103, v220
    v_mul_f32 v104, v104, v220
    v_mul_f32 v105, v105, v220
    v_mul_f32 v106, v106, v220
    v_mul_f32 v107, v107, v220
    v_mul_f32 v108, v108, v220
    v_mul_f32 v109, v109, v220
    v_mul_f32 v110, v110, v220
    v_mul_f32 v111, v111, v220
    s_nop 1
    v_mfma_f32_32x32x16_bf16 v[96:111], a[80:83], v[208:211], v[96:111]
    ds_read_b128 v[176:179], v31 offset:0
    v_mul_f32 v112, v112, v220
    v_mul_f32 v113, v113, v220
    ds_read_b128 v[180:183], v31 offset:1024
    ds_write_b128 v26, a[144:147] offset:12288
    buffer_load_dwordx4 a[144:147], v20, s[32:35], s58 offen nt
    v_mul_f32 v114, v114, v220
    v_mul_f32 v115, v115, v220
    ds_read_b128 v[184:187], v31 offset:2048
    v_mul_f32 v116, v116, v220
    v_mfma_f32_32x32x16_bf16 v[96:111], a[84:87], v[212:215], v[96:111]
    v_mul_f32 v117, v117, v220
    ds_read_b128 v[188:191], v31 offset:3072
    v_mul_f32 v118, v118, v220
    ds_write_b128 v26, a[148:151] offset:13312
    buffer_load_dwordx4 a[148:151], v21, s[32:35], s58 offen nt
    v_mul_f32 v119, v119, v220
    v_mul_f32 v120, v120, v220
    v_mul_f32 v121, v121, v220
    v_mul_f32 v122, v122, v220
    v_mul_f32 v123, v123, v220
    v_mul_f32 v124, v124, v220
    v_mul_f32 v125, v125, v220
    v_mul_f32 v126, v126, v220
    v_mul_f32 v127, v127, v220
    s_nop 1
    v_mfma_f32_32x32x16_bf16 v[112:127], a[88:91], v[208:211], v[112:127]
    v_add_f32 v192, v192, v200
    v_add_f32 v193, v193, v201
    v_add_f32 v194, v194, v202
    v_add_f32 v195, v195, v203
    ds_write_b128 v26, a[152:155] offset:14336
    buffer_load_dwordx4 a[152:155], v22, s[32:35], s58 offen nt
    v_add_f32 v196, v196, v204
    v_add_f32 v197, v197, v205
    v_add_f32 v198, v198, v206
    v_add_f32 v199, v199, v207
    v_mfma_f32_32x32x16_bf16 v[112:127], a[92:95], v[212:215], v[112:127]
    v_add_f32 v192, v192, v196
    v_add_f32 v193, v193, v197
    v_add_f32 v194, v194, v198
    ds_write_b128 v26, a[156:159] offset:15360
    buffer_load_dwordx4 a[156:159], v23, s[32:35], s58 offen nt
    s_add_u32 s58, s58, 16384
    v_add_f32 v195, v195, v199
    v_add_f32 v192, v192, v193
    v_add_f32 v194, v194, v195
    v_add_f32 v192, v192, v194
    v_add_f32 v217, v217, v192
    ds_read_b128 a[32:35], v32 offset:24576
    ds_read_b128 a[36:39], v33 offset:24576
    ds_read_b128 a[40:43], v34 offset:24576
    ds_read_b128 a[44:47], v35 offset:24576
    ds_read_b128 a[48:51], v36 offset:24576
    ds_read_b128 a[52:55], v37 offset:24576
    ds_read_b128 a[56:59], v38 offset:24576
    ds_read_b128 a[60:63], v39 offset:24576
    s_waitcnt lgkmcnt(8)
    v_add_f32 v144, v144, v128
    v_add_f32 v145, v145, v129
    v_add_f32 v146, v146, v130
    v_add_f32 v147, v147, v131
    v_add_f32 v148, v148, v132
    v_add_f32 v149, v149, v133
    v_add_f32 v150, v150, v134
    v_add_f32 v151, v151, v135
    v_add_f32 v152, v152, v136
    v_add_f32 v153, v153, v137
    v_add_f32 v154, v154, v138
    v_add_f32 v155, v155, v139
    v_add_f32 v156, v156, v140
    v_add_f32 v157, v157, v141
    v_add_f32 v158, v158, v142
    v_add_f32 v159, v159, v143
    s_waitcnt lgkmcnt(0)
    v_mfma_f32_32x32x16_bf16 v[128:143], a[32:35], a[0:3], 0
    ds_read_b64_tr_b16 a[64:65], v40 offset:16384
    ds_read_b64_tr_b16 a[66:67], v41 offset:18432
    v_add_f32 v160, v160, v176
    v_add_f32 v161, v161, v177
    v_add_f32 v162, v162, v178
    v_add_f32 v163, v163, v179
    v_add_f32 v164, v164, v180
    v_mfma_f32_32x32x16_bf16 v[128:143], a[36:39], a[4:7], v[128:143]
    ds_read_b64_tr_b16 a[72:73], v42 offset:16384
    ds_read_b64_tr_b16 a[74:75], v43 offset:18432
    v_add_f32 v165, v165, v181
    v_add_f32 v166, v166, v182
    v_add_f32 v167, v167, v183
    v_add_f32 v168, v168, v184
    v_add_f32 v169, v169, v185
    v_mfma_f32_32x32x16_bf16 v[128:143], a[40:43], a[8:11], v[128:143]
    ds_read_b64_tr_b16 a[80:81], v44 offset:16384
    ds_read_b64_tr_b16 a[82:83], v45 offset:18432
    v_add_f32 v170, v170, v186
    v_add_f32 v171, v171, v187
    v_add_f32 v172, v172, v188
    v_add_f32 v173, v173, v189
    v_add_f32 v174, v174, v190
    v_mfma_f32_32x32x16_bf16 v[128:143], a[44:47], a[12:15], v[128:143]
    ds_read_b64_tr_b16 a[88:89], v46 offset:16384
    ds_read_b64_tr_b16 a[90:91], v47 offset:18432
    v_add_f32 v175, v175, v191
    v_add_f32 v144, v144, v160
    v_add_f32 v145, v145, v161
    v_add_f32 v146, v146, v162
    v_add_f32 v147, v147, v163
    v_mfma_f32_32x32x16_bf16 v[128:143], a[48:51], a[16:19], v[128:143]
    ds_read_b64_tr_b16 a[68:69], v40 offset:20480
    ds_read_b64_tr_b16 a[70:71], v41 offset:22528
    v_add_f32 v148, v148, v164
    v_add_f32 v149, v149, v165
    v_add_f32 v150, v150, v166
    v_add_f32 v151, v151, v167
    v_add_f32 v152, v152, v168
    v_mfma_f32_32x32x16_bf16 v[128:143], a[52:55], a[20:23], v[128:143]
    ds_read_b64_tr_b16 a[76:77], v42 offset:20480
    ds_read_b64_tr_b16 a[78:79], v43 offset:22528
    v_add_f32 v153, v153, v169
    v_add_f32 v154, v154, v170
    v_add_f32 v155, v155, v171
    v_add_f32 v156, v156, v172
    v_add_f32 v157, v157, v173
    v_mfma_f32_32x32x16_bf16 v[128:143], a[56:59], a[24:27], v[128:143]
    ds_read_b64_tr_b16 a[84:85], v44 offset:20480
    ds_read_b64_tr_b16 a[86:87], v45 offset:22528
    v_add_f32 v158, v158, v174
    v_add_f32 v159, v159, v175
    v_max3_f32 v218, v144, v145, v146
    v_max3_f32 v219, v147, v148, v149
    v_max3_f32 v220, v150, v151, v152
    v_mfma_f32_32x32x16_bf16 v[128:143], a[60:63], a[28:31], v[128:143]
    ds_read_b64_tr_b16 a[92:93], v46 offset:20480
    ds_read_b64_tr_b16 a[94:95], v47 offset:22528
    v_max3_f32 v221, v153, v154, v155
    v_max3_f32 v218, v218, v156, v157
    v_max3_f32 v219, v219, v158, v159
    v_max3_f32 v218, v218, v219, v220
    v_max_f32 v218, v218, v221
    v_mov_b32 v219, v218
    s_nop 1
    v_permlane32_swap_b32 v218, v219
    v_max3_f32 v218, v218, v219, v216
    v_sub_f32 v220, v216, v218
    v_mov_b32 v216, v218
    v_exp_f32 v220, v220
    v_sub_f32 v192, v144, v218
    v_sub_f32 v193, v145, v218
    v_sub_f32 v194, v146, v218
    v_sub_f32 v195, v147, v218
    v_sub_f32 v196, v148, v218
    v_sub_f32 v197, v149, v218
    v_sub_f32 v198, v150, v218
    v_sub_f32 v199, v151, v218
    v_sub_f32 v200, v152, v218
    v_sub_f32 v201, v153, v218
    v_sub_f32 v202, v154, v218
    v_sub_f32 v203, v155, v218
    v_sub_f32 v204, v156, v218
    v_sub_f32 v205, v157, v218
    v_sub_f32 v206, v158, v218
    v_sub_f32 v207, v159, v218
    ds_write_b128 v28, v[128:131] offset:16384
    v_exp_f32 v192, v192
    v_exp_f32 v193, v193
    v_exp_f32 v194, v194
    v_exp_f32 v195, v195
    ds_write_b128 v28, v[132:135] offset:17408
    v_exp_f32 v196, v196
    v_exp_f32 v197, v197
    v_exp_f32 v198, v198
    v_exp_f32 v199, v199
    ds_write_b128 v28, v[136:139] offset:18432
    v_exp_f32 v200, v200
    v_exp_f32 v201, v201
    v_exp_f32 v202, v202
    v_exp_f32 v203, v203
    ds_write_b128 v28, v[140:143] offset:19456
    v_exp_f32 v204, v204
    v_exp_f32 v205, v205
    v_exp_f32 v206, v206
    v_exp_f32 v207, v207
    v_mul_f32 v217, v217, v220
    v_cvt_pk_bf16_f32 v208, v192, v193
    v_cvt_pk_bf16_f32 v209, v194, v195
    v_cvt_pk_bf16_f32 v210, v196, v197
    v_cvt_pk_bf16_f32 v211, v198, v199
    v_cvt_pk_bf16_f32 v212, v200, v201
    v_cvt_pk_bf16_f32 v213, v202, v203
    v_cvt_pk_bf16_f32 v214, v204, v205
    v_cvt_pk_bf16_f32 v215, v206, v207
    v_mul_f32 v64, v64, v220
    v_mul_f32 v65, v65, v220
    v_mul_f32 v66, v66, v220
    v_mul_f32 v67, v67, v220
    v_mul_f32 v68, v68, v220
    v_mul_f32 v69, v69, v220
    v_mul_f32 v70, v70, v220
    v_mul_f32 v71, v71, v220
    v_mul_f32 v72, v72, v220
    v_mul_f32 v73, v73, v220
    v_mul_f32 v74, v74, v220
    v_mul_f32 v75, v75, v220
    v_mul_f32 v76, v76, v220
    v_mul_f32 v77, v77, v220
    v_mul_f32 v78, v78, v220
    v_mul_f32 v79, v79, v220
    s_waitcnt lgkmcnt(0)
    s_barrier
    v_mfma_f32_32x32x16_bf16 v[64:79], a[64:67], v[208:211], v[64:79]
    ds_read_b128 v[144:147], v29 offset:16384
    v_mul_f32 v80, v80, v220
    v_mul_f32 v81, v81, v220
    ds_read_b128 v[148:151], v29 offset:17408
    ds_write_b128 v26, a[160:163] offset:16384
    buffer_load_dwordx4 a[160:163], v20, s[32:35], s58 offen nt
    v_mul_f32 v82, v82, v220
    v_mul_f32 v83, v83, v220
    ds_read_b128 v[152:155], v29 offset:18432
    v_mul_f32 v84, v84, v220
    v_mfma_f32_32x32x16_bf16 v[64:79], a[68:71], v[212:215], v[64:79]
    v_mul_f32 v85, v85, v220
    ds_read_b128 v[156:159], v29 offset:19456
    v_mul_f32 v86, v86, v220
    ds_write_b128 v26, a[164:167] offset:17408
    buffer_load_dwordx4 a[164:167], v21, s[32:35], s58 offen nt
    v_mul_f32 v87, v87, v220
    v_mul_f32 v88, v88, v220
    v_mul_f32 v89, v89, v220
    v_mul_f32 v90, v90, v220
    v_mul_f32 v91, v91, v220
    v_mul_f32 v92, v92, v220
    v_mul_f32 v93, v93, v220
    v_mul_f32 v94, v94, v220
    v_mul_f32 v95, v95, v220
    s_nop 1
    v_mfma_f32_32x32x16_bf16 v[80:95], a[72:75], v[208:211], v[80:95]
    ds_read_b128 v[160:163], v30 offset:16384
    v_mul_f32 v96, v96, v220
    v_mul_f32 v97, v97, v220
    ds_read_b128 v[164:167], v30 offset:17408
    ds_write_b128 v26, a[168:171] offset:18432
    buffer_load_dwordx4 a[168:171], v22, s[32:35], s58 offen nt
    v_mul_f32 v98, v98, v220
    v_mul_f32 v99, v99, v220
    ds_read_b128 v[168:171], v30 offset:18432
    v_mul_f32 v100, v100, v220
    v_mfma_f32_32x32x16_bf16 v[80:95], a[76:79], v[212:215], v[80:95]
    v_mul_f32 v101, v101, v220
    ds_read_b128 v[172:175], v30 offset:19456
    v_mul_f32 v102, v102, v220
    ds_write_b128 v26, a[172:175] offset:19456
    v_mul_f32 v103, v103, v220
    v_mul_f32 v104, v104, v220
    v_mul_f32 v105, v105, v220
    v_mul_f32 v106, v106, v220
    v_mul_f32 v107, v107, v220
    v_mul_f32 v108, v108, v220
    v_mul_f32 v109, v109, v220
    v_mul_f32 v110, v110, v220
    v_mul_f32 v111, v111, v220
    s_nop 1
    v_mfma_f32_32x32x16_bf16 v[96:111], a[80:83], v[208:211], v[96:111]
    ds_read_b128 v[176:179], v31 offset:16384
    v_mul_f32 v112, v112, v220
    v_mul_f32 v113, v113, v220
    ds_read_b128 v[180:183], v31 offset:17408
    ds_write_b128 v26, a[176:179] offset:20480
    buffer_load_dwordx4 a[172:175], v23, s[32:35], s58 offen nt
    s_add_u32 s58, s58, 16384
    v_mul_f32 v114, v114, v220
    v_mul_f32 v115, v115, v220
    ds_read_b128 v[184:187], v31 offset:18432
    v_mul_f32 v116, v116, v220
    v_mfma_f32_32x32x16_bf16 v[96:111], a[84:87], v[212:215], v[96:111]
    v_mul_f32 v117, v117, v220
    ds_read_b128 v[188:191], v31 offset:19456
    v_mul_f32 v118, v118, v220
    ds_write_b128 v26, a[180:183] offset:21504
    buffer_load_dwordx4 a[176:179], v20, s[32:35], s58 offen nt
    v_mul_f32 v119, v119, v220
    v_mul_f32 v120, v120, v220
    v_mul_f32 v121, v121, v220
    v_mul_f32 v122, v122, v220
    v_mul_f32 v123, v123, v220
    v_mul_f32 v124, v124, v220
    v_mul_f32 v125, v125, v220
    v_mul_f32 v126, v126, v220
    v_mul_f32 v127, v127, v220
    s_nop 1
    v_mfma_f32_32x32x16_bf16 v[112:127], a[88:91], v[208:211], v[112:127]
    v_add_f32 v192, v192, v200
    v_add_f32 v193, v193, v201
    v_add_f32 v194, v194, v202
    v_add_f32 v195, v195, v203
    ds_write_b128 v26, a[184:187] offset:22528
    buffer_load_dwordx4 a[180:183], v21, s[32:35], s58 offen nt
    v_add_f32 v196, v196, v204
    v_add_f32 v197, v197, v205
    v_add_f32 v198, v198, v206
    v_add_f32 v199, v199, v207
    v_mfma_f32_32x32x16_bf16 v[112:127], a[92:95], v[212:215], v[112:127]
    v_add_f32 v192, v192, v196
    v_add_f32 v193, v193, v197
    v_add_f32 v194, v194, v198
    ds_write_b128 v26, a[188:191] offset:23552
    v_add_f32 v195, v195, v199
    v_add_f32 v192, v192, v193
    v_add_f32 v194, v194, v195
    v_add_f32 v192, v192, v194
    v_add_f32 v217, v217, v192
    ds_read_b128 a[32:35], v32 offset:0
    ds_read_b128 a[36:39], v33 offset:0
    ds_read_b128 a[40:43], v34 offset:0
    ds_read_b128 a[44:47], v35 offset:0
    ds_read_b128 a[48:51], v36 offset:0
    ds_read_b128 a[52:55], v37 offset:0
    ds_read_b128 a[56:59], v38 offset:0
    ds_read_b128 a[60:63], v39 offset:0
    s_waitcnt lgkmcnt(8)
    v_add_f32 v144, v144, v128
    v_add_f32 v145, v145, v129
    v_add_f32 v146, v146, v130
    v_add_f32 v147, v147, v131
    buffer_load_dwordx4 a[184:187], v22, s[32:35], s58 offen nt
    v_add_f32 v148, v148, v132
    v_add_f32 v149, v149, v133
    v_add_f32 v150, v150, v134
    v_add_f32 v151, v151, v135
    v_add_f32 v152, v152, v136
    v_add_f32 v153, v153, v137
    v_add_f32 v154, v154, v138
    v_add_f32 v155, v155, v139
    v_add_f32 v156, v156, v140
    v_add_f32 v157, v157, v141
    v_add_f32 v158, v158, v142
    v_add_f32 v159, v159, v143
    s_waitcnt lgkmcnt(0)
    v_mfma_f32_32x32x16_bf16 v[128:143], a[32:35], a[0:3], 0
    ds_read_b64_tr_b16 a[64:65], v40 offset:24576
    ds_read_b64_tr_b16 a[66:67], v41 offset:26624
    v_add_f32 v160, v160, v176
    v_add_f32 v161, v161, v177
    v_add_f32 v162, v162, v178
    v_add_f32 v163, v163, v179
    v_add_f32 v164, v164, v180
    v_mfma_f32_32x32x16_bf16 v[128:143], a[36:39], a[4:7], v[128:143]
    ds_read_b64_tr_b16 a[72:73], v42 offset:24576
    ds_read_b64_tr_b16 a[74:75], v43 offset:26624
    v_add_f32 v165, v165, v181
    v_add_f32 v166, v166, v182
    v_add_f32 v167, v167, v183
    v_add_f32 v168, v168, v184
    v_add_f32 v169, v169, v185
    v_mfma_f32_32x32x16_bf16 v[128:143], a[40:43], a[8:11], v[128:143]
    ds_read_b64_tr_b16 a[80:81], v44 offset:24576
    ds_read_b64_tr_b16 a[82:83], v45 offset:26624
    v_add_f32 v170, v170, v186
    v_add_f32 v171, v171, v187
    v_add_f32 v172, v172, v188
    v_add_f32 v173, v173, v189
    v_add_f32 v174, v174, v190
    v_mfma_f32_32x32x16_bf16 v[128:143], a[44:47], a[12:15], v[128:143]
    ds_read_b64_tr_b16 a[88:89], v46 offset:24576
    ds_read_b64_tr_b16 a[90:91], v47 offset:26624
    v_add_f32 v175, v175, v191
    v_add_f32 v144, v144, v160
    v_add_f32 v145, v145, v161
    v_add_f32 v146, v146, v162
    v_add_f32 v147, v147, v163
    v_mfma_f32_32x32x16_bf16 v[128:143], a[48:51], a[16:19], v[128:143]
    ds_read_b64_tr_b16 a[68:69], v40 offset:28672
    ds_read_b64_tr_b16 a[70:71], v41 offset:30720
    v_add_f32 v148, v148, v164
    v_add_f32 v149, v149, v165
    v_add_f32 v150, v150, v166
    v_add_f32 v151, v151, v167
    v_add_f32 v152, v152, v168
    v_mfma_f32_32x32x16_bf16 v[128:143], a[52:55], a[20:23], v[128:143]
    ds_read_b64_tr_b16 a[76:77], v42 offset:28672
    ds_read_b64_tr_b16 a[78:79], v43 offset:30720
    v_add_f32 v153, v153, v169
    v_add_f32 v154, v154, v170
    v_add_f32 v155, v155, v171
    v_add_f32 v156, v156, v172
    v_add_f32 v157, v157, v173
    v_mfma_f32_32x32x16_bf16 v[128:143], a[56:59], a[24:27], v[128:143]
    ds_read_b64_tr_b16 a[84:85], v44 offset:28672
    ds_read_b64_tr_b16 a[86:87], v45 offset:30720
    v_add_f32 v158, v158, v174
    v_add_f32 v159, v159, v175
    v_max3_f32 v218, v144, v145, v146
    v_max3_f32 v219, v147, v148, v149
    v_max3_f32 v220, v150, v151, v152
    v_mfma_f32_32x32x16_bf16 v[128:143], a[60:63], a[28:31], v[128:143]
    ds_read_b64_tr_b16 a[92:93], v46 offset:28672
    ds_read_b64_tr_b16 a[94:95], v47 offset:30720
    v_max3_f32 v221, v153, v154, v155
    v_max3_f32 v218, v218, v156, v157
    v_max3_f32 v219, v219, v158, v159
    v_max3_f32 v218, v218, v219, v220
    v_max_f32 v218, v218, v221
    v_mov_b32 v219, v218
    s_nop 1
    v_permlane32_swap_b32 v218, v219
    v_max3_f32 v218, v218, v219, v216
    v_sub_f32 v220, v216, v218
    v_mov_b32 v216, v218
    v_exp_f32 v220, v220
    v_sub_f32 v192, v144, v218
    v_sub_f32 v193, v145, v218
    buffer_load_dwordx4 a[188:191], v23, s[32:35], s58 offen nt
    s_add_u32 s58, s58, 16384
    v_sub_f32 v194, v146, v218
    v_sub_f32 v195, v147, v218
    v_sub_f32 v196, v148, v218
    v_sub_f32 v197, v149, v218
    v_sub_f32 v198, v150, v218
    v_sub_f32 v199, v151, v218
    v_sub_f32 v200, v152, v218
    v_sub_f32 v201, v153, v218
    v_sub_f32 v202, v154, v218
    v_sub_f32 v203, v155, v218
    v_sub_f32 v204, v156, v218
    v_sub_f32 v205, v157, v218
    v_sub_f32 v206, v158, v218
    v_sub_f32 v207, v159, v218
    ds_write_b128 v28, v[128:131] offset:0
    v_exp_f32 v192, v192
    v_exp_f32 v193, v193
    v_exp_f32 v194, v194
    v_exp_f32 v195, v195
    ds_write_b128 v28, v[132:135] offset:1024
    v_exp_f32 v196, v196
    v_exp_f32 v197, v197
    v_exp_f32 v198, v198
    v_exp_f32 v199, v199
    ds_write_b128 v28, v[136:139] offset:2048
    v_exp_f32 v200, v200
    v_exp_f32 v201, v201
    v_exp_f32 v202, v202
    v_exp_f32 v203, v203
    ds_write_b128 v28, v[140:143] offset:3072
    v_exp_f32 v204, v204
    v_exp_f32 v205, v205
    v_exp_f32 v206, v206
    v_exp_f32 v207, v207
    v_mul_f32 v217, v217, v220
    v_cvt_pk_bf16_f32 v208, v192, v193
    v_cvt_pk_bf16_f32 v209, v194, v195
    v_cvt_pk_bf16_f32 v210, v196, v197
    v_cvt_pk_bf16_f32 v211, v198, v199
    v_cvt_pk_bf16_f32 v212, v200, v201
    v_cvt_pk_bf16_f32 v213, v202, v203
    v_cvt_pk_bf16_f32 v214, v204, v205
    v_cvt_pk_bf16_f32 v215, v206, v207
    v_mul_f32 v64, v64, v220
    v_mul_f32 v65, v65, v220
    v_mul_f32 v66, v66, v220
    v_mul_f32 v67, v67, v220
    v_mul_f32 v68, v68, v220
    v_mul_f32 v69, v69, v220
    v_mul_f32 v70, v70, v220
    v_mul_f32 v71, v71, v220
    v_mul_f32 v72, v72, v220
    v_mul_f32 v73, v73, v220
    v_mul_f32 v74, v74, v220
    v_mul_f32 v75, v75, v220
    v_mul_f32 v76, v76, v220
    v_mul_f32 v77, v77, v220
    v_mul_f32 v78, v78, v220
    v_mul_f32 v79, v79, v220
    s_waitcnt lgkmcnt(0)
    s_barrier
    v_mfma_f32_32x32x16_bf16 v[64:79], a[64:67], v[208:211], v[64:79]
    ds_read_b128 v[144:147], v29 offset:0
    v_mul_f32 v80, v80, v220
    v_mul_f32 v81, v81, v220
    ds_read_b128 v[148:151], v29 offset:1024
    ds_write_b128 v26, a[192:195] offset:24576
    buffer_load_dwordx4 a[192:195], v20, s[32:35], s58 offen nt
    v_mul_f32 v82, v82, v220
    v_mul_f32 v83, v83, v220
    ds_read_b128 v[152:155], v29 offset:2048
    v_mul_f32 v84, v84, v220
    v_mfma_f32_32x32x16_bf16 v[64:79], a[68:71], v[212:215], v[64:79]
    v_mul_f32 v85, v85, v220
    ds_read_b128 v[156:159], v29 offset:3072
    v_mul_f32 v86, v86, v220
    ds_write_b128 v26, a[196:199] offset:25600
    v_mul_f32 v87, v87, v220
    v_mul_f32 v88, v88, v220
    v_mul_f32 v89, v89, v220
    v_mul_f32 v90, v90, v220
    v_mul_f32 v91, v91, v220
    v_mul_f32 v92, v92, v220
    v_mul_f32 v93, v93, v220
    v_mul_f32 v94, v94, v220
    v_mul_f32 v95, v95, v220
    s_nop 1
    v_mfma_f32_32x32x16_bf16 v[80:95], a[72:75], v[208:211], v[80:95]
    ds_read_b128 v[160:163], v30 offset:0
    v_mul_f32 v96, v96, v220
    v_mul_f32 v97, v97, v220
    ds_read_b128 v[164:167], v30 offset:1024
    ds_write_b128 v26, a[200:203] offset:26624
    buffer_load_dwordx4 a[196:199], v21, s[32:35], s58 offen nt
    v_mul_f32 v98, v98, v220
    v_mul_f32 v99, v99, v220
    ds_read_b128 v[168:171], v30 offset:2048
    v_mul_f32 v100, v100, v220
    v_mfma_f32_32x32x16_bf16 v[80:95], a[76:79], v[212:215], v[80:95]
    v_mul_f32 v101, v101, v220
    ds_read_b128 v[172:175], v30 offset:3072
    v_mul_f32 v102, v102, v220
    ds_write_b128 v26, a[204:207] offset:27648
    v_mul_f32 v103, v103, v220
    v_mul_f32 v104, v104, v220
    v_mul_f32 v105, v105, v220
    v_mul_f32 v106, v106, v220
    v_mul_f32 v107, v107, v220
    v_mul_f32 v108, v108, v220
    v_mul_f32 v109, v109, v220
    v_mul_f32 v110, v110, v220
    v_mul_f32 v111, v111, v220
    s_nop 1
    v_mfma_f32_32x32x16_bf16 v[96:111], a[80:83], v[208:211], v[96:111]
    ds_read_b128 v[176:179], v31 offset:0
    v_mul_f32 v112, v112, v220
    v_mul_f32 v113, v113, v220
    ds_read_b128 v[180:183], v31 offset:1024
    ds_write_b128 v26, a[208:211] offset:28672
    buffer_load_dwordx4 a[200:203], v22, s[32:35], s58 offen nt
    v_mul_f32 v114, v114, v220
    v_mul_f32 v115, v115, v220
    ds_read_b128 v[184:187], v31 offset:2048
    v_mul_f32 v116, v116, v220
    v_mfma_f32_32x32x16_bf16 v[96:111], a[84:87], v[212:215], v[96:111]
    v_mul_f32 v117, v117, v220
    ds_read_b128 v[188:191], v31 offset:3072
    v_mul_f32 v118, v118, v220
    ds_write_b128 v26, a[212:215] offset:29696
    v_mul_f32 v119, v119, v220
    v_mul_f32 v120, v120, v220
    v_mul_f32 v121, v121, v220
    v_mul_f32 v122, v122, v220
    v_mul_f32 v123, v123, v220
    v_mul_f32 v124, v124, v220
    v_mul_f32 v125, v125, v220
    v_mul_f32 v126, v126, v220
    v_mul_f32 v127, v127, v220
    s_nop 1
    v_mfma_f32_32x32x16_bf16 v[112:127], a[88:91], v[208:211], v[112:127]
    v_add_f32 v192, v192, v200
    v_add_f32 v193, v193, v201
    v_add_f32 v194, v194, v202
    v_add_f32 v195, v195, v203
    ds_write_b128 v26, a[216:219] offset:30720
    buffer_load_dwordx4 a[204:207], v23, s[32:35], s58 offen nt
    s_add_u32 s58, s58, 16384
    v_add_f32 v196, v196, v204
    v_add_f32 v197, v197, v205
    v_add_f32 v198, v198, v206
    v_add_f32 v199, v199, v207
    v_mfma_f32_32x32x16_bf16 v[112:127], a[92:95], v[212:215], v[112:127]
    v_add_f32 v192, v192, v196
    v_add_f32 v193, v193, v197
    v_add_f32 v194, v194, v198
    ds_write_b128 v26, a[220:223] offset:31744
    v_add_f32 v195, v195, v199
    v_add_f32 v192, v192, v193
    v_add_f32 v194, v194, v195
    v_add_f32 v192, v192, v194
    v_add_f32 v217, v217, v192
    ds_read_b128 a[32:35], v32 offset:8192
    ds_read_b128 a[36:39], v33 offset:8192
    ds_read_b128 a[40:43], v34 offset:8192
    ds_read_b128 a[44:47], v35 offset:8192
    ds_read_b128 a[48:51], v36 offset:8192
    ds_read_b128 a[52:55], v37 offset:8192
    ds_read_b128 a[56:59], v38 offset:8192
    ds_read_b128 a[60:63], v39 offset:8192
    s_waitcnt lgkmcnt(8)
    v_add_f32 v144, v144, v128
    v_add_f32 v145, v145, v129
    v_add_f32 v146, v146, v130
    v_add_f32 v147, v147, v131
    buffer_load_dwordx4 a[208:211], v20, s[32:35], s58 offen nt
    v_add_f32 v148, v148, v132
    v_add_f32 v149, v149, v133
    v_add_f32 v150, v150, v134
    v_add_f32 v151, v151, v135
    v_add_f32 v152, v152, v136
    v_add_f32 v153, v153, v137
    v_add_f32 v154, v154, v138
    v_add_f32 v155, v155, v139
    v_add_f32 v156, v156, v140
    v_add_f32 v157, v157, v141
    v_add_f32 v158, v158, v142
    v_add_f32 v159, v159, v143
    s_waitcnt lgkmcnt(0)
    v_mfma_f32_32x32x16_bf16 v[128:143], a[32:35], a[0:3], 0
    ds_read_b64_tr_b16 a[64:65], v40 offset:0
    ds_read_b64_tr_b16 a[66:67], v41 offset:2048
    v_add_f32 v160, v160, v176
    v_add_f32 v161, v161, v177
    v_add_f32 v162, v162, v178
    v_add_f32 v163, v163, v179
    v_add_f32 v164, v164, v180
    v_mfma_f32_32x32x16_bf16 v[128:143], a[36:39], a[4:7], v[128:143]
    ds_read_b64_tr_b16 a[72:73], v42 offset:0
    ds_read_b64_tr_b16 a[74:75], v43 offset:2048
    v_add_f32 v165, v165, v181
    v_add_f32 v166, v166, v182
    v_add_f32 v167, v167, v183
    v_add_f32 v168, v168, v184
    v_add_f32 v169, v169, v185
    v_mfma_f32_32x32x16_bf16 v[128:143], a[40:43], a[8:11], v[128:143]
    ds_read_b64_tr_b16 a[80:81], v44 offset:0
    ds_read_b64_tr_b16 a[82:83], v45 offset:2048
    v_add_f32 v170, v170, v186
    v_add_f32 v171, v171, v187
    v_add_f32 v172, v172, v188
    v_add_f32 v173, v173, v189
    v_add_f32 v174, v174, v190
    v_mfma_f32_32x32x16_bf16 v[128:143], a[44:47], a[12:15], v[128:143]
    ds_read_b64_tr_b16 a[88:89], v46 offset:0
    ds_read_b64_tr_b16 a[90:91], v47 offset:2048
    v_add_f32 v175, v175, v191
    v_add_f32 v144, v144, v160
    v_add_f32 v145, v145, v161
    v_add_f32 v146, v146, v162
    v_add_f32 v147, v147, v163
    v_mfma_f32_32x32x16_bf16 v[128:143], a[48:51], a[16:19], v[128:143]
    ds_read_b64_tr_b16 a[68:69], v40 offset:4096
    ds_read_b64_tr_b16 a[70:71], v41 offset:6144
    v_add_f32 v148, v148, v164
    v_add_f32 v149, v149, v165
    v_add_f32 v150, v150, v166
    v_add_f32 v151, v151, v167
    v_add_f32 v152, v152, v168
    v_mfma_f32_32x32x16_bf16 v[128:143], a[52:55], a[20:23], v[128:143]
    ds_read_b64_tr_b16 a[76:77], v42 offset:4096
    ds_read_b64_tr_b16 a[78:79], v43 offset:6144
    v_add_f32 v153, v153, v169
    v_add_f32 v154, v154, v170
    v_add_f32 v155, v155, v171
    v_add_f32 v156, v156, v172
    v_add_f32 v157, v157, v173
    v_mfma_f32_32x32x16_bf16 v[128:143], a[56:59], a[24:27], v[128:143]
    ds_read_b64_tr_b16 a[84:85], v44 offset:4096
    ds_read_b64_tr_b16 a[86:87], v45 offset:6144
    v_add_f32 v158, v158, v174
    v_add_f32 v159, v159, v175
    v_max3_f32 v218, v144, v145, v146
    v_max3_f32 v219, v147, v148, v149
    v_max3_f32 v220, v150, v151, v152
    v_mfma_f32_32x32x16_bf16 v[128:143], a[60:63], a[28:31], v[128:143]
    ds_read_b64_tr_b16 a[92:93], v46 offset:4096
    ds_read_b64_tr_b16 a[94:95], v47 offset:6144
    v_max3_f32 v221, v153, v154, v155
    v_max3_f32 v218, v218, v156, v157
    v_max3_f32 v219, v219, v158, v159
    v_max3_f32 v218, v218, v219, v220
    v_max_f32 v218, v218, v221
    v_mov_b32 v219, v218
    s_nop 1
    v_permlane32_swap_b32 v218, v219
    v_max3_f32 v218, v218, v219, v216
    v_sub_f32 v220, v216, v218
    v_mov_b32 v216, v218
    v_exp_f32 v220, v220
    v_sub_f32 v192, v144, v218
    v_sub_f32 v193, v145, v218
    buffer_load_dwordx4 a[212:215], v21, s[32:35], s58 offen nt
    v_sub_f32 v194, v146, v218
    v_sub_f32 v195, v147, v218
    v_sub_f32 v196, v148, v218
    v_sub_f32 v197, v149, v218
    v_sub_f32 v198, v150, v218
    buffer_load_dwordx4 a[216:219], v22, s[32:35], s58 offen nt
    v_sub_f32 v199, v151, v218
    v_sub_f32 v200, v152, v218
    v_sub_f32 v201, v153, v218
    v_sub_f32 v202, v154, v218
    v_sub_f32 v203, v155, v218
    v_sub_f32 v204, v156, v218
    v_sub_f32 v205, v157, v218
    v_sub_f32 v206, v158, v218
    v_sub_f32 v207, v159, v218
    ds_write_b128 v28, v[128:131] offset:16384
    v_exp_f32 v192, v192
    v_exp_f32 v193, v193
    v_exp_f32 v194, v194
    v_exp_f32 v195, v195
    ds_write_b128 v28, v[132:135] offset:17408
    v_exp_f32 v196, v196
    v_exp_f32 v197, v197
    v_exp_f32 v198, v198
    v_exp_f32 v199, v199
    ds_write_b128 v28, v[136:139] offset:18432
    v_exp_f32 v200, v200
    v_exp_f32 v201, v201
    v_exp_f32 v202, v202
    v_exp_f32 v203, v203
    ds_write_b128 v28, v[140:143] offset:19456
    v_exp_f32 v204, v204
    v_exp_f32 v205, v205
    v_exp_f32 v206, v206
    v_exp_f32 v207, v207
    v_mul_f32 v217, v217, v220
    v_cvt_pk_bf16_f32 v208, v192, v193
    v_cvt_pk_bf16_f32 v209, v194, v195
    v_cvt_pk_bf16_f32 v210, v196, v197
    v_cvt_pk_bf16_f32 v211, v198, v199
    v_cvt_pk_bf16_f32 v212, v200, v201
    v_cvt_pk_bf16_f32 v213, v202, v203
    v_cvt_pk_bf16_f32 v214, v204, v205
    v_cvt_pk_bf16_f32 v215, v206, v207
    v_mul_f32 v64, v64, v220
    v_mul_f32 v65, v65, v220
    v_mul_f32 v66, v66, v220
    v_mul_f32 v67, v67, v220
    v_mul_f32 v68, v68, v220
    v_mul_f32 v69, v69, v220
    v_mul_f32 v70, v70, v220
    v_mul_f32 v71, v71, v220
    v_mul_f32 v72, v72, v220
    v_mul_f32 v73, v73, v220
    v_mul_f32 v74, v74, v220
    v_mul_f32 v75, v75, v220
    v_mul_f32 v76, v76, v220
    v_mul_f32 v77, v77, v220
    v_mul_f32 v78, v78, v220
    v_mul_f32 v79, v79, v220
    s_waitcnt lgkmcnt(0)
    s_barrier
    v_mfma_f32_32x32x16_bf16 v[64:79], a[64:67], v[208:211], v[64:79]
    ds_read_b128 v[144:147], v29 offset:16384
    v_mul_f32 v80, v80, v220
    v_mul_f32 v81, v81, v220
    ds_read_b128 v[148:151], v29 offset:17408
    ds_write_b128 v26, a[224:227] offset:0
    buffer_load_dwordx4 a[220:223], v23, s[32:35], s58 offen nt
    s_add_u32 s58, s58, 16384
    v_mul_f32 v82, v82, v220
    v_mul_f32 v83, v83, v220
    ds_read_b128 v[152:155], v29 offset:18432
    v_mul_f32 v84, v84, v220
    v_mfma_f32_32x32x16_bf16 v[64:79], a[68:71], v[212:215], v[64:79]
    v_mul_f32 v85, v85, v220
    ds_read_b128 v[156:159], v29 offset:19456
    v_mul_f32 v86, v86, v220
    ds_write_b128 v26, a[228:231] offset:1024
    v_mul_f32 v87, v87, v220
    v_mul_f32 v88, v88, v220
    v_mul_f32 v89, v89, v220
    v_mul_f32 v90, v90, v220
    v_mul_f32 v91, v91, v220
    v_mul_f32 v92, v92, v220
    v_mul_f32 v93, v93, v220
    v_mul_f32 v94, v94, v220
    v_mul_f32 v95, v95, v220
    s_nop 1
    v_mfma_f32_32x32x16_bf16 v[80:95], a[72:75], v[208:211], v[80:95]
    ds_read_b128 v[160:163], v30 offset:16384
    v_mul_f32 v96, v96, v220
    v_mul_f32 v97, v97, v220
    ds_read_b128 v[164:167], v30 offset:17408
    ds_write_b128 v26, a[232:235] offset:2048
    buffer_load_dwordx4 a[224:227], v20, s[32:35], s58 offen nt
    v_mul_f32 v98, v98, v220
    v_mul_f32 v99, v99, v220
    ds_read_b128 v[168:171], v30 offset:18432
    v_mul_f32 v100, v100, v220
    v_mfma_f32_32x32x16_bf16 v[80:95], a[76:79], v[212:215], v[80:95]
    v_mul_f32 v101, v101, v220
    ds_read_b128 v[172:175], v30 offset:19456
    v_mul_f32 v102, v102, v220
    ds_write_b128 v26, a[236:239] offset:3072
    v_mul_f32 v103, v103, v220
    v_mul_f32 v104, v104, v220
    v_mul_f32 v105, v105, v220
    v_mul_f32 v106, v106, v220
    v_mul_f32 v107, v107, v220
    v_mul_f32 v108, v108, v220
    v_mul_f32 v109, v109, v220
    v_mul_f32 v110, v110, v220
    v_mul_f32 v111, v111, v220
    s_nop 1
    v_mfma_f32_32x32x16_bf16 v[96:111], a[80:83], v[208:211], v[96:111]
    ds_read_b128 v[176:179], v31 offset:16384
    v_mul_f32 v112, v112, v220
    v_mul_f32 v113, v113, v220
    ds_read_b128 v[180:183], v31 offset:17408
    ds_write_b128 v26, a[240:243] offset:4096
    v_mul_f32 v114, v114, v220
    v_mul_f32 v115, v115, v220
    ds_read_b128 v[184:187], v31 offset:18432
    v_mul_f32 v116, v116, v220
    v_mfma_f32_32x32x16_bf16 v[96:111], a[84:87], v[212:215], v[96:111]
    v_mul_f32 v117, v117, v220
    ds_read_b128 v[188:191], v31 offset:19456
    v_mul_f32 v118, v118, v220
    ds_write_b128 v26, a[244:247] offset:5120
    buffer_load_dwordx4 a[228:231], v21, s[32:35], s58 offen nt
    v_mul_f32 v119, v119, v220
    v_mul_f32 v120, v120, v220
    v_mul_f32 v121, v121, v220
    v_mul_f32 v122, v122, v220
    v_mul_f32 v123, v123, v220
    v_mul_f32 v124, v124, v220
    v_mul_f32 v125, v125, v220
    v_mul_f32 v126, v126, v220
    v_mul_f32 v127, v127, v220
    s_nop 1
    v_mfma_f32_32x32x16_bf16 v[112:127], a[88:91], v[208:211], v[112:127]
    v_add_f32 v192, v192, v200
    v_add_f32 v193, v193, v201
    v_add_f32 v194, v194, v202
    v_add_f32 v195, v195, v203
    ds_write_b128 v26, a[248:251] offset:6144
    v_add_f32 v196, v196, v204
    v_add_f32 v197, v197, v205
    v_add_f32 v198, v198, v206
    v_add_f32 v199, v199, v207
    v_mfma_f32_32x32x16_bf16 v[112:127], a[92:95], v[212:215], v[112:127]
    v_add_f32 v192, v192, v196
    v_add_f32 v193, v193, v197
    v_add_f32 v194, v194, v198
    ds_write_b128 v26, a[252:255] offset:7168
    v_add_f32 v195, v195, v199
    v_add_f32 v192, v192, v193
    v_add_f32 v194, v194, v195
    v_add_f32 v192, v192, v194
    v_add_f32 v217, v217, v192
    ds_read_b128 a[32:35], v32 offset:16384
    ds_read_b128 a[36:39], v33 offset:16384
    ds_read_b128 a[40:43], v34 offset:16384
    ds_read_b128 a[44:47], v35 offset:16384
    ds_read_b128 a[48:51], v36 offset:16384
    ds_read_b128 a[52:55], v37 offset:16384
    ds_read_b128 a[56:59], v38 offset:16384
    ds_read_b128 a[60:63], v39 offset:16384
    s_waitcnt lgkmcnt(8)
    v_add_f32 v144, v144, v128
    v_add_f32 v145, v145, v129
    v_add_f32 v146, v146, v130
    v_add_f32 v147, v147, v131
    buffer_load_dwordx4 a[232:235], v22, s[32:35], s58 offen nt
    v_add_f32 v148, v148, v132
    v_add_f32 v149, v149, v133
    v_add_f32 v150, v150, v134
    v_add_f32 v151, v151, v135
    v_add_f32 v152, v152, v136
    v_add_f32 v153, v153, v137
    v_add_f32 v154, v154, v138
    v_add_f32 v155, v155, v139
    v_add_f32 v156, v156, v140
    v_add_f32 v157, v157, v141
    v_add_f32 v158, v158, v142
    v_add_f32 v159, v159, v143
    s_waitcnt lgkmcnt(0)
    v_mfma_f32_32x32x16_bf16 v[128:143], a[32:35], a[0:3], 0
    ds_read_b64_tr_b16 a[64:65], v40 offset:8192
    ds_read_b64_tr_b16 a[66:67], v41 offset:10240
    v_add_f32 v160, v160, v176
    v_add_f32 v161, v161, v177
    v_add_f32 v162, v162, v178
    v_add_f32 v163, v163, v179
    v_add_f32 v164, v164, v180
    v_mfma_f32_32x32x16_bf16 v[128:143], a[36:39], a[4:7], v[128:143]
    ds_read_b64_tr_b16 a[72:73], v42 offset:8192
    ds_read_b64_tr_b16 a[74:75], v43 offset:10240
    v_add_f32 v165, v165, v181
    v_add_f32 v166, v166, v182
    v_add_f32 v167, v167, v183
    v_add_f32 v168, v168, v184
    v_add_f32 v169, v169, v185
    v_mfma_f32_32x32x16_bf16 v[128:143], a[40:43], a[8:11], v[128:143]
    ds_read_b64_tr_b16 a[80:81], v44 offset:8192
    ds_read_b64_tr_b16 a[82:83], v45 offset:10240
    v_add_f32 v170, v170, v186
    v_add_f32 v171, v171, v187
    v_add_f32 v172, v172, v188
    v_add_f32 v173, v173, v189
    v_add_f32 v174, v174, v190
    v_mfma_f32_32x32x16_bf16 v[128:143], a[44:47], a[12:15], v[128:143]
    ds_read_b64_tr_b16 a[88:89], v46 offset:8192
    ds_read_b64_tr_b16 a[90:91], v47 offset:10240
    v_add_f32 v175, v175, v191
    v_add_f32 v144, v144, v160
    v_add_f32 v145, v145, v161
    v_add_f32 v146, v146, v162
    v_add_f32 v147, v147, v163
    v_mfma_f32_32x32x16_bf16 v[128:143], a[48:51], a[16:19], v[128:143]
    ds_read_b64_tr_b16 a[68:69], v40 offset:12288
    ds_read_b64_tr_b16 a[70:71], v41 offset:14336
    v_add_f32 v148, v148, v164
    v_add_f32 v149, v149, v165
    v_add_f32 v150, v150, v166
    v_add_f32 v151, v151, v167
    v_add_f32 v152, v152, v168
    v_mfma_f32_32x32x16_bf16 v[128:143], a[52:55], a[20:23], v[128:143]
    ds_read_b64_tr_b16 a[76:77], v42 offset:12288
    ds_read_b64_tr_b16 a[78:79], v43 offset:14336
    v_add_f32 v153, v153, v169
    v_add_f32 v154, v154, v170
    v_add_f32 v155, v155, v171
    v_add_f32 v156, v156, v172
    v_add_f32 v157, v157, v173
    v_mfma_f32_32x32x16_bf16 v[128:143], a[56:59], a[24:27], v[128:143]
    ds_read_b64_tr_b16 a[84:85], v44 offset:12288
    ds_read_b64_tr_b16 a[86:87], v45 offset:14336
    v_add_f32 v158, v158, v174
    v_add_f32 v159, v159, v175
    v_max3_f32 v218, v144, v145, v146
    v_max3_f32 v219, v147, v148, v149
    v_max3_f32 v220, v150, v151, v152
    v_mfma_f32_32x32x16_bf16 v[128:143], a[60:63], a[28:31], v[128:143]
    ds_read_b64_tr_b16 a[92:93], v46 offset:12288
    ds_read_b64_tr_b16 a[94:95], v47 offset:14336
    v_max3_f32 v221, v153, v154, v155
    v_max3_f32 v218, v218, v156, v157
    v_max3_f32 v219, v219, v158, v159
    v_max3_f32 v218, v218, v219, v220
    v_max_f32 v218, v218, v221
    v_mov_b32 v219, v218
    s_nop 1
    v_permlane32_swap_b32 v218, v219
    v_max3_f32 v218, v218, v219, v216
    v_sub_f32 v220, v216, v218
    v_mov_b32 v216, v218
    v_exp_f32 v220, v220
    v_sub_f32 v192, v144, v218
    v_sub_f32 v193, v145, v218
    buffer_load_dwordx4 a[236:239], v23, s[32:35], s58 offen nt
    s_add_u32 s58, s58, 16384
    v_sub_f32 v194, v146, v218
    v_sub_f32 v195, v147, v218
    v_sub_f32 v196, v148, v218
    v_sub_f32 v197, v149, v218
    v_sub_f32 v198, v150, v218
    buffer_load_dwordx4 a[240:243], v20, s[32:35], s58 offen nt
    v_sub_f32 v199, v151, v218
    v_sub_f32 v200, v152, v218
    v_sub_f32 v201, v153, v218
    v_sub_f32 v202, v154, v218
    v_sub_f32 v203, v155, v218
    v_sub_f32 v204, v156, v218
    v_sub_f32 v205, v157, v218
    v_sub_f32 v206, v158, v218
    v_sub_f32 v207, v159, v218
    ds_write_b128 v28, v[128:131] offset:0
    v_exp_f32 v192, v192
    v_exp_f32 v193, v193
    v_exp_f32 v194, v194
    v_exp_f32 v195, v195
    ds_write_b128 v28, v[132:135] offset:1024
    v_exp_f32 v196, v196
    v_exp_f32 v197, v197
    v_exp_f32 v198, v198
    v_exp_f32 v199, v199
    ds_write_b128 v28, v[136:139] offset:2048
    v_exp_f32 v200, v200
    v_exp_f32 v201, v201
    v_exp_f32 v202, v202
    v_exp_f32 v203, v203
    ds_write_b128 v28, v[140:143] offset:3072
    v_exp_f32 v204, v204
    v_exp_f32 v205, v205
    v_exp_f32 v206, v206
    v_exp_f32 v207, v207
    v_mul_f32 v217, v217, v220
    v_cvt_pk_bf16_f32 v208, v192, v193
    v_cvt_pk_bf16_f32 v209, v194, v195
    v_cvt_pk_bf16_f32 v210, v196, v197
    v_cvt_pk_bf16_f32 v211, v198, v199
    v_cvt_pk_bf16_f32 v212, v200, v201
    v_cvt_pk_bf16_f32 v213, v202, v203
    v_cvt_pk_bf16_f32 v214, v204, v205
    v_cvt_pk_bf16_f32 v215, v206, v207
    v_mul_f32 v64, v64, v220
    v_mul_f32 v65, v65, v220
    v_mul_f32 v66, v66, v220
    v_mul_f32 v67, v67, v220
    v_mul_f32 v68, v68, v220
    v_mul_f32 v69, v69, v220
    v_mul_f32 v70, v70, v220
    v_mul_f32 v71, v71, v220
    v_mul_f32 v72, v72, v220
    v_mul_f32 v73, v73, v220
    v_mul_f32 v74, v74, v220
    v_mul_f32 v75, v75, v220
    v_mul_f32 v76, v76, v220
    v_mul_f32 v77, v77, v220
    v_mul_f32 v78, v78, v220
    v_mul_f32 v79, v79, v220
    s_waitcnt lgkmcnt(0)
    s_barrier
    v_mfma_f32_32x32x16_bf16 v[64:79], a[64:67], v[208:211], v[64:79]
    ds_read_b128 v[144:147], v29 offset:0
    v_mul_f32 v80, v80, v220
    v_mul_f32 v81, v81, v220
    ds_read_b128 v[148:151], v29 offset:1024
    ds_write_b128 v26, v[224:227] offset:8192
    buffer_load_dwordx4 a[244:247], v21, s[32:35], s58 offen nt
    v_mul_f32 v82, v82, v220
    v_mul_f32 v83, v83, v220
    ds_read_b128 v[152:155], v29 offset:2048
    v_mul_f32 v84, v84, v220
    v_mfma_f32_32x32x16_bf16 v[64:79], a[68:71], v[212:215], v[64:79]
    v_mul_f32 v85, v85, v220
    ds_read_b128 v[156:159], v29 offset:3072
    v_mul_f32 v86, v86, v220
    ds_write_b128 v26, v[228:231] offset:9216
    v_mul_f32 v87, v87, v220
    v_mul_f32 v88, v88, v220
    v_mul_f32 v89, v89, v220
    v_mul_f32 v90, v90, v220
    v_mul_f32 v91, v91, v220
    v_mul_f32 v92, v92, v220
    v_mul_f32 v93, v93, v220
    v_mul_f32 v94, v94, v220
    v_mul_f32 v95, v95, v220
    s_nop 1
    v_mfma_f32_32x32x16_bf16 v[80:95], a[72:75], v[208:211], v[80:95]
    ds_read_b128 v[160:163], v30 offset:0
    v_mul_f32 v96, v96, v220
    v_mul_f32 v97, v97, v220
    ds_read_b128 v[164:167], v30 offset:1024
    ds_write_b128 v26, v[232:235] offset:10240
    buffer_load_dwordx4 a[248:251], v22, s[32:35], s58 offen nt
    v_mul_f32 v98, v98, v220
    v_mul_f32 v99, v99, v220
    ds_read_b128 v[168:171], v30 offset:2048
    v_mul_f32 v100, v100, v220
    v_mfma_f32_32x32x16_bf16 v[80:95], a[76:79], v[212:215], v[80:95]
    v_mul_f32 v101, v101, v220
    ds_read_b128 v[172:175], v30 offset:3072
    v_mul_f32 v102, v102, v220
    ds_write_b128 v26, v[236:239] offset:11264
    v_mul_f32 v103, v103, v220
    v_mul_f32 v104, v104, v220
    v_mul_f32 v105, v105, v220
    v_mul_f32 v106, v106, v220
    v_mul_f32 v107, v107, v220
    v_mul_f32 v108, v108, v220
    v_mul_f32 v109, v109, v220
    v_mul_f32 v110, v110, v220
    v_mul_f32 v111, v111, v220
    s_nop 1
    v_mfma_f32_32x32x16_bf16 v[96:111], a[80:83], v[208:211], v[96:111]
    ds_read_b128 v[176:179], v31 offset:0
    v_mul_f32 v112, v112, v220
    v_mul_f32 v113, v113, v220
    ds_read_b128 v[180:183], v31 offset:1024
    ds_write_b128 v26, v[240:243] offset:12288
    v_mul_f32 v114, v114, v220
    v_mul_f32 v115, v115, v220
    ds_read_b128 v[184:187], v31 offset:2048
    v_mul_f32 v116, v116, v220
    v_mfma_f32_32x32x16_bf16 v[96:111], a[84:87], v[212:215], v[96:111]
    v_mul_f32 v117, v117, v220
    ds_read_b128 v[188:191], v31 offset:3072
    v_mul_f32 v118, v118, v220
    ds_write_b128 v26, v[244:247] offset:13312
    buffer_load_dwordx4 a[252:255], v23, s[32:35], s58 offen nt
    s_add_u32 s58, s58, 16384
    v_mul_f32 v119, v119, v220
    v_mul_f32 v120, v120, v220
    v_mul_f32 v121, v121, v220
    v_mul_f32 v122, v122, v220
    v_mul_f32 v123, v123, v220
    v_mul_f32 v124, v124, v220
    v_mul_f32 v125, v125, v220
    v_mul_f32 v126, v126, v220
    v_mul_f32 v127, v127, v220
    s_nop 1
    v_mfma_f32_32x32x16_bf16 v[112:127], a[88:91], v[208:211], v[112:127]
    v_add_f32 v192, v192, v200
    v_add_f32 v193, v193, v201
    v_add_f32 v194, v194, v202
    v_add_f32 v195, v195, v203
    ds_write_b128 v26, v[248:251] offset:14336
    v_add_f32 v196, v196, v204
    v_add_f32 v197, v197, v205
    v_add_f32 v198, v198, v206
    v_add_f32 v199, v199, v207
    v_mfma_f32_32x32x16_bf16 v[112:127], a[92:95], v[212:215], v[112:127]
    v_add_f32 v192, v192, v196
    v_add_f32 v193, v193, v197
    v_add_f32 v194, v194, v198
    ds_write_b128 v26, v[252:255] offset:15360
    v_add_f32 v195, v195, v199
    v_add_f32 v192, v192, v193
    v_add_f32 v194, v194, v195
    v_add_f32 v192, v192, v194
    v_add_f32 v217, v217, v192
    ds_read_b128 a[32:35], v32 offset:24576
    ds_read_b128 a[36:39], v33 offset:24576
    ds_read_b128 a[40:43], v34 offset:24576
    ds_read_b128 a[44:47], v35 offset:24576
    ds_read_b128 a[48:51], v36 offset:24576
    ds_read_b128 a[52:55], v37 offset:24576
    ds_read_b128 a[56:59], v38 offset:24576
    ds_read_b128 a[60:63], v39 offset:24576
    s_waitcnt lgkmcnt(8)
    v_add_f32 v144, v144, v128
    v_add_f32 v145, v145, v129
    v_add_f32 v146, v146, v130
    v_add_f32 v147, v147, v131
    buffer_load_dwordx4 v[224:227], v20, s[32:35], s58 offen nt
    v_add_f32 v148, v148, v132
    v_add_f32 v149, v149, v133
    v_add_f32 v150, v150, v134
    v_add_f32 v151, v151, v135
    v_add_f32 v152, v152, v136
    v_add_f32 v153, v153, v137
    v_add_f32 v154, v154, v138
    v_add_f32 v155, v155, v139
    v_add_f32 v156, v156, v140
    v_add_f32 v157, v157, v141
    v_add_f32 v158, v158, v142
    v_add_f32 v159, v159, v143
    s_waitcnt lgkmcnt(0)
    v_mfma_f32_32x32x16_bf16 v[128:143], a[32:35], a[0:3], 0
    ds_read_b64_tr_b16 a[64:65], v40 offset:16384
    ds_read_b64_tr_b16 a[66:67], v41 offset:18432
    v_add_f32 v160, v160, v176
    v_add_f32 v161, v161, v177
    v_add_f32 v162, v162, v178
    v_add_f32 v163, v163, v179
    v_add_f32 v164, v164, v180
    v_mfma_f32_32x32x16_bf16 v[128:143], a[36:39], a[4:7], v[128:143]
    ds_read_b64_tr_b16 a[72:73], v42 offset:16384
    ds_read_b64_tr_b16 a[74:75], v43 offset:18432
    v_add_f32 v165, v165, v181
    v_add_f32 v166, v166, v182
    v_add_f32 v167, v167, v183
    v_add_f32 v168, v168, v184
    v_add_f32 v169, v169, v185
    v_mfma_f32_32x32x16_bf16 v[128:143], a[40:43], a[8:11], v[128:143]
    ds_read_b64_tr_b16 a[80:81], v44 offset:16384
    ds_read_b64_tr_b16 a[82:83], v45 offset:18432
    v_add_f32 v170, v170, v186
    v_add_f32 v171, v171, v187
    v_add_f32 v172, v172, v188
    v_add_f32 v173, v173, v189
    v_add_f32 v174, v174, v190
    v_mfma_f32_32x32x16_bf16 v[128:143], a[44:47], a[12:15], v[128:143]
    ds_read_b64_tr_b16 a[88:89], v46 offset:16384
    ds_read_b64_tr_b16 a[90:91], v47 offset:18432
    v_add_f32 v175, v175, v191
    v_add_f32 v144, v144, v160
    v_add_f32 v145, v145, v161
    v_add_f32 v146, v146, v162
    v_add_f32 v147, v147, v163
    v_mfma_f32_32x32x16_bf16 v[128:143], a[48:51], a[16:19], v[128:143]
    ds_read_b64_tr_b16 a[68:69], v40 offset:20480
    ds_read_b64_tr_b16 a[70:71], v41 offset:22528
    v_add_f32 v148, v148, v164
    v_add_f32 v149, v149, v165
    v_add_f32 v150, v150, v166
    v_add_f32 v151, v151, v167
    v_add_f32 v152, v152, v168
    v_mfma_f32_32x32x16_bf16 v[128:143], a[52:55], a[20:23], v[128:143]
    ds_read_b64_tr_b16 a[76:77], v42 offset:20480
    ds_read_b64_tr_b16 a[78:79], v43 offset:22528
    v_add_f32 v153, v153, v169
    v_add_f32 v154, v154, v170
    v_add_f32 v155, v155, v171
    v_add_f32 v156, v156, v172
    v_add_f32 v157, v157, v173
    v_mfma_f32_32x32x16_bf16 v[128:143], a[56:59], a[24:27], v[128:143]
    ds_read_b64_tr_b16 a[84:85], v44 offset:20480
    ds_read_b64_tr_b16 a[86:87], v45 offset:22528
    v_add_f32 v158, v158, v174
    v_add_f32 v159, v159, v175
    v_max3_f32 v218, v144, v145, v146
    v_max3_f32 v219, v147, v148, v149
    v_max3_f32 v220, v150, v151, v152
    v_mfma_f32_32x32x16_bf16 v[128:143], a[60:63], a[28:31], v[128:143]
    ds_read_b64_tr_b16 a[92:93], v46 offset:20480
    ds_read_b64_tr_b16 a[94:95], v47 offset:22528
    v_max3_f32 v221, v153, v154, v155
    v_max3_f32 v218, v218, v156, v157
    v_max3_f32 v219, v219, v158, v159
    v_max3_f32 v218, v218, v219, v220
    v_max_f32 v218, v218, v221
    v_mov_b32 v219, v218
    s_nop 1
    v_permlane32_swap_b32 v218, v219
    v_max3_f32 v218, v218, v219, v216
    v_sub_f32 v220, v216, v218
    v_mov_b32 v216, v218
    v_exp_f32 v220, v220
    v_sub_f32 v192, v144, v218
    v_sub_f32 v193, v145, v218
    buffer_load_dwordx4 v[228:231], v21, s[32:35], s58 offen nt
    v_sub_f32 v194, v146, v218
    v_sub_f32 v195, v147, v218
    v_sub_f32 v196, v148, v218
    v_sub_f32 v197, v149, v218
    v_sub_f32 v198, v150, v218
    buffer_load_dwordx4 v[232:235], v22, s[32:35], s58 offen nt
    v_sub_f32 v199, v151, v218
    v_sub_f32 v200, v152, v218
    v_sub_f32 v201, v153, v218
    v_sub_f32 v202, v154, v218
    v_sub_f32 v203, v155, v218
    v_sub_f32 v204, v156, v218
    v_sub_f32 v205, v157, v218
    v_sub_f32 v206, v158, v218
    v_sub_f32 v207, v159, v218
    ds_write_b128 v28, v[128:131] offset:16384
    v_exp_f32 v192, v192
    v_exp_f32 v193, v193
    v_exp_f32 v194, v194
    v_exp_f32 v195, v195
    ds_write_b128 v28, v[132:135] offset:17408
    v_exp_f32 v196, v196
    v_exp_f32 v197, v197
    v_exp_f32 v198, v198
    v_exp_f32 v199, v199
    ds_write_b128 v28, v[136:139] offset:18432
    v_exp_f32 v200, v200
    v_exp_f32 v201, v201
    v_exp_f32 v202, v202
    v_exp_f32 v203, v203
    ds_write_b128 v28, v[140:143] offset:19456
    v_exp_f32 v204, v204
    v_exp_f32 v205, v205
    v_exp_f32 v206, v206
    v_exp_f32 v207, v207
    v_mul_f32 v217, v217, v220
    v_cvt_pk_bf16_f32 v208, v192, v193
    v_cvt_pk_bf16_f32 v209, v194, v195
    v_cvt_pk_bf16_f32 v210, v196, v197
    v_cvt_pk_bf16_f32 v211, v198, v199
    v_cvt_pk_bf16_f32 v212, v200, v201
    v_cvt_pk_bf16_f32 v213, v202, v203
    v_cvt_pk_bf16_f32 v214, v204, v205
    v_cvt_pk_bf16_f32 v215, v206, v207
    v_mul_f32 v64, v64, v220
    v_mul_f32 v65, v65, v220
    v_mul_f32 v66, v66, v220
    v_mul_f32 v67, v67, v220
    v_mul_f32 v68, v68, v220
    v_mul_f32 v69, v69, v220
    v_mul_f32 v70, v70, v220
    v_mul_f32 v71, v71, v220
    v_mul_f32 v72, v72, v220
    v_mul_f32 v73, v73, v220
    v_mul_f32 v74, v74, v220
    v_mul_f32 v75, v75, v220
    v_mul_f32 v76, v76, v220
    v_mul_f32 v77, v77, v220
    v_mul_f32 v78, v78, v220
    v_mul_f32 v79, v79, v220
    s_waitcnt lgkmcnt(0)
    s_barrier
    v_mfma_f32_32x32x16_bf16 v[64:79], a[64:67], v[208:211], v[64:79]
    ds_read_b128 v[144:147], v29 offset:16384
    v_mul_f32 v80, v80, v220
    v_mul_f32 v81, v81, v220
    ds_read_b128 v[148:151], v29 offset:17408
    buffer_load_dwordx4 v[236:239], v23, s[32:35], s58 offen nt
    s_add_u32 s58, s58, 16384
    v_mul_f32 v82, v82, v220
    v_mul_f32 v83, v83, v220
    ds_read_b128 v[152:155], v29 offset:18432
    v_mul_f32 v84, v84, v220
    v_mfma_f32_32x32x16_bf16 v[64:79], a[68:71], v[212:215], v[64:79]
    v_mul_f32 v85, v85, v220
    ds_read_b128 v[156:159], v29 offset:19456
    v_mul_f32 v86, v86, v220
    v_mul_f32 v87, v87, v220
    v_mul_f32 v88, v88, v220
    v_mul_f32 v89, v89, v220
    v_mul_f32 v90, v90, v220
    v_mul_f32 v91, v91, v220
    v_mul_f32 v92, v92, v220
    v_mul_f32 v93, v93, v220
    v_mul_f32 v94, v94, v220
    v_mul_f32 v95, v95, v220
    s_nop 1
    v_mfma_f32_32x32x16_bf16 v[80:95], a[72:75], v[208:211], v[80:95]
    ds_read_b128 v[160:163], v30 offset:16384
    v_mul_f32 v96, v96, v220
    v_mul_f32 v97, v97, v220
    ds_read_b128 v[164:167], v30 offset:17408
    buffer_load_dwordx4 v[240:243], v20, s[32:35], s58 offen nt
    v_mul_f32 v98, v98, v220
    v_mul_f32 v99, v99, v220
    ds_read_b128 v[168:171], v30 offset:18432
    v_mul_f32 v100, v100, v220
    v_mfma_f32_32x32x16_bf16 v[80:95], a[76:79], v[212:215], v[80:95]
    v_mul_f32 v101, v101, v220
    ds_read_b128 v[172:175], v30 offset:19456
    v_mul_f32 v102, v102, v220
    v_mul_f32 v103, v103, v220
    v_mul_f32 v104, v104, v220
    v_mul_f32 v105, v105, v220
    v_mul_f32 v106, v106, v220
    v_mul_f32 v107, v107, v220
    v_mul_f32 v108, v108, v220
    v_mul_f32 v109, v109, v220
    v_mul_f32 v110, v110, v220
    v_mul_f32 v111, v111, v220
    s_nop 1
    v_mfma_f32_32x32x16_bf16 v[96:111], a[80:83], v[208:211], v[96:111]
    ds_read_b128 v[176:179], v31 offset:16384
    v_mul_f32 v112, v112, v220
    v_mul_f32 v113, v113, v220
    ds_read_b128 v[180:183], v31 offset:17408
    v_mul_f32 v114, v114, v220
    v_mul_f32 v115, v115, v220
    ds_read_b128 v[184:187], v31 offset:18432
    v_mul_f32 v116, v116, v220
    v_mfma_f32_32x32x16_bf16 v[96:111], a[84:87], v[212:215], v[96:111]
    v_mul_f32 v117, v117, v220
    ds_read_b128 v[188:191], v31 offset:19456
    v_mul_f32 v118, v118, v220
    buffer_load_dwordx4 v[244:247], v21, s[32:35], s58 offen nt
    v_mul_f32 v119, v119, v220
    v_mul_f32 v120, v120, v220
    v_mul_f32 v121, v121, v220
    v_mul_f32 v122, v122, v220
    v_mul_f32 v123, v123, v220
    v_mul_f32 v124, v124, v220
    v_mul_f32 v125, v125, v220
    v_mul_f32 v126, v126, v220
    v_mul_f32 v127, v127, v220
    s_nop 1
    v_mfma_f32_32x32x16_bf16 v[112:127], a[88:91], v[208:211], v[112:127]
    v_add_f32 v192, v192, v200
    v_add_f32 v193, v193, v201
    v_add_f32 v194, v194, v202
    v_add_f32 v195, v195, v203
    v_add_f32 v196, v196, v204
    v_add_f32 v197, v197, v205
    v_add_f32 v198, v198, v206
    v_add_f32 v199, v199, v207
    v_mfma_f32_32x32x16_bf16 v[112:127], a[92:95], v[212:215], v[112:127]
    v_add_f32 v192, v192, v196
    v_add_f32 v193, v193, v197
    v_add_f32 v194, v194, v198
    v_add_f32 v195, v195, v199
    v_add_f32 v192, v192, v193
    v_add_f32 v194, v194, v195
    v_add_f32 v192, v192, v194
    v_add_f32 v217, v217, v192
    ds_read_b128 a[32:35], v32 offset:0
    ds_read_b128 a[36:39], v33 offset:0
    ds_read_b128 a[40:43], v34 offset:0
    ds_read_b128 a[44:47], v35 offset:0
    ds_read_b128 a[48:51], v36 offset:0
    ds_read_b128 a[52:55], v37 offset:0
    ds_read_b128 a[56:59], v38 offset:0
    ds_read_b128 a[60:63], v39 offset:0
    s_waitcnt lgkmcnt(8)
    v_add_f32 v144, v144, v128
    v_add_f32 v145, v145, v129
    v_add_f32 v146, v146, v130
    v_add_f32 v147, v147, v131
    buffer_load_dwordx4 v[248:251], v22, s[32:35], s58 offen nt
    v_add_f32 v148, v148, v132
    v_add_f32 v149, v149, v133
    v_add_f32 v150, v150, v134
    v_add_f32 v151, v151, v135
    v_add_f32 v152, v152, v136
    v_add_f32 v153, v153, v137
    v_add_f32 v154, v154, v138
    v_add_f32 v155, v155, v139
    v_add_f32 v156, v156, v140
    v_add_f32 v157, v157, v141
    v_add_f32 v158, v158, v142
    v_add_f32 v159, v159, v143
    s_waitcnt lgkmcnt(0)
    v_mfma_f32_32x32x16_bf16 v[128:143], a[32:35], a[0:3], 0
    ds_read_b64_tr_b16 a[64:65], v40 offset:24576
    ds_read_b64_tr_b16 a[66:67], v41 offset:26624
    v_add_f32 v160, v160, v176
    v_add_f32 v161, v161, v177
    v_add_f32 v162, v162, v178
    v_add_f32 v163, v163, v179
    v_add_f32 v164, v164, v180
    v_mfma_f32_32x32x16_bf16 v[128:143], a[36:39], a[4:7], v[128:143]
    ds_read_b64_tr_b16 a[72:73], v42 offset:24576
    ds_read_b64_tr_b16 a[74:75], v43 offset:26624
    v_add_f32 v165, v165, v181
    v_add_f32 v166, v166, v182
    v_add_f32 v167, v167, v183
    v_add_f32 v168, v168, v184
    v_add_f32 v169, v169, v185
    v_mfma_f32_32x32x16_bf16 v[128:143], a[40:43], a[8:11], v[128:143]
    ds_read_b64_tr_b16 a[80:81], v44 offset:24576
    ds_read_b64_tr_b16 a[82:83], v45 offset:26624
    v_add_f32 v170, v170, v186
    v_add_f32 v171, v171, v187
    v_add_f32 v172, v172, v188
    v_add_f32 v173, v173, v189
    v_add_f32 v174, v174, v190
    v_mfma_f32_32x32x16_bf16 v[128:143], a[44:47], a[12:15], v[128:143]
    ds_read_b64_tr_b16 a[88:89], v46 offset:24576
    ds_read_b64_tr_b16 a[90:91], v47 offset:26624
    v_add_f32 v175, v175, v191
    v_add_f32 v144, v144, v160
    v_add_f32 v145, v145, v161
    v_add_f32 v146, v146, v162
    v_add_f32 v147, v147, v163
    v_mfma_f32_32x32x16_bf16 v[128:143], a[48:51], a[16:19], v[128:143]
    ds_read_b64_tr_b16 a[68:69], v40 offset:28672
    ds_read_b64_tr_b16 a[70:71], v41 offset:30720
    v_add_f32 v148, v148, v164
    v_add_f32 v149, v149, v165
    v_add_f32 v150, v150, v166
    v_add_f32 v151, v151, v167
    v_add_f32 v152, v152, v168
    v_mfma_f32_32x32x16_bf16 v[128:143], a[52:55], a[20:23], v[128:143]
    ds_read_b64_tr_b16 a[76:77], v42 offset:28672
    ds_read_b64_tr_b16 a[78:79], v43 offset:30720
    v_add_f32 v153, v153, v169
    v_add_f32 v154, v154, v170
    v_add_f32 v155, v155, v171
    v_add_f32 v156, v156, v172
    v_add_f32 v157, v157, v173
    v_mfma_f32_32x32x16_bf16 v[128:143], a[56:59], a[24:27], v[128:143]
    ds_read_b64_tr_b16 a[84:85], v44 offset:28672
    ds_read_b64_tr_b16 a[86:87], v45 offset:30720
    v_add_f32 v158, v158, v174
    v_add_f32 v159, v159, v175
    v_max3_f32 v218, v144, v145, v146
    v_max3_f32 v219, v147, v148, v149
    v_max3_f32 v220, v150, v151, v152
    v_mfma_f32_32x32x16_bf16 v[128:143], a[60:63], a[28:31], v[128:143]
    ds_read_b64_tr_b16 a[92:93], v46 offset:28672
    ds_read_b64_tr_b16 a[94:95], v47 offset:30720
    v_max3_f32 v221, v153, v154, v155
    v_max3_f32 v218, v218, v156, v157
    v_max3_f32 v219, v219, v158, v159
    v_max3_f32 v218, v218, v219, v220
    v_max_f32 v218, v218, v221
    v_mov_b32 v219, v218
    s_nop 1
    v_permlane32_swap_b32 v218, v219
    v_max3_f32 v218, v218, v219, v216
    v_sub_f32 v220, v216, v218
    v_mov_b32 v216, v218
    v_exp_f32 v220, v220
    v_sub_f32 v192, v144, v218
    v_sub_f32 v193, v145, v218
    buffer_load_dwordx4 v[252:255], v23, s[32:35], s58 offen nt
    s_add_u32 s58, s58, 16384
    v_sub_f32 v194, v146, v218
    v_sub_f32 v195, v147, v218
    v_sub_f32 v196, v148, v218
    v_sub_f32 v197, v149, v218
    v_sub_f32 v198, v150, v218
    v_sub_f32 v199, v151, v218
    v_sub_f32 v200, v152, v218
    v_sub_f32 v201, v153, v218
    v_sub_f32 v202, v154, v218
    v_sub_f32 v203, v155, v218
    v_sub_f32 v204, v156, v218
    v_sub_f32 v205, v157, v218
    v_sub_f32 v206, v158, v218
    v_sub_f32 v207, v159, v218
    ds_write_b128 v28, v[128:131] offset:0
    v_exp_f32 v192, v192
    v_exp_f32 v193, v193
    v_exp_f32 v194, v194
    v_exp_f32 v195, v195
    ds_write_b128 v28, v[132:135] offset:1024
    v_exp_f32 v196, v196
    v_exp_f32 v197, v197
    v_exp_f32 v198, v198
    v_exp_f32 v199, v199
    ds_write_b128 v28, v[136:139] offset:2048
    v_exp_f32 v200, v200
    v_exp_f32 v201, v201
    v_exp_f32 v202, v202
    v_exp_f32 v203, v203
    ds_write_b128 v28, v[140:143] offset:3072
    v_exp_f32 v204, v204
    v_exp_f32 v205, v205
    v_exp_f32 v206, v206
    v_exp_f32 v207, v207
    v_mul_f32 v217, v217, v220
    v_cvt_pk_bf16_f32 v208, v192, v193
    v_cvt_pk_bf16_f32 v209, v194, v195
    v_cvt_pk_bf16_f32 v210, v196, v197
    v_cvt_pk_bf16_f32 v211, v198, v199
    v_cvt_pk_bf16_f32 v212, v200, v201
    v_cvt_pk_bf16_f32 v213, v202, v203
    v_cvt_pk_bf16_f32 v214, v204, v205
    v_cvt_pk_bf16_f32 v215, v206, v207
    v_mul_f32 v64, v64, v220
    v_mul_f32 v65, v65, v220
    v_mul_f32 v66, v66, v220
    v_mul_f32 v67, v67, v220
    v_mul_f32 v68, v68, v220
    v_mul_f32 v69, v69, v220
    v_mul_f32 v70, v70, v220
    v_mul_f32 v71, v71, v220
    v_mul_f32 v72, v72, v220
    v_mul_f32 v73, v73, v220
    v_mul_f32 v74, v74, v220
    v_mul_f32 v75, v75, v220
    v_mul_f32 v76, v76, v220
    v_mul_f32 v77, v77, v220
    v_mul_f32 v78, v78, v220
    v_mul_f32 v79, v79, v220
    s_waitcnt lgkmcnt(0)
    s_barrier
    v_mfma_f32_32x32x16_bf16 v[64:79], a[64:67], v[208:211], v[64:79]
    ds_read_b128 v[144:147], v29 offset:0
    v_mul_f32 v80, v80, v220
    v_mul_f32 v81, v81, v220
    ds_read_b128 v[148:151], v29 offset:1024
    v_mul_f32 v82, v82, v220
    v_mul_f32 v83, v83, v220
    ds_read_b128 v[152:155], v29 offset:2048
    v_mul_f32 v84, v84, v220
    v_mfma_f32_32x32x16_bf16 v[64:79], a[68:71], v[212:215], v[64:79]
    v_mul_f32 v85, v85, v220
    ds_read_b128 v[156:159], v29 offset:3072
    v_mul_f32 v86, v86, v220
    v_mul_f32 v87, v87, v220
    v_mul_f32 v88, v88, v220
    v_mul_f32 v89, v89, v220
    v_mul_f32 v90, v90, v220
    v_mul_f32 v91, v91, v220
    v_mul_f32 v92, v92, v220
    v_mul_f32 v93, v93, v220
    v_mul_f32 v94, v94, v220
    v_mul_f32 v95, v95, v220
    s_nop 1
    v_mfma_f32_32x32x16_bf16 v[80:95], a[72:75], v[208:211], v[80:95]
    ds_read_b128 v[160:163], v30 offset:0
    v_mul_f32 v96, v96, v220
    v_mul_f32 v97, v97, v220
    ds_read_b128 v[164:167], v30 offset:1024
    v_mul_f32 v98, v98, v220
    v_mul_f32 v99, v99, v220
    ds_read_b128 v[168:171], v30 offset:2048
    v_mul_f32 v100, v100, v220
    v_mfma_f32_32x32x16_bf16 v[80:95], a[76:79], v[212:215], v[80:95]
    v_mul_f32 v101, v101, v220
    ds_read_b128 v[172:175], v30 offset:3072
    v_mul_f32 v102, v102, v220
    v_mul_f32 v103, v103, v220
    v_mul_f32 v104, v104, v220
    v_mul_f32 v105, v105, v220
    v_mul_f32 v106, v106, v220
    v_mul_f32 v107, v107, v220
    v_mul_f32 v108, v108, v220
    v_mul_f32 v109, v109, v220
    v_mul_f32 v110, v110, v220
    v_mul_f32 v111, v111, v220
    s_nop 1
    v_mfma_f32_32x32x16_bf16 v[96:111], a[80:83], v[208:211], v[96:111]
    ds_read_b128 v[176:179], v31 offset:0
    v_mul_f32 v112, v112, v220
    v_mul_f32 v113, v113, v220
    ds_read_b128 v[180:183], v31 offset:1024
    v_mul_f32 v114, v114, v220
    v_mul_f32 v115, v115, v220
    ds_read_b128 v[184:187], v31 offset:2048
    v_mul_f32 v116, v116, v220
    v_mfma_f32_32x32x16_bf16 v[96:111], a[84:87], v[212:215], v[96:111]
    v_mul_f32 v117, v117, v220
    ds_read_b128 v[188:191], v31 offset:3072
    v_mul_f32 v118, v118, v220
    v_mul_f32 v119, v119, v220
    v_mul_f32 v120, v120, v220
    v_mul_f32 v121, v121, v220
    v_mul_f32 v122, v122, v220
    v_mul_f32 v123, v123, v220
    v_mul_f32 v124, v124, v220
    v_mul_f32 v125, v125, v220
    v_mul_f32 v126, v126, v220
    v_mul_f32 v127, v127, v220
    s_nop 1
    v_mfma_f32_32x32x16_bf16 v[112:127], a[88:91], v[208:211], v[112:127]
    v_add_f32 v192, v192, v200
    v_add_f32 v193, v193, v201
    v_add_f32 v194, v194, v202
    v_add_f32 v195, v195, v203
    v_add_f32 v196, v196, v204
    v_add_f32 v197, v197, v205
    v_add_f32 v198, v198, v206
    v_add_f32 v199, v199, v207
    v_mfma_f32_32x32x16_bf16 v[112:127], a[92:95], v[212:215], v[112:127]
    v_add_f32 v192, v192, v196
    v_add_f32 v193, v193, v197
    v_add_f32 v194, v194, v198
    v_add_f32 v195, v195, v199
    v_add_f32 v192, v192, v193
    v_add_f32 v194, v194, v195
    v_add_f32 v192, v192, v194
    v_add_f32 v217, v217, v192
    ds_read_b128 a[32:35], v32 offset:8192
    ds_read_b128 a[36:39], v33 offset:8192
    ds_read_b128 a[40:43], v34 offset:8192
    ds_read_b128 a[44:47], v35 offset:8192
    ds_read_b128 a[48:51], v36 offset:8192
    ds_read_b128 a[52:55], v37 offset:8192
    ds_read_b128 a[56:59], v38 offset:8192
    ds_read_b128 a[60:63], v39 offset:8192
    s_waitcnt lgkmcnt(8)
    v_add_f32 v144, v144, v128
    v_add_f32 v145, v145, v129
    v_add_f32 v146, v146, v130
    v_add_f32 v147, v147, v131
    v_add_f32 v148, v148, v132
    v_add_f32 v149, v149, v133
    v_add_f32 v150, v150, v134
    v_add_f32 v151, v151, v135
    v_add_f32 v152, v152, v136
    v_add_f32 v153, v153, v137
    v_add_f32 v154, v154, v138
    v_add_f32 v155, v155, v139
    v_add_f32 v156, v156, v140
    v_add_f32 v157, v157, v141
    v_add_f32 v158, v158, v142
    v_add_f32 v159, v159, v143
    s_waitcnt lgkmcnt(0)
    v_mfma_f32_32x32x16_bf16 v[128:143], a[32:35], a[0:3], 0
    ds_read_b64_tr_b16 a[64:65], v40 offset:0
    ds_read_b64_tr_b16 a[66:67], v41 offset:2048
    v_add_f32 v160, v160, v176
    v_add_f32 v161, v161, v177
    v_add_f32 v162, v162, v178
    v_add_f32 v163, v163, v179
    v_add_f32 v164, v164, v180
    v_mfma_f32_32x32x16_bf16 v[128:143], a[36:39], a[4:7], v[128:143]
    ds_read_b64_tr_b16 a[72:73], v42 offset:0
    ds_read_b64_tr_b16 a[74:75], v43 offset:2048
    v_add_f32 v165, v165, v181
    v_add_f32 v166, v166, v182
    v_add_f32 v167, v167, v183
    v_add_f32 v168, v168, v184
    v_add_f32 v169, v169, v185
    v_mfma_f32_32x32x16_bf16 v[128:143], a[40:43], a[8:11], v[128:143]
    ds_read_b64_tr_b16 a[80:81], v44 offset:0
    ds_read_b64_tr_b16 a[82:83], v45 offset:2048
    v_add_f32 v170, v170, v186
    v_add_f32 v171, v171, v187
    v_add_f32 v172, v172, v188
    v_add_f32 v173, v173, v189
    v_add_f32 v174, v174, v190
    v_mfma_f32_32x32x16_bf16 v[128:143], a[44:47], a[12:15], v[128:143]
    ds_read_b64_tr_b16 a[88:89], v46 offset:0
    ds_read_b64_tr_b16 a[90:91], v47 offset:2048
    v_add_f32 v175, v175, v191
    v_add_f32 v144, v144, v160
    v_add_f32 v145, v145, v161
    v_add_f32 v146, v146, v162
    v_add_f32 v147, v147, v163
    v_mfma_f32_32x32x16_bf16 v[128:143], a[48:51], a[16:19], v[128:143]
    ds_read_b64_tr_b16 a[68:69], v40 offset:4096
    ds_read_b64_tr_b16 a[70:71], v41 offset:6144
    v_add_f32 v148, v148, v164
    v_add_f32 v149, v149, v165
    v_add_f32 v150, v150, v166
    v_add_f32 v151, v151, v167
    v_add_f32 v152, v152, v168
    v_mfma_f32_32x32x16_bf16 v[128:143], a[52:55], a[20:23], v[128:143]
    ds_read_b64_tr_b16 a[76:77], v42 offset:4096
    ds_read_b64_tr_b16 a[78:79], v43 offset:6144
    v_add_f32 v153, v153, v169
    v_add_f32 v154, v154, v170
    v_add_f32 v155, v155, v171
    v_add_f32 v156, v156, v172
    v_add_f32 v157, v157, v173
    v_mfma_f32_32x32x16_bf16 v[128:143], a[56:59], a[24:27], v[128:143]
    ds_read_b64_tr_b16 a[84:85], v44 offset:4096
    ds_read_b64_tr_b16 a[86:87], v45 offset:6144
    v_add_f32 v158, v158, v174
    v_add_f32 v159, v159, v175
    v_max3_f32 v218, v144, v145, v146
    v_max3_f32 v219, v147, v148, v149
    v_max3_f32 v220, v150, v151, v152
    v_mfma_f32_32x32x16_bf16 v[128:143], a[60:63], a[28:31], v[128:143]
    ds_read_b64_tr_b16 a[92:93], v46 offset:4096
    ds_read_b64_tr_b16 a[94:95], v47 offset:6144
    v_max3_f32 v221, v153, v154, v155
    v_max3_f32 v218, v218, v156, v157
    v_max3_f32 v219, v219, v158, v159
    v_max3_f32 v218, v218, v219, v220
    v_max_f32 v218, v218, v221
    v_mov_b32 v219, v218
    s_nop 1
    v_permlane32_swap_b32 v218, v219
    v_max3_f32 v218, v218, v219, v216
    v_sub_f32 v220, v216, v218
    v_mov_b32 v216, v218
    v_exp_f32 v220, v220
    v_sub_f32 v192, v144, v218
    v_sub_f32 v193, v145, v218
    v_sub_f32 v194, v146, v218
    v_sub_f32 v195, v147, v218
    v_sub_f32 v196, v148, v218
    v_sub_f32 v197, v149, v218
    v_sub_f32 v198, v150, v218
    v_sub_f32 v199, v151, v218
    v_sub_f32 v200, v152, v218
    v_sub_f32 v201, v153, v218
    v_sub_f32 v202, v154, v218
    v_sub_f32 v203, v155, v218
    v_sub_f32 v204, v156, v218
    v_sub_f32 v205, v157, v218
    v_sub_f32 v206, v158, v218
    v_sub_f32 v207, v159, v218
    ds_write_b128 v28, v[128:131] offset:16384
    v_exp_f32 v192, v192
    v_exp_f32 v193, v193
    v_exp_f32 v194, v194
    v_exp_f32 v195, v195
    ds_write_b128 v28, v[132:135] offset:17408
    v_exp_f32 v196, v196
    v_exp_f32 v197, v197
    v_exp_f32 v198, v198
    v_exp_f32 v199, v199
    ds_write_b128 v28, v[136:139] offset:18432
    v_exp_f32 v200, v200
    v_exp_f32 v201, v201
    v_exp_f32 v202, v202
    v_exp_f32 v203, v203
    ds_write_b128 v28, v[140:143] offset:19456
    v_exp_f32 v204, v204
    v_exp_f32 v205, v205
    v_exp_f32 v206, v206
    v_exp_f32 v207, v207
    v_mul_f32 v217, v217, v220
    v_cvt_pk_bf16_f32 v208, v192, v193
    v_cvt_pk_bf16_f32 v209, v194, v195
    v_cvt_pk_bf16_f32 v210, v196, v197
    v_cvt_pk_bf16_f32 v211, v198, v199
    v_cvt_pk_bf16_f32 v212, v200, v201
    v_cvt_pk_bf16_f32 v213, v202, v203
    v_cvt_pk_bf16_f32 v214, v204, v205
    v_cvt_pk_bf16_f32 v215, v206, v207
    v_mul_f32 v64, v64, v220
    v_mul_f32 v65, v65, v220
    v_mul_f32 v66, v66, v220
    v_mul_f32 v67, v67, v220
    v_mul_f32 v68, v68, v220
    v_mul_f32 v69, v69, v220
    v_mul_f32 v70, v70, v220
    v_mul_f32 v71, v71, v220
    v_mul_f32 v72, v72, v220
    v_mul_f32 v73, v73, v220
    v_mul_f32 v74, v74, v220
    v_mul_f32 v75, v75, v220
    v_mul_f32 v76, v76, v220
    v_mul_f32 v77, v77, v220
    v_mul_f32 v78, v78, v220
    v_mul_f32 v79, v79, v220
    s_waitcnt lgkmcnt(0)
    s_barrier
    v_mfma_f32_32x32x16_bf16 v[64:79], a[64:67], v[208:211], v[64:79]
    ds_read_b128 v[144:147], v29 offset:16384
    v_mul_f32 v80, v80, v220
    v_mul_f32 v81, v81, v220
    ds_read_b128 v[148:151], v29 offset:17408
    s_waitcnt vmcnt(47)
    ds_write_b128 v26, a[96:99] offset:16384
    v_mul_f32 v82, v82, v220
    v_mul_f32 v83, v83, v220
    ds_read_b128 v[152:155], v29 offset:18432
    v_mul_f32 v84, v84, v220
    v_mfma_f32_32x32x16_bf16 v[64:79], a[68:71], v[212:215], v[64:79]
    v_mul_f32 v85, v85, v220
    ds_read_b128 v[156:159], v29 offset:19456
    v_mul_f32 v86, v86, v220
    s_waitcnt vmcnt(46)
    ds_write_b128 v26, a[100:103] offset:17408
    v_mul_f32 v87, v87, v220
    v_mul_f32 v88, v88, v220
    v_mul_f32 v89, v89, v220
    v_mul_f32 v90, v90, v220
    v_mul_f32 v91, v91, v220
    v_mul_f32 v92, v92, v220
    v_mul_f32 v93, v93, v220
    v_mul_f32 v94, v94, v220
    v_mul_f32 v95, v95, v220
    s_nop 1
    v_mfma_f32_32x32x16_bf16 v[80:95], a[72:75], v[208:211], v[80:95]
    ds_read_b128 v[160:163], v30 offset:16384
    v_mul_f32 v96, v96, v220
    v_mul_f32 v97, v97, v220
    ds_read_b128 v[164:167], v30 offset:17408
    s_waitcnt vmcnt(45)
    ds_write_b128 v26, a[104:107] offset:18432
    v_mul_f32 v98, v98, v220
    v_mul_f32 v99, v99, v220
    ds_read_b128 v[168:171], v30 offset:18432
    v_mul_f32 v100, v100, v220
    v_mfma_f32_32x32x16_bf16 v[80:95], a[76:79], v[212:215], v[80:95]
    v_mul_f32 v101, v101, v220
    ds_read_b128 v[172:175], v30 offset:19456
    v_mul_f32 v102, v102, v220
    s_waitcnt vmcnt(44)
    ds_write_b128 v26, a[108:111] offset:19456
    v_mul_f32 v103, v103, v220
    v_mul_f32 v104, v104, v220
    v_mul_f32 v105, v105, v220
    v_mul_f32 v106, v106, v220
    v_mul_f32 v107, v107, v220
    v_mul_f32 v108, v108, v220
    v_mul_f32 v109, v109, v220
    v_mul_f32 v110, v110, v220
    v_mul_f32 v111, v111, v220
    s_nop 1
    v_mfma_f32_32x32x16_bf16 v[96:111], a[80:83], v[208:211], v[96:111]
    ds_read_b128 v[176:179], v31 offset:16384
    v_mul_f32 v112, v112, v220
    v_mul_f32 v113, v113, v220
    ds_read_b128 v[180:183], v31 offset:17408
    s_waitcnt vmcnt(43)
    ds_write_b128 v26, a[112:115] offset:20480
    v_mul_f32 v114, v114, v220
    v_mul_f32 v115, v115, v220
    ds_read_b128 v[184:187], v31 offset:18432
    v_mul_f32 v116, v116, v220
    v_mfma_f32_32x32x16_bf16 v[96:111], a[84:87], v[212:215], v[96:111]
    v_mul_f32 v117, v117, v220
    ds_read_b128 v[188:191], v31 offset:19456
    v_mul_f32 v118, v118, v220
    s_waitcnt vmcnt(42)
    ds_write_b128 v26, a[116:119] offset:21504
    v_mul_f32 v119, v119, v220
    v_mul_f32 v120, v120, v220
    v_mul_f32 v121, v121, v220
    v_mul_f32 v122, v122, v220
    v_mul_f32 v123, v123, v220
    v_mul_f32 v124, v124, v220
    v_mul_f32 v125, v125, v220
    v_mul_f32 v126, v126, v220
    v_mul_f32 v127, v127, v220
    s_nop 1
    v_mfma_f32_32x32x16_bf16 v[112:127], a[88:91], v[208:211], v[112:127]
    v_add_f32 v192, v192, v200
    v_add_f32 v193, v193, v201
    v_add_f32 v194, v194, v202
    v_add_f32 v195, v195, v203
    s_waitcnt vmcnt(41)
    ds_write_b128 v26, a[120:123] offset:22528
    v_add_f32 v196, v196, v204
    v_add_f32 v197, v197, v205
    v_add_f32 v198, v198, v206
    v_add_f32 v199, v199, v207
    v_mfma_f32_32x32x16_bf16 v[112:127], a[92:95], v[212:215], v[112:127]
    v_add_f32 v192, v192, v196
    v_add_f32 v193, v193, v197
    v_add_f32 v194, v194, v198
    s_waitcnt vmcnt(40)
    ds_write_b128 v26, a[124:127] offset:23552
    v_add_f32 v195, v195, v199
    v_add_f32 v192, v192, v193
    v_add_f32 v194, v194, v195
    v_add_f32 v192, v192, v194
    v_add_f32 v217, v217, v192
    ds_read_b128 a[32:35], v32 offset:16384
    ds_read_b128 a[36:39], v33 offset:16384
    ds_read_b128 a[40:43], v34 offset:16384
    ds_read_b128 a[44:47], v35 offset:16384
    ds_read_b128 a[48:51], v36 offset:16384
    ds_read_b128 a[52:55], v37 offset:16384
    ds_read_b128 a[56:59], v38 offset:16384
    ds_read_b128 a[60:63], v39 offset:16384
    s_waitcnt lgkmcnt(8)
    v_add_f32 v144, v144, v128
    v_add_f32 v145, v145, v129
    v_add_f32 v146, v146, v130
    v_add_f32 v147, v147, v131
    v_add_f32 v148, v148, v132
    v_add_f32 v149, v149, v133
    v_add_f32 v150, v150, v134
    v_add_f32 v151, v151, v135
    v_add_f32 v152, v152, v136
    v_add_f32 v153, v153, v137
    v_add_f32 v154, v154, v138
    v_add_f32 v155, v155, v139
    v_add_f32 v156, v156, v140
    v_add_f32 v157, v157, v141
    v_add_f32 v158, v158, v142
    v_add_f32 v159, v159, v143
    s_waitcnt lgkmcnt(0)
    v_mfma_f32_32x32x16_bf16 v[128:143], a[32:35], a[0:3], 0
    ds_read_b64_tr_b16 a[64:65], v40 offset:8192
    ds_read_b64_tr_b16 a[66:67], v41 offset:10240
    v_add_f32 v160, v160, v176
    v_add_f32 v161, v161, v177
    v_add_f32 v162, v162, v178
    v_add_f32 v163, v163, v179
    v_add_f32 v164, v164, v180
    v_mfma_f32_32x32x16_bf16 v[128:143], a[36:39], a[4:7], v[128:143]
    ds_read_b64_tr_b16 a[72:73], v42 offset:8192
    ds_read_b64_tr_b16 a[74:75], v43 offset:10240
    v_add_f32 v165, v165, v181
    v_add_f32 v166, v166, v182
    v_add_f32 v167, v167, v183
    v_add_f32 v168, v168, v184
    v_add_f32 v169, v169, v185
    v_mfma_f32_32x32x16_bf16 v[128:143], a[40:43], a[8:11], v[128:143]
    ds_read_b64_tr_b16 a[80:81], v44 offset:8192
    ds_read_b64_tr_b16 a[82:83], v45 offset:10240
    v_add_f32 v170, v170, v186
    v_add_f32 v171, v171, v187
    v_add_f32 v172, v172, v188
    v_add_f32 v173, v173, v189
    v_add_f32 v174, v174, v190
    v_mfma_f32_32x32x16_bf16 v[128:143], a[44:47], a[12:15], v[128:143]
    ds_read_b64_tr_b16 a[88:89], v46 offset:8192
    ds_read_b64_tr_b16 a[90:91], v47 offset:10240
    v_add_f32 v175, v175, v191
    v_add_f32 v144, v144, v160
    v_add_f32 v145, v145, v161
    v_add_f32 v146, v146, v162
    v_add_f32 v147, v147, v163
    v_mfma_f32_32x32x16_bf16 v[128:143], a[48:51], a[16:19], v[128:143]
    ds_read_b64_tr_b16 a[68:69], v40 offset:12288
    ds_read_b64_tr_b16 a[70:71], v41 offset:14336
    v_add_f32 v148, v148, v164
    v_add_f32 v149, v149, v165
    v_add_f32 v150, v150, v166
    v_add_f32 v151, v151, v167
    v_add_f32 v152, v152, v168
    v_mfma_f32_32x32x16_bf16 v[128:143], a[52:55], a[20:23], v[128:143]
    ds_read_b64_tr_b16 a[76:77], v42 offset:12288
    ds_read_b64_tr_b16 a[78:79], v43 offset:14336
    v_add_f32 v153, v153, v169
    v_add_f32 v154, v154, v170
    v_add_f32 v155, v155, v171
    v_add_f32 v156, v156, v172
    v_add_f32 v157, v157, v173
    v_mfma_f32_32x32x16_bf16 v[128:143], a[56:59], a[24:27], v[128:143]
    ds_read_b64_tr_b16 a[84:85], v44 offset:12288
    ds_read_b64_tr_b16 a[86:87], v45 offset:14336
    v_add_f32 v158, v158, v174
    v_add_f32 v159, v159, v175
    v_max3_f32 v218, v144, v145, v146
    v_max3_f32 v219, v147, v148, v149
    v_max3_f32 v220, v150, v151, v152
    v_mfma_f32_32x32x16_bf16 v[128:143], a[60:63], a[28:31], v[128:143]
    ds_read_b64_tr_b16 a[92:93], v46 offset:12288
    ds_read_b64_tr_b16 a[94:95], v47 offset:14336
    v_max3_f32 v221, v153, v154, v155
    v_max3_f32 v218, v218, v156, v157
    v_max3_f32 v219, v219, v158, v159
    v_max3_f32 v218, v218, v219, v220
    v_max_f32 v218, v218, v221
    v_mov_b32 v219, v218
    s_nop 1
    v_permlane32_swap_b32 v218, v219
    v_max3_f32 v218, v218, v219, v216
    v_sub_f32 v220, v216, v218
    v_mov_b32 v216, v218
    v_exp_f32 v220, v220
    v_sub_f32 v192, v144, v218
    v_sub_f32 v193, v145, v218
    v_sub_f32 v194, v146, v218
    v_sub_f32 v195, v147, v218
    v_sub_f32 v196, v148, v218
    v_sub_f32 v197, v149, v218
    v_sub_f32 v198, v150, v218
    v_sub_f32 v199, v151, v218
    v_sub_f32 v200, v152, v218
    v_sub_f32 v201, v153, v218
    v_sub_f32 v202, v154, v218
    v_sub_f32 v203, v155, v218
    v_sub_f32 v204, v156, v218
    v_sub_f32 v205, v157, v218
    v_sub_f32 v206, v158, v218
    v_sub_f32 v207, v159, v218
    ds_write_b128 v28, v[128:131] offset:0
    v_exp_f32 v192, v192
    v_exp_f32 v193, v193
    v_exp_f32 v194, v194
    v_exp_f32 v195, v195
    ds_write_b128 v28, v[132:135] offset:1024
    v_exp_f32 v196, v196
    v_exp_f32 v197, v197
    v_exp_f32 v198, v198
    v_exp_f32 v199, v199
    ds_write_b128 v28, v[136:139] offset:2048
    v_exp_f32 v200, v200
    v_exp_f32 v201, v201
    v_exp_f32 v202, v202
    v_exp_f32 v203, v203
    ds_write_b128 v28, v[140:143] offset:3072
    v_exp_f32 v204, v204
    v_exp_f32 v205, v205
    v_exp_f32 v206, v206
    v_exp_f32 v207, v207
    v_mul_f32 v217, v217, v220
    v_cvt_pk_bf16_f32 v208, v192, v193
    v_cvt_pk_bf16_f32 v209, v194, v195
    v_cvt_pk_bf16_f32 v210, v196, v197
    v_cvt_pk_bf16_f32 v211, v198, v199
    v_cvt_pk_bf16_f32 v212, v200, v201
    v_cvt_pk_bf16_f32 v213, v202, v203
    v_cvt_pk_bf16_f32 v214, v204, v205
    v_cvt_pk_bf16_f32 v215, v206, v207
    v_mul_f32 v64, v64, v220
    v_mul_f32 v65, v65, v220
    v_mul_f32 v66, v66, v220
    v_mul_f32 v67, v67, v220
    v_mul_f32 v68, v68, v220
    v_mul_f32 v69, v69, v220
    v_mul_f32 v70, v70, v220
    v_mul_f32 v71, v71, v220
    v_mul_f32 v72, v72, v220
    v_mul_f32 v73, v73, v220
    v_mul_f32 v74, v74, v220
    v_mul_f32 v75, v75, v220
    v_mul_f32 v76, v76, v220
    v_mul_f32 v77, v77, v220
    v_mul_f32 v78, v78, v220
    v_mul_f32 v79, v79, v220
    s_waitcnt lgkmcnt(0)
    s_barrier
    v_mfma_f32_32x32x16_bf16 v[64:79], a[64:67], v[208:211], v[64:79]
    ds_read_b128 v[144:147], v29 offset:0
    v_mul_f32 v80, v80, v220
    v_mul_f32 v81, v81, v220
    ds_read_b128 v[148:151], v29 offset:1024
    s_waitcnt vmcnt(39)
    ds_write_b128 v26, a[128:131] offset:24576
    v_mul_f32 v82, v82, v220
    v_mul_f32 v83, v83, v220
    ds_read_b128 v[152:155], v29 offset:2048
    v_mul_f32 v84, v84, v220
    v_mfma_f32_32x32x16_bf16 v[64:79], a[68:71], v[212:215], v[64:79]
    v_mul_f32 v85, v85, v220
    ds_read_b128 v[156:159], v29 offset:3072
    v_mul_f32 v86, v86, v220
    s_waitcnt vmcnt(38)
    ds_write_b128 v26, a[132:135] offset:25600
    v_mul_f32 v87, v87, v220
    v_mul_f32 v88, v88, v220
    v_mul_f32 v89, v89, v220
    v_mul_f32 v90, v90, v220
    v_mul_f32 v91, v91, v220
    v_mul_f32 v92, v92, v220
    v_mul_f32 v93, v93, v220
    v_mul_f32 v94, v94, v220
    v_mul_f32 v95, v95, v220
    s_nop 1
    v_mfma_f32_32x32x16_bf16 v[80:95], a[72:75], v[208:211], v[80:95]
    ds_read_b128 v[160:163], v30 offset:0
    v_mul_f32 v96, v96, v220
    v_mul_f32 v97, v97, v220
    ds_read_b128 v[164:167], v30 offset:1024
    s_waitcnt vmcnt(37)
    ds_write_b128 v26, a[136:139] offset:26624
    v_mul_f32 v98, v98, v220
    v_mul_f32 v99, v99, v220
    ds_read_b128 v[168:171], v30 offset:2048
    v_mul_f32 v100, v100, v220
    v_mfma_f32_32x32x16_bf16 v[80:95], a[76:79], v[212:215], v[80:95]
    v_mul_f32 v101, v101, v220
    ds_read_b128 v[172:175], v30 offset:3072
    v_mul_f32 v102, v102, v220
    s_waitcnt vmcnt(36)
    ds_write_b128 v26, a[140:143] offset:27648
    v_mul_f32 v103, v103, v220
    v_mul_f32 v104, v104, v220
    v_mul_f32 v105, v105, v220
    v_mul_f32 v106, v106, v220
    v_mul_f32 v107, v107, v220
    v_mul_f32 v108, v108, v220
    v_mul_f32 v109, v109, v220
    v_mul_f32 v110, v110, v220
    v_mul_f32 v111, v111, v220
    s_nop 1
    v_mfma_f32_32x32x16_bf16 v[96:111], a[80:83], v[208:211], v[96:111]
    ds_read_b128 v[176:179], v31 offset:0
    v_mul_f32 v112, v112, v220
    v_mul_f32 v113, v113, v220
    ds_read_b128 v[180:183], v31 offset:1024
    s_waitcnt vmcnt(35)
    ds_write_b128 v26, a[144:147] offset:28672
    v_mul_f32 v114, v114, v220
    v_mul_f32 v115, v115, v220
    ds_read_b128 v[184:187], v31 offset:2048
    v_mul_f32 v116, v116, v220
    v_mfma_f32_32x32x16_bf16 v[96:111], a[84:87], v[212:215], v[96:111]
    v_mul_f32 v117, v117, v220
    ds_read_b128 v[188:191], v31 offset:3072
    v_mul_f32 v118, v118, v220
    s_waitcnt vmcnt(34)
    ds_write_b128 v26, a[148:151] offset:29696
    v_mul_f32 v119, v119, v220
    v_mul_f32 v120, v120, v220
    v_mul_f32 v121, v121, v220
    v_mul_f32 v122, v122, v220
    v_mul_f32 v123, v123, v220
    v_mul_f32 v124, v124, v220
    v_mul_f32 v125, v125, v220
    v_mul_f32 v126, v126, v220
    v_mul_f32 v127, v127, v220
    s_nop 1
    v_mfma_f32_32x32x16_bf16 v[112:127], a[88:91], v[208:211], v[112:127]
    v_add_f32 v192, v192, v200
    v_add_f32 v193, v193, v201
    v_add_f32 v194, v194, v202
    v_add_f32 v195, v195, v203
    s_waitcnt vmcnt(33)
    ds_write_b128 v26, a[152:155] offset:30720
    v_add_f32 v196, v196, v204
    v_add_f32 v197, v197, v205
    v_add_f32 v198, v198, v206
    v_add_f32 v199, v199, v207
    v_mfma_f32_32x32x16_bf16 v[112:127], a[92:95], v[212:215], v[112:127]
    v_add_f32 v192, v192, v196
    v_add_f32 v193, v193, v197
    v_add_f32 v194, v194, v198
    s_waitcnt vmcnt(32)
    ds_write_b128 v26, a[156:159] offset:31744
    v_add_f32 v195, v195, v199
    v_add_f32 v192, v192, v193
    v_add_f32 v194, v194, v195
    v_add_f32 v192, v192, v194
    v_add_f32 v217, v217, v192
    ds_read_b128 a[32:35], v32 offset:24576
    ds_read_b128 a[36:39], v33 offset:24576
    ds_read_b128 a[40:43], v34 offset:24576
    ds_read_b128 a[44:47], v35 offset:24576
    ds_read_b128 a[48:51], v36 offset:24576
    ds_read_b128 a[52:55], v37 offset:24576
    ds_read_b128 a[56:59], v38 offset:24576
    ds_read_b128 a[60:63], v39 offset:24576
    s_waitcnt lgkmcnt(8)
    v_add_f32 v144, v144, v128
    v_add_f32 v145, v145, v129
    v_add_f32 v146, v146, v130
    v_add_f32 v147, v147, v131
    v_add_f32 v148, v148, v132
    v_add_f32 v149, v149, v133
    v_add_f32 v150, v150, v134
    v_add_f32 v151, v151, v135
    v_add_f32 v152, v152, v136
    v_add_f32 v153, v153, v137
    v_add_f32 v154, v154, v138
    v_add_f32 v155, v155, v139
    v_add_f32 v156, v156, v140
    v_add_f32 v157, v157, v141
    v_add_f32 v158, v158, v142
    v_add_f32 v159, v159, v143
    s_waitcnt lgkmcnt(0)
    v_mfma_f32_32x32x16_bf16 v[128:143], a[32:35], a[0:3], 0
    ds_read_b64_tr_b16 a[64:65], v40 offset:16384
    ds_read_b64_tr_b16 a[66:67], v41 offset:18432
    v_add_f32 v160, v160, v176
    v_add_f32 v161, v161, v177
    v_add_f32 v162, v162, v178
    v_add_f32 v163, v163, v179
    v_add_f32 v164, v164, v180
    v_mfma_f32_32x32x16_bf16 v[128:143], a[36:39], a[4:7], v[128:143]
    ds_read_b64_tr_b16 a[72:73], v42 offset:16384
    ds_read_b64_tr_b16 a[74:75], v43 offset:18432
    v_add_f32 v165, v165, v181
    v_add_f32 v166, v166, v182
    v_add_f32 v167, v167, v183
    v_add_f32 v168, v168, v184
    v_add_f32 v169, v169, v185
    v_mfma_f32_32x32x16_bf16 v[128:143], a[40:43], a[8:11], v[128:143]
    ds_read_b64_tr_b16 a[80:81], v44 offset:16384
    ds_read_b64_tr_b16 a[82:83], v45 offset:18432
    v_add_f32 v170, v170, v186
    v_add_f32 v171, v171, v187
    v_add_f32 v172, v172, v188
    v_add_f32 v173, v173, v189
    v_add_f32 v174, v174, v190
    v_mfma_f32_32x32x16_bf16 v[128:143], a[44:47], a[12:15], v[128:143]
    ds_read_b64_tr_b16 a[88:89], v46 offset:16384
    ds_read_b64_tr_b16 a[90:91], v47 offset:18432
    v_add_f32 v175, v175, v191
    v_add_f32 v144, v144, v160
    v_add_f32 v145, v145, v161
    v_add_f32 v146, v146, v162
    v_add_f32 v147, v147, v163
    v_mfma_f32_32x32x16_bf16 v[128:143], a[48:51], a[16:19], v[128:143]
    ds_read_b64_tr_b16 a[68:69], v40 offset:20480
    ds_read_b64_tr_b16 a[70:71], v41 offset:22528
    v_add_f32 v148, v148, v164
    v_add_f32 v149, v149, v165
    v_add_f32 v150, v150, v166
    v_add_f32 v151, v151, v167
    v_add_f32 v152, v152, v168
    v_mfma_f32_32x32x16_bf16 v[128:143], a[52:55], a[20:23], v[128:143]
    ds_read_b64_tr_b16 a[76:77], v42 offset:20480
    ds_read_b64_tr_b16 a[78:79], v43 offset:22528
    v_add_f32 v153, v153, v169
    v_add_f32 v154, v154, v170
    v_add_f32 v155, v155, v171
    v_add_f32 v156, v156, v172
    v_add_f32 v157, v157, v173
    v_mfma_f32_32x32x16_bf16 v[128:143], a[56:59], a[24:27], v[128:143]
    ds_read_b64_tr_b16 a[84:85], v44 offset:20480
    ds_read_b64_tr_b16 a[86:87], v45 offset:22528
    v_add_f32 v158, v158, v174
    v_add_f32 v159, v159, v175
    v_max3_f32 v218, v144, v145, v146
    v_max3_f32 v219, v147, v148, v149
    v_max3_f32 v220, v150, v151, v152
    v_mfma_f32_32x32x16_bf16 v[128:143], a[60:63], a[28:31], v[128:143]
    ds_read_b64_tr_b16 a[92:93], v46 offset:20480
    ds_read_b64_tr_b16 a[94:95], v47 offset:22528
    v_max3_f32 v221, v153, v154, v155
    v_max3_f32 v218, v218, v156, v157
    v_max3_f32 v219, v219, v158, v159
    v_max3_f32 v218, v218, v219, v220
    v_max_f32 v218, v218, v221
    v_mov_b32 v219, v218
    s_nop 1
    v_permlane32_swap_b32 v218, v219
    v_max3_f32 v218, v218, v219, v216
    v_sub_f32 v220, v216, v218
    v_mov_b32 v216, v218
    v_exp_f32 v220, v220
    v_sub_f32 v192, v144, v218
    v_sub_f32 v193, v145, v218
    v_sub_f32 v194, v146, v218
    v_sub_f32 v195, v147, v218
    v_sub_f32 v196, v148, v218
    v_sub_f32 v197, v149, v218
    v_sub_f32 v198, v150, v218
    v_sub_f32 v199, v151, v218
    v_sub_f32 v200, v152, v218
    v_sub_f32 v201, v153, v218
    v_sub_f32 v202, v154, v218
    v_sub_f32 v203, v155, v218
    v_sub_f32 v204, v156, v218
    v_sub_f32 v205, v157, v218
    v_sub_f32 v206, v158, v218
    v_sub_f32 v207, v159, v218
    ds_write_b128 v28, v[128:131] offset:16384
    v_exp_f32 v192, v192
    v_exp_f32 v193, v193
    v_exp_f32 v194, v194
    v_exp_f32 v195, v195
    ds_write_b128 v28, v[132:135] offset:17408
    v_exp_f32 v196, v196
    v_exp_f32 v197, v197
    v_exp_f32 v198, v198
    v_exp_f32 v199, v199
    ds_write_b128 v28, v[136:139] offset:18432
    v_exp_f32 v200, v200
    v_exp_f32 v201, v201
    v_exp_f32 v202, v202
    v_exp_f32 v203, v203
    ds_write_b128 v28, v[140:143] offset:19456
    v_exp_f32 v204, v204
    v_exp_f32 v205, v205
    v_exp_f32 v206, v206
    v_exp_f32 v207, v207
    v_mul_f32 v217, v217, v220
    v_cvt_pk_bf16_f32 v208, v192, v193
    v_cvt_pk_bf16_f32 v209, v194, v195
    v_cvt_pk_bf16_f32 v210, v196, v197
    v_cvt_pk_bf16_f32 v211, v198, v199
    v_cvt_pk_bf16_f32 v212, v200, v201
    v_cvt_pk_bf16_f32 v213, v202, v203
    v_cvt_pk_bf16_f32 v214, v204, v205
    v_cvt_pk_bf16_f32 v215, v206, v207
    v_mul_f32 v64, v64, v220
    v_mul_f32 v65, v65, v220
    v_mul_f32 v66, v66, v220
    v_mul_f32 v67, v67, v220
    v_mul_f32 v68, v68, v220
    v_mul_f32 v69, v69, v220
    v_mul_f32 v70, v70, v220
    v_mul_f32 v71, v71, v220
    v_mul_f32 v72, v72, v220
    v_mul_f32 v73, v73, v220
    v_mul_f32 v74, v74, v220
    v_mul_f32 v75, v75, v220
    v_mul_f32 v76, v76, v220
    v_mul_f32 v77, v77, v220
    v_mul_f32 v78, v78, v220
    v_mul_f32 v79, v79, v220
    s_waitcnt lgkmcnt(0)
    s_barrier
    v_mfma_f32_32x32x16_bf16 v[64:79], a[64:67], v[208:211], v[64:79]
    ds_read_b128 v[144:147], v29 offset:16384
    v_mul_f32 v80, v80, v220
    v_mul_f32 v81, v81, v220
    ds_read_b128 v[148:151], v29 offset:17408
    s_waitcnt vmcnt(31)
    ds_write_b128 v26, a[160:163] offset:0
    v_mul_f32 v82, v82, v220
    v_mul_f32 v83, v83, v220
    ds_read_b128 v[152:155], v29 offset:18432
    v_mul_f32 v84, v84, v220
    v_mfma_f32_32x32x16_bf16 v[64:79], a[68:71], v[212:215], v[64:79]
    v_mul_f32 v85, v85, v220
    ds_read_b128 v[156:159], v29 offset:19456
    v_mul_f32 v86, v86, v220
    s_waitcnt vmcnt(30)
    ds_write_b128 v26, a[164:167] offset:1024
    v_mul_f32 v87, v87, v220
    v_mul_f32 v88, v88, v220
    v_mul_f32 v89, v89, v220
    v_mul_f32 v90, v90, v220
    v_mul_f32 v91, v91, v220
    v_mul_f32 v92, v92, v220
    v_mul_f32 v93, v93, v220
    v_mul_f32 v94, v94, v220
    v_mul_f32 v95, v95, v220
    s_nop 1
    v_mfma_f32_32x32x16_bf16 v[80:95], a[72:75], v[208:211], v[80:95]
    ds_read_b128 v[160:163], v30 offset:16384
    v_mul_f32 v96, v96, v220
    v_mul_f32 v97, v97, v220
    ds_read_b128 v[164:167], v30 offset:17408
    s_waitcnt vmcnt(29)
    ds_write_b128 v26, a[168:171] offset:2048
    v_mul_f32 v98, v98, v220
    v_mul_f32 v99, v99, v220
    ds_read_b128 v[168:171], v30 offset:18432
    v_mul_f32 v100, v100, v220
    v_mfma_f32_32x32x16_bf16 v[80:95], a[76:79], v[212:215], v[80:95]
    v_mul_f32 v101, v101, v220
    ds_read_b128 v[172:175], v30 offset:19456
    v_mul_f32 v102, v102, v220
    s_waitcnt vmcnt(28)
    ds_write_b128 v26, a[172:175] offset:3072
    v_mul_f32 v103, v103, v220
    v_mul_f32 v104, v104, v220
    v_mul_f32 v105, v105, v220
    v_mul_f32 v106, v106, v220
    v_mul_f32 v107, v107, v220
    v_mul_f32 v108, v108, v220
    v_mul_f32 v109, v109, v220
    v_mul_f32 v110, v110, v220
    v_mul_f32 v111, v111, v220
    s_nop 1
    v_mfma_f32_32x32x16_bf16 v[96:111], a[80:83], v[208:211], v[96:111]
    ds_read_b128 v[176:179], v31 offset:16384
    v_mul_f32 v112, v112, v220
    v_mul_f32 v113, v113, v220
    ds_read_b128 v[180:183], v31 offset:17408
    s_waitcnt vmcnt(27)
    ds_write_b128 v26, a[176:179] offset:4096
    v_mul_f32 v114, v114, v220
    v_mul_f32 v115, v115, v220
    ds_read_b128 v[184:187], v31 offset:18432
    v_mul_f32 v116, v116, v220
    v_mfma_f32_32x32x16_bf16 v[96:111], a[84:87], v[212:215], v[96:111]
    v_mul_f32 v117, v117, v220
    ds_read_b128 v[188:191], v31 offset:19456
    v_mul_f32 v118, v118, v220
    s_waitcnt vmcnt(26)
    ds_write_b128 v26, a[180:183] offset:5120
    v_mul_f32 v119, v119, v220
    v_mul_f32 v120, v120, v220
    v_mul_f32 v121, v121, v220
    v_mul_f32 v122, v122, v220
    v_mul_f32 v123, v123, v220
    v_mul_f32 v124, v124, v220
    v_mul_f32 v125, v125, v220
    v_mul_f32 v126, v126, v220
    v_mul_f32 v127, v127, v220
    s_nop 1
    v_mfma_f32_32x32x16_bf16 v[112:127], a[88:91], v[208:211], v[112:127]
    v_add_f32 v192, v192, v200
    v_add_f32 v193, v193, v201
    v_add_f32 v194, v194, v202
    v_add_f32 v195, v195, v203
    s_waitcnt vmcnt(25)
    ds_write_b128 v26, a[184:187] offset:6144
    v_add_f32 v196, v196, v204
    v_add_f32 v197, v197, v205
    v_add_f32 v198, v198, v206
    v_add_f32 v199, v199, v207
    v_mfma_f32_32x32x16_bf16 v[112:127], a[92:95], v[212:215], v[112:127]
    v_add_f32 v192, v192, v196
    v_add_f32 v193, v193, v197
    v_add_f32 v194, v194, v198
    s_waitcnt vmcnt(24)
    ds_write_b128 v26, a[188:191] offset:7168
    v_add_f32 v195, v195, v199
    v_add_f32 v192, v192, v193
    v_add_f32 v194, v194, v195
    v_add_f32 v192, v192, v194
    v_add_f32 v217, v217, v192
    ds_read_b128 a[32:35], v32 offset:0
    ds_read_b128 a[36:39], v33 offset:0
    ds_read_b128 a[40:43], v34 offset:0
    ds_read_b128 a[44:47], v35 offset:0
    ds_read_b128 a[48:51], v36 offset:0
    ds_read_b128 a[52:55], v37 offset:0
    ds_read_b128 a[56:59], v38 offset:0
    ds_read_b128 a[60:63], v39 offset:0
    s_waitcnt lgkmcnt(8)
    v_add_f32 v144, v144, v128
    v_add_f32 v145, v145, v129
    v_add_f32 v146, v146, v130
    v_add_f32 v147, v147, v131
    v_add_f32 v148, v148, v132
    v_add_f32 v149, v149, v133
    v_add_f32 v150, v150, v134
    v_add_f32 v151, v151, v135
    v_add_f32 v152, v152, v136
    v_add_f32 v153, v153, v137
    v_add_f32 v154, v154, v138
    v_add_f32 v155, v155, v139
    v_add_f32 v156, v156, v140
    v_add_f32 v157, v157, v141
    v_add_f32 v158, v158, v142
    v_add_f32 v159, v159, v143
    s_waitcnt lgkmcnt(0)
    v_mfma_f32_32x32x16_bf16 v[128:143], a[32:35], a[0:3], 0
    ds_read_b64_tr_b16 a[64:65], v40 offset:24576
    ds_read_b64_tr_b16 a[66:67], v41 offset:26624
    v_add_f32 v160, v160, v176
    v_add_f32 v161, v161, v177
    v_add_f32 v162, v162, v178
    v_add_f32 v163, v163, v179
    v_add_f32 v164, v164, v180
    v_mfma_f32_32x32x16_bf16 v[128:143], a[36:39], a[4:7], v[128:143]
    ds_read_b64_tr_b16 a[72:73], v42 offset:24576
    ds_read_b64_tr_b16 a[74:75], v43 offset:26624
    v_add_f32 v165, v165, v181
    v_add_f32 v166, v166, v182
    v_add_f32 v167, v167, v183
    v_add_f32 v168, v168, v184
    v_add_f32 v169, v169, v185
    v_mfma_f32_32x32x16_bf16 v[128:143], a[40:43], a[8:11], v[128:143]
    ds_read_b64_tr_b16 a[80:81], v44 offset:24576
    ds_read_b64_tr_b16 a[82:83], v45 offset:26624
    v_add_f32 v170, v170, v186
    v_add_f32 v171, v171, v187
    v_add_f32 v172, v172, v188
    v_add_f32 v173, v173, v189
    v_add_f32 v174, v174, v190
    v_mfma_f32_32x32x16_bf16 v[128:143], a[44:47], a[12:15], v[128:143]
    ds_read_b64_tr_b16 a[88:89], v46 offset:24576
    ds_read_b64_tr_b16 a[90:91], v47 offset:26624
    v_add_f32 v175, v175, v191
    v_add_f32 v144, v144, v160
    v_add_f32 v145, v145, v161
    v_add_f32 v146, v146, v162
    v_add_f32 v147, v147, v163
    v_mfma_f32_32x32x16_bf16 v[128:143], a[48:51], a[16:19], v[128:143]
    ds_read_b64_tr_b16 a[68:69], v40 offset:28672
    ds_read_b64_tr_b16 a[70:71], v41 offset:30720
    v_add_f32 v148, v148, v164
    v_add_f32 v149, v149, v165
    v_add_f32 v150, v150, v166
    v_add_f32 v151, v151, v167
    v_add_f32 v152, v152, v168
    v_mfma_f32_32x32x16_bf16 v[128:143], a[52:55], a[20:23], v[128:143]
    ds_read_b64_tr_b16 a[76:77], v42 offset:28672
    ds_read_b64_tr_b16 a[78:79], v43 offset:30720
    v_add_f32 v153, v153, v169
    v_add_f32 v154, v154, v170
    v_add_f32 v155, v155, v171
    v_add_f32 v156, v156, v172
    v_add_f32 v157, v157, v173
    v_mfma_f32_32x32x16_bf16 v[128:143], a[56:59], a[24:27], v[128:143]
    ds_read_b64_tr_b16 a[84:85], v44 offset:28672
    ds_read_b64_tr_b16 a[86:87], v45 offset:30720
    v_add_f32 v158, v158, v174
    v_add_f32 v159, v159, v175
    v_max3_f32 v218, v144, v145, v146
    v_max3_f32 v219, v147, v148, v149
    v_max3_f32 v220, v150, v151, v152
    v_mfma_f32_32x32x16_bf16 v[128:143], a[60:63], a[28:31], v[128:143]
    ds_read_b64_tr_b16 a[92:93], v46 offset:28672
    ds_read_b64_tr_b16 a[94:95], v47 offset:30720
    v_max3_f32 v221, v153, v154, v155
    v_max3_f32 v218, v218, v156, v157
    v_max3_f32 v219, v219, v158, v159
    v_max3_f32 v218, v218, v219, v220
    v_max_f32 v218, v218, v221
    v_mov_b32 v219, v218
    s_nop 1
    v_permlane32_swap_b32 v218, v219
    v_max3_f32 v218, v218, v219, v216
    v_sub_f32 v220, v216, v218
    v_mov_b32 v216, v218
    v_exp_f32 v220, v220
    v_sub_f32 v192, v144, v218
    v_sub_f32 v193, v145, v218
    v_sub_f32 v194, v146, v218
    v_sub_f32 v195, v147, v218
    v_sub_f32 v196, v148, v218
    v_sub_f32 v197, v149, v218
    v_sub_f32 v198, v150, v218
    v_sub_f32 v199, v151, v218
    v_sub_f32 v200, v152, v218
    v_sub_f32 v201, v153, v218
    v_sub_f32 v202, v154, v218
    v_sub_f32 v203, v155, v218
    v_sub_f32 v204, v156, v218
    v_sub_f32 v205, v157, v218
    v_sub_f32 v206, v158, v218
    v_sub_f32 v207, v159, v218
    ds_write_b128 v28, v[128:131] offset:0
    v_exp_f32 v192, v192
    v_exp_f32 v193, v193
    v_exp_f32 v194, v194
    v_exp_f32 v195, v195
    ds_write_b128 v28, v[132:135] offset:1024
    v_exp_f32 v196, v196
    v_exp_f32 v197, v197
    v_exp_f32 v198, v198
    v_exp_f32 v199, v199
    ds_write_b128 v28, v[136:139] offset:2048
    v_exp_f32 v200, v200
    v_exp_f32 v201, v201
    v_exp_f32 v202, v202
    v_exp_f32 v203, v203
    ds_write_b128 v28, v[140:143] offset:3072
    v_exp_f32 v204, v204
    v_exp_f32 v205, v205
    v_exp_f32 v206, v206
    v_exp_f32 v207, v207
    v_mul_f32 v217, v217, v220
    v_cvt_pk_bf16_f32 v208, v192, v193
    v_cvt_pk_bf16_f32 v209, v194, v195
    v_cvt_pk_bf16_f32 v210, v196, v197
    v_cvt_pk_bf16_f32 v211, v198, v199
    v_cvt_pk_bf16_f32 v212, v200, v201
    v_cvt_pk_bf16_f32 v213, v202, v203
    v_cvt_pk_bf16_f32 v214, v204, v205
    v_cvt_pk_bf16_f32 v215, v206, v207
    v_mul_f32 v64, v64, v220
    v_mul_f32 v65, v65, v220
    v_mul_f32 v66, v66, v220
    v_mul_f32 v67, v67, v220
    v_mul_f32 v68, v68, v220
    v_mul_f32 v69, v69, v220
    v_mul_f32 v70, v70, v220
    v_mul_f32 v71, v71, v220
    v_mul_f32 v72, v72, v220
    v_mul_f32 v73, v73, v220
    v_mul_f32 v74, v74, v220
    v_mul_f32 v75, v75, v220
    v_mul_f32 v76, v76, v220
    v_mul_f32 v77, v77, v220
    v_mul_f32 v78, v78, v220
    v_mul_f32 v79, v79, v220
    s_waitcnt lgkmcnt(0)
    s_barrier
    v_mfma_f32_32x32x16_bf16 v[64:79], a[64:67], v[208:211], v[64:79]
    ds_read_b128 v[144:147], v29 offset:0
    v_mul_f32 v80, v80, v220
    v_mul_f32 v81, v81, v220
    ds_read_b128 v[148:151], v29 offset:1024
    s_waitcnt vmcnt(23)
    ds_write_b128 v26, a[192:195] offset:8192
    v_mul_f32 v82, v82, v220
    v_mul_f32 v83, v83, v220
    ds_read_b128 v[152:155], v29 offset:2048
    v_mul_f32 v84, v84, v220
    v_mfma_f32_32x32x16_bf16 v[64:79], a[68:71], v[212:215], v[64:79]
    v_mul_f32 v85, v85, v220
    ds_read_b128 v[156:159], v29 offset:3072
    v_mul_f32 v86, v86, v220
    s_waitcnt vmcnt(22)
    ds_write_b128 v26, a[196:199] offset:9216
    v_mul_f32 v87, v87, v220
    v_mul_f32 v88, v88, v220
    v_mul_f32 v89, v89, v220
    v_mul_f32 v90, v90, v220
    v_mul_f32 v91, v91, v220
    v_mul_f32 v92, v92, v220
    v_mul_f32 v93, v93, v220
    v_mul_f32 v94, v94, v220
    v_mul_f32 v95, v95, v220
    s_nop 1
    v_mfma_f32_32x32x16_bf16 v[80:95], a[72:75], v[208:211], v[80:95]
    ds_read_b128 v[160:163], v30 offset:0
    v_mul_f32 v96, v96, v220
    v_mul_f32 v97, v97, v220
    ds_read_b128 v[164:167], v30 offset:1024
    s_waitcnt vmcnt(21)
    ds_write_b128 v26, a[200:203] offset:10240
    v_mul_f32 v98, v98, v220
    v_mul_f32 v99, v99, v220
    ds_read_b128 v[168:171], v30 offset:2048
    v_mul_f32 v100, v100, v220
    v_mfma_f32_32x32x16_bf16 v[80:95], a[76:79], v[212:215], v[80:95]
    v_mul_f32 v101, v101, v220
    ds_read_b128 v[172:175], v30 offset:3072
    v_mul_f32 v102, v102, v220
    s_waitcnt vmcnt(20)
    ds_write_b128 v26, a[204:207] offset:11264
    v_mul_f32 v103, v103, v220
    v_mul_f32 v104, v104, v220
    v_mul_f32 v105, v105, v220
    v_mul_f32 v106, v106, v220
    v_mul_f32 v107, v107, v220
    v_mul_f32 v108, v108, v220
    v_mul_f32 v109, v109, v220
    v_mul_f32 v110, v110, v220
    v_mul_f32 v111, v111, v220
    s_nop 1
    v_mfma_f32_32x32x16_bf16 v[96:111], a[80:83], v[208:211], v[96:111]
    ds_read_b128 v[176:179], v31 offset:0
    v_mul_f32 v112, v112, v220
    v_mul_f32 v113, v113, v220
    ds_read_b128 v[180:183], v31 offset:1024
    s_waitcnt vmcnt(19)
    ds_write_b128 v26, a[208:211] offset:12288
    v_mul_f32 v114, v114, v220
    v_mul_f32 v115, v115, v220
    ds_read_b128 v[184:187], v31 offset:2048
    v_mul_f32 v116, v116, v220
    v_mfma_f32_32x32x16_bf16 v[96:111], a[84:87], v[212:215], v[96:111]
    v_mul_f32 v117, v117, v220
    ds_read_b128 v[188:191], v31 offset:3072
    v_mul_f32 v118, v118, v220
    s_waitcnt vmcnt(18)
    ds_write_b128 v26, a[212:215] offset:13312
    v_mul_f32 v119, v119, v220
    v_mul_f32 v120, v120, v220
    v_mul_f32 v121, v121, v220
    v_mul_f32 v122, v122, v220
    v_mul_f32 v123, v123, v220
    v_mul_f32 v124, v124, v220
    v_mul_f32 v125, v125, v220
    v_mul_f32 v126, v126, v220
    v_mul_f32 v127, v127, v220
    s_nop 1
    v_mfma_f32_32x32x16_bf16 v[112:127], a[88:91], v[208:211], v[112:127]
    v_add_f32 v192, v192, v200
    v_add_f32 v193, v193, v201
    v_add_f32 v194, v194, v202
    v_add_f32 v195, v195, v203
    s_waitcnt vmcnt(17)
    ds_write_b128 v26, a[216:219] offset:14336
    v_add_f32 v196, v196, v204
    v_add_f32 v197, v197, v205
    v_add_f32 v198, v198, v206
    v_add_f32 v199, v199, v207
    v_mfma_f32_32x32x16_bf16 v[112:127], a[92:95], v[212:215], v[112:127]
    v_add_f32 v192, v192, v196
    v_add_f32 v193, v193, v197
    v_add_f32 v194, v194, v198
    s_waitcnt vmcnt(16)
    ds_write_b128 v26, a[220:223] offset:15360
    v_add_f32 v195, v195, v199
    v_add_f32 v192, v192, v193
    v_add_f32 v194, v194, v195
    v_add_f32 v192, v192, v194
    v_add_f32 v217, v217, v192
    ds_read_b128 a[32:35], v32 offset:8192
    ds_read_b128 a[36:39], v33 offset:8192
    ds_read_b128 a[40:43], v34 offset:8192
    ds_read_b128 a[44:47], v35 offset:8192
    ds_read_b128 a[48:51], v36 offset:8192
    ds_read_b128 a[52:55], v37 offset:8192
    ds_read_b128 a[56:59], v38 offset:8192
    ds_read_b128 a[60:63], v39 offset:8192
    s_waitcnt lgkmcnt(8)
    v_add_f32 v144, v144, v128
    v_add_f32 v145, v145, v129
    v_add_f32 v146, v146, v130
    v_add_f32 v147, v147, v131
    v_add_f32 v148, v148, v132
    v_add_f32 v149, v149, v133
    v_add_f32 v150, v150, v134
    v_add_f32 v151, v151, v135
    v_add_f32 v152, v152, v136
    v_add_f32 v153, v153, v137
    v_add_f32 v154, v154, v138
    v_add_f32 v155, v155, v139
    v_add_f32 v156, v156, v140
    v_add_f32 v157, v157, v141
    v_add_f32 v158, v158, v142
    v_add_f32 v159, v159, v143
    s_waitcnt lgkmcnt(0)
    v_mfma_f32_32x32x16_bf16 v[128:143], a[32:35], a[0:3], 0
    ds_read_b64_tr_b16 a[64:65], v40 offset:0
    ds_read_b64_tr_b16 a[66:67], v41 offset:2048
    v_add_f32 v160, v160, v176
    v_add_f32 v161, v161, v177
    v_add_f32 v162, v162, v178
    v_add_f32 v163, v163, v179
    v_add_f32 v164, v164, v180
    v_mfma_f32_32x32x16_bf16 v[128:143], a[36:39], a[4:7], v[128:143]
    ds_read_b64_tr_b16 a[72:73], v42 offset:0
    ds_read_b64_tr_b16 a[74:75], v43 offset:2048
    v_add_f32 v165, v165, v181
    v_add_f32 v166, v166, v182
    v_add_f32 v167, v167, v183
    v_add_f32 v168, v168, v184
    v_add_f32 v169, v169, v185
    v_mfma_f32_32x32x16_bf16 v[128:143], a[40:43], a[8:11], v[128:143]
    ds_read_b64_tr_b16 a[80:81], v44 offset:0
    ds_read_b64_tr_b16 a[82:83], v45 offset:2048
    v_add_f32 v170, v170, v186
    v_add_f32 v171, v171, v187
    v_add_f32 v172, v172, v188
    v_add_f32 v173, v173, v189
    v_add_f32 v174, v174, v190
    v_mfma_f32_32x32x16_bf16 v[128:143], a[44:47], a[12:15], v[128:143]
    ds_read_b64_tr_b16 a[88:89], v46 offset:0
    ds_read_b64_tr_b16 a[90:91], v47 offset:2048
    v_add_f32 v175, v175, v191
    v_add_f32 v144, v144, v160
    v_add_f32 v145, v145, v161
    v_add_f32 v146, v146, v162
    v_add_f32 v147, v147, v163
    v_mfma_f32_32x32x16_bf16 v[128:143], a[48:51], a[16:19], v[128:143]
    ds_read_b64_tr_b16 a[68:69], v40 offset:4096
    ds_read_b64_tr_b16 a[70:71], v41 offset:6144
    v_add_f32 v148, v148, v164
    v_add_f32 v149, v149, v165
    v_add_f32 v150, v150, v166
    v_add_f32 v151, v151, v167
    v_add_f32 v152, v152, v168
    v_mfma_f32_32x32x16_bf16 v[128:143], a[52:55], a[20:23], v[128:143]
    ds_read_b64_tr_b16 a[76:77], v42 offset:4096
    ds_read_b64_tr_b16 a[78:79], v43 offset:6144
    v_add_f32 v153, v153, v169
    v_add_f32 v154, v154, v170
    v_add_f32 v155, v155, v171
    v_add_f32 v156, v156, v172
    v_add_f32 v157, v157, v173
    v_mfma_f32_32x32x16_bf16 v[128:143], a[56:59], a[24:27], v[128:143]
    ds_read_b64_tr_b16 a[84:85], v44 offset:4096
    ds_read_b64_tr_b16 a[86:87], v45 offset:6144
    v_add_f32 v158, v158, v174
    v_add_f32 v159, v159, v175
    v_max3_f32 v218, v144, v145, v146
    v_max3_f32 v219, v147, v148, v149
    v_max3_f32 v220, v150, v151, v152
    v_mfma_f32_32x32x16_bf16 v[128:143], a[60:63], a[28:31], v[128:143]
    ds_read_b64_tr_b16 a[92:93], v46 offset:4096
    ds_read_b64_tr_b16 a[94:95], v47 offset:6144
    v_max3_f32 v221, v153, v154, v155
    v_max3_f32 v218, v218, v156, v157
    v_max3_f32 v219, v219, v158, v159
    v_max3_f32 v218, v218, v219, v220
    v_max_f32 v218, v218, v221
    v_mov_b32 v219, v218
    s_nop 1
    v_permlane32_swap_b32 v218, v219
    v_max3_f32 v218, v218, v219, v216
    v_sub_f32 v220, v216, v218
    v_mov_b32 v216, v218
    v_exp_f32 v220, v220
    v_sub_f32 v192, v144, v218
    v_sub_f32 v193, v145, v218
    v_sub_f32 v194, v146, v218
    v_sub_f32 v195, v147, v218
    v_sub_f32 v196, v148, v218
    v_sub_f32 v197, v149, v218
    v_sub_f32 v198, v150, v218
    v_sub_f32 v199, v151, v218
    v_sub_f32 v200, v152, v218
    v_sub_f32 v201, v153, v218
    v_sub_f32 v202, v154, v218
    v_sub_f32 v203, v155, v218
    v_sub_f32 v204, v156, v218
    v_sub_f32 v205, v157, v218
    v_sub_f32 v206, v158, v218
    v_sub_f32 v207, v159, v218
    ds_write_b128 v28, v[128:131] offset:16384
    v_exp_f32 v192, v192
    v_exp_f32 v193, v193
    v_exp_f32 v194, v194
    v_exp_f32 v195, v195
    ds_write_b128 v28, v[132:135] offset:17408
    v_exp_f32 v196, v196
    v_exp_f32 v197, v197
    v_exp_f32 v198, v198
    v_exp_f32 v199, v199
    ds_write_b128 v28, v[136:139] offset:18432
    v_exp_f32 v200, v200
    v_exp_f32 v201, v201
    v_exp_f32 v202, v202
    v_exp_f32 v203, v203
    ds_write_b128 v28, v[140:143] offset:19456
    v_exp_f32 v204, v204
    v_exp_f32 v205, v205
    v_exp_f32 v206, v206
    v_exp_f32 v207, v207
    v_mul_f32 v217, v217, v220
    v_cvt_pk_bf16_f32 v208, v192, v193
    v_cvt_pk_bf16_f32 v209, v194, v195
    v_cvt_pk_bf16_f32 v210, v196, v197
    v_cvt_pk_bf16_f32 v211, v198, v199
    v_cvt_pk_bf16_f32 v212, v200, v201
    v_cvt_pk_bf16_f32 v213, v202, v203
    v_cvt_pk_bf16_f32 v214, v204, v205
    v_cvt_pk_bf16_f32 v215, v206, v207
    v_mul_f32 v64, v64, v220
    v_mul_f32 v65, v65, v220
    v_mul_f32 v66, v66, v220
    v_mul_f32 v67, v67, v220
    v_mul_f32 v68, v68, v220
    v_mul_f32 v69, v69, v220
    v_mul_f32 v70, v70, v220
    v_mul_f32 v71, v71, v220
    v_mul_f32 v72, v72, v220
    v_mul_f32 v73, v73, v220
    v_mul_f32 v74, v74, v220
    v_mul_f32 v75, v75, v220
    v_mul_f32 v76, v76, v220
    v_mul_f32 v77, v77, v220
    v_mul_f32 v78, v78, v220
    v_mul_f32 v79, v79, v220
    s_waitcnt lgkmcnt(0)
    s_barrier
    v_mfma_f32_32x32x16_bf16 v[64:79], a[64:67], v[208:211], v[64:79]
    ds_read_b128 v[144:147], v29 offset:16384
    v_mul_f32 v80, v80, v220
    v_mul_f32 v81, v81, v220
    ds_read_b128 v[148:151], v29 offset:17408
    s_waitcnt vmcnt(15)
    ds_write_b128 v26, a[224:227] offset:16384
    v_mul_f32 v82, v82, v220
    v_mul_f32 v83, v83, v220
    ds_read_b128 v[152:155], v29 offset:18432
    v_mul_f32 v84, v84, v220
    v_mfma_f32_32x32x16_bf16 v[64:79], a[68:71], v[212:215], v[64:79]
    v_mul_f32 v85, v85, v220
    ds_read_b128 v[156:159], v29 offset:19456
    v_mul_f32 v86, v86, v220
    s_waitcnt vmcnt(14)
    ds_write_b128 v26, a[228:231] offset:17408
    v_mul_f32 v87, v87, v220
    v_mul_f32 v88, v88, v220
    v_mul_f32 v89, v89, v220
    v_mul_f32 v90, v90, v220
    v_mul_f32 v91, v91, v220
    v_mul_f32 v92, v92, v220
    v_mul_f32 v93, v93, v220
    v_mul_f32 v94, v94, v220
    v_mul_f32 v95, v95, v220
    s_nop 1
    v_mfma_f32_32x32x16_bf16 v[80:95], a[72:75], v[208:211], v[80:95]
    ds_read_b128 v[160:163], v30 offset:16384
    v_mul_f32 v96, v96, v220
    v_mul_f32 v97, v97, v220
    ds_read_b128 v[164:167], v30 offset:17408
    s_waitcnt vmcnt(13)
    ds_write_b128 v26, a[232:235] offset:18432
    v_mul_f32 v98, v98, v220
    v_mul_f32 v99, v99, v220
    ds_read_b128 v[168:171], v30 offset:18432
    v_mul_f32 v100, v100, v220
    v_mfma_f32_32x32x16_bf16 v[80:95], a[76:79], v[212:215], v[80:95]
    v_mul_f32 v101, v101, v220
    ds_read_b128 v[172:175], v30 offset:19456
    v_mul_f32 v102, v102, v220
    s_waitcnt vmcnt(12)
    ds_write_b128 v26, a[236:239] offset:19456
    v_mul_f32 v103, v103, v220
    v_mul_f32 v104, v104, v220
    v_mul_f32 v105, v105, v220
    v_mul_f32 v106, v106, v220
    v_mul_f32 v107, v107, v220
    v_mul_f32 v108, v108, v220
    v_mul_f32 v109, v109, v220
    v_mul_f32 v110, v110, v220
    v_mul_f32 v111, v111, v220
    s_nop 1
    v_mfma_f32_32x32x16_bf16 v[96:111], a[80:83], v[208:211], v[96:111]
    ds_read_b128 v[176:179], v31 offset:16384
    v_mul_f32 v112, v112, v220
    v_mul_f32 v113, v113, v220
    ds_read_b128 v[180:183], v31 offset:17408
    s_waitcnt vmcnt(11)
    ds_write_b128 v26, a[240:243] offset:20480
    v_mul_f32 v114, v114, v220
    v_mul_f32 v115, v115, v220
    ds_read_b128 v[184:187], v31 offset:18432
    v_mul_f32 v116, v116, v220
    v_mfma_f32_32x32x16_bf16 v[96:111], a[84:87], v[212:215], v[96:111]
    v_mul_f32 v117, v117, v220
    ds_read_b128 v[188:191], v31 offset:19456
    v_mul_f32 v118, v118, v220
    s_waitcnt vmcnt(10)
    ds_write_b128 v26, a[244:247] offset:21504
    v_mul_f32 v119, v119, v220
    v_mul_f32 v120, v120, v220
    v_mul_f32 v121, v121, v220
    v_mul_f32 v122, v122, v220
    v_mul_f32 v123, v123, v220
    v_mul_f32 v124, v124, v220
    v_mul_f32 v125, v125, v220
    v_mul_f32 v126, v126, v220
    v_mul_f32 v127, v127, v220
    s_nop 1
    v_mfma_f32_32x32x16_bf16 v[112:127], a[88:91], v[208:211], v[112:127]
    v_add_f32 v192, v192, v200
    v_add_f32 v193, v193, v201
    v_add_f32 v194, v194, v202
    v_add_f32 v195, v195, v203
    s_waitcnt vmcnt(9)
    ds_write_b128 v26, a[248:251] offset:22528
    v_add_f32 v196, v196, v204
    v_add_f32 v197, v197, v205
    v_add_f32 v198, v198, v206
    v_add_f32 v199, v199, v207
    v_mfma_f32_32x32x16_bf16 v[112:127], a[92:95], v[212:215], v[112:127]
    v_add_f32 v192, v192, v196
    v_add_f32 v193, v193, v197
    v_add_f32 v194, v194, v198
    s_waitcnt vmcnt(8)
    ds_write_b128 v26, a[252:255] offset:23552
    v_add_f32 v195, v195, v199
    v_add_f32 v192, v192, v193
    v_add_f32 v194, v194, v195
    v_add_f32 v192, v192, v194
    v_add_f32 v217, v217, v192
    ds_read_b128 a[32:35], v32 offset:16384
    ds_read_b128 a[36:39], v33 offset:16384
    ds_read_b128 a[40:43], v34 offset:16384
    ds_read_b128 a[44:47], v35 offset:16384
    ds_read_b128 a[48:51], v36 offset:16384
    ds_read_b128 a[52:55], v37 offset:16384
    ds_read_b128 a[56:59], v38 offset:16384
    ds_read_b128 a[60:63], v39 offset:16384
    s_waitcnt lgkmcnt(8)
    v_add_f32 v144, v144, v128
    v_add_f32 v145, v145, v129
    v_add_f32 v146, v146, v130
    v_add_f32 v147, v147, v131
    v_add_f32 v148, v148, v132
    v_add_f32 v149, v149, v133
    v_add_f32 v150, v150, v134
    v_add_f32 v151, v151, v135
    v_add_f32 v152, v152, v136
    v_add_f32 v153, v153, v137
    v_add_f32 v154, v154, v138
    v_add_f32 v155, v155, v139
    v_add_f32 v156, v156, v140
    v_add_f32 v157, v157, v141
    v_add_f32 v158, v158, v142
    v_add_f32 v159, v159, v143
    s_waitcnt lgkmcnt(0)
    v_mfma_f32_32x32x16_bf16 v[128:143], a[32:35], a[0:3], 0
    ds_read_b64_tr_b16 a[64:65], v40 offset:8192
    ds_read_b64_tr_b16 a[66:67], v41 offset:10240
    v_add_f32 v160, v160, v176
    v_add_f32 v161, v161, v177
    v_add_f32 v162, v162, v178
    v_add_f32 v163, v163, v179
    v_add_f32 v164, v164, v180
    v_mfma_f32_32x32x16_bf16 v[128:143], a[36:39], a[4:7], v[128:143]
    ds_read_b64_tr_b16 a[72:73], v42 offset:8192
    ds_read_b64_tr_b16 a[74:75], v43 offset:10240
    v_add_f32 v165, v165, v181
    v_add_f32 v166, v166, v182
    v_add_f32 v167, v167, v183
    v_add_f32 v168, v168, v184
    v_add_f32 v169, v169, v185
    v_mfma_f32_32x32x16_bf16 v[128:143], a[40:43], a[8:11], v[128:143]
    ds_read_b64_tr_b16 a[80:81], v44 offset:8192
    ds_read_b64_tr_b16 a[82:83], v45 offset:10240
    v_add_f32 v170, v170, v186
    v_add_f32 v171, v171, v187
    v_add_f32 v172, v172, v188
    v_add_f32 v173, v173, v189
    v_add_f32 v174, v174, v190
    v_mfma_f32_32x32x16_bf16 v[128:143], a[44:47], a[12:15], v[128:143]
    ds_read_b64_tr_b16 a[88:89], v46 offset:8192
    ds_read_b64_tr_b16 a[90:91], v47 offset:10240
    v_add_f32 v175, v175, v191
    v_add_f32 v144, v144, v160
    v_add_f32 v145, v145, v161
    v_add_f32 v146, v146, v162
    v_add_f32 v147, v147, v163
    v_mfma_f32_32x32x16_bf16 v[128:143], a[48:51], a[16:19], v[128:143]
    ds_read_b64_tr_b16 a[68:69], v40 offset:12288
    ds_read_b64_tr_b16 a[70:71], v41 offset:14336
    v_add_f32 v148, v148, v164
    v_add_f32 v149, v149, v165
    v_add_f32 v150, v150, v166
    v_add_f32 v151, v151, v167
    v_add_f32 v152, v152, v168
    v_mfma_f32_32x32x16_bf16 v[128:143], a[52:55], a[20:23], v[128:143]
    ds_read_b64_tr_b16 a[76:77], v42 offset:12288
    ds_read_b64_tr_b16 a[78:79], v43 offset:14336
    v_add_f32 v153, v153, v169
    v_add_f32 v154, v154, v170
    v_add_f32 v155, v155, v171
    v_add_f32 v156, v156, v172
    v_add_f32 v157, v157, v173
    v_mfma_f32_32x32x16_bf16 v[128:143], a[56:59], a[24:27], v[128:143]
    ds_read_b64_tr_b16 a[84:85], v44 offset:12288
    ds_read_b64_tr_b16 a[86:87], v45 offset:14336
    v_add_f32 v158, v158, v174
    v_add_f32 v159, v159, v175
    v_max3_f32 v218, v144, v145, v146
    v_max3_f32 v219, v147, v148, v149
    v_max3_f32 v220, v150, v151, v152
    v_mfma_f32_32x32x16_bf16 v[128:143], a[60:63], a[28:31], v[128:143]
    ds_read_b64_tr_b16 a[92:93], v46 offset:12288
    ds_read_b64_tr_b16 a[94:95], v47 offset:14336
    v_max3_f32 v221, v153, v154, v155
    v_max3_f32 v218, v218, v156, v157
    v_max3_f32 v219, v219, v158, v159
    v_max3_f32 v218, v218, v219, v220
    v_max_f32 v218, v218, v221
    v_mov_b32 v219, v218
    s_nop 1
    v_permlane32_swap_b32 v218, v219
    v_max3_f32 v218, v218, v219, v216
    v_sub_f32 v220, v216, v218
    v_mov_b32 v216, v218
    v_exp_f32 v220, v220
    v_sub_f32 v192, v144, v218
    v_sub_f32 v193, v145, v218
    v_sub_f32 v194, v146, v218
    v_sub_f32 v195, v147, v218
    v_sub_f32 v196, v148, v218
    v_sub_f32 v197, v149, v218
    v_sub_f32 v198, v150, v218
    v_sub_f32 v199, v151, v218
    v_sub_f32 v200, v152, v218
    v_sub_f32 v201, v153, v218
    v_sub_f32 v202, v154, v218
    v_sub_f32 v203, v155, v218
    v_sub_f32 v204, v156, v218
    v_sub_f32 v205, v157, v218
    v_sub_f32 v206, v158, v218
    v_sub_f32 v207, v159, v218
    ds_write_b128 v28, v[128:131] offset:0
    v_exp_f32 v192, v192
    v_exp_f32 v193, v193
    v_exp_f32 v194, v194
    v_exp_f32 v195, v195
    ds_write_b128 v28, v[132:135] offset:1024
    v_exp_f32 v196, v196
    v_exp_f32 v197, v197
    v_exp_f32 v198, v198
    v_exp_f32 v199, v199
    ds_write_b128 v28, v[136:139] offset:2048
    v_exp_f32 v200, v200
    v_exp_f32 v201, v201
    v_exp_f32 v202, v202
    v_exp_f32 v203, v203
    ds_write_b128 v28, v[140:143] offset:3072
    v_exp_f32 v204, v204
    v_exp_f32 v205, v205
    v_exp_f32 v206, v206
    v_exp_f32 v207, v207
    v_mul_f32 v217, v217, v220
    v_cvt_pk_bf16_f32 v208, v192, v193
    v_cvt_pk_bf16_f32 v209, v194, v195
    v_cvt_pk_bf16_f32 v210, v196, v197
    v_cvt_pk_bf16_f32 v211, v198, v199
    v_cvt_pk_bf16_f32 v212, v200, v201
    v_cvt_pk_bf16_f32 v213, v202, v203
    v_cvt_pk_bf16_f32 v214, v204, v205
    v_cvt_pk_bf16_f32 v215, v206, v207
    v_mul_f32 v64, v64, v220
    v_mul_f32 v65, v65, v220
    v_mul_f32 v66, v66, v220
    v_mul_f32 v67, v67, v220
    v_mul_f32 v68, v68, v220
    v_mul_f32 v69, v69, v220
    v_mul_f32 v70, v70, v220
    v_mul_f32 v71, v71, v220
    v_mul_f32 v72, v72, v220
    v_mul_f32 v73, v73, v220
    v_mul_f32 v74, v74, v220
    v_mul_f32 v75, v75, v220
    v_mul_f32 v76, v76, v220
    v_mul_f32 v77, v77, v220
    v_mul_f32 v78, v78, v220
    v_mul_f32 v79, v79, v220
    s_waitcnt lgkmcnt(0)
    s_barrier
    v_mfma_f32_32x32x16_bf16 v[64:79], a[64:67], v[208:211], v[64:79]
    ds_read_b128 v[144:147], v29 offset:0
    v_mul_f32 v80, v80, v220
    v_mul_f32 v81, v81, v220
    ds_read_b128 v[148:151], v29 offset:1024
    s_waitcnt vmcnt(7)
    ds_write_b128 v26, v[224:227] offset:24576
    v_mul_f32 v82, v82, v220
    v_mul_f32 v83, v83, v220
    ds_read_b128 v[152:155], v29 offset:2048
    v_mul_f32 v84, v84, v220
    v_mfma_f32_32x32x16_bf16 v[64:79], a[68:71], v[212:215], v[64:79]
    v_mul_f32 v85, v85, v220
    ds_read_b128 v[156:159], v29 offset:3072
    v_mul_f32 v86, v86, v220
    s_waitcnt vmcnt(6)
    ds_write_b128 v26, v[228:231] offset:25600
    v_mul_f32 v87, v87, v220
    v_mul_f32 v88, v88, v220
    v_mul_f32 v89, v89, v220
    v_mul_f32 v90, v90, v220
    v_mul_f32 v91, v91, v220
    v_mul_f32 v92, v92, v220
    v_mul_f32 v93, v93, v220
    v_mul_f32 v94, v94, v220
    v_mul_f32 v95, v95, v220
    s_nop 1
    v_mfma_f32_32x32x16_bf16 v[80:95], a[72:75], v[208:211], v[80:95]
    ds_read_b128 v[160:163], v30 offset:0
    v_mul_f32 v96, v96, v220
    v_mul_f32 v97, v97, v220
    ds_read_b128 v[164:167], v30 offset:1024
    s_waitcnt vmcnt(5)
    ds_write_b128 v26, v[232:235] offset:26624
    v_mul_f32 v98, v98, v220
    v_mul_f32 v99, v99, v220
    ds_read_b128 v[168:171], v30 offset:2048
    v_mul_f32 v100, v100, v220
    v_mfma_f32_32x32x16_bf16 v[80:95], a[76:79], v[212:215], v[80:95]
    v_mul_f32 v101, v101, v220
    ds_read_b128 v[172:175], v30 offset:3072
    v_mul_f32 v102, v102, v220
    s_waitcnt vmcnt(4)
    ds_write_b128 v26, v[236:239] offset:27648
    v_mul_f32 v103, v103, v220
    v_mul_f32 v104, v104, v220
    v_mul_f32 v105, v105, v220
    v_mul_f32 v106, v106, v220
    v_mul_f32 v107, v107, v220
    v_mul_f32 v108, v108, v220
    v_mul_f32 v109, v109, v220
    v_mul_f32 v110, v110, v220
    v_mul_f32 v111, v111, v220
    s_nop 1
    v_mfma_f32_32x32x16_bf16 v[96:111], a[80:83], v[208:211], v[96:111]
    ds_read_b128 v[176:179], v31 offset:0
    v_mul_f32 v112, v112, v220
    v_mul_f32 v113, v113, v220
    ds_read_b128 v[180:183], v31 offset:1024
    s_waitcnt vmcnt(3)
    ds_write_b128 v26, v[240:243] offset:28672
    v_mul_f32 v114, v114, v220
    v_mul_f32 v115, v115, v220
    ds_read_b128 v[184:187], v31 offset:2048
    v_mul_f32 v116, v116, v220
    v_mfma_f32_32x32x16_bf16 v[96:111], a[84:87], v[212:215], v[96:111]
    v_mul_f32 v117, v117, v220
    ds_read_b128 v[188:191], v31 offset:3072
    v_mul_f32 v118, v118, v220
    s_waitcnt vmcnt(2)
    ds_write_b128 v26, v[244:247] offset:29696
    v_mul_f32 v119, v119, v220
    v_mul_f32 v120, v120, v220
    v_mul_f32 v121, v121, v220
    v_mul_f32 v122, v122, v220
    v_mul_f32 v123, v123, v220
    v_mul_f32 v124, v124, v220
    v_mul_f32 v125, v125, v220
    v_mul_f32 v126, v126, v220
    v_mul_f32 v127, v127, v220
    s_nop 1
    v_mfma_f32_32x32x16_bf16 v[112:127], a[88:91], v[208:211], v[112:127]
    v_add_f32 v192, v192, v200
    v_add_f32 v193, v193, v201
    v_add_f32 v194, v194, v202
    v_add_f32 v195, v195, v203
    s_waitcnt vmcnt(1)
    ds_write_b128 v26, v[248:251] offset:30720
    v_add_f32 v196, v196, v204
    v_add_f32 v197, v197, v205
    v_add_f32 v198, v198, v206
    v_add_f32 v199, v199, v207
    v_mfma_f32_32x32x16_bf16 v[112:127], a[92:95], v[212:215], v[112:127]
    v_add_f32 v192, v192, v196
    v_add_f32 v193, v193, v197
    v_add_f32 v194, v194, v198
    s_waitcnt vmcnt(0)
    ds_write_b128 v26, v[252:255] offset:31744
    v_add_f32 v195, v195, v199
    v_add_f32 v192, v192, v193
    v_add_f32 v194, v194, v195
    v_add_f32 v192, v192, v194
    v_add_f32 v217, v217, v192
    ds_read_b128 a[32:35], v32 offset:24576
    ds_read_b128 a[36:39], v33 offset:24576
    ds_read_b128 a[40:43], v34 offset:24576
    ds_read_b128 a[44:47], v35 offset:24576
    ds_read_b128 a[48:51], v36 offset:24576
    ds_read_b128 a[52:55], v37 offset:24576
    ds_read_b128 a[56:59], v38 offset:24576
    ds_read_b128 a[60:63], v39 offset:24576
    s_waitcnt lgkmcnt(8)
    v_add_f32 v144, v144, v128
    v_add_f32 v145, v145, v129
    v_add_f32 v146, v146, v130
    v_add_f32 v147, v147, v131
    v_add_f32 v148, v148, v132
    v_add_f32 v149, v149, v133
    v_add_f32 v150, v150, v134
    v_add_f32 v151, v151, v135
    v_add_f32 v152, v152, v136
    v_add_f32 v153, v153, v137
    v_add_f32 v154, v154, v138
    v_add_f32 v155, v155, v139
    v_add_f32 v156, v156, v140
    v_add_f32 v157, v157, v141
    v_add_f32 v158, v158, v142
    v_add_f32 v159, v159, v143
    s_waitcnt lgkmcnt(0)
    v_mfma_f32_32x32x16_bf16 v[128:143], a[32:35], a[0:3], 0
    ds_read_b64_tr_b16 a[64:65], v40 offset:16384
    ds_read_b64_tr_b16 a[66:67], v41 offset:18432
    v_add_f32 v160, v160, v176
    v_add_f32 v161, v161, v177
    v_add_f32 v162, v162, v178
    v_add_f32 v163, v163, v179
    v_add_f32 v164, v164, v180
    v_mfma_f32_32x32x16_bf16 v[128:143], a[36:39], a[4:7], v[128:143]
    ds_read_b64_tr_b16 a[72:73], v42 offset:16384
    ds_read_b64_tr_b16 a[74:75], v43 offset:18432
    v_add_f32 v165, v165, v181
    v_add_f32 v166, v166, v182
    v_add_f32 v167, v167, v183
    v_add_f32 v168, v168, v184
    v_add_f32 v169, v169, v185
    v_mfma_f32_32x32x16_bf16 v[128:143], a[40:43], a[8:11], v[128:143]
    ds_read_b64_tr_b16 a[80:81], v44 offset:16384
    ds_read_b64_tr_b16 a[82:83], v45 offset:18432
    v_add_f32 v170, v170, v186
    v_add_f32 v171, v171, v187
    v_add_f32 v172, v172, v188
    v_add_f32 v173, v173, v189
    v_add_f32 v174, v174, v190
    v_mfma_f32_32x32x16_bf16 v[128:143], a[44:47], a[12:15], v[128:143]
    ds_read_b64_tr_b16 a[88:89], v46 offset:16384
    ds_read_b64_tr_b16 a[90:91], v47 offset:18432
    v_add_f32 v175, v175, v191
    v_add_f32 v144, v144, v160
    v_add_f32 v145, v145, v161
    v_add_f32 v146, v146, v162
    v_add_f32 v147, v147, v163
    v_mfma_f32_32x32x16_bf16 v[128:143], a[48:51], a[16:19], v[128:143]
    ds_read_b64_tr_b16 a[68:69], v40 offset:20480
    ds_read_b64_tr_b16 a[70:71], v41 offset:22528
    v_add_f32 v148, v148, v164
    v_add_f32 v149, v149, v165
    v_add_f32 v150, v150, v166
    v_add_f32 v151, v151, v167
    v_add_f32 v152, v152, v168
    v_mfma_f32_32x32x16_bf16 v[128:143], a[52:55], a[20:23], v[128:143]
    ds_read_b64_tr_b16 a[76:77], v42 offset:20480
    ds_read_b64_tr_b16 a[78:79], v43 offset:22528
    v_add_f32 v153, v153, v169
    v_add_f32 v154, v154, v170
    v_add_f32 v155, v155, v171
    v_add_f32 v156, v156, v172
    v_add_f32 v157, v157, v173
    v_mfma_f32_32x32x16_bf16 v[128:143], a[56:59], a[24:27], v[128:143]
    ds_read_b64_tr_b16 a[84:85], v44 offset:20480
    ds_read_b64_tr_b16 a[86:87], v45 offset:22528
    v_add_f32 v158, v158, v174
    v_add_f32 v159, v159, v175
    v_max3_f32 v218, v144, v145, v146
    v_max3_f32 v219, v147, v148, v149
    v_max3_f32 v220, v150, v151, v152
    v_mfma_f32_32x32x16_bf16 v[128:143], a[60:63], a[28:31], v[128:143]
    ds_read_b64_tr_b16 a[92:93], v46 offset:20480
    ds_read_b64_tr_b16 a[94:95], v47 offset:22528
    v_max3_f32 v221, v153, v154, v155
    v_max3_f32 v218, v218, v156, v157
    v_max3_f32 v219, v219, v158, v159
    v_max3_f32 v218, v218, v219, v220
    v_max_f32 v218, v218, v221
    v_mov_b32 v219, v218
    s_nop 1
    v_permlane32_swap_b32 v218, v219
    v_max3_f32 v218, v218, v219, v216
    v_sub_f32 v220, v216, v218
    v_mov_b32 v216, v218
    v_exp_f32 v220, v220
    v_sub_f32 v192, v144, v218
    v_sub_f32 v193, v145, v218
    v_sub_f32 v194, v146, v218
    v_sub_f32 v195, v147, v218
    v_sub_f32 v196, v148, v218
    v_sub_f32 v197, v149, v218
    v_sub_f32 v198, v150, v218
    v_sub_f32 v199, v151, v218
    v_sub_f32 v200, v152, v218
    v_sub_f32 v201, v153, v218
    v_sub_f32 v202, v154, v218
    v_sub_f32 v203, v155, v218
    v_sub_f32 v204, v156, v218
    v_sub_f32 v205, v157, v218
    v_sub_f32 v206, v158, v218
    v_sub_f32 v207, v159, v218
    ds_write_b128 v28, v[128:131] offset:16384
    v_exp_f32 v192, v192
    v_exp_f32 v193, v193
    v_exp_f32 v194, v194
    v_exp_f32 v195, v195
    ds_write_b128 v28, v[132:135] offset:17408
    v_exp_f32 v196, v196
    v_exp_f32 v197, v197
    v_exp_f32 v198, v198
    v_exp_f32 v199, v199
    ds_write_b128 v28, v[136:139] offset:18432
    v_exp_f32 v200, v200
    v_exp_f32 v201, v201
    v_exp_f32 v202, v202
    v_exp_f32 v203, v203
    ds_write_b128 v28, v[140:143] offset:19456
    v_exp_f32 v204, v204
    v_exp_f32 v205, v205
    v_exp_f32 v206, v206
    v_exp_f32 v207, v207
    v_mul_f32 v217, v217, v220
    v_cvt_pk_bf16_f32 v208, v192, v193
    v_cvt_pk_bf16_f32 v209, v194, v195
    v_cvt_pk_bf16_f32 v210, v196, v197
    v_cvt_pk_bf16_f32 v211, v198, v199
    v_cvt_pk_bf16_f32 v212, v200, v201
    v_cvt_pk_bf16_f32 v213, v202, v203
    v_cvt_pk_bf16_f32 v214, v204, v205
    v_cvt_pk_bf16_f32 v215, v206, v207
    v_mul_f32 v64, v64, v220
    v_mul_f32 v65, v65, v220
    v_mul_f32 v66, v66, v220
    v_mul_f32 v67, v67, v220
    v_mul_f32 v68, v68, v220
    v_mul_f32 v69, v69, v220
    v_mul_f32 v70, v70, v220
    v_mul_f32 v71, v71, v220
    v_mul_f32 v72, v72, v220
    v_mul_f32 v73, v73, v220
    v_mul_f32 v74, v74, v220
    v_mul_f32 v75, v75, v220
    v_mul_f32 v76, v76, v220
    v_mul_f32 v77, v77, v220
    v_mul_f32 v78, v78, v220
    v_mul_f32 v79, v79, v220
    s_waitcnt lgkmcnt(0)
    s_barrier
    v_mfma_f32_32x32x16_bf16 v[64:79], a[64:67], v[208:211], v[64:79]
    ds_read_b128 v[144:147], v29 offset:16384
    v_mul_f32 v80, v80, v220
    v_mul_f32 v81, v81, v220
    ds_read_b128 v[148:151], v29 offset:17408
    v_mul_f32 v82, v82, v220
    v_mul_f32 v83, v83, v220
    ds_read_b128 v[152:155], v29 offset:18432
    v_mul_f32 v84, v84, v220
    v_mfma_f32_32x32x16_bf16 v[64:79], a[68:71], v[212:215], v[64:79]
    v_mul_f32 v85, v85, v220
    ds_read_b128 v[156:159], v29 offset:19456
    v_mul_f32 v86, v86, v220
    v_mul_f32 v87, v87, v220
    v_mul_f32 v88, v88, v220
    v_mul_f32 v89, v89, v220
    v_mul_f32 v90, v90, v220
    v_mul_f32 v91, v91, v220
    v_mul_f32 v92, v92, v220
    v_mul_f32 v93, v93, v220
    v_mul_f32 v94, v94, v220
    v_mul_f32 v95, v95, v220
    s_nop 1
    v_mfma_f32_32x32x16_bf16 v[80:95], a[72:75], v[208:211], v[80:95]
    ds_read_b128 v[160:163], v30 offset:16384
    v_mul_f32 v96, v96, v220
    v_mul_f32 v97, v97, v220
    ds_read_b128 v[164:167], v30 offset:17408
    v_mul_f32 v98, v98, v220
    v_mul_f32 v99, v99, v220
    ds_read_b128 v[168:171], v30 offset:18432
    v_mul_f32 v100, v100, v220
    v_mfma_f32_32x32x16_bf16 v[80:95], a[76:79], v[212:215], v[80:95]
    v_mul_f32 v101, v101, v220
    ds_read_b128 v[172:175], v30 offset:19456
    v_mul_f32 v102, v102, v220
    v_mul_f32 v103, v103, v220
    v_mul_f32 v104, v104, v220
    v_mul_f32 v105, v105, v220
    v_mul_f32 v106, v106, v220
    v_mul_f32 v107, v107, v220
    v_mul_f32 v108, v108, v220
    v_mul_f32 v109, v109, v220
    v_mul_f32 v110, v110, v220
    v_mul_f32 v111, v111, v220
    s_nop 1
    v_mfma_f32_32x32x16_bf16 v[96:111], a[80:83], v[208:211], v[96:111]
    ds_read_b128 v[176:179], v31 offset:16384
    v_mul_f32 v112, v112, v220
    v_mul_f32 v113, v113, v220
    ds_read_b128 v[180:183], v31 offset:17408
    v_mul_f32 v114, v114, v220
    v_mul_f32 v115, v115, v220
    ds_read_b128 v[184:187], v31 offset:18432
    v_mul_f32 v116, v116, v220
    v_mfma_f32_32x32x16_bf16 v[96:111], a[84:87], v[212:215], v[96:111]
    v_mul_f32 v117, v117, v220
    ds_read_b128 v[188:191], v31 offset:19456
    v_mul_f32 v118, v118, v220
    v_mul_f32 v119, v119, v220
    v_mul_f32 v120, v120, v220
    v_mul_f32 v121, v121, v220
    v_mul_f32 v122, v122, v220
    v_mul_f32 v123, v123, v220
    v_mul_f32 v124, v124, v220
    v_mul_f32 v125, v125, v220
    v_mul_f32 v126, v126, v220
    v_mul_f32 v127, v127, v220
    s_nop 1
    v_mfma_f32_32x32x16_bf16 v[112:127], a[88:91], v[208:211], v[112:127]
    v_add_f32 v192, v192, v200
    v_add_f32 v193, v193, v201
    v_add_f32 v194, v194, v202
    v_add_f32 v195, v195, v203
    v_add_f32 v196, v196, v204
    v_add_f32 v197, v197, v205
    v_add_f32 v198, v198, v206
    v_add_f32 v199, v199, v207
    v_mfma_f32_32x32x16_bf16 v[112:127], a[92:95], v[212:215], v[112:127]
    v_add_f32 v192, v192, v196
    v_add_f32 v193, v193, v197
    v_add_f32 v194, v194, v198
    v_add_f32 v195, v195, v199
    v_add_f32 v192, v192, v193
    v_add_f32 v194, v194, v195
    v_add_f32 v192, v192, v194
    v_add_f32 v217, v217, v192
    s_waitcnt lgkmcnt(0)
    v_add_f32 v144, v144, v128
    v_add_f32 v145, v145, v129
    v_add_f32 v146, v146, v130
    v_add_f32 v147, v147, v131
    v_add_f32 v148, v148, v132
    v_add_f32 v149, v149, v133
    v_add_f32 v150, v150, v134
    v_add_f32 v151, v151, v135
    v_add_f32 v152, v152, v136
    v_add_f32 v153, v153, v137
    v_add_f32 v154, v154, v138
    v_add_f32 v155, v155, v139
    v_add_f32 v156, v156, v140
    v_add_f32 v157, v157, v141
    v_add_f32 v158, v158, v142
    v_add_f32 v159, v159, v143
    s_waitcnt lgkmcnt(0)
    ds_read_b64_tr_b16 a[64:65], v40 offset:24576
    ds_read_b64_tr_b16 a[66:67], v41 offset:26624
    v_add_f32 v160, v160, v176
    v_add_f32 v161, v161, v177
    v_add_f32 v162, v162, v178
    v_add_f32 v163, v163, v179
    v_add_f32 v164, v164, v180
    ds_read_b64_tr_b16 a[72:73], v42 offset:24576
    ds_read_b64_tr_b16 a[74:75], v43 offset:26624
    v_add_f32 v165, v165, v181
    v_add_f32 v166, v166, v182
    v_add_f32 v167, v167, v183
    v_add_f32 v168, v168, v184
    v_add_f32 v169, v169, v185
    ds_read_b64_tr_b16 a[80:81], v44 offset:24576
    ds_read_b64_tr_b16 a[82:83], v45 offset:26624
    v_add_f32 v170, v170, v186
    v_add_f32 v171, v171, v187
    v_add_f32 v172, v172, v188
    v_add_f32 v173, v173, v189
    v_add_f32 v174, v174, v190
    ds_read_b64_tr_b16 a[88:89], v46 offset:24576
    ds_read_b64_tr_b16 a[90:91], v47 offset:26624
    v_add_f32 v175, v175, v191
    v_add_f32 v144, v144, v160
    v_add_f32 v145, v145, v161
    v_add_f32 v146, v146, v162
    v_add_f32 v147, v147, v163
    ds_read_b64_tr_b16 a[68:69], v40 offset:28672
    ds_read_b64_tr_b16 a[70:71], v41 offset:30720
    v_add_f32 v148, v148, v164
    v_add_f32 v149, v149, v165
    v_add_f32 v150, v150, v166
    v_add_f32 v151, v151, v167
    v_add_f32 v152, v152, v168
    ds_read_b64_tr_b16 a[76:77], v42 offset:28672
    ds_read_b64_tr_b16 a[78:79], v43 offset:30720
    v_add_f32 v153, v153, v169
    v_add_f32 v154, v154, v170
    v_add_f32 v155, v155, v171
    v_add_f32 v156, v156, v172
    v_add_f32 v157, v157, v173
    ds_read_b64_tr_b16 a[84:85], v44 offset:28672
    ds_read_b64_tr_b16 a[86:87], v45 offset:30720
    v_add_f32 v158, v158, v174
    v_add_f32 v159, v159, v175
    v_max3_f32 v218, v144, v145, v146
    v_max3_f32 v219, v147, v148, v149
    v_max3_f32 v220, v150, v151, v152
    ds_read_b64_tr_b16 a[92:93], v46 offset:28672
    ds_read_b64_tr_b16 a[94:95], v47 offset:30720
    v_max3_f32 v221, v153, v154, v155
    v_max3_f32 v218, v218, v156, v157
    v_max3_f32 v219, v219, v158, v159
    v_max3_f32 v218, v218, v219, v220
    v_max_f32 v218, v218, v221
    v_mov_b32 v219, v218
    s_nop 1
    v_permlane32_swap_b32 v218, v219
    v_max3_f32 v218, v218, v219, v216
    v_sub_f32 v220, v216, v218
    v_mov_b32 v216, v218
    v_exp_f32 v220, v220
    v_sub_f32 v192, v144, v218
    v_sub_f32 v193, v145, v218
    v_sub_f32 v194, v146, v218
    v_sub_f32 v195, v147, v218
    v_sub_f32 v196, v148, v218
    v_sub_f32 v197, v149, v218
    v_sub_f32 v198, v150, v218
    v_sub_f32 v199, v151, v218
    v_sub_f32 v200, v152, v218
    v_sub_f32 v201, v153, v218
    v_sub_f32 v202, v154, v218
    v_sub_f32 v203, v155, v218
    v_sub_f32 v204, v156, v218
    v_sub_f32 v205, v157, v218
    v_sub_f32 v206, v158, v218
    v_sub_f32 v207, v159, v218
    v_exp_f32 v192, v192
    v_exp_f32 v193, v193
    v_exp_f32 v194, v194
    v_exp_f32 v195, v195
    v_exp_f32 v196, v196
    v_exp_f32 v197, v197
    v_exp_f32 v198, v198
    v_exp_f32 v199, v199
    v_exp_f32 v200, v200
    v_exp_f32 v201, v201
    v_exp_f32 v202, v202
    v_exp_f32 v203, v203
    v_exp_f32 v204, v204
    v_exp_f32 v205, v205
    v_exp_f32 v206, v206
    v_exp_f32 v207, v207
    v_mul_f32 v217, v217, v220
    v_cvt_pk_bf16_f32 v208, v192, v193
    v_cvt_pk_bf16_f32 v209, v194, v195
    v_cvt_pk_bf16_f32 v210, v196, v197
    v_cvt_pk_bf16_f32 v211, v198, v199
    v_cvt_pk_bf16_f32 v212, v200, v201
    v_cvt_pk_bf16_f32 v213, v202, v203
    v_cvt_pk_bf16_f32 v214, v204, v205
    v_cvt_pk_bf16_f32 v215, v206, v207
    v_mul_f32 v64, v64, v220
    v_mul_f32 v65, v65, v220
    v_mul_f32 v66, v66, v220
    v_mul_f32 v67, v67, v220
    v_mul_f32 v68, v68, v220
    v_mul_f32 v69, v69, v220
    v_mul_f32 v70, v70, v220
    v_mul_f32 v71, v71, v220
    v_mul_f32 v72, v72, v220
    v_mul_f32 v73, v73, v220
    v_mul_f32 v74, v74, v220
    v_mul_f32 v75, v75, v220
    v_mul_f32 v76, v76, v220
    v_mul_f32 v77, v77, v220
    v_mul_f32 v78, v78, v220
    v_mul_f32 v79, v79, v220
    s_waitcnt lgkmcnt(0)
    s_nop 0
    v_mfma_f32_32x32x16_bf16 v[64:79], a[64:67], v[208:211], v[64:79]
    v_mul_f32 v80, v80, v220
    v_mul_f32 v81, v81, v220
    v_mul_f32 v82, v82, v220
    v_mul_f32 v83, v83, v220
    v_mul_f32 v84, v84, v220
    v_mul_f32 v85, v85, v220
    v_mul_f32 v86, v86, v220
    v_mul_f32 v87, v87, v220
    v_mfma_f32_32x32x16_bf16 v[64:79], a[68:71], v[212:215], v[64:79]
    v_mul_f32 v88, v88, v220
    v_mul_f32 v89, v89, v220
    v_mul_f32 v90, v90, v220
    v_mul_f32 v91, v91, v220
    v_mul_f32 v92, v92, v220
    v_mul_f32 v93, v93, v220
    v_mul_f32 v94, v94, v220
    v_mul_f32 v95, v95, v220
    s_nop 1
    v_mfma_f32_32x32x16_bf16 v[80:95], a[72:75], v[208:211], v[80:95]
    v_mul_f32 v96, v96, v220
    v_mul_f32 v97, v97, v220
    v_mul_f32 v98, v98, v220
    v_mul_f32 v99, v99, v220
    v_mul_f32 v100, v100, v220
    v_mul_f32 v101, v101, v220
    v_mul_f32 v102, v102, v220
    v_mul_f32 v103, v103, v220
    v_mfma_f32_32x32x16_bf16 v[80:95], a[76:79], v[212:215], v[80:95]
    v_mul_f32 v104, v104, v220
    v_mul_f32 v105, v105, v220
    v_mul_f32 v106, v106, v220
    v_mul_f32 v107, v107, v220
    v_mul_f32 v108, v108, v220
    v_mul_f32 v109, v109, v220
    v_mul_f32 v110, v110, v220
    v_mul_f32 v111, v111, v220
    s_nop 1
    v_mfma_f32_32x32x16_bf16 v[96:111], a[80:83], v[208:211], v[96:111]
    v_mul_f32 v112, v112, v220
    v_mul_f32 v113, v113, v220
    v_mul_f32 v114, v114, v220
    v_mul_f32 v115, v115, v220
    v_mul_f32 v116, v116, v220
    v_mul_f32 v117, v117, v220
    v_mul_f32 v118, v118, v220
    v_mul_f32 v119, v119, v220
    v_mfma_f32_32x32x16_bf16 v[96:111], a[84:87], v[212:215], v[96:111]
    v_mul_f32 v120, v120, v220
    v_mul_f32 v121, v121, v220
    v_mul_f32 v122, v122, v220
    v_mul_f32 v123, v123, v220
    v_mul_f32 v124, v124, v220
    v_mul_f32 v125, v125, v220
    v_mul_f32 v126, v126, v220
    v_mul_f32 v127, v127, v220
    s_nop 1
    v_mfma_f32_32x32x16_bf16 v[112:127], a[88:91], v[208:211], v[112:127]
    v_add_f32 v192, v192, v200
    v_add_f32 v193, v193, v201
    v_add_f32 v194, v194, v202
    v_add_f32 v195, v195, v203
    v_add_f32 v196, v196, v204
    v_add_f32 v197, v197, v205
    v_add_f32 v198, v198, v206
    v_add_f32 v199, v199, v207
    v_mfma_f32_32x32x16_bf16 v[112:127], a[92:95], v[212:215], v[112:127]
    v_add_f32 v192, v192, v196
    v_add_f32 v193, v193, v197
    v_add_f32 v194, v194, v198
    v_add_f32 v195, v195, v199
    v_add_f32 v192, v192, v193
    v_add_f32 v194, v194, v195
    v_add_f32 v192, v192, v194
    v_add_f32 v217, v217, v192
    s_waitcnt lgkmcnt(0)
    v_mov_b32 v219, v217
    s_nop 1
    v_permlane32_swap_b32 v217, v219
    v_add_f32 v217, v217, v219
    v_rcp_f32 v220, v217
    v_mul_u32_u24 v5, 272, v24
    v_lshl_add_u32 v5, v25, 3, v5
    v_add_u32 v5, s63, v5
    v_mul_f32 v64, v64, v220
    v_mul_f32 v65, v65, v220
    v_mul_f32 v66, v66, v220
    v_mul_f32 v67, v67, v220
    v_mul_f32 v68, v68, v220
    v_mul_f32 v69, v69, v220
    v_mul_f32 v70, v70, v220
    v_mul_f32 v71, v71, v220
    v_mul_f32 v72, v72, v220
    v_mul_f32 v73, v73, v220
    v_mul_f32 v74, v74, v220
    v_mul_f32 v75, v75, v220
    v_mul_f32 v76, v76, v220
    v_mul_f32 v77, v77, v220
    v_mul_f32 v78, v78, v220
    v_mul_f32 v79, v79, v220
    v_mul_f32 v80, v80, v220
    v_mul_f32 v81, v81, v220
    v_mul_f32 v82, v82, v220
    v_mul_f32 v83, v83, v220
    v_mul_f32 v84, v84, v220
    v_mul_f32 v85, v85, v220
    v_mul_f32 v86, v86, v220
    v_mul_f32 v87, v87, v220
    v_mul_f32 v88, v88, v220
    v_mul_f32 v89, v89, v220
    v_mul_f32 v90, v90, v220
    v_mul_f32 v91, v91, v220
    v_mul_f32 v92, v92, v220
    v_mul_f32 v93, v93, v220
    v_mul_f32 v94, v94, v220
    v_mul_f32 v95, v95, v220
    v_mul_f32 v96, v96, v220
    v_mul_f32 v97, v97, v220
    v_mul_f32 v98, v98, v220
    v_mul_f32 v99, v99, v220
    v_mul_f32 v100, v100, v220
    v_mul_f32 v101, v101, v220
    v_mul_f32 v102, v102, v220
    v_mul_f32 v103, v103, v220
    v_mul_f32 v104, v104, v220
    v_mul_f32 v105, v105, v220
    v_mul_f32 v106, v106, v220
    v_mul_f32 v107, v107, v220
    v_mul_f32 v108, v108, v220
    v_mul_f32 v109, v109, v220
    v_mul_f32 v110, v110, v220
    v_mul_f32 v111, v111, v220
    v_mul_f32 v112, v112, v220
    v_mul_f32 v113, v113, v220
    v_mul_f32 v114, v114, v220
    v_mul_f32 v115, v115, v220
    v_mul_f32 v116, v116, v220
    v_mul_f32 v117, v117, v220
    v_mul_f32 v118, v118, v220
    v_mul_f32 v119, v119, v220
    v_mul_f32 v120, v120, v220
    v_mul_f32 v121, v121, v220
    v_mul_f32 v122, v122, v220
    v_mul_f32 v123, v123, v220
    v_mul_f32 v124, v124, v220
    v_mul_f32 v125, v125, v220
    v_mul_f32 v126, v126, v220
    v_mul_f32 v127, v127, v220
    v_cvt_pk_bf16_f32 v128, v64, v65
    v_cvt_pk_bf16_f32 v129, v66, v67
    v_cvt_pk_bf16_f32 v130, v68, v69
    v_cvt_pk_bf16_f32 v131, v70, v71
    v_cvt_pk_bf16_f32 v132, v72, v73
    v_cvt_pk_bf16_f32 v133, v74, v75
    v_cvt_pk_bf16_f32 v134, v76, v77
    v_cvt_pk_bf16_f32 v135, v78, v79
    v_cvt_pk_bf16_f32 v136, v80, v81
    v_cvt_pk_bf16_f32 v137, v82, v83
    v_cvt_pk_bf16_f32 v138, v84, v85
    v_cvt_pk_bf16_f32 v139, v86, v87
    v_cvt_pk_bf16_f32 v140, v88, v89
    v_cvt_pk_bf16_f32 v141, v90, v91
    v_cvt_pk_bf16_f32 v142, v92, v93
    v_cvt_pk_bf16_f32 v143, v94, v95
    v_cvt_pk_bf16_f32 v144, v96, v97
    v_cvt_pk_bf16_f32 v145, v98, v99
    v_cvt_pk_bf16_f32 v146, v100, v101
    v_cvt_pk_bf16_f32 v147, v102, v103
    v_cvt_pk_bf16_f32 v148, v104, v105
    v_cvt_pk_bf16_f32 v149, v106, v107
    v_cvt_pk_bf16_f32 v150, v108, v109
    v_cvt_pk_bf16_f32 v151, v110, v111
    v_cvt_pk_bf16_f32 v152, v112, v113
    v_cvt_pk_bf16_f32 v153, v114, v115
    v_cvt_pk_bf16_f32 v154, v116, v117
    v_cvt_pk_bf16_f32 v155, v118, v119
    v_cvt_pk_bf16_f32 v156, v120, v121
    v_cvt_pk_bf16_f32 v157, v122, v123
    v_cvt_pk_bf16_f32 v158, v124, v125
    v_cvt_pk_bf16_f32 v159, v126, v127
    v_min_u32 v216, -2, v216
    v_min_u32 v217, -2, v217
    s_nop 0
    v_mov_b32_dpp v218, v216 quad_perm:[1,1,3,3] row_mask:0xf bank_mask:0xf
    v_mov_b32_dpp v219, v217 quad_perm:[1,1,3,3] row_mask:0xf bank_mask:0xf
    ds_write_b64 v5, v[128:129] offset:0
    ds_write_b64 v5, v[130:131] offset:16
    ds_write_b64 v5, v[132:133] offset:32
    ds_write_b64 v5, v[134:135] offset:48
    ds_write_b64 v5, v[136:137] offset:64
    ds_write_b64 v5, v[138:139] offset:80
    ds_write_b64 v5, v[140:141] offset:96
    ds_write_b64 v5, v[142:143] offset:112
    ds_write_b64 v5, v[144:145] offset:128
    ds_write_b64 v5, v[146:147] offset:144
    ds_write_b64 v5, v[148:149] offset:160
    ds_write_b64 v5, v[150:151] offset:176
    ds_write_b64 v5, v[152:153] offset:192
    ds_write_b64 v5, v[154:155] offset:208
    ds_write_b64 v5, v[156:157] offset:224
    ds_write_b64 v5, v[158:159] offset:240
    v_mul_u32_u24 v6, 272, v4
    v_lshl_add_u32 v6, v3, 4, v6
    v_add_u32 v6, s63, v6
    s_waitcnt lgkmcnt(0)
    ds_read_b128 v[64:67], v6 offset:0
    ds_read_b128 v[68:71], v6 offset:1088
    ds_read_b128 v[72:75], v6 offset:2176
    ds_read_b128 v[76:79], v6 offset:3264
    ds_read_b128 v[80:83], v6 offset:4352
    ds_read_b128 v[84:87], v6 offset:5440
    ds_read_b128 v[88:91], v6 offset:6528
    ds_read_b128 v[92:95], v6 offset:7616
    v_lshlrev_b32 v7, 10, v4
    v_lshl_add_u32 v7, v3, 4, v7
    s_lshl_b32 s54, s53, 15
    s_lshl_b32 s55, s3, 8
    s_add_u32 s54, s54, s55
    s_add_u32 s54, s54, 2097152
    s_waitcnt lgkmcnt(7)
    buffer_store_dwordx4 v[64:67], v7, s[44:47], s54 offen sc1
    s_add_u32 s54, s54, 4096
    s_waitcnt lgkmcnt(6)
    buffer_store_dwordx4 v[68:71], v7, s[44:47], s54 offen sc1
    s_add_u32 s54, s54, 4096
    s_waitcnt lgkmcnt(5)
    buffer_store_dwordx4 v[72:75], v7, s[44:47], s54 offen sc1
    s_add_u32 s54, s54, 4096
    s_waitcnt lgkmcnt(4)
    buffer_store_dwordx4 v[76:79], v7, s[44:47], s54 offen sc1
    s_add_u32 s54, s54, 4096
    s_waitcnt lgkmcnt(3)
    buffer_store_dwordx4 v[80:83], v7, s[44:47], s54 offen sc1
    s_add_u32 s54, s54, 4096
    s_waitcnt lgkmcnt(2)
    buffer_store_dwordx4 v[84:87], v7, s[44:47], s54 offen sc1
    s_add_u32 s54, s54, 4096
    s_waitcnt lgkmcnt(1)
    buffer_store_dwordx4 v[88:91], v7, s[44:47], s54 offen sc1
    s_add_u32 s54, s54, 4096
    s_waitcnt lgkmcnt(0)
    buffer_store_dwordx4 v[92:95], v7, s[44:47], s54 offen sc1
    s_add_u32 s54, s54, 4096
    v_lshlrev_b32 v5, 3, v1
    s_lshl_b32 s54, s53, 8
    s_add_u32 s54, s54, 3145728
    s_cmp_eq_u32 s3, 0
    s_cselect_b32 s56, 0x55555555, 0
    s_mov_b32 s57, 0
    s_waitcnt vmcnt(0)
    s_barrier
    s_mov_b64 exec, s[56:57]
    buffer_store_dwordx4 v[216:219], v5, s[44:47], s54 offen sc1
    s_mov_b64 exec, -1
    s_mov_b32 s48, s26
    s_mov_b32 s49, s27
    s_mov_b32 s50, 9216
    s_mov_b32 s51, 0x20000
    s_lshl_b32 s54, s3, 5
    s_add_u32 s54, s54, s53
    s_cmp_ge_u32 s54, 72
    s_cbranch_scc1 L_nored_31
    s_waitcnt vmcnt(0)
    v_mov_b32 v48, -1
    v_mov_b32 v49, -1
    v_mov_b32 v50, -1
    v_mov_b32 v51, -1
    v_mov_b32 v52, -1
    v_mov_b32 v53, -1
    v_mov_b32 v54, -1
    v_mov_b32 v55, -1
    v_mov_b32 v56, -1
    v_mov_b32 v57, -1
    v_mov_b32 v58, -1
    v_mov_b32 v59, -1
    v_mov_b32 v60, -1
    v_mov_b32 v61, -1
    v_mov_b32 v62, -1
    v_mov_b32 v63, -1
    s_lshl_b32 s55, s54, 12
    s_add_u32 s55, s55, 4194304
    s_mul_hi_u32 s56, s54, 238609295
    s_add_u32 s56, s56, 0
    s_mul_i32 s56, s56, 1152
    s_lshl_b32 s57, s54, 6
    s_add_u32 s56, s56, s57
    v_lshlrev_b32 v5, 3, v3
    v_lshl_add_u32 v5, v4, 1, v5
    v_mov_b32 v6, 0x4000
    v_cmp_gt_u32 vcc, 8, v3
    s_nop 1
    v_cndmask_b32 v5, v6, v5, vcc
    s_mov_b64 s[4:5], -1
    s_mov_b64 s[6:7], -1
    s_mov_b64 s[8:9], -1
    s_mov_b64 s[10:11], -1
L_mpoll_32:
    s_mov_b64 exec, s[4:5]
    buffer_load_dwordx4 v[48:51], v2, s[44:47], s55 offen offset:0 sc1
    s_mov_b64 exec, s[6:7]
    buffer_load_dwordx4 v[52:55], v2, s[44:47], s55 offen offset:1024 sc1
    s_mov_b64 exec, s[8:9]
    buffer_load_dwordx4 v[56:59], v2, s[44:47], s55 offen offset:2048 sc1
    s_mov_b64 exec, s[10:11]
    buffer_load_dwordx4 v[60:63], v2, s[44:47], s55 offen offset:3072 sc1
    s_mov_b64 exec, -1
    s_waitcnt vmcnt(4)
    v_max3_u32 v32, v48, v49, v50
    v_max3_u32 v33, v52, v53, v54
    v_max3_u32 v34, v56, v57, v58
    v_max3_u32 v35, v60, v61, v62
    v_max_u32 v32, v32, v51
    v_max_u32 v33, v33, v55
    v_max_u32 v34, v34, v59
    v_max_u32 v35, v35, v63
    v_cmp_eq_u32 s[4:5], -1, v32
    v_cmp_eq_u32 s[6:7], -1, v33
    v_cmp_eq_u32 s[8:9], -1, v34
    v_cmp_eq_u32 s[10:11], -1, v35
    s_or_b64 vcc, s[4:5], s[6:7]
    s_or_b64 vcc, vcc, s[8:9]
    s_or_b64 vcc, vcc, s[10:11]
    s_cbranch_scc0 L_mpollok_33
    s_and_b64 vcc, s[4:5], s[6:7]
    s_and_b64 vcc, vcc, s[8:9]
    s_and_b64 vcc, vcc, s[10:11]
    s_cmp_eq_u64 vcc, -1
    s_cbranch_scc0 L_mpoll_32_b
    s_sleep 4
L_mpoll_32_b:
    s_sub_u32 s101, s101, 1
    s_cbranch_scc0 L_mpoll_32
    s_mov_b32 s101, 0
L_mpollok_33:
    v_add_f32 v16, v48, v52
    v_add_f32 v24, v56, v60
    v_add_f32 v18, v50, v54
    v_add_f32 v26, v58, v62
    v_add_f32 v17, v49, v53
    v_add_f32 v25, v57, v61
    v_add_f32 v19, v51, v55
    v_add_f32 v27, v59, v63
    v_add_f32 v16, v16, v24
    v_add_f32 v18, v18, v26
    v_add_f32 v17, v17, v25
    v_add_f32 v19, v19, v27
    v_permlane32_swap_b32 v16, v18
    s_nop 0
    v_permlane32_swap_b32 v17, v19
    v_add_f32 v16, v16, v18
    v_add_f32 v17, v17, v19
    s_nop 1
    v_permlane16_swap_b32 v16, v17
    v_add_f32 v16, v16, v17
    s_nop 1
    v_add_f32_dpp v16, v16, v16 row_ror:8 row_mask:0xf bank_mask:0xf
    v_cvt_pk_bf16_f32 v16, v16, v16
    buffer_store_short v16, v5, s[48:51], s56 offen
L_nored_31:
    s_endpgm
L_roleC_end:
L_exit:
    s_endpgm
.section .rodata,"a"
.p2align 6
.amdhsa_kernel concat_heads__mha_block_cached__compressed_kv_cla__decode_kernel
  .amdhsa_next_free_vgpr 512
  .amdhsa_next_free_sgpr 102
  .amdhsa_accum_offset 256
  .amdhsa_group_segment_fixed_size 0
  .amdhsa_kernarg_size 112
  .amdhsa_user_sgpr_count 2
  .amdhsa_user_sgpr_kernarg_segment_ptr 1
  .amdhsa_system_sgpr_workgroup_id_x 1
.end_amdhsa_kernel
```

```asm
; @launch grid=(256,1,1) block=(256,1,1) lds=163840
.amdgcn_target "amdgcn-amd-amdhsa--gfx950"
.text
.globl concat_heads__mha_block_cached__compressed_kv_cla__decode_kernel
.p2align 12
.p2align 8
.type concat_heads__mha_block_cached__compressed_kv_cla__decode_kernel,@function
concat_heads__mha_block_cached__compressed_kv_cla__decode_kernel:
    s_cmp_ge_u32 s2, 256
    s_cbranch_scc1 L_exit
    s_load_dwordx16 s[4:19], s[0:1], 0
    s_load_dwordx8 s[20:27], s[0:1], 64
    s_load_dwordx4 s[28:31], s[0:1], 96
    v_lshrrev_b32 v2, 6, v0
    v_and_b32 v1, 63, v0
    v_readfirstlane_b32 s3, v2
    v_and_b32 v3, 15, v0
    v_bfe_u32 v4, v0, 4, 2
    v_lshlrev_b32 v2, 4, v1
    s_and_b32 s52, s2, 31
    s_mov_b32 s53, s52
    s_cmp_lt_u32 s2, 32
    s_cbranch_scc1 L_roleH
    s_cmp_lt_u32 s2, 64
    s_cbranch_scc1 L_roleC
L_roleA:
    s_sub_u32 s54, s2, 64
    s_mul_hi_u32 s96, s54, 178956971
    s_mul_i32 s56, s96, 24
    s_sub_u32 s97, s54, s56
    s_lshr_b32 s55, s97, 3
    s_add_u32 s3, s3, s97
    s_add_u32 s3, s3, s55
    s_and_b32 s3, s3, 3
    s_add_u32 s56, s96, s3
    s_and_b32 s56, s56, 3
    s_lshr_b32 s55, s97, 3
    s_and_b32 s53, s97, 7
    s_lshl_b32 s96, s96, 2
    s_add_u32 s55, s55, s56
    s_add_u32 s55, s55, 1
    s_and_b32 s55, s55, 3
    s_add_u32 s52, s96, s55
    s_add_u32 s96, s96, s56
    s_lshl_b32 s100, s53, 11
    s_and_b32 s100, s100, 0x800
    s_lshl_b32 s55, s53, 12
    s_and_b32 s55, s55, 0x6000
    s_or_b32 s100, s100, s55
    s_lshl_b32 s55, s3, 25
    s_or_b32 s100, s100, s55
    s_lshl_b32 s55, s52, 20
    s_or_b32 s100, s100, s55
    s_lshl_b32 s58, s52, 2
    s_add_u32 s58, s58, s3
    s_mul_i32 s58, s58, 0
    s_lshl_b32 s61, s58, 9
    s_and_b32 s61, s61, 0x600
    s_lshl_b32 s55, s58, 15
    s_and_b32 s55, s55, 0xe0000
    s_or_b32 s61, s61, s55
    s_mov_b32 s58, 393216
    s_mov_b32 s59, 1048576
    s_and_b32 s99, s96, 28
    s_add_u32 s99, s99, s3
    s_mul_i32 s99, s99, 37
    s_mov_b32 s63, s53
    s_getpc_b64 s[56:57]
L_pc_1:
    s_sub_u32 s56, s56, L_pc_1-L_roleA
    s_subb_u32 s57, s57, 0
    v_lshlrev_b32 v5, 7, v0
    v_min_u32 v6, L_roleA_end-L_roleA-4, v5
    global_load_dword v56, v6, s[56:57]
    s_mov_b32 s53, 536870912
    v_cmp_eq_u32 vcc, 0, v1
    v_lshlrev_b32 v0, 4, v3
    v_and_b32 v5, 1, v4
    v_lshl_add_u32 v0, v5, 8, v0
    v_lshrrev_b32 v5, 1, v4
    v_lshl_add_u32 v0, v5, 12, v0
    v_add_u32 v18, 32768, v0
    v_add_u32 v48, 65536, v0
    v_add_u32 v49, 98304, v0
    s_waitcnt lgkmcnt(0)
    s_mov_b32 s32, s6
    s_mov_b32 s33, s7
    s_mov_b32 s34, 134217728
    s_mov_b32 s35, 0x20000
    s_mov_b32 s36, s8
    s_mov_b32 s37, s9
    s_mov_b32 s38, 134217728
    s_mov_b32 s39, 0x20000
    s_mov_b32 s44, s30
    s_mov_b32 s45, s31
    s_mov_b32 s46, 536870912
    s_mov_b32 s47, 0x20000
    s_or_b32 s60, s61, s100
    s_or_b32 s61, s61, 0xfff1f9ff
    s_add_u32 s61, s61, 1
    s_and_b32 s61, s61, 0xe0600
    buffer_load_dwordx4 v[96:99], v0, s[32:35], s60 offen nt
    buffer_load_dwordx4 v[100:103], v18, s[32:35], s60 offen nt
    buffer_load_dwordx4 v[104:107], v48, s[32:35], s60 offen nt
    buffer_load_dwordx4 v[108:111], v49, s[32:35], s60 offen nt
    buffer_load_dwordx4 a[32:35], v0, s[36:39], s60 offen nt
    buffer_load_dwordx4 a[36:39], v18, s[36:39], s60 offen nt
    buffer_load_dwordx4 a[40:43], v48, s[36:39], s60 offen nt
    buffer_load_dwordx4 a[44:47], v49, s[36:39], s60 offen nt
    s_or_b32 s60, s61, s100
    s_or_b32 s61, s61, 0xfff1f9ff
    s_add_u32 s61, s61, 1
    s_and_b32 s61, s61, 0xe0600
    buffer_load_dwordx4 v[112:115], v0, s[32:35], s60 offen nt
    buffer_load_dwordx4 v[116:119], v18, s[32:35], s60 offen nt
    buffer_load_dwordx4 v[120:123], v48, s[32:35], s60 offen nt
    buffer_load_dwordx4 v[124:127], v49, s[32:35], s60 offen nt
    buffer_load_dwordx4 a[48:51], v0, s[36:39], s60 offen nt
    buffer_load_dwordx4 a[52:55], v18, s[36:39], s60 offen nt
    buffer_load_dwordx4 a[56:59], v48, s[36:39], s60 offen nt
    buffer_load_dwordx4 a[60:63], v49, s[36:39], s60 offen nt
    s_or_b32 s60, s61, s100
    s_or_b32 s61, s61, 0xfff1f9ff
    s_add_u32 s61, s61, 1
    s_and_b32 s61, s61, 0xe0600
    buffer_load_dwordx4 v[128:131], v0, s[32:35], s60 offen nt
    buffer_load_dwordx4 v[132:135], v18, s[32:35], s60 offen nt
    buffer_load_dwordx4 v[136:139], v48, s[32:35], s60 offen nt
    buffer_load_dwordx4 v[140:143], v49, s[32:35], s60 offen nt
    buffer_load_dwordx4 a[64:67], v0, s[36:39], s60 offen nt
    buffer_load_dwordx4 a[68:71], v18, s[36:39], s60 offen nt
    buffer_load_dwordx4 a[72:75], v48, s[36:39], s60 offen nt
    buffer_load_dwordx4 a[76:79], v49, s[36:39], s60 offen nt
    s_or_b32 s60, s61, s100
    s_or_b32 s61, s61, 0xfff1f9ff
    s_add_u32 s61, s61, 1
    s_and_b32 s61, s61, 0xe0600
    buffer_load_dwordx4 v[144:147], v0, s[32:35], s60 offen nt
    buffer_load_dwordx4 v[148:151], v18, s[32:35], s60 offen nt
    buffer_load_dwordx4 v[152:155], v48, s[32:35], s60 offen nt
    buffer_load_dwordx4 v[156:159], v49, s[32:35], s60 offen nt
    buffer_load_dwordx4 a[80:83], v0, s[36:39], s60 offen nt
    buffer_load_dwordx4 a[84:87], v18, s[36:39], s60 offen nt
    buffer_load_dwordx4 a[88:91], v48, s[36:39], s60 offen nt
    buffer_load_dwordx4 a[92:95], v49, s[36:39], s60 offen nt
    s_or_b32 s60, s61, s100
    s_or_b32 s61, s61, 0xfff1f9ff
    s_add_u32 s61, s61, 1
    s_and_b32 s61, s61, 0xe0600
    buffer_load_dwordx4 v[160:163], v0, s[32:35], s60 offen nt
    buffer_load_dwordx4 v[164:167], v18, s[32:35], s60 offen nt
    buffer_load_dwordx4 v[168:171], v48, s[32:35], s60 offen nt
    buffer_load_dwordx4 v[172:175], v49, s[32:35], s60 offen nt
    buffer_load_dwordx4 a[96:99], v0, s[36:39], s60 offen nt
    buffer_load_dwordx4 a[100:103], v18, s[36:39], s60 offen nt
    buffer_load_dwordx4 a[104:107], v48, s[36:39], s60 offen nt
    buffer_load_dwordx4 a[108:111], v49, s[36:39], s60 offen nt
    s_or_b32 s60, s61, s100
    s_or_b32 s61, s61, 0xfff1f9ff
    s_add_u32 s61, s61, 1
    s_and_b32 s61, s61, 0xe0600
    buffer_load_dwordx4 v[176:179], v0, s[32:35], s60 offen nt
    buffer_load_dwordx4 v[180:183], v18, s[32:35], s60 offen nt
    buffer_load_dwordx4 v[184:187], v48, s[32:35], s60 offen nt
    buffer_load_dwordx4 v[188:191], v49, s[32:35], s60 offen nt
    buffer_load_dwordx4 a[112:115], v0, s[36:39], s60 offen nt
    buffer_load_dwordx4 a[116:119], v18, s[36:39], s60 offen nt
    buffer_load_dwordx4 a[120:123], v48, s[36:39], s60 offen nt
    buffer_load_dwordx4 a[124:127], v49, s[36:39], s60 offen nt
    s_or_b32 s60, s61, s100
    s_or_b32 s61, s61, 0xfff1f9ff
    s_add_u32 s61, s61, 1
    s_and_b32 s61, s61, 0xe0600
    buffer_load_dwordx4 v[192:195], v0, s[32:35], s60 offen nt
    buffer_load_dwordx4 v[196:199], v18, s[32:35], s60 offen nt
    buffer_load_dwordx4 v[200:203], v48, s[32:35], s60 offen nt
    buffer_load_dwordx4 v[204:207], v49, s[32:35], s60 offen nt
    buffer_load_dwordx4 a[128:131], v0, s[36:39], s60 offen nt
    buffer_load_dwordx4 a[132:135], v18, s[36:39], s60 offen nt
    buffer_load_dwordx4 a[136:139], v48, s[36:39], s60 offen nt
    buffer_load_dwordx4 a[140:143], v49, s[36:39], s60 offen nt
    s_sub_u32 s23, s2, 64
    s_and_b32 s26, s23, 7
    s_lshr_b32 s23, s23, 3
    s_mul_i32 s27, s23, 43
    s_lshr_b32 s27, s27, 8
    s_lshl_b32 s26, s26, 2
    s_add_u32 s26, s26, s27
    s_mul_i32 s27, s27, 6
    s_sub_u32 s23, s23, s27
    v_mov_b32 v58, 0
    s_load_dword s18, s[28:29], 0
    s_waitcnt vmcnt(48)
    s_or_b32 s60, s61, s100
    s_or_b32 s61, s61, 0xfff1f9ff
    s_add_u32 s61, s61, 1
    s_and_b32 s61, s61, 0xe0600
    buffer_load_dwordx4 v[208:211], v0, s[32:35], s60 offen nt
    buffer_load_dwordx4 v[212:215], v18, s[32:35], s60 offen nt
    buffer_load_dwordx4 v[216:219], v48, s[32:35], s60 offen nt
    buffer_load_dwordx4 v[220:223], v49, s[32:35], s60 offen nt
    buffer_load_dwordx4 a[144:147], v0, s[36:39], s60 offen nt
    buffer_load_dwordx4 a[148:151], v18, s[36:39], s60 offen nt
    buffer_load_dwordx4 a[152:155], v48, s[36:39], s60 offen nt
    buffer_load_dwordx4 a[156:159], v49, s[36:39], s60 offen nt
    s_waitcnt vmcnt(48)
    s_or_b32 s60, s61, s100
    s_or_b32 s61, s61, 0xfff1f9ff
    s_add_u32 s61, s61, 1
    s_and_b32 s61, s61, 0xe0600
    buffer_load_dwordx4 v[224:227], v0, s[32:35], s60 offen nt
    buffer_load_dwordx4 v[228:231], v18, s[32:35], s60 offen nt
    buffer_load_dwordx4 v[232:235], v48, s[32:35], s60 offen nt
    buffer_load_dwordx4 v[236:239], v49, s[32:35], s60 offen nt
    buffer_load_dwordx4 a[160:163], v0, s[36:39], s60 offen nt
    buffer_load_dwordx4 a[164:167], v18, s[36:39], s60 offen nt
    buffer_load_dwordx4 a[168:171], v48, s[36:39], s60 offen nt
    buffer_load_dwordx4 a[172:175], v49, s[36:39], s60 offen nt
    v_and_b32 v5, 1, v3
    v_cmp_eq_u32 vcc, 1, v5
    v_mov_b32 v5, 0xffff
    v_mov_b32 v6, 0xffff0000
    v_cndmask_b32 v5, v5, v6, vcc
    v_lshrrev_b32 v6, 1, v3
    v_cmp_eq_u32 vcc, 0, v6
    s_nop 1
    v_cndmask_b32 v8, 0, v5, vcc
    v_cmp_eq_u32 vcc, 1, v6
    s_nop 1
    v_cndmask_b32 v9, 0, v5, vcc
    v_cmp_eq_u32 vcc, 2, v6
    s_nop 1
    v_cndmask_b32 v10, 0, v5, vcc
    v_cmp_eq_u32 vcc, 3, v6
    s_nop 1
    v_cndmask_b32 v11, 0, v5, vcc
    s_bitcmp1_b32 s23, 0
    s_cselect_b32 s40, s24, s12
    s_cselect_b32 s41, s25, s13
    s_cselect_b32 s25, 524288, 0
    s_add_u32 s25, s25, 4194304
    s_mov_b32 s42, 4718592
    s_mov_b32 s43, 0x20000
    s_lshr_b32 s54, s23, 1
    s_mul_i32 s54, s54, 3
    s_add_u32 s54, s54, s3
    s_and_b32 s23, s23, 1
    s_mul_i32 s24, s26, 147456
    s_lshl_b32 s55, s54, 7
    s_add_u32 s24, s24, s55
    s_lshl_b32 s54, s54, 13
    s_lshl_b32 s55, s26, 7
    s_add_u32 s54, s54, s55
    s_add_u32 s25, s25, s54
    s_lshl_b32 s27, s26, 10
    s_add_u32 s27, s27, 5439488
    s_lshl_b32 s22, s26, 2
    s_add_u32 s22, s22, s3
    s_lshl_b32 s22, s22, 13
    s_add_u32 s22, s22, 8388608
    s_lshr_b32 s55, s26, 2
    s_add_u32 s55, s55, s3
    s_and_b32 s55, s55, 3
    s_and_b32 s54, s26, 3
    s_cmp_eq_u32 s54, s55
    s_cselect_b32 s54, 7, 1
    s_cselect_b32 s55, 5, 1
    s_cselect_b32 s26, 2, 0
    s_or_b32 s23, s23, s26
    v_and_b32 v30, s54, v3
    v_min_u32 v30, s55, v30
    v_lshl_add_u32 v30, v30, 2, v4
    v_lshlrev_b32 v30, 4, v30
    v_add_u32 v30, 6144, v30
    v_lshrrev_b32 v19, 3, v3
    v_lshl_add_u32 v19, v19, 2, v4
    v_mul_u32_u24 v19, 9216, v19
    v_and_b32 v5, 7, v3
    v_lshl_add_u32 v19, v5, 4, v19
    v_mov_b32 v12, 0
    v_mov_b32 v13, 0
    v_mov_b32 v14, 0
    v_mov_b32 v15, 0
    v_mov_b32 v16, 0xff800000
    v_mov_b32 v17, 0
    v_lshlrev_b32 v59, 4, v3
    v_and_b32 v5, 1, v4
    s_lshl_b32 s54, s52, 2
    s_add_u32 s54, s54, s3
    s_lshl_b32 s54, s54, 13
    s_lshl_b32 s55, s96, 2
    s_add_u32 s55, s55, s3
    s_lshl_b32 s55, s55, 13
    v_cmp_eq_u32 vcc, 1, v5
    v_mov_b32 v6, s54
    v_mov_b32 v7, s55
    v_cndmask_b32 v6, v6, v7, vcc
    v_mov_b32 v20, s63
    v_mov_b32 v7, s97
    v_cndmask_b32 v7, v20, v7, vcc
    v_lshl_add_u32 v20, v7, 4, v3
    v_lshl_add_u32 v20, v20, 4, v6
    v_lshl_add_u32 v21, v7, 4, v6
    v_add_u32 v21, 6144, v21
    v_mov_b32 v7, s53
    v_cmp_eq_u32 vcc, 0, v3
    s_nop 1
    v_cndmask_b32 v21, v7, v21, vcc
    v_cmp_gt_u32 vcc, 32, v1
    s_nop 1
    v_cndmask_b32 v3, v21, v20, vcc
    s_mov_b32 s8, 919040
    s_mov_b32 s9, s100
    s_mov_b32 s10, 0xff000
    s_lshl_b32 s11, s3, 25
    s_lshl_b32 s54, s96, 20
    s_add_u32 s11, s11, s54
    s_and_b32 s57, s96, 28
    s_add_u32 s57, s57, s3
    s_mul_i32 s57, s57, 256
    s_add_u32 s57, s57, 16777216
    s_lshl_b32 s54, s3, 8
    s_add_u32 s54, s54, 5242880
    s_lshl_b32 s56, s52, 10
    s_add_u32 s56, s56, s54
    s_lshl_b32 s12, s96, 10
    s_add_u32 s12, s12, s54
    s_mov_b32 s13, 0
    s_add_u32 s15, s59, 65536
    s_sub_u32 s14, s15, 131072
    s_mov_b32 s96, 1035273459
    s_mov_b32 s97, 1069066811
    s_mov_b32 s98, 0xffff0000
    s_mov_b32 s62, 2
    s_mov_b32 s101, 100000
    s_waitcnt lgkmcnt(0)
    s_cmp_lt_u32 s18, 64
    s_cbranch_scc1 L_aflag
L_aflag_ok:
    s_mov_b32 s18, 20
    s_mov_b64 s[6:7], s[8:9]
    s_mov_b32 s63, 0
    s_cmp_eq_u32 s3, 3
    s_cselect_b32 s19, -1, 256
    buffer_load_dwordx4 v[60:63], v59, s[44:47], s56 offen sc1
    s_waitcnt vmcnt(49)
    s_or_b32 s60, s61, s100
    s_or_b32 s61, s61, 0xfff1f9ff
    s_add_u32 s61, s61, 1
    s_and_b32 s61, s61, 0xe0600
    buffer_load_dwordx4 v[240:243], v0, s[32:35], s60 offen nt
    buffer_load_dwordx4 v[244:247], v18, s[32:35], s60 offen nt
    buffer_load_dwordx4 v[248:251], v48, s[32:35], s60 offen nt
    buffer_load_dwordx4 v[252:255], v49, s[32:35], s60 offen nt
    buffer_load_dwordx4 a[176:179], v0, s[36:39], s60 offen nt
    buffer_load_dwordx4 a[180:183], v18, s[36:39], s60 offen nt
    buffer_load_dwordx4 a[184:187], v48, s[36:39], s60 offen nt
    buffer_load_dwordx4 a[188:191], v49, s[36:39], s60 offen nt
    s_waitcnt vmcnt(49)
    s_or_b32 s60, s61, s100
    s_or_b32 s61, s61, 0xfff1f9ff
    s_add_u32 s61, s61, 1
    s_and_b32 s61, s61, 0xe0600
    buffer_load_dwordx4 v[64:67], v0, s[32:35], s60 offen nt
    buffer_load_dwordx4 v[68:71], v18, s[32:35], s60 offen nt
    buffer_load_dwordx4 v[72:75], v48, s[32:35], s60 offen nt
    buffer_load_dwordx4 v[76:79], v49, s[32:35], s60 offen nt
    buffer_load_dwordx4 a[0:3], v0, s[36:39], s60 offen nt
    buffer_load_dwordx4 a[4:7], v18, s[36:39], s60 offen nt
    buffer_load_dwordx4 a[8:11], v48, s[36:39], s60 offen nt
    buffer_load_dwordx4 a[12:15], v49, s[36:39], s60 offen nt
    s_waitcnt vmcnt(49)
    s_or_b32 s60, s61, s100
    s_or_b32 s61, s61, 0xfff1f9ff
    s_add_u32 s61, s61, 1
    s_and_b32 s61, s61, 0xe0600
    buffer_load_dwordx4 v[80:83], v0, s[32:35], s60 offen nt
    buffer_load_dwordx4 v[84:87], v18, s[32:35], s60 offen nt
    buffer_load_dwordx4 v[88:91], v48, s[32:35], s60 offen nt
    buffer_load_dwordx4 v[92:95], v49, s[32:35], s60 offen nt
    buffer_load_dwordx4 a[16:19], v0, s[36:39], s60 offen nt
    buffer_load_dwordx4 a[20:23], v18, s[36:39], s60 offen nt
    buffer_load_dwordx4 a[24:27], v48, s[36:39], s60 offen nt
    buffer_load_dwordx4 a[28:31], v49, s[36:39], s60 offen nt
    s_waitcnt vmcnt(24)
L_aq1:
    v_max3_u32 v20, v60, v61, v62
    v_max_u32 v20, v20, v63
    v_cmp_eq_u32 vcc, -1, v20
    s_cbranch_vccz L_aq1_ok
    buffer_load_dwordx4 v[60:63], v59, s[44:47], s56 offen sc1
    s_waitcnt vmcnt(0)
    s_sub_u32 s101, s101, 1
    s_cbranch_scc0 L_aq1
    s_mov_b32 s101, 0
L_aq1_ok:
    v_mov_b32 v4, v60
    v_mov_b32 v5, v61
    v_mov_b32 v6, v62
    v_mov_b32 v7, v63
    s_mov_b32 s56, 1
L_aloop:
    s_waitcnt vmcnt(12)
    v_dot2_f32_bf16 v20, v64, v4, 0
    v_dot2_f32_bf16 v21, v68, v4, 0
    v_dot2_f32_bf16 v22, v72, v4, 0
    v_dot2_f32_bf16 v23, v76, v4, 0
    v_dot2_f32_bf16 v20, v65, v5, v20
    v_dot2_f32_bf16 v21, v69, v5, v21
    v_dot2_f32_bf16 v22, v73, v5, v22
    v_dot2_f32_bf16 v23, v77, v5, v23
    v_dot2_f32_bf16 v20, v66, v6, v20
    v_dot2_f32_bf16 v21, v70, v6, v21
    v_dot2_f32_bf16 v22, v74, v6, v22
    v_dot2_f32_bf16 v23, v78, v6, v23
    v_dot2_f32_bf16 v20, v67, v7, v20
    v_dot2_f32_bf16 v21, v71, v7, v21
    v_dot2_f32_bf16 v22, v75, v7, v22
    v_dot2_f32_bf16 v23, v79, v7, v23
    s_cmp_lg_u32 s18, 0
    s_cbranch_scc1 L_have_2
    s_waitcnt lgkmcnt(0)
    s_mov_b32 s17, s16
    s_mov_b32 s18, 1
    s_min_u32 s54, s16, 68
    s_cselect_b32 s18, 2, s18
    s_mul_i32 s54, s54, 1
    s_add_u32 s17, s17, s54
    s_min_u32 s54, s16, 28
    s_cselect_b32 s18, 4, s18
    s_mul_i32 s54, s54, 2
    s_add_u32 s17, s17, s54
    s_cmp_ge_u32 s17, s19
    s_cbranch_scc1 L_adrain0
    s_add_u32 s54, s17, s99
    s_lshl_b32 s61, s54, 9
    s_and_b32 s61, s61, 0xe00
    s_lshl_b32 s55, s54, 10
    s_and_b32 s55, s55, 0x6000
    s_or_b32 s61, s61, s55
    s_lshl_b32 s55, s54, 12
    s_and_b32 s55, s55, 0xe0000
    s_or_b32 s61, s61, s55
    s_cmp_lt_u32 s17, 256
    s_cselect_b32 s7, s11, 0x8000000
    s_cselect_b32 s18, s18, 9
    s_cselect_b32 s63, 0, 1
    s_mov_b32 s6, 0xe6e00
L_have_2:
    s_or_b32 s60, s61, s7
    buffer_load_dwordx4 v[64:67], v0, s[32:35], s60 offen nt
    buffer_load_dwordx4 v[68:71], v18, s[32:35], s60 offen nt
    buffer_load_dwordx4 v[72:75], v48, s[32:35], s60 offen nt
    buffer_load_dwordx4 v[76:79], v49, s[32:35], s60 offen nt
    s_orn2_b32 s61, s61, s6
    s_add_u32 s61, s61, 1
    s_and_b32 s61, s61, s6
    s_add_u32 s58, s58, 32768
    s_sub_u32 s18, s18, 1
    s_sub_u32 s62, s62, s63
    v_add_f32_dpp v24, v20, v20 row_ror:8 row_mask:0xf bank_mask:0x3
    v_add_f32_dpp v25, v22, v22 row_ror:8 row_mask:0xf bank_mask:0x3
    v_add_f32_dpp v24, v21, v21 row_ror:8 row_mask:0xf bank_mask:0xc
    v_add_f32_dpp v25, v23, v23 row_ror:8 row_mask:0xf bank_mask:0xc
    s_nop 0
    v_add_f32_dpp v26, v24, v24 row_shl:4 row_mask:0xf bank_mask:0x5
    v_add_f32_dpp v26, v25, v25 row_shr:4 row_mask:0xf bank_mask:0xa
    s_nop 1
    v_add_f32_dpp v26, v26, v26 quad_perm:[1,0,3,2] row_mask:0xf bank_mask:0xf
    s_nop 1
    v_add_f32_dpp v26, v26, v26 quad_perm:[2,3,0,1] row_mask:0xf bank_mask:0xf
    v_cvt_pk_bf16_f32 v26, v26, v26
    v_and_b32 v26, s98, v26
    v_mul_f32 v26, s96, v26
    v_cvt_pk_bf16_f32 v26, v26, v26
    v_and_b32 v26, s98, v26
    s_nop 1
    v_max_f32_dpp v27, v26, v26 row_ror:4 row_mask:0xf bank_mask:0xf
    s_nop 1
    v_max_f32_dpp v27, v27, v27 row_ror:8 row_mask:0xf bank_mask:0xf
    v_mov_b32 v28, v27
    s_nop 1
    v_permlane16_swap_b32 v27, v28
    v_max_f32 v27, v27, v28
    v_mov_b32 v28, v27
    s_nop 1
    v_permlane32_swap_b32 v27, v28
    v_max3_f32 v27, v27, v28, v16
    v_sub_f32 v28, v16, v27
    v_sub_f32 v29, v26, v27
    v_mul_f32 v28, s97, v28
    v_mul_f32 v29, s97, v29
    v_exp_f32 v28, v28
    v_exp_f32 v29, v29
    v_mov_b32 v16, v27
    v_fma_f32 v17, v17, v28, v29
    v_cvt_pk_bf16_f32 v29, v29, v29
    v_mul_f32 v12, v12, v28
    v_mul_f32 v13, v13, v28
    v_mul_f32 v14, v14, v28
    v_mul_f32 v15, v15, v28
    s_waitcnt vmcnt(12)
    v_and_b32_dpp v32, v29, v8 row_newbcast:0 row_mask:0xf bank_mask:0xf
    v_and_b32_dpp v33, v29, v9 row_newbcast:0 row_mask:0xf bank_mask:0xf
    v_and_b32_dpp v34, v29, v10 row_newbcast:0 row_mask:0xf bank_mask:0xf
    v_and_b32_dpp v35, v29, v11 row_newbcast:0 row_mask:0xf bank_mask:0xf
    v_and_b32_dpp v36, v29, v8 row_newbcast:8 row_mask:0xf bank_mask:0xf
    v_and_b32_dpp v37, v29, v9 row_newbcast:8 row_mask:0xf bank_mask:0xf
    v_and_b32_dpp v38, v29, v10 row_newbcast:8 row_mask:0xf bank_mask:0xf
    v_and_b32_dpp v39, v29, v11 row_newbcast:8 row_mask:0xf bank_mask:0xf
    v_and_b32_dpp v40, v29, v8 row_newbcast:4 row_mask:0xf bank_mask:0xf
    v_and_b32_dpp v41, v29, v9 row_newbcast:4 row_mask:0xf bank_mask:0xf
    v_and_b32_dpp v42, v29, v10 row_newbcast:4 row_mask:0xf bank_mask:0xf
    v_and_b32_dpp v43, v29, v11 row_newbcast:4 row_mask:0xf bank_mask:0xf
    v_and_b32_dpp v44, v29, v8 row_newbcast:12 row_mask:0xf bank_mask:0xf
    v_and_b32_dpp v45, v29, v9 row_newbcast:12 row_mask:0xf bank_mask:0xf
    v_and_b32_dpp v46, v29, v10 row_newbcast:12 row_mask:0xf bank_mask:0xf
    v_and_b32_dpp v47, v29, v11 row_newbcast:12 row_mask:0xf bank_mask:0xf
    v_mfma_f32_16x16x32_bf16 v[12:15], v[32:35], a[0:3], v[12:15]
    v_mfma_f32_16x16x32_bf16 v[12:15], v[36:39], a[4:7], v[12:15]
    v_mfma_f32_16x16x32_bf16 v[12:15], v[40:43], a[8:11], v[12:15]
    v_mfma_f32_16x16x32_bf16 v[12:15], v[44:47], a[12:15], v[12:15]
    buffer_load_dwordx4 a[0:3], v0, s[36:39], s60 offen nt
    buffer_load_dwordx4 a[4:7], v18, s[36:39], s60 offen nt
    buffer_load_dwordx4 a[8:11], v48, s[36:39], s60 offen nt
    buffer_load_dwordx4 a[12:15], v49, s[36:39], s60 offen nt
    s_cmp_eq_u32 s18, 0
    s_cbranch_scc0 L_notk_3
    s_mov_b32 s16, 1
    s_atomic_add s16, s[30:31], s57 glc
L_notk_3:
    s_cmp_eq_u32 s62, 0
    s_cbranch_scc1 L_adone
    s_cmp_lg_u32 s56, 0
    s_cbranch_scc1 L_aext0
L_aback0:
    s_waitcnt vmcnt(12)
    v_dot2_f32_bf16 v20, v80, v4, 0
    v_dot2_f32_bf16 v21, v84, v4, 0
    v_dot2_f32_bf16 v22, v88, v4, 0
    v_dot2_f32_bf16 v23, v92, v4, 0
    v_dot2_f32_bf16 v20, v81, v5, v20
    v_dot2_f32_bf16 v21, v85, v5, v21
    v_dot2_f32_bf16 v22, v89, v5, v22
    v_dot2_f32_bf16 v23, v93, v5, v23
    v_dot2_f32_bf16 v20, v82, v6, v20
    v_dot2_f32_bf16 v21, v86, v6, v21
    v_dot2_f32_bf16 v22, v90, v6, v22
    v_dot2_f32_bf16 v23, v94, v6, v23
    v_dot2_f32_bf16 v20, v83, v7, v20
    v_dot2_f32_bf16 v21, v87, v7, v21
    v_dot2_f32_bf16 v22, v91, v7, v22
    v_dot2_f32_bf16 v23, v95, v7, v23
    s_cmp_lg_u32 s18, 0
    s_cbranch_scc1 L_have_4
    s_waitcnt lgkmcnt(0)
    s_mov_b32 s17, s16
    s_mov_b32 s18, 1
    s_min_u32 s54, s16, 68
    s_cselect_b32 s18, 2, s18
    s_mul_i32 s54, s54, 1
    s_add_u32 s17, s17, s54
    s_min_u32 s54, s16, 28
    s_cselect_b32 s18, 4, s18
    s_mul_i32 s54, s54, 2
    s_add_u32 s17, s17, s54
    s_cmp_ge_u32 s17, s19
    s_cbranch_scc1 L_adrain1
    s_add_u32 s54, s17, s99
    s_lshl_b32 s61, s54, 9
    s_and_b32 s61, s61, 0xe00
    s_lshl_b32 s55, s54, 10
    s_and_b32 s55, s55, 0x6000
    s_or_b32 s61, s61, s55
    s_lshl_b32 s55, s54, 12
    s_and_b32 s55, s55, 0xe0000
    s_or_b32 s61, s61, s55
    s_cmp_lt_u32 s17, 256
    s_cselect_b32 s7, s11, 0x8000000
    s_cselect_b32 s18, s18, 9
    s_cselect_b32 s63, 0, 1
    s_mov_b32 s6, 0xe6e00
L_have_4:
    s_or_b32 s60, s61, s7
    buffer_load_dwordx4 v[80:83], v0, s[32:35], s60 offen nt
    buffer_load_dwordx4 v[84:87], v18, s[32:35], s60 offen nt
    buffer_load_dwordx4 v[88:91], v48, s[32:35], s60 offen nt
    buffer_load_dwordx4 v[92:95], v49, s[32:35], s60 offen nt
    s_orn2_b32 s61, s61, s6
    s_add_u32 s61, s61, 1
    s_and_b32 s61, s61, s6
    s_add_u32 s58, s58, 32768
    s_sub_u32 s18, s18, 1
    s_sub_u32 s62, s62, s63
    v_add_f32_dpp v24, v20, v20 row_ror:8 row_mask:0xf bank_mask:0x3
    v_add_f32_dpp v25, v22, v22 row_ror:8 row_mask:0xf bank_mask:0x3
    v_add_f32_dpp v24, v21, v21 row_ror:8 row_mask:0xf bank_mask:0xc
    v_add_f32_dpp v25, v23, v23 row_ror:8 row_mask:0xf bank_mask:0xc
    s_nop 0
    v_add_f32_dpp v26, v24, v24 row_shl:4 row_mask:0xf bank_mask:0x5
    v_add_f32_dpp v26, v25, v25 row_shr:4 row_mask:0xf bank_mask:0xa
    s_nop 1
    v_add_f32_dpp v26, v26, v26 quad_perm:[1,0,3,2] row_mask:0xf bank_mask:0xf
    s_nop 1
    v_add_f32_dpp v26, v26, v26 quad_perm:[2,3,0,1] row_mask:0xf bank_mask:0xf
    v_cvt_pk_bf16_f32 v26, v26, v26
    v_and_b32 v26, s98, v26
    v_mul_f32 v26, s96, v26
    v_cvt_pk_bf16_f32 v26, v26, v26
    v_and_b32 v26, s98, v26
    s_nop 1
    v_max_f32_dpp v27, v26, v26 row_ror:4 row_mask:0xf bank_mask:0xf
    s_nop 1
    v_max_f32_dpp v27, v27, v27 row_ror:8 row_mask:0xf bank_mask:0xf
    v_mov_b32 v28, v27
    s_nop 1
    v_permlane16_swap_b32 v27, v28
    v_max_f32 v27, v27, v28
    v_mov_b32 v28, v27
    s_nop 1
    v_permlane32_swap_b32 v27, v28
    v_max3_f32 v27, v27, v28, v16
    v_sub_f32 v28, v16, v27
    v_sub_f32 v29, v26, v27
    v_mul_f32 v28, s97, v28
    v_mul_f32 v29, s97, v29
    v_exp_f32 v28, v28
    v_exp_f32 v29, v29
    v_mov_b32 v16, v27
    v_fma_f32 v17, v17, v28, v29
    v_cvt_pk_bf16_f32 v29, v29, v29
    v_mul_f32 v12, v12, v28
    v_mul_f32 v13, v13, v28
    v_mul_f32 v14, v14, v28
    v_mul_f32 v15, v15, v28
    s_waitcnt vmcnt(12)
    v_and_b32_dpp v32, v29, v8 row_newbcast:0 row_mask:0xf bank_mask:0xf
    v_and_b32_dpp v33, v29, v9 row_newbcast:0 row_mask:0xf bank_mask:0xf
    v_and_b32_dpp v34, v29, v10 row_newbcast:0 row_mask:0xf bank_mask:0xf
    v_and_b32_dpp v35, v29, v11 row_newbcast:0 row_mask:0xf bank_mask:0xf
    v_and_b32_dpp v36, v29, v8 row_newbcast:8 row_mask:0xf bank_mask:0xf
    v_and_b32_dpp v37, v29, v9 row_newbcast:8 row_mask:0xf bank_mask:0xf
    v_and_b32_dpp v38, v29, v10 row_newbcast:8 row_mask:0xf bank_mask:0xf
    v_and_b32_dpp v39, v29, v11 row_newbcast:8 row_mask:0xf bank_mask:0xf
    v_and_b32_dpp v40, v29, v8 row_newbcast:4 row_mask:0xf bank_mask:0xf
    v_and_b32_dpp v41, v29, v9 row_newbcast:4 row_mask:0xf bank_mask:0xf
    v_and_b32_dpp v42, v29, v10 row_newbcast:4 row_mask:0xf bank_mask:0xf
    v_and_b32_dpp v43, v29, v11 row_newbcast:4 row_mask:0xf bank_mask:0xf
    v_and_b32_dpp v44, v29, v8 row_newbcast:12 row_mask:0xf bank_mask:0xf
    v_and_b32_dpp v45, v29, v9 row_newbcast:12 row_mask:0xf bank_mask:0xf
    v_and_b32_dpp v46, v29, v10 row_newbcast:12 row_mask:0xf bank_mask:0xf
    v_and_b32_dpp v47, v29, v11 row_newbcast:12 row_mask:0xf bank_mask:0xf
    v_mfma_f32_16x16x32_bf16 v[12:15], v[32:35], a[16:19], v[12:15]
    v_mfma_f32_16x16x32_bf16 v[12:15], v[36:39], a[20:23], v[12:15]
    v_mfma_f32_16x16x32_bf16 v[12:15], v[40:43], a[24:27], v[12:15]
    v_mfma_f32_16x16x32_bf16 v[12:15], v[44:47], a[28:31], v[12:15]
    buffer_load_dwordx4 a[16:19], v0, s[36:39], s60 offen nt
    buffer_load_dwordx4 a[20:23], v18, s[36:39], s60 offen nt
    buffer_load_dwordx4 a[24:27], v48, s[36:39], s60 offen nt
    buffer_load_dwordx4 a[28:31], v49, s[36:39], s60 offen nt
    s_cmp_eq_u32 s18, 0
    s_cbranch_scc0 L_notk_5
    s_mov_b32 s16, 1
    s_atomic_add s16, s[30:31], s57 glc
L_notk_5:
    s_cmp_eq_u32 s62, 0
    s_cbranch_scc1 L_adone
    s_cmp_lg_u32 s56, 0
    s_cbranch_scc1 L_aext1
L_aback1:
    s_cmp_lg_u32 s58, s14
    s_cbranch_scc1 L_aloop
    s_cmp_eq_u32 s14, s15
    s_cbranch_scc1 L_aswitch
    buffer_load_dwordx4 v[60:63], v59, s[44:47], s12 offen sc1
    s_mov_b32 s14, s15
    s_branch L_aloop
L_aswitch:
    s_nop 11
    v_add_f32_dpp v17, v17, v17 row_ror:4 row_mask:0xf bank_mask:0xf
    s_nop 1
    v_add_f32_dpp v17, v17, v17 row_ror:8 row_mask:0xf bank_mask:0xf
    v_mov_b32 v28, v17
    s_nop 1
    v_permlane16_swap_b32 v17, v28
    v_add_f32 v17, v17, v28
    v_mov_b32 v28, v17
    s_nop 1
    v_permlane32_swap_b32 v17, v28
    v_add_f32 v51, v17, v28
    v_mov_b32 v50, v16
    v_cvt_pk_bf16_f32 v52, v12, v13
    v_cvt_pk_bf16_f32 v53, v14, v15
    v_mov_b32 v12, 0
    v_mov_b32 v13, 0
    v_mov_b32 v14, 0
    v_mov_b32 v15, 0
    v_mov_b32 v16, 0xff800000
    v_mov_b32 v17, 0
    s_mov_b32 s13, 1
    s_cmp_eq_u32 s62, 0
    s_cbranch_scc1 L_adone
L_aq2:
    v_max3_u32 v20, v60, v61, v62
    v_max_u32 v20, v20, v63
    v_cmp_eq_u32 vcc, -1, v20
    s_cbranch_vccz L_aq2_ok
    buffer_load_dwordx4 v[60:63], v59, s[44:47], s12 offen sc1
    s_waitcnt vmcnt(0)
    s_sub_u32 s101, s101, 1
    s_cbranch_scc0 L_aq2
    s_mov_b32 s101, 0
L_aq2_ok:
    v_mov_b32 v4, v60
    v_mov_b32 v5, v61
    v_mov_b32 v6, v62
    v_mov_b32 v7, v63
    s_cmp_lg_u32 s62, 3
    s_cbranch_scc1 L_aloop
    s_branch L_alast0
L_adrain1:
    buffer_load_dwordx4 v[128:131], v19, s[40:43], s24 offen offset:0 nt
    buffer_load_dwordx4 v[132:135], v19, s[40:43], s24 offen offset:1152 nt
    buffer_load_dwordx4 v[136:139], v19, s[40:43], s24 offen offset:2304 nt
    buffer_load_dwordx4 v[140:143], v19, s[40:43], s24 offen offset:3456 nt
    s_add_u32 s24, s24, 4608
    buffer_load_dwordx4 v[144:147], v19, s[40:43], s24 offen offset:0 nt
    buffer_load_dwordx4 v[148:151], v19, s[40:43], s24 offen offset:1152 nt
    buffer_load_dwordx4 v[152:155], v19, s[40:43], s24 offen offset:2304 nt
    buffer_load_dwordx4 v[156:159], v19, s[40:43], s24 offen offset:3456 nt
    s_add_u32 s24, s24, 69120
    v_add_f32_dpp v24, v20, v20 row_ror:8 row_mask:0xf bank_mask:0x3
    v_add_f32_dpp v25, v22, v22 row_ror:8 row_mask:0xf bank_mask:0x3
    v_add_f32_dpp v24, v21, v21 row_ror:8 row_mask:0xf bank_mask:0xc
    v_add_f32_dpp v25, v23, v23 row_ror:8 row_mask:0xf bank_mask:0xc
    s_nop 0
    v_add_f32_dpp v26, v24, v24 row_shl:4 row_mask:0xf bank_mask:0x5
    v_add_f32_dpp v26, v25, v25 row_shr:4 row_mask:0xf bank_mask:0xa
    s_nop 1
    v_add_f32_dpp v26, v26, v26 quad_perm:[1,0,3,2] row_mask:0xf bank_mask:0xf
    s_nop 1
    v_add_f32_dpp v26, v26, v26 quad_perm:[2,3,0,1] row_mask:0xf bank_mask:0xf
    v_cvt_pk_bf16_f32 v26, v26, v26
    v_and_b32 v26, s98, v26
    v_mul_f32 v26, s96, v26
    v_cvt_pk_bf16_f32 v26, v26, v26
    v_and_b32 v26, s98, v26
    s_nop 1
    v_max_f32_dpp v27, v26, v26 row_ror:4 row_mask:0xf bank_mask:0xf
    s_nop 1
    v_max_f32_dpp v27, v27, v27 row_ror:8 row_mask:0xf bank_mask:0xf
    v_mov_b32 v28, v27
    s_nop 1
    v_permlane16_swap_b32 v27, v28
    v_max_f32 v27, v27, v28
    v_mov_b32 v28, v27
    s_nop 1
    v_permlane32_swap_b32 v27, v28
    v_max3_f32 v27, v27, v28, v16
    v_sub_f32 v28, v16, v27
    v_sub_f32 v29, v26, v27
    v_mul_f32 v28, s97, v28
    v_mul_f32 v29, s97, v29
    v_exp_f32 v28, v28
    v_exp_f32 v29, v29
    v_mov_b32 v16, v27
    v_fma_f32 v17, v17, v28, v29
    v_cvt_pk_bf16_f32 v29, v29, v29
    v_mul_f32 v12, v12, v28
    v_mul_f32 v13, v13, v28
    v_mul_f32 v14, v14, v28
    v_mul_f32 v15, v15, v28
    s_waitcnt vmcnt(16)
    v_and_b32_dpp v32, v29, v8 row_newbcast:0 row_mask:0xf bank_mask:0xf
    v_and_b32_dpp v33, v29, v9 row_newbcast:0 row_mask:0xf bank_mask:0xf
    v_and_b32_dpp v34, v29, v10 row_newbcast:0 row_mask:0xf bank_mask:0xf
    v_and_b32_dpp v35, v29, v11 row_newbcast:0 row_mask:0xf bank_mask:0xf
    v_and_b32_dpp v36, v29, v8 row_newbcast:8 row_mask:0xf bank_mask:0xf
    v_and_b32_dpp v37, v29, v9 row_newbcast:8 row_mask:0xf bank_mask:0xf
    v_and_b32_dpp v38, v29, v10 row_newbcast:8 row_mask:0xf bank_mask:0xf
    v_and_b32_dpp v39, v29, v11 row_newbcast:8 row_mask:0xf bank_mask:0xf
    v_and_b32_dpp v40, v29, v8 row_newbcast:4 row_mask:0xf bank_mask:0xf
    v_and_b32_dpp v41, v29, v9 row_newbcast:4 row_mask:0xf bank_mask:0xf
    v_and_b32_dpp v42, v29, v10 row_newbcast:4 row_mask:0xf bank_mask:0xf
    v_and_b32_dpp v43, v29, v11 row_newbcast:4 row_mask:0xf bank_mask:0xf
    v_and_b32_dpp v44, v29, v8 row_newbcast:12 row_mask:0xf bank_mask:0xf
    v_and_b32_dpp v45, v29, v9 row_newbcast:12 row_mask:0xf bank_mask:0xf
    v_and_b32_dpp v46, v29, v10 row_newbcast:12 row_mask:0xf bank_mask:0xf
    v_and_b32_dpp v47, v29, v11 row_newbcast:12 row_mask:0xf bank_mask:0xf
    v_mfma_f32_16x16x32_bf16 v[12:15], v[32:35], a[16:19], v[12:15]
    v_mfma_f32_16x16x32_bf16 v[12:15], v[36:39], a[20:23], v[12:15]
    v_mfma_f32_16x16x32_bf16 v[12:15], v[40:43], a[24:27], v[12:15]
    v_mfma_f32_16x16x32_bf16 v[12:15], v[44:47], a[28:31], v[12:15]
    s_mov_b32 s62, 3
    s_cmp_eq_u32 s13, 0
    s_cbranch_scc1 L_aswitch
L_alast0:
    s_waitcnt vmcnt(12)
    v_dot2_f32_bf16 v20, v64, v4, 0
    v_dot2_f32_bf16 v21, v68, v4, 0
    v_dot2_f32_bf16 v22, v72, v4, 0
    v_dot2_f32_bf16 v23, v76, v4, 0
    v_dot2_f32_bf16 v20, v65, v5, v20
    v_dot2_f32_bf16 v21, v69, v5, v21
    v_dot2_f32_bf16 v22, v73, v5, v22
    v_dot2_f32_bf16 v23, v77, v5, v23
    v_dot2_f32_bf16 v20, v66, v6, v20
    v_dot2_f32_bf16 v21, v70, v6, v21
    v_dot2_f32_bf16 v22, v74, v6, v22
    v_dot2_f32_bf16 v23, v78, v6, v23
    v_dot2_f32_bf16 v20, v67, v7, v20
    v_dot2_f32_bf16 v21, v71, v7, v21
    v_dot2_f32_bf16 v22, v75, v7, v22
    v_dot2_f32_bf16 v23, v79, v7, v23
    buffer_load_dwordx4 v[160:163], v19, s[40:43], s24 offen offset:0 nt
    buffer_load_dwordx4 v[164:167], v19, s[40:43], s24 offen offset:1152 nt
    buffer_load_dwordx4 v[168:171], v19, s[40:43], s24 offen offset:2304 nt
    buffer_load_dwordx4 v[172:175], v19, s[40:43], s24 offen offset:3456 nt
    s_add_u32 s24, s24, 4608
    buffer_load_dwordx4 v[176:179], v19, s[40:43], s24 offen offset:0 nt
    buffer_load_dwordx4 v[180:183], v19, s[40:43], s24 offen offset:1152 nt
    buffer_load_dwordx4 v[184:187], v19, s[40:43], s24 offen offset:2304 nt
    buffer_load_dwordx4 v[188:191], v19, s[40:43], s24 offen offset:3456 nt
    v_add_f32_dpp v24, v20, v20 row_ror:8 row_mask:0xf bank_mask:0x3
    v_add_f32_dpp v25, v22, v22 row_ror:8 row_mask:0xf bank_mask:0x3
    v_add_f32_dpp v24, v21, v21 row_ror:8 row_mask:0xf bank_mask:0xc
    v_add_f32_dpp v25, v23, v23 row_ror:8 row_mask:0xf bank_mask:0xc
    s_nop 0
    v_add_f32_dpp v26, v24, v24 row_shl:4 row_mask:0xf bank_mask:0x5
    v_add_f32_dpp v26, v25, v25 row_shr:4 row_mask:0xf bank_mask:0xa
    s_nop 1
    v_add_f32_dpp v26, v26, v26 quad_perm:[1,0,3,2] row_mask:0xf bank_mask:0xf
    s_nop 1
    v_add_f32_dpp v26, v26, v26 quad_perm:[2,3,0,1] row_mask:0xf bank_mask:0xf
    v_cvt_pk_bf16_f32 v26, v26, v26
    v_and_b32 v26, s98, v26
    v_mul_f32 v26, s96, v26
    v_cvt_pk_bf16_f32 v26, v26, v26
    v_and_b32 v26, s98, v26
    s_nop 1
    v_max_f32_dpp v27, v26, v26 row_ror:4 row_mask:0xf bank_mask:0xf
    s_nop 1
    v_max_f32_dpp v27, v27, v27 row_ror:8 row_mask:0xf bank_mask:0xf
    v_mov_b32 v28, v27
    s_nop 1
    v_permlane16_swap_b32 v27, v28
    v_max_f32 v27, v27, v28
    v_mov_b32 v28, v27
    s_nop 1
    v_permlane32_swap_b32 v27, v28
    v_max3_f32 v27, v27, v28, v16
    v_sub_f32 v28, v16, v27
    v_sub_f32 v29, v26, v27
    v_mul_f32 v28, s97, v28
    v_mul_f32 v29, s97, v29
    v_exp_f32 v28, v28
    v_exp_f32 v29, v29
    v_mov_b32 v16, v27
    v_fma_f32 v17, v17, v28, v29
    v_cvt_pk_bf16_f32 v29, v29, v29
    v_mul_f32 v12, v12, v28
    v_mul_f32 v13, v13, v28
    v_mul_f32 v14, v14, v28
    v_mul_f32 v15, v15, v28
    s_waitcnt vmcnt(16)
    v_and_b32_dpp v32, v29, v8 row_newbcast:0 row_mask:0xf bank_mask:0xf
    v_and_b32_dpp v33, v29, v9 row_newbcast:0 row_mask:0xf bank_mask:0xf
    v_and_b32_dpp v34, v29, v10 row_newbcast:0 row_mask:0xf bank_mask:0xf
    v_and_b32_dpp v35, v29, v11 row_newbcast:0 row_mask:0xf bank_mask:0xf
    v_and_b32_dpp v36, v29, v8 row_newbcast:8 row_mask:0xf bank_mask:0xf
    v_and_b32_dpp v37, v29, v9 row_newbcast:8 row_mask:0xf bank_mask:0xf
    v_and_b32_dpp v38, v29, v10 row_newbcast:8 row_mask:0xf bank_mask:0xf
    v_and_b32_dpp v39, v29, v11 row_newbcast:8 row_mask:0xf bank_mask:0xf
    v_and_b32_dpp v40, v29, v8 row_newbcast:4 row_mask:0xf bank_mask:0xf
    v_and_b32_dpp v41, v29, v9 row_newbcast:4 row_mask:0xf bank_mask:0xf
    v_and_b32_dpp v42, v29, v10 row_newbcast:4 row_mask:0xf bank_mask:0xf
    v_and_b32_dpp v43, v29, v11 row_newbcast:4 row_mask:0xf bank_mask:0xf
    v_and_b32_dpp v44, v29, v8 row_newbcast:12 row_mask:0xf bank_mask:0xf
    v_and_b32_dpp v45, v29, v9 row_newbcast:12 row_mask:0xf bank_mask:0xf
    v_and_b32_dpp v46, v29, v10 row_newbcast:12 row_mask:0xf bank_mask:0xf
    v_and_b32_dpp v47, v29, v11 row_newbcast:12 row_mask:0xf bank_mask:0xf
    v_mfma_f32_16x16x32_bf16 v[12:15], v[32:35], a[0:3], v[12:15]
    v_mfma_f32_16x16x32_bf16 v[12:15], v[36:39], a[4:7], v[12:15]
    v_mfma_f32_16x16x32_bf16 v[12:15], v[40:43], a[8:11], v[12:15]
    v_mfma_f32_16x16x32_bf16 v[12:15], v[44:47], a[12:15], v[12:15]
    s_nop 3
    s_branch L_adone2
L_adrain0:
    buffer_load_dwordx4 v[128:131], v19, s[40:43], s24 offen offset:0 nt
    buffer_load_dwordx4 v[132:135], v19, s[40:43], s24 offen offset:1152 nt
    buffer_load_dwordx4 v[136:139], v19, s[40:43], s24 offen offset:2304 nt
    buffer_load_dwordx4 v[140:143], v19, s[40:43], s24 offen offset:3456 nt
    s_add_u32 s24, s24, 4608
    buffer_load_dwordx4 v[144:147], v19, s[40:43], s24 offen offset:0 nt
    buffer_load_dwordx4 v[148:151], v19, s[40:43], s24 offen offset:1152 nt
    buffer_load_dwordx4 v[152:155], v19, s[40:43], s24 offen offset:2304 nt
    buffer_load_dwordx4 v[156:159], v19, s[40:43], s24 offen offset:3456 nt
    s_add_u32 s24, s24, 69120
    v_add_f32_dpp v24, v20, v20 row_ror:8 row_mask:0xf bank_mask:0x3
    v_add_f32_dpp v25, v22, v22 row_ror:8 row_mask:0xf bank_mask:0x3
    v_add_f32_dpp v24, v21, v21 row_ror:8 row_mask:0xf bank_mask:0xc
    v_add_f32_dpp v25, v23, v23 row_ror:8 row_mask:0xf bank_mask:0xc
    s_nop 0
    v_add_f32_dpp v26, v24, v24 row_shl:4 row_mask:0xf bank_mask:0x5
    v_add_f32_dpp v26, v25, v25 row_shr:4 row_mask:0xf bank_mask:0xa
    s_nop 1
    v_add_f32_dpp v26, v26, v26 quad_perm:[1,0,3,2] row_mask:0xf bank_mask:0xf
    s_nop 1
    v_add_f32_dpp v26, v26, v26 quad_perm:[2,3,0,1] row_mask:0xf bank_mask:0xf
    v_cvt_pk_bf16_f32 v26, v26, v26
    v_and_b32 v26, s98, v26
    v_mul_f32 v26, s96, v26
    v_cvt_pk_bf16_f32 v26, v26, v26
    v_and_b32 v26, s98, v26
    s_nop 1
    v_max_f32_dpp v27, v26, v26 row_ror:4 row_mask:0xf bank_mask:0xf
    s_nop 1
    v_max_f32_dpp v27, v27, v27 row_ror:8 row_mask:0xf bank_mask:0xf
    v_mov_b32 v28, v27
    s_nop 1
    v_permlane16_swap_b32 v27, v28
    v_max_f32 v27, v27, v28
    v_mov_b32 v28, v27
    s_nop 1
    v_permlane32_swap_b32 v27, v28
    v_max3_f32 v27, v27, v28, v16
    v_sub_f32 v28, v16, v27
    v_sub_f32 v29, v26, v27
    v_mul_f32 v28, s97, v28
    v_mul_f32 v29, s97, v29
    v_exp_f32 v28, v28
    v_exp_f32 v29, v29
    v_mov_b32 v16, v27
    v_fma_f32 v17, v17, v28, v29
    v_cvt_pk_bf16_f32 v29, v29, v29
    v_mul_f32 v12, v12, v28
    v_mul_f32 v13, v13, v28
    v_mul_f32 v14, v14, v28
    v_mul_f32 v15, v15, v28
    s_waitcnt vmcnt(16)
    v_and_b32_dpp v32, v29, v8 row_newbcast:0 row_mask:0xf bank_mask:0xf
    v_and_b32_dpp v33, v29, v9 row_newbcast:0 row_mask:0xf bank_mask:0xf
    v_and_b32_dpp v34, v29, v10 row_newbcast:0 row_mask:0xf bank_mask:0xf
    v_and_b32_dpp v35, v29, v11 row_newbcast:0 row_mask:0xf bank_mask:0xf
    v_and_b32_dpp v36, v29, v8 row_newbcast:8 row_mask:0xf bank_mask:0xf
    v_and_b32_dpp v37, v29, v9 row_newbcast:8 row_mask:0xf bank_mask:0xf
    v_and_b32_dpp v38, v29, v10 row_newbcast:8 row_mask:0xf bank_mask:0xf
    v_and_b32_dpp v39, v29, v11 row_newbcast:8 row_mask:0xf bank_mask:0xf
    v_and_b32_dpp v40, v29, v8 row_newbcast:4 row_mask:0xf bank_mask:0xf
    v_and_b32_dpp v41, v29, v9 row_newbcast:4 row_mask:0xf bank_mask:0xf
    v_and_b32_dpp v42, v29, v10 row_newbcast:4 row_mask:0xf bank_mask:0xf
    v_and_b32_dpp v43, v29, v11 row_newbcast:4 row_mask:0xf bank_mask:0xf
    v_and_b32_dpp v44, v29, v8 row_newbcast:12 row_mask:0xf bank_mask:0xf
    v_and_b32_dpp v45, v29, v9 row_newbcast:12 row_mask:0xf bank_mask:0xf
    v_and_b32_dpp v46, v29, v10 row_newbcast:12 row_mask:0xf bank_mask:0xf
    v_and_b32_dpp v47, v29, v11 row_newbcast:12 row_mask:0xf bank_mask:0xf
    v_mfma_f32_16x16x32_bf16 v[12:15], v[32:35], a[0:3], v[12:15]
    v_mfma_f32_16x16x32_bf16 v[12:15], v[36:39], a[4:7], v[12:15]
    v_mfma_f32_16x16x32_bf16 v[12:15], v[40:43], a[8:11], v[12:15]
    v_mfma_f32_16x16x32_bf16 v[12:15], v[44:47], a[12:15], v[12:15]
    s_waitcnt vmcnt(12)
    v_dot2_f32_bf16 v20, v80, v4, 0
    v_dot2_f32_bf16 v21, v84, v4, 0
    v_dot2_f32_bf16 v22, v88, v4, 0
    v_dot2_f32_bf16 v23, v92, v4, 0
    v_dot2_f32_bf16 v20, v81, v5, v20
    v_dot2_f32_bf16 v21, v85, v5, v21
    v_dot2_f32_bf16 v22, v89, v5, v22
    v_dot2_f32_bf16 v23, v93, v5, v23
    v_dot2_f32_bf16 v20, v82, v6, v20
    v_dot2_f32_bf16 v21, v86, v6, v21
    v_dot2_f32_bf16 v22, v90, v6, v22
    v_dot2_f32_bf16 v23, v94, v6, v23
    v_dot2_f32_bf16 v20, v83, v7, v20
    v_dot2_f32_bf16 v21, v87, v7, v21
    v_dot2_f32_bf16 v22, v91, v7, v22
    v_dot2_f32_bf16 v23, v95, v7, v23
    buffer_load_dwordx4 v[160:163], v19, s[40:43], s24 offen offset:0 nt
    buffer_load_dwordx4 v[164:167], v19, s[40:43], s24 offen offset:1152 nt
    buffer_load_dwordx4 v[168:171], v19, s[40:43], s24 offen offset:2304 nt
    buffer_load_dwordx4 v[172:175], v19, s[40:43], s24 offen offset:3456 nt
    s_add_u32 s24, s24, 4608
    buffer_load_dwordx4 v[176:179], v19, s[40:43], s24 offen offset:0 nt
    buffer_load_dwordx4 v[180:183], v19, s[40:43], s24 offen offset:1152 nt
    buffer_load_dwordx4 v[184:187], v19, s[40:43], s24 offen offset:2304 nt
    buffer_load_dwordx4 v[188:191], v19, s[40:43], s24 offen offset:3456 nt
    v_add_f32_dpp v24, v20, v20 row_ror:8 row_mask:0xf bank_mask:0x3
    v_add_f32_dpp v25, v22, v22 row_ror:8 row_mask:0xf bank_mask:0x3
    v_add_f32_dpp v24, v21, v21 row_ror:8 row_mask:0xf bank_mask:0xc
    v_add_f32_dpp v25, v23, v23 row_ror:8 row_mask:0xf bank_mask:0xc
    s_nop 0
    v_add_f32_dpp v26, v24, v24 row_shl:4 row_mask:0xf bank_mask:0x5
    v_add_f32_dpp v26, v25, v25 row_shr:4 row_mask:0xf bank_mask:0xa
    s_nop 1
    v_add_f32_dpp v26, v26, v26 quad_perm:[1,0,3,2] row_mask:0xf bank_mask:0xf
    s_nop 1
    v_add_f32_dpp v26, v26, v26 quad_perm:[2,3,0,1] row_mask:0xf bank_mask:0xf
    v_cvt_pk_bf16_f32 v26, v26, v26
    v_and_b32 v26, s98, v26
    v_mul_f32 v26, s96, v26
    v_cvt_pk_bf16_f32 v26, v26, v26
    v_and_b32 v26, s98, v26
    s_nop 1
    v_max_f32_dpp v27, v26, v26 row_ror:4 row_mask:0xf bank_mask:0xf
    s_nop 1
    v_max_f32_dpp v27, v27, v27 row_ror:8 row_mask:0xf bank_mask:0xf
    v_mov_b32 v28, v27
    s_nop 1
    v_permlane16_swap_b32 v27, v28
    v_max_f32 v27, v27, v28
    v_mov_b32 v28, v27
    s_nop 1
    v_permlane32_swap_b32 v27, v28
    v_max3_f32 v27, v27, v28, v16
    v_sub_f32 v28, v16, v27
    v_sub_f32 v29, v26, v27
    v_mul_f32 v28, s97, v28
    v_mul_f32 v29, s97, v29
    v_exp_f32 v28, v28
    v_exp_f32 v29, v29
    v_mov_b32 v16, v27
    v_fma_f32 v17, v17, v28, v29
    v_cvt_pk_bf16_f32 v29, v29, v29
    v_mul_f32 v12, v12, v28
    v_mul_f32 v13, v13, v28
    v_mul_f32 v14, v14, v28
    v_mul_f32 v15, v15, v28
    s_waitcnt vmcnt(16)
    v_and_b32_dpp v32, v29, v8 row_newbcast:0 row_mask:0xf bank_mask:0xf
    v_and_b32_dpp v33, v29, v9 row_newbcast:0 row_mask:0xf bank_mask:0xf
    v_and_b32_dpp v34, v29, v10 row_newbcast:0 row_mask:0xf bank_mask:0xf
    v_and_b32_dpp v35, v29, v11 row_newbcast:0 row_mask:0xf bank_mask:0xf
    v_and_b32_dpp v36, v29, v8 row_newbcast:8 row_mask:0xf bank_mask:0xf
    v_and_b32_dpp v37, v29, v9 row_newbcast:8 row_mask:0xf bank_mask:0xf
    v_and_b32_dpp v38, v29, v10 row_newbcast:8 row_mask:0xf bank_mask:0xf
    v_and_b32_dpp v39, v29, v11 row_newbcast:8 row_mask:0xf bank_mask:0xf
    v_and_b32_dpp v40, v29, v8 row_newbcast:4 row_mask:0xf bank_mask:0xf
    v_and_b32_dpp v41, v29, v9 row_newbcast:4 row_mask:0xf bank_mask:0xf
    v_and_b32_dpp v42, v29, v10 row_newbcast:4 row_mask:0xf bank_mask:0xf
    v_and_b32_dpp v43, v29, v11 row_newbcast:4 row_mask:0xf bank_mask:0xf
    v_and_b32_dpp v44, v29, v8 row_newbcast:12 row_mask:0xf bank_mask:0xf
    v_and_b32_dpp v45, v29, v9 row_newbcast:12 row_mask:0xf bank_mask:0xf
    v_and_b32_dpp v46, v29, v10 row_newbcast:12 row_mask:0xf bank_mask:0xf
    v_and_b32_dpp v47, v29, v11 row_newbcast:12 row_mask:0xf bank_mask:0xf
    v_mfma_f32_16x16x32_bf16 v[12:15], v[32:35], a[16:19], v[12:15]
    v_mfma_f32_16x16x32_bf16 v[12:15], v[36:39], a[20:23], v[12:15]
    v_mfma_f32_16x16x32_bf16 v[12:15], v[40:43], a[24:27], v[12:15]
    v_mfma_f32_16x16x32_bf16 v[12:15], v[44:47], a[28:31], v[12:15]
    s_mov_b32 s62, 0
L_adone:
    s_cmp_eq_u32 s13, 0
    s_cbranch_scc1 L_aswitch
L_adone2:
    v_add_f32_dpp v17, v17, v17 row_ror:4 row_mask:0xf bank_mask:0xf
    s_nop 1
    v_add_f32_dpp v17, v17, v17 row_ror:8 row_mask:0xf bank_mask:0xf
    v_mov_b32 v28, v17
    s_nop 1
    v_permlane16_swap_b32 v17, v28
    v_add_f32 v17, v17, v28
    v_mov_b32 v28, v17
    s_nop 1
    v_permlane32_swap_b32 v17, v28
    v_add_f32 v17, v17, v28
    v_cvt_pk_bf16_f32 v54, v12, v13
    v_cvt_pk_bf16_f32 v55, v14, v15
    v_cmp_gt_u32 vcc, 48, v1
    s_nop 1
    v_cndmask_b32 v16, v16, v50, vcc
    v_cndmask_b32 v17, v17, v51, vcc
    v_permlane16_swap_b32 v52, v54
    v_permlane16_swap_b32 v53, v55
    v_cmp_gt_u32 vcc, 32, v1
    s_nop 1
    v_cndmask_b32 v52, v16, v52, vcc
    v_cndmask_b32 v53, v17, v53, vcc
    v_cndmask_b32 v54, v16, v54, vcc
    v_cndmask_b32 v55, v17, v55, vcc
    v_min_u32 v52, -2, v52
    v_min_u32 v53, -2, v53
    v_min_u32 v54, -2, v54
    v_min_u32 v55, -2, v55
    s_mov_b32 s54, 8388608
    buffer_store_dwordx4 v[52:55], v3, s[44:47], s54 offen sc1
    s_barrier
    s_mov_b32 s58, s22
    s_add_u32 s59, s22, 4096
    s_cmp_eq_u32 s23, 2
    s_cbranch_scc1 L_eshared
    s_cmp_lg_u32 s23, 0
    s_cbranch_scc1 L_epiB
    buffer_load_dwordx4 v[40:43], v30, s[44:47], s58 offen sc1
    buffer_load_dwordx4 v[192:195], v2, s[44:47], s58 offen offset:0 sc1
    buffer_load_dwordx4 v[196:199], v2, s[44:47], s58 offen offset:1024 sc1
    v_and_b32 v3, 15, v1
    v_lshrrev_b32 v4, 4, v1
    s_mov_b32 s60, 0x05040100
    s_mov_b32 s61, 0x07060302
    v_mul_u32_u24 v0, 73728, v4
    v_bfe_u32 v5, v1, 2, 1
    v_lshl_add_u32 v0, v5, 12, v0
    v_and_b32 v5, 3, v1
    v_lshl_add_u32 v0, v5, 5, v0
    v_bfe_u32 v5, v1, 3, 1
    v_lshl_add_u32 v0, v5, 4, v0
    s_lshl_b32 s54, s3, 9
    v_lshl_add_u32 v5, v3, 4, s54
    v_and_b32 v6, 1, v4
    v_lshl_add_u32 v5, v6, 3, v5
    v_lshrrev_b32 v6, 1, v4
    v_lshl_add_u32 v5, v6, 8, v5
    v_lshrrev_b32 v7, 2, v3
    v_lshlrev_b32 v7, 9, v7
    v_lshl_add_u32 v7, v4, 4, v7
    v_and_b32 v6, 1, v1
    v_lshl_add_u32 v7, v6, 6, v7
    v_and_b32 v6, 1, v3
    v_cmp_gt_u32 s[20:21], 2, v6
    s_waitcnt vmcnt(17)
    v_perm_b32 v64, v132, v128, s60
    v_perm_b32 v68, v132, v128, s61
    v_perm_b32 v72, v133, v129, s60
    v_perm_b32 v76, v133, v129, s61
    v_perm_b32 v80, v134, v130, s60
    v_perm_b32 v84, v134, v130, s61
    v_perm_b32 v88, v135, v131, s60
    v_perm_b32 v92, v135, v131, s61
    s_waitcnt vmcnt(15)
    v_perm_b32 v65, v140, v136, s60
    v_perm_b32 v69, v140, v136, s61
    v_perm_b32 v73, v141, v137, s60
    v_perm_b32 v77, v141, v137, s61
    v_perm_b32 v81, v142, v138, s60
    v_perm_b32 v85, v142, v138, s61
    v_perm_b32 v89, v143, v139, s60
    v_perm_b32 v93, v143, v139, s61
    s_waitcnt vmcnt(13)
    v_perm_b32 v66, v148, v144, s60
    v_perm_b32 v70, v148, v144, s61
    v_perm_b32 v74, v149, v145, s60
    v_perm_b32 v78, v149, v145, s61
    v_perm_b32 v82, v150, v146, s60
    v_perm_b32 v86, v150, v146, s61
    v_perm_b32 v90, v151, v147, s60
    v_perm_b32 v94, v151, v147, s61
    s_waitcnt vmcnt(11)
    v_perm_b32 v67, v156, v152, s60
    v_perm_b32 v71, v156, v152, s61
    v_perm_b32 v75, v157, v153, s60
    v_perm_b32 v79, v157, v153, s61
    v_perm_b32 v83, v158, v154, s60
    v_perm_b32 v87, v158, v154, s61
    v_perm_b32 v91, v159, v155, s60
    v_perm_b32 v95, v159, v155, s61
    s_waitcnt vmcnt(9)
    v_perm_b32 v96, v164, v160, s60
    v_perm_b32 v100, v164, v160, s61
    v_perm_b32 v104, v165, v161, s60
    v_perm_b32 v108, v165, v161, s61
    v_perm_b32 v112, v166, v162, s60
    v_perm_b32 v116, v166, v162, s61
    v_perm_b32 v120, v167, v163, s60
    v_perm_b32 v124, v167, v163, s61
    s_waitcnt vmcnt(7)
    v_perm_b32 v97, v172, v168, s60
    v_perm_b32 v101, v172, v168, s61
    v_perm_b32 v105, v173, v169, s60
    v_perm_b32 v109, v173, v169, s61
    v_perm_b32 v113, v174, v170, s60
    v_perm_b32 v117, v174, v170, s61
    v_perm_b32 v121, v175, v171, s60
    v_perm_b32 v125, v175, v171, s61
    s_waitcnt vmcnt(5)
    v_perm_b32 v98, v180, v176, s60
    v_perm_b32 v102, v180, v176, s61
    v_perm_b32 v106, v181, v177, s60
    v_perm_b32 v110, v181, v177, s61
    v_perm_b32 v114, v182, v178, s60
    v_perm_b32 v118, v182, v178, s61
    v_perm_b32 v122, v183, v179, s60
    v_perm_b32 v126, v183, v179, s61
    s_waitcnt vmcnt(3)
    v_perm_b32 v99, v188, v184, s60
    v_perm_b32 v103, v188, v184, s61
    v_perm_b32 v107, v189, v185, s60
    v_perm_b32 v111, v189, v185, s61
    v_perm_b32 v115, v190, v186, s60
    v_perm_b32 v119, v190, v186, s61
    v_perm_b32 v123, v191, v187, s60
    v_perm_b32 v127, v191, v187, s61
    s_waitcnt vmcnt(0)
    s_branch L_mpoll_8_c
L_mpoll_8:
    s_mov_b64 exec, s[4:5]
    buffer_load_dwordx4 v[40:43], v30, s[44:47], s58 offen sc1
    s_mov_b64 exec, s[6:7]
    buffer_load_dwordx4 v[192:195], v2, s[44:47], s58 offen offset:0 sc1
    s_mov_b64 exec, s[8:9]
    buffer_load_dwordx4 v[196:199], v2, s[44:47], s58 offen offset:1024 sc1
    s_mov_b64 exec, -1
    s_waitcnt vmcnt(3)
L_mpoll_8_c:
    v_max3_u32 v236, v40, v41, v42
    v_max3_u32 v237, v192, v193, v194
    v_max3_u32 v238, v196, v197, v198
    v_max_u32 v236, v236, v43
    v_max_u32 v237, v237, v195
    v_max_u32 v238, v238, v199
    v_cmp_eq_u32 s[4:5], -1, v236
    v_cmp_eq_u32 s[6:7], -1, v237
    v_cmp_eq_u32 s[8:9], -1, v238
    s_or_b64 vcc, s[4:5], s[6:7]
    s_or_b64 vcc, vcc, s[8:9]
    s_cbranch_scc0 L_mpollok_9
    s_sub_u32 s101, s101, 1
    s_cbranch_scc0 L_mpoll_8
    s_mov_b32 s101, 0
L_mpollok_9:
    v_max_f32_dpp v44, v40, v40 row_ror:1 row_mask:0xf bank_mask:0xf
    v_cndmask_b32 v47, 0, v41, s[20:21]
    v_mov_b32 v45, v44
    s_nop 1
    v_permlane16_swap_b32 v44, v45
    v_max_f32 v44, v44, v45
    v_mov_b32 v45, v44
    s_nop 1
    v_permlane32_swap_b32 v44, v45
    v_max_f32 v44, v44, v45
    v_sub_f32 v45, v40, v44
    v_mul_f32 v45, s97, v45
    v_exp_f32 v45, v45
    s_nop 0
    v_cvt_pk_bf16_f32 v46, v45, v45
    v_and_b32 v45, s98, v46
    v_mul_f32 v47, v47, v45
    v_and_b32_dpp v232, v46, v8 row_newbcast:0 row_mask:0xf bank_mask:0xf
    v_and_b32_dpp v233, v46, v9 row_newbcast:0 row_mask:0xf bank_mask:0xf
    v_add_f32_dpp v47, v47, v47 row_ror:1 row_mask:0xf bank_mask:0xf
    v_and_b32_dpp v234, v46, v10 row_newbcast:0 row_mask:0xf bank_mask:0xf
    v_and_b32_dpp v235, v46, v11 row_newbcast:0 row_mask:0xf bank_mask:0xf
    v_and_b32_dpp v236, v46, v8 row_newbcast:1 row_mask:0xf bank_mask:0xf
    v_mov_b32 v45, v47
    v_and_b32_dpp v237, v46, v9 row_newbcast:1 row_mask:0xf bank_mask:0xf
    v_and_b32_dpp v238, v46, v10 row_newbcast:1 row_mask:0xf bank_mask:0xf
    v_and_b32_dpp v239, v46, v11 row_newbcast:1 row_mask:0xf bank_mask:0xf
    v_permlane16_swap_b32 v47, v45
    v_mfma_f32_16x16x32_bf16 v[228:231], v[232:235], v[192:195], 0
    v_add_f32 v47, v47, v45
    v_mfma_f32_16x16x32_bf16 v[228:231], v[236:239], v[196:199], v[228:231]
    v_mov_b32 v45, v47
    s_nop 1
    v_permlane32_swap_b32 v47, v45
    v_add_f32 v47, v47, v45
    v_rcp_f32 v47, v47
    s_nop 1
    v_mul_f32 v228, v228, v47
    v_mul_f32 v229, v229, v47
    v_mul_f32 v230, v230, v47
    v_mul_f32 v231, v231, v47
    v_cvt_pk_bf16_f32 v224, v228, v229
    v_cvt_pk_bf16_f32 v225, v230, v231
    s_branch L_emerged
L_eshared:
    buffer_load_dwordx4 v[40:43], v30, s[44:47], s58 offen sc1
    buffer_load_dwordx4 v[192:195], v2, s[44:47], s58 offen offset:0 sc1
    buffer_load_dwordx4 v[196:199], v2, s[44:47], s58 offen offset:1024 sc1
    buffer_load_dwordx4 v[200:203], v2, s[44:47], s58 offen offset:2048 sc1
    buffer_load_dwordx4 v[204:207], v2, s[44:47], s58 offen offset:3072 sc1
    buffer_load_dwordx4 v[208:211], v2, s[44:47], s59 offen offset:0 sc1
    buffer_load_dwordx4 v[212:215], v2, s[44:47], s59 offen offset:1024 sc1
    v_and_b32 v3, 15, v1
    v_lshrrev_b32 v4, 4, v1
    s_mov_b32 s60, 0x05040100
    s_mov_b32 s61, 0x07060302
    v_mul_u32_u24 v0, 73728, v4
    v_bfe_u32 v5, v1, 2, 1
    v_lshl_add_u32 v0, v5, 12, v0
    v_and_b32 v5, 3, v1
    v_lshl_add_u32 v0, v5, 5, v0
    v_bfe_u32 v5, v1, 3, 1
    v_lshl_add_u32 v0, v5, 4, v0
    s_lshl_b32 s54, s3, 9
    v_lshl_add_u32 v5, v3, 4, s54
    v_and_b32 v6, 1, v4
    v_lshl_add_u32 v5, v6, 3, v5
    v_lshrrev_b32 v6, 1, v4
    v_lshl_add_u32 v5, v6, 8, v5
    v_lshrrev_b32 v7, 2, v3
    v_lshlrev_b32 v7, 9, v7
    v_lshl_add_u32 v7, v4, 4, v7
    v_and_b32 v6, 1, v1
    v_lshl_add_u32 v7, v6, 6, v7
    v_and_b32 v6, 7, v3
    v_cmp_gt_u32 s[20:21], 6, v6
    s_waitcnt vmcnt(21)
    v_perm_b32 v64, v132, v128, s60
    v_perm_b32 v68, v132, v128, s61
    v_perm_b32 v72, v133, v129, s60
    v_perm_b32 v76, v133, v129, s61
    v_perm_b32 v80, v134, v130, s60
    v_perm_b32 v84, v134, v130, s61
    v_perm_b32 v88, v135, v131, s60
    v_perm_b32 v92, v135, v131, s61
    s_waitcnt vmcnt(19)
    v_perm_b32 v65, v140, v136, s60
    v_perm_b32 v69, v140, v136, s61
    v_perm_b32 v73, v141, v137, s60
    v_perm_b32 v77, v141, v137, s61
    v_perm_b32 v81, v142, v138, s60
    v_perm_b32 v85, v142, v138, s61
    v_perm_b32 v89, v143, v139, s60
    v_perm_b32 v93, v143, v139, s61
    s_waitcnt vmcnt(17)
    v_perm_b32 v66, v148, v144, s60
    v_perm_b32 v70, v148, v144, s61
    v_perm_b32 v74, v149, v145, s60
    v_perm_b32 v78, v149, v145, s61
    v_perm_b32 v82, v150, v146, s60
    v_perm_b32 v86, v150, v146, s61
    v_perm_b32 v90, v151, v147, s60
    v_perm_b32 v94, v151, v147, s61
    s_waitcnt vmcnt(15)
    v_perm_b32 v67, v156, v152, s60
    v_perm_b32 v71, v156, v152, s61
    v_perm_b32 v75, v157, v153, s60
    v_perm_b32 v79, v157, v153, s61
    v_perm_b32 v83, v158, v154, s60
    v_perm_b32 v87, v158, v154, s61
    v_perm_b32 v91, v159, v155, s60
    v_perm_b32 v95, v159, v155, s61
    s_waitcnt vmcnt(13)
    v_perm_b32 v96, v164, v160, s60
    v_perm_b32 v100, v164, v160, s61
    v_perm_b32 v104, v165, v161, s60
    v_perm_b32 v108, v165, v161, s61
    v_perm_b32 v112, v166, v162, s60
    v_perm_b32 v116, v166, v162, s61
    v_perm_b32 v120, v167, v163, s60
    v_perm_b32 v124, v167, v163, s61
    s_waitcnt vmcnt(11)
    v_perm_b32 v97, v172, v168, s60
    v_perm_b32 v101, v172, v168, s61
    v_perm_b32 v105, v173, v169, s60
    v_perm_b32 v109, v173, v169, s61
    v_perm_b32 v113, v174, v170, s60
    v_perm_b32 v117, v174, v170, s61
    v_perm_b32 v121, v175, v171, s60
    v_perm_b32 v125, v175, v171, s61
    s_waitcnt vmcnt(9)
    v_perm_b32 v98, v180, v176, s60
    v_perm_b32 v102, v180, v176, s61
    v_perm_b32 v106, v181, v177, s60
    v_perm_b32 v110, v181, v177, s61
    v_perm_b32 v114, v182, v178, s60
    v_perm_b32 v118, v182, v178, s61
    v_perm_b32 v122, v183, v179, s60
    v_perm_b32 v126, v183, v179, s61
    s_waitcnt vmcnt(7)
    v_perm_b32 v99, v188, v184, s60
    v_perm_b32 v103, v188, v184, s61
    v_perm_b32 v107, v189, v185, s60
    v_perm_b32 v111, v189, v185, s61
    v_perm_b32 v115, v190, v186, s60
    v_perm_b32 v119, v190, v186, s61
    v_perm_b32 v123, v191, v187, s60
    v_perm_b32 v127, v191, v187, s61
    s_waitcnt vmcnt(0)
    s_branch L_mpoll_12_c
L_mpoll_12:
    s_mov_b64 exec, s[4:5]
    buffer_load_dwordx4 v[40:43], v30, s[44:47], s58 offen sc1
    s_mov_b64 exec, s[6:7]
    buffer_load_dwordx4 v[192:195], v2, s[44:47], s58 offen offset:0 sc1
    s_mov_b64 exec, s[8:9]
    buffer_load_dwordx4 v[196:199], v2, s[44:47], s58 offen offset:1024 sc1
    s_mov_b64 exec, s[10:11]
    buffer_load_dwordx4 v[200:203], v2, s[44:47], s58 offen offset:2048 sc1
    s_mov_b64 exec, s[12:13]
    buffer_load_dwordx4 v[204:207], v2, s[44:47], s58 offen offset:3072 sc1
    s_mov_b64 exec, s[14:15]
    buffer_load_dwordx4 v[208:211], v2, s[44:47], s59 offen offset:0 sc1
    s_mov_b64 exec, s[16:17]
    buffer_load_dwordx4 v[212:215], v2, s[44:47], s59 offen offset:1024 sc1
    s_mov_b64 exec, -1
    s_waitcnt vmcnt(7)
L_mpoll_12_c:
    v_max3_u32 v236, v40, v41, v42
    v_max3_u32 v237, v192, v193, v194
    v_max3_u32 v238, v196, v197, v198
    v_max3_u32 v239, v200, v201, v202
    v_max3_u32 v240, v204, v205, v206
    v_max3_u32 v241, v208, v209, v210
    v_max3_u32 v242, v212, v213, v214
    v_max_u32 v236, v236, v43
    v_max_u32 v237, v237, v195
    v_max_u32 v238, v238, v199
    v_max_u32 v239, v239, v203
    v_max_u32 v240, v240, v207
    v_max_u32 v241, v241, v211
    v_max_u32 v242, v242, v215
    v_cmp_eq_u32 s[4:5], -1, v236
    v_cmp_eq_u32 s[6:7], -1, v237
    v_cmp_eq_u32 s[8:9], -1, v238
    v_cmp_eq_u32 s[10:11], -1, v239
    v_cmp_eq_u32 s[12:13], -1, v240
    v_cmp_eq_u32 s[14:15], -1, v241
    v_cmp_eq_u32 s[16:17], -1, v242
    s_or_b64 vcc, s[4:5], s[6:7]
    s_or_b64 vcc, vcc, s[8:9]
    s_or_b64 vcc, vcc, s[10:11]
    s_or_b64 vcc, vcc, s[12:13]
    s_or_b64 vcc, vcc, s[14:15]
    s_or_b64 vcc, vcc, s[16:17]
    s_cbranch_scc0 L_mpollok_13
    s_sub_u32 s101, s101, 1
    s_cbranch_scc0 L_mpoll_12
    s_mov_b32 s101, 0
L_mpollok_13:
    v_max_f32_dpp v44, v40, v40 row_ror:1 row_mask:0xf bank_mask:0xf
    v_cndmask_b32 v47, 0, v41, s[20:21]
    s_nop 0
    v_max_f32_dpp v44, v44, v44 row_ror:2 row_mask:0xf bank_mask:0xf
    s_nop 1
    v_max_f32_dpp v44, v44, v44 row_ror:4 row_mask:0xf bank_mask:0xf
    v_mov_b32 v45, v44
    s_nop 1
    v_permlane16_swap_b32 v44, v45
    v_max_f32 v44, v44, v45
    v_mov_b32 v45, v44
    s_nop 1
    v_permlane32_swap_b32 v44, v45
    v_max_f32 v44, v44, v45
    v_sub_f32 v45, v40, v44
    v_mul_f32 v45, s97, v45
    v_exp_f32 v45, v45
    s_nop 0
    v_cvt_pk_bf16_f32 v46, v45, v45
    v_and_b32 v45, s98, v46
    v_mul_f32 v47, v47, v45
    v_and_b32_dpp v232, v46, v8 row_newbcast:0 row_mask:0xf bank_mask:0xf
    v_and_b32_dpp v233, v46, v9 row_newbcast:0 row_mask:0xf bank_mask:0xf
    v_add_f32_dpp v47, v47, v47 row_ror:1 row_mask:0xf bank_mask:0xf
    v_and_b32_dpp v234, v46, v10 row_newbcast:0 row_mask:0xf bank_mask:0xf
    v_and_b32_dpp v235, v46, v11 row_newbcast:0 row_mask:0xf bank_mask:0xf
    v_and_b32_dpp v236, v46, v8 row_newbcast:1 row_mask:0xf bank_mask:0xf
    v_and_b32_dpp v237, v46, v9 row_newbcast:1 row_mask:0xf bank_mask:0xf
    v_add_f32_dpp v47, v47, v47 row_ror:2 row_mask:0xf bank_mask:0xf
    v_and_b32_dpp v238, v46, v10 row_newbcast:1 row_mask:0xf bank_mask:0xf
    v_and_b32_dpp v239, v46, v11 row_newbcast:1 row_mask:0xf bank_mask:0xf
    v_mfma_f32_16x16x32_bf16 v[228:231], v[232:235], v[192:195], 0
    v_and_b32_dpp v240, v46, v8 row_newbcast:2 row_mask:0xf bank_mask:0xf
    v_add_f32_dpp v47, v47, v47 row_ror:4 row_mask:0xf bank_mask:0xf
    v_and_b32_dpp v241, v46, v9 row_newbcast:2 row_mask:0xf bank_mask:0xf
    v_and_b32_dpp v242, v46, v10 row_newbcast:2 row_mask:0xf bank_mask:0xf
    v_and_b32_dpp v243, v46, v11 row_newbcast:2 row_mask:0xf bank_mask:0xf
    v_mfma_f32_16x16x32_bf16 v[228:231], v[236:239], v[196:199], v[228:231]
    v_mov_b32 v45, v47
    v_and_b32_dpp v244, v46, v8 row_newbcast:3 row_mask:0xf bank_mask:0xf
    v_and_b32_dpp v245, v46, v9 row_newbcast:3 row_mask:0xf bank_mask:0xf
    v_and_b32_dpp v246, v46, v10 row_newbcast:3 row_mask:0xf bank_mask:0xf
    v_and_b32_dpp v247, v46, v11 row_newbcast:3 row_mask:0xf bank_mask:0xf
    v_permlane16_swap_b32 v47, v45
    v_mfma_f32_16x16x32_bf16 v[228:231], v[240:243], v[200:203], v[228:231]
    v_and_b32_dpp v248, v46, v8 row_newbcast:4 row_mask:0xf bank_mask:0xf
    v_and_b32_dpp v249, v46, v9 row_newbcast:4 row_mask:0xf bank_mask:0xf
    v_and_b32_dpp v250, v46, v10 row_newbcast:4 row_mask:0xf bank_mask:0xf
    v_add_f32 v47, v47, v45
    v_and_b32_dpp v251, v46, v11 row_newbcast:4 row_mask:0xf bank_mask:0xf
    v_mfma_f32_16x16x32_bf16 v[228:231], v[244:247], v[204:207], v[228:231]
    v_and_b32_dpp v252, v46, v8 row_newbcast:5 row_mask:0xf bank_mask:0xf
    v_and_b32_dpp v253, v46, v9 row_newbcast:5 row_mask:0xf bank_mask:0xf
    v_mov_b32 v45, v47
    v_and_b32_dpp v254, v46, v10 row_newbcast:5 row_mask:0xf bank_mask:0xf
    v_and_b32_dpp v255, v46, v11 row_newbcast:5 row_mask:0xf bank_mask:0xf
    v_mfma_f32_16x16x32_bf16 v[228:231], v[248:251], v[208:211], v[228:231]
    v_permlane32_swap_b32 v47, v45
    v_add_f32 v47, v47, v45
    v_mfma_f32_16x16x32_bf16 v[228:231], v[252:255], v[212:215], v[228:231]
    v_rcp_f32 v47, v47
    s_nop 6
    v_mul_f32 v228, v228, v47
    v_mul_f32 v229, v229, v47
    v_mul_f32 v230, v230, v47
    v_mul_f32 v231, v231, v47
    v_cvt_pk_bf16_f32 v224, v228, v229
    v_cvt_pk_bf16_f32 v225, v230, v231
L_emerged:
    ds_write_b64 v5, v[224:225]
    s_cmp_eq_u32 s3, 3
    s_waitcnt lgkmcnt(0)
    s_barrier
    s_cbranch_scc1 L_eendA
    ds_read_b128 v[48:51], v7 offset:0
    ds_read_b128 v[52:55], v7 offset:128
    s_waitcnt lgkmcnt(1)
    v_mfma_f32_16x16x32_bf16 v[224:227], v[48:51], v[64:67], 0
    v_mfma_f32_16x16x32_bf16 v[228:231], v[48:51], v[68:71], 0
    v_mfma_f32_16x16x32_bf16 v[232:235], v[48:51], v[72:75], 0
    v_mfma_f32_16x16x32_bf16 v[236:239], v[48:51], v[76:79], 0
    v_mfma_f32_16x16x32_bf16 v[240:243], v[48:51], v[80:83], 0
    v_mfma_f32_16x16x32_bf16 v[244:247], v[48:51], v[84:87], 0
    v_mfma_f32_16x16x32_bf16 v[248:251], v[48:51], v[88:91], 0
    v_mfma_f32_16x16x32_bf16 v[252:255], v[48:51], v[92:95], 0
    s_waitcnt lgkmcnt(0)
    v_mfma_f32_16x16x32_bf16 v[224:227], v[52:55], v[96:99], v[224:227]
    s_nop 1
    v_mfma_f32_16x16x32_bf16 v[228:231], v[52:55], v[100:103], v[228:231]
    s_nop 1
    v_mfma_f32_16x16x32_bf16 v[232:235], v[52:55], v[104:107], v[232:235]
    s_nop 1
    v_mfma_f32_16x16x32_bf16 v[236:239], v[52:55], v[108:111], v[236:239]
    s_nop 0
    v_add_f32_dpp v56, v225, v224 row_ror:8 row_mask:0xf bank_mask:0x3
    v_mfma_f32_16x16x32_bf16 v[240:243], v[52:55], v[112:115], v[240:243]
    s_nop 0
    v_add_f32_dpp v57, v229, v228 row_ror:8 row_mask:0xf bank_mask:0x3
    v_mfma_f32_16x16x32_bf16 v[244:247], v[52:55], v[116:119], v[244:247]
    s_nop 0
    v_add_f32_dpp v58, v233, v232 row_ror:8 row_mask:0xf bank_mask:0x3
    v_mfma_f32_16x16x32_bf16 v[248:251], v[52:55], v[120:123], v[248:251]
    s_nop 0
    v_add_f32_dpp v59, v237, v236 row_ror:8 row_mask:0xf bank_mask:0x3
    v_mfma_f32_16x16x32_bf16 v[252:255], v[52:55], v[124:127], v[252:255]
    s_nop 0
    v_add_f32_dpp v56, v240, v241 row_ror:8 row_mask:0xf bank_mask:0xc
    v_add_f32_dpp v57, v244, v245 row_ror:8 row_mask:0xf bank_mask:0xc
    v_min_u32 v56, -2, v56
    s_nop 0
    v_add_f32_dpp v58, v248, v249 row_ror:8 row_mask:0xf bank_mask:0xc
    v_min_u32 v57, -2, v57
    s_nop 0
    v_add_f32_dpp v59, v252, v253 row_ror:8 row_mask:0xf bank_mask:0xc
    v_min_u32 v58, -2, v58
    v_min_u32 v59, -2, v59
    buffer_store_dwordx4 v[56:59], v0, s[44:47], s25 offen sc1
L_eendA:
    s_endpgm
L_epiB:
    s_cmp_eq_u32 s3, 3
    s_cbranch_scc1 L_eendB
    v_bfe_u32 v6, v1, 2, 2
    v_lshlrev_b32 v6, 6, v6
    v_and_b32 v5, 48, v1
    v_add_u32 v6, v6, v5
    v_and_b32 v5, 1, v1
    v_lshl_add_u32 v6, v5, 8, v6
    buffer_load_dwordx4 v[48:51], v6, s[44:47], s27 offen offset:0 sc1
    buffer_load_dwordx4 v[52:55], v6, s[44:47], s27 offen offset:512 sc1
    v_and_b32 v3, 15, v1
    v_lshrrev_b32 v4, 4, v1
    s_mov_b32 s60, 0x05040100
    s_mov_b32 s61, 0x07060302
    v_mul_u32_u24 v0, 73728, v4
    v_bfe_u32 v5, v1, 2, 1
    v_lshl_add_u32 v0, v5, 12, v0
    v_and_b32 v5, 3, v1
    v_lshl_add_u32 v0, v5, 5, v0
    v_bfe_u32 v5, v1, 3, 1
    v_lshl_add_u32 v0, v5, 4, v0
    s_waitcnt vmcnt(16)
    v_perm_b32 v64, v132, v128, s60
    v_perm_b32 v68, v132, v128, s61
    v_perm_b32 v72, v133, v129, s60
    v_perm_b32 v76, v133, v129, s61
    v_perm_b32 v80, v134, v130, s60
    v_perm_b32 v84, v134, v130, s61
    v_perm_b32 v88, v135, v131, s60
    v_perm_b32 v92, v135, v131, s61
    s_waitcnt vmcnt(14)
    v_perm_b32 v65, v140, v136, s60
    v_perm_b32 v69, v140, v136, s61
    v_perm_b32 v73, v141, v137, s60
    v_perm_b32 v77, v141, v137, s61
    v_perm_b32 v81, v142, v138, s60
    v_perm_b32 v85, v142, v138, s61
    v_perm_b32 v89, v143, v139, s60
    v_perm_b32 v93, v143, v139, s61
    s_waitcnt vmcnt(12)
    v_perm_b32 v66, v148, v144, s60
    v_perm_b32 v70, v148, v144, s61
    v_perm_b32 v74, v149, v145, s60
    v_perm_b32 v78, v149, v145, s61
    v_perm_b32 v82, v150, v146, s60
    v_perm_b32 v86, v150, v146, s61
    v_perm_b32 v90, v151, v147, s60
    v_perm_b32 v94, v151, v147, s61
    s_waitcnt vmcnt(10)
    v_perm_b32 v67, v156, v152, s60
    v_perm_b32 v71, v156, v152, s61
    v_perm_b32 v75, v157, v153, s60
    v_perm_b32 v79, v157, v153, s61
    v_perm_b32 v83, v158, v154, s60
    v_perm_b32 v87, v158, v154, s61
    v_perm_b32 v91, v159, v155, s60
    v_perm_b32 v95, v159, v155, s61
    s_waitcnt vmcnt(8)
    v_perm_b32 v96, v164, v160, s60
    v_perm_b32 v100, v164, v160, s61
    v_perm_b32 v104, v165, v161, s60
    v_perm_b32 v108, v165, v161, s61
    v_perm_b32 v112, v166, v162, s60
    v_perm_b32 v116, v166, v162, s61
    v_perm_b32 v120, v167, v163, s60
    v_perm_b32 v124, v167, v163, s61
    s_waitcnt vmcnt(6)
    v_perm_b32 v97, v172, v168, s60
    v_perm_b32 v101, v172, v168, s61
    v_perm_b32 v105, v173, v169, s60
    v_perm_b32 v109, v173, v169, s61
    v_perm_b32 v113, v174, v170, s60
    v_perm_b32 v117, v174, v170, s61
    v_perm_b32 v121, v175, v171, s60
    v_perm_b32 v125, v175, v171, s61
    s_waitcnt vmcnt(4)
    v_perm_b32 v98, v180, v176, s60
    v_perm_b32 v102, v180, v176, s61
    v_perm_b32 v106, v181, v177, s60
    v_perm_b32 v110, v181, v177, s61
    v_perm_b32 v114, v182, v178, s60
    v_perm_b32 v118, v182, v178, s61
    v_perm_b32 v122, v183, v179, s60
    v_perm_b32 v126, v183, v179, s61
    s_waitcnt vmcnt(2)
    v_perm_b32 v99, v188, v184, s60
    v_perm_b32 v103, v188, v184, s61
    v_perm_b32 v107, v189, v185, s60
    v_perm_b32 v111, v189, v185, s61
    v_perm_b32 v115, v190, v186, s60
    v_perm_b32 v119, v190, v186, s61
    v_perm_b32 v123, v191, v187, s60
    v_perm_b32 v127, v191, v187, s61
    s_waitcnt vmcnt(0)
    s_branch L_mpoll_14_c
L_mpoll_14:
    s_mov_b64 exec, s[4:5]
    buffer_load_dwordx4 v[48:51], v6, s[44:47], s27 offen offset:0 sc1
    s_mov_b64 exec, s[6:7]
    buffer_load_dwordx4 v[52:55], v6, s[44:47], s27 offen offset:512 sc1
    s_mov_b64 exec, -1
    s_waitcnt vmcnt(0)
L_mpoll_14_c:
    v_max3_u32 v236, v48, v49, v50
    v_max3_u32 v237, v52, v53, v54
    v_max_u32 v236, v236, v51
    v_max_u32 v237, v237, v55
    v_cmp_eq_u32 s[4:5], -1, v236
    v_cmp_eq_u32 s[6:7], -1, v237
    s_nop 0
    s_or_b64 vcc, s[4:5], s[6:7]
    s_cbranch_scc0 L_mpollok_15
    s_sub_u32 s101, s101, 1
    s_cbranch_scc0 L_mpoll_14
    s_mov_b32 s101, 0
L_mpollok_15:
    v_mfma_f32_16x16x32_bf16 v[224:227], v[48:51], v[64:67], 0
    v_mfma_f32_16x16x32_bf16 v[228:231], v[48:51], v[68:71], 0
    v_mfma_f32_16x16x32_bf16 v[232:235], v[48:51], v[72:75], 0
    v_mfma_f32_16x16x32_bf16 v[236:239], v[48:51], v[76:79], 0
    v_mfma_f32_16x16x32_bf16 v[240:243], v[48:51], v[80:83], 0
    v_mfma_f32_16x16x32_bf16 v[244:247], v[48:51], v[84:87], 0
    v_mfma_f32_16x16x32_bf16 v[248:251], v[48:51], v[88:91], 0
    v_mfma_f32_16x16x32_bf16 v[252:255], v[48:51], v[92:95], 0
    v_mfma_f32_16x16x32_bf16 v[224:227], v[52:55], v[96:99], v[224:227]
    s_nop 1
    v_mfma_f32_16x16x32_bf16 v[228:231], v[52:55], v[100:103], v[228:231]
    s_nop 1
    v_mfma_f32_16x16x32_bf16 v[232:235], v[52:55], v[104:107], v[232:235]
    s_nop 1
    v_mfma_f32_16x16x32_bf16 v[236:239], v[52:55], v[108:111], v[236:239]
    s_nop 0
    v_add_f32_dpp v56, v225, v224 row_ror:8 row_mask:0xf bank_mask:0x3
    v_mfma_f32_16x16x32_bf16 v[240:243], v[52:55], v[112:115], v[240:243]
    s_nop 0
    v_add_f32_dpp v57, v229, v228 row_ror:8 row_mask:0xf bank_mask:0x3
    v_mfma_f32_16x16x32_bf16 v[244:247], v[52:55], v[116:119], v[244:247]
    s_nop 0
    v_add_f32_dpp v58, v233, v232 row_ror:8 row_mask:0xf bank_mask:0x3
    v_mfma_f32_16x16x32_bf16 v[248:251], v[52:55], v[120:123], v[248:251]
    s_nop 0
    v_add_f32_dpp v59, v237, v236 row_ror:8 row_mask:0xf bank_mask:0x3
    v_mfma_f32_16x16x32_bf16 v[252:255], v[52:55], v[124:127], v[252:255]
    s_nop 0
    v_add_f32_dpp v56, v240, v241 row_ror:8 row_mask:0xf bank_mask:0xc
    v_add_f32_dpp v57, v244, v245 row_ror:8 row_mask:0xf bank_mask:0xc
    v_min_u32 v56, -2, v56
    s_nop 0
    v_add_f32_dpp v58, v248, v249 row_ror:8 row_mask:0xf bank_mask:0xc
    v_min_u32 v57, -2, v57
    s_nop 0
    v_add_f32_dpp v59, v252, v253 row_ror:8 row_mask:0xf bank_mask:0xc
    v_min_u32 v58, -2, v58
    v_min_u32 v59, -2, v59
    buffer_store_dwordx4 v[56:59], v0, s[44:47], s25 offen sc1
L_eendB:
    s_endpgm
L_aext0:
    s_cmp_lg_u32 s56, 1
    s_cbranch_scc1 L_aext2
    v_dot2_f32_bf16 v20, v96, v4, 0
    v_dot2_f32_bf16 v21, v100, v4, 0
    v_dot2_f32_bf16 v22, v104, v4, 0
    v_dot2_f32_bf16 v23, v108, v4, 0
    v_dot2_f32_bf16 v20, v97, v5, v20
    v_dot2_f32_bf16 v21, v101, v5, v21
    v_dot2_f32_bf16 v22, v105, v5, v22
    v_dot2_f32_bf16 v23, v109, v5, v23
    v_dot2_f32_bf16 v20, v98, v6, v20
    v_dot2_f32_bf16 v21, v102, v6, v21
    v_dot2_f32_bf16 v22, v106, v6, v22
    v_dot2_f32_bf16 v23, v110, v6, v23
    v_dot2_f32_bf16 v20, v99, v7, v20
    v_dot2_f32_bf16 v21, v103, v7, v21
    v_dot2_f32_bf16 v22, v107, v7, v22
    v_dot2_f32_bf16 v23, v111, v7, v23
    v_add_f32_dpp v24, v20, v20 row_ror:8 row_mask:0xf bank_mask:0x3
    s_nop 0
    v_add_f32_dpp v25, v22, v22 row_ror:8 row_mask:0xf bank_mask:0x3
    v_add_f32_dpp v24, v21, v21 row_ror:8 row_mask:0xf bank_mask:0xc
    v_add_f32_dpp v25, v23, v23 row_ror:8 row_mask:0xf bank_mask:0xc
    s_nop 0
    v_add_f32_dpp v26, v24, v24 row_shl:4 row_mask:0xf bank_mask:0x5
    v_add_f32_dpp v26, v25, v25 row_shr:4 row_mask:0xf bank_mask:0xa
    s_nop 1
    v_add_f32_dpp v26, v26, v26 quad_perm:[1,0,3,2] row_mask:0xf bank_mask:0xf
    s_nop 1
    v_add_f32_dpp v26, v26, v26 quad_perm:[2,3,0,1] row_mask:0xf bank_mask:0xf
    v_cvt_pk_bf16_f32 v26, v26, v26
    v_and_b32 v26, s98, v26
    v_mul_f32 v26, s96, v26
    v_cvt_pk_bf16_f32 v26, v26, v26
    v_and_b32 v26, s98, v26
    s_nop 1
    v_max_f32_dpp v27, v26, v26 row_ror:4 row_mask:0xf bank_mask:0xf
    s_nop 1
    v_max_f32_dpp v27, v27, v27 row_ror:8 row_mask:0xf bank_mask:0xf
    v_mov_b32 v28, v27
    s_nop 1
    v_permlane16_swap_b32 v27, v28
    v_max_f32 v27, v27, v28
    v_mov_b32 v28, v27
    s_nop 1
    v_permlane32_swap_b32 v27, v28
    v_max3_f32 v27, v27, v28, v16
    v_sub_f32 v28, v16, v27
    v_sub_f32 v29, v26, v27
    v_mul_f32 v28, s97, v28
    v_mul_f32 v29, s97, v29
    v_exp_f32 v28, v28
    v_exp_f32 v29, v29
    v_mov_b32 v16, v27
    v_fma_f32 v17, v17, v28, v29
    v_cvt_pk_bf16_f32 v29, v29, v29
    v_mul_f32 v12, v12, v28
    v_mul_f32 v13, v13, v28
    v_mul_f32 v14, v14, v28
    v_mul_f32 v15, v15, v28
    v_and_b32_dpp v32, v29, v8 row_newbcast:0 row_mask:0xf bank_mask:0xf
    v_and_b32_dpp v33, v29, v9 row_newbcast:0 row_mask:0xf bank_mask:0xf
    v_and_b32_dpp v34, v29, v10 row_newbcast:0 row_mask:0xf bank_mask:0xf
    v_and_b32_dpp v35, v29, v11 row_newbcast:0 row_mask:0xf bank_mask:0xf
    v_and_b32_dpp v36, v29, v8 row_newbcast:8 row_mask:0xf bank_mask:0xf
    v_and_b32_dpp v37, v29, v9 row_newbcast:8 row_mask:0xf bank_mask:0xf
    v_and_b32_dpp v38, v29, v10 row_newbcast:8 row_mask:0xf bank_mask:0xf
    v_and_b32_dpp v39, v29, v11 row_newbcast:8 row_mask:0xf bank_mask:0xf
    v_and_b32_dpp v40, v29, v8 row_newbcast:4 row_mask:0xf bank_mask:0xf
    v_and_b32_dpp v41, v29, v9 row_newbcast:4 row_mask:0xf bank_mask:0xf
    v_and_b32_dpp v42, v29, v10 row_newbcast:4 row_mask:0xf bank_mask:0xf
    v_and_b32_dpp v43, v29, v11 row_newbcast:4 row_mask:0xf bank_mask:0xf
    v_and_b32_dpp v44, v29, v8 row_newbcast:12 row_mask:0xf bank_mask:0xf
    v_and_b32_dpp v45, v29, v9 row_newbcast:12 row_mask:0xf bank_mask:0xf
    v_and_b32_dpp v46, v29, v10 row_newbcast:12 row_mask:0xf bank_mask:0xf
    v_and_b32_dpp v47, v29, v11 row_newbcast:12 row_mask:0xf bank_mask:0xf
    v_mfma_f32_16x16x32_bf16 v[12:15], v[32:35], a[32:35], v[12:15]
    v_mfma_f32_16x16x32_bf16 v[12:15], v[36:39], a[36:39], v[12:15]
    v_mfma_f32_16x16x32_bf16 v[12:15], v[40:43], a[40:43], v[12:15]
    v_mfma_f32_16x16x32_bf16 v[12:15], v[44:47], a[44:47], v[12:15]
    s_mov_b32 s56, 2
    s_branch L_aback0
L_aext1:
    s_cmp_lg_u32 s56, 2
    s_cbranch_scc1 L_aext3
    v_dot2_f32_bf16 v20, v112, v4, 0
    v_dot2_f32_bf16 v21, v116, v4, 0
    v_dot2_f32_bf16 v22, v120, v4, 0
    v_dot2_f32_bf16 v23, v124, v4, 0
    v_dot2_f32_bf16 v20, v113, v5, v20
    v_dot2_f32_bf16 v21, v117, v5, v21
    v_dot2_f32_bf16 v22, v121, v5, v22
    v_dot2_f32_bf16 v23, v125, v5, v23
    v_dot2_f32_bf16 v20, v114, v6, v20
    v_dot2_f32_bf16 v21, v118, v6, v21
    v_dot2_f32_bf16 v22, v122, v6, v22
    v_dot2_f32_bf16 v23, v126, v6, v23
    v_dot2_f32_bf16 v20, v115, v7, v20
    v_dot2_f32_bf16 v21, v119, v7, v21
    v_dot2_f32_bf16 v22, v123, v7, v22
    v_dot2_f32_bf16 v23, v127, v7, v23
    v_add_f32_dpp v24, v20, v20 row_ror:8 row_mask:0xf bank_mask:0x3
    s_nop 0
    v_add_f32_dpp v25, v22, v22 row_ror:8 row_mask:0xf bank_mask:0x3
    v_add_f32_dpp v24, v21, v21 row_ror:8 row_mask:0xf bank_mask:0xc
    v_add_f32_dpp v25, v23, v23 row_ror:8 row_mask:0xf bank_mask:0xc
    s_nop 0
    v_add_f32_dpp v26, v24, v24 row_shl:4 row_mask:0xf bank_mask:0x5
    v_add_f32_dpp v26, v25, v25 row_shr:4 row_mask:0xf bank_mask:0xa
    s_nop 1
    v_add_f32_dpp v26, v26, v26 quad_perm:[1,0,3,2] row_mask:0xf bank_mask:0xf
    s_nop 1
    v_add_f32_dpp v26, v26, v26 quad_perm:[2,3,0,1] row_mask:0xf bank_mask:0xf
    v_cvt_pk_bf16_f32 v26, v26, v26
    v_and_b32 v26, s98, v26
    v_mul_f32 v26, s96, v26
    v_cvt_pk_bf16_f32 v26, v26, v26
    v_and_b32 v26, s98, v26
    s_nop 1
    v_max_f32_dpp v27, v26, v26 row_ror:4 row_mask:0xf bank_mask:0xf
    s_nop 1
    v_max_f32_dpp v27, v27, v27 row_ror:8 row_mask:0xf bank_mask:0xf
    v_mov_b32 v28, v27
    s_nop 1
    v_permlane16_swap_b32 v27, v28
    v_max_f32 v27, v27, v28
    v_mov_b32 v28, v27
    s_nop 1
    v_permlane32_swap_b32 v27, v28
    v_max3_f32 v27, v27, v28, v16
    v_sub_f32 v28, v16, v27
    v_sub_f32 v29, v26, v27
    v_mul_f32 v28, s97, v28
    v_mul_f32 v29, s97, v29
    v_exp_f32 v28, v28
    v_exp_f32 v29, v29
    v_mov_b32 v16, v27
    v_fma_f32 v17, v17, v28, v29
    v_cvt_pk_bf16_f32 v29, v29, v29
    v_mul_f32 v12, v12, v28
    v_mul_f32 v13, v13, v28
    v_mul_f32 v14, v14, v28
    v_mul_f32 v15, v15, v28
    v_and_b32_dpp v32, v29, v8 row_newbcast:0 row_mask:0xf bank_mask:0xf
    v_and_b32_dpp v33, v29, v9 row_newbcast:0 row_mask:0xf bank_mask:0xf
    v_and_b32_dpp v34, v29, v10 row_newbcast:0 row_mask:0xf bank_mask:0xf
    v_and_b32_dpp v35, v29, v11 row_newbcast:0 row_mask:0xf bank_mask:0xf
    v_and_b32_dpp v36, v29, v8 row_newbcast:8 row_mask:0xf bank_mask:0xf
    v_and_b32_dpp v37, v29, v9 row_newbcast:8 row_mask:0xf bank_mask:0xf
    v_and_b32_dpp v38, v29, v10 row_newbcast:8 row_mask:0xf bank_mask:0xf
    v_and_b32_dpp v39, v29, v11 row_newbcast:8 row_mask:0xf bank_mask:0xf
    v_and_b32_dpp v40, v29, v8 row_newbcast:4 row_mask:0xf bank_mask:0xf
    v_and_b32_dpp v41, v29, v9 row_newbcast:4 row_mask:0xf bank_mask:0xf
    v_and_b32_dpp v42, v29, v10 row_newbcast:4 row_mask:0xf bank_mask:0xf
    v_and_b32_dpp v43, v29, v11 row_newbcast:4 row_mask:0xf bank_mask:0xf
    v_and_b32_dpp v44, v29, v8 row_newbcast:12 row_mask:0xf bank_mask:0xf
    v_and_b32_dpp v45, v29, v9 row_newbcast:12 row_mask:0xf bank_mask:0xf
    v_and_b32_dpp v46, v29, v10 row_newbcast:12 row_mask:0xf bank_mask:0xf
    v_and_b32_dpp v47, v29, v11 row_newbcast:12 row_mask:0xf bank_mask:0xf
    v_mfma_f32_16x16x32_bf16 v[12:15], v[32:35], a[48:51], v[12:15]
    v_mfma_f32_16x16x32_bf16 v[12:15], v[36:39], a[52:55], v[12:15]
    v_mfma_f32_16x16x32_bf16 v[12:15], v[40:43], a[56:59], v[12:15]
    v_mfma_f32_16x16x32_bf16 v[12:15], v[44:47], a[60:63], v[12:15]
    s_mov_b32 s56, 3
    s_branch L_aback1
L_aext2:
    s_cmp_lg_u32 s56, 3
    s_cbranch_scc1 L_aext4
    v_dot2_f32_bf16 v20, v128, v4, 0
    v_dot2_f32_bf16 v21, v132, v4, 0
    v_dot2_f32_bf16 v22, v136, v4, 0
    v_dot2_f32_bf16 v23, v140, v4, 0
    v_dot2_f32_bf16 v20, v129, v5, v20
    v_dot2_f32_bf16 v21, v133, v5, v21
    v_dot2_f32_bf16 v22, v137, v5, v22
    v_dot2_f32_bf16 v23, v141, v5, v23
    v_dot2_f32_bf16 v20, v130, v6, v20
    v_dot2_f32_bf16 v21, v134, v6, v21
    v_dot2_f32_bf16 v22, v138, v6, v22
    v_dot2_f32_bf16 v23, v142, v6, v23
    v_dot2_f32_bf16 v20, v131, v7, v20
    v_dot2_f32_bf16 v21, v135, v7, v21
    v_dot2_f32_bf16 v22, v139, v7, v22
    v_dot2_f32_bf16 v23, v143, v7, v23
    v_add_f32_dpp v24, v20, v20 row_ror:8 row_mask:0xf bank_mask:0x3
    s_nop 0
    v_add_f32_dpp v25, v22, v22 row_ror:8 row_mask:0xf bank_mask:0x3
    v_add_f32_dpp v24, v21, v21 row_ror:8 row_mask:0xf bank_mask:0xc
    v_add_f32_dpp v25, v23, v23 row_ror:8 row_mask:0xf bank_mask:0xc
    s_nop 0
    v_add_f32_dpp v26, v24, v24 row_shl:4 row_mask:0xf bank_mask:0x5
    v_add_f32_dpp v26, v25, v25 row_shr:4 row_mask:0xf bank_mask:0xa
    s_nop 1
    v_add_f32_dpp v26, v26, v26 quad_perm:[1,0,3,2] row_mask:0xf bank_mask:0xf
    s_nop 1
    v_add_f32_dpp v26, v26, v26 quad_perm:[2,3,0,1] row_mask:0xf bank_mask:0xf
    v_cvt_pk_bf16_f32 v26, v26, v26
    v_and_b32 v26, s98, v26
    v_mul_f32 v26, s96, v26
    v_cvt_pk_bf16_f32 v26, v26, v26
    v_and_b32 v26, s98, v26
    s_nop 1
    v_max_f32_dpp v27, v26, v26 row_ror:4 row_mask:0xf bank_mask:0xf
    s_nop 1
    v_max_f32_dpp v27, v27, v27 row_ror:8 row_mask:0xf bank_mask:0xf
    v_mov_b32 v28, v27
    s_nop 1
    v_permlane16_swap_b32 v27, v28
    v_max_f32 v27, v27, v28
    v_mov_b32 v28, v27
    s_nop 1
    v_permlane32_swap_b32 v27, v28
    v_max3_f32 v27, v27, v28, v16
    v_sub_f32 v28, v16, v27
    v_sub_f32 v29, v26, v27
    v_mul_f32 v28, s97, v28
    v_mul_f32 v29, s97, v29
    v_exp_f32 v28, v28
    v_exp_f32 v29, v29
    v_mov_b32 v16, v27
    v_fma_f32 v17, v17, v28, v29
    v_cvt_pk_bf16_f32 v29, v29, v29
    v_mul_f32 v12, v12, v28
    v_mul_f32 v13, v13, v28
    v_mul_f32 v14, v14, v28
    v_mul_f32 v15, v15, v28
    v_and_b32_dpp v32, v29, v8 row_newbcast:0 row_mask:0xf bank_mask:0xf
    v_and_b32_dpp v33, v29, v9 row_newbcast:0 row_mask:0xf bank_mask:0xf
    v_and_b32_dpp v34, v29, v10 row_newbcast:0 row_mask:0xf bank_mask:0xf
    v_and_b32_dpp v35, v29, v11 row_newbcast:0 row_mask:0xf bank_mask:0xf
    v_and_b32_dpp v36, v29, v8 row_newbcast:8 row_mask:0xf bank_mask:0xf
    v_and_b32_dpp v37, v29, v9 row_newbcast:8 row_mask:0xf bank_mask:0xf
    v_and_b32_dpp v38, v29, v10 row_newbcast:8 row_mask:0xf bank_mask:0xf
    v_and_b32_dpp v39, v29, v11 row_newbcast:8 row_mask:0xf bank_mask:0xf
    v_and_b32_dpp v40, v29, v8 row_newbcast:4 row_mask:0xf bank_mask:0xf
    v_and_b32_dpp v41, v29, v9 row_newbcast:4 row_mask:0xf bank_mask:0xf
    v_and_b32_dpp v42, v29, v10 row_newbcast:4 row_mask:0xf bank_mask:0xf
    v_and_b32_dpp v43, v29, v11 row_newbcast:4 row_mask:0xf bank_mask:0xf
    v_and_b32_dpp v44, v29, v8 row_newbcast:12 row_mask:0xf bank_mask:0xf
    v_and_b32_dpp v45, v29, v9 row_newbcast:12 row_mask:0xf bank_mask:0xf
    v_and_b32_dpp v46, v29, v10 row_newbcast:12 row_mask:0xf bank_mask:0xf
    v_and_b32_dpp v47, v29, v11 row_newbcast:12 row_mask:0xf bank_mask:0xf
    v_mfma_f32_16x16x32_bf16 v[12:15], v[32:35], a[64:67], v[12:15]
    v_mfma_f32_16x16x32_bf16 v[12:15], v[36:39], a[68:71], v[12:15]
    v_mfma_f32_16x16x32_bf16 v[12:15], v[40:43], a[72:75], v[12:15]
    v_mfma_f32_16x16x32_bf16 v[12:15], v[44:47], a[76:79], v[12:15]
    s_mov_b32 s56, 4
    s_branch L_aback0
L_aext3:
    s_cmp_lg_u32 s56, 4
    s_cbranch_scc1 L_aext5
    v_dot2_f32_bf16 v20, v144, v4, 0
    v_dot2_f32_bf16 v21, v148, v4, 0
    v_dot2_f32_bf16 v22, v152, v4, 0
    v_dot2_f32_bf16 v23, v156, v4, 0
    v_dot2_f32_bf16 v20, v145, v5, v20
    v_dot2_f32_bf16 v21, v149, v5, v21
    v_dot2_f32_bf16 v22, v153, v5, v22
    v_dot2_f32_bf16 v23, v157, v5, v23
    v_dot2_f32_bf16 v20, v146, v6, v20
    v_dot2_f32_bf16 v21, v150, v6, v21
    v_dot2_f32_bf16 v22, v154, v6, v22
    v_dot2_f32_bf16 v23, v158, v6, v23
    v_dot2_f32_bf16 v20, v147, v7, v20
    v_dot2_f32_bf16 v21, v151, v7, v21
    v_dot2_f32_bf16 v22, v155, v7, v22
    v_dot2_f32_bf16 v23, v159, v7, v23
    v_add_f32_dpp v24, v20, v20 row_ror:8 row_mask:0xf bank_mask:0x3
    s_nop 0
    v_add_f32_dpp v25, v22, v22 row_ror:8 row_mask:0xf bank_mask:0x3
    v_add_f32_dpp v24, v21, v21 row_ror:8 row_mask:0xf bank_mask:0xc
    v_add_f32_dpp v25, v23, v23 row_ror:8 row_mask:0xf bank_mask:0xc
    s_nop 0
    v_add_f32_dpp v26, v24, v24 row_shl:4 row_mask:0xf bank_mask:0x5
    v_add_f32_dpp v26, v25, v25 row_shr:4 row_mask:0xf bank_mask:0xa
    s_nop 1
    v_add_f32_dpp v26, v26, v26 quad_perm:[1,0,3,2] row_mask:0xf bank_mask:0xf
    s_nop 1
    v_add_f32_dpp v26, v26, v26 quad_perm:[2,3,0,1] row_mask:0xf bank_mask:0xf
    v_cvt_pk_bf16_f32 v26, v26, v26
    v_and_b32 v26, s98, v26
    v_mul_f32 v26, s96, v26
    v_cvt_pk_bf16_f32 v26, v26, v26
    v_and_b32 v26, s98, v26
    s_nop 1
    v_max_f32_dpp v27, v26, v26 row_ror:4 row_mask:0xf bank_mask:0xf
    s_nop 1
    v_max_f32_dpp v27, v27, v27 row_ror:8 row_mask:0xf bank_mask:0xf
    v_mov_b32 v28, v27
    s_nop 1
    v_permlane16_swap_b32 v27, v28
    v_max_f32 v27, v27, v28
    v_mov_b32 v28, v27
    s_nop 1
    v_permlane32_swap_b32 v27, v28
    v_max3_f32 v27, v27, v28, v16
    v_sub_f32 v28, v16, v27
    v_sub_f32 v29, v26, v27
    v_mul_f32 v28, s97, v28
    v_mul_f32 v29, s97, v29
    v_exp_f32 v28, v28
    v_exp_f32 v29, v29
    v_mov_b32 v16, v27
    v_fma_f32 v17, v17, v28, v29
    v_cvt_pk_bf16_f32 v29, v29, v29
    v_mul_f32 v12, v12, v28
    v_mul_f32 v13, v13, v28
    v_mul_f32 v14, v14, v28
    v_mul_f32 v15, v15, v28
    v_and_b32_dpp v32, v29, v8 row_newbcast:0 row_mask:0xf bank_mask:0xf
    v_and_b32_dpp v33, v29, v9 row_newbcast:0 row_mask:0xf bank_mask:0xf
    v_and_b32_dpp v34, v29, v10 row_newbcast:0 row_mask:0xf bank_mask:0xf
    v_and_b32_dpp v35, v29, v11 row_newbcast:0 row_mask:0xf bank_mask:0xf
    v_and_b32_dpp v36, v29, v8 row_newbcast:8 row_mask:0xf bank_mask:0xf
    v_and_b32_dpp v37, v29, v9 row_newbcast:8 row_mask:0xf bank_mask:0xf
    v_and_b32_dpp v38, v29, v10 row_newbcast:8 row_mask:0xf bank_mask:0xf
    v_and_b32_dpp v39, v29, v11 row_newbcast:8 row_mask:0xf bank_mask:0xf
    v_and_b32_dpp v40, v29, v8 row_newbcast:4 row_mask:0xf bank_mask:0xf
    v_and_b32_dpp v41, v29, v9 row_newbcast:4 row_mask:0xf bank_mask:0xf
    v_and_b32_dpp v42, v29, v10 row_newbcast:4 row_mask:0xf bank_mask:0xf
    v_and_b32_dpp v43, v29, v11 row_newbcast:4 row_mask:0xf bank_mask:0xf
    v_and_b32_dpp v44, v29, v8 row_newbcast:12 row_mask:0xf bank_mask:0xf
    v_and_b32_dpp v45, v29, v9 row_newbcast:12 row_mask:0xf bank_mask:0xf
    v_and_b32_dpp v46, v29, v10 row_newbcast:12 row_mask:0xf bank_mask:0xf
    v_and_b32_dpp v47, v29, v11 row_newbcast:12 row_mask:0xf bank_mask:0xf
    v_mfma_f32_16x16x32_bf16 v[12:15], v[32:35], a[80:83], v[12:15]
    v_mfma_f32_16x16x32_bf16 v[12:15], v[36:39], a[84:87], v[12:15]
    v_mfma_f32_16x16x32_bf16 v[12:15], v[40:43], a[88:91], v[12:15]
    v_mfma_f32_16x16x32_bf16 v[12:15], v[44:47], a[92:95], v[12:15]
    s_mov_b32 s56, 5
    s_branch L_aback1
L_aext4:
    s_cmp_lg_u32 s56, 5
    s_cbranch_scc1 L_aext6
    v_dot2_f32_bf16 v20, v160, v4, 0
    v_dot2_f32_bf16 v21, v164, v4, 0
    v_dot2_f32_bf16 v22, v168, v4, 0
    v_dot2_f32_bf16 v23, v172, v4, 0
    v_dot2_f32_bf16 v20, v161, v5, v20
    v_dot2_f32_bf16 v21, v165, v5, v21
    v_dot2_f32_bf16 v22, v169, v5, v22
    v_dot2_f32_bf16 v23, v173, v5, v23
    v_dot2_f32_bf16 v20, v162, v6, v20
    v_dot2_f32_bf16 v21, v166, v6, v21
    v_dot2_f32_bf16 v22, v170, v6, v22
    v_dot2_f32_bf16 v23, v174, v6, v23
    v_dot2_f32_bf16 v20, v163, v7, v20
    v_dot2_f32_bf16 v21, v167, v7, v21
    v_dot2_f32_bf16 v22, v171, v7, v22
    v_dot2_f32_bf16 v23, v175, v7, v23
    v_add_f32_dpp v24, v20, v20 row_ror:8 row_mask:0xf bank_mask:0x3
    s_nop 0
    v_add_f32_dpp v25, v22, v22 row_ror:8 row_mask:0xf bank_mask:0x3
    v_add_f32_dpp v24, v21, v21 row_ror:8 row_mask:0xf bank_mask:0xc
    v_add_f32_dpp v25, v23, v23 row_ror:8 row_mask:0xf bank_mask:0xc
    s_nop 0
    v_add_f32_dpp v26, v24, v24 row_shl:4 row_mask:0xf bank_mask:0x5
    v_add_f32_dpp v26, v25, v25 row_shr:4 row_mask:0xf bank_mask:0xa
    s_nop 1
    v_add_f32_dpp v26, v26, v26 quad_perm:[1,0,3,2] row_mask:0xf bank_mask:0xf
    s_nop 1
    v_add_f32_dpp v26, v26, v26 quad_perm:[2,3,0,1] row_mask:0xf bank_mask:0xf
    v_cvt_pk_bf16_f32 v26, v26, v26
    v_and_b32 v26, s98, v26
    v_mul_f32 v26, s96, v26
    v_cvt_pk_bf16_f32 v26, v26, v26
    v_and_b32 v26, s98, v26
    s_nop 1
    v_max_f32_dpp v27, v26, v26 row_ror:4 row_mask:0xf bank_mask:0xf
    s_nop 1
    v_max_f32_dpp v27, v27, v27 row_ror:8 row_mask:0xf bank_mask:0xf
    v_mov_b32 v28, v27
    s_nop 1
    v_permlane16_swap_b32 v27, v28
    v_max_f32 v27, v27, v28
    v_mov_b32 v28, v27
    s_nop 1
    v_permlane32_swap_b32 v27, v28
    v_max3_f32 v27, v27, v28, v16
    v_sub_f32 v28, v16, v27
    v_sub_f32 v29, v26, v27
    v_mul_f32 v28, s97, v28
    v_mul_f32 v29, s97, v29
    v_exp_f32 v28, v28
    v_exp_f32 v29, v29
    v_mov_b32 v16, v27
    v_fma_f32 v17, v17, v28, v29
    v_cvt_pk_bf16_f32 v29, v29, v29
    v_mul_f32 v12, v12, v28
    v_mul_f32 v13, v13, v28
    v_mul_f32 v14, v14, v28
    v_mul_f32 v15, v15, v28
    v_and_b32_dpp v32, v29, v8 row_newbcast:0 row_mask:0xf bank_mask:0xf
    v_and_b32_dpp v33, v29, v9 row_newbcast:0 row_mask:0xf bank_mask:0xf
    v_and_b32_dpp v34, v29, v10 row_newbcast:0 row_mask:0xf bank_mask:0xf
    v_and_b32_dpp v35, v29, v11 row_newbcast:0 row_mask:0xf bank_mask:0xf
    v_and_b32_dpp v36, v29, v8 row_newbcast:8 row_mask:0xf bank_mask:0xf
    v_and_b32_dpp v37, v29, v9 row_newbcast:8 row_mask:0xf bank_mask:0xf
    v_and_b32_dpp v38, v29, v10 row_newbcast:8 row_mask:0xf bank_mask:0xf
    v_and_b32_dpp v39, v29, v11 row_newbcast:8 row_mask:0xf bank_mask:0xf
    v_and_b32_dpp v40, v29, v8 row_newbcast:4 row_mask:0xf bank_mask:0xf
    v_and_b32_dpp v41, v29, v9 row_newbcast:4 row_mask:0xf bank_mask:0xf
    v_and_b32_dpp v42, v29, v10 row_newbcast:4 row_mask:0xf bank_mask:0xf
    v_and_b32_dpp v43, v29, v11 row_newbcast:4 row_mask:0xf bank_mask:0xf
    v_and_b32_dpp v44, v29, v8 row_newbcast:12 row_mask:0xf bank_mask:0xf
    v_and_b32_dpp v45, v29, v9 row_newbcast:12 row_mask:0xf bank_mask:0xf
    v_and_b32_dpp v46, v29, v10 row_newbcast:12 row_mask:0xf bank_mask:0xf
    v_and_b32_dpp v47, v29, v11 row_newbcast:12 row_mask:0xf bank_mask:0xf
    v_mfma_f32_16x16x32_bf16 v[12:15], v[32:35], a[96:99], v[12:15]
    v_mfma_f32_16x16x32_bf16 v[12:15], v[36:39], a[100:103], v[12:15]
    v_mfma_f32_16x16x32_bf16 v[12:15], v[40:43], a[104:107], v[12:15]
    v_mfma_f32_16x16x32_bf16 v[12:15], v[44:47], a[108:111], v[12:15]
    s_mov_b32 s56, 6
    s_branch L_aback0
L_aext5:
    s_cmp_lg_u32 s56, 6
    s_cbranch_scc1 L_aext7
    v_dot2_f32_bf16 v20, v176, v4, 0
    v_dot2_f32_bf16 v21, v180, v4, 0
    v_dot2_f32_bf16 v22, v184, v4, 0
    v_dot2_f32_bf16 v23, v188, v4, 0
    v_dot2_f32_bf16 v20, v177, v5, v20
    v_dot2_f32_bf16 v21, v181, v5, v21
    v_dot2_f32_bf16 v22, v185, v5, v22
    v_dot2_f32_bf16 v23, v189, v5, v23
    v_dot2_f32_bf16 v20, v178, v6, v20
    v_dot2_f32_bf16 v21, v182, v6, v21
    v_dot2_f32_bf16 v22, v186, v6, v22
    v_dot2_f32_bf16 v23, v190, v6, v23
    v_dot2_f32_bf16 v20, v179, v7, v20
    v_dot2_f32_bf16 v21, v183, v7, v21
    v_dot2_f32_bf16 v22, v187, v7, v22
    v_dot2_f32_bf16 v23, v191, v7, v23
    v_add_f32_dpp v24, v20, v20 row_ror:8 row_mask:0xf bank_mask:0x3
    s_nop 0
    v_add_f32_dpp v25, v22, v22 row_ror:8 row_mask:0xf bank_mask:0x3
    v_add_f32_dpp v24, v21, v21 row_ror:8 row_mask:0xf bank_mask:0xc
    v_add_f32_dpp v25, v23, v23 row_ror:8 row_mask:0xf bank_mask:0xc
    s_nop 0
    v_add_f32_dpp v26, v24, v24 row_shl:4 row_mask:0xf bank_mask:0x5
    v_add_f32_dpp v26, v25, v25 row_shr:4 row_mask:0xf bank_mask:0xa
    s_nop 1
    v_add_f32_dpp v26, v26, v26 quad_perm:[1,0,3,2] row_mask:0xf bank_mask:0xf
    s_nop 1
    v_add_f32_dpp v26, v26, v26 quad_perm:[2,3,0,1] row_mask:0xf bank_mask:0xf
    v_cvt_pk_bf16_f32 v26, v26, v26
    v_and_b32 v26, s98, v26
    v_mul_f32 v26, s96, v26
    v_cvt_pk_bf16_f32 v26, v26, v26
    v_and_b32 v26, s98, v26
    s_nop 1
    v_max_f32_dpp v27, v26, v26 row_ror:4 row_mask:0xf bank_mask:0xf
    s_nop 1
    v_max_f32_dpp v27, v27, v27 row_ror:8 row_mask:0xf bank_mask:0xf
    v_mov_b32 v28, v27
    s_nop 1
    v_permlane16_swap_b32 v27, v28
    v_max_f32 v27, v27, v28
    v_mov_b32 v28, v27
    s_nop 1
    v_permlane32_swap_b32 v27, v28
    v_max3_f32 v27, v27, v28, v16
    v_sub_f32 v28, v16, v27
    v_sub_f32 v29, v26, v27
    v_mul_f32 v28, s97, v28
    v_mul_f32 v29, s97, v29
    v_exp_f32 v28, v28
    v_exp_f32 v29, v29
    v_mov_b32 v16, v27
    v_fma_f32 v17, v17, v28, v29
    v_cvt_pk_bf16_f32 v29, v29, v29
    v_mul_f32 v12, v12, v28
    v_mul_f32 v13, v13, v28
    v_mul_f32 v14, v14, v28
    v_mul_f32 v15, v15, v28
    v_and_b32_dpp v32, v29, v8 row_newbcast:0 row_mask:0xf bank_mask:0xf
    v_and_b32_dpp v33, v29, v9 row_newbcast:0 row_mask:0xf bank_mask:0xf
    v_and_b32_dpp v34, v29, v10 row_newbcast:0 row_mask:0xf bank_mask:0xf
    v_and_b32_dpp v35, v29, v11 row_newbcast:0 row_mask:0xf bank_mask:0xf
    v_and_b32_dpp v36, v29, v8 row_newbcast:8 row_mask:0xf bank_mask:0xf
    v_and_b32_dpp v37, v29, v9 row_newbcast:8 row_mask:0xf bank_mask:0xf
    v_and_b32_dpp v38, v29, v10 row_newbcast:8 row_mask:0xf bank_mask:0xf
    v_and_b32_dpp v39, v29, v11 row_newbcast:8 row_mask:0xf bank_mask:0xf
    v_and_b32_dpp v40, v29, v8 row_newbcast:4 row_mask:0xf bank_mask:0xf
    v_and_b32_dpp v41, v29, v9 row_newbcast:4 row_mask:0xf bank_mask:0xf
    v_and_b32_dpp v42, v29, v10 row_newbcast:4 row_mask:0xf bank_mask:0xf
    v_and_b32_dpp v43, v29, v11 row_newbcast:4 row_mask:0xf bank_mask:0xf
    v_and_b32_dpp v44, v29, v8 row_newbcast:12 row_mask:0xf bank_mask:0xf
    v_and_b32_dpp v45, v29, v9 row_newbcast:12 row_mask:0xf bank_mask:0xf
    v_and_b32_dpp v46, v29, v10 row_newbcast:12 row_mask:0xf bank_mask:0xf
    v_and_b32_dpp v47, v29, v11 row_newbcast:12 row_mask:0xf bank_mask:0xf
    v_mfma_f32_16x16x32_bf16 v[12:15], v[32:35], a[112:115], v[12:15]
    v_mfma_f32_16x16x32_bf16 v[12:15], v[36:39], a[116:119], v[12:15]
    v_mfma_f32_16x16x32_bf16 v[12:15], v[40:43], a[120:123], v[12:15]
    v_mfma_f32_16x16x32_bf16 v[12:15], v[44:47], a[124:127], v[12:15]
    s_mov_b32 s56, 7
    s_branch L_aback1
L_aext6:
    s_cmp_lg_u32 s56, 7
    s_cbranch_scc1 L_aext8
    v_dot2_f32_bf16 v20, v192, v4, 0
    v_dot2_f32_bf16 v21, v196, v4, 0
    v_dot2_f32_bf16 v22, v200, v4, 0
    v_dot2_f32_bf16 v23, v204, v4, 0
    v_dot2_f32_bf16 v20, v193, v5, v20
    v_dot2_f32_bf16 v21, v197, v5, v21
    v_dot2_f32_bf16 v22, v201, v5, v22
    v_dot2_f32_bf16 v23, v205, v5, v23
    v_dot2_f32_bf16 v20, v194, v6, v20
    v_dot2_f32_bf16 v21, v198, v6, v21
    v_dot2_f32_bf16 v22, v202, v6, v22
    v_dot2_f32_bf16 v23, v206, v6, v23
    v_dot2_f32_bf16 v20, v195, v7, v20
    v_dot2_f32_bf16 v21, v199, v7, v21
    v_dot2_f32_bf16 v22, v203, v7, v22
    v_dot2_f32_bf16 v23, v207, v7, v23
    v_add_f32_dpp v24, v20, v20 row_ror:8 row_mask:0xf bank_mask:0x3
    s_nop 0
    v_add_f32_dpp v25, v22, v22 row_ror:8 row_mask:0xf bank_mask:0x3
    v_add_f32_dpp v24, v21, v21 row_ror:8 row_mask:0xf bank_mask:0xc
    v_add_f32_dpp v25, v23, v23 row_ror:8 row_mask:0xf bank_mask:0xc
    s_nop 0
    v_add_f32_dpp v26, v24, v24 row_shl:4 row_mask:0xf bank_mask:0x5
    v_add_f32_dpp v26, v25, v25 row_shr:4 row_mask:0xf bank_mask:0xa
    s_nop 1
    v_add_f32_dpp v26, v26, v26 quad_perm:[1,0,3,2] row_mask:0xf bank_mask:0xf
    s_nop 1
    v_add_f32_dpp v26, v26, v26 quad_perm:[2,3,0,1] row_mask:0xf bank_mask:0xf
    v_cvt_pk_bf16_f32 v26, v26, v26
    v_and_b32 v26, s98, v26
    v_mul_f32 v26, s96, v26
    v_cvt_pk_bf16_f32 v26, v26, v26
    v_and_b32 v26, s98, v26
    s_nop 1
    v_max_f32_dpp v27, v26, v26 row_ror:4 row_mask:0xf bank_mask:0xf
    s_nop 1
    v_max_f32_dpp v27, v27, v27 row_ror:8 row_mask:0xf bank_mask:0xf
    v_mov_b32 v28, v27
    s_nop 1
    v_permlane16_swap_b32 v27, v28
    v_max_f32 v27, v27, v28
    v_mov_b32 v28, v27
    s_nop 1
    v_permlane32_swap_b32 v27, v28
    v_max3_f32 v27, v27, v28, v16
    v_sub_f32 v28, v16, v27
    v_sub_f32 v29, v26, v27
    v_mul_f32 v28, s97, v28
    v_mul_f32 v29, s97, v29
    v_exp_f32 v28, v28
    v_exp_f32 v29, v29
    v_mov_b32 v16, v27
    v_fma_f32 v17, v17, v28, v29
    v_cvt_pk_bf16_f32 v29, v29, v29
    v_mul_f32 v12, v12, v28
    v_mul_f32 v13, v13, v28
    v_mul_f32 v14, v14, v28
    v_mul_f32 v15, v15, v28
    v_and_b32_dpp v32, v29, v8 row_newbcast:0 row_mask:0xf bank_mask:0xf
    v_and_b32_dpp v33, v29, v9 row_newbcast:0 row_mask:0xf bank_mask:0xf
    v_and_b32_dpp v34, v29, v10 row_newbcast:0 row_mask:0xf bank_mask:0xf
    v_and_b32_dpp v35, v29, v11 row_newbcast:0 row_mask:0xf bank_mask:0xf
    v_and_b32_dpp v36, v29, v8 row_newbcast:8 row_mask:0xf bank_mask:0xf
    v_and_b32_dpp v37, v29, v9 row_newbcast:8 row_mask:0xf bank_mask:0xf
    v_and_b32_dpp v38, v29, v10 row_newbcast:8 row_mask:0xf bank_mask:0xf
    v_and_b32_dpp v39, v29, v11 row_newbcast:8 row_mask:0xf bank_mask:0xf
    v_and_b32_dpp v40, v29, v8 row_newbcast:4 row_mask:0xf bank_mask:0xf
    v_and_b32_dpp v41, v29, v9 row_newbcast:4 row_mask:0xf bank_mask:0xf
    v_and_b32_dpp v42, v29, v10 row_newbcast:4 row_mask:0xf bank_mask:0xf
    v_and_b32_dpp v43, v29, v11 row_newbcast:4 row_mask:0xf bank_mask:0xf
    v_and_b32_dpp v44, v29, v8 row_newbcast:12 row_mask:0xf bank_mask:0xf
    v_and_b32_dpp v45, v29, v9 row_newbcast:12 row_mask:0xf bank_mask:0xf
    v_and_b32_dpp v46, v29, v10 row_newbcast:12 row_mask:0xf bank_mask:0xf
    v_and_b32_dpp v47, v29, v11 row_newbcast:12 row_mask:0xf bank_mask:0xf
    v_mfma_f32_16x16x32_bf16 v[12:15], v[32:35], a[128:131], v[12:15]
    v_mfma_f32_16x16x32_bf16 v[12:15], v[36:39], a[132:135], v[12:15]
    v_mfma_f32_16x16x32_bf16 v[12:15], v[40:43], a[136:139], v[12:15]
    v_mfma_f32_16x16x32_bf16 v[12:15], v[44:47], a[140:143], v[12:15]
    s_mov_b32 s56, 8
    s_branch L_aback0
L_aext7:
    s_cmp_lg_u32 s56, 8
    s_cbranch_scc1 L_aext9
    v_dot2_f32_bf16 v20, v208, v4, 0
    v_dot2_f32_bf16 v21, v212, v4, 0
    v_dot2_f32_bf16 v22, v216, v4, 0
    v_dot2_f32_bf16 v23, v220, v4, 0
    v_dot2_f32_bf16 v20, v209, v5, v20
    v_dot2_f32_bf16 v21, v213, v5, v21
    v_dot2_f32_bf16 v22, v217, v5, v22
    v_dot2_f32_bf16 v23, v221, v5, v23
    v_dot2_f32_bf16 v20, v210, v6, v20
    v_dot2_f32_bf16 v21, v214, v6, v21
    v_dot2_f32_bf16 v22, v218, v6, v22
    v_dot2_f32_bf16 v23, v222, v6, v23
    v_dot2_f32_bf16 v20, v211, v7, v20
    v_dot2_f32_bf16 v21, v215, v7, v21
    v_dot2_f32_bf16 v22, v219, v7, v22
    v_dot2_f32_bf16 v23, v223, v7, v23
    v_add_f32_dpp v24, v20, v20 row_ror:8 row_mask:0xf bank_mask:0x3
    s_nop 0
    v_add_f32_dpp v25, v22, v22 row_ror:8 row_mask:0xf bank_mask:0x3
    v_add_f32_dpp v24, v21, v21 row_ror:8 row_mask:0xf bank_mask:0xc
    v_add_f32_dpp v25, v23, v23 row_ror:8 row_mask:0xf bank_mask:0xc
    s_nop 0
    v_add_f32_dpp v26, v24, v24 row_shl:4 row_mask:0xf bank_mask:0x5
    v_add_f32_dpp v26, v25, v25 row_shr:4 row_mask:0xf bank_mask:0xa
    s_nop 1
    v_add_f32_dpp v26, v26, v26 quad_perm:[1,0,3,2] row_mask:0xf bank_mask:0xf
    s_nop 1
    v_add_f32_dpp v26, v26, v26 quad_perm:[2,3,0,1] row_mask:0xf bank_mask:0xf
    v_cvt_pk_bf16_f32 v26, v26, v26
    v_and_b32 v26, s98, v26
    v_mul_f32 v26, s96, v26
    v_cvt_pk_bf16_f32 v26, v26, v26
    v_and_b32 v26, s98, v26
    s_nop 1
    v_max_f32_dpp v27, v26, v26 row_ror:4 row_mask:0xf bank_mask:0xf
    s_nop 1
    v_max_f32_dpp v27, v27, v27 row_ror:8 row_mask:0xf bank_mask:0xf
    v_mov_b32 v28, v27
    s_nop 1
    v_permlane16_swap_b32 v27, v28
    v_max_f32 v27, v27, v28
    v_mov_b32 v28, v27
    s_nop 1
    v_permlane32_swap_b32 v27, v28
    v_max3_f32 v27, v27, v28, v16
    v_sub_f32 v28, v16, v27
    v_sub_f32 v29, v26, v27
    v_mul_f32 v28, s97, v28
    v_mul_f32 v29, s97, v29
    v_exp_f32 v28, v28
    v_exp_f32 v29, v29
    v_mov_b32 v16, v27
    v_fma_f32 v17, v17, v28, v29
    v_cvt_pk_bf16_f32 v29, v29, v29
    v_mul_f32 v12, v12, v28
    v_mul_f32 v13, v13, v28
    v_mul_f32 v14, v14, v28
    v_mul_f32 v15, v15, v28
    v_and_b32_dpp v32, v29, v8 row_newbcast:0 row_mask:0xf bank_mask:0xf
    v_and_b32_dpp v33, v29, v9 row_newbcast:0 row_mask:0xf bank_mask:0xf
    v_and_b32_dpp v34, v29, v10 row_newbcast:0 row_mask:0xf bank_mask:0xf
    v_and_b32_dpp v35, v29, v11 row_newbcast:0 row_mask:0xf bank_mask:0xf
    v_and_b32_dpp v36, v29, v8 row_newbcast:8 row_mask:0xf bank_mask:0xf
    v_and_b32_dpp v37, v29, v9 row_newbcast:8 row_mask:0xf bank_mask:0xf
    v_and_b32_dpp v38, v29, v10 row_newbcast:8 row_mask:0xf bank_mask:0xf
    v_and_b32_dpp v39, v29, v11 row_newbcast:8 row_mask:0xf bank_mask:0xf
    v_and_b32_dpp v40, v29, v8 row_newbcast:4 row_mask:0xf bank_mask:0xf
    v_and_b32_dpp v41, v29, v9 row_newbcast:4 row_mask:0xf bank_mask:0xf
    v_and_b32_dpp v42, v29, v10 row_newbcast:4 row_mask:0xf bank_mask:0xf
    v_and_b32_dpp v43, v29, v11 row_newbcast:4 row_mask:0xf bank_mask:0xf
    v_and_b32_dpp v44, v29, v8 row_newbcast:12 row_mask:0xf bank_mask:0xf
    v_and_b32_dpp v45, v29, v9 row_newbcast:12 row_mask:0xf bank_mask:0xf
    v_and_b32_dpp v46, v29, v10 row_newbcast:12 row_mask:0xf bank_mask:0xf
    v_and_b32_dpp v47, v29, v11 row_newbcast:12 row_mask:0xf bank_mask:0xf
    v_mfma_f32_16x16x32_bf16 v[12:15], v[32:35], a[144:147], v[12:15]
    v_mfma_f32_16x16x32_bf16 v[12:15], v[36:39], a[148:151], v[12:15]
    v_mfma_f32_16x16x32_bf16 v[12:15], v[40:43], a[152:155], v[12:15]
    v_mfma_f32_16x16x32_bf16 v[12:15], v[44:47], a[156:159], v[12:15]
    s_mov_b32 s56, 9
    s_branch L_aback1
L_aext8:
    v_dot2_f32_bf16 v20, v224, v4, 0
    v_dot2_f32_bf16 v21, v228, v4, 0
    v_dot2_f32_bf16 v22, v232, v4, 0
    v_dot2_f32_bf16 v23, v236, v4, 0
    v_dot2_f32_bf16 v20, v225, v5, v20
    v_dot2_f32_bf16 v21, v229, v5, v21
    v_dot2_f32_bf16 v22, v233, v5, v22
    v_dot2_f32_bf16 v23, v237, v5, v23
    v_dot2_f32_bf16 v20, v226, v6, v20
    v_dot2_f32_bf16 v21, v230, v6, v21
    v_dot2_f32_bf16 v22, v234, v6, v22
    v_dot2_f32_bf16 v23, v238, v6, v23
    v_dot2_f32_bf16 v20, v227, v7, v20
    v_dot2_f32_bf16 v21, v231, v7, v21
    v_dot2_f32_bf16 v22, v235, v7, v22
    v_dot2_f32_bf16 v23, v239, v7, v23
    v_add_f32_dpp v24, v20, v20 row_ror:8 row_mask:0xf bank_mask:0x3
    s_nop 0
    v_add_f32_dpp v25, v22, v22 row_ror:8 row_mask:0xf bank_mask:0x3
    v_add_f32_dpp v24, v21, v21 row_ror:8 row_mask:0xf bank_mask:0xc
    v_add_f32_dpp v25, v23, v23 row_ror:8 row_mask:0xf bank_mask:0xc
    s_nop 0
    v_add_f32_dpp v26, v24, v24 row_shl:4 row_mask:0xf bank_mask:0x5
    v_add_f32_dpp v26, v25, v25 row_shr:4 row_mask:0xf bank_mask:0xa
    s_nop 1
    v_add_f32_dpp v26, v26, v26 quad_perm:[1,0,3,2] row_mask:0xf bank_mask:0xf
    s_nop 1
    v_add_f32_dpp v26, v26, v26 quad_perm:[2,3,0,1] row_mask:0xf bank_mask:0xf
    v_cvt_pk_bf16_f32 v26, v26, v26
    v_and_b32 v26, s98, v26
    v_mul_f32 v26, s96, v26
    v_cvt_pk_bf16_f32 v26, v26, v26
    v_and_b32 v26, s98, v26
    s_nop 1
    v_max_f32_dpp v27, v26, v26 row_ror:4 row_mask:0xf bank_mask:0xf
    s_nop 1
    v_max_f32_dpp v27, v27, v27 row_ror:8 row_mask:0xf bank_mask:0xf
    v_mov_b32 v28, v27
    s_nop 1
    v_permlane16_swap_b32 v27, v28
    v_max_f32 v27, v27, v28
    v_mov_b32 v28, v27
    s_nop 1
    v_permlane32_swap_b32 v27, v28
    v_max3_f32 v27, v27, v28, v16
    v_sub_f32 v28, v16, v27
    v_sub_f32 v29, v26, v27
    v_mul_f32 v28, s97, v28
    v_mul_f32 v29, s97, v29
    v_exp_f32 v28, v28
    v_exp_f32 v29, v29
    v_mov_b32 v16, v27
    v_fma_f32 v17, v17, v28, v29
    v_cvt_pk_bf16_f32 v29, v29, v29
    v_mul_f32 v12, v12, v28
    v_mul_f32 v13, v13, v28
    v_mul_f32 v14, v14, v28
    v_mul_f32 v15, v15, v28
    v_and_b32_dpp v32, v29, v8 row_newbcast:0 row_mask:0xf bank_mask:0xf
    v_and_b32_dpp v33, v29, v9 row_newbcast:0 row_mask:0xf bank_mask:0xf
    v_and_b32_dpp v34, v29, v10 row_newbcast:0 row_mask:0xf bank_mask:0xf
    v_and_b32_dpp v35, v29, v11 row_newbcast:0 row_mask:0xf bank_mask:0xf
    v_and_b32_dpp v36, v29, v8 row_newbcast:8 row_mask:0xf bank_mask:0xf
    v_and_b32_dpp v37, v29, v9 row_newbcast:8 row_mask:0xf bank_mask:0xf
    v_and_b32_dpp v38, v29, v10 row_newbcast:8 row_mask:0xf bank_mask:0xf
    v_and_b32_dpp v39, v29, v11 row_newbcast:8 row_mask:0xf bank_mask:0xf
    v_and_b32_dpp v40, v29, v8 row_newbcast:4 row_mask:0xf bank_mask:0xf
    v_and_b32_dpp v41, v29, v9 row_newbcast:4 row_mask:0xf bank_mask:0xf
    v_and_b32_dpp v42, v29, v10 row_newbcast:4 row_mask:0xf bank_mask:0xf
    v_and_b32_dpp v43, v29, v11 row_newbcast:4 row_mask:0xf bank_mask:0xf
    v_and_b32_dpp v44, v29, v8 row_newbcast:12 row_mask:0xf bank_mask:0xf
    v_and_b32_dpp v45, v29, v9 row_newbcast:12 row_mask:0xf bank_mask:0xf
    v_and_b32_dpp v46, v29, v10 row_newbcast:12 row_mask:0xf bank_mask:0xf
    v_and_b32_dpp v47, v29, v11 row_newbcast:12 row_mask:0xf bank_mask:0xf
    v_mfma_f32_16x16x32_bf16 v[12:15], v[32:35], a[160:163], v[12:15]
    v_mfma_f32_16x16x32_bf16 v[12:15], v[36:39], a[164:167], v[12:15]
    v_mfma_f32_16x16x32_bf16 v[12:15], v[40:43], a[168:171], v[12:15]
    v_mfma_f32_16x16x32_bf16 v[12:15], v[44:47], a[172:175], v[12:15]
    s_mov_b32 s56, 10
    s_branch L_aback0
L_aext9:
    v_dot2_f32_bf16 v20, v240, v4, 0
    v_dot2_f32_bf16 v21, v244, v4, 0
    v_dot2_f32_bf16 v22, v248, v4, 0
    v_dot2_f32_bf16 v23, v252, v4, 0
    v_dot2_f32_bf16 v20, v241, v5, v20
    v_dot2_f32_bf16 v21, v245, v5, v21
    v_dot2_f32_bf16 v22, v249, v5, v22
    v_dot2_f32_bf16 v23, v253, v5, v23
    v_dot2_f32_bf16 v20, v242, v6, v20
    v_dot2_f32_bf16 v21, v246, v6, v21
    v_dot2_f32_bf16 v22, v250, v6, v22
    v_dot2_f32_bf16 v23, v254, v6, v23
    v_dot2_f32_bf16 v20, v243, v7, v20
    v_dot2_f32_bf16 v21, v247, v7, v21
    v_dot2_f32_bf16 v22, v251, v7, v22
    v_dot2_f32_bf16 v23, v255, v7, v23
    v_add_f32_dpp v24, v20, v20 row_ror:8 row_mask:0xf bank_mask:0x3
    s_nop 0
    v_add_f32_dpp v25, v22, v22 row_ror:8 row_mask:0xf bank_mask:0x3
    v_add_f32_dpp v24, v21, v21 row_ror:8 row_mask:0xf bank_mask:0xc
    v_add_f32_dpp v25, v23, v23 row_ror:8 row_mask:0xf bank_mask:0xc
    s_nop 0
    v_add_f32_dpp v26, v24, v24 row_shl:4 row_mask:0xf bank_mask:0x5
    v_add_f32_dpp v26, v25, v25 row_shr:4 row_mask:0xf bank_mask:0xa
    s_nop 1
    v_add_f32_dpp v26, v26, v26 quad_perm:[1,0,3,2] row_mask:0xf bank_mask:0xf
    s_nop 1
    v_add_f32_dpp v26, v26, v26 quad_perm:[2,3,0,1] row_mask:0xf bank_mask:0xf
    v_cvt_pk_bf16_f32 v26, v26, v26
    v_and_b32 v26, s98, v26
    v_mul_f32 v26, s96, v26
    v_cvt_pk_bf16_f32 v26, v26, v26
    v_and_b32 v26, s98, v26
    s_nop 1
    v_max_f32_dpp v27, v26, v26 row_ror:4 row_mask:0xf bank_mask:0xf
    s_nop 1
    v_max_f32_dpp v27, v27, v27 row_ror:8 row_mask:0xf bank_mask:0xf
    v_mov_b32 v28, v27
    s_nop 1
    v_permlane16_swap_b32 v27, v28
    v_max_f32 v27, v27, v28
    v_mov_b32 v28, v27
    s_nop 1
    v_permlane32_swap_b32 v27, v28
    v_max3_f32 v27, v27, v28, v16
    v_sub_f32 v28, v16, v27
    v_sub_f32 v29, v26, v27
    v_mul_f32 v28, s97, v28
    v_mul_f32 v29, s97, v29
    v_exp_f32 v28, v28
    v_exp_f32 v29, v29
    v_mov_b32 v16, v27
    v_fma_f32 v17, v17, v28, v29
    v_cvt_pk_bf16_f32 v29, v29, v29
    v_mul_f32 v12, v12, v28
    v_mul_f32 v13, v13, v28
    v_mul_f32 v14, v14, v28
    v_mul_f32 v15, v15, v28
    v_and_b32_dpp v32, v29, v8 row_newbcast:0 row_mask:0xf bank_mask:0xf
    v_and_b32_dpp v33, v29, v9 row_newbcast:0 row_mask:0xf bank_mask:0xf
    v_and_b32_dpp v34, v29, v10 row_newbcast:0 row_mask:0xf bank_mask:0xf
    v_and_b32_dpp v35, v29, v11 row_newbcast:0 row_mask:0xf bank_mask:0xf
    v_and_b32_dpp v36, v29, v8 row_newbcast:8 row_mask:0xf bank_mask:0xf
    v_and_b32_dpp v37, v29, v9 row_newbcast:8 row_mask:0xf bank_mask:0xf
    v_and_b32_dpp v38, v29, v10 row_newbcast:8 row_mask:0xf bank_mask:0xf
    v_and_b32_dpp v39, v29, v11 row_newbcast:8 row_mask:0xf bank_mask:0xf
    v_and_b32_dpp v40, v29, v8 row_newbcast:4 row_mask:0xf bank_mask:0xf
    v_and_b32_dpp v41, v29, v9 row_newbcast:4 row_mask:0xf bank_mask:0xf
    v_and_b32_dpp v42, v29, v10 row_newbcast:4 row_mask:0xf bank_mask:0xf
    v_and_b32_dpp v43, v29, v11 row_newbcast:4 row_mask:0xf bank_mask:0xf
    v_and_b32_dpp v44, v29, v8 row_newbcast:12 row_mask:0xf bank_mask:0xf
    v_and_b32_dpp v45, v29, v9 row_newbcast:12 row_mask:0xf bank_mask:0xf
    v_and_b32_dpp v46, v29, v10 row_newbcast:12 row_mask:0xf bank_mask:0xf
    v_and_b32_dpp v47, v29, v11 row_newbcast:12 row_mask:0xf bank_mask:0xf
    v_mfma_f32_16x16x32_bf16 v[12:15], v[32:35], a[176:179], v[12:15]
    v_mfma_f32_16x16x32_bf16 v[12:15], v[36:39], a[180:183], v[12:15]
    v_mfma_f32_16x16x32_bf16 v[12:15], v[40:43], a[184:187], v[12:15]
    v_mfma_f32_16x16x32_bf16 v[12:15], v[44:47], a[188:191], v[12:15]
    s_mov_b32 s56, 0
    s_branch L_aback1
L_aflag:
    s_sleep 2
    global_load_dword v57, v58, s[28:29] sc1
    s_waitcnt vmcnt(0)
    v_cmp_gt_u32 vcc, 64, v57
    s_cbranch_vccz L_aflag_ok
    s_sub_u32 s101, s101, 1
    s_cbranch_scc0 L_aflag
    s_mov_b32 s101, 0
    s_branch L_aflag_ok
L_roleA_end:
L_roleH:
    s_mov_b32 s101, 100000
    s_getpc_b64 s[56:57]
L_pc_16:
    s_sub_u32 s56, s56, L_pc_16-L_roleH
    s_subb_u32 s57, s57, 0
    v_lshlrev_b32 v5, 7, v0
    v_min_u32 v6, L_roleH_end-L_roleH-4, v5
    global_load_dword v122, v6, s[56:57]
    v_mov_b32 v20, -1
    v_mov_b32 v21, -1
    v_mov_b32 v22, -1
    v_mov_b32 v23, -1
    v_mul_u32_u24 v7, 73728, v4
    v_lshrrev_b32 v5, 3, v3
    v_lshl_add_u32 v6, v5, 13, v7
    v_and_b32 v5, 7, v3
    v_lshl_add_u32 v6, v5, 4, v6
    v_lshl_add_u32 v7, v3, 3, v7
    v_add_u32 v7, 65536, v7
    s_lshl_b32 s56, s52, 7
    s_add_u32 s56, s56, 4718592
    s_lshl_b32 s54, s3, 14
    s_add_u32 s54, s54, s56
    s_add_u32 s55, s54, 4096
    s_and_b32 s57, s3, 1
    s_lshl_b32 s57, s57, 12
    s_add_u32 s56, s56, s57
    s_waitcnt lgkmcnt(0)
    s_mov_b32 s44, s30
    s_mov_b32 s45, s31
    s_mov_b32 s46, 536870912
    s_mov_b32 s47, 0x20000
    buffer_store_dwordx4 v[20:23], v6, s[44:47], s54 offen sc1
    buffer_store_dwordx4 v[20:23], v6, s[44:47], s55 offen sc1
    buffer_store_dwordx2 v[20:21], v7, s[44:47], s56 offen sc1
    v_lshrrev_b32 v5, 2, v3
    v_lshlrev_b32 v5, 15, v5
    v_lshl_add_u32 v5, v4, 4, v5
    v_and_b32 v6, 3, v3
    v_lshl_add_u32 v5, v6, 6, v5
    s_lshl_b32 s54, s52, 10
    s_lshl_b32 s55, s3, 8
    s_add_u32 s54, s54, s55
    s_add_u32 s54, s54, 1048576
    buffer_store_dwordx4 v[20:23], v5, s[44:47], s54 offen sc1
    v_bfe_u32 v6, v1, 2, 2
    v_lshlrev_b32 v6, 6, v6
    v_and_b32 v5, 48, v1
    v_add_u32 v6, v6, v5
    v_and_b32 v5, 3, v1
    v_lshl_add_u32 v6, v5, 29, v6
    s_lshl_b32 s54, s52, 10
    s_lshl_b32 s55, s3, 8
    s_add_u32 s54, s54, s55
    s_add_u32 s54, s54, 5439488
    buffer_store_dwordx4 v[20:23], v6, s[44:47], s54 offen sc1
    s_mov_b32 s32, s18
    s_mov_b32 s33, s19
    s_mov_b32 s34, 4718592
    s_mov_b32 s35, 0x20000
    s_mov_b32 s36, s14
    s_mov_b32 s37, s15
    s_mov_b32 s38, 4608
    s_mov_b32 s39, 0x20000
    v_lshrrev_b32 v5, 3, v3
    v_mul_u32_u24 v5, 1152, v5
    v_mul_u32_u24 v6, 72, v4
    v_add_u32 v5, v5, v6
    s_mul_i32 s54, s3, 288
    buffer_load_dwordx4 v[48:51], v5, s[36:39], s54 offen offset:0
    buffer_load_dwordx4 v[52:55], v5, s[36:39], s54 offen offset:16
    buffer_load_dwordx4 v[56:59], v5, s[36:39], s54 offen offset:32
    buffer_load_dwordx4 v[60:63], v5, s[36:39], s54 offen offset:48
    buffer_load_dwordx2 v[64:65], v5, s[36:39], s54 offen offset:64
    buffer_load_dwordx4 v[68:71], v5, s[36:39], s54 offen offset:2304
    buffer_load_dwordx4 v[72:75], v5, s[36:39], s54 offen offset:2320
    buffer_load_dwordx4 v[76:79], v5, s[36:39], s54 offen offset:2336
    buffer_load_dwordx4 v[80:83], v5, s[36:39], s54 offen offset:2352
    buffer_load_dwordx2 v[84:85], v5, s[36:39], s54 offen offset:2368
    v_mul_u32_u24 v120, 294912, v4
    v_lshl_add_u32 v120, v3, 4, v120
    s_mul_i32 s61, s3, 1179648
    s_lshl_b32 s54, s52, 8
    s_add_u32 s61, s61, s54
    buffer_load_dwordx4 a[112:115], v120, s[32:35], s61 offen nt
    s_add_u32 s61, s61, 8192
    buffer_load_dwordx4 a[116:119], v120, s[32:35], s61 offen nt
    s_add_u32 s61, s61, 8192
    buffer_load_dwordx4 a[120:123], v120, s[32:35], s61 offen nt
    s_add_u32 s61, s61, 8192
    buffer_load_dwordx4 a[124:127], v120, s[32:35], s61 offen nt
    s_add_u32 s61, s61, 8192
    buffer_load_dwordx4 a[128:131], v120, s[32:35], s61 offen nt
    s_add_u32 s61, s61, 8192
    buffer_load_dwordx4 a[132:135], v120, s[32:35], s61 offen nt
    s_add_u32 s61, s61, 8192
    buffer_load_dwordx4 a[136:139], v120, s[32:35], s61 offen nt
    s_add_u32 s61, s61, 8192
    buffer_load_dwordx4 a[140:143], v120, s[32:35], s61 offen nt
    s_add_u32 s61, s61, 8192
    buffer_load_dwordx4 a[144:147], v120, s[32:35], s61 offen nt
    s_add_u32 s61, s61, 8192
    s_waitcnt vmcnt(19)
    s_barrier
    s_cmp_lg_u32 s3, 0
    s_cbranch_scc1 L_nosig_17
    s_mov_b32 s97, 1
    s_atomic_add s97, s[28:29], 0 glc
L_nosig_17:
    buffer_load_dwordx4 a[148:151], v120, s[32:35], s61 offen nt
    s_add_u32 s61, s61, 8192
    buffer_load_dwordx4 a[152:155], v120, s[32:35], s61 offen nt
    s_add_u32 s61, s61, 8192
    buffer_load_dwordx4 a[156:159], v120, s[32:35], s61 offen nt
    s_add_u32 s61, s61, 8192
    buffer_load_dwordx4 a[160:163], v120, s[32:35], s61 offen nt
    s_add_u32 s61, s61, 8192
    buffer_load_dwordx4 a[164:167], v120, s[32:35], s61 offen nt
    s_add_u32 s61, s61, 8192
    buffer_load_dwordx4 a[168:171], v120, s[32:35], s61 offen nt
    s_add_u32 s61, s61, 8192
    buffer_load_dwordx4 a[172:175], v120, s[32:35], s61 offen nt
    s_add_u32 s61, s61, 8192
    buffer_load_dwordx4 a[176:179], v120, s[32:35], s61 offen nt
    s_add_u32 s61, s61, 8192
    buffer_load_dwordx4 a[180:183], v120, s[32:35], s61 offen nt
    s_add_u32 s61, s61, 8192
    s_mov_b32 s36, s20
    s_mov_b32 s37, s21
    s_mov_b32 s38, 4194304
    s_mov_b32 s39, 0x20000
    s_mov_b32 s40, s22
    s_mov_b32 s41, s23
    s_mov_b32 s42, 4194304
    s_mov_b32 s43, 0x20000
    v_lshlrev_b32 v5, 2, v4
    v_xor_b32 v5, v5, v3
    v_lshlrev_b32 v6, 13, v4
    v_xor_b32 v7, 0, v5
    v_lshl_add_u32 v88, v7, 4, v6
    v_xor_b32 v7, 1, v5
    v_lshl_add_u32 v89, v7, 4, v6
    v_xor_b32 v7, 2, v5
    v_lshl_add_u32 v90, v7, 4, v6
    v_xor_b32 v7, 3, v5
    v_lshl_add_u32 v91, v7, 4, v6
    s_lshl_b32 s62, s3, 20
    s_lshl_b32 s54, s52, 8
    s_add_u32 s62, s62, s54
    s_mov_b32 s60, s62
    s_lshl_b32 s63, s3, 15
    v_lshlrev_b32 v121, 18, v4
    v_lshl_add_u32 v121, v3, 4, v121
    v_lshrrev_b32 v5, 2, v3
    v_and_b32 v6, 3, v3
    v_lshl_add_u32 v7, v5, 3, v6
    v_lshlrev_b32 v92, 8, v7
    v_lshl_or_b32 v5, v6, 2, v5
    v_xor_b32 v5, v5, v4
    v_lshl_add_u32 v92, v5, 4, v92
    v_add_u32 v92, s63, v92
    v_xor_b32 v93, 64, v92
    v_xor_b32 v94, 128, v92
    v_xor_b32 v95, 192, v92
    v_and_b32 v5, 1, v3
    v_cmp_eq_u32 vcc, 1, v5
    v_mov_b32 v5, 0x0c0c0100
    v_mov_b32 v6, 0x01000c0c
    v_cndmask_b32 v5, v5, v6, vcc
    v_mov_b32 v6, 0x0c0c0302
    v_mov_b32 v7, 0x03020c0c
    v_cndmask_b32 v6, v6, v7, vcc
    v_bfe_u32 v7, v3, 1, 2
    v_mov_b32 v16, 0x0c0c0c0c
    v_cmp_eq_u32 vcc, 0, v7
    s_nop 1
    v_cndmask_b32 v8, v16, v5, vcc
    v_cndmask_b32 v9, v16, v6, vcc
    v_cmp_eq_u32 vcc, 1, v7
    s_nop 1
    v_cndmask_b32 v10, v16, v5, vcc
    v_cndmask_b32 v11, v16, v6, vcc
    v_cmp_eq_u32 vcc, 2, v7
    s_nop 1
    v_cndmask_b32 v12, v16, v5, vcc
    v_cndmask_b32 v13, v16, v6, vcc
    v_cmp_eq_u32 vcc, 3, v7
    s_nop 1
    v_cndmask_b32 v14, v16, v5, vcc
    v_cndmask_b32 v15, v16, v6, vcc
    s_waitcnt vmcnt(9)
    buffer_load_dwordx4 a[184:187], v120, s[32:35], s61 offen nt
    s_add_u32 s61, s61, 8192
    buffer_load_dwordx4 a[188:191], v120, s[32:35], s61 offen nt
    s_add_u32 s61, s61, 8192
    buffer_load_dwordx4 a[192:195], v120, s[32:35], s61 offen nt
    s_add_u32 s61, s61, 8192
    buffer_load_dwordx4 a[196:199], v120, s[32:35], s61 offen nt
    s_add_u32 s61, s61, 8192
    buffer_load_dwordx4 a[200:203], v120, s[32:35], s61 offen nt
    s_add_u32 s61, s61, 8192
    buffer_load_dwordx4 a[204:207], v120, s[32:35], s61 offen nt
    s_add_u32 s61, s61, 8192
    buffer_load_dwordx4 a[208:211], v120, s[32:35], s61 offen nt
    s_add_u32 s61, s61, 8192
    buffer_load_dwordx4 a[212:215], v120, s[32:35], s61 offen nt
    s_add_u32 s61, s61, 8192
    buffer_load_dwordx4 a[216:219], v120, s[32:35], s61 offen nt
    s_add_u32 s61, s61, 8192
    buffer_load_dwordx4 a[220:223], v120, s[32:35], s61 offen nt
    s_add_u32 s61, s61, 8192
    buffer_load_dwordx4 a[224:227], v120, s[32:35], s61 offen nt
    s_add_u32 s61, s61, 8192
    buffer_load_dwordx4 a[228:231], v120, s[32:35], s61 offen nt
    s_add_u32 s61, s61, 8192
    buffer_load_dwordx4 a[232:235], v120, s[32:35], s61 offen nt
    s_add_u32 s61, s61, 8192
    buffer_load_dwordx4 a[236:239], v120, s[32:35], s61 offen nt
    s_add_u32 s61, s61, 8192
    buffer_load_dwordx4 a[240:243], v120, s[32:35], s61 offen nt
    s_add_u32 s61, s61, 8192
    buffer_load_dwordx4 a[244:247], v120, s[32:35], s61 offen nt
    s_add_u32 s61, s61, 8192
    buffer_load_dwordx4 a[248:251], v120, s[32:35], s61 offen nt
    s_add_u32 s61, s61, 8192
    buffer_load_dwordx4 a[252:255], v120, s[32:35], s61 offen nt
    s_add_u32 s61, s61, 8192
    s_add_u32 m0, s63, 0
    s_nop 0
    buffer_load_dwordx4 v88, s[36:39], s60 offen nt lds
    s_add_u32 s60, s60, 32768
    v_perm_b32 v96, v48, v48, v8
    v_perm_b32 v97, v48, v48, v10
    v_perm_b32 v98, v48, v48, v12
    v_perm_b32 v99, v48, v48, v14
    s_nop 1
    v_mfma_f32_16x16x32_bf16 v[112:115], v[96:99], a[112:115], 0
    v_perm_b32 v100, v68, v68, v8
    v_perm_b32 v101, v68, v68, v10
    v_perm_b32 v102, v68, v68, v12
    v_perm_b32 v103, v68, v68, v14
    s_nop 1
    v_mfma_f32_16x16x32_bf16 v[116:119], v[100:103], a[112:115], 0
    v_perm_b32 v104, v48, v48, v9
    v_perm_b32 v105, v48, v48, v11
    v_perm_b32 v106, v48, v48, v13
    v_perm_b32 v107, v48, v48, v15
    s_nop 1
    v_mfma_f32_16x16x32_bf16 v[112:115], v[104:107], a[116:119], v[112:115]
    v_perm_b32 v108, v68, v68, v9
    v_perm_b32 v109, v68, v68, v11
    v_perm_b32 v110, v68, v68, v13
    v_perm_b32 v111, v68, v68, v15
    s_nop 1
    v_mfma_f32_16x16x32_bf16 v[116:119], v[108:111], a[116:119], v[116:119]
    v_perm_b32 v96, v49, v49, v8
    v_perm_b32 v97, v49, v49, v10
    v_perm_b32 v98, v49, v49, v12
    v_perm_b32 v99, v49, v49, v14
    s_nop 1
    v_mfma_f32_16x16x32_bf16 v[112:115], v[96:99], a[120:123], v[112:115]
    v_perm_b32 v100, v69, v69, v8
    v_perm_b32 v101, v69, v69, v10
    v_perm_b32 v102, v69, v69, v12
    v_perm_b32 v103, v69, v69, v14
    s_nop 1
    v_mfma_f32_16x16x32_bf16 v[116:119], v[100:103], a[120:123], v[116:119]
    v_perm_b32 v104, v49, v49, v9
    v_perm_b32 v105, v49, v49, v11
    v_perm_b32 v106, v49, v49, v13
    v_perm_b32 v107, v49, v49, v15
    s_nop 1
    v_mfma_f32_16x16x32_bf16 v[112:115], v[104:107], a[124:127], v[112:115]
    v_perm_b32 v108, v69, v69, v9
    v_perm_b32 v109, v69, v69, v11
    v_perm_b32 v110, v69, v69, v13
    v_perm_b32 v111, v69, v69, v15
    s_nop 1
    v_mfma_f32_16x16x32_bf16 v[116:119], v[108:111], a[124:127], v[116:119]
    v_perm_b32 v96, v50, v50, v8
    v_perm_b32 v97, v50, v50, v10
    v_perm_b32 v98, v50, v50, v12
    v_perm_b32 v99, v50, v50, v14
    s_nop 1
    v_mfma_f32_16x16x32_bf16 v[112:115], v[96:99], a[128:131], v[112:115]
    v_perm_b32 v100, v70, v70, v8
    v_perm_b32 v101, v70, v70, v10
    v_perm_b32 v102, v70, v70, v12
    v_perm_b32 v103, v70, v70, v14
    s_nop 1
    v_mfma_f32_16x16x32_bf16 v[116:119], v[100:103], a[128:131], v[116:119]
    v_perm_b32 v104, v50, v50, v9
    v_perm_b32 v105, v50, v50, v11
    v_perm_b32 v106, v50, v50, v13
    v_perm_b32 v107, v50, v50, v15
    s_nop 1
    v_mfma_f32_16x16x32_bf16 v[112:115], v[104:107], a[132:135], v[112:115]
    v_perm_b32 v108, v70, v70, v9
    v_perm_b32 v109, v70, v70, v11
    v_perm_b32 v110, v70, v70, v13
    v_perm_b32 v111, v70, v70, v15
    s_nop 1
    v_mfma_f32_16x16x32_bf16 v[116:119], v[108:111], a[132:135], v[116:119]
    v_perm_b32 v96, v51, v51, v8
    v_perm_b32 v97, v51, v51, v10
    v_perm_b32 v98, v51, v51, v12
    v_perm_b32 v99, v51, v51, v14
    s_nop 1
    v_mfma_f32_16x16x32_bf16 v[112:115], v[96:99], a[136:139], v[112:115]
    v_perm_b32 v100, v71, v71, v8
    v_perm_b32 v101, v71, v71, v10
    v_perm_b32 v102, v71, v71, v12
    v_perm_b32 v103, v71, v71, v14
    s_nop 1
    v_mfma_f32_16x16x32_bf16 v[116:119], v[100:103], a[136:139], v[116:119]
    v_perm_b32 v104, v51, v51, v9
    v_perm_b32 v105, v51, v51, v11
    v_perm_b32 v106, v51, v51, v13
    v_perm_b32 v107, v51, v51, v15
    s_nop 1
    v_mfma_f32_16x16x32_bf16 v[112:115], v[104:107], a[140:143], v[112:115]
    v_perm_b32 v108, v71, v71, v9
    v_perm_b32 v109, v71, v71, v11
    v_perm_b32 v110, v71, v71, v13
    v_perm_b32 v111, v71, v71, v15
    s_nop 1
    v_mfma_f32_16x16x32_bf16 v[116:119], v[108:111], a[140:143], v[116:119]
    v_perm_b32 v96, v52, v52, v8
    v_perm_b32 v97, v52, v52, v10
    v_perm_b32 v98, v52, v52, v12
    v_perm_b32 v99, v52, v52, v14
    s_nop 1
    v_mfma_f32_16x16x32_bf16 v[112:115], v[96:99], a[144:147], v[112:115]
    v_perm_b32 v100, v72, v72, v8
    v_perm_b32 v101, v72, v72, v10
    v_perm_b32 v102, v72, v72, v12
    v_perm_b32 v103, v72, v72, v14
    s_nop 1
    v_mfma_f32_16x16x32_bf16 v[116:119], v[100:103], a[144:147], v[116:119]
    s_waitcnt vmcnt(19)
    s_add_u32 m0, s63, 1024
    s_nop 0
    buffer_load_dwordx4 v88, s[36:39], s60 offen nt lds
    s_add_u32 s60, s60, 32768
    s_add_u32 m0, s63, 2048
    s_nop 0
    buffer_load_dwordx4 v89, s[36:39], s60 offen nt lds
    s_add_u32 s60, s60, 32768
    s_add_u32 m0, s63, 3072
    s_nop 0
    buffer_load_dwordx4 v89, s[36:39], s60 offen nt lds
    s_add_u32 s60, s60, 32768
    s_add_u32 m0, s63, 4096
    s_nop 0
    buffer_load_dwordx4 v90, s[36:39], s60 offen nt lds
    s_add_u32 s60, s60, 32768
    s_add_u32 m0, s63, 5120
    s_nop 0
    buffer_load_dwordx4 v90, s[36:39], s60 offen nt lds
    s_add_u32 s60, s60, 32768
    s_add_u32 m0, s63, 6144
    s_nop 0
    buffer_load_dwordx4 v91, s[36:39], s60 offen nt lds
    s_add_u32 s60, s60, 32768
    s_add_u32 m0, s63, 7168
    s_nop 0
    buffer_load_dwordx4 v91, s[36:39], s60 offen nt lds
    s_add_u32 s60, s60, 32768
    s_add_u32 m0, s63, 8192
    s_nop 0
    buffer_load_dwordx4 v88, s[36:39], s60 offen nt lds
    s_add_u32 s60, s60, 32768
    s_add_u32 m0, s63, 9216
    s_nop 0
    buffer_load_dwordx4 v88, s[36:39], s60 offen nt lds
    s_add_u32 s60, s60, 32768
    v_perm_b32 v104, v52, v52, v9
    v_perm_b32 v105, v52, v52, v11
    v_perm_b32 v106, v52, v52, v13
    v_perm_b32 v107, v52, v52, v15
    s_nop 1
    v_mfma_f32_16x16x32_bf16 v[112:115], v[104:107], a[148:151], v[112:115]
    v_perm_b32 v108, v72, v72, v9
    v_perm_b32 v109, v72, v72, v11
    v_perm_b32 v110, v72, v72, v13
    v_perm_b32 v111, v72, v72, v15
    s_nop 1
    v_mfma_f32_16x16x32_bf16 v[116:119], v[108:111], a[148:151], v[116:119]
    v_perm_b32 v96, v53, v53, v8
    v_perm_b32 v97, v53, v53, v10
    v_perm_b32 v98, v53, v53, v12
    v_perm_b32 v99, v53, v53, v14
    s_nop 1
    v_mfma_f32_16x16x32_bf16 v[112:115], v[96:99], a[152:155], v[112:115]
    v_perm_b32 v100, v73, v73, v8
    v_perm_b32 v101, v73, v73, v10
    v_perm_b32 v102, v73, v73, v12
    v_perm_b32 v103, v73, v73, v14
    s_nop 1
    v_mfma_f32_16x16x32_bf16 v[116:119], v[100:103], a[152:155], v[116:119]
    v_perm_b32 v104, v53, v53, v9
    v_perm_b32 v105, v53, v53, v11
    v_perm_b32 v106, v53, v53, v13
    v_perm_b32 v107, v53, v53, v15
    s_nop 1
    v_mfma_f32_16x16x32_bf16 v[112:115], v[104:107], a[156:159], v[112:115]
    v_perm_b32 v108, v73, v73, v9
    v_perm_b32 v109, v73, v73, v11
    v_perm_b32 v110, v73, v73, v13
    v_perm_b32 v111, v73, v73, v15
    s_nop 1
    v_mfma_f32_16x16x32_bf16 v[116:119], v[108:111], a[156:159], v[116:119]
    v_perm_b32 v96, v54, v54, v8
    v_perm_b32 v97, v54, v54, v10
    v_perm_b32 v98, v54, v54, v12
    v_perm_b32 v99, v54, v54, v14
    s_nop 1
    v_mfma_f32_16x16x32_bf16 v[112:115], v[96:99], a[160:163], v[112:115]
    v_perm_b32 v100, v74, v74, v8
    v_perm_b32 v101, v74, v74, v10
    v_perm_b32 v102, v74, v74, v12
    v_perm_b32 v103, v74, v74, v14
    s_nop 1
    v_mfma_f32_16x16x32_bf16 v[116:119], v[100:103], a[160:163], v[116:119]
    v_perm_b32 v104, v54, v54, v9
    v_perm_b32 v105, v54, v54, v11
    v_perm_b32 v106, v54, v54, v13
    v_perm_b32 v107, v54, v54, v15
    s_nop 1
    v_mfma_f32_16x16x32_bf16 v[112:115], v[104:107], a[164:167], v[112:115]
    v_perm_b32 v108, v74, v74, v9
    v_perm_b32 v109, v74, v74, v11
    v_perm_b32 v110, v74, v74, v13
    v_perm_b32 v111, v74, v74, v15
    s_nop 1
    v_mfma_f32_16x16x32_bf16 v[116:119], v[108:111], a[164:167], v[116:119]
    v_perm_b32 v96, v55, v55, v8
    v_perm_b32 v97, v55, v55, v10
    v_perm_b32 v98, v55, v55, v12
    v_perm_b32 v99, v55, v55, v14
    s_nop 1
    v_mfma_f32_16x16x32_bf16 v[112:115], v[96:99], a[168:171], v[112:115]
    v_perm_b32 v100, v75, v75, v8
    v_perm_b32 v101, v75, v75, v10
    v_perm_b32 v102, v75, v75, v12
    v_perm_b32 v103, v75, v75, v14
    s_nop 1
    v_mfma_f32_16x16x32_bf16 v[116:119], v[100:103], a[168:171], v[116:119]
    v_perm_b32 v104, v55, v55, v9
    v_perm_b32 v105, v55, v55, v11
    v_perm_b32 v106, v55, v55, v13
    v_perm_b32 v107, v55, v55, v15
    s_nop 1
    v_mfma_f32_16x16x32_bf16 v[112:115], v[104:107], a[172:175], v[112:115]
    v_perm_b32 v108, v75, v75, v9
    v_perm_b32 v109, v75, v75, v11
    v_perm_b32 v110, v75, v75, v13
    v_perm_b32 v111, v75, v75, v15
    s_nop 1
    v_mfma_f32_16x16x32_bf16 v[116:119], v[108:111], a[172:175], v[116:119]
    v_perm_b32 v96, v56, v56, v8
    v_perm_b32 v97, v56, v56, v10
    v_perm_b32 v98, v56, v56, v12
    v_perm_b32 v99, v56, v56, v14
    s_nop 1
    v_mfma_f32_16x16x32_bf16 v[112:115], v[96:99], a[176:179], v[112:115]
    v_perm_b32 v100, v76, v76, v8
    v_perm_b32 v101, v76, v76, v10
    v_perm_b32 v102, v76, v76, v12
    v_perm_b32 v103, v76, v76, v14
    s_nop 1
    v_mfma_f32_16x16x32_bf16 v[116:119], v[100:103], a[176:179], v[116:119]
    v_perm_b32 v104, v56, v56, v9
    v_perm_b32 v105, v56, v56, v11
    v_perm_b32 v106, v56, v56, v13
    v_perm_b32 v107, v56, v56, v15
    s_nop 1
    v_mfma_f32_16x16x32_bf16 v[112:115], v[104:107], a[180:183], v[112:115]
    v_perm_b32 v108, v76, v76, v9
    v_perm_b32 v109, v76, v76, v11
    v_perm_b32 v110, v76, v76, v13
    v_perm_b32 v111, v76, v76, v15
    s_nop 1
    v_mfma_f32_16x16x32_bf16 v[116:119], v[108:111], a[180:183], v[116:119]
    s_waitcnt vmcnt(19)
    s_add_u32 m0, s63, 10240
    s_nop 0
    buffer_load_dwordx4 v89, s[36:39], s60 offen nt lds
    s_add_u32 s60, s60, 32768
    s_add_u32 m0, s63, 11264
    s_nop 0
    buffer_load_dwordx4 v89, s[36:39], s60 offen nt lds
    s_add_u32 s60, s60, 32768
    s_add_u32 m0, s63, 12288
    s_nop 0
    buffer_load_dwordx4 v90, s[36:39], s60 offen nt lds
    s_add_u32 s60, s60, 32768
    s_add_u32 m0, s63, 13312
    s_nop 0
    buffer_load_dwordx4 v90, s[36:39], s60 offen nt lds
    s_add_u32 s60, s60, 32768
    s_add_u32 m0, s63, 14336
    s_nop 0
    buffer_load_dwordx4 v91, s[36:39], s60 offen nt lds
    s_add_u32 s60, s60, 32768
    s_add_u32 m0, s63, 15360
    s_nop 0
    buffer_load_dwordx4 v91, s[36:39], s60 offen nt lds
    s_add_u32 s60, s60, 32768
    s_add_u32 m0, s63, 16384
    s_nop 0
    buffer_load_dwordx4 v88, s[36:39], s60 offen nt lds
    s_add_u32 s60, s60, 32768
    s_add_u32 m0, s63, 17408
    s_nop 0
    buffer_load_dwordx4 v88, s[36:39], s60 offen nt lds
    s_add_u32 s60, s60, 32768
    s_add_u32 m0, s63, 18432
    s_nop 0
    buffer_load_dwordx4 v89, s[36:39], s60 offen nt lds
    s_add_u32 s60, s60, 32768
    v_perm_b32 v96, v57, v57, v8
    v_perm_b32 v97, v57, v57, v10
    v_perm_b32 v98, v57, v57, v12
    v_perm_b32 v99, v57, v57, v14
    s_nop 1
    v_mfma_f32_16x16x32_bf16 v[112:115], v[96:99], a[184:187], v[112:115]
    v_perm_b32 v100, v77, v77, v8
    v_perm_b32 v101, v77, v77, v10
    v_perm_b32 v102, v77, v77, v12
    v_perm_b32 v103, v77, v77, v14
    s_nop 1
    v_mfma_f32_16x16x32_bf16 v[116:119], v[100:103], a[184:187], v[116:119]
    v_perm_b32 v104, v57, v57, v9
    v_perm_b32 v105, v57, v57, v11
    v_perm_b32 v106, v57, v57, v13
    v_perm_b32 v107, v57, v57, v15
    s_nop 1
    v_mfma_f32_16x16x32_bf16 v[112:115], v[104:107], a[188:191], v[112:115]
    v_perm_b32 v108, v77, v77, v9
    v_perm_b32 v109, v77, v77, v11
    v_perm_b32 v110, v77, v77, v13
    v_perm_b32 v111, v77, v77, v15
    s_nop 1
    v_mfma_f32_16x16x32_bf16 v[116:119], v[108:111], a[188:191], v[116:119]
    v_perm_b32 v96, v58, v58, v8
    v_perm_b32 v97, v58, v58, v10
    v_perm_b32 v98, v58, v58, v12
    v_perm_b32 v99, v58, v58, v14
    s_nop 1
    v_mfma_f32_16x16x32_bf16 v[112:115], v[96:99], a[192:195], v[112:115]
    v_perm_b32 v100, v78, v78, v8
    v_perm_b32 v101, v78, v78, v10
    v_perm_b32 v102, v78, v78, v12
    v_perm_b32 v103, v78, v78, v14
    s_nop 1
    v_mfma_f32_16x16x32_bf16 v[116:119], v[100:103], a[192:195], v[116:119]
    v_perm_b32 v104, v58, v58, v9
    v_perm_b32 v105, v58, v58, v11
    v_perm_b32 v106, v58, v58, v13
    v_perm_b32 v107, v58, v58, v15
    s_nop 1
    v_mfma_f32_16x16x32_bf16 v[112:115], v[104:107], a[196:199], v[112:115]
    v_perm_b32 v108, v78, v78, v9
    v_perm_b32 v109, v78, v78, v11
    v_perm_b32 v110, v78, v78, v13
    v_perm_b32 v111, v78, v78, v15
    s_nop 1
    v_mfma_f32_16x16x32_bf16 v[116:119], v[108:111], a[196:199], v[116:119]
    v_perm_b32 v96, v59, v59, v8
    v_perm_b32 v97, v59, v59, v10
    v_perm_b32 v98, v59, v59, v12
    v_perm_b32 v99, v59, v59, v14
    s_nop 1
    v_mfma_f32_16x16x32_bf16 v[112:115], v[96:99], a[200:203], v[112:115]
    v_perm_b32 v100, v79, v79, v8
    v_perm_b32 v101, v79, v79, v10
    v_perm_b32 v102, v79, v79, v12
    v_perm_b32 v103, v79, v79, v14
    s_nop 1
    v_mfma_f32_16x16x32_bf16 v[116:119], v[100:103], a[200:203], v[116:119]
    v_perm_b32 v104, v59, v59, v9
    v_perm_b32 v105, v59, v59, v11
    v_perm_b32 v106, v59, v59, v13
    v_perm_b32 v107, v59, v59, v15
    s_nop 1
    v_mfma_f32_16x16x32_bf16 v[112:115], v[104:107], a[204:207], v[112:115]
    v_perm_b32 v108, v79, v79, v9
    v_perm_b32 v109, v79, v79, v11
    v_perm_b32 v110, v79, v79, v13
    v_perm_b32 v111, v79, v79, v15
    s_nop 1
    v_mfma_f32_16x16x32_bf16 v[116:119], v[108:111], a[204:207], v[116:119]
    v_perm_b32 v96, v60, v60, v8
    v_perm_b32 v97, v60, v60, v10
    v_perm_b32 v98, v60, v60, v12
    v_perm_b32 v99, v60, v60, v14
    s_nop 1
    v_mfma_f32_16x16x32_bf16 v[112:115], v[96:99], a[208:211], v[112:115]
    v_perm_b32 v100, v80, v80, v8
    v_perm_b32 v101, v80, v80, v10
    v_perm_b32 v102, v80, v80, v12
    v_perm_b32 v103, v80, v80, v14
    s_nop 1
    v_mfma_f32_16x16x32_bf16 v[116:119], v[100:103], a[208:211], v[116:119]
    v_perm_b32 v104, v60, v60, v9
    v_perm_b32 v105, v60, v60, v11
    v_perm_b32 v106, v60, v60, v13
    v_perm_b32 v107, v60, v60, v15
    s_nop 1
    v_mfma_f32_16x16x32_bf16 v[112:115], v[104:107], a[212:215], v[112:115]
    v_perm_b32 v108, v80, v80, v9
    v_perm_b32 v109, v80, v80, v11
    v_perm_b32 v110, v80, v80, v13
    v_perm_b32 v111, v80, v80, v15
    s_nop 1
    v_mfma_f32_16x16x32_bf16 v[116:119], v[108:111], a[212:215], v[116:119]
    v_perm_b32 v96, v61, v61, v8
    v_perm_b32 v97, v61, v61, v10
    v_perm_b32 v98, v61, v61, v12
    v_perm_b32 v99, v61, v61, v14
    s_nop 1
    v_mfma_f32_16x16x32_bf16 v[112:115], v[96:99], a[216:219], v[112:115]
    v_perm_b32 v100, v81, v81, v8
    v_perm_b32 v101, v81, v81, v10
    v_perm_b32 v102, v81, v81, v12
    v_perm_b32 v103, v81, v81, v14
    s_nop 1
    v_mfma_f32_16x16x32_bf16 v[116:119], v[100:103], a[216:219], v[116:119]
    s_waitcnt vmcnt(19)
    s_add_u32 m0, s63, 19456
    s_nop 0
    buffer_load_dwordx4 v89, s[36:39], s60 offen nt lds
    s_add_u32 s60, s60, 32768
    s_add_u32 m0, s63, 20480
    s_nop 0
    buffer_load_dwordx4 v90, s[36:39], s60 offen nt lds
    s_add_u32 s60, s60, 32768
    s_add_u32 m0, s63, 21504
    s_nop 0
    buffer_load_dwordx4 v90, s[36:39], s60 offen nt lds
    s_add_u32 s60, s60, 32768
    s_add_u32 m0, s63, 22528
    s_nop 0
    buffer_load_dwordx4 v91, s[36:39], s60 offen nt lds
    s_add_u32 s60, s60, 32768
    s_add_u32 m0, s63, 23552
    s_nop 0
    buffer_load_dwordx4 v91, s[36:39], s60 offen nt lds
    s_add_u32 s60, s60, 32768
    s_add_u32 m0, s63, 24576
    s_nop 0
    buffer_load_dwordx4 v88, s[36:39], s60 offen nt lds
    s_add_u32 s60, s60, 32768
    s_add_u32 m0, s63, 25600
    s_nop 0
    buffer_load_dwordx4 v88, s[36:39], s60 offen nt lds
    s_add_u32 s60, s60, 32768
    s_add_u32 m0, s63, 26624
    s_nop 0
    buffer_load_dwordx4 v89, s[36:39], s60 offen nt lds
    s_add_u32 s60, s60, 32768
    s_add_u32 m0, s63, 27648
    s_nop 0
    buffer_load_dwordx4 v89, s[36:39], s60 offen nt lds
    s_add_u32 s60, s60, 32768
    v_perm_b32 v104, v61, v61, v9
    v_perm_b32 v105, v61, v61, v11
    v_perm_b32 v106, v61, v61, v13
    v_perm_b32 v107, v61, v61, v15
    s_nop 1
    v_mfma_f32_16x16x32_bf16 v[112:115], v[104:107], a[220:223], v[112:115]
    v_perm_b32 v108, v81, v81, v9
    v_perm_b32 v109, v81, v81, v11
    v_perm_b32 v110, v81, v81, v13
    v_perm_b32 v111, v81, v81, v15
    s_nop 1
    v_mfma_f32_16x16x32_bf16 v[116:119], v[108:111], a[220:223], v[116:119]
    v_perm_b32 v96, v62, v62, v8
    v_perm_b32 v97, v62, v62, v10
    v_perm_b32 v98, v62, v62, v12
    v_perm_b32 v99, v62, v62, v14
    s_nop 1
    v_mfma_f32_16x16x32_bf16 v[112:115], v[96:99], a[224:227], v[112:115]
    v_perm_b32 v100, v82, v82, v8
    v_perm_b32 v101, v82, v82, v10
    v_perm_b32 v102, v82, v82, v12
    v_perm_b32 v103, v82, v82, v14
    s_nop 1
    v_mfma_f32_16x16x32_bf16 v[116:119], v[100:103], a[224:227], v[116:119]
    v_perm_b32 v104, v62, v62, v9
    v_perm_b32 v105, v62, v62, v11
    v_perm_b32 v106, v62, v62, v13
    v_perm_b32 v107, v62, v62, v15
    s_nop 1
    v_mfma_f32_16x16x32_bf16 v[112:115], v[104:107], a[228:231], v[112:115]
    v_perm_b32 v108, v82, v82, v9
    v_perm_b32 v109, v82, v82, v11
    v_perm_b32 v110, v82, v82, v13
    v_perm_b32 v111, v82, v82, v15
    s_nop 1
    v_mfma_f32_16x16x32_bf16 v[116:119], v[108:111], a[228:231], v[116:119]
    v_perm_b32 v96, v63, v63, v8
    v_perm_b32 v97, v63, v63, v10
    v_perm_b32 v98, v63, v63, v12
    v_perm_b32 v99, v63, v63, v14
    s_nop 1
    v_mfma_f32_16x16x32_bf16 v[112:115], v[96:99], a[232:235], v[112:115]
    v_perm_b32 v100, v83, v83, v8
    v_perm_b32 v101, v83, v83, v10
    v_perm_b32 v102, v83, v83, v12
    v_perm_b32 v103, v83, v83, v14
    s_nop 1
    v_mfma_f32_16x16x32_bf16 v[116:119], v[100:103], a[232:235], v[116:119]
    v_perm_b32 v104, v63, v63, v9
    v_perm_b32 v105, v63, v63, v11
    v_perm_b32 v106, v63, v63, v13
    v_perm_b32 v107, v63, v63, v15
    s_nop 1
    v_mfma_f32_16x16x32_bf16 v[112:115], v[104:107], a[236:239], v[112:115]
    v_perm_b32 v108, v83, v83, v9
    v_perm_b32 v109, v83, v83, v11
    v_perm_b32 v110, v83, v83, v13
    v_perm_b32 v111, v83, v83, v15
    s_nop 1
    v_mfma_f32_16x16x32_bf16 v[116:119], v[108:111], a[236:239], v[116:119]
    v_perm_b32 v96, v64, v64, v8
    v_perm_b32 v97, v64, v64, v10
    v_perm_b32 v98, v64, v64, v12
    v_perm_b32 v99, v64, v64, v14
    s_nop 1
    v_mfma_f32_16x16x32_bf16 v[112:115], v[96:99], a[240:243], v[112:115]
    v_perm_b32 v100, v84, v84, v8
    v_perm_b32 v101, v84, v84, v10
    v_perm_b32 v102, v84, v84, v12
    v_perm_b32 v103, v84, v84, v14
    s_nop 1
    v_mfma_f32_16x16x32_bf16 v[116:119], v[100:103], a[240:243], v[116:119]
    v_perm_b32 v104, v64, v64, v9
    v_perm_b32 v105, v64, v64, v11
    v_perm_b32 v106, v64, v64, v13
    v_perm_b32 v107, v64, v64, v15
    s_nop 1
    v_mfma_f32_16x16x32_bf16 v[112:115], v[104:107], a[244:247], v[112:115]
    v_perm_b32 v108, v84, v84, v9
    v_perm_b32 v109, v84, v84, v11
    v_perm_b32 v110, v84, v84, v13
    v_perm_b32 v111, v84, v84, v15
    s_nop 1
    v_mfma_f32_16x16x32_bf16 v[116:119], v[108:111], a[244:247], v[116:119]
    v_perm_b32 v96, v65, v65, v8
    v_perm_b32 v97, v65, v65, v10
    v_perm_b32 v98, v65, v65, v12
    v_perm_b32 v99, v65, v65, v14
    s_nop 1
    v_mfma_f32_16x16x32_bf16 v[112:115], v[96:99], a[248:251], v[112:115]
    v_perm_b32 v100, v85, v85, v8
    v_perm_b32 v101, v85, v85, v10
    v_perm_b32 v102, v85, v85, v12
    v_perm_b32 v103, v85, v85, v14
    s_nop 1
    v_mfma_f32_16x16x32_bf16 v[116:119], v[100:103], a[248:251], v[116:119]
    v_perm_b32 v104, v65, v65, v9
    v_perm_b32 v105, v65, v65, v11
    v_perm_b32 v106, v65, v65, v13
    v_perm_b32 v107, v65, v65, v15
    s_nop 1
    v_mfma_f32_16x16x32_bf16 v[112:115], v[104:107], a[252:255], v[112:115]
    v_perm_b32 v108, v85, v85, v9
    v_perm_b32 v109, v85, v85, v11
    v_perm_b32 v110, v85, v85, v13
    v_perm_b32 v111, v85, v85, v15
    s_nop 1
    v_mfma_f32_16x16x32_bf16 v[116:119], v[108:111], a[252:255], v[116:119]
    v_lshrrev_b32 v5, 1, v4
    v_lshlrev_b32 v5, 9, v5
    v_lshl_add_u32 v5, v3, 5, v5
    v_and_b32 v6, 1, v4
    v_lshl_add_u32 v5, v6, 4, v5
    s_lshl_b32 s54, s3, 11
    s_add_u32 s54, s54, 131072
    v_add_u32 v5, s54, v5
    ds_write_b128 v5, v[112:115]
    ds_write_b128 v5, v[116:119] offset:1024
    s_waitcnt lgkmcnt(0)
    s_barrier
    s_add_u32 m0, s63, 28672
    s_nop 0
    buffer_load_dwordx4 v90, s[36:39], s60 offen nt lds
    s_add_u32 s60, s60, 32768
    s_add_u32 m0, s63, 29696
    s_nop 0
    buffer_load_dwordx4 v90, s[36:39], s60 offen nt lds
    s_add_u32 s60, s60, 32768
    s_add_u32 m0, s63, 30720
    s_nop 0
    buffer_load_dwordx4 v91, s[36:39], s60 offen nt lds
    s_add_u32 s60, s60, 32768
    s_add_u32 m0, s63, 31744
    s_nop 0
    buffer_load_dwordx4 v91, s[36:39], s60 offen nt lds
    s_add_u32 s60, s60, 32768
    v_lshrrev_b32 v5, 2, v3
    v_lshlrev_b32 v5, 9, v5
    v_lshl_add_u32 v5, v4, 5, v5
    v_add_u32 v5, 131072, v5
    ds_read_b128 v[48:51], v5 offset:0
    ds_read_b128 v[52:55], v5 offset:16
    ds_read_b128 v[56:59], v5 offset:2048
    ds_read_b128 v[60:63], v5 offset:2064
    ds_read_b128 v[64:67], v5 offset:4096
    ds_read_b128 v[68:71], v5 offset:4112
    ds_read_b128 v[72:75], v5 offset:6144
    ds_read_b128 v[76:79], v5 offset:6160
    s_waitcnt lgkmcnt(0)
    v_add_f32 v48, v48, v56
    v_add_f32 v64, v64, v72
    v_add_f32 v49, v49, v57
    v_add_f32 v65, v65, v73
    v_add_f32 v50, v50, v58
    v_add_f32 v66, v66, v74
    v_add_f32 v51, v51, v59
    v_add_f32 v67, v67, v75
    v_add_f32 v52, v52, v60
    v_add_f32 v68, v68, v76
    v_add_f32 v53, v53, v61
    v_add_f32 v69, v69, v77
    v_add_f32 v54, v54, v62
    v_add_f32 v70, v70, v78
    v_add_f32 v55, v55, v63
    v_add_f32 v71, v71, v79
    v_add_f32 v48, v48, v64
    v_add_f32 v49, v49, v65
    v_add_f32 v50, v50, v66
    v_add_f32 v51, v51, v67
    v_add_f32 v52, v52, v68
    v_add_f32 v53, v53, v69
    v_add_f32 v54, v54, v70
    v_add_f32 v55, v55, v71
    v_cvt_pk_bf16_f32 v96, v48, v49
    v_cvt_pk_bf16_f32 v97, v50, v51
    v_cvt_pk_bf16_f32 v98, v52, v53
    v_cvt_pk_bf16_f32 v99, v54, v55
    ds_read_b128 v[48:51], v5 offset:128
    ds_read_b128 v[52:55], v5 offset:144
    ds_read_b128 v[56:59], v5 offset:2176
    ds_read_b128 v[60:63], v5 offset:2192
    ds_read_b128 v[64:67], v5 offset:4224
    ds_read_b128 v[68:71], v5 offset:4240
    ds_read_b128 v[72:75], v5 offset:6272
    ds_read_b128 v[76:79], v5 offset:6288
    s_waitcnt lgkmcnt(0)
    v_add_f32 v48, v48, v56
    v_add_f32 v64, v64, v72
    v_add_f32 v49, v49, v57
    v_add_f32 v65, v65, v73
    v_add_f32 v50, v50, v58
    v_add_f32 v66, v66, v74
    v_add_f32 v51, v51, v59
    v_add_f32 v67, v67, v75
    v_add_f32 v52, v52, v60
    v_add_f32 v68, v68, v76
    v_add_f32 v53, v53, v61
    v_add_f32 v69, v69, v77
    v_add_f32 v54, v54, v62
    v_add_f32 v70, v70, v78
    v_add_f32 v55, v55, v63
    v_add_f32 v71, v71, v79
    v_add_f32 v48, v48, v64
    v_add_f32 v49, v49, v65
    v_add_f32 v50, v50, v66
    v_add_f32 v51, v51, v67
    v_add_f32 v52, v52, v68
    v_add_f32 v53, v53, v69
    v_add_f32 v54, v54, v70
    v_add_f32 v55, v55, v71
    v_cvt_pk_bf16_f32 v100, v48, v49
    v_cvt_pk_bf16_f32 v101, v50, v51
    v_cvt_pk_bf16_f32 v102, v52, v53
    v_cvt_pk_bf16_f32 v103, v54, v55
    ds_read_b128 v[48:51], v5 offset:256
    ds_read_b128 v[52:55], v5 offset:272
    ds_read_b128 v[56:59], v5 offset:2304
    ds_read_b128 v[60:63], v5 offset:2320
    ds_read_b128 v[64:67], v5 offset:4352
    ds_read_b128 v[68:71], v5 offset:4368
    ds_read_b128 v[72:75], v5 offset:6400
    ds_read_b128 v[76:79], v5 offset:6416
    s_waitcnt lgkmcnt(0)
    v_add_f32 v48, v48, v56
    v_add_f32 v64, v64, v72
    v_add_f32 v49, v49, v57
    v_add_f32 v65, v65, v73
    v_add_f32 v50, v50, v58
    v_add_f32 v66, v66, v74
    v_add_f32 v51, v51, v59
    v_add_f32 v67, v67, v75
    v_add_f32 v52, v52, v60
    v_add_f32 v68, v68, v76
    v_add_f32 v53, v53, v61
    v_add_f32 v69, v69, v77
    v_add_f32 v54, v54, v62
    v_add_f32 v70, v70, v78
    v_add_f32 v55, v55, v63
    v_add_f32 v71, v71, v79
    v_add_f32 v48, v48, v64
    v_add_f32 v49, v49, v65
    v_add_f32 v50, v50, v66
    v_add_f32 v51, v51, v67
    v_add_f32 v52, v52, v68
    v_add_f32 v53, v53, v69
    v_add_f32 v54, v54, v70
    v_add_f32 v55, v55, v71
    v_cvt_pk_bf16_f32 v104, v48, v49
    v_cvt_pk_bf16_f32 v105, v50, v51
    v_cvt_pk_bf16_f32 v106, v52, v53
    v_cvt_pk_bf16_f32 v107, v54, v55
    ds_read_b128 v[48:51], v5 offset:384
    ds_read_b128 v[52:55], v5 offset:400
    ds_read_b128 v[56:59], v5 offset:2432
    ds_read_b128 v[60:63], v5 offset:2448
    ds_read_b128 v[64:67], v5 offset:4480
    ds_read_b128 v[68:71], v5 offset:4496
    ds_read_b128 v[72:75], v5 offset:6528
    ds_read_b128 v[76:79], v5 offset:6544
    s_waitcnt lgkmcnt(0)
    v_add_f32 v48, v48, v56
    v_add_f32 v64, v64, v72
    v_add_f32 v49, v49, v57
    v_add_f32 v65, v65, v73
    v_add_f32 v50, v50, v58
    v_add_f32 v66, v66, v74
    v_add_f32 v51, v51, v59
    v_add_f32 v67, v67, v75
    v_add_f32 v52, v52, v60
    v_add_f32 v68, v68, v76
    v_add_f32 v53, v53, v61
    v_add_f32 v69, v69, v77
    v_add_f32 v54, v54, v62
    v_add_f32 v70, v70, v78
    v_add_f32 v55, v55, v63
    v_add_f32 v71, v71, v79
    v_add_f32 v48, v48, v64
    v_add_f32 v49, v49, v65
    v_add_f32 v50, v50, v66
    v_add_f32 v51, v51, v67
    v_add_f32 v52, v52, v68
    v_add_f32 v53, v53, v69
    v_add_f32 v54, v54, v70
    v_add_f32 v55, v55, v71
    v_cvt_pk_bf16_f32 v108, v48, v49
    v_cvt_pk_bf16_f32 v109, v50, v51
    v_cvt_pk_bf16_f32 v110, v52, v53
    v_cvt_pk_bf16_f32 v111, v54, v55
    s_waitcnt vmcnt(24)
    ds_read_b128 v[128:131], v92 offset:0
    ds_read_b128 v[132:135], v93 offset:0
    ds_read_b128 v[136:139], v94 offset:0
    ds_read_b128 v[140:143], v95 offset:0
    ds_read_b128 v[144:147], v92 offset:1024
    ds_read_b128 v[148:151], v93 offset:1024
    ds_read_b128 v[152:155], v94 offset:1024
    ds_read_b128 v[156:159], v95 offset:1024
    s_waitcnt lgkmcnt(7)
    v_mfma_f32_16x16x32_bf16 v[48:51], v[128:131], v[96:99], 0
    s_waitcnt lgkmcnt(6)
    v_mfma_f32_16x16x32_bf16 v[48:51], v[132:135], v[100:103], v[48:51]
    s_waitcnt lgkmcnt(5)
    v_mfma_f32_16x16x32_bf16 v[48:51], v[136:139], v[104:107], v[48:51]
    s_waitcnt lgkmcnt(4)
    v_mfma_f32_16x16x32_bf16 v[48:51], v[140:143], v[108:111], v[48:51]
    s_waitcnt lgkmcnt(3)
    v_mfma_f32_16x16x32_bf16 v[52:55], v[144:147], v[96:99], 0
    s_waitcnt lgkmcnt(2)
    v_mfma_f32_16x16x32_bf16 v[52:55], v[148:151], v[100:103], v[52:55]
    s_waitcnt lgkmcnt(1)
    v_mfma_f32_16x16x32_bf16 v[52:55], v[152:155], v[104:107], v[52:55]
    s_waitcnt lgkmcnt(0)
    v_mfma_f32_16x16x32_bf16 v[52:55], v[156:159], v[108:111], v[52:55]
    s_waitcnt vmcnt(16)
    ds_read_b128 v[160:163], v92 offset:8192
    ds_read_b128 v[164:167], v93 offset:8192
    ds_read_b128 v[168:171], v94 offset:8192
    ds_read_b128 v[172:175], v95 offset:8192
    ds_read_b128 v[176:179], v92 offset:9216
    ds_read_b128 v[180:183], v93 offset:9216
    ds_read_b128 v[184:187], v94 offset:9216
    ds_read_b128 v[188:191], v95 offset:9216
    s_waitcnt lgkmcnt(7)
    v_mfma_f32_16x16x32_bf16 v[56:59], v[160:163], v[96:99], 0
    s_waitcnt lgkmcnt(6)
    v_mfma_f32_16x16x32_bf16 v[56:59], v[164:167], v[100:103], v[56:59]
    s_waitcnt lgkmcnt(5)
    v_mfma_f32_16x16x32_bf16 v[56:59], v[168:171], v[104:107], v[56:59]
    s_waitcnt lgkmcnt(4)
    v_mfma_f32_16x16x32_bf16 v[56:59], v[172:175], v[108:111], v[56:59]
    s_waitcnt lgkmcnt(3)
    v_mfma_f32_16x16x32_bf16 v[60:63], v[176:179], v[96:99], 0
    s_waitcnt lgkmcnt(2)
    v_mfma_f32_16x16x32_bf16 v[60:63], v[180:183], v[100:103], v[60:63]
    s_waitcnt lgkmcnt(1)
    v_mfma_f32_16x16x32_bf16 v[60:63], v[184:187], v[104:107], v[60:63]
    s_waitcnt lgkmcnt(0)
    v_mfma_f32_16x16x32_bf16 v[60:63], v[188:191], v[108:111], v[60:63]
    s_waitcnt vmcnt(8)
    ds_read_b128 v[128:131], v92 offset:16384
    ds_read_b128 v[132:135], v93 offset:16384
    ds_read_b128 v[136:139], v94 offset:16384
    ds_read_b128 v[140:143], v95 offset:16384
    ds_read_b128 v[144:147], v92 offset:17408
    ds_read_b128 v[148:151], v93 offset:17408
    ds_read_b128 v[152:155], v94 offset:17408
    ds_read_b128 v[156:159], v95 offset:17408
    s_waitcnt lgkmcnt(7)
    v_mfma_f32_16x16x32_bf16 v[64:67], v[128:131], v[96:99], 0
    s_waitcnt lgkmcnt(6)
    v_mfma_f32_16x16x32_bf16 v[64:67], v[132:135], v[100:103], v[64:67]
    s_waitcnt lgkmcnt(5)
    v_mfma_f32_16x16x32_bf16 v[64:67], v[136:139], v[104:107], v[64:67]
    s_waitcnt lgkmcnt(4)
    v_mfma_f32_16x16x32_bf16 v[64:67], v[140:143], v[108:111], v[64:67]
    s_waitcnt lgkmcnt(3)
    v_mfma_f32_16x16x32_bf16 v[68:71], v[144:147], v[96:99], 0
    s_waitcnt lgkmcnt(2)
    v_mfma_f32_16x16x32_bf16 v[68:71], v[148:151], v[100:103], v[68:71]
    s_waitcnt lgkmcnt(1)
    v_mfma_f32_16x16x32_bf16 v[68:71], v[152:155], v[104:107], v[68:71]
    s_waitcnt lgkmcnt(0)
    v_mfma_f32_16x16x32_bf16 v[68:71], v[156:159], v[108:111], v[68:71]
    s_waitcnt vmcnt(0)
    ds_read_b128 v[160:163], v92 offset:24576
    ds_read_b128 v[164:167], v93 offset:24576
    ds_read_b128 v[168:171], v94 offset:24576
    ds_read_b128 v[172:175], v95 offset:24576
    ds_read_b128 v[176:179], v92 offset:25600
    ds_read_b128 v[180:183], v93 offset:25600
    ds_read_b128 v[184:187], v94 offset:25600
    ds_read_b128 v[188:191], v95 offset:25600
    s_waitcnt lgkmcnt(7)
    v_mfma_f32_16x16x32_bf16 v[72:75], v[160:163], v[96:99], 0
    s_waitcnt lgkmcnt(6)
    v_mfma_f32_16x16x32_bf16 v[72:75], v[164:167], v[100:103], v[72:75]
    s_waitcnt lgkmcnt(5)
    v_mfma_f32_16x16x32_bf16 v[72:75], v[168:171], v[104:107], v[72:75]
    s_waitcnt lgkmcnt(4)
    v_mfma_f32_16x16x32_bf16 v[72:75], v[172:175], v[108:111], v[72:75]
    s_waitcnt lgkmcnt(3)
    v_mfma_f32_16x16x32_bf16 v[76:79], v[176:179], v[96:99], 0
    s_waitcnt lgkmcnt(2)
    v_mfma_f32_16x16x32_bf16 v[76:79], v[180:183], v[100:103], v[76:79]
    s_waitcnt lgkmcnt(1)
    v_mfma_f32_16x16x32_bf16 v[76:79], v[184:187], v[104:107], v[76:79]
    s_waitcnt lgkmcnt(0)
    v_mfma_f32_16x16x32_bf16 v[76:79], v[188:191], v[108:111], v[76:79]
    s_mov_b32 s96, 1040356334
    v_and_b32 v6, 3, v3
    v_cmp_eq_u32 vcc, 1, v6
    s_nop 1
    v_cndmask_b32 v48, v48, v56, vcc
    v_cndmask_b32 v49, v49, v57, vcc
    v_cndmask_b32 v50, v50, v58, vcc
    v_cndmask_b32 v51, v51, v59, vcc
    v_cndmask_b32 v52, v52, v60, vcc
    v_cndmask_b32 v53, v53, v61, vcc
    v_cndmask_b32 v54, v54, v62, vcc
    v_cndmask_b32 v55, v55, v63, vcc
    v_cmp_eq_u32 vcc, 2, v6
    s_nop 1
    v_cndmask_b32 v48, v48, v64, vcc
    v_cndmask_b32 v49, v49, v65, vcc
    v_cndmask_b32 v50, v50, v66, vcc
    v_cndmask_b32 v51, v51, v67, vcc
    v_cndmask_b32 v52, v52, v68, vcc
    v_cndmask_b32 v53, v53, v69, vcc
    v_cndmask_b32 v54, v54, v70, vcc
    v_cndmask_b32 v55, v55, v71, vcc
    v_cmp_eq_u32 vcc, 3, v6
    s_nop 1
    v_cndmask_b32 v48, v48, v72, vcc
    v_cndmask_b32 v49, v49, v73, vcc
    v_cndmask_b32 v50, v50, v74, vcc
    v_cndmask_b32 v51, v51, v75, vcc
    v_cndmask_b32 v52, v52, v76, vcc
    v_cndmask_b32 v53, v53, v77, vcc
    v_cndmask_b32 v54, v54, v78, vcc
    v_cndmask_b32 v55, v55, v79, vcc
    v_mul_f32 v48, s96, v48
    v_mul_f32 v49, s96, v49
    v_mul_f32 v50, s96, v50
    v_mul_f32 v51, s96, v51
    v_mul_f32 v52, s96, v52
    v_mul_f32 v53, s96, v53
    v_mul_f32 v54, s96, v54
    v_mul_f32 v55, s96, v55
    v_cvt_pk_bf16_f32 v24, v48, v49
    v_cvt_pk_bf16_f32 v25, v50, v51
    v_cvt_pk_bf16_f32 v26, v52, v53
    v_cvt_pk_bf16_f32 v27, v54, v55
    v_min_u32 v24, -2, v24
    v_min_u32 v25, -2, v25
    v_min_u32 v26, -2, v26
    v_min_u32 v27, -2, v27
    v_lshrrev_b32 v5, 2, v3
    v_lshlrev_b32 v5, 15, v5
    v_lshl_add_u32 v5, v4, 4, v5
    v_and_b32 v6, 3, v3
    v_lshl_add_u32 v5, v6, 6, v5
    s_lshl_b32 s54, s52, 10
    s_lshl_b32 s55, s3, 8
    s_add_u32 s54, s54, s55
    s_add_u32 s54, s54, 1048576
    buffer_store_dwordx4 v[24:27], v5, s[44:47], s54 offen sc1
    buffer_load_dwordx4 a[0:3], v121, s[40:43], s62 offen nt
    s_add_u32 s62, s62, 8192
    buffer_load_dwordx4 a[4:7], v121, s[40:43], s62 offen nt
    s_add_u32 s62, s62, 8192
    buffer_load_dwordx4 a[8:11], v121, s[40:43], s62 offen nt
    s_add_u32 s62, s62, 8192
    buffer_load_dwordx4 a[12:15], v121, s[40:43], s62 offen nt
    s_add_u32 s62, s62, 8192
    buffer_load_dwordx4 a[16:19], v121, s[40:43], s62 offen nt
    s_add_u32 s62, s62, 8192
    buffer_load_dwordx4 a[20:23], v121, s[40:43], s62 offen nt
    s_add_u32 s62, s62, 8192
    buffer_load_dwordx4 a[24:27], v121, s[40:43], s62 offen nt
    s_add_u32 s62, s62, 8192
    buffer_load_dwordx4 a[28:31], v121, s[40:43], s62 offen nt
    s_add_u32 s62, s62, 8192
    buffer_load_dwordx4 a[32:35], v121, s[40:43], s62 offen nt
    s_add_u32 s62, s62, 8192
    buffer_load_dwordx4 a[36:39], v121, s[40:43], s62 offen nt
    s_add_u32 s62, s62, 8192
    buffer_load_dwordx4 a[40:43], v121, s[40:43], s62 offen nt
    s_add_u32 s62, s62, 8192
    buffer_load_dwordx4 a[44:47], v121, s[40:43], s62 offen nt
    s_add_u32 s62, s62, 8192
    buffer_load_dwordx4 a[48:51], v121, s[40:43], s62 offen nt
    s_add_u32 s62, s62, 8192
    buffer_load_dwordx4 a[52:55], v121, s[40:43], s62 offen nt
    s_add_u32 s62, s62, 8192
    buffer_load_dwordx4 a[56:59], v121, s[40:43], s62 offen nt
    s_add_u32 s62, s62, 8192
    buffer_load_dwordx4 a[60:63], v121, s[40:43], s62 offen nt
    s_add_u32 s62, s62, 8192
    buffer_load_dwordx4 a[64:67], v121, s[40:43], s62 offen nt
    s_add_u32 s62, s62, 8192
    buffer_load_dwordx4 a[68:71], v121, s[40:43], s62 offen nt
    s_add_u32 s62, s62, 8192
    buffer_load_dwordx4 a[72:75], v121, s[40:43], s62 offen nt
    s_add_u32 s62, s62, 8192
    buffer_load_dwordx4 a[76:79], v121, s[40:43], s62 offen nt
    s_add_u32 s62, s62, 8192
    buffer_load_dwordx4 a[80:83], v121, s[40:43], s62 offen nt
    s_add_u32 s62, s62, 8192
    buffer_load_dwordx4 a[84:87], v121, s[40:43], s62 offen nt
    s_add_u32 s62, s62, 8192
    buffer_load_dwordx4 a[88:91], v121, s[40:43], s62 offen nt
    s_add_u32 s62, s62, 8192
    buffer_load_dwordx4 a[92:95], v121, s[40:43], s62 offen nt
    s_add_u32 s62, s62, 8192
    buffer_load_dwordx4 a[96:99], v121, s[40:43], s62 offen nt
    s_add_u32 s62, s62, 8192
    buffer_load_dwordx4 a[100:103], v121, s[40:43], s62 offen nt
    s_add_u32 s62, s62, 8192
    buffer_load_dwordx4 a[104:107], v121, s[40:43], s62 offen nt
    s_add_u32 s62, s62, 8192
    buffer_load_dwordx4 a[108:111], v121, s[40:43], s62 offen nt
    s_add_u32 s62, s62, 8192
    buffer_load_dwordx4 a[112:115], v121, s[40:43], s62 offen nt
    s_add_u32 s62, s62, 8192
    buffer_load_dwordx4 a[116:119], v121, s[40:43], s62 offen nt
    s_add_u32 s62, s62, 8192
    buffer_load_dwordx4 a[120:123], v121, s[40:43], s62 offen nt
    s_add_u32 s62, s62, 8192
    buffer_load_dwordx4 a[124:127], v121, s[40:43], s62 offen nt
    s_add_u32 s62, s62, 8192
    v_mov_b32 v16, 0
    global_load_dword v17, v16, s[28:29] sc1
    s_waitcnt vmcnt(0)
    s_barrier
L_flags_18:
    v_cmp_gt_u32 vcc, 64, v17
    s_cbranch_vccz L_flagsok_19
    s_sleep 2
    global_load_dword v17, v16, s[28:29] sc1
    s_waitcnt vmcnt(0)
    s_sub_u32 s101, s101, 1
    s_cbranch_scc0 L_flags_18
    s_mov_b32 s101, 0
L_flagsok_19:
    s_lshl_b32 s58, s3, 18
    s_lshl_b32 s54, s52, 10
    s_add_u32 s58, s58, s54
    s_add_u32 s58, s58, 2097152
    s_lshl_b32 s59, s3, 11
    s_lshl_b32 s54, s52, 3
    s_add_u32 s59, s59, s54
    s_add_u32 s59, s59, 3145728
    s_mov_b32 s98, 0xffff0000
    v_and_b32 v5, 7, v1
    v_lshlrev_b32 v5, 8, v5
L_blight_20:
    buffer_load_dwordx2 v[232:233], v5, s[44:47], s59 offen sc1
    s_waitcnt vmcnt(0)
    v_max_u32 v6, v232, v233
    v_cmp_eq_u32 vcc, -1, v6
    s_cbranch_vccz L_bheavy_21
    s_sleep 2
    s_sub_u32 s101, s101, 1
    s_cbranch_scc0 L_blight_20
    s_mov_b32 s101, 0
L_bheavy_21:
    buffer_load_dwordx4 v[16:19], v2, s[44:47], s58 offen sc1 nt
    s_add_u32 s58, s58, 32768
    buffer_load_dwordx4 v[20:23], v2, s[44:47], s58 offen sc1 nt
    s_add_u32 s58, s58, 32768
    buffer_load_dwordx4 v[24:27], v2, s[44:47], s58 offen sc1 nt
    s_add_u32 s58, s58, 32768
    buffer_load_dwordx4 v[28:31], v2, s[44:47], s58 offen sc1 nt
    s_add_u32 s58, s58, 32768
    buffer_load_dwordx4 v[32:35], v2, s[44:47], s58 offen sc1 nt
    s_add_u32 s58, s58, 32768
    buffer_load_dwordx4 v[36:39], v2, s[44:47], s58 offen sc1 nt
    s_add_u32 s58, s58, 32768
    buffer_load_dwordx4 v[40:43], v2, s[44:47], s58 offen sc1 nt
    s_add_u32 s58, s58, 32768
    buffer_load_dwordx4 v[44:47], v2, s[44:47], s58 offen sc1 nt
    s_add_u32 s58, s58, 32768
    v_max_f32_dpp v234, v232, v232 row_ror:1 row_mask:0xf bank_mask:0xf
    s_nop 1
    v_max_f32_dpp v234, v234, v234 row_ror:2 row_mask:0xf bank_mask:0xf
    s_nop 1
    v_max_f32_dpp v234, v234, v234 row_ror:4 row_mask:0xf bank_mask:0xf
    v_sub_f32 v232, v232, v234
    v_exp_f32 v232, v232
    s_nop 0
    v_mul_f32 v232, v232, v233
    s_nop 1
    v_add_f32_dpp v234, v232, v232 row_ror:1 row_mask:0xf bank_mask:0xf
    s_nop 1
    v_add_f32_dpp v234, v234, v234 row_ror:2 row_mask:0xf bank_mask:0xf
    s_nop 1
    v_add_f32_dpp v234, v234, v234 row_ror:4 row_mask:0xf bank_mask:0xf
    v_rcp_f32 v234, v234
    s_nop 0
    v_mul_f32 v232, v232, v234
    s_waitcnt vmcnt(7)
    v_lshlrev_b32 v240, 16, v16
    v_and_b32 v16, s98, v16
    v_lshlrev_b32 v241, 16, v17
    v_and_b32 v17, s98, v17
    v_lshlrev_b32 v242, 16, v18
    v_and_b32 v18, s98, v18
    v_lshlrev_b32 v243, 16, v19
    v_and_b32 v19, s98, v19
    v_mul_f32_dpp v224, v232, v240 row_newbcast:0 row_mask:0xf bank_mask:0xf
    v_mul_f32_dpp v225, v232, v16 row_newbcast:0 row_mask:0xf bank_mask:0xf
    v_mul_f32_dpp v226, v232, v241 row_newbcast:0 row_mask:0xf bank_mask:0xf
    v_mul_f32_dpp v227, v232, v17 row_newbcast:0 row_mask:0xf bank_mask:0xf
    v_mul_f32_dpp v228, v232, v242 row_newbcast:0 row_mask:0xf bank_mask:0xf
    v_mul_f32_dpp v229, v232, v18 row_newbcast:0 row_mask:0xf bank_mask:0xf
    v_mul_f32_dpp v230, v232, v243 row_newbcast:0 row_mask:0xf bank_mask:0xf
    v_mul_f32_dpp v231, v232, v19 row_newbcast:0 row_mask:0xf bank_mask:0xf
    s_waitcnt vmcnt(6)
    v_lshlrev_b32 v240, 16, v20
    v_and_b32 v20, s98, v20
    v_lshlrev_b32 v241, 16, v21
    v_and_b32 v21, s98, v21
    v_lshlrev_b32 v242, 16, v22
    v_and_b32 v22, s98, v22
    v_lshlrev_b32 v243, 16, v23
    v_and_b32 v23, s98, v23
    v_fmac_f32_dpp v224, v232, v240 row_newbcast:1 row_mask:0xf bank_mask:0xf
    v_fmac_f32_dpp v225, v232, v20 row_newbcast:1 row_mask:0xf bank_mask:0xf
    v_fmac_f32_dpp v226, v232, v241 row_newbcast:1 row_mask:0xf bank_mask:0xf
    v_fmac_f32_dpp v227, v232, v21 row_newbcast:1 row_mask:0xf bank_mask:0xf
    v_fmac_f32_dpp v228, v232, v242 row_newbcast:1 row_mask:0xf bank_mask:0xf
    v_fmac_f32_dpp v229, v232, v22 row_newbcast:1 row_mask:0xf bank_mask:0xf
    v_fmac_f32_dpp v230, v232, v243 row_newbcast:1 row_mask:0xf bank_mask:0xf
    v_fmac_f32_dpp v231, v232, v23 row_newbcast:1 row_mask:0xf bank_mask:0xf
    s_waitcnt vmcnt(5)
    v_lshlrev_b32 v240, 16, v24
    v_and_b32 v24, s98, v24
    v_lshlrev_b32 v241, 16, v25
    v_and_b32 v25, s98, v25
    v_lshlrev_b32 v242, 16, v26
    v_and_b32 v26, s98, v26
    v_lshlrev_b32 v243, 16, v27
    v_and_b32 v27, s98, v27
    v_fmac_f32_dpp v224, v232, v240 row_newbcast:2 row_mask:0xf bank_mask:0xf
    v_fmac_f32_dpp v225, v232, v24 row_newbcast:2 row_mask:0xf bank_mask:0xf
    v_fmac_f32_dpp v226, v232, v241 row_newbcast:2 row_mask:0xf bank_mask:0xf
    v_fmac_f32_dpp v227, v232, v25 row_newbcast:2 row_mask:0xf bank_mask:0xf
    v_fmac_f32_dpp v228, v232, v242 row_newbcast:2 row_mask:0xf bank_mask:0xf
    v_fmac_f32_dpp v229, v232, v26 row_newbcast:2 row_mask:0xf bank_mask:0xf
    v_fmac_f32_dpp v230, v232, v243 row_newbcast:2 row_mask:0xf bank_mask:0xf
    v_fmac_f32_dpp v231, v232, v27 row_newbcast:2 row_mask:0xf bank_mask:0xf
    s_waitcnt vmcnt(4)
    v_lshlrev_b32 v240, 16, v28
    v_and_b32 v28, s98, v28
    v_lshlrev_b32 v241, 16, v29
    v_and_b32 v29, s98, v29
    v_lshlrev_b32 v242, 16, v30
    v_and_b32 v30, s98, v30
    v_lshlrev_b32 v243, 16, v31
    v_and_b32 v31, s98, v31
    v_fmac_f32_dpp v224, v232, v240 row_newbcast:3 row_mask:0xf bank_mask:0xf
    v_fmac_f32_dpp v225, v232, v28 row_newbcast:3 row_mask:0xf bank_mask:0xf
    v_fmac_f32_dpp v226, v232, v241 row_newbcast:3 row_mask:0xf bank_mask:0xf
    v_fmac_f32_dpp v227, v232, v29 row_newbcast:3 row_mask:0xf bank_mask:0xf
    v_fmac_f32_dpp v228, v232, v242 row_newbcast:3 row_mask:0xf bank_mask:0xf
    v_fmac_f32_dpp v229, v232, v30 row_newbcast:3 row_mask:0xf bank_mask:0xf
    v_fmac_f32_dpp v230, v232, v243 row_newbcast:3 row_mask:0xf bank_mask:0xf
    v_fmac_f32_dpp v231, v232, v31 row_newbcast:3 row_mask:0xf bank_mask:0xf
    s_waitcnt vmcnt(3)
    v_lshlrev_b32 v240, 16, v32
    v_and_b32 v32, s98, v32
    v_lshlrev_b32 v241, 16, v33
    v_and_b32 v33, s98, v33
    v_lshlrev_b32 v242, 16, v34
    v_and_b32 v34, s98, v34
    v_lshlrev_b32 v243, 16, v35
    v_and_b32 v35, s98, v35
    v_fmac_f32_dpp v224, v232, v240 row_newbcast:4 row_mask:0xf bank_mask:0xf
    v_fmac_f32_dpp v225, v232, v32 row_newbcast:4 row_mask:0xf bank_mask:0xf
    v_fmac_f32_dpp v226, v232, v241 row_newbcast:4 row_mask:0xf bank_mask:0xf
    v_fmac_f32_dpp v227, v232, v33 row_newbcast:4 row_mask:0xf bank_mask:0xf
    v_fmac_f32_dpp v228, v232, v242 row_newbcast:4 row_mask:0xf bank_mask:0xf
    v_fmac_f32_dpp v229, v232, v34 row_newbcast:4 row_mask:0xf bank_mask:0xf
    v_fmac_f32_dpp v230, v232, v243 row_newbcast:4 row_mask:0xf bank_mask:0xf
    v_fmac_f32_dpp v231, v232, v35 row_newbcast:4 row_mask:0xf bank_mask:0xf
    s_waitcnt vmcnt(2)
    v_lshlrev_b32 v240, 16, v36
    v_and_b32 v36, s98, v36
    v_lshlrev_b32 v241, 16, v37
    v_and_b32 v37, s98, v37
    v_lshlrev_b32 v242, 16, v38
    v_and_b32 v38, s98, v38
    v_lshlrev_b32 v243, 16, v39
    v_and_b32 v39, s98, v39
    v_fmac_f32_dpp v224, v232, v240 row_newbcast:5 row_mask:0xf bank_mask:0xf
    v_fmac_f32_dpp v225, v232, v36 row_newbcast:5 row_mask:0xf bank_mask:0xf
    v_fmac_f32_dpp v226, v232, v241 row_newbcast:5 row_mask:0xf bank_mask:0xf
    v_fmac_f32_dpp v227, v232, v37 row_newbcast:5 row_mask:0xf bank_mask:0xf
    v_fmac_f32_dpp v228, v232, v242 row_newbcast:5 row_mask:0xf bank_mask:0xf
    v_fmac_f32_dpp v229, v232, v38 row_newbcast:5 row_mask:0xf bank_mask:0xf
    v_fmac_f32_dpp v230, v232, v243 row_newbcast:5 row_mask:0xf bank_mask:0xf
    v_fmac_f32_dpp v231, v232, v39 row_newbcast:5 row_mask:0xf bank_mask:0xf
    s_waitcnt vmcnt(1)
    v_lshlrev_b32 v240, 16, v40
    v_and_b32 v40, s98, v40
    v_lshlrev_b32 v241, 16, v41
    v_and_b32 v41, s98, v41
    v_lshlrev_b32 v242, 16, v42
    v_and_b32 v42, s98, v42
    v_lshlrev_b32 v243, 16, v43
    v_and_b32 v43, s98, v43
    v_fmac_f32_dpp v224, v232, v240 row_newbcast:6 row_mask:0xf bank_mask:0xf
    v_fmac_f32_dpp v225, v232, v40 row_newbcast:6 row_mask:0xf bank_mask:0xf
    v_fmac_f32_dpp v226, v232, v241 row_newbcast:6 row_mask:0xf bank_mask:0xf
    v_fmac_f32_dpp v227, v232, v41 row_newbcast:6 row_mask:0xf bank_mask:0xf
    v_fmac_f32_dpp v228, v232, v242 row_newbcast:6 row_mask:0xf bank_mask:0xf
    v_fmac_f32_dpp v229, v232, v42 row_newbcast:6 row_mask:0xf bank_mask:0xf
    v_fmac_f32_dpp v230, v232, v243 row_newbcast:6 row_mask:0xf bank_mask:0xf
    v_fmac_f32_dpp v231, v232, v43 row_newbcast:6 row_mask:0xf bank_mask:0xf
    s_waitcnt vmcnt(0)
    v_lshlrev_b32 v240, 16, v44
    v_and_b32 v44, s98, v44
    v_lshlrev_b32 v241, 16, v45
    v_and_b32 v45, s98, v45
    v_lshlrev_b32 v242, 16, v46
    v_and_b32 v46, s98, v46
    v_lshlrev_b32 v243, 16, v47
    v_and_b32 v47, s98, v47
    v_fmac_f32_dpp v224, v232, v240 row_newbcast:7 row_mask:0xf bank_mask:0xf
    v_fmac_f32_dpp v225, v232, v44 row_newbcast:7 row_mask:0xf bank_mask:0xf
    v_fmac_f32_dpp v226, v232, v241 row_newbcast:7 row_mask:0xf bank_mask:0xf
    v_fmac_f32_dpp v227, v232, v45 row_newbcast:7 row_mask:0xf bank_mask:0xf
    v_fmac_f32_dpp v228, v232, v242 row_newbcast:7 row_mask:0xf bank_mask:0xf
    v_fmac_f32_dpp v229, v232, v46 row_newbcast:7 row_mask:0xf bank_mask:0xf
    v_fmac_f32_dpp v230, v232, v243 row_newbcast:7 row_mask:0xf bank_mask:0xf
    v_fmac_f32_dpp v231, v232, v47 row_newbcast:7 row_mask:0xf bank_mask:0xf
    v_cvt_pk_bf16_f32 v244, v224, v225
    v_cvt_pk_bf16_f32 v245, v226, v227
    v_cvt_pk_bf16_f32 v246, v228, v229
    v_cvt_pk_bf16_f32 v247, v230, v231
    s_lshl_b32 s54, s3, 10
    v_add_u32 v5, s54, v2
    ds_write_b128 v5, v[244:247]
    v_lshrrev_b32 v5, 3, v3
    v_lshlrev_b32 v5, 10, v5
    v_lshl_add_u32 v5, v4, 6, v5
    s_lshl_b32 s54, s3, 8
    v_add_u32 v5, s54, v5
    s_waitcnt lgkmcnt(0)
    s_barrier
    ds_read_b128 v[16:19], v5 offset:0
    ds_read_b128 v[20:23], v5 offset:16
    ds_read_b128 v[24:27], v5 offset:32
    ds_read_b128 v[28:31], v5 offset:48
    ds_read_b128 v[32:35], v5 offset:2048
    ds_read_b128 v[36:39], v5 offset:2064
    ds_read_b128 v[40:43], v5 offset:2080
    ds_read_b128 v[44:47], v5 offset:2096
    s_waitcnt lgkmcnt(0)
    v_perm_b32 v48, v16, v16, v8
    v_perm_b32 v49, v16, v16, v10
    v_perm_b32 v50, v16, v16, v12
    v_perm_b32 v51, v16, v16, v14
    s_nop 1
    v_mfma_f32_16x16x32_bf16 v[224:227], v[48:51], a[0:3], 0
    v_perm_b32 v52, v32, v32, v8
    v_perm_b32 v53, v32, v32, v10
    v_perm_b32 v54, v32, v32, v12
    v_perm_b32 v55, v32, v32, v14
    s_nop 1
    v_mfma_f32_16x16x32_bf16 v[228:231], v[52:55], a[0:3], 0
    v_perm_b32 v56, v16, v16, v9
    v_perm_b32 v57, v16, v16, v11
    v_perm_b32 v58, v16, v16, v13
    v_perm_b32 v59, v16, v16, v15
    s_nop 1
    v_mfma_f32_16x16x32_bf16 v[224:227], v[56:59], a[4:7], v[224:227]
    v_perm_b32 v60, v32, v32, v9
    v_perm_b32 v61, v32, v32, v11
    v_perm_b32 v62, v32, v32, v13
    v_perm_b32 v63, v32, v32, v15
    s_nop 1
    v_mfma_f32_16x16x32_bf16 v[228:231], v[60:63], a[4:7], v[228:231]
    v_perm_b32 v48, v17, v17, v8
    v_perm_b32 v49, v17, v17, v10
    v_perm_b32 v50, v17, v17, v12
    v_perm_b32 v51, v17, v17, v14
    s_nop 1
    v_mfma_f32_16x16x32_bf16 v[224:227], v[48:51], a[8:11], v[224:227]
    v_perm_b32 v52, v33, v33, v8
    v_perm_b32 v53, v33, v33, v10
    v_perm_b32 v54, v33, v33, v12
    v_perm_b32 v55, v33, v33, v14
    s_nop 1
    v_mfma_f32_16x16x32_bf16 v[228:231], v[52:55], a[8:11], v[228:231]
    v_perm_b32 v56, v17, v17, v9
    v_perm_b32 v57, v17, v17, v11
    v_perm_b32 v58, v17, v17, v13
    v_perm_b32 v59, v17, v17, v15
    s_nop 1
    v_mfma_f32_16x16x32_bf16 v[224:227], v[56:59], a[12:15], v[224:227]
    v_perm_b32 v60, v33, v33, v9
    v_perm_b32 v61, v33, v33, v11
    v_perm_b32 v62, v33, v33, v13
    v_perm_b32 v63, v33, v33, v15
    s_nop 1
    v_mfma_f32_16x16x32_bf16 v[228:231], v[60:63], a[12:15], v[228:231]
    v_perm_b32 v48, v18, v18, v8
    v_perm_b32 v49, v18, v18, v10
    v_perm_b32 v50, v18, v18, v12
    v_perm_b32 v51, v18, v18, v14
    s_nop 1
    v_mfma_f32_16x16x32_bf16 v[224:227], v[48:51], a[16:19], v[224:227]
    v_perm_b32 v52, v34, v34, v8
    v_perm_b32 v53, v34, v34, v10
    v_perm_b32 v54, v34, v34, v12
    v_perm_b32 v55, v34, v34, v14
    s_nop 1
    v_mfma_f32_16x16x32_bf16 v[228:231], v[52:55], a[16:19], v[228:231]
    v_perm_b32 v56, v18, v18, v9
    v_perm_b32 v57, v18, v18, v11
    v_perm_b32 v58, v18, v18, v13
    v_perm_b32 v59, v18, v18, v15
    s_nop 1
    v_mfma_f32_16x16x32_bf16 v[224:227], v[56:59], a[20:23], v[224:227]
    v_perm_b32 v60, v34, v34, v9
    v_perm_b32 v61, v34, v34, v11
    v_perm_b32 v62, v34, v34, v13
    v_perm_b32 v63, v34, v34, v15
    s_nop 1
    v_mfma_f32_16x16x32_bf16 v[228:231], v[60:63], a[20:23], v[228:231]
    v_perm_b32 v48, v19, v19, v8
    v_perm_b32 v49, v19, v19, v10
    v_perm_b32 v50, v19, v19, v12
    v_perm_b32 v51, v19, v19, v14
    s_nop 1
    v_mfma_f32_16x16x32_bf16 v[224:227], v[48:51], a[24:27], v[224:227]
    v_perm_b32 v52, v35, v35, v8
    v_perm_b32 v53, v35, v35, v10
    v_perm_b32 v54, v35, v35, v12
    v_perm_b32 v55, v35, v35, v14
    s_nop 1
    v_mfma_f32_16x16x32_bf16 v[228:231], v[52:55], a[24:27], v[228:231]
    v_perm_b32 v56, v19, v19, v9
    v_perm_b32 v57, v19, v19, v11
    v_perm_b32 v58, v19, v19, v13
    v_perm_b32 v59, v19, v19, v15
    s_nop 1
    v_mfma_f32_16x16x32_bf16 v[224:227], v[56:59], a[28:31], v[224:227]
    v_perm_b32 v60, v35, v35, v9
    v_perm_b32 v61, v35, v35, v11
    v_perm_b32 v62, v35, v35, v13
    v_perm_b32 v63, v35, v35, v15
    s_nop 1
    v_mfma_f32_16x16x32_bf16 v[228:231], v[60:63], a[28:31], v[228:231]
    v_perm_b32 v48, v20, v20, v8
    v_perm_b32 v49, v20, v20, v10
    v_perm_b32 v50, v20, v20, v12
    v_perm_b32 v51, v20, v20, v14
    s_nop 1
    v_mfma_f32_16x16x32_bf16 v[224:227], v[48:51], a[32:35], v[224:227]
    v_perm_b32 v52, v36, v36, v8
    v_perm_b32 v53, v36, v36, v10
    v_perm_b32 v54, v36, v36, v12
    v_perm_b32 v55, v36, v36, v14
    s_nop 1
    v_mfma_f32_16x16x32_bf16 v[228:231], v[52:55], a[32:35], v[228:231]
    v_perm_b32 v56, v20, v20, v9
    v_perm_b32 v57, v20, v20, v11
    v_perm_b32 v58, v20, v20, v13
    v_perm_b32 v59, v20, v20, v15
    s_nop 1
    v_mfma_f32_16x16x32_bf16 v[224:227], v[56:59], a[36:39], v[224:227]
    v_perm_b32 v60, v36, v36, v9
    v_perm_b32 v61, v36, v36, v11
    v_perm_b32 v62, v36, v36, v13
    v_perm_b32 v63, v36, v36, v15
    s_nop 1
    v_mfma_f32_16x16x32_bf16 v[228:231], v[60:63], a[36:39], v[228:231]
    v_perm_b32 v48, v21, v21, v8
    v_perm_b32 v49, v21, v21, v10
    v_perm_b32 v50, v21, v21, v12
    v_perm_b32 v51, v21, v21, v14
    s_nop 1
    v_mfma_f32_16x16x32_bf16 v[224:227], v[48:51], a[40:43], v[224:227]
    v_perm_b32 v52, v37, v37, v8
    v_perm_b32 v53, v37, v37, v10
    v_perm_b32 v54, v37, v37, v12
    v_perm_b32 v55, v37, v37, v14
    s_nop 1
    v_mfma_f32_16x16x32_bf16 v[228:231], v[52:55], a[40:43], v[228:231]
    v_perm_b32 v56, v21, v21, v9
    v_perm_b32 v57, v21, v21, v11
    v_perm_b32 v58, v21, v21, v13
    v_perm_b32 v59, v21, v21, v15
    s_nop 1
    v_mfma_f32_16x16x32_bf16 v[224:227], v[56:59], a[44:47], v[224:227]
    v_perm_b32 v60, v37, v37, v9
    v_perm_b32 v61, v37, v37, v11
    v_perm_b32 v62, v37, v37, v13
    v_perm_b32 v63, v37, v37, v15
    s_nop 1
    v_mfma_f32_16x16x32_bf16 v[228:231], v[60:63], a[44:47], v[228:231]
    v_perm_b32 v48, v22, v22, v8
    v_perm_b32 v49, v22, v22, v10
    v_perm_b32 v50, v22, v22, v12
    v_perm_b32 v51, v22, v22, v14
    s_nop 1
    v_mfma_f32_16x16x32_bf16 v[224:227], v[48:51], a[48:51], v[224:227]
    v_perm_b32 v52, v38, v38, v8
    v_perm_b32 v53, v38, v38, v10
    v_perm_b32 v54, v38, v38, v12
    v_perm_b32 v55, v38, v38, v14
    s_nop 1
    v_mfma_f32_16x16x32_bf16 v[228:231], v[52:55], a[48:51], v[228:231]
    v_perm_b32 v56, v22, v22, v9
    v_perm_b32 v57, v22, v22, v11
    v_perm_b32 v58, v22, v22, v13
    v_perm_b32 v59, v22, v22, v15
    s_nop 1
    v_mfma_f32_16x16x32_bf16 v[224:227], v[56:59], a[52:55], v[224:227]
    v_perm_b32 v60, v38, v38, v9
    v_perm_b32 v61, v38, v38, v11
    v_perm_b32 v62, v38, v38, v13
    v_perm_b32 v63, v38, v38, v15
    s_nop 1
    v_mfma_f32_16x16x32_bf16 v[228:231], v[60:63], a[52:55], v[228:231]
    v_perm_b32 v48, v23, v23, v8
    v_perm_b32 v49, v23, v23, v10
    v_perm_b32 v50, v23, v23, v12
    v_perm_b32 v51, v23, v23, v14
    s_nop 1
    v_mfma_f32_16x16x32_bf16 v[224:227], v[48:51], a[56:59], v[224:227]
    v_perm_b32 v52, v39, v39, v8
    v_perm_b32 v53, v39, v39, v10
    v_perm_b32 v54, v39, v39, v12
    v_perm_b32 v55, v39, v39, v14
    s_nop 1
    v_mfma_f32_16x16x32_bf16 v[228:231], v[52:55], a[56:59], v[228:231]
    v_perm_b32 v56, v23, v23, v9
    v_perm_b32 v57, v23, v23, v11
    v_perm_b32 v58, v23, v23, v13
    v_perm_b32 v59, v23, v23, v15
    s_nop 1
    v_mfma_f32_16x16x32_bf16 v[224:227], v[56:59], a[60:63], v[224:227]
    v_perm_b32 v60, v39, v39, v9
    v_perm_b32 v61, v39, v39, v11
    v_perm_b32 v62, v39, v39, v13
    v_perm_b32 v63, v39, v39, v15
    s_nop 1
    v_mfma_f32_16x16x32_bf16 v[228:231], v[60:63], a[60:63], v[228:231]
    v_perm_b32 v48, v24, v24, v8
    v_perm_b32 v49, v24, v24, v10
    v_perm_b32 v50, v24, v24, v12
    v_perm_b32 v51, v24, v24, v14
    s_nop 1
    v_mfma_f32_16x16x32_bf16 v[224:227], v[48:51], a[64:67], v[224:227]
    v_perm_b32 v52, v40, v40, v8
    v_perm_b32 v53, v40, v40, v10
    v_perm_b32 v54, v40, v40, v12
    v_perm_b32 v55, v40, v40, v14
    s_nop 1
    v_mfma_f32_16x16x32_bf16 v[228:231], v[52:55], a[64:67], v[228:231]
    v_perm_b32 v56, v24, v24, v9
    v_perm_b32 v57, v24, v24, v11
    v_perm_b32 v58, v24, v24, v13
    v_perm_b32 v59, v24, v24, v15
    s_nop 1
    v_mfma_f32_16x16x32_bf16 v[224:227], v[56:59], a[68:71], v[224:227]
    v_perm_b32 v60, v40, v40, v9
    v_perm_b32 v61, v40, v40, v11
    v_perm_b32 v62, v40, v40, v13
    v_perm_b32 v63, v40, v40, v15
    s_nop 1
    v_mfma_f32_16x16x32_bf16 v[228:231], v[60:63], a[68:71], v[228:231]
    v_perm_b32 v48, v25, v25, v8
    v_perm_b32 v49, v25, v25, v10
    v_perm_b32 v50, v25, v25, v12
    v_perm_b32 v51, v25, v25, v14
    s_nop 1
    v_mfma_f32_16x16x32_bf16 v[224:227], v[48:51], a[72:75], v[224:227]
    v_perm_b32 v52, v41, v41, v8
    v_perm_b32 v53, v41, v41, v10
    v_perm_b32 v54, v41, v41, v12
    v_perm_b32 v55, v41, v41, v14
    s_nop 1
    v_mfma_f32_16x16x32_bf16 v[228:231], v[52:55], a[72:75], v[228:231]
    v_perm_b32 v56, v25, v25, v9
    v_perm_b32 v57, v25, v25, v11
    v_perm_b32 v58, v25, v25, v13
    v_perm_b32 v59, v25, v25, v15
    s_nop 1
    v_mfma_f32_16x16x32_bf16 v[224:227], v[56:59], a[76:79], v[224:227]
    v_perm_b32 v60, v41, v41, v9
    v_perm_b32 v61, v41, v41, v11
    v_perm_b32 v62, v41, v41, v13
    v_perm_b32 v63, v41, v41, v15
    s_nop 1
    v_mfma_f32_16x16x32_bf16 v[228:231], v[60:63], a[76:79], v[228:231]
    v_perm_b32 v48, v26, v26, v8
    v_perm_b32 v49, v26, v26, v10
    v_perm_b32 v50, v26, v26, v12
    v_perm_b32 v51, v26, v26, v14
    s_nop 1
    v_mfma_f32_16x16x32_bf16 v[224:227], v[48:51], a[80:83], v[224:227]
    v_perm_b32 v52, v42, v42, v8
    v_perm_b32 v53, v42, v42, v10
    v_perm_b32 v54, v42, v42, v12
    v_perm_b32 v55, v42, v42, v14
    s_nop 1
    v_mfma_f32_16x16x32_bf16 v[228:231], v[52:55], a[80:83], v[228:231]
    v_perm_b32 v56, v26, v26, v9
    v_perm_b32 v57, v26, v26, v11
    v_perm_b32 v58, v26, v26, v13
    v_perm_b32 v59, v26, v26, v15
    s_nop 1
    v_mfma_f32_16x16x32_bf16 v[224:227], v[56:59], a[84:87], v[224:227]
    v_perm_b32 v60, v42, v42, v9
    v_perm_b32 v61, v42, v42, v11
    v_perm_b32 v62, v42, v42, v13
    v_perm_b32 v63, v42, v42, v15
    s_nop 1
    v_mfma_f32_16x16x32_bf16 v[228:231], v[60:63], a[84:87], v[228:231]
    v_perm_b32 v48, v27, v27, v8
    v_perm_b32 v49, v27, v27, v10
    v_perm_b32 v50, v27, v27, v12
    v_perm_b32 v51, v27, v27, v14
    s_nop 1
    v_mfma_f32_16x16x32_bf16 v[224:227], v[48:51], a[88:91], v[224:227]
    v_perm_b32 v52, v43, v43, v8
    v_perm_b32 v53, v43, v43, v10
    v_perm_b32 v54, v43, v43, v12
    v_perm_b32 v55, v43, v43, v14
    s_nop 1
    v_mfma_f32_16x16x32_bf16 v[228:231], v[52:55], a[88:91], v[228:231]
    v_perm_b32 v56, v27, v27, v9
    v_perm_b32 v57, v27, v27, v11
    v_perm_b32 v58, v27, v27, v13
    v_perm_b32 v59, v27, v27, v15
    s_nop 1
    v_mfma_f32_16x16x32_bf16 v[224:227], v[56:59], a[92:95], v[224:227]
    v_perm_b32 v60, v43, v43, v9
    v_perm_b32 v61, v43, v43, v11
    v_perm_b32 v62, v43, v43, v13
    v_perm_b32 v63, v43, v43, v15
    s_nop 1
    v_mfma_f32_16x16x32_bf16 v[228:231], v[60:63], a[92:95], v[228:231]
    v_perm_b32 v48, v28, v28, v8
    v_perm_b32 v49, v28, v28, v10
    v_perm_b32 v50, v28, v28, v12
    v_perm_b32 v51, v28, v28, v14
    s_nop 1
    v_mfma_f32_16x16x32_bf16 v[224:227], v[48:51], a[96:99], v[224:227]
    v_perm_b32 v52, v44, v44, v8
    v_perm_b32 v53, v44, v44, v10
    v_perm_b32 v54, v44, v44, v12
    v_perm_b32 v55, v44, v44, v14
    s_nop 1
    v_mfma_f32_16x16x32_bf16 v[228:231], v[52:55], a[96:99], v[228:231]
    v_perm_b32 v56, v28, v28, v9
    v_perm_b32 v57, v28, v28, v11
    v_perm_b32 v58, v28, v28, v13
    v_perm_b32 v59, v28, v28, v15
    s_nop 1
    v_mfma_f32_16x16x32_bf16 v[224:227], v[56:59], a[100:103], v[224:227]
    v_perm_b32 v60, v44, v44, v9
    v_perm_b32 v61, v44, v44, v11
    v_perm_b32 v62, v44, v44, v13
    v_perm_b32 v63, v44, v44, v15
    s_nop 1
    v_mfma_f32_16x16x32_bf16 v[228:231], v[60:63], a[100:103], v[228:231]
    v_perm_b32 v48, v29, v29, v8
    v_perm_b32 v49, v29, v29, v10
    v_perm_b32 v50, v29, v29, v12
    v_perm_b32 v51, v29, v29, v14
    s_nop 1
    v_mfma_f32_16x16x32_bf16 v[224:227], v[48:51], a[104:107], v[224:227]
    v_perm_b32 v52, v45, v45, v8
    v_perm_b32 v53, v45, v45, v10
    v_perm_b32 v54, v45, v45, v12
    v_perm_b32 v55, v45, v45, v14
    s_nop 1
    v_mfma_f32_16x16x32_bf16 v[228:231], v[52:55], a[104:107], v[228:231]
    v_perm_b32 v56, v29, v29, v9
    v_perm_b32 v57, v29, v29, v11
    v_perm_b32 v58, v29, v29, v13
    v_perm_b32 v59, v29, v29, v15
    s_nop 1
    v_mfma_f32_16x16x32_bf16 v[224:227], v[56:59], a[108:111], v[224:227]
    v_perm_b32 v60, v45, v45, v9
    v_perm_b32 v61, v45, v45, v11
    v_perm_b32 v62, v45, v45, v13
    v_perm_b32 v63, v45, v45, v15
    s_nop 1
    v_mfma_f32_16x16x32_bf16 v[228:231], v[60:63], a[108:111], v[228:231]
    v_perm_b32 v48, v30, v30, v8
    v_perm_b32 v49, v30, v30, v10
    v_perm_b32 v50, v30, v30, v12
    v_perm_b32 v51, v30, v30, v14
    s_nop 1
    v_mfma_f32_16x16x32_bf16 v[224:227], v[48:51], a[112:115], v[224:227]
    v_perm_b32 v52, v46, v46, v8
    v_perm_b32 v53, v46, v46, v10
    v_perm_b32 v54, v46, v46, v12
    v_perm_b32 v55, v46, v46, v14
    s_nop 1
    v_mfma_f32_16x16x32_bf16 v[228:231], v[52:55], a[112:115], v[228:231]
    v_perm_b32 v56, v30, v30, v9
    v_perm_b32 v57, v30, v30, v11
    v_perm_b32 v58, v30, v30, v13
    v_perm_b32 v59, v30, v30, v15
    s_nop 1
    v_mfma_f32_16x16x32_bf16 v[224:227], v[56:59], a[116:119], v[224:227]
    v_perm_b32 v60, v46, v46, v9
    v_perm_b32 v61, v46, v46, v11
    v_perm_b32 v62, v46, v46, v13
    v_perm_b32 v63, v46, v46, v15
    s_nop 1
    v_mfma_f32_16x16x32_bf16 v[228:231], v[60:63], a[116:119], v[228:231]
    v_perm_b32 v48, v31, v31, v8
    v_perm_b32 v49, v31, v31, v10
    v_perm_b32 v50, v31, v31, v12
    v_perm_b32 v51, v31, v31, v14
    s_nop 1
    v_mfma_f32_16x16x32_bf16 v[224:227], v[48:51], a[120:123], v[224:227]
    v_perm_b32 v52, v47, v47, v8
    v_perm_b32 v53, v47, v47, v10
    v_perm_b32 v54, v47, v47, v12
    v_perm_b32 v55, v47, v47, v14
    s_nop 1
    v_mfma_f32_16x16x32_bf16 v[228:231], v[52:55], a[120:123], v[228:231]
    v_perm_b32 v56, v31, v31, v9
    v_perm_b32 v57, v31, v31, v11
    v_perm_b32 v58, v31, v31, v13
    v_perm_b32 v59, v31, v31, v15
    s_nop 1
    v_mfma_f32_16x16x32_bf16 v[224:227], v[56:59], a[124:127], v[224:227]
    v_perm_b32 v60, v47, v47, v9
    v_perm_b32 v61, v47, v47, v11
    v_perm_b32 v62, v47, v47, v13
    v_perm_b32 v63, v47, v47, v15
    s_nop 1
    v_mfma_f32_16x16x32_bf16 v[228:231], v[60:63], a[124:127], v[228:231]
    v_lshrrev_b32 v5, 1, v4
    v_lshlrev_b32 v5, 9, v5
    v_lshl_add_u32 v5, v3, 5, v5
    v_and_b32 v6, 1, v4
    v_lshl_add_u32 v5, v6, 4, v5
    s_lshl_b32 s54, s3, 11
    s_add_u32 s54, s54, 131072
    v_add_u32 v5, s54, v5
    ds_write_b128 v5, v[224:227]
    ds_write_b128 v5, v[228:231] offset:1024
    s_waitcnt lgkmcnt(0)
    s_barrier
    v_lshrrev_b32 v5, 2, v3
    v_lshlrev_b32 v5, 9, v5
    v_lshl_add_u32 v5, v4, 5, v5
    s_lshl_b32 s54, s3, 7
    s_add_u32 s54, s54, 131072
    v_add_u32 v5, s54, v5
    ds_read_b128 v[16:19], v5 offset:0
    ds_read_b128 v[20:23], v5 offset:16
    ds_read_b128 v[24:27], v5 offset:2048
    ds_read_b128 v[28:31], v5 offset:2064
    ds_read_b128 v[32:35], v5 offset:4096
    ds_read_b128 v[36:39], v5 offset:4112
    ds_read_b128 v[40:43], v5 offset:6144
    ds_read_b128 v[44:47], v5 offset:6160
    s_waitcnt lgkmcnt(0)
    v_add_f32 v16, v16, v24
    v_add_f32 v32, v32, v40
    v_add_f32 v17, v17, v25
    v_add_f32 v33, v33, v41
    v_add_f32 v18, v18, v26
    v_add_f32 v34, v34, v42
    v_add_f32 v19, v19, v27
    v_add_f32 v35, v35, v43
    v_add_f32 v20, v20, v28
    v_add_f32 v36, v36, v44
    v_add_f32 v21, v21, v29
    v_add_f32 v37, v37, v45
    v_add_f32 v22, v22, v30
    v_add_f32 v38, v38, v46
    v_add_f32 v23, v23, v31
    v_add_f32 v39, v39, v47
    v_add_f32 v16, v16, v32
    v_add_f32 v17, v17, v33
    v_add_f32 v18, v18, v34
    v_add_f32 v19, v19, v35
    v_add_f32 v20, v20, v36
    v_add_f32 v21, v21, v37
    v_add_f32 v22, v22, v38
    v_add_f32 v23, v23, v39
    v_cvt_pk_bf16_f32 v64, v16, v17
    v_cvt_pk_bf16_f32 v65, v18, v19
    v_cvt_pk_bf16_f32 v66, v20, v21
    v_cvt_pk_bf16_f32 v67, v22, v23
    v_min_u32 v64, -2, v64
    v_min_u32 v65, -2, v65
    v_min_u32 v66, -2, v66
    v_min_u32 v67, -2, v67
    v_bfe_u32 v6, v1, 2, 2
    v_lshlrev_b32 v6, 6, v6
    v_and_b32 v5, 48, v1
    v_add_u32 v6, v6, v5
    v_and_b32 v5, 3, v1
    v_lshl_add_u32 v6, v5, 29, v6
    s_lshl_b32 s54, s52, 10
    s_lshl_b32 s55, s3, 8
    s_add_u32 s54, s54, s55
    s_add_u32 s54, s54, 5439488
    buffer_store_dwordx4 v[64:67], v6, s[44:47], s54 offen sc1
    s_mov_b32 s48, s26
    s_mov_b32 s49, s27
    s_mov_b32 s50, 9216
    s_mov_b32 s51, 0x20000
    s_lshl_b32 s54, s3, 5
    s_add_u32 s54, s54, s53
    s_cmp_ge_u32 s54, 72
    s_cbranch_scc1 L_nored_22
    v_mov_b32 v48, -1
    v_mov_b32 v49, -1
    v_mov_b32 v50, -1
    v_mov_b32 v51, -1
    v_mov_b32 v52, -1
    v_mov_b32 v53, -1
    v_mov_b32 v54, -1
    v_mov_b32 v55, -1
    v_mov_b32 v56, -1
    v_mov_b32 v57, -1
    v_mov_b32 v58, -1
    v_mov_b32 v59, -1
    v_mov_b32 v60, -1
    v_mov_b32 v61, -1
    v_mov_b32 v62, -1
    v_mov_b32 v63, -1
    s_lshl_b32 s55, s54, 12
    s_add_u32 s55, s55, 4718592
    s_mul_hi_u32 s56, s54, 238609295
    s_add_u32 s56, s56, 1
    s_mul_i32 s56, s56, 1152
    s_lshl_b32 s57, s54, 6
    s_add_u32 s56, s56, s57
    v_lshlrev_b32 v5, 3, v3
    v_lshl_add_u32 v5, v4, 1, v5
    v_mov_b32 v6, 0x4000
    v_cmp_gt_u32 vcc, 8, v3
    s_nop 1
    v_cndmask_b32 v5, v6, v5, vcc
    s_mov_b64 s[4:5], -1
    s_mov_b64 s[6:7], -1
    s_mov_b64 s[8:9], -1
    s_mov_b64 s[10:11], -1
L_mpoll_23:
    s_mov_b64 exec, s[4:5]
    buffer_load_dwordx4 v[48:51], v2, s[44:47], s55 offen offset:0 sc1
    s_mov_b64 exec, s[6:7]
    buffer_load_dwordx4 v[52:55], v2, s[44:47], s55 offen offset:1024 sc1
    s_mov_b64 exec, s[8:9]
    buffer_load_dwordx4 v[56:59], v2, s[44:47], s55 offen offset:2048 sc1
    s_mov_b64 exec, s[10:11]
    buffer_load_dwordx4 v[60:63], v2, s[44:47], s55 offen offset:3072 sc1
    s_mov_b64 exec, -1
    s_waitcnt vmcnt(4)
    v_max3_u32 v32, v48, v49, v50
    v_max3_u32 v33, v52, v53, v54
    v_max3_u32 v34, v56, v57, v58
    v_max3_u32 v35, v60, v61, v62
    v_max_u32 v32, v32, v51
    v_max_u32 v33, v33, v55
    v_max_u32 v34, v34, v59
    v_max_u32 v35, v35, v63
    v_cmp_eq_u32 s[4:5], -1, v32
    v_cmp_eq_u32 s[6:7], -1, v33
    v_cmp_eq_u32 s[8:9], -1, v34
    v_cmp_eq_u32 s[10:11], -1, v35
    s_or_b64 vcc, s[4:5], s[6:7]
    s_or_b64 vcc, vcc, s[8:9]
    s_or_b64 vcc, vcc, s[10:11]
    s_cbranch_scc0 L_mpollok_24
    s_and_b64 vcc, s[4:5], s[6:7]
    s_and_b64 vcc, vcc, s[8:9]
    s_and_b64 vcc, vcc, s[10:11]
    s_cmp_eq_u64 vcc, -1
    s_cbranch_scc0 L_mpoll_23_b
    s_sleep 4
L_mpoll_23_b:
    s_sub_u32 s101, s101, 1
    s_cbranch_scc0 L_mpoll_23
    s_mov_b32 s101, 0
L_mpollok_24:
    v_add_f32 v16, v48, v52
    v_add_f32 v24, v56, v60
    v_add_f32 v18, v50, v54
    v_add_f32 v26, v58, v62
    v_add_f32 v17, v49, v53
    v_add_f32 v25, v57, v61
    v_add_f32 v19, v51, v55
    v_add_f32 v27, v59, v63
    v_add_f32 v16, v16, v24
    v_add_f32 v18, v18, v26
    v_add_f32 v17, v17, v25
    v_add_f32 v19, v19, v27
    v_permlane32_swap_b32 v16, v18
    s_nop 0
    v_permlane32_swap_b32 v17, v19
    v_add_f32 v16, v16, v18
    v_add_f32 v17, v17, v19
    s_nop 1
    v_permlane16_swap_b32 v16, v17
    v_add_f32 v16, v16, v17
    s_nop 1
    v_add_f32_dpp v16, v16, v16 row_ror:8 row_mask:0xf bank_mask:0xf
    v_cvt_pk_bf16_f32 v16, v16, v16
    buffer_store_short v16, v5, s[48:51], s56 offen
L_nored_22:
    s_endpgm
L_roleH_end:
L_roleC:
    s_mov_b32 s101, 100000
    s_getpc_b64 s[56:57]
L_pc_25:
    s_sub_u32 s56, s56, L_pc_25-L_roleC
    s_subb_u32 s57, s57, 0
    v_lshlrev_b32 v5, 7, v0
    v_min_u32 v6, L_roleC_end-L_roleC-4, v5
    global_load_dword v122, v6, s[56:57]
    v_add_u32 v5, 32768, v5
    v_min_u32 v6, L_roleC_end-L_roleC-4, v5
    global_load_dword v122, v6, s[56:57]
    v_mov_b32 v20, -1
    v_mov_b32 v21, -1
    v_mov_b32 v22, -1
    v_mov_b32 v23, -1
    v_mul_u32_u24 v7, 73728, v4
    v_lshrrev_b32 v5, 3, v3
    v_lshl_add_u32 v6, v5, 13, v7
    v_and_b32 v5, 7, v3
    v_lshl_add_u32 v6, v5, 4, v6
    v_lshl_add_u32 v7, v3, 3, v7
    v_add_u32 v7, 65536, v7
    s_lshl_b32 s56, s52, 7
    s_add_u32 s56, s56, 4194304
    s_lshl_b32 s54, s3, 14
    s_add_u32 s54, s54, s56
    s_add_u32 s55, s54, 4096
    s_and_b32 s57, s3, 1
    s_lshl_b32 s57, s57, 12
    s_add_u32 s56, s56, s57
    s_waitcnt lgkmcnt(0)
    s_mov_b32 s44, s30
    s_mov_b32 s45, s31
    s_mov_b32 s46, 536870912
    s_mov_b32 s47, 0x20000
    buffer_store_dwordx4 v[20:23], v6, s[44:47], s54 offen sc1
    buffer_store_dwordx4 v[20:23], v6, s[44:47], s55 offen sc1
    buffer_store_dwordx2 v[20:21], v7, s[44:47], s56 offen sc1
    v_mov_b32 v7, 536870912
    v_cmp_gt_u32 vcc, 16, v1
    s_nop 1
    v_cndmask_b32 v123, v7, v2, vcc
    s_lshl_b32 s98, s52, 10
    s_lshl_b32 s54, s3, 8
    s_add_u32 s98, s98, s54
    s_add_u32 s98, s98, 5242880
    buffer_store_dwordx4 v[20:23], v123, s[44:47], s98 offen sc1
    s_lshl_b32 s58, s52, 2
    s_add_u32 s58, s58, s3
    s_lshl_b32 s58, s58, 13
    s_add_u32 s58, s58, 8388608
    s_add_u32 s59, s58, 4096
    v_min_u32 v6, 1, v3
    v_lshl_add_u32 v6, v6, 2, v4
    v_lshlrev_b32 v6, 4, v6
    s_lshr_b32 s55, s52, 2
    s_add_u32 s55, s55, s3
    s_and_b32 s55, s55, 3
    s_and_b32 s54, s52, 3
    s_cmp_eq_u32 s54, s55
    s_mov_b32 s56, 255
    s_cselect_b32 s56, 16777215, s56
    s_mov_b32 s57, 0
    s_cbranch_scc0 L_cclr
    buffer_store_dwordx4 v[20:23], v2, s[44:47], s58 offen offset:2048 sc1
    buffer_store_dwordx4 v[20:23], v2, s[44:47], s58 offen offset:3072 sc1
    buffer_store_dwordx4 v[20:23], v2, s[44:47], s59 offen offset:0 sc1
    buffer_store_dwordx4 v[20:23], v2, s[44:47], s59 offen offset:1024 sc1
    s_and_b32 s55, s52, 28
    s_add_u32 s55, s55, s3
    s_mul_i32 s55, s55, 256
    s_add_u32 s55, s55, 16777216
    v_mov_b32 v5, 0
    s_mov_b64 exec, 1
    buffer_store_dword v5, v5, s[44:47], s55 offen sc1
    s_lshl_b32 s55, s53, 8
    s_add_u32 s55, s55, 3145728
    s_mov_b64 exec, 0xffff
    buffer_store_dwordx4 v[20:23], v2, s[44:47], s55 offen sc1
    s_mov_b64 exec, -1
L_cclr:
    buffer_store_dwordx4 v[20:23], v2, s[44:47], s58 offen offset:0 sc1
    buffer_store_dwordx4 v[20:23], v2, s[44:47], s58 offen offset:1024 sc1
    s_mov_b64 exec, s[56:57]
    buffer_store_dwordx4 v[20:23], v2, s[44:47], s59 offen offset:2048 sc1
    s_mov_b64 exec, -1
    s_mov_b32 s40, s10
    s_mov_b32 s41, s11
    s_mov_b32 s42, 4718592
    s_mov_b32 s43, 0x20000
    s_mov_b32 s48, s4
    s_mov_b32 s49, s5
    s_mov_b32 s50, 4608
    s_mov_b32 s51, 0x20000
    s_mov_b32 s32, s16
    s_mov_b32 s33, s17
    s_mov_b32 s34, 16777216
    s_mov_b32 s35, 0x20000
    v_lshrrev_b32 v5, 3, v3
    v_mul_u32_u24 v5, 1152, v5
    v_mul_u32_u24 v6, 72, v4
    v_add_u32 v5, v5, v6
    s_mul_i32 s54, s3, 288
    buffer_load_dwordx4 v[48:51], v5, s[48:51], s54 offen offset:0
    buffer_load_dwordx4 v[52:55], v5, s[48:51], s54 offen offset:16
    buffer_load_dwordx4 v[56:59], v5, s[48:51], s54 offen offset:32
    buffer_load_dwordx4 v[60:63], v5, s[48:51], s54 offen offset:48
    buffer_load_dwordx2 v[64:65], v5, s[48:51], s54 offen offset:64
    buffer_load_dwordx4 v[68:71], v5, s[48:51], s54 offen offset:2304
    buffer_load_dwordx4 v[72:75], v5, s[48:51], s54 offen offset:2320
    buffer_load_dwordx4 v[76:79], v5, s[48:51], s54 offen offset:2336
    buffer_load_dwordx4 v[80:83], v5, s[48:51], s54 offen offset:2352
    buffer_load_dwordx2 v[84:85], v5, s[48:51], s54 offen offset:2368
    v_mul_u32_u24 v120, 294912, v4
    v_lshl_add_u32 v120, v3, 4, v120
    s_mul_i32 s61, s3, 1179648
    s_lshl_b32 s54, s52, 8
    s_add_u32 s61, s61, s54
    buffer_load_dwordx4 a[0:3], v120, s[40:43], s61 offen nt
    s_add_u32 s61, s61, 8192
    buffer_load_dwordx4 a[4:7], v120, s[40:43], s61 offen nt
    s_add_u32 s61, s61, 8192
    buffer_load_dwordx4 a[8:11], v120, s[40:43], s61 offen nt
    s_add_u32 s61, s61, 8192
    buffer_load_dwordx4 a[12:15], v120, s[40:43], s61 offen nt
    s_add_u32 s61, s61, 8192
    buffer_load_dwordx4 a[16:19], v120, s[40:43], s61 offen nt
    s_add_u32 s61, s61, 8192
    buffer_load_dwordx4 a[20:23], v120, s[40:43], s61 offen nt
    s_add_u32 s61, s61, 8192
    buffer_load_dwordx4 a[24:27], v120, s[40:43], s61 offen nt
    s_add_u32 s61, s61, 8192
    buffer_load_dwordx4 a[28:31], v120, s[40:43], s61 offen nt
    s_add_u32 s61, s61, 8192
    buffer_load_dwordx4 a[32:35], v120, s[40:43], s61 offen nt
    s_add_u32 s61, s61, 8192
    s_waitcnt vmcnt(19)
    s_barrier
    s_cmp_lg_u32 s3, 0
    s_cbranch_scc1 L_nosig_26
    s_mov_b32 s97, 1
    s_atomic_add s97, s[28:29], 0 glc
L_nosig_26:
    buffer_load_dwordx4 a[36:39], v120, s[40:43], s61 offen nt
    s_add_u32 s61, s61, 8192
    buffer_load_dwordx4 a[40:43], v120, s[40:43], s61 offen nt
    s_add_u32 s61, s61, 8192
    buffer_load_dwordx4 a[44:47], v120, s[40:43], s61 offen nt
    s_add_u32 s61, s61, 8192
    buffer_load_dwordx4 a[48:51], v120, s[40:43], s61 offen nt
    s_add_u32 s61, s61, 8192
    buffer_load_dwordx4 a[52:55], v120, s[40:43], s61 offen nt
    s_add_u32 s61, s61, 8192
    buffer_load_dwordx4 a[56:59], v120, s[40:43], s61 offen nt
    s_add_u32 s61, s61, 8192
    buffer_load_dwordx4 a[60:63], v120, s[40:43], s61 offen nt
    s_add_u32 s61, s61, 8192
    buffer_load_dwordx4 a[64:67], v120, s[40:43], s61 offen nt
    s_add_u32 s61, s61, 8192
    buffer_load_dwordx4 a[68:71], v120, s[40:43], s61 offen nt
    s_add_u32 s61, s61, 8192
    buffer_load_dwordx4 a[72:75], v120, s[40:43], s61 offen nt
    s_add_u32 s61, s61, 8192
    buffer_load_dwordx4 a[76:79], v120, s[40:43], s61 offen nt
    s_add_u32 s61, s61, 8192
    buffer_load_dwordx4 a[80:83], v120, s[40:43], s61 offen nt
    s_add_u32 s61, s61, 8192
    buffer_load_dwordx4 a[84:87], v120, s[40:43], s61 offen nt
    s_add_u32 s61, s61, 8192
    buffer_load_dwordx4 a[88:91], v120, s[40:43], s61 offen nt
    s_add_u32 s61, s61, 8192
    buffer_load_dwordx4 a[92:95], v120, s[40:43], s61 offen nt
    s_add_u32 s61, s61, 8192
    buffer_load_dwordx4 a[96:99], v120, s[40:43], s61 offen nt
    s_add_u32 s61, s61, 8192
    buffer_load_dwordx4 a[100:103], v120, s[40:43], s61 offen nt
    s_add_u32 s61, s61, 8192
    buffer_load_dwordx4 a[104:107], v120, s[40:43], s61 offen nt
    s_add_u32 s61, s61, 8192
    buffer_load_dwordx4 a[108:111], v120, s[40:43], s61 offen nt
    s_add_u32 s61, s61, 8192
    buffer_load_dwordx4 a[112:115], v120, s[40:43], s61 offen nt
    s_add_u32 s61, s61, 8192
    buffer_load_dwordx4 a[116:119], v120, s[40:43], s61 offen nt
    s_add_u32 s61, s61, 8192
    buffer_load_dwordx4 a[120:123], v120, s[40:43], s61 offen nt
    s_add_u32 s61, s61, 8192
    buffer_load_dwordx4 a[124:127], v120, s[40:43], s61 offen nt
    s_add_u32 s61, s61, 8192
    buffer_load_dwordx4 a[128:131], v120, s[40:43], s61 offen nt
    s_add_u32 s61, s61, 8192
    buffer_load_dwordx4 a[132:135], v120, s[40:43], s61 offen nt
    s_add_u32 s61, s61, 8192
    buffer_load_dwordx4 a[136:139], v120, s[40:43], s61 offen nt
    s_add_u32 s61, s61, 8192
    buffer_load_dwordx4 a[140:143], v120, s[40:43], s61 offen nt
    s_add_u32 s61, s61, 8192
    v_and_b32 v5, 1, v3
    v_cmp_eq_u32 vcc, 1, v5
    v_mov_b32 v5, 0x0c0c0100
    v_mov_b32 v6, 0x01000c0c
    v_cndmask_b32 v5, v5, v6, vcc
    v_mov_b32 v6, 0x0c0c0302
    v_mov_b32 v7, 0x03020c0c
    v_cndmask_b32 v6, v6, v7, vcc
    v_bfe_u32 v7, v3, 1, 2
    v_mov_b32 v16, 0x0c0c0c0c
    v_cmp_eq_u32 vcc, 0, v7
    s_nop 1
    v_cndmask_b32 v8, v16, v5, vcc
    v_cndmask_b32 v9, v16, v6, vcc
    v_cmp_eq_u32 vcc, 1, v7
    s_nop 1
    v_cndmask_b32 v10, v16, v5, vcc
    v_cndmask_b32 v11, v16, v6, vcc
    v_cmp_eq_u32 vcc, 2, v7
    s_nop 1
    v_cndmask_b32 v12, v16, v5, vcc
    v_cndmask_b32 v13, v16, v6, vcc
    v_cmp_eq_u32 vcc, 3, v7
    s_nop 1
    v_cndmask_b32 v14, v16, v5, vcc
    v_cndmask_b32 v15, v16, v6, vcc
    v_lshlrev_b32 v5, 2, v4
    v_xor_b32 v5, v5, v3
    v_lshlrev_b32 v6, 10, v4
    v_xor_b32 v7, 0, v5
    v_lshl_add_u32 v20, v7, 4, v6
    v_xor_b32 v7, 1, v5
    v_lshl_add_u32 v21, v7, 4, v6
    v_add_u32 v21, 4096, v21
    v_xor_b32 v7, 2, v5
    v_lshl_add_u32 v22, v7, 4, v6
    v_add_u32 v22, 8192, v22
    v_xor_b32 v7, 3, v5
    v_lshl_add_u32 v23, v7, 4, v6
    v_add_u32 v23, 12288, v23
    s_lshl_b32 s58, s53, 19
    s_lshl_b32 s54, s3, 8
    s_add_u32 s58, s58, s54
    s_lshl_b32 s63, s3, 15
    s_mov_b32 s59, s63
    s_add_u32 m0, s59, 0
    s_add_u32 s54, s58, 0
    buffer_load_dwordx4 v20, s[32:35], s54 offen nt lds
    s_add_u32 m0, s59, 1024
    s_add_u32 s54, s58, 0
    buffer_load_dwordx4 v21, s[32:35], s54 offen nt lds
    s_add_u32 m0, s59, 2048
    s_add_u32 s54, s58, 0
    buffer_load_dwordx4 v22, s[32:35], s54 offen nt lds
    s_add_u32 m0, s59, 3072
    s_add_u32 s54, s58, 0
    buffer_load_dwordx4 v23, s[32:35], s54 offen nt lds
    s_add_u32 m0, s59, 4096
    s_add_u32 s54, s58, 16384
    buffer_load_dwordx4 v20, s[32:35], s54 offen nt lds
    s_add_u32 m0, s59, 5120
    s_add_u32 s54, s58, 16384
    buffer_load_dwordx4 v21, s[32:35], s54 offen nt lds
    s_add_u32 m0, s59, 6144
    s_add_u32 s54, s58, 16384
    buffer_load_dwordx4 v22, s[32:35], s54 offen nt lds
    s_add_u32 m0, s59, 7168
    s_add_u32 s54, s58, 16384
    buffer_load_dwordx4 v23, s[32:35], s54 offen nt lds
    s_add_u32 s58, s58, 32768
    s_add_u32 s59, s59, 8192
    s_waitcnt vmcnt(35)
    v_perm_b32 v96, v48, v48, v8
    v_perm_b32 v97, v48, v48, v10
    v_perm_b32 v98, v48, v48, v12
    v_perm_b32 v99, v48, v48, v14
    s_nop 1
    v_mfma_f32_16x16x32_bf16 v[112:115], v[96:99], a[0:3], 0
    v_perm_b32 v100, v68, v68, v8
    v_perm_b32 v101, v68, v68, v10
    v_perm_b32 v102, v68, v68, v12
    v_perm_b32 v103, v68, v68, v14
    s_nop 1
    v_mfma_f32_16x16x32_bf16 v[116:119], v[100:103], a[0:3], 0
    v_perm_b32 v104, v48, v48, v9
    v_perm_b32 v105, v48, v48, v11
    v_perm_b32 v106, v48, v48, v13
    v_perm_b32 v107, v48, v48, v15
    s_nop 1
    v_mfma_f32_16x16x32_bf16 v[112:115], v[104:107], a[4:7], v[112:115]
    v_perm_b32 v108, v68, v68, v9
    v_perm_b32 v109, v68, v68, v11
    v_perm_b32 v110, v68, v68, v13
    v_perm_b32 v111, v68, v68, v15
    s_nop 1
    v_mfma_f32_16x16x32_bf16 v[116:119], v[108:111], a[4:7], v[116:119]
    v_perm_b32 v96, v49, v49, v8
    v_perm_b32 v97, v49, v49, v10
    v_perm_b32 v98, v49, v49, v12
    v_perm_b32 v99, v49, v49, v14
    s_nop 1
    v_mfma_f32_16x16x32_bf16 v[112:115], v[96:99], a[8:11], v[112:115]
    v_perm_b32 v100, v69, v69, v8
    v_perm_b32 v101, v69, v69, v10
    v_perm_b32 v102, v69, v69, v12
    v_perm_b32 v103, v69, v69, v14
    s_nop 1
    v_mfma_f32_16x16x32_bf16 v[116:119], v[100:103], a[8:11], v[116:119]
    v_perm_b32 v104, v49, v49, v9
    v_perm_b32 v105, v49, v49, v11
    v_perm_b32 v106, v49, v49, v13
    v_perm_b32 v107, v49, v49, v15
    s_nop 1
    v_mfma_f32_16x16x32_bf16 v[112:115], v[104:107], a[12:15], v[112:115]
    v_perm_b32 v108, v69, v69, v9
    v_perm_b32 v109, v69, v69, v11
    v_perm_b32 v110, v69, v69, v13
    v_perm_b32 v111, v69, v69, v15
    s_nop 1
    v_mfma_f32_16x16x32_bf16 v[116:119], v[108:111], a[12:15], v[116:119]
    v_perm_b32 v96, v50, v50, v8
    v_perm_b32 v97, v50, v50, v10
    v_perm_b32 v98, v50, v50, v12
    v_perm_b32 v99, v50, v50, v14
    s_nop 1
    v_mfma_f32_16x16x32_bf16 v[112:115], v[96:99], a[16:19], v[112:115]
    v_perm_b32 v100, v70, v70, v8
    v_perm_b32 v101, v70, v70, v10
    v_perm_b32 v102, v70, v70, v12
    v_perm_b32 v103, v70, v70, v14
    s_nop 1
    v_mfma_f32_16x16x32_bf16 v[116:119], v[100:103], a[16:19], v[116:119]
    v_perm_b32 v104, v50, v50, v9
    v_perm_b32 v105, v50, v50, v11
    v_perm_b32 v106, v50, v50, v13
    v_perm_b32 v107, v50, v50, v15
    s_nop 1
    v_mfma_f32_16x16x32_bf16 v[112:115], v[104:107], a[20:23], v[112:115]
    v_perm_b32 v108, v70, v70, v9
    v_perm_b32 v109, v70, v70, v11
    v_perm_b32 v110, v70, v70, v13
    v_perm_b32 v111, v70, v70, v15
    s_nop 1
    v_mfma_f32_16x16x32_bf16 v[116:119], v[108:111], a[20:23], v[116:119]
    v_perm_b32 v96, v51, v51, v8
    v_perm_b32 v97, v51, v51, v10
    v_perm_b32 v98, v51, v51, v12
    v_perm_b32 v99, v51, v51, v14
    s_nop 1
    v_mfma_f32_16x16x32_bf16 v[112:115], v[96:99], a[24:27], v[112:115]
    v_perm_b32 v100, v71, v71, v8
    v_perm_b32 v101, v71, v71, v10
    v_perm_b32 v102, v71, v71, v12
    v_perm_b32 v103, v71, v71, v14
    s_nop 1
    v_mfma_f32_16x16x32_bf16 v[116:119], v[100:103], a[24:27], v[116:119]
    v_perm_b32 v104, v51, v51, v9
    v_perm_b32 v105, v51, v51, v11
    v_perm_b32 v106, v51, v51, v13
    v_perm_b32 v107, v51, v51, v15
    s_nop 1
    v_mfma_f32_16x16x32_bf16 v[112:115], v[104:107], a[28:31], v[112:115]
    v_perm_b32 v108, v71, v71, v9
    v_perm_b32 v109, v71, v71, v11
    v_perm_b32 v110, v71, v71, v13
    v_perm_b32 v111, v71, v71, v15
    s_nop 1
    v_mfma_f32_16x16x32_bf16 v[116:119], v[108:111], a[28:31], v[116:119]
    v_perm_b32 v96, v52, v52, v8
    v_perm_b32 v97, v52, v52, v10
    v_perm_b32 v98, v52, v52, v12
    v_perm_b32 v99, v52, v52, v14
    s_nop 1
    v_mfma_f32_16x16x32_bf16 v[112:115], v[96:99], a[32:35], v[112:115]
    v_perm_b32 v100, v72, v72, v8
    v_perm_b32 v101, v72, v72, v10
    v_perm_b32 v102, v72, v72, v12
    v_perm_b32 v103, v72, v72, v14
    s_nop 1
    v_mfma_f32_16x16x32_bf16 v[116:119], v[100:103], a[32:35], v[116:119]
    s_waitcnt vmcnt(26)
    v_perm_b32 v104, v52, v52, v9
    v_perm_b32 v105, v52, v52, v11
    v_perm_b32 v106, v52, v52, v13
    v_perm_b32 v107, v52, v52, v15
    s_nop 1
    v_mfma_f32_16x16x32_bf16 v[112:115], v[104:107], a[36:39], v[112:115]
    v_perm_b32 v108, v72, v72, v9
    v_perm_b32 v109, v72, v72, v11
    v_perm_b32 v110, v72, v72, v13
    v_perm_b32 v111, v72, v72, v15
    s_nop 1
    v_mfma_f32_16x16x32_bf16 v[116:119], v[108:111], a[36:39], v[116:119]
    v_perm_b32 v96, v53, v53, v8
    v_perm_b32 v97, v53, v53, v10
    v_perm_b32 v98, v53, v53, v12
    v_perm_b32 v99, v53, v53, v14
    s_nop 1
    v_mfma_f32_16x16x32_bf16 v[112:115], v[96:99], a[40:43], v[112:115]
    v_perm_b32 v100, v73, v73, v8
    v_perm_b32 v101, v73, v73, v10
    v_perm_b32 v102, v73, v73, v12
    v_perm_b32 v103, v73, v73, v14
    s_nop 1
    v_mfma_f32_16x16x32_bf16 v[116:119], v[100:103], a[40:43], v[116:119]
    v_perm_b32 v104, v53, v53, v9
    v_perm_b32 v105, v53, v53, v11
    v_perm_b32 v106, v53, v53, v13
    v_perm_b32 v107, v53, v53, v15
    s_nop 1
    v_mfma_f32_16x16x32_bf16 v[112:115], v[104:107], a[44:47], v[112:115]
    v_perm_b32 v108, v73, v73, v9
    v_perm_b32 v109, v73, v73, v11
    v_perm_b32 v110, v73, v73, v13
    v_perm_b32 v111, v73, v73, v15
    s_nop 1
    v_mfma_f32_16x16x32_bf16 v[116:119], v[108:111], a[44:47], v[116:119]
    v_perm_b32 v96, v54, v54, v8
    v_perm_b32 v97, v54, v54, v10
    v_perm_b32 v98, v54, v54, v12
    v_perm_b32 v99, v54, v54, v14
    s_nop 1
    v_mfma_f32_16x16x32_bf16 v[112:115], v[96:99], a[48:51], v[112:115]
    v_perm_b32 v100, v74, v74, v8
    v_perm_b32 v101, v74, v74, v10
    v_perm_b32 v102, v74, v74, v12
    v_perm_b32 v103, v74, v74, v14
    s_nop 1
    v_mfma_f32_16x16x32_bf16 v[116:119], v[100:103], a[48:51], v[116:119]
    v_perm_b32 v104, v54, v54, v9
    v_perm_b32 v105, v54, v54, v11
    v_perm_b32 v106, v54, v54, v13
    v_perm_b32 v107, v54, v54, v15
    s_nop 1
    v_mfma_f32_16x16x32_bf16 v[112:115], v[104:107], a[52:55], v[112:115]
    v_perm_b32 v108, v74, v74, v9
    v_perm_b32 v109, v74, v74, v11
    v_perm_b32 v110, v74, v74, v13
    v_perm_b32 v111, v74, v74, v15
    s_nop 1
    v_mfma_f32_16x16x32_bf16 v[116:119], v[108:111], a[52:55], v[116:119]
    v_perm_b32 v96, v55, v55, v8
    v_perm_b32 v97, v55, v55, v10
    v_perm_b32 v98, v55, v55, v12
    v_perm_b32 v99, v55, v55, v14
    s_nop 1
    v_mfma_f32_16x16x32_bf16 v[112:115], v[96:99], a[56:59], v[112:115]
    v_perm_b32 v100, v75, v75, v8
    v_perm_b32 v101, v75, v75, v10
    v_perm_b32 v102, v75, v75, v12
    v_perm_b32 v103, v75, v75, v14
    s_nop 1
    v_mfma_f32_16x16x32_bf16 v[116:119], v[100:103], a[56:59], v[116:119]
    v_perm_b32 v104, v55, v55, v9
    v_perm_b32 v105, v55, v55, v11
    v_perm_b32 v106, v55, v55, v13
    v_perm_b32 v107, v55, v55, v15
    s_nop 1
    v_mfma_f32_16x16x32_bf16 v[112:115], v[104:107], a[60:63], v[112:115]
    v_perm_b32 v108, v75, v75, v9
    v_perm_b32 v109, v75, v75, v11
    v_perm_b32 v110, v75, v75, v13
    v_perm_b32 v111, v75, v75, v15
    s_nop 1
    v_mfma_f32_16x16x32_bf16 v[116:119], v[108:111], a[60:63], v[116:119]
    v_perm_b32 v96, v56, v56, v8
    v_perm_b32 v97, v56, v56, v10
    v_perm_b32 v98, v56, v56, v12
    v_perm_b32 v99, v56, v56, v14
    s_nop 1
    v_mfma_f32_16x16x32_bf16 v[112:115], v[96:99], a[64:67], v[112:115]
    v_perm_b32 v100, v76, v76, v8
    v_perm_b32 v101, v76, v76, v10
    v_perm_b32 v102, v76, v76, v12
    v_perm_b32 v103, v76, v76, v14
    s_nop 1
    v_mfma_f32_16x16x32_bf16 v[116:119], v[100:103], a[64:67], v[116:119]
    v_perm_b32 v104, v56, v56, v9
    v_perm_b32 v105, v56, v56, v11
    v_perm_b32 v106, v56, v56, v13
    v_perm_b32 v107, v56, v56, v15
    s_nop 1
    v_mfma_f32_16x16x32_bf16 v[112:115], v[104:107], a[68:71], v[112:115]
    v_perm_b32 v108, v76, v76, v9
    v_perm_b32 v109, v76, v76, v11
    v_perm_b32 v110, v76, v76, v13
    v_perm_b32 v111, v76, v76, v15
    s_nop 1
    v_mfma_f32_16x16x32_bf16 v[116:119], v[108:111], a[68:71], v[116:119]
    s_waitcnt vmcnt(17)
    v_perm_b32 v96, v57, v57, v8
    v_perm_b32 v97, v57, v57, v10
    v_perm_b32 v98, v57, v57, v12
    v_perm_b32 v99, v57, v57, v14
    s_nop 1
    v_mfma_f32_16x16x32_bf16 v[112:115], v[96:99], a[72:75], v[112:115]
    v_perm_b32 v100, v77, v77, v8
    v_perm_b32 v101, v77, v77, v10
    v_perm_b32 v102, v77, v77, v12
    v_perm_b32 v103, v77, v77, v14
    s_nop 1
    v_mfma_f32_16x16x32_bf16 v[116:119], v[100:103], a[72:75], v[116:119]
    v_perm_b32 v104, v57, v57, v9
    v_perm_b32 v105, v57, v57, v11
    v_perm_b32 v106, v57, v57, v13
    v_perm_b32 v107, v57, v57, v15
    s_nop 1
    v_mfma_f32_16x16x32_bf16 v[112:115], v[104:107], a[76:79], v[112:115]
    v_perm_b32 v108, v77, v77, v9
    v_perm_b32 v109, v77, v77, v11
    v_perm_b32 v110, v77, v77, v13
    v_perm_b32 v111, v77, v77, v15
    s_nop 1
    v_mfma_f32_16x16x32_bf16 v[116:119], v[108:111], a[76:79], v[116:119]
    v_perm_b32 v96, v58, v58, v8
    v_perm_b32 v97, v58, v58, v10
    v_perm_b32 v98, v58, v58, v12
    v_perm_b32 v99, v58, v58, v14
    s_nop 1
    v_mfma_f32_16x16x32_bf16 v[112:115], v[96:99], a[80:83], v[112:115]
    v_perm_b32 v100, v78, v78, v8
    v_perm_b32 v101, v78, v78, v10
    v_perm_b32 v102, v78, v78, v12
    v_perm_b32 v103, v78, v78, v14
    s_nop 1
    v_mfma_f32_16x16x32_bf16 v[116:119], v[100:103], a[80:83], v[116:119]
    v_perm_b32 v104, v58, v58, v9
    v_perm_b32 v105, v58, v58, v11
    v_perm_b32 v106, v58, v58, v13
    v_perm_b32 v107, v58, v58, v15
    s_nop 1
    v_mfma_f32_16x16x32_bf16 v[112:115], v[104:107], a[84:87], v[112:115]
    v_perm_b32 v108, v78, v78, v9
    v_perm_b32 v109, v78, v78, v11
    v_perm_b32 v110, v78, v78, v13
    v_perm_b32 v111, v78, v78, v15
    s_nop 1
    v_mfma_f32_16x16x32_bf16 v[116:119], v[108:111], a[84:87], v[116:119]
    v_perm_b32 v96, v59, v59, v8
    v_perm_b32 v97, v59, v59, v10
    v_perm_b32 v98, v59, v59, v12
    v_perm_b32 v99, v59, v59, v14
    s_nop 1
    v_mfma_f32_16x16x32_bf16 v[112:115], v[96:99], a[88:91], v[112:115]
    v_perm_b32 v100, v79, v79, v8
    v_perm_b32 v101, v79, v79, v10
    v_perm_b32 v102, v79, v79, v12
    v_perm_b32 v103, v79, v79, v14
    s_nop 1
    v_mfma_f32_16x16x32_bf16 v[116:119], v[100:103], a[88:91], v[116:119]
    v_perm_b32 v104, v59, v59, v9
    v_perm_b32 v105, v59, v59, v11
    v_perm_b32 v106, v59, v59, v13
    v_perm_b32 v107, v59, v59, v15
    s_nop 1
    v_mfma_f32_16x16x32_bf16 v[112:115], v[104:107], a[92:95], v[112:115]
    v_perm_b32 v108, v79, v79, v9
    v_perm_b32 v109, v79, v79, v11
    v_perm_b32 v110, v79, v79, v13
    v_perm_b32 v111, v79, v79, v15
    s_nop 1
    v_mfma_f32_16x16x32_bf16 v[116:119], v[108:111], a[92:95], v[116:119]
    v_perm_b32 v96, v60, v60, v8
    v_perm_b32 v97, v60, v60, v10
    v_perm_b32 v98, v60, v60, v12
    v_perm_b32 v99, v60, v60, v14
    s_nop 1
    v_mfma_f32_16x16x32_bf16 v[112:115], v[96:99], a[96:99], v[112:115]
    v_perm_b32 v100, v80, v80, v8
    v_perm_b32 v101, v80, v80, v10
    v_perm_b32 v102, v80, v80, v12
    v_perm_b32 v103, v80, v80, v14
    s_nop 1
    v_mfma_f32_16x16x32_bf16 v[116:119], v[100:103], a[96:99], v[116:119]
    v_perm_b32 v104, v60, v60, v9
    v_perm_b32 v105, v60, v60, v11
    v_perm_b32 v106, v60, v60, v13
    v_perm_b32 v107, v60, v60, v15
    s_nop 1
    v_mfma_f32_16x16x32_bf16 v[112:115], v[104:107], a[100:103], v[112:115]
    v_perm_b32 v108, v80, v80, v9
    v_perm_b32 v109, v80, v80, v11
    v_perm_b32 v110, v80, v80, v13
    v_perm_b32 v111, v80, v80, v15
    s_nop 1
    v_mfma_f32_16x16x32_bf16 v[116:119], v[108:111], a[100:103], v[116:119]
    v_perm_b32 v96, v61, v61, v8
    v_perm_b32 v97, v61, v61, v10
    v_perm_b32 v98, v61, v61, v12
    v_perm_b32 v99, v61, v61, v14
    s_nop 1
    v_mfma_f32_16x16x32_bf16 v[112:115], v[96:99], a[104:107], v[112:115]
    v_perm_b32 v100, v81, v81, v8
    v_perm_b32 v101, v81, v81, v10
    v_perm_b32 v102, v81, v81, v12
    v_perm_b32 v103, v81, v81, v14
    s_nop 1
    v_mfma_f32_16x16x32_bf16 v[116:119], v[100:103], a[104:107], v[116:119]
    s_waitcnt vmcnt(8)
    v_perm_b32 v104, v61, v61, v9
    v_perm_b32 v105, v61, v61, v11
    v_perm_b32 v106, v61, v61, v13
    v_perm_b32 v107, v61, v61, v15
    s_nop 1
    v_mfma_f32_16x16x32_bf16 v[112:115], v[104:107], a[108:111], v[112:115]
    v_perm_b32 v108, v81, v81, v9
    v_perm_b32 v109, v81, v81, v11
    v_perm_b32 v110, v81, v81, v13
    v_perm_b32 v111, v81, v81, v15
    s_nop 1
    v_mfma_f32_16x16x32_bf16 v[116:119], v[108:111], a[108:111], v[116:119]
    v_perm_b32 v96, v62, v62, v8
    v_perm_b32 v97, v62, v62, v10
    v_perm_b32 v98, v62, v62, v12
    v_perm_b32 v99, v62, v62, v14
    s_nop 1
    v_mfma_f32_16x16x32_bf16 v[112:115], v[96:99], a[112:115], v[112:115]
    v_perm_b32 v100, v82, v82, v8
    v_perm_b32 v101, v82, v82, v10
    v_perm_b32 v102, v82, v82, v12
    v_perm_b32 v103, v82, v82, v14
    s_nop 1
    v_mfma_f32_16x16x32_bf16 v[116:119], v[100:103], a[112:115], v[116:119]
    v_perm_b32 v104, v62, v62, v9
    v_perm_b32 v105, v62, v62, v11
    v_perm_b32 v106, v62, v62, v13
    v_perm_b32 v107, v62, v62, v15
    s_nop 1
    v_mfma_f32_16x16x32_bf16 v[112:115], v[104:107], a[116:119], v[112:115]
    v_perm_b32 v108, v82, v82, v9
    v_perm_b32 v109, v82, v82, v11
    v_perm_b32 v110, v82, v82, v13
    v_perm_b32 v111, v82, v82, v15
    s_nop 1
    v_mfma_f32_16x16x32_bf16 v[116:119], v[108:111], a[116:119], v[116:119]
    v_perm_b32 v96, v63, v63, v8
    v_perm_b32 v97, v63, v63, v10
    v_perm_b32 v98, v63, v63, v12
    v_perm_b32 v99, v63, v63, v14
    s_nop 1
    v_mfma_f32_16x16x32_bf16 v[112:115], v[96:99], a[120:123], v[112:115]
    v_perm_b32 v100, v83, v83, v8
    v_perm_b32 v101, v83, v83, v10
    v_perm_b32 v102, v83, v83, v12
    v_perm_b32 v103, v83, v83, v14
    s_nop 1
    v_mfma_f32_16x16x32_bf16 v[116:119], v[100:103], a[120:123], v[116:119]
    v_perm_b32 v104, v63, v63, v9
    v_perm_b32 v105, v63, v63, v11
    v_perm_b32 v106, v63, v63, v13
    v_perm_b32 v107, v63, v63, v15
    s_nop 1
    v_mfma_f32_16x16x32_bf16 v[112:115], v[104:107], a[124:127], v[112:115]
    v_perm_b32 v108, v83, v83, v9
    v_perm_b32 v109, v83, v83, v11
    v_perm_b32 v110, v83, v83, v13
    v_perm_b32 v111, v83, v83, v15
    s_nop 1
    v_mfma_f32_16x16x32_bf16 v[116:119], v[108:111], a[124:127], v[116:119]
    v_perm_b32 v96, v64, v64, v8
    v_perm_b32 v97, v64, v64, v10
    v_perm_b32 v98, v64, v64, v12
    v_perm_b32 v99, v64, v64, v14
    s_nop 1
    v_mfma_f32_16x16x32_bf16 v[112:115], v[96:99], a[128:131], v[112:115]
    v_perm_b32 v100, v84, v84, v8
    v_perm_b32 v101, v84, v84, v10
    v_perm_b32 v102, v84, v84, v12
    v_perm_b32 v103, v84, v84, v14
    s_nop 1
    v_mfma_f32_16x16x32_bf16 v[116:119], v[100:103], a[128:131], v[116:119]
    v_perm_b32 v104, v64, v64, v9
    v_perm_b32 v105, v64, v64, v11
    v_perm_b32 v106, v64, v64, v13
    v_perm_b32 v107, v64, v64, v15
    s_nop 1
    v_mfma_f32_16x16x32_bf16 v[112:115], v[104:107], a[132:135], v[112:115]
    v_perm_b32 v108, v84, v84, v9
    v_perm_b32 v109, v84, v84, v11
    v_perm_b32 v110, v84, v84, v13
    v_perm_b32 v111, v84, v84, v15
    s_nop 1
    v_mfma_f32_16x16x32_bf16 v[116:119], v[108:111], a[132:135], v[116:119]
    v_perm_b32 v96, v65, v65, v8
    v_perm_b32 v97, v65, v65, v10
    v_perm_b32 v98, v65, v65, v12
    v_perm_b32 v99, v65, v65, v14
    s_nop 1
    v_mfma_f32_16x16x32_bf16 v[112:115], v[96:99], a[136:139], v[112:115]
    v_perm_b32 v100, v85, v85, v8
    v_perm_b32 v101, v85, v85, v10
    v_perm_b32 v102, v85, v85, v12
    v_perm_b32 v103, v85, v85, v14
    s_nop 1
    v_mfma_f32_16x16x32_bf16 v[116:119], v[100:103], a[136:139], v[116:119]
    v_perm_b32 v104, v65, v65, v9
    v_perm_b32 v105, v65, v65, v11
    v_perm_b32 v106, v65, v65, v13
    v_perm_b32 v107, v65, v65, v15
    s_nop 1
    v_mfma_f32_16x16x32_bf16 v[112:115], v[104:107], a[140:143], v[112:115]
    v_perm_b32 v108, v85, v85, v9
    v_perm_b32 v109, v85, v85, v11
    v_perm_b32 v110, v85, v85, v13
    v_perm_b32 v111, v85, v85, v15
    s_nop 1
    v_mfma_f32_16x16x32_bf16 v[116:119], v[108:111], a[140:143], v[116:119]
    v_lshrrev_b32 v5, 1, v4
    v_lshlrev_b32 v5, 9, v5
    v_lshl_add_u32 v5, v3, 5, v5
    v_and_b32 v6, 1, v4
    v_lshl_add_u32 v5, v6, 4, v5
    s_lshl_b32 s54, s3, 11
    s_add_u32 s54, s54, 139264
    v_add_u32 v5, s54, v5
    ds_write_b128 v5, v[112:115]
    ds_write_b128 v5, v[116:119] offset:1024
    s_waitcnt lgkmcnt(0)
    s_barrier
    s_lshl_b32 s54, s3, 9
    s_add_u32 s54, s54, 139264
    v_lshl_add_u32 v5, v3, 5, s54
    ds_read_b128 v[48:51], v5 offset:0
    ds_read_b128 v[52:55], v5 offset:16
    ds_read_b128 v[56:59], v5 offset:2048
    ds_read_b128 v[60:63], v5 offset:2064
    ds_read_b128 v[64:67], v5 offset:4096
    ds_read_b128 v[68:71], v5 offset:4112
    ds_read_b128 v[72:75], v5 offset:6144
    ds_read_b128 v[76:79], v5 offset:6160
    s_waitcnt lgkmcnt(0)
    v_add_f32 v48, v48, v56
    v_add_f32 v64, v64, v72
    v_add_f32 v49, v49, v57
    v_add_f32 v65, v65, v73
    v_add_f32 v50, v50, v58
    v_add_f32 v66, v66, v74
    v_add_f32 v51, v51, v59
    v_add_f32 v67, v67, v75
    v_add_f32 v52, v52, v60
    v_add_f32 v68, v68, v76
    v_add_f32 v53, v53, v61
    v_add_f32 v69, v69, v77
    v_add_f32 v54, v54, v62
    v_add_f32 v70, v70, v78
    v_add_f32 v55, v55, v63
    v_add_f32 v71, v71, v79
    v_add_f32 v48, v48, v64
    v_add_f32 v49, v49, v65
    v_add_f32 v50, v50, v66
    v_add_f32 v51, v51, v67
    v_add_f32 v52, v52, v68
    v_add_f32 v53, v53, v69
    v_add_f32 v54, v54, v70
    v_add_f32 v55, v55, v71
    v_cvt_pk_bf16_f32 v124, v48, v49
    v_cvt_pk_bf16_f32 v125, v50, v51
    v_cvt_pk_bf16_f32 v126, v52, v53
    v_cvt_pk_bf16_f32 v127, v54, v55
    v_min_u32 v124, -2, v124
    v_min_u32 v125, -2, v125
    v_min_u32 v126, -2, v126
    v_min_u32 v127, -2, v127
    buffer_store_dwordx4 v[124:127], v123, s[44:47], s98 offen sc1
    s_add_u32 m0, s59, 0
    s_add_u32 s54, s58, 0
    buffer_load_dwordx4 v20, s[32:35], s54 offen nt lds
    s_add_u32 m0, s59, 1024
    s_add_u32 s54, s58, 0
    buffer_load_dwordx4 v21, s[32:35], s54 offen nt lds
    s_add_u32 m0, s59, 2048
    s_add_u32 s54, s58, 0
    buffer_load_dwordx4 v22, s[32:35], s54 offen nt lds
    s_add_u32 m0, s59, 3072
    s_add_u32 s54, s58, 0
    buffer_load_dwordx4 v23, s[32:35], s54 offen nt lds
    s_add_u32 m0, s59, 4096
    s_add_u32 s54, s58, 16384
    buffer_load_dwordx4 v20, s[32:35], s54 offen nt lds
    s_add_u32 m0, s59, 5120
    s_add_u32 s54, s58, 16384
    buffer_load_dwordx4 v21, s[32:35], s54 offen nt lds
    s_add_u32 m0, s59, 6144
    s_add_u32 s54, s58, 16384
    buffer_load_dwordx4 v22, s[32:35], s54 offen nt lds
    s_add_u32 m0, s59, 7168
    s_add_u32 s54, s58, 16384
    buffer_load_dwordx4 v23, s[32:35], s54 offen nt lds
    s_add_u32 s58, s58, 32768
    s_add_u32 s59, s59, 8192
    s_add_u32 m0, s59, 0
    s_add_u32 s54, s58, 0
    buffer_load_dwordx4 v20, s[32:35], s54 offen nt lds
    s_add_u32 m0, s59, 1024
    s_add_u32 s54, s58, 0
    buffer_load_dwordx4 v21, s[32:35], s54 offen nt lds
    s_add_u32 m0, s59, 2048
    s_add_u32 s54, s58, 0
    buffer_load_dwordx4 v22, s[32:35], s54 offen nt lds
    s_add_u32 m0, s59, 3072
    s_add_u32 s54, s58, 0
    buffer_load_dwordx4 v23, s[32:35], s54 offen nt lds
    s_add_u32 m0, s59, 4096
    s_add_u32 s54, s58, 16384
    buffer_load_dwordx4 v20, s[32:35], s54 offen nt lds
    s_add_u32 m0, s59, 5120
    s_add_u32 s54, s58, 16384
    buffer_load_dwordx4 v21, s[32:35], s54 offen nt lds
    s_add_u32 m0, s59, 6144
    s_add_u32 s54, s58, 16384
    buffer_load_dwordx4 v22, s[32:35], s54 offen nt lds
    s_add_u32 m0, s59, 7168
    s_add_u32 s54, s58, 16384
    buffer_load_dwordx4 v23, s[32:35], s54 offen nt lds
    s_add_u32 s58, s58, 32768
    s_add_u32 s59, s59, 8192
    s_add_u32 m0, s59, 0
    s_add_u32 s54, s58, 0
    buffer_load_dwordx4 v20, s[32:35], s54 offen nt lds
    s_add_u32 m0, s59, 1024
    s_add_u32 s54, s58, 0
    buffer_load_dwordx4 v21, s[32:35], s54 offen nt lds
    s_add_u32 m0, s59, 2048
    s_add_u32 s54, s58, 0
    buffer_load_dwordx4 v22, s[32:35], s54 offen nt lds
    s_add_u32 m0, s59, 3072
    s_add_u32 s54, s58, 0
    buffer_load_dwordx4 v23, s[32:35], s54 offen nt lds
    s_add_u32 m0, s59, 4096
    s_add_u32 s54, s58, 16384
    buffer_load_dwordx4 v20, s[32:35], s54 offen nt lds
    s_add_u32 m0, s59, 5120
    s_add_u32 s54, s58, 16384
    buffer_load_dwordx4 v21, s[32:35], s54 offen nt lds
    s_add_u32 m0, s59, 6144
    s_add_u32 s54, s58, 16384
    buffer_load_dwordx4 v22, s[32:35], s54 offen nt lds
    s_add_u32 m0, s59, 7168
    s_add_u32 s54, s58, 16384
    buffer_load_dwordx4 v23, s[32:35], s54 offen nt lds
    s_add_u32 s58, s58, 32768
    s_add_u32 s59, s59, 8192
    s_waitcnt vmcnt(40)
    v_mov_b32 v27, 0
    global_load_dword v18, v27, s[28:29] sc1
    buffer_load_dwordx4 a[96:99], v20, s[32:35], s58 offen nt
    buffer_load_dwordx4 a[100:103], v21, s[32:35], s58 offen nt
    buffer_load_dwordx4 a[104:107], v22, s[32:35], s58 offen nt
    buffer_load_dwordx4 a[108:111], v23, s[32:35], s58 offen nt
    s_add_u32 s58, s58, 16384
    buffer_load_dwordx4 a[112:115], v20, s[32:35], s58 offen nt
    buffer_load_dwordx4 a[116:119], v21, s[32:35], s58 offen nt
    buffer_load_dwordx4 a[120:123], v22, s[32:35], s58 offen nt
    buffer_load_dwordx4 a[124:127], v23, s[32:35], s58 offen nt
    s_add_u32 s58, s58, 16384
    s_waitcnt vmcnt(40)
    buffer_load_dwordx4 a[128:131], v20, s[32:35], s58 offen nt
    buffer_load_dwordx4 a[132:135], v21, s[32:35], s58 offen nt
    buffer_load_dwordx4 a[136:139], v22, s[32:35], s58 offen nt
    buffer_load_dwordx4 a[140:143], v23, s[32:35], s58 offen nt
    s_add_u32 s58, s58, 16384
    buffer_load_dwordx4 a[144:147], v20, s[32:35], s58 offen nt
    buffer_load_dwordx4 a[148:151], v21, s[32:35], s58 offen nt
    buffer_load_dwordx4 a[152:155], v22, s[32:35], s58 offen nt
    buffer_load_dwordx4 a[156:159], v23, s[32:35], s58 offen nt
    s_add_u32 s58, s58, 16384
    s_mov_b32 s36, s12
    s_mov_b32 s37, s13
    s_mov_b32 s38, 4718592
    s_mov_b32 s39, 0x20000
    v_mul_u32_u24 v49, 9216, v4
    v_lshl_add_u32 v48, v3, 4, v49
    v_lshl_add_u32 v49, v3, 2, v49
    s_mul_i32 s100, s52, 147456
    s_lshl_b32 s54, s3, 8
    s_add_u32 s99, s100, s54
    s_and_b32 s54, s3, 1
    s_lshl_b32 s54, s54, 6
    s_add_u32 s100, s100, s54
    s_add_u32 s100, s100, 1024
    v_add_u32 v26, s63, v2
    v_and_b32 v24, 31, v1
    v_lshrrev_b32 v25, 5, v1
    v_lshlrev_b32 v19, 10, v24
    v_lshl_add_u32 v19, v25, 4, v19
    s_lshr_b32 s96, s53, 3
    s_lshl_b32 s96, s96, 15
    s_lshl_b32 s55, s3, 8
    s_add_u32 s96, s96, s55
    s_add_u32 s96, s96, 1048576
    v_and_b32 v5, 3, v24
    v_lshlrev_b32 v5, 2, v5
    v_bfe_u32 v6, v24, 2, 2
    v_or_b32 v5, v5, v6
    v_xor_b32 v5, v5, v25
    v_lshlrev_b32 v32, 8, v24
    v_lshl_add_u32 v32, v5, 4, v32
    v_add_u32 v32, s63, v32
    v_bfe_u32 v5, v1, 2, 2
    v_lshl_add_u32 v6, v25, 2, v5
    v_lshlrev_b32 v40, 8, v6
    v_and_b32 v6, 1, v1
    v_lshl_add_u32 v40, v6, 3, v40
    v_bfe_u32 v6, v1, 4, 1
    v_lshlrev_b32 v6, 1, v6
    v_bfe_u32 v7, v1, 1, 1
    v_or_b32 v6, v6, v7
    v_xor_b32 v6, v6, v25
    v_lshl_or_b32 v6, v5, 2, v6
    v_lshl_add_u32 v40, v6, 4, v40
    v_add_u32 v40, s63, v40
    v_xor_b32 v33, 32, v32
    v_xor_b32 v41, 32, v40
    v_xor_b32 v34, 64, v32
    v_xor_b32 v42, 64, v40
    v_xor_b32 v35, 96, v32
    v_xor_b32 v43, 96, v40
    v_xor_b32 v36, 128, v32
    v_xor_b32 v44, 128, v40
    v_xor_b32 v37, 160, v32
    v_xor_b32 v45, 160, v40
    v_xor_b32 v38, 192, v32
    v_xor_b32 v46, 192, v40
    v_xor_b32 v39, 224, v32
    v_xor_b32 v47, 224, v40
    s_lshl_b32 s54, s3, 12
    s_add_u32 s54, s54, 131072
    v_add_u32 v28, s54, v2
    v_xor_b32 v29, 4096, v28
    v_xor_b32 v30, 8192, v28
    v_xor_b32 v31, 12288, v28
    v_mov_b32 v64, 0
    v_mov_b32 v65, 0
    v_mov_b32 v66, 0
    v_mov_b32 v67, 0
    v_mov_b32 v68, 0
    v_mov_b32 v69, 0
    v_mov_b32 v70, 0
    v_mov_b32 v71, 0
    v_mov_b32 v72, 0
    v_mov_b32 v73, 0
    v_mov_b32 v74, 0
    v_mov_b32 v75, 0
    v_mov_b32 v76, 0
    v_mov_b32 v77, 0
    v_mov_b32 v78, 0
    v_mov_b32 v79, 0
    v_mov_b32 v80, 0
    v_mov_b32 v81, 0
    v_mov_b32 v82, 0
    v_mov_b32 v83, 0
    v_mov_b32 v84, 0
    v_mov_b32 v85, 0
    v_mov_b32 v86, 0
    v_mov_b32 v87, 0
    v_mov_b32 v88, 0
    v_mov_b32 v89, 0
    v_mov_b32 v90, 0
    v_mov_b32 v91, 0
    v_mov_b32 v92, 0
    v_mov_b32 v93, 0
    v_mov_b32 v94, 0
    v_mov_b32 v95, 0
    v_mov_b32 v96, 0
    v_mov_b32 v97, 0
    v_mov_b32 v98, 0
    v_mov_b32 v99, 0
    v_mov_b32 v100, 0
    v_mov_b32 v101, 0
    v_mov_b32 v102, 0
    v_mov_b32 v103, 0
    v_mov_b32 v104, 0
    v_mov_b32 v105, 0
    v_mov_b32 v106, 0
    v_mov_b32 v107, 0
    v_mov_b32 v108, 0
    v_mov_b32 v109, 0
    v_mov_b32 v110, 0
    v_mov_b32 v111, 0
    v_mov_b32 v112, 0
    v_mov_b32 v113, 0
    v_mov_b32 v114, 0
    v_mov_b32 v115, 0
    v_mov_b32 v116, 0
    v_mov_b32 v117, 0
    v_mov_b32 v118, 0
    v_mov_b32 v119, 0
    v_mov_b32 v120, 0
    v_mov_b32 v121, 0
    v_mov_b32 v122, 0
    v_mov_b32 v123, 0
    v_mov_b32 v124, 0
    v_mov_b32 v125, 0
    v_mov_b32 v126, 0
    v_mov_b32 v127, 0
    v_mov_b32 v216, 0xff800000
    v_mov_b32 v217, 0
    s_waitcnt vmcnt(16)
L_flags_27:
    v_cmp_gt_u32 vcc, 64, v18
    s_cbranch_vccz L_flagsok_28
    s_sleep 2
    global_load_dword v18, v27, s[28:29] sc1
    s_waitcnt vmcnt(0)
    s_sub_u32 s101, s101, 1
    s_cbranch_scc0 L_flags_27
    s_mov_b32 s101, 0
L_flagsok_28:
    s_barrier
    ds_read_b128 a[32:35], v32 offset:0
    ds_read_b128 a[36:39], v33 offset:0
    ds_read_b128 a[40:43], v34 offset:0
    ds_read_b128 a[44:47], v35 offset:0
    ds_read_b128 a[48:51], v36 offset:0
    ds_read_b128 a[52:55], v37 offset:0
    ds_read_b128 a[56:59], v38 offset:0
    ds_read_b128 a[60:63], v39 offset:0
    buffer_load_dwordx4 v[128:131], v19, s[44:47], s96 offen offset:0 sc1
    buffer_load_dwordx4 v[132:135], v19, s[44:47], s96 offen offset:32 sc1
    buffer_load_dwordx4 v[136:139], v19, s[44:47], s96 offen offset:64 sc1
    buffer_load_dwordx4 v[140:143], v19, s[44:47], s96 offen offset:96 sc1
    buffer_load_dwordx4 v[144:147], v19, s[44:47], s96 offen offset:128 sc1
    buffer_load_dwordx4 v[148:151], v19, s[44:47], s96 offen offset:160 sc1
    buffer_load_dwordx4 v[152:155], v19, s[44:47], s96 offen offset:192 sc1
    buffer_load_dwordx4 v[156:159], v19, s[44:47], s96 offen offset:224 sc1
    buffer_load_dwordx4 a[160:163], v20, s[32:35], s58 offen nt
    buffer_load_dwordx4 a[164:167], v21, s[32:35], s58 offen nt
    buffer_load_dwordx4 a[168:171], v22, s[32:35], s58 offen nt
    buffer_load_dwordx4 a[172:175], v23, s[32:35], s58 offen nt
    s_add_u32 s58, s58, 16384
    buffer_load_dwordx4 a[176:179], v20, s[32:35], s58 offen nt
    buffer_load_dwordx4 a[180:183], v21, s[32:35], s58 offen nt
    buffer_load_dwordx4 a[184:187], v22, s[32:35], s58 offen nt
    buffer_load_dwordx4 a[188:191], v23, s[32:35], s58 offen nt
    s_add_u32 s58, s58, 16384
    s_waitcnt vmcnt(8)
    s_branch L_qpoll_29_c
L_qpoll_29:
    s_sleep 4
    buffer_load_dwordx4 v[128:131], v19, s[44:47], s96 offen offset:0 sc1
    buffer_load_dwordx4 v[132:135], v19, s[44:47], s96 offen offset:32 sc1
    buffer_load_dwordx4 v[136:139], v19, s[44:47], s96 offen offset:64 sc1
    buffer_load_dwordx4 v[140:143], v19, s[44:47], s96 offen offset:96 sc1
    buffer_load_dwordx4 v[144:147], v19, s[44:47], s96 offen offset:128 sc1
    buffer_load_dwordx4 v[148:151], v19, s[44:47], s96 offen offset:160 sc1
    buffer_load_dwordx4 v[152:155], v19, s[44:47], s96 offen offset:192 sc1
    buffer_load_dwordx4 v[156:159], v19, s[44:47], s96 offen offset:224 sc1
    s_waitcnt vmcnt(0)
L_qpoll_29_c:
    v_max3_u32 v5, v128, v129, v130
    v_max3_u32 v6, v144, v145, v146
    v_max3_u32 v5, v5, v131, v132
    v_max3_u32 v6, v6, v147, v148
    v_max3_u32 v5, v5, v133, v134
    v_max3_u32 v6, v6, v149, v150
    v_max3_u32 v5, v5, v135, v136
    v_max3_u32 v6, v6, v151, v152
    v_max3_u32 v5, v5, v137, v138
    v_max3_u32 v6, v6, v153, v154
    v_max3_u32 v5, v5, v139, v140
    v_max3_u32 v6, v6, v155, v156
    v_max3_u32 v5, v5, v141, v142
    v_max3_u32 v6, v6, v157, v158
    v_max3_u32 v5, v5, v143, v159
    v_max_u32 v5, v5, v6
    v_cmp_eq_u32 vcc, -1, v5
    s_nop 0
    s_mov_b64 exec, vcc
    s_cbranch_execz L_qok_30
    s_sub_u32 s101, s101, 1
    s_cbranch_scc0 L_qpoll_29
    s_mov_b32 s101, 0
L_qok_30:
    s_mov_b64 exec, -1
    v_accvgpr_write_b32 a0, v128
    v_accvgpr_write_b32 a1, v129
    v_accvgpr_write_b32 a2, v130
    v_accvgpr_write_b32 a3, v131
    v_accvgpr_write_b32 a4, v132
    v_accvgpr_write_b32 a5, v133
    v_accvgpr_write_b32 a6, v134
    v_accvgpr_write_b32 a7, v135
    v_accvgpr_write_b32 a8, v136
    v_accvgpr_write_b32 a9, v137
    v_accvgpr_write_b32 a10, v138
    v_accvgpr_write_b32 a11, v139
    v_accvgpr_write_b32 a12, v140
    v_accvgpr_write_b32 a13, v141
    v_accvgpr_write_b32 a14, v142
    v_accvgpr_write_b32 a15, v143
    v_accvgpr_write_b32 a16, v144
    v_accvgpr_write_b32 a17, v145
    v_accvgpr_write_b32 a18, v146
    v_accvgpr_write_b32 a19, v147
    v_accvgpr_write_b32 a20, v148
    v_accvgpr_write_b32 a21, v149
    v_accvgpr_write_b32 a22, v150
    v_accvgpr_write_b32 a23, v151
    v_accvgpr_write_b32 a24, v152
    v_accvgpr_write_b32 a25, v153
    v_accvgpr_write_b32 a26, v154
    v_accvgpr_write_b32 a27, v155
    v_accvgpr_write_b32 a28, v156
    v_accvgpr_write_b32 a29, v157
    v_accvgpr_write_b32 a30, v158
    v_accvgpr_write_b32 a31, v159
    s_waitcnt lgkmcnt(0)
    v_mfma_f32_32x32x16_bf16 v[128:143], a[32:35], a[0:3], 0
    v_mfma_f32_32x32x16_bf16 v[128:143], a[36:39], a[4:7], v[128:143]
    v_mfma_f32_32x32x16_bf16 v[128:143], a[40:43], a[8:11], v[128:143]
    v_mfma_f32_32x32x16_bf16 v[128:143], a[44:47], a[12:15], v[128:143]
    v_mfma_f32_32x32x16_bf16 v[128:143], a[48:51], a[16:19], v[128:143]
    v_mfma_f32_32x32x16_bf16 v[128:143], a[52:55], a[20:23], v[128:143]
    v_mfma_f32_32x32x16_bf16 v[128:143], a[56:59], a[24:27], v[128:143]
    v_mfma_f32_32x32x16_bf16 v[128:143], a[60:63], a[28:31], v[128:143]
    s_nop 11
    ds_write_b128 v28, v[128:131] offset:0
    ds_write_b128 v28, v[132:135] offset:1024
    ds_write_b128 v28, v[136:139] offset:2048
    ds_write_b128 v28, v[140:143] offset:3072
    s_waitcnt lgkmcnt(0)
    s_barrier
    ds_read_b128 v[144:147], v29 offset:0
    ds_read_b128 v[148:151], v29 offset:1024
    ds_read_b128 v[152:155], v29 offset:2048
    ds_read_b128 v[156:159], v29 offset:3072
    ds_read_b128 v[160:163], v30 offset:0
    ds_read_b128 v[164:167], v30 offset:1024
    ds_read_b128 v[168:171], v30 offset:2048
    ds_read_b128 v[172:175], v30 offset:3072
    ds_read_b128 v[176:179], v31 offset:0
    ds_read_b128 v[180:183], v31 offset:1024
    ds_read_b128 v[184:187], v31 offset:2048
    ds_read_b128 v[188:191], v31 offset:3072
    ds_read_b128 a[32:35], v32 offset:8192
    ds_read_b128 a[36:39], v33 offset:8192
    ds_read_b128 a[40:43], v34 offset:8192
    ds_read_b128 a[44:47], v35 offset:8192
    ds_read_b128 a[48:51], v36 offset:8192
    ds_read_b128 a[52:55], v37 offset:8192
    ds_read_b128 a[56:59], v38 offset:8192
    ds_read_b128 a[60:63], v39 offset:8192
    s_waitcnt lgkmcnt(8)
    v_add_f32 v144, v144, v128
    v_add_f32 v145, v145, v129
    v_add_f32 v146, v146, v130
    v_add_f32 v147, v147, v131
    buffer_load_dwordx4 a[192:195], v20, s[32:35], s58 offen nt
    v_add_f32 v148, v148, v132
    v_add_f32 v149, v149, v133
    v_add_f32 v150, v150, v134
    v_add_f32 v151, v151, v135
    v_add_f32 v152, v152, v136
    v_add_f32 v153, v153, v137
    v_add_f32 v154, v154, v138
    v_add_f32 v155, v155, v139
    v_add_f32 v156, v156, v140
    v_add_f32 v157, v157, v141
    v_add_f32 v158, v158, v142
    v_add_f32 v159, v159, v143
    s_waitcnt lgkmcnt(0)
    v_mfma_f32_32x32x16_bf16 v[128:143], a[32:35], a[0:3], 0
    ds_read_b64_tr_b16 a[64:65], v40 offset:0
    ds_read_b64_tr_b16 a[66:67], v41 offset:2048
    v_add_f32 v160, v160, v176
    v_add_f32 v161, v161, v177
    v_add_f32 v162, v162, v178
    v_add_f32 v163, v163, v179
    v_add_f32 v164, v164, v180
    v_mfma_f32_32x32x16_bf16 v[128:143], a[36:39], a[4:7], v[128:143]
    ds_read_b64_tr_b16 a[72:73], v42 offset:0
    ds_read_b64_tr_b16 a[74:75], v43 offset:2048
    v_add_f32 v165, v165, v181
    v_add_f32 v166, v166, v182
    v_add_f32 v167, v167, v183
    v_add_f32 v168, v168, v184
    v_add_f32 v169, v169, v185
    v_mfma_f32_32x32x16_bf16 v[128:143], a[40:43], a[8:11], v[128:143]
    ds_read_b64_tr_b16 a[80:81], v44 offset:0
    ds_read_b64_tr_b16 a[82:83], v45 offset:2048
    v_add_f32 v170, v170, v186
    v_add_f32 v171, v171, v187
    v_add_f32 v172, v172, v188
    v_add_f32 v173, v173, v189
    v_add_f32 v174, v174, v190
    v_mfma_f32_32x32x16_bf16 v[128:143], a[44:47], a[12:15], v[128:143]
    ds_read_b64_tr_b16 a[88:89], v46 offset:0
    ds_read_b64_tr_b16 a[90:91], v47 offset:2048
    v_add_f32 v175, v175, v191
    v_add_f32 v144, v144, v160
    v_add_f32 v145, v145, v161
    v_add_f32 v146, v146, v162
    v_add_f32 v147, v147, v163
    v_mfma_f32_32x32x16_bf16 v[128:143], a[48:51], a[16:19], v[128:143]
    ds_read_b64_tr_b16 a[68:69], v40 offset:4096
    ds_read_b64_tr_b16 a[70:71], v41 offset:6144
    v_add_f32 v148, v148, v164
    v_add_f32 v149, v149, v165
    v_add_f32 v150, v150, v166
    v_add_f32 v151, v151, v167
    v_add_f32 v152, v152, v168
    v_mfma_f32_32x32x16_bf16 v[128:143], a[52:55], a[20:23], v[128:143]
    ds_read_b64_tr_b16 a[76:77], v42 offset:4096
    ds_read_b64_tr_b16 a[78:79], v43 offset:6144
    v_add_f32 v153, v153, v169
    v_add_f32 v154, v154, v170
    v_add_f32 v155, v155, v171
    v_add_f32 v156, v156, v172
    v_add_f32 v157, v157, v173
    v_mfma_f32_32x32x16_bf16 v[128:143], a[56:59], a[24:27], v[128:143]
    ds_read_b64_tr_b16 a[84:85], v44 offset:4096
    ds_read_b64_tr_b16 a[86:87], v45 offset:6144
    v_add_f32 v158, v158, v174
    v_add_f32 v159, v159, v175
    v_max3_f32 v218, v144, v145, v146
    v_max3_f32 v219, v147, v148, v149
    v_max3_f32 v220, v150, v151, v152
    v_mfma_f32_32x32x16_bf16 v[128:143], a[60:63], a[28:31], v[128:143]
    ds_read_b64_tr_b16 a[92:93], v46 offset:4096
    ds_read_b64_tr_b16 a[94:95], v47 offset:6144
    v_max3_f32 v221, v153, v154, v155
    v_max3_f32 v218, v218, v156, v157
    v_max3_f32 v219, v219, v158, v159
    v_max3_f32 v218, v218, v219, v220
    v_max_f32 v218, v218, v221
    v_mov_b32 v219, v218
    s_nop 1
    v_permlane32_swap_b32 v218, v219
    v_max3_f32 v218, v218, v219, v216
    v_sub_f32 v220, v216, v218
    v_mov_b32 v216, v218
    v_exp_f32 v220, v220
    v_sub_f32 v192, v144, v218
    v_sub_f32 v193, v145, v218
    buffer_load_dwordx4 a[196:199], v21, s[32:35], s58 offen nt
    v_sub_f32 v194, v146, v218
    v_sub_f32 v195, v147, v218
    v_sub_f32 v196, v148, v218
    v_sub_f32 v197, v149, v218
    v_sub_f32 v198, v150, v218
    buffer_load_dwordx4 a[200:203], v22, s[32:35], s58 offen nt
    v_sub_f32 v199, v151, v218
    v_sub_f32 v200, v152, v218
    v_sub_f32 v201, v153, v218
    v_sub_f32 v202, v154, v218
    v_sub_f32 v203, v155, v218
    v_sub_f32 v204, v156, v218
    v_sub_f32 v205, v157, v218
    v_sub_f32 v206, v158, v218
    v_sub_f32 v207, v159, v218
    ds_write_b128 v28, v[128:131] offset:16384
    v_exp_f32 v192, v192
    v_exp_f32 v193, v193
    v_exp_f32 v194, v194
    v_exp_f32 v195, v195
    ds_write_b128 v28, v[132:135] offset:17408
    v_exp_f32 v196, v196
    v_exp_f32 v197, v197
    v_exp_f32 v198, v198
    v_exp_f32 v199, v199
    ds_write_b128 v28, v[136:139] offset:18432
    v_exp_f32 v200, v200
    v_exp_f32 v201, v201
    v_exp_f32 v202, v202
    v_exp_f32 v203, v203
    ds_write_b128 v28, v[140:143] offset:19456
    v_exp_f32 v204, v204
    v_exp_f32 v205, v205
    v_exp_f32 v206, v206
    v_exp_f32 v207, v207
    v_mul_f32 v217, v217, v220
    v_cvt_pk_bf16_f32 v208, v192, v193
    v_cvt_pk_bf16_f32 v209, v194, v195
    v_cvt_pk_bf16_f32 v210, v196, v197
    v_cvt_pk_bf16_f32 v211, v198, v199
    v_cvt_pk_bf16_f32 v212, v200, v201
    v_cvt_pk_bf16_f32 v213, v202, v203
    v_cvt_pk_bf16_f32 v214, v204, v205
    v_cvt_pk_bf16_f32 v215, v206, v207
    v_mul_f32 v64, v64, v220
    v_mul_f32 v65, v65, v220
    v_mul_f32 v66, v66, v220
    v_mul_f32 v67, v67, v220
    v_mul_f32 v68, v68, v220
    v_mul_f32 v69, v69, v220
    v_mul_f32 v70, v70, v220
    v_mul_f32 v71, v71, v220
    v_mul_f32 v72, v72, v220
    v_mul_f32 v73, v73, v220
    v_mul_f32 v74, v74, v220
    v_mul_f32 v75, v75, v220
    v_mul_f32 v76, v76, v220
    v_mul_f32 v77, v77, v220
    v_mul_f32 v78, v78, v220
    v_mul_f32 v79, v79, v220
    s_waitcnt lgkmcnt(0)
    s_barrier
    v_mfma_f32_32x32x16_bf16 v[64:79], a[64:67], v[208:211], v[64:79]
    ds_read_b128 v[144:147], v29 offset:16384
    v_mul_f32 v80, v80, v220
    v_mul_f32 v81, v81, v220
    ds_read_b128 v[148:151], v29 offset:17408
    ds_write_b128 v26, a[96:99] offset:0
    buffer_load_dwordx4 a[204:207], v23, s[32:35], s58 offen nt
    s_add_u32 s58, s58, 16384
    v_mul_f32 v82, v82, v220
    v_mul_f32 v83, v83, v220
    ds_read_b128 v[152:155], v29 offset:18432
    v_mul_f32 v84, v84, v220
    v_mfma_f32_32x32x16_bf16 v[64:79], a[68:71], v[212:215], v[64:79]
    v_mul_f32 v85, v85, v220
    ds_read_b128 v[156:159], v29 offset:19456
    v_mul_f32 v86, v86, v220
    ds_write_b128 v26, a[100:103] offset:1024
    v_mul_f32 v87, v87, v220
    v_mul_f32 v88, v88, v220
    v_mul_f32 v89, v89, v220
    v_mul_f32 v90, v90, v220
    v_mul_f32 v91, v91, v220
    v_mul_f32 v92, v92, v220
    v_mul_f32 v93, v93, v220
    v_mul_f32 v94, v94, v220
    v_mul_f32 v95, v95, v220
    s_nop 1
    v_mfma_f32_32x32x16_bf16 v[80:95], a[72:75], v[208:211], v[80:95]
    ds_read_b128 v[160:163], v30 offset:16384
    v_mul_f32 v96, v96, v220
    v_mul_f32 v97, v97, v220
    ds_read_b128 v[164:167], v30 offset:17408
    ds_write_b128 v26, a[104:107] offset:2048
    buffer_load_dwordx4 a[208:211], v20, s[32:35], s58 offen nt
    v_mul_f32 v98, v98, v220
    v_mul_f32 v99, v99, v220
    ds_read_b128 v[168:171], v30 offset:18432
    v_mul_f32 v100, v100, v220
    v_mfma_f32_32x32x16_bf16 v[80:95], a[76:79], v[212:215], v[80:95]
    v_mul_f32 v101, v101, v220
    ds_read_b128 v[172:175], v30 offset:19456
    v_mul_f32 v102, v102, v220
    ds_write_b128 v26, a[108:111] offset:3072
    v_mul_f32 v103, v103, v220
    v_mul_f32 v104, v104, v220
    v_mul_f32 v105, v105, v220
    v_mul_f32 v106, v106, v220
    v_mul_f32 v107, v107, v220
    v_mul_f32 v108, v108, v220
    v_mul_f32 v109, v109, v220
    v_mul_f32 v110, v110, v220
    v_mul_f32 v111, v111, v220
    s_nop 1
    v_mfma_f32_32x32x16_bf16 v[96:111], a[80:83], v[208:211], v[96:111]
    ds_read_b128 v[176:179], v31 offset:16384
    v_mul_f32 v112, v112, v220
    v_mul_f32 v113, v113, v220
    ds_read_b128 v[180:183], v31 offset:17408
    ds_write_b128 v26, a[112:115] offset:4096
    v_mul_f32 v114, v114, v220
    v_mul_f32 v115, v115, v220
    ds_read_b128 v[184:187], v31 offset:18432
    v_mul_f32 v116, v116, v220
    v_mfma_f32_32x32x16_bf16 v[96:111], a[84:87], v[212:215], v[96:111]
    v_mul_f32 v117, v117, v220
    ds_read_b128 v[188:191], v31 offset:19456
    v_mul_f32 v118, v118, v220
    ds_write_b128 v26, a[116:119] offset:5120
    buffer_load_dwordx4 a[212:215], v21, s[32:35], s58 offen nt
    v_mul_f32 v119, v119, v220
    v_mul_f32 v120, v120, v220
    v_mul_f32 v121, v121, v220
    v_mul_f32 v122, v122, v220
    v_mul_f32 v123, v123, v220
    v_mul_f32 v124, v124, v220
    v_mul_f32 v125, v125, v220
    v_mul_f32 v126, v126, v220
    v_mul_f32 v127, v127, v220
    s_nop 1
    v_mfma_f32_32x32x16_bf16 v[112:127], a[88:91], v[208:211], v[112:127]
    v_add_f32 v192, v192, v200
    v_add_f32 v193, v193, v201
    v_add_f32 v194, v194, v202
    v_add_f32 v195, v195, v203
    ds_write_b128 v26, a[120:123] offset:6144
    v_add_f32 v196, v196, v204
    v_add_f32 v197, v197, v205
    v_add_f32 v198, v198, v206
    v_add_f32 v199, v199, v207
    v_mfma_f32_32x32x16_bf16 v[112:127], a[92:95], v[212:215], v[112:127]
    v_add_f32 v192, v192, v196
    v_add_f32 v193, v193, v197
    v_add_f32 v194, v194, v198
    ds_write_b128 v26, a[124:127] offset:7168
    v_add_f32 v195, v195, v199
    v_add_f32 v192, v192, v193
    v_add_f32 v194, v194, v195
    v_add_f32 v192, v192, v194
    v_add_f32 v217, v217, v192
    ds_read_b128 a[32:35], v32 offset:16384
    ds_read_b128 a[36:39], v33 offset:16384
    ds_read_b128 a[40:43], v34 offset:16384
    ds_read_b128 a[44:47], v35 offset:16384
    ds_read_b128 a[48:51], v36 offset:16384
    ds_read_b128 a[52:55], v37 offset:16384
    ds_read_b128 a[56:59], v38 offset:16384
    ds_read_b128 a[60:63], v39 offset:16384
    s_waitcnt lgkmcnt(8)
    v_add_f32 v144, v144, v128
    v_add_f32 v145, v145, v129
    v_add_f32 v146, v146, v130
    v_add_f32 v147, v147, v131
    buffer_load_dwordx4 a[216:219], v22, s[32:35], s58 offen nt
    v_add_f32 v148, v148, v132
    v_add_f32 v149, v149, v133
    v_add_f32 v150, v150, v134
    v_add_f32 v151, v151, v135
    v_add_f32 v152, v152, v136
    v_add_f32 v153, v153, v137
    v_add_f32 v154, v154, v138
    v_add_f32 v155, v155, v139
    v_add_f32 v156, v156, v140
    v_add_f32 v157, v157, v141
    v_add_f32 v158, v158, v142
    v_add_f32 v159, v159, v143
    s_waitcnt lgkmcnt(0)
    v_mfma_f32_32x32x16_bf16 v[128:143], a[32:35], a[0:3], 0
    ds_read_b64_tr_b16 a[64:65], v40 offset:8192
    ds_read_b64_tr_b16 a[66:67], v41 offset:10240
    v_add_f32 v160, v160, v176
    v_add_f32 v161, v161, v177
    v_add_f32 v162, v162, v178
    v_add_f32 v163, v163, v179
    v_add_f32 v164, v164, v180
    v_mfma_f32_32x32x16_bf16 v[128:143], a[36:39], a[4:7], v[128:143]
    ds_read_b64_tr_b16 a[72:73], v42 offset:8192
    ds_read_b64_tr_b16 a[74:75], v43 offset:10240
    v_add_f32 v165, v165, v181
    v_add_f32 v166, v166, v182
    v_add_f32 v167, v167, v183
    v_add_f32 v168, v168, v184
    v_add_f32 v169, v169, v185
    v_mfma_f32_32x32x16_bf16 v[128:143], a[40:43], a[8:11], v[128:143]
    ds_read_b64_tr_b16 a[80:81], v44 offset:8192
    ds_read_b64_tr_b16 a[82:83], v45 offset:10240
    v_add_f32 v170, v170, v186
    v_add_f32 v171, v171, v187
    v_add_f32 v172, v172, v188
    v_add_f32 v173, v173, v189
    v_add_f32 v174, v174, v190
    v_mfma_f32_32x32x16_bf16 v[128:143], a[44:47], a[12:15], v[128:143]
    ds_read_b64_tr_b16 a[88:89], v46 offset:8192
    ds_read_b64_tr_b16 a[90:91], v47 offset:10240
    v_add_f32 v175, v175, v191
    v_add_f32 v144, v144, v160
    v_add_f32 v145, v145, v161
    v_add_f32 v146, v146, v162
    v_add_f32 v147, v147, v163
    v_mfma_f32_32x32x16_bf16 v[128:143], a[48:51], a[16:19], v[128:143]
    ds_read_b64_tr_b16 a[68:69], v40 offset:12288
    ds_read_b64_tr_b16 a[70:71], v41 offset:14336
    v_add_f32 v148, v148, v164
    v_add_f32 v149, v149, v165
    v_add_f32 v150, v150, v166
    v_add_f32 v151, v151, v167
    v_add_f32 v152, v152, v168
    v_mfma_f32_32x32x16_bf16 v[128:143], a[52:55], a[20:23], v[128:143]
    ds_read_b64_tr_b16 a[76:77], v42 offset:12288
    ds_read_b64_tr_b16 a[78:79], v43 offset:14336
    v_add_f32 v153, v153, v169
    v_add_f32 v154, v154, v170
    v_add_f32 v155, v155, v171
    v_add_f32 v156, v156, v172
    v_add_f32 v157, v157, v173
    v_mfma_f32_32x32x16_bf16 v[128:143], a[56:59], a[24:27], v[128:143]
    ds_read_b64_tr_b16 a[84:85], v44 offset:12288
    ds_read_b64_tr_b16 a[86:87], v45 offset:14336
    v_add_f32 v158, v158, v174
    v_add_f32 v159, v159, v175
    v_max3_f32 v218, v144, v145, v146
    v_max3_f32 v219, v147, v148, v149
    v_max3_f32 v220, v150, v151, v152
    v_mfma_f32_32x32x16_bf16 v[128:143], a[60:63], a[28:31], v[128:143]
    ds_read_b64_tr_b16 a[92:93], v46 offset:12288
    ds_read_b64_tr_b16 a[94:95], v47 offset:14336
    v_max3_f32 v221, v153, v154, v155
    v_max3_f32 v218, v218, v156, v157
    v_max3_f32 v219, v219, v158, v159
    v_max3_f32 v218, v218, v219, v220
    v_max_f32 v218, v218, v221
    v_mov_b32 v219, v218
    s_nop 1
    v_permlane32_swap_b32 v218, v219
    v_max3_f32 v218, v218, v219, v216
    v_sub_f32 v220, v216, v218
    v_mov_b32 v216, v218
    v_exp_f32 v220, v220
    v_sub_f32 v192, v144, v218
    v_sub_f32 v193, v145, v218
    buffer_load_dwordx4 a[220:223], v23, s[32:35], s58 offen nt
    s_add_u32 s58, s58, 16384
    v_sub_f32 v194, v146, v218
    v_sub_f32 v195, v147, v218
    v_sub_f32 v196, v148, v218
    v_sub_f32 v197, v149, v218
    v_sub_f32 v198, v150, v218
    buffer_load_dwordx4 a[224:227], v20, s[32:35], s58 offen nt
    v_sub_f32 v199, v151, v218
    v_sub_f32 v200, v152, v218
    v_sub_f32 v201, v153, v218
    v_sub_f32 v202, v154, v218
    v_sub_f32 v203, v155, v218
    v_sub_f32 v204, v156, v218
    v_sub_f32 v205, v157, v218
    v_sub_f32 v206, v158, v218
    v_sub_f32 v207, v159, v218
    ds_write_b128 v28, v[128:131] offset:0
    v_exp_f32 v192, v192
    v_exp_f32 v193, v193
    v_exp_f32 v194, v194
    v_exp_f32 v195, v195
    ds_write_b128 v28, v[132:135] offset:1024
    v_exp_f32 v196, v196
    v_exp_f32 v197, v197
    v_exp_f32 v198, v198
    v_exp_f32 v199, v199
    ds_write_b128 v28, v[136:139] offset:2048
    v_exp_f32 v200, v200
    v_exp_f32 v201, v201
    v_exp_f32 v202, v202
    v_exp_f32 v203, v203
    ds_write_b128 v28, v[140:143] offset:3072
    v_exp_f32 v204, v204
    v_exp_f32 v205, v205
    v_exp_f32 v206, v206
    v_exp_f32 v207, v207
    v_mul_f32 v217, v217, v220
    v_cvt_pk_bf16_f32 v208, v192, v193
    v_cvt_pk_bf16_f32 v209, v194, v195
    v_cvt_pk_bf16_f32 v210, v196, v197
    v_cvt_pk_bf16_f32 v211, v198, v199
    v_cvt_pk_bf16_f32 v212, v200, v201
    v_cvt_pk_bf16_f32 v213, v202, v203
    v_cvt_pk_bf16_f32 v214, v204, v205
    v_cvt_pk_bf16_f32 v215, v206, v207
    v_mul_f32 v64, v64, v220
    v_mul_f32 v65, v65, v220
    v_mul_f32 v66, v66, v220
    v_mul_f32 v67, v67, v220
    v_mul_f32 v68, v68, v220
    v_mul_f32 v69, v69, v220
    v_mul_f32 v70, v70, v220
    v_mul_f32 v71, v71, v220
    v_mul_f32 v72, v72, v220
    v_mul_f32 v73, v73, v220
    v_mul_f32 v74, v74, v220
    v_mul_f32 v75, v75, v220
    v_mul_f32 v76, v76, v220
    v_mul_f32 v77, v77, v220
    v_mul_f32 v78, v78, v220
    v_mul_f32 v79, v79, v220
    s_waitcnt lgkmcnt(0)
    s_barrier
    v_mfma_f32_32x32x16_bf16 v[64:79], a[64:67], v[208:211], v[64:79]
    ds_read_b128 v[144:147], v29 offset:0
    v_mul_f32 v80, v80, v220
    v_mul_f32 v81, v81, v220
    ds_read_b128 v[148:151], v29 offset:1024
    ds_write_b128 v26, a[128:131] offset:8192
    buffer_load_dwordx4 a[228:231], v21, s[32:35], s58 offen nt
    v_mul_f32 v82, v82, v220
    v_mul_f32 v83, v83, v220
    ds_read_b128 v[152:155], v29 offset:2048
    v_mul_f32 v84, v84, v220
    v_mfma_f32_32x32x16_bf16 v[64:79], a[68:71], v[212:215], v[64:79]
    v_mul_f32 v85, v85, v220
    ds_read_b128 v[156:159], v29 offset:3072
    v_mul_f32 v86, v86, v220
    ds_write_b128 v26, a[132:135] offset:9216
    v_mul_f32 v87, v87, v220
    v_mul_f32 v88, v88, v220
    v_mul_f32 v89, v89, v220
    v_mul_f32 v90, v90, v220
    v_mul_f32 v91, v91, v220
    v_mul_f32 v92, v92, v220
    v_mul_f32 v93, v93, v220
    v_mul_f32 v94, v94, v220
    v_mul_f32 v95, v95, v220
    s_nop 1
    v_mfma_f32_32x32x16_bf16 v[80:95], a[72:75], v[208:211], v[80:95]
    ds_read_b128 v[160:163], v30 offset:0
    v_mul_f32 v96, v96, v220
    v_mul_f32 v97, v97, v220
    ds_read_b128 v[164:167], v30 offset:1024
    ds_write_b128 v26, a[136:139] offset:10240
    buffer_load_dwordx4 a[232:235], v22, s[32:35], s58 offen nt
    v_mul_f32 v98, v98, v220
    v_mul_f32 v99, v99, v220
    ds_read_b128 v[168:171], v30 offset:2048
    v_mul_f32 v100, v100, v220
    v_mfma_f32_32x32x16_bf16 v[80:95], a[76:79], v[212:215], v[80:95]
    v_mul_f32 v101, v101, v220
    ds_read_b128 v[172:175], v30 offset:3072
    v_mul_f32 v102, v102, v220
    ds_write_b128 v26, a[140:143] offset:11264
    v_mul_f32 v103, v103, v220
    v_mul_f32 v104, v104, v220
    v_mul_f32 v105, v105, v220
    v_mul_f32 v106, v106, v220
    v_mul_f32 v107, v107, v220
    v_mul_f32 v108, v108, v220
    v_mul_f32 v109, v109, v220
    v_mul_f32 v110, v110, v220
    v_mul_f32 v111, v111, v220
    s_nop 1
    v_mfma_f32_32x32x16_bf16 v[96:111], a[80:83], v[208:211], v[96:111]
    ds_read_b128 v[176:179], v31 offset:0
    v_mul_f32 v112, v112, v220
    v_mul_f32 v113, v113, v220
    ds_read_b128 v[180:183], v31 offset:1024
    ds_write_b128 v26, a[144:147] offset:12288
    v_mul_f32 v114, v114, v220
    v_mul_f32 v115, v115, v220
    ds_read_b128 v[184:187], v31 offset:2048
    v_mul_f32 v116, v116, v220
    v_mfma_f32_32x32x16_bf16 v[96:111], a[84:87], v[212:215], v[96:111]
    v_mul_f32 v117, v117, v220
    ds_read_b128 v[188:191], v31 offset:3072
    v_mul_f32 v118, v118, v220
    ds_write_b128 v26, a[148:151] offset:13312
    buffer_load_dwordx4 a[236:239], v23, s[32:35], s58 offen nt
    s_add_u32 s58, s58, 16384
    v_mul_f32 v119, v119, v220
    v_mul_f32 v120, v120, v220
    v_mul_f32 v121, v121, v220
    v_mul_f32 v122, v122, v220
    v_mul_f32 v123, v123, v220
    v_mul_f32 v124, v124, v220
    v_mul_f32 v125, v125, v220
    v_mul_f32 v126, v126, v220
    v_mul_f32 v127, v127, v220
    s_nop 1
    v_mfma_f32_32x32x16_bf16 v[112:127], a[88:91], v[208:211], v[112:127]
    v_add_f32 v192, v192, v200
    v_add_f32 v193, v193, v201
    v_add_f32 v194, v194, v202
    v_add_f32 v195, v195, v203
    ds_write_b128 v26, a[152:155] offset:14336
    v_add_f32 v196, v196, v204
    v_add_f32 v197, v197, v205
    v_add_f32 v198, v198, v206
    v_add_f32 v199, v199, v207
    v_mfma_f32_32x32x16_bf16 v[112:127], a[92:95], v[212:215], v[112:127]
    v_add_f32 v192, v192, v196
    v_add_f32 v193, v193, v197
    v_add_f32 v194, v194, v198
    ds_write_b128 v26, a[156:159] offset:15360
    v_add_f32 v195, v195, v199
    v_add_f32 v192, v192, v193
    v_add_f32 v194, v194, v195
    v_add_f32 v192, v192, v194
    v_add_f32 v217, v217, v192
    ds_read_b128 a[32:35], v32 offset:24576
    ds_read_b128 a[36:39], v33 offset:24576
    ds_read_b128 a[40:43], v34 offset:24576
    ds_read_b128 a[44:47], v35 offset:24576
    ds_read_b128 a[48:51], v36 offset:24576
    ds_read_b128 a[52:55], v37 offset:24576
    ds_read_b128 a[56:59], v38 offset:24576
    ds_read_b128 a[60:63], v39 offset:24576
    s_waitcnt lgkmcnt(8)
    v_add_f32 v144, v144, v128
    v_add_f32 v145, v145, v129
    v_add_f32 v146, v146, v130
    v_add_f32 v147, v147, v131
    buffer_load_dwordx4 a[240:243], v20, s[32:35], s58 offen nt
    v_add_f32 v148, v148, v132
    v_add_f32 v149, v149, v133
    v_add_f32 v150, v150, v134
    v_add_f32 v151, v151, v135
    v_add_f32 v152, v152, v136
    v_add_f32 v153, v153, v137
    v_add_f32 v154, v154, v138
    v_add_f32 v155, v155, v139
    v_add_f32 v156, v156, v140
    v_add_f32 v157, v157, v141
    v_add_f32 v158, v158, v142
    v_add_f32 v159, v159, v143
    s_waitcnt lgkmcnt(0)
    v_mfma_f32_32x32x16_bf16 v[128:143], a[32:35], a[0:3], 0
    ds_read_b64_tr_b16 a[64:65], v40 offset:16384
    ds_read_b64_tr_b16 a[66:67], v41 offset:18432
    v_add_f32 v160, v160, v176
    v_add_f32 v161, v161, v177
    v_add_f32 v162, v162, v178
    v_add_f32 v163, v163, v179
    v_add_f32 v164, v164, v180
    v_mfma_f32_32x32x16_bf16 v[128:143], a[36:39], a[4:7], v[128:143]
    ds_read_b64_tr_b16 a[72:73], v42 offset:16384
    ds_read_b64_tr_b16 a[74:75], v43 offset:18432
    v_add_f32 v165, v165, v181
    v_add_f32 v166, v166, v182
    v_add_f32 v167, v167, v183
    v_add_f32 v168, v168, v184
    v_add_f32 v169, v169, v185
    v_mfma_f32_32x32x16_bf16 v[128:143], a[40:43], a[8:11], v[128:143]
    ds_read_b64_tr_b16 a[80:81], v44 offset:16384
    ds_read_b64_tr_b16 a[82:83], v45 offset:18432
    v_add_f32 v170, v170, v186
    v_add_f32 v171, v171, v187
    v_add_f32 v172, v172, v188
    v_add_f32 v173, v173, v189
    v_add_f32 v174, v174, v190
    v_mfma_f32_32x32x16_bf16 v[128:143], a[44:47], a[12:15], v[128:143]
    ds_read_b64_tr_b16 a[88:89], v46 offset:16384
    ds_read_b64_tr_b16 a[90:91], v47 offset:18432
    v_add_f32 v175, v175, v191
    v_add_f32 v144, v144, v160
    v_add_f32 v145, v145, v161
    v_add_f32 v146, v146, v162
    v_add_f32 v147, v147, v163
    v_mfma_f32_32x32x16_bf16 v[128:143], a[48:51], a[16:19], v[128:143]
    ds_read_b64_tr_b16 a[68:69], v40 offset:20480
    ds_read_b64_tr_b16 a[70:71], v41 offset:22528
    v_add_f32 v148, v148, v164
    v_add_f32 v149, v149, v165
    v_add_f32 v150, v150, v166
    v_add_f32 v151, v151, v167
    v_add_f32 v152, v152, v168
    v_mfma_f32_32x32x16_bf16 v[128:143], a[52:55], a[20:23], v[128:143]
    ds_read_b64_tr_b16 a[76:77], v42 offset:20480
    ds_read_b64_tr_b16 a[78:79], v43 offset:22528
    v_add_f32 v153, v153, v169
    v_add_f32 v154, v154, v170
    v_add_f32 v155, v155, v171
    v_add_f32 v156, v156, v172
    v_add_f32 v157, v157, v173
    v_mfma_f32_32x32x16_bf16 v[128:143], a[56:59], a[24:27], v[128:143]
    ds_read_b64_tr_b16 a[84:85], v44 offset:20480
    ds_read_b64_tr_b16 a[86:87], v45 offset:22528
    v_add_f32 v158, v158, v174
    v_add_f32 v159, v159, v175
    v_max3_f32 v218, v144, v145, v146
    v_max3_f32 v219, v147, v148, v149
    v_max3_f32 v220, v150, v151, v152
    v_mfma_f32_32x32x16_bf16 v[128:143], a[60:63], a[28:31], v[128:143]
    ds_read_b64_tr_b16 a[92:93], v46 offset:20480
    ds_read_b64_tr_b16 a[94:95], v47 offset:22528
    v_max3_f32 v221, v153, v154, v155
    v_max3_f32 v218, v218, v156, v157
    v_max3_f32 v219, v219, v158, v159
    v_max3_f32 v218, v218, v219, v220
    v_max_f32 v218, v218, v221
    v_mov_b32 v219, v218
    s_nop 1
    v_permlane32_swap_b32 v218, v219
    v_max3_f32 v218, v218, v219, v216
    v_sub_f32 v220, v216, v218
    v_mov_b32 v216, v218
    v_exp_f32 v220, v220
    v_sub_f32 v192, v144, v218
    v_sub_f32 v193, v145, v218
    buffer_load_dwordx4 a[244:247], v21, s[32:35], s58 offen nt
    v_sub_f32 v194, v146, v218
    v_sub_f32 v195, v147, v218
    v_sub_f32 v196, v148, v218
    v_sub_f32 v197, v149, v218
    v_sub_f32 v198, v150, v218
    buffer_load_dwordx4 a[248:251], v22, s[32:35], s58 offen nt
    v_sub_f32 v199, v151, v218
    v_sub_f32 v200, v152, v218
    v_sub_f32 v201, v153, v218
    v_sub_f32 v202, v154, v218
    v_sub_f32 v203, v155, v218
    v_sub_f32 v204, v156, v218
    v_sub_f32 v205, v157, v218
    v_sub_f32 v206, v158, v218
    v_sub_f32 v207, v159, v218
    ds_write_b128 v28, v[128:131] offset:16384
    v_exp_f32 v192, v192
    v_exp_f32 v193, v193
    v_exp_f32 v194, v194
    v_exp_f32 v195, v195
    ds_write_b128 v28, v[132:135] offset:17408
    v_exp_f32 v196, v196
    v_exp_f32 v197, v197
    v_exp_f32 v198, v198
    v_exp_f32 v199, v199
    ds_write_b128 v28, v[136:139] offset:18432
    v_exp_f32 v200, v200
    v_exp_f32 v201, v201
    v_exp_f32 v202, v202
    v_exp_f32 v203, v203
    ds_write_b128 v28, v[140:143] offset:19456
    v_exp_f32 v204, v204
    v_exp_f32 v205, v205
    v_exp_f32 v206, v206
    v_exp_f32 v207, v207
    v_mul_f32 v217, v217, v220
    v_cvt_pk_bf16_f32 v208, v192, v193
    v_cvt_pk_bf16_f32 v209, v194, v195
    v_cvt_pk_bf16_f32 v210, v196, v197
    v_cvt_pk_bf16_f32 v211, v198, v199
    v_cvt_pk_bf16_f32 v212, v200, v201
    v_cvt_pk_bf16_f32 v213, v202, v203
    v_cvt_pk_bf16_f32 v214, v204, v205
    v_cvt_pk_bf16_f32 v215, v206, v207
    v_mul_f32 v64, v64, v220
    v_mul_f32 v65, v65, v220
    v_mul_f32 v66, v66, v220
    v_mul_f32 v67, v67, v220
    v_mul_f32 v68, v68, v220
    v_mul_f32 v69, v69, v220
    v_mul_f32 v70, v70, v220
    v_mul_f32 v71, v71, v220
    v_mul_f32 v72, v72, v220
    v_mul_f32 v73, v73, v220
    v_mul_f32 v74, v74, v220
    v_mul_f32 v75, v75, v220
    v_mul_f32 v76, v76, v220
    v_mul_f32 v77, v77, v220
    v_mul_f32 v78, v78, v220
    v_mul_f32 v79, v79, v220
    s_waitcnt lgkmcnt(0)
    s_barrier
    v_mfma_f32_32x32x16_bf16 v[64:79], a[64:67], v[208:211], v[64:79]
    ds_read_b128 v[144:147], v29 offset:16384
    v_mul_f32 v80, v80, v220
    v_mul_f32 v81, v81, v220
    ds_read_b128 v[148:151], v29 offset:17408
    s_waitcnt vmcnt(22)
    ds_write_b128 v26, a[160:163] offset:16384
    buffer_load_dwordx4 a[252:255], v23, s[32:35], s58 offen nt
    s_add_u32 s58, s58, 16384
    v_mul_f32 v82, v82, v220
    v_mul_f32 v83, v83, v220
    ds_read_b128 v[152:155], v29 offset:18432
    v_mul_f32 v84, v84, v220
    v_mfma_f32_32x32x16_bf16 v[64:79], a[68:71], v[212:215], v[64:79]
    v_mul_f32 v85, v85, v220
    ds_read_b128 v[156:159], v29 offset:19456
    v_mul_f32 v86, v86, v220
    s_waitcnt vmcnt(22)
    ds_write_b128 v26, a[164:167] offset:17408
    v_mul_f32 v87, v87, v220
    v_mul_f32 v88, v88, v220
    v_mul_f32 v89, v89, v220
    v_mul_f32 v90, v90, v220
    v_mul_f32 v91, v91, v220
    v_mul_f32 v92, v92, v220
    v_mul_f32 v93, v93, v220
    v_mul_f32 v94, v94, v220
    v_mul_f32 v95, v95, v220
    s_nop 1
    v_mfma_f32_32x32x16_bf16 v[80:95], a[72:75], v[208:211], v[80:95]
    ds_read_b128 v[160:163], v30 offset:16384
    v_mul_f32 v96, v96, v220
    v_mul_f32 v97, v97, v220
    ds_read_b128 v[164:167], v30 offset:17408
    s_waitcnt vmcnt(21)
    ds_write_b128 v26, a[168:171] offset:18432
    buffer_load_dwordx4 v[224:227], v20, s[32:35], s58 offen nt
    v_mul_f32 v98, v98, v220
    v_mul_f32 v99, v99, v220
    ds_read_b128 v[168:171], v30 offset:18432
    v_mul_f32 v100, v100, v220
    v_mfma_f32_32x32x16_bf16 v[80:95], a[76:79], v[212:215], v[80:95]
    v_mul_f32 v101, v101, v220
    ds_read_b128 v[172:175], v30 offset:19456
    v_mul_f32 v102, v102, v220
    s_waitcnt vmcnt(21)
    ds_write_b128 v26, a[172:175] offset:19456
    v_mul_f32 v103, v103, v220
    v_mul_f32 v104, v104, v220
    v_mul_f32 v105, v105, v220
    v_mul_f32 v106, v106, v220
    v_mul_f32 v107, v107, v220
    v_mul_f32 v108, v108, v220
    v_mul_f32 v109, v109, v220
    v_mul_f32 v110, v110, v220
    v_mul_f32 v111, v111, v220
    s_nop 1
    v_mfma_f32_32x32x16_bf16 v[96:111], a[80:83], v[208:211], v[96:111]
    ds_read_b128 v[176:179], v31 offset:16384
    v_mul_f32 v112, v112, v220
    v_mul_f32 v113, v113, v220
    ds_read_b128 v[180:183], v31 offset:17408
    s_waitcnt vmcnt(20)
    ds_write_b128 v26, a[176:179] offset:20480
    v_mul_f32 v114, v114, v220
    v_mul_f32 v115, v115, v220
    ds_read_b128 v[184:187], v31 offset:18432
    v_mul_f32 v116, v116, v220
    v_mfma_f32_32x32x16_bf16 v[96:111], a[84:87], v[212:215], v[96:111]
    v_mul_f32 v117, v117, v220
    ds_read_b128 v[188:191], v31 offset:19456
    v_mul_f32 v118, v118, v220
    s_waitcnt vmcnt(19)
    ds_write_b128 v26, a[180:183] offset:21504
    buffer_load_dwordx4 v[228:231], v21, s[32:35], s58 offen nt
    v_mul_f32 v119, v119, v220
    v_mul_f32 v120, v120, v220
    v_mul_f32 v121, v121, v220
    v_mul_f32 v122, v122, v220
    v_mul_f32 v123, v123, v220
    v_mul_f32 v124, v124, v220
    v_mul_f32 v125, v125, v220
    v_mul_f32 v126, v126, v220
    v_mul_f32 v127, v127, v220
    s_nop 1
    v_mfma_f32_32x32x16_bf16 v[112:127], a[88:91], v[208:211], v[112:127]
    v_add_f32 v192, v192, v200
    v_add_f32 v193, v193, v201
    v_add_f32 v194, v194, v202
    v_add_f32 v195, v195, v203
    s_waitcnt vmcnt(19)
    ds_write_b128 v26, a[184:187] offset:22528
    v_add_f32 v196, v196, v204
    v_add_f32 v197, v197, v205
    v_add_f32 v198, v198, v206
    v_add_f32 v199, v199, v207
    v_mfma_f32_32x32x16_bf16 v[112:127], a[92:95], v[212:215], v[112:127]
    v_add_f32 v192, v192, v196
    v_add_f32 v193, v193, v197
    v_add_f32 v194, v194, v198
    s_waitcnt vmcnt(18)
    ds_write_b128 v26, a[188:191] offset:23552
    v_add_f32 v195, v195, v199
    v_add_f32 v192, v192, v193
    v_add_f32 v194, v194, v195
    v_add_f32 v192, v192, v194
    v_add_f32 v217, v217, v192
    ds_read_b128 a[32:35], v32 offset:0
    ds_read_b128 a[36:39], v33 offset:0
    ds_read_b128 a[40:43], v34 offset:0
    ds_read_b128 a[44:47], v35 offset:0
    ds_read_b128 a[48:51], v36 offset:0
    ds_read_b128 a[52:55], v37 offset:0
    ds_read_b128 a[56:59], v38 offset:0
    ds_read_b128 a[60:63], v39 offset:0
    s_waitcnt lgkmcnt(8)
    v_add_f32 v144, v144, v128
    v_add_f32 v145, v145, v129
    v_add_f32 v146, v146, v130
    v_add_f32 v147, v147, v131
    buffer_load_dwordx4 v[232:235], v22, s[32:35], s58 offen nt
    v_add_f32 v148, v148, v132
    v_add_f32 v149, v149, v133
    v_add_f32 v150, v150, v134
    v_add_f32 v151, v151, v135
    v_add_f32 v152, v152, v136
    v_add_f32 v153, v153, v137
    v_add_f32 v154, v154, v138
    v_add_f32 v155, v155, v139
    v_add_f32 v156, v156, v140
    v_add_f32 v157, v157, v141
    v_add_f32 v158, v158, v142
    v_add_f32 v159, v159, v143
    s_waitcnt lgkmcnt(0)
    v_mfma_f32_32x32x16_bf16 v[128:143], a[32:35], a[0:3], 0
    ds_read_b64_tr_b16 a[64:65], v40 offset:24576
    ds_read_b64_tr_b16 a[66:67], v41 offset:26624
    v_add_f32 v160, v160, v176
    v_add_f32 v161, v161, v177
    v_add_f32 v162, v162, v178
    v_add_f32 v163, v163, v179
    v_add_f32 v164, v164, v180
    v_mfma_f32_32x32x16_bf16 v[128:143], a[36:39], a[4:7], v[128:143]
    ds_read_b64_tr_b16 a[72:73], v42 offset:24576
    ds_read_b64_tr_b16 a[74:75], v43 offset:26624
    v_add_f32 v165, v165, v181
    v_add_f32 v166, v166, v182
    v_add_f32 v167, v167, v183
    v_add_f32 v168, v168, v184
    v_add_f32 v169, v169, v185
    v_mfma_f32_32x32x16_bf16 v[128:143], a[40:43], a[8:11], v[128:143]
    ds_read_b64_tr_b16 a[80:81], v44 offset:24576
    ds_read_b64_tr_b16 a[82:83], v45 offset:26624
    v_add_f32 v170, v170, v186
    v_add_f32 v171, v171, v187
    v_add_f32 v172, v172, v188
    v_add_f32 v173, v173, v189
    v_add_f32 v174, v174, v190
    v_mfma_f32_32x32x16_bf16 v[128:143], a[44:47], a[12:15], v[128:143]
    ds_read_b64_tr_b16 a[88:89], v46 offset:24576
    ds_read_b64_tr_b16 a[90:91], v47 offset:26624
    v_add_f32 v175, v175, v191
    v_add_f32 v144, v144, v160
    v_add_f32 v145, v145, v161
    v_add_f32 v146, v146, v162
    v_add_f32 v147, v147, v163
    v_mfma_f32_32x32x16_bf16 v[128:143], a[48:51], a[16:19], v[128:143]
    ds_read_b64_tr_b16 a[68:69], v40 offset:28672
    ds_read_b64_tr_b16 a[70:71], v41 offset:30720
    v_add_f32 v148, v148, v164
    v_add_f32 v149, v149, v165
    v_add_f32 v150, v150, v166
    v_add_f32 v151, v151, v167
    v_add_f32 v152, v152, v168
    v_mfma_f32_32x32x16_bf16 v[128:143], a[52:55], a[20:23], v[128:143]
    ds_read_b64_tr_b16 a[76:77], v42 offset:28672
    ds_read_b64_tr_b16 a[78:79], v43 offset:30720
    v_add_f32 v153, v153, v169
    v_add_f32 v154, v154, v170
    v_add_f32 v155, v155, v171
    v_add_f32 v156, v156, v172
    v_add_f32 v157, v157, v173
    v_mfma_f32_32x32x16_bf16 v[128:143], a[56:59], a[24:27], v[128:143]
    ds_read_b64_tr_b16 a[84:85], v44 offset:28672
    ds_read_b64_tr_b16 a[86:87], v45 offset:30720
    v_add_f32 v158, v158, v174
    v_add_f32 v159, v159, v175
    v_max3_f32 v218, v144, v145, v146
    v_max3_f32 v219, v147, v148, v149
    v_max3_f32 v220, v150, v151, v152
    v_mfma_f32_32x32x16_bf16 v[128:143], a[60:63], a[28:31], v[128:143]
    ds_read_b64_tr_b16 a[92:93], v46 offset:28672
    ds_read_b64_tr_b16 a[94:95], v47 offset:30720
    v_max3_f32 v221, v153, v154, v155
    v_max3_f32 v218, v218, v156, v157
    v_max3_f32 v219, v219, v158, v159
    v_max3_f32 v218, v218, v219, v220
    v_max_f32 v218, v218, v221
    v_mov_b32 v219, v218
    s_nop 1
    v_permlane32_swap_b32 v218, v219
    v_max3_f32 v218, v218, v219, v216
    v_sub_f32 v220, v216, v218
    v_mov_b32 v216, v218
    v_exp_f32 v220, v220
    v_sub_f32 v192, v144, v218
    v_sub_f32 v193, v145, v218
    buffer_load_dwordx4 v[236:239], v23, s[32:35], s58 offen nt
    s_add_u32 s58, s58, 16384
    v_sub_f32 v194, v146, v218
    v_sub_f32 v195, v147, v218
    v_sub_f32 v196, v148, v218
    v_sub_f32 v197, v149, v218
    v_sub_f32 v198, v150, v218
    buffer_load_dwordx4 v[240:243], v20, s[32:35], s58 offen nt
    v_sub_f32 v199, v151, v218
    v_sub_f32 v200, v152, v218
    v_sub_f32 v201, v153, v218
    v_sub_f32 v202, v154, v218
    v_sub_f32 v203, v155, v218
    v_sub_f32 v204, v156, v218
    v_sub_f32 v205, v157, v218
    v_sub_f32 v206, v158, v218
    v_sub_f32 v207, v159, v218
    ds_write_b128 v28, v[128:131] offset:0
    v_exp_f32 v192, v192
    v_exp_f32 v193, v193
    v_exp_f32 v194, v194
    v_exp_f32 v195, v195
    ds_write_b128 v28, v[132:135] offset:1024
    v_exp_f32 v196, v196
    v_exp_f32 v197, v197
    v_exp_f32 v198, v198
    v_exp_f32 v199, v199
    ds_write_b128 v28, v[136:139] offset:2048
    v_exp_f32 v200, v200
    v_exp_f32 v201, v201
    v_exp_f32 v202, v202
    v_exp_f32 v203, v203
    ds_write_b128 v28, v[140:143] offset:3072
    v_exp_f32 v204, v204
    v_exp_f32 v205, v205
    v_exp_f32 v206, v206
    v_exp_f32 v207, v207
    v_mul_f32 v217, v217, v220
    v_cvt_pk_bf16_f32 v208, v192, v193
    v_cvt_pk_bf16_f32 v209, v194, v195
    v_cvt_pk_bf16_f32 v210, v196, v197
    v_cvt_pk_bf16_f32 v211, v198, v199
    v_cvt_pk_bf16_f32 v212, v200, v201
    v_cvt_pk_bf16_f32 v213, v202, v203
    v_cvt_pk_bf16_f32 v214, v204, v205
    v_cvt_pk_bf16_f32 v215, v206, v207
    v_mul_f32 v64, v64, v220
    v_mul_f32 v65, v65, v220
    v_mul_f32 v66, v66, v220
    v_mul_f32 v67, v67, v220
    v_mul_f32 v68, v68, v220
    v_mul_f32 v69, v69, v220
    v_mul_f32 v70, v70, v220
    v_mul_f32 v71, v71, v220
    v_mul_f32 v72, v72, v220
    v_mul_f32 v73, v73, v220
    v_mul_f32 v74, v74, v220
    v_mul_f32 v75, v75, v220
    v_mul_f32 v76, v76, v220
    v_mul_f32 v77, v77, v220
    v_mul_f32 v78, v78, v220
    v_mul_f32 v79, v79, v220
    s_waitcnt lgkmcnt(0)
    s_barrier
    v_mfma_f32_32x32x16_bf16 v[64:79], a[64:67], v[208:211], v[64:79]
    ds_read_b128 v[144:147], v29 offset:0
    v_mul_f32 v80, v80, v220
    v_mul_f32 v81, v81, v220
    ds_read_b128 v[148:151], v29 offset:1024
    buffer_load_dwordx4 v[244:247], v21, s[32:35], s58 offen nt
    v_mul_f32 v82, v82, v220
    v_mul_f32 v83, v83, v220
    ds_read_b128 v[152:155], v29 offset:2048
    v_mul_f32 v84, v84, v220
    v_mfma_f32_32x32x16_bf16 v[64:79], a[68:71], v[212:215], v[64:79]
    v_mul_f32 v85, v85, v220
    ds_read_b128 v[156:159], v29 offset:3072
    v_mul_f32 v86, v86, v220
    v_mul_f32 v87, v87, v220
    v_mul_f32 v88, v88, v220
    v_mul_f32 v89, v89, v220
    v_mul_f32 v90, v90, v220
    v_mul_f32 v91, v91, v220
    v_mul_f32 v92, v92, v220
    v_mul_f32 v93, v93, v220
    v_mul_f32 v94, v94, v220
    v_mul_f32 v95, v95, v220
    s_nop 1
    v_mfma_f32_32x32x16_bf16 v[80:95], a[72:75], v[208:211], v[80:95]
    ds_read_b128 v[160:163], v30 offset:0
    v_mul_f32 v96, v96, v220
    v_mul_f32 v97, v97, v220
    ds_read_b128 v[164:167], v30 offset:1024
    buffer_load_dwordx4 v[248:251], v22, s[32:35], s58 offen nt
    v_mul_f32 v98, v98, v220
    v_mul_f32 v99, v99, v220
    ds_read_b128 v[168:171], v30 offset:2048
    v_mul_f32 v100, v100, v220
    v_mfma_f32_32x32x16_bf16 v[80:95], a[76:79], v[212:215], v[80:95]
    v_mul_f32 v101, v101, v220
    ds_read_b128 v[172:175], v30 offset:3072
    v_mul_f32 v102, v102, v220
    v_mul_f32 v103, v103, v220
    v_mul_f32 v104, v104, v220
    v_mul_f32 v105, v105, v220
    v_mul_f32 v106, v106, v220
    v_mul_f32 v107, v107, v220
    v_mul_f32 v108, v108, v220
    v_mul_f32 v109, v109, v220
    v_mul_f32 v110, v110, v220
    v_mul_f32 v111, v111, v220
    s_nop 1
    v_mfma_f32_32x32x16_bf16 v[96:111], a[80:83], v[208:211], v[96:111]
    ds_read_b128 v[176:179], v31 offset:0
    v_mul_f32 v112, v112, v220
    v_mul_f32 v113, v113, v220
    ds_read_b128 v[180:183], v31 offset:1024
    v_mul_f32 v114, v114, v220
    v_mul_f32 v115, v115, v220
    ds_read_b128 v[184:187], v31 offset:2048
    v_mul_f32 v116, v116, v220
    v_mfma_f32_32x32x16_bf16 v[96:111], a[84:87], v[212:215], v[96:111]
    v_mul_f32 v117, v117, v220
    ds_read_b128 v[188:191], v31 offset:3072
    v_mul_f32 v118, v118, v220
    buffer_load_dwordx4 v[252:255], v23, s[32:35], s58 offen nt
    s_add_u32 s58, s58, 16384
    v_mul_f32 v119, v119, v220
    v_mul_f32 v120, v120, v220
    v_mul_f32 v121, v121, v220
    v_mul_f32 v122, v122, v220
    v_mul_f32 v123, v123, v220
    v_mul_f32 v124, v124, v220
    v_mul_f32 v125, v125, v220
    v_mul_f32 v126, v126, v220
    v_mul_f32 v127, v127, v220
    s_nop 1
    v_mfma_f32_32x32x16_bf16 v[112:127], a[88:91], v[208:211], v[112:127]
    v_add_f32 v192, v192, v200
    v_add_f32 v193, v193, v201
    v_add_f32 v194, v194, v202
    v_add_f32 v195, v195, v203
    v_add_f32 v196, v196, v204
    v_add_f32 v197, v197, v205
    v_add_f32 v198, v198, v206
    v_add_f32 v199, v199, v207
    v_mfma_f32_32x32x16_bf16 v[112:127], a[92:95], v[212:215], v[112:127]
    v_add_f32 v192, v192, v196
    v_add_f32 v193, v193, v197
    v_add_f32 v194, v194, v198
    v_add_f32 v195, v195, v199
    v_add_f32 v192, v192, v193
    v_add_f32 v194, v194, v195
    v_add_f32 v192, v192, v194
    v_add_f32 v217, v217, v192
    ds_read_b128 a[32:35], v32 offset:8192
    ds_read_b128 a[36:39], v33 offset:8192
    ds_read_b128 a[40:43], v34 offset:8192
    ds_read_b128 a[44:47], v35 offset:8192
    ds_read_b128 a[48:51], v36 offset:8192
    ds_read_b128 a[52:55], v37 offset:8192
    ds_read_b128 a[56:59], v38 offset:8192
    ds_read_b128 a[60:63], v39 offset:8192
    s_waitcnt lgkmcnt(8)
    v_add_f32 v144, v144, v128
    v_add_f32 v145, v145, v129
    v_add_f32 v146, v146, v130
    v_add_f32 v147, v147, v131
    buffer_load_dwordx4 a[96:99], v20, s[32:35], s58 offen nt
    v_add_f32 v148, v148, v132
    v_add_f32 v149, v149, v133
    v_add_f32 v150, v150, v134
    v_add_f32 v151, v151, v135
    v_add_f32 v152, v152, v136
    v_add_f32 v153, v153, v137
    v_add_f32 v154, v154, v138
    v_add_f32 v155, v155, v139
    v_add_f32 v156, v156, v140
    v_add_f32 v157, v157, v141
    v_add_f32 v158, v158, v142
    v_add_f32 v159, v159, v143
    s_waitcnt lgkmcnt(0)
    v_mfma_f32_32x32x16_bf16 v[128:143], a[32:35], a[0:3], 0
    ds_read_b64_tr_b16 a[64:65], v40 offset:0
    ds_read_b64_tr_b16 a[66:67], v41 offset:2048
    v_add_f32 v160, v160, v176
    v_add_f32 v161, v161, v177
    v_add_f32 v162, v162, v178
    v_add_f32 v163, v163, v179
    v_add_f32 v164, v164, v180
    v_mfma_f32_32x32x16_bf16 v[128:143], a[36:39], a[4:7], v[128:143]
    ds_read_b64_tr_b16 a[72:73], v42 offset:0
    ds_read_b64_tr_b16 a[74:75], v43 offset:2048
    v_add_f32 v165, v165, v181
    v_add_f32 v166, v166, v182
    v_add_f32 v167, v167, v183
    v_add_f32 v168, v168, v184
    v_add_f32 v169, v169, v185
    v_mfma_f32_32x32x16_bf16 v[128:143], a[40:43], a[8:11], v[128:143]
    ds_read_b64_tr_b16 a[80:81], v44 offset:0
    ds_read_b64_tr_b16 a[82:83], v45 offset:2048
    v_add_f32 v170, v170, v186
    v_add_f32 v171, v171, v187
    v_add_f32 v172, v172, v188
    v_add_f32 v173, v173, v189
    v_add_f32 v174, v174, v190
    v_mfma_f32_32x32x16_bf16 v[128:143], a[44:47], a[12:15], v[128:143]
    ds_read_b64_tr_b16 a[88:89], v46 offset:0
    ds_read_b64_tr_b16 a[90:91], v47 offset:2048
    v_add_f32 v175, v175, v191
    v_add_f32 v144, v144, v160
    v_add_f32 v145, v145, v161
    v_add_f32 v146, v146, v162
    v_add_f32 v147, v147, v163
    v_mfma_f32_32x32x16_bf16 v[128:143], a[48:51], a[16:19], v[128:143]
    ds_read_b64_tr_b16 a[68:69], v40 offset:4096
    ds_read_b64_tr_b16 a[70:71], v41 offset:6144
    v_add_f32 v148, v148, v164
    v_add_f32 v149, v149, v165
    v_add_f32 v150, v150, v166
    v_add_f32 v151, v151, v167
    v_add_f32 v152, v152, v168
    v_mfma_f32_32x32x16_bf16 v[128:143], a[52:55], a[20:23], v[128:143]
    ds_read_b64_tr_b16 a[76:77], v42 offset:4096
    ds_read_b64_tr_b16 a[78:79], v43 offset:6144
    v_add_f32 v153, v153, v169
    v_add_f32 v154, v154, v170
    v_add_f32 v155, v155, v171
    v_add_f32 v156, v156, v172
    v_add_f32 v157, v157, v173
    v_mfma_f32_32x32x16_bf16 v[128:143], a[56:59], a[24:27], v[128:143]
    ds_read_b64_tr_b16 a[84:85], v44 offset:4096
    ds_read_b64_tr_b16 a[86:87], v45 offset:6144
    v_add_f32 v158, v158, v174
    v_add_f32 v159, v159, v175
    v_max3_f32 v218, v144, v145, v146
    v_max3_f32 v219, v147, v148, v149
    v_max3_f32 v220, v150, v151, v152
    v_mfma_f32_32x32x16_bf16 v[128:143], a[60:63], a[28:31], v[128:143]
    ds_read_b64_tr_b16 a[92:93], v46 offset:4096
    ds_read_b64_tr_b16 a[94:95], v47 offset:6144
    v_max3_f32 v221, v153, v154, v155
    v_max3_f32 v218, v218, v156, v157
    v_max3_f32 v219, v219, v158, v159
    v_max3_f32 v218, v218, v219, v220
    v_max_f32 v218, v218, v221
    v_mov_b32 v219, v218
    s_nop 1
    v_permlane32_swap_b32 v218, v219
    v_max3_f32 v218, v218, v219, v216
    v_sub_f32 v220, v216, v218
    v_mov_b32 v216, v218
    v_exp_f32 v220, v220
    v_sub_f32 v192, v144, v218
    v_sub_f32 v193, v145, v218
    buffer_load_dwordx4 a[100:103], v21, s[32:35], s58 offen nt
    v_sub_f32 v194, v146, v218
    v_sub_f32 v195, v147, v218
    v_sub_f32 v196, v148, v218
    v_sub_f32 v197, v149, v218
    v_sub_f32 v198, v150, v218
    buffer_load_dwordx4 a[104:107], v22, s[32:35], s58 offen nt
    v_sub_f32 v199, v151, v218
    v_sub_f32 v200, v152, v218
    v_sub_f32 v201, v153, v218
    v_sub_f32 v202, v154, v218
    v_sub_f32 v203, v155, v218
    v_sub_f32 v204, v156, v218
    v_sub_f32 v205, v157, v218
    v_sub_f32 v206, v158, v218
    v_sub_f32 v207, v159, v218
    ds_write_b128 v28, v[128:131] offset:16384
    v_exp_f32 v192, v192
    v_exp_f32 v193, v193
    v_exp_f32 v194, v194
    v_exp_f32 v195, v195
    ds_write_b128 v28, v[132:135] offset:17408
    v_exp_f32 v196, v196
    v_exp_f32 v197, v197
    v_exp_f32 v198, v198
    v_exp_f32 v199, v199
    ds_write_b128 v28, v[136:139] offset:18432
    v_exp_f32 v200, v200
    v_exp_f32 v201, v201
    v_exp_f32 v202, v202
    v_exp_f32 v203, v203
    ds_write_b128 v28, v[140:143] offset:19456
    v_exp_f32 v204, v204
    v_exp_f32 v205, v205
    v_exp_f32 v206, v206
    v_exp_f32 v207, v207
    v_mul_f32 v217, v217, v220
    v_cvt_pk_bf16_f32 v208, v192, v193
    v_cvt_pk_bf16_f32 v209, v194, v195
    v_cvt_pk_bf16_f32 v210, v196, v197
    v_cvt_pk_bf16_f32 v211, v198, v199
    v_cvt_pk_bf16_f32 v212, v200, v201
    v_cvt_pk_bf16_f32 v213, v202, v203
    v_cvt_pk_bf16_f32 v214, v204, v205
    v_cvt_pk_bf16_f32 v215, v206, v207
    v_mul_f32 v64, v64, v220
    v_mul_f32 v65, v65, v220
    v_mul_f32 v66, v66, v220
    v_mul_f32 v67, v67, v220
    v_mul_f32 v68, v68, v220
    v_mul_f32 v69, v69, v220
    v_mul_f32 v70, v70, v220
    v_mul_f32 v71, v71, v220
    v_mul_f32 v72, v72, v220
    v_mul_f32 v73, v73, v220
    v_mul_f32 v74, v74, v220
    v_mul_f32 v75, v75, v220
    v_mul_f32 v76, v76, v220
    v_mul_f32 v77, v77, v220
    v_mul_f32 v78, v78, v220
    v_mul_f32 v79, v79, v220
    s_waitcnt lgkmcnt(0)
    s_barrier
    v_mfma_f32_32x32x16_bf16 v[64:79], a[64:67], v[208:211], v[64:79]
    ds_read_b128 v[144:147], v29 offset:16384
    v_mul_f32 v80, v80, v220
    v_mul_f32 v81, v81, v220
    ds_read_b128 v[148:151], v29 offset:17408
    buffer_load_dwordx4 a[108:111], v23, s[32:35], s58 offen nt
    s_add_u32 s58, s58, 16384
    v_mul_f32 v82, v82, v220
    v_mul_f32 v83, v83, v220
    ds_read_b128 v[152:155], v29 offset:18432
    v_mul_f32 v84, v84, v220
    v_mfma_f32_32x32x16_bf16 v[64:79], a[68:71], v[212:215], v[64:79]
    v_mul_f32 v85, v85, v220
    ds_read_b128 v[156:159], v29 offset:19456
    v_mul_f32 v86, v86, v220
    v_mul_f32 v87, v87, v220
    v_mul_f32 v88, v88, v220
    v_mul_f32 v89, v89, v220
    v_mul_f32 v90, v90, v220
    v_mul_f32 v91, v91, v220
    v_mul_f32 v92, v92, v220
    v_mul_f32 v93, v93, v220
    v_mul_f32 v94, v94, v220
    v_mul_f32 v95, v95, v220
    s_nop 1
    v_mfma_f32_32x32x16_bf16 v[80:95], a[72:75], v[208:211], v[80:95]
    ds_read_b128 v[160:163], v30 offset:16384
    v_mul_f32 v96, v96, v220
    v_mul_f32 v97, v97, v220
    ds_read_b128 v[164:167], v30 offset:17408
    buffer_load_dwordx4 a[112:115], v20, s[32:35], s58 offen nt
    v_mul_f32 v98, v98, v220
    v_mul_f32 v99, v99, v220
    ds_read_b128 v[168:171], v30 offset:18432
    v_mul_f32 v100, v100, v220
    v_mfma_f32_32x32x16_bf16 v[80:95], a[76:79], v[212:215], v[80:95]
    v_mul_f32 v101, v101, v220
    ds_read_b128 v[172:175], v30 offset:19456
    v_mul_f32 v102, v102, v220
    v_mul_f32 v103, v103, v220
    v_mul_f32 v104, v104, v220
    v_mul_f32 v105, v105, v220
    v_mul_f32 v106, v106, v220
    v_mul_f32 v107, v107, v220
    v_mul_f32 v108, v108, v220
    v_mul_f32 v109, v109, v220
    v_mul_f32 v110, v110, v220
    v_mul_f32 v111, v111, v220
    s_nop 1
    v_mfma_f32_32x32x16_bf16 v[96:111], a[80:83], v[208:211], v[96:111]
    ds_read_b128 v[176:179], v31 offset:16384
    v_mul_f32 v112, v112, v220
    v_mul_f32 v113, v113, v220
    ds_read_b128 v[180:183], v31 offset:17408
    v_mul_f32 v114, v114, v220
    v_mul_f32 v115, v115, v220
    ds_read_b128 v[184:187], v31 offset:18432
    v_mul_f32 v116, v116, v220
    v_mfma_f32_32x32x16_bf16 v[96:111], a[84:87], v[212:215], v[96:111]
    v_mul_f32 v117, v117, v220
    ds_read_b128 v[188:191], v31 offset:19456
    v_mul_f32 v118, v118, v220
    buffer_load_dwordx4 a[116:119], v21, s[32:35], s58 offen nt
    v_mul_f32 v119, v119, v220
    v_mul_f32 v120, v120, v220
    v_mul_f32 v121, v121, v220
    v_mul_f32 v122, v122, v220
    v_mul_f32 v123, v123, v220
    v_mul_f32 v124, v124, v220
    v_mul_f32 v125, v125, v220
    v_mul_f32 v126, v126, v220
    v_mul_f32 v127, v127, v220
    s_nop 1
    v_mfma_f32_32x32x16_bf16 v[112:127], a[88:91], v[208:211], v[112:127]
    v_add_f32 v192, v192, v200
    v_add_f32 v193, v193, v201
    v_add_f32 v194, v194, v202
    v_add_f32 v195, v195, v203
    v_add_f32 v196, v196, v204
    v_add_f32 v197, v197, v205
    v_add_f32 v198, v198, v206
    v_add_f32 v199, v199, v207
    v_mfma_f32_32x32x16_bf16 v[112:127], a[92:95], v[212:215], v[112:127]
    v_add_f32 v192, v192, v196
    v_add_f32 v193, v193, v197
    v_add_f32 v194, v194, v198
    v_add_f32 v195, v195, v199
    v_add_f32 v192, v192, v193
    v_add_f32 v194, v194, v195
    v_add_f32 v192, v192, v194
    v_add_f32 v217, v217, v192
    ds_read_b128 a[32:35], v32 offset:16384
    ds_read_b128 a[36:39], v33 offset:16384
    ds_read_b128 a[40:43], v34 offset:16384
    ds_read_b128 a[44:47], v35 offset:16384
    ds_read_b128 a[48:51], v36 offset:16384
    ds_read_b128 a[52:55], v37 offset:16384
    ds_read_b128 a[56:59], v38 offset:16384
    ds_read_b128 a[60:63], v39 offset:16384
    s_waitcnt lgkmcnt(8)
    v_add_f32 v144, v144, v128
    v_add_f32 v145, v145, v129
    v_add_f32 v146, v146, v130
    v_add_f32 v147, v147, v131
    buffer_load_dwordx4 a[120:123], v22, s[32:35], s58 offen nt
    v_add_f32 v148, v148, v132
    v_add_f32 v149, v149, v133
    v_add_f32 v150, v150, v134
    v_add_f32 v151, v151, v135
    v_add_f32 v152, v152, v136
    v_add_f32 v153, v153, v137
    v_add_f32 v154, v154, v138
    v_add_f32 v155, v155, v139
    v_add_f32 v156, v156, v140
    v_add_f32 v157, v157, v141
    v_add_f32 v158, v158, v142
    v_add_f32 v159, v159, v143
    s_waitcnt lgkmcnt(0)
    v_mfma_f32_32x32x16_bf16 v[128:143], a[32:35], a[0:3], 0
    ds_read_b64_tr_b16 a[64:65], v40 offset:8192
    ds_read_b64_tr_b16 a[66:67], v41 offset:10240
    v_add_f32 v160, v160, v176
    v_add_f32 v161, v161, v177
    v_add_f32 v162, v162, v178
    v_add_f32 v163, v163, v179
    v_add_f32 v164, v164, v180
    v_mfma_f32_32x32x16_bf16 v[128:143], a[36:39], a[4:7], v[128:143]
    ds_read_b64_tr_b16 a[72:73], v42 offset:8192
    ds_read_b64_tr_b16 a[74:75], v43 offset:10240
    v_add_f32 v165, v165, v181
    v_add_f32 v166, v166, v182
    v_add_f32 v167, v167, v183
    v_add_f32 v168, v168, v184
    v_add_f32 v169, v169, v185
    v_mfma_f32_32x32x16_bf16 v[128:143], a[40:43], a[8:11], v[128:143]
    ds_read_b64_tr_b16 a[80:81], v44 offset:8192
    ds_read_b64_tr_b16 a[82:83], v45 offset:10240
    v_add_f32 v170, v170, v186
    v_add_f32 v171, v171, v187
    v_add_f32 v172, v172, v188
    v_add_f32 v173, v173, v189
    v_add_f32 v174, v174, v190
    v_mfma_f32_32x32x16_bf16 v[128:143], a[44:47], a[12:15], v[128:143]
    ds_read_b64_tr_b16 a[88:89], v46 offset:8192
    ds_read_b64_tr_b16 a[90:91], v47 offset:10240
    v_add_f32 v175, v175, v191
    v_add_f32 v144, v144, v160
    v_add_f32 v145, v145, v161
    v_add_f32 v146, v146, v162
    v_add_f32 v147, v147, v163
    v_mfma_f32_32x32x16_bf16 v[128:143], a[48:51], a[16:19], v[128:143]
    ds_read_b64_tr_b16 a[68:69], v40 offset:12288
    ds_read_b64_tr_b16 a[70:71], v41 offset:14336
    v_add_f32 v148, v148, v164
    v_add_f32 v149, v149, v165
    v_add_f32 v150, v150, v166
    v_add_f32 v151, v151, v167
    v_add_f32 v152, v152, v168
    v_mfma_f32_32x32x16_bf16 v[128:143], a[52:55], a[20:23], v[128:143]
    ds_read_b64_tr_b16 a[76:77], v42 offset:12288
    ds_read_b64_tr_b16 a[78:79], v43 offset:14336
    v_add_f32 v153, v153, v169
    v_add_f32 v154, v154, v170
    v_add_f32 v155, v155, v171
    v_add_f32 v156, v156, v172
    v_add_f32 v157, v157, v173
    v_mfma_f32_32x32x16_bf16 v[128:143], a[56:59], a[24:27], v[128:143]
    ds_read_b64_tr_b16 a[84:85], v44 offset:12288
    ds_read_b64_tr_b16 a[86:87], v45 offset:14336
    v_add_f32 v158, v158, v174
    v_add_f32 v159, v159, v175
    v_max3_f32 v218, v144, v145, v146
    v_max3_f32 v219, v147, v148, v149
    v_max3_f32 v220, v150, v151, v152
    v_mfma_f32_32x32x16_bf16 v[128:143], a[60:63], a[28:31], v[128:143]
    ds_read_b64_tr_b16 a[92:93], v46 offset:12288
    ds_read_b64_tr_b16 a[94:95], v47 offset:14336
    v_max3_f32 v221, v153, v154, v155
    v_max3_f32 v218, v218, v156, v157
    v_max3_f32 v219, v219, v158, v159
    v_max3_f32 v218, v218, v219, v220
    v_max_f32 v218, v218, v221
    v_mov_b32 v219, v218
    s_nop 1
    v_permlane32_swap_b32 v218, v219
    v_max3_f32 v218, v218, v219, v216
    v_sub_f32 v220, v216, v218
    v_mov_b32 v216, v218
    v_exp_f32 v220, v220
    v_sub_f32 v192, v144, v218
    v_sub_f32 v193, v145, v218
    buffer_load_dwordx4 a[124:127], v23, s[32:35], s58 offen nt
    s_add_u32 s58, s58, 16384
    v_sub_f32 v194, v146, v218
    v_sub_f32 v195, v147, v218
    v_sub_f32 v196, v148, v218
    v_sub_f32 v197, v149, v218
    v_sub_f32 v198, v150, v218
    buffer_load_dwordx4 a[128:131], v20, s[32:35], s58 offen nt
    v_sub_f32 v199, v151, v218
    v_sub_f32 v200, v152, v218
    v_sub_f32 v201, v153, v218
    v_sub_f32 v202, v154, v218
    v_sub_f32 v203, v155, v218
    v_sub_f32 v204, v156, v218
    v_sub_f32 v205, v157, v218
    v_sub_f32 v206, v158, v218
    v_sub_f32 v207, v159, v218
    ds_write_b128 v28, v[128:131] offset:0
    v_exp_f32 v192, v192
    v_exp_f32 v193, v193
    v_exp_f32 v194, v194
    v_exp_f32 v195, v195
    ds_write_b128 v28, v[132:135] offset:1024
    v_exp_f32 v196, v196
    v_exp_f32 v197, v197
    v_exp_f32 v198, v198
    v_exp_f32 v199, v199
    ds_write_b128 v28, v[136:139] offset:2048
    v_exp_f32 v200, v200
    v_exp_f32 v201, v201
    v_exp_f32 v202, v202
    v_exp_f32 v203, v203
    ds_write_b128 v28, v[140:143] offset:3072
    v_exp_f32 v204, v204
    v_exp_f32 v205, v205
    v_exp_f32 v206, v206
    v_exp_f32 v207, v207
    v_mul_f32 v217, v217, v220
    v_cvt_pk_bf16_f32 v208, v192, v193
    v_cvt_pk_bf16_f32 v209, v194, v195
    v_cvt_pk_bf16_f32 v210, v196, v197
    v_cvt_pk_bf16_f32 v211, v198, v199
    v_cvt_pk_bf16_f32 v212, v200, v201
    v_cvt_pk_bf16_f32 v213, v202, v203
    v_cvt_pk_bf16_f32 v214, v204, v205
    v_cvt_pk_bf16_f32 v215, v206, v207
    v_mul_f32 v64, v64, v220
    v_mul_f32 v65, v65, v220
    v_mul_f32 v66, v66, v220
    v_mul_f32 v67, v67, v220
    v_mul_f32 v68, v68, v220
    v_mul_f32 v69, v69, v220
    v_mul_f32 v70, v70, v220
    v_mul_f32 v71, v71, v220
    v_mul_f32 v72, v72, v220
    v_mul_f32 v73, v73, v220
    v_mul_f32 v74, v74, v220
    v_mul_f32 v75, v75, v220
    v_mul_f32 v76, v76, v220
    v_mul_f32 v77, v77, v220
    v_mul_f32 v78, v78, v220
    v_mul_f32 v79, v79, v220
    s_waitcnt lgkmcnt(0)
    s_barrier
    v_mfma_f32_32x32x16_bf16 v[64:79], a[64:67], v[208:211], v[64:79]
    ds_read_b128 v[144:147], v29 offset:0
    v_mul_f32 v80, v80, v220
    v_mul_f32 v81, v81, v220
    ds_read_b128 v[148:151], v29 offset:1024
    s_waitcnt vmcnt(32)
    ds_write_b128 v26, a[192:195] offset:24576
    buffer_load_dwordx4 a[132:135], v21, s[32:35], s58 offen nt
    v_mul_f32 v82, v82, v220
    v_mul_f32 v83, v83, v220
    ds_read_b128 v[152:155], v29 offset:2048
    v_mul_f32 v84, v84, v220
    v_mfma_f32_32x32x16_bf16 v[64:79], a[68:71], v[212:215], v[64:79]
    v_mul_f32 v85, v85, v220
    ds_read_b128 v[156:159], v29 offset:3072
    v_mul_f32 v86, v86, v220
    s_waitcnt vmcnt(32)
    ds_write_b128 v26, a[196:199] offset:25600
    v_mul_f32 v87, v87, v220
    v_mul_f32 v88, v88, v220
    v_mul_f32 v89, v89, v220
    v_mul_f32 v90, v90, v220
    v_mul_f32 v91, v91, v220
    v_mul_f32 v92, v92, v220
    v_mul_f32 v93, v93, v220
    v_mul_f32 v94, v94, v220
    v_mul_f32 v95, v95, v220
    s_nop 1
    v_mfma_f32_32x32x16_bf16 v[80:95], a[72:75], v[208:211], v[80:95]
    ds_read_b128 v[160:163], v30 offset:0
    v_mul_f32 v96, v96, v220
    v_mul_f32 v97, v97, v220
    ds_read_b128 v[164:167], v30 offset:1024
    s_waitcnt vmcnt(31)
    ds_write_b128 v26, a[200:203] offset:26624
    buffer_load_dwordx4 a[136:139], v22, s[32:35], s58 offen nt
    v_mul_f32 v98, v98, v220
    v_mul_f32 v99, v99, v220
    ds_read_b128 v[168:171], v30 offset:2048
    v_mul_f32 v100, v100, v220
    v_mfma_f32_32x32x16_bf16 v[80:95], a[76:79], v[212:215], v[80:95]
    v_mul_f32 v101, v101, v220
    ds_read_b128 v[172:175], v30 offset:3072
    v_mul_f32 v102, v102, v220
    s_waitcnt vmcnt(31)
    ds_write_b128 v26, a[204:207] offset:27648
    v_mul_f32 v103, v103, v220
    v_mul_f32 v104, v104, v220
    v_mul_f32 v105, v105, v220
    v_mul_f32 v106, v106, v220
    v_mul_f32 v107, v107, v220
    v_mul_f32 v108, v108, v220
    v_mul_f32 v109, v109, v220
    v_mul_f32 v110, v110, v220
    v_mul_f32 v111, v111, v220
    s_nop 1
    v_mfma_f32_32x32x16_bf16 v[96:111], a[80:83], v[208:211], v[96:111]
    ds_read_b128 v[176:179], v31 offset:0
    v_mul_f32 v112, v112, v220
    v_mul_f32 v113, v113, v220
    ds_read_b128 v[180:183], v31 offset:1024
    s_waitcnt vmcnt(30)
    ds_write_b128 v26, a[208:211] offset:28672
    v_mul_f32 v114, v114, v220
    v_mul_f32 v115, v115, v220
    ds_read_b128 v[184:187], v31 offset:2048
    v_mul_f32 v116, v116, v220
    v_mfma_f32_32x32x16_bf16 v[96:111], a[84:87], v[212:215], v[96:111]
    v_mul_f32 v117, v117, v220
    ds_read_b128 v[188:191], v31 offset:3072
    v_mul_f32 v118, v118, v220
    s_waitcnt vmcnt(29)
    ds_write_b128 v26, a[212:215] offset:29696
    buffer_load_dwordx4 a[140:143], v23, s[32:35], s58 offen nt
    s_add_u32 s58, s58, 16384
    v_mul_f32 v119, v119, v220
    v_mul_f32 v120, v120, v220
    v_mul_f32 v121, v121, v220
    v_mul_f32 v122, v122, v220
    v_mul_f32 v123, v123, v220
    v_mul_f32 v124, v124, v220
    v_mul_f32 v125, v125, v220
    v_mul_f32 v126, v126, v220
    v_mul_f32 v127, v127, v220
    s_nop 1
    v_mfma_f32_32x32x16_bf16 v[112:127], a[88:91], v[208:211], v[112:127]
    v_add_f32 v192, v192, v200
    v_add_f32 v193, v193, v201
    v_add_f32 v194, v194, v202
    v_add_f32 v195, v195, v203
    s_waitcnt vmcnt(29)
    ds_write_b128 v26, a[216:219] offset:30720
    v_add_f32 v196, v196, v204
    v_add_f32 v197, v197, v205
    v_add_f32 v198, v198, v206
    v_add_f32 v199, v199, v207
    v_mfma_f32_32x32x16_bf16 v[112:127], a[92:95], v[212:215], v[112:127]
    v_add_f32 v192, v192, v196
    v_add_f32 v193, v193, v197
    v_add_f32 v194, v194, v198
    s_waitcnt vmcnt(28)
    ds_write_b128 v26, a[220:223] offset:31744
    v_add_f32 v195, v195, v199
    v_add_f32 v192, v192, v193
    v_add_f32 v194, v194, v195
    v_add_f32 v192, v192, v194
    v_add_f32 v217, v217, v192
    ds_read_b128 a[32:35], v32 offset:24576
    ds_read_b128 a[36:39], v33 offset:24576
    ds_read_b128 a[40:43], v34 offset:24576
    ds_read_b128 a[44:47], v35 offset:24576
    ds_read_b128 a[48:51], v36 offset:24576
    ds_read_b128 a[52:55], v37 offset:24576
    ds_read_b128 a[56:59], v38 offset:24576
    ds_read_b128 a[60:63], v39 offset:24576
    s_waitcnt lgkmcnt(8)
    v_add_f32 v144, v144, v128
    v_add_f32 v145, v145, v129
    v_add_f32 v146, v146, v130
    v_add_f32 v147, v147, v131
    buffer_load_dwordx4 a[144:147], v20, s[32:35], s58 offen nt
    v_add_f32 v148, v148, v132
    v_add_f32 v149, v149, v133
    v_add_f32 v150, v150, v134
    v_add_f32 v151, v151, v135
    v_add_f32 v152, v152, v136
    v_add_f32 v153, v153, v137
    v_add_f32 v154, v154, v138
    v_add_f32 v155, v155, v139
    v_add_f32 v156, v156, v140
    v_add_f32 v157, v157, v141
    v_add_f32 v158, v158, v142
    v_add_f32 v159, v159, v143
    s_waitcnt lgkmcnt(0)
    v_mfma_f32_32x32x16_bf16 v[128:143], a[32:35], a[0:3], 0
    ds_read_b64_tr_b16 a[64:65], v40 offset:16384
    ds_read_b64_tr_b16 a[66:67], v41 offset:18432
    v_add_f32 v160, v160, v176
    v_add_f32 v161, v161, v177
    v_add_f32 v162, v162, v178
    v_add_f32 v163, v163, v179
    v_add_f32 v164, v164, v180
    v_mfma_f32_32x32x16_bf16 v[128:143], a[36:39], a[4:7], v[128:143]
    ds_read_b64_tr_b16 a[72:73], v42 offset:16384
    ds_read_b64_tr_b16 a[74:75], v43 offset:18432
    v_add_f32 v165, v165, v181
    v_add_f32 v166, v166, v182
    v_add_f32 v167, v167, v183
    v_add_f32 v168, v168, v184
    v_add_f32 v169, v169, v185
    v_mfma_f32_32x32x16_bf16 v[128:143], a[40:43], a[8:11], v[128:143]
    ds_read_b64_tr_b16 a[80:81], v44 offset:16384
    ds_read_b64_tr_b16 a[82:83], v45 offset:18432
    v_add_f32 v170, v170, v186
    v_add_f32 v171, v171, v187
    v_add_f32 v172, v172, v188
    v_add_f32 v173, v173, v189
    v_add_f32 v174, v174, v190
    v_mfma_f32_32x32x16_bf16 v[128:143], a[44:47], a[12:15], v[128:143]
    ds_read_b64_tr_b16 a[88:89], v46 offset:16384
    ds_read_b64_tr_b16 a[90:91], v47 offset:18432
    v_add_f32 v175, v175, v191
    v_add_f32 v144, v144, v160
    v_add_f32 v145, v145, v161
    v_add_f32 v146, v146, v162
    v_add_f32 v147, v147, v163
    v_mfma_f32_32x32x16_bf16 v[128:143], a[48:51], a[16:19], v[128:143]
    ds_read_b64_tr_b16 a[68:69], v40 offset:20480
    ds_read_b64_tr_b16 a[70:71], v41 offset:22528
    v_add_f32 v148, v148, v164
    v_add_f32 v149, v149, v165
    v_add_f32 v150, v150, v166
    v_add_f32 v151, v151, v167
    v_add_f32 v152, v152, v168
    v_mfma_f32_32x32x16_bf16 v[128:143], a[52:55], a[20:23], v[128:143]
    ds_read_b64_tr_b16 a[76:77], v42 offset:20480
    ds_read_b64_tr_b16 a[78:79], v43 offset:22528
    v_add_f32 v153, v153, v169
    v_add_f32 v154, v154, v170
    v_add_f32 v155, v155, v171
    v_add_f32 v156, v156, v172
    v_add_f32 v157, v157, v173
    v_mfma_f32_32x32x16_bf16 v[128:143], a[56:59], a[24:27], v[128:143]
    ds_read_b64_tr_b16 a[84:85], v44 offset:20480
    ds_read_b64_tr_b16 a[86:87], v45 offset:22528
    v_add_f32 v158, v158, v174
    v_add_f32 v159, v159, v175
    v_max3_f32 v218, v144, v145, v146
    v_max3_f32 v219, v147, v148, v149
    v_max3_f32 v220, v150, v151, v152
    v_mfma_f32_32x32x16_bf16 v[128:143], a[60:63], a[28:31], v[128:143]
    ds_read_b64_tr_b16 a[92:93], v46 offset:20480
    ds_read_b64_tr_b16 a[94:95], v47 offset:22528
    v_max3_f32 v221, v153, v154, v155
    v_max3_f32 v218, v218, v156, v157
    v_max3_f32 v219, v219, v158, v159
    v_max3_f32 v218, v218, v219, v220
    v_max_f32 v218, v218, v221
    v_mov_b32 v219, v218
    s_nop 1
    v_permlane32_swap_b32 v218, v219
    v_max3_f32 v218, v218, v219, v216
    v_sub_f32 v220, v216, v218
    v_mov_b32 v216, v218
    v_exp_f32 v220, v220
    v_sub_f32 v192, v144, v218
    v_sub_f32 v193, v145, v218
    buffer_load_dwordx4 a[148:151], v21, s[32:35], s58 offen nt
    v_sub_f32 v194, v146, v218
    v_sub_f32 v195, v147, v218
    v_sub_f32 v196, v148, v218
    v_sub_f32 v197, v149, v218
    v_sub_f32 v198, v150, v218
    buffer_load_dwordx4 a[152:155], v22, s[32:35], s58 offen nt
    v_sub_f32 v199, v151, v218
    v_sub_f32 v200, v152, v218
    v_sub_f32 v201, v153, v218
    v_sub_f32 v202, v154, v218
    v_sub_f32 v203, v155, v218
    v_sub_f32 v204, v156, v218
    v_sub_f32 v205, v157, v218
    v_sub_f32 v206, v158, v218
    v_sub_f32 v207, v159, v218
    ds_write_b128 v28, v[128:131] offset:16384
    v_exp_f32 v192, v192
    v_exp_f32 v193, v193
    v_exp_f32 v194, v194
    v_exp_f32 v195, v195
    ds_write_b128 v28, v[132:135] offset:17408
    v_exp_f32 v196, v196
    v_exp_f32 v197, v197
    v_exp_f32 v198, v198
    v_exp_f32 v199, v199
    ds_write_b128 v28, v[136:139] offset:18432
    v_exp_f32 v200, v200
    v_exp_f32 v201, v201
    v_exp_f32 v202, v202
    v_exp_f32 v203, v203
    ds_write_b128 v28, v[140:143] offset:19456
    v_exp_f32 v204, v204
    v_exp_f32 v205, v205
    v_exp_f32 v206, v206
    v_exp_f32 v207, v207
    v_mul_f32 v217, v217, v220
    v_cvt_pk_bf16_f32 v208, v192, v193
    v_cvt_pk_bf16_f32 v209, v194, v195
    v_cvt_pk_bf16_f32 v210, v196, v197
    v_cvt_pk_bf16_f32 v211, v198, v199
    v_cvt_pk_bf16_f32 v212, v200, v201
    v_cvt_pk_bf16_f32 v213, v202, v203
    v_cvt_pk_bf16_f32 v214, v204, v205
    v_cvt_pk_bf16_f32 v215, v206, v207
    v_mul_f32 v64, v64, v220
    v_mul_f32 v65, v65, v220
    v_mul_f32 v66, v66, v220
    v_mul_f32 v67, v67, v220
    v_mul_f32 v68, v68, v220
    v_mul_f32 v69, v69, v220
    v_mul_f32 v70, v70, v220
    v_mul_f32 v71, v71, v220
    v_mul_f32 v72, v72, v220
    v_mul_f32 v73, v73, v220
    v_mul_f32 v74, v74, v220
    v_mul_f32 v75, v75, v220
    v_mul_f32 v76, v76, v220
    v_mul_f32 v77, v77, v220
    v_mul_f32 v78, v78, v220
    v_mul_f32 v79, v79, v220
    s_waitcnt lgkmcnt(0)
    s_barrier
    v_mfma_f32_32x32x16_bf16 v[64:79], a[64:67], v[208:211], v[64:79]
    ds_read_b128 v[144:147], v29 offset:16384
    v_mul_f32 v80, v80, v220
    v_mul_f32 v81, v81, v220
    ds_read_b128 v[148:151], v29 offset:17408
    s_waitcnt vmcnt(30)
    ds_write_b128 v26, a[224:227] offset:0
    buffer_load_dwordx4 a[156:159], v23, s[32:35], s58 offen nt
    s_add_u32 s58, s58, 16384
    v_mul_f32 v82, v82, v220
    v_mul_f32 v83, v83, v220
    ds_read_b128 v[152:155], v29 offset:18432
    v_mul_f32 v84, v84, v220
    v_mfma_f32_32x32x16_bf16 v[64:79], a[68:71], v[212:215], v[64:79]
    v_mul_f32 v85, v85, v220
    ds_read_b128 v[156:159], v29 offset:19456
    v_mul_f32 v86, v86, v220
    s_waitcnt vmcnt(30)
    ds_write_b128 v26, a[228:231] offset:1024
    v_mul_f32 v87, v87, v220
    v_mul_f32 v88, v88, v220
    v_mul_f32 v89, v89, v220
    v_mul_f32 v90, v90, v220
    v_mul_f32 v91, v91, v220
    v_mul_f32 v92, v92, v220
    v_mul_f32 v93, v93, v220
    v_mul_f32 v94, v94, v220
    v_mul_f32 v95, v95, v220
    s_nop 1
    v_mfma_f32_32x32x16_bf16 v[80:95], a[72:75], v[208:211], v[80:95]
    ds_read_b128 v[160:163], v30 offset:16384
    v_mul_f32 v96, v96, v220
    v_mul_f32 v97, v97, v220
    ds_read_b128 v[164:167], v30 offset:17408
    s_waitcnt vmcnt(29)
    ds_write_b128 v26, a[232:235] offset:2048
    buffer_load_dwordx4 a[160:163], v20, s[32:35], s58 offen nt
    v_mul_f32 v98, v98, v220
    v_mul_f32 v99, v99, v220
    ds_read_b128 v[168:171], v30 offset:18432
    v_mul_f32 v100, v100, v220
    v_mfma_f32_32x32x16_bf16 v[80:95], a[76:79], v[212:215], v[80:95]
    v_mul_f32 v101, v101, v220
    ds_read_b128 v[172:175], v30 offset:19456
    v_mul_f32 v102, v102, v220
    s_waitcnt vmcnt(29)
    ds_write_b128 v26, a[236:239] offset:3072
    v_mul_f32 v103, v103, v220
    v_mul_f32 v104, v104, v220
    v_mul_f32 v105, v105, v220
    v_mul_f32 v106, v106, v220
    v_mul_f32 v107, v107, v220
    v_mul_f32 v108, v108, v220
    v_mul_f32 v109, v109, v220
    v_mul_f32 v110, v110, v220
    v_mul_f32 v111, v111, v220
    s_nop 1
    v_mfma_f32_32x32x16_bf16 v[96:111], a[80:83], v[208:211], v[96:111]
    ds_read_b128 v[176:179], v31 offset:16384
    v_mul_f32 v112, v112, v220
    v_mul_f32 v113, v113, v220
    ds_read_b128 v[180:183], v31 offset:17408
    s_waitcnt vmcnt(28)
    ds_write_b128 v26, a[240:243] offset:4096
    v_mul_f32 v114, v114, v220
    v_mul_f32 v115, v115, v220
    ds_read_b128 v[184:187], v31 offset:18432
    v_mul_f32 v116, v116, v220
    v_mfma_f32_32x32x16_bf16 v[96:111], a[84:87], v[212:215], v[96:111]
    v_mul_f32 v117, v117, v220
    ds_read_b128 v[188:191], v31 offset:19456
    v_mul_f32 v118, v118, v220
    s_waitcnt vmcnt(27)
    ds_write_b128 v26, a[244:247] offset:5120
    buffer_load_dwordx4 a[164:167], v21, s[32:35], s58 offen nt
    v_mul_f32 v119, v119, v220
    v_mul_f32 v120, v120, v220
    v_mul_f32 v121, v121, v220
    v_mul_f32 v122, v122, v220
    v_mul_f32 v123, v123, v220
    v_mul_f32 v124, v124, v220
    v_mul_f32 v125, v125, v220
    v_mul_f32 v126, v126, v220
    v_mul_f32 v127, v127, v220
    s_nop 1
    v_mfma_f32_32x32x16_bf16 v[112:127], a[88:91], v[208:211], v[112:127]
    v_add_f32 v192, v192, v200
    v_add_f32 v193, v193, v201
    v_add_f32 v194, v194, v202
    v_add_f32 v195, v195, v203
    s_waitcnt vmcnt(27)
    ds_write_b128 v26, a[248:251] offset:6144
    v_add_f32 v196, v196, v204
    v_add_f32 v197, v197, v205
    v_add_f32 v198, v198, v206
    v_add_f32 v199, v199, v207
    v_mfma_f32_32x32x16_bf16 v[112:127], a[92:95], v[212:215], v[112:127]
    v_add_f32 v192, v192, v196
    v_add_f32 v193, v193, v197
    v_add_f32 v194, v194, v198
    s_waitcnt vmcnt(26)
    ds_write_b128 v26, a[252:255] offset:7168
    v_add_f32 v195, v195, v199
    v_add_f32 v192, v192, v193
    v_add_f32 v194, v194, v195
    v_add_f32 v192, v192, v194
    v_add_f32 v217, v217, v192
    ds_read_b128 a[32:35], v32 offset:0
    ds_read_b128 a[36:39], v33 offset:0
    ds_read_b128 a[40:43], v34 offset:0
    ds_read_b128 a[44:47], v35 offset:0
    ds_read_b128 a[48:51], v36 offset:0
    ds_read_b128 a[52:55], v37 offset:0
    ds_read_b128 a[56:59], v38 offset:0
    ds_read_b128 a[60:63], v39 offset:0
    s_waitcnt lgkmcnt(8)
    v_add_f32 v144, v144, v128
    v_add_f32 v145, v145, v129
    v_add_f32 v146, v146, v130
    v_add_f32 v147, v147, v131
    buffer_load_dwordx4 a[168:171], v22, s[32:35], s58 offen nt
    v_add_f32 v148, v148, v132
    v_add_f32 v149, v149, v133
    v_add_f32 v150, v150, v134
    v_add_f32 v151, v151, v135
    v_add_f32 v152, v152, v136
    v_add_f32 v153, v153, v137
    v_add_f32 v154, v154, v138
    v_add_f32 v155, v155, v139
    v_add_f32 v156, v156, v140
    v_add_f32 v157, v157, v141
    v_add_f32 v158, v158, v142
    v_add_f32 v159, v159, v143
    s_waitcnt lgkmcnt(0)
    v_mfma_f32_32x32x16_bf16 v[128:143], a[32:35], a[0:3], 0
    ds_read_b64_tr_b16 a[64:65], v40 offset:24576
    ds_read_b64_tr_b16 a[66:67], v41 offset:26624
    v_add_f32 v160, v160, v176
    v_add_f32 v161, v161, v177
    v_add_f32 v162, v162, v178
    v_add_f32 v163, v163, v179
    v_add_f32 v164, v164, v180
    v_mfma_f32_32x32x16_bf16 v[128:143], a[36:39], a[4:7], v[128:143]
    ds_read_b64_tr_b16 a[72:73], v42 offset:24576
    ds_read_b64_tr_b16 a[74:75], v43 offset:26624
    v_add_f32 v165, v165, v181
    v_add_f32 v166, v166, v182
    v_add_f32 v167, v167, v183
    v_add_f32 v168, v168, v184
    v_add_f32 v169, v169, v185
    v_mfma_f32_32x32x16_bf16 v[128:143], a[40:43], a[8:11], v[128:143]
    ds_read_b64_tr_b16 a[80:81], v44 offset:24576
    ds_read_b64_tr_b16 a[82:83], v45 offset:26624
    v_add_f32 v170, v170, v186
    v_add_f32 v171, v171, v187
    v_add_f32 v172, v172, v188
    v_add_f32 v173, v173, v189
    v_add_f32 v174, v174, v190
    v_mfma_f32_32x32x16_bf16 v[128:143], a[44:47], a[12:15], v[128:143]
    ds_read_b64_tr_b16 a[88:89], v46 offset:24576
    ds_read_b64_tr_b16 a[90:91], v47 offset:26624
    v_add_f32 v175, v175, v191
    v_add_f32 v144, v144, v160
    v_add_f32 v145, v145, v161
    v_add_f32 v146, v146, v162
    v_add_f32 v147, v147, v163
    v_mfma_f32_32x32x16_bf16 v[128:143], a[48:51], a[16:19], v[128:143]
    ds_read_b64_tr_b16 a[68:69], v40 offset:28672
    ds_read_b64_tr_b16 a[70:71], v41 offset:30720
    v_add_f32 v148, v148, v164
    v_add_f32 v149, v149, v165
    v_add_f32 v150, v150, v166
    v_add_f32 v151, v151, v167
    v_add_f32 v152, v152, v168
    v_mfma_f32_32x32x16_bf16 v[128:143], a[52:55], a[20:23], v[128:143]
    ds_read_b64_tr_b16 a[76:77], v42 offset:28672
    ds_read_b64_tr_b16 a[78:79], v43 offset:30720
    v_add_f32 v153, v153, v169
    v_add_f32 v154, v154, v170
    v_add_f32 v155, v155, v171
    v_add_f32 v156, v156, v172
    v_add_f32 v157, v157, v173
    v_mfma_f32_32x32x16_bf16 v[128:143], a[56:59], a[24:27], v[128:143]
    ds_read_b64_tr_b16 a[84:85], v44 offset:28672
    ds_read_b64_tr_b16 a[86:87], v45 offset:30720
    v_add_f32 v158, v158, v174
    v_add_f32 v159, v159, v175
    v_max3_f32 v218, v144, v145, v146
    v_max3_f32 v219, v147, v148, v149
    v_max3_f32 v220, v150, v151, v152
    v_mfma_f32_32x32x16_bf16 v[128:143], a[60:63], a[28:31], v[128:143]
    ds_read_b64_tr_b16 a[92:93], v46 offset:28672
    ds_read_b64_tr_b16 a[94:95], v47 offset:30720
    v_max3_f32 v221, v153, v154, v155
    v_max3_f32 v218, v218, v156, v157
    v_max3_f32 v219, v219, v158, v159
    v_max3_f32 v218, v218, v219, v220
    v_max_f32 v218, v218, v221
    v_mov_b32 v219, v218
    s_nop 1
    v_permlane32_swap_b32 v218, v219
    v_max3_f32 v218, v218, v219, v216
    v_sub_f32 v220, v216, v218
    v_mov_b32 v216, v218
    v_exp_f32 v220, v220
    v_sub_f32 v192, v144, v218
    v_sub_f32 v193, v145, v218
    buffer_load_dwordx4 a[172:175], v23, s[32:35], s58 offen nt
    s_add_u32 s58, s58, 16384
    v_sub_f32 v194, v146, v218
    v_sub_f32 v195, v147, v218
    v_sub_f32 v196, v148, v218
    v_sub_f32 v197, v149, v218
    v_sub_f32 v198, v150, v218
    buffer_load_dwordx4 a[176:179], v20, s[32:35], s58 offen nt
    v_sub_f32 v199, v151, v218
    v_sub_f32 v200, v152, v218
    v_sub_f32 v201, v153, v218
    v_sub_f32 v202, v154, v218
    v_sub_f32 v203, v155, v218
    v_sub_f32 v204, v156, v218
    v_sub_f32 v205, v157, v218
    v_sub_f32 v206, v158, v218
    v_sub_f32 v207, v159, v218
    ds_write_b128 v28, v[128:131] offset:0
    v_exp_f32 v192, v192
    v_exp_f32 v193, v193
    v_exp_f32 v194, v194
    v_exp_f32 v195, v195
    ds_write_b128 v28, v[132:135] offset:1024
    v_exp_f32 v196, v196
    v_exp_f32 v197, v197
    v_exp_f32 v198, v198
    v_exp_f32 v199, v199
    ds_write_b128 v28, v[136:139] offset:2048
    v_exp_f32 v200, v200
    v_exp_f32 v201, v201
    v_exp_f32 v202, v202
    v_exp_f32 v203, v203
    ds_write_b128 v28, v[140:143] offset:3072
    v_exp_f32 v204, v204
    v_exp_f32 v205, v205
    v_exp_f32 v206, v206
    v_exp_f32 v207, v207
    v_mul_f32 v217, v217, v220
    v_cvt_pk_bf16_f32 v208, v192, v193
    v_cvt_pk_bf16_f32 v209, v194, v195
    v_cvt_pk_bf16_f32 v210, v196, v197
    v_cvt_pk_bf16_f32 v211, v198, v199
    v_cvt_pk_bf16_f32 v212, v200, v201
    v_cvt_pk_bf16_f32 v213, v202, v203
    v_cvt_pk_bf16_f32 v214, v204, v205
    v_cvt_pk_bf16_f32 v215, v206, v207
    v_mul_f32 v64, v64, v220
    v_mul_f32 v65, v65, v220
    v_mul_f32 v66, v66, v220
    v_mul_f32 v67, v67, v220
    v_mul_f32 v68, v68, v220
    v_mul_f32 v69, v69, v220
    v_mul_f32 v70, v70, v220
    v_mul_f32 v71, v71, v220
    v_mul_f32 v72, v72, v220
    v_mul_f32 v73, v73, v220
    v_mul_f32 v74, v74, v220
    v_mul_f32 v75, v75, v220
    v_mul_f32 v76, v76, v220
    v_mul_f32 v77, v77, v220
    v_mul_f32 v78, v78, v220
    v_mul_f32 v79, v79, v220
    s_waitcnt lgkmcnt(0)
    s_barrier
    v_mfma_f32_32x32x16_bf16 v[64:79], a[64:67], v[208:211], v[64:79]
    ds_read_b128 v[144:147], v29 offset:0
    v_mul_f32 v80, v80, v220
    v_mul_f32 v81, v81, v220
    ds_read_b128 v[148:151], v29 offset:1024
    s_waitcnt vmcnt(28)
    ds_write_b128 v26, v[224:227] offset:8192
    buffer_load_dwordx4 a[180:183], v21, s[32:35], s58 offen nt
    v_mul_f32 v82, v82, v220
    v_mul_f32 v83, v83, v220
    ds_read_b128 v[152:155], v29 offset:2048
    v_mul_f32 v84, v84, v220
    v_mfma_f32_32x32x16_bf16 v[64:79], a[68:71], v[212:215], v[64:79]
    v_mul_f32 v85, v85, v220
    ds_read_b128 v[156:159], v29 offset:3072
    v_mul_f32 v86, v86, v220
    s_waitcnt vmcnt(28)
    ds_write_b128 v26, v[228:231] offset:9216
    v_mul_f32 v87, v87, v220
    v_mul_f32 v88, v88, v220
    v_mul_f32 v89, v89, v220
    v_mul_f32 v90, v90, v220
    v_mul_f32 v91, v91, v220
    v_mul_f32 v92, v92, v220
    v_mul_f32 v93, v93, v220
    v_mul_f32 v94, v94, v220
    v_mul_f32 v95, v95, v220
    s_nop 1
    v_mfma_f32_32x32x16_bf16 v[80:95], a[72:75], v[208:211], v[80:95]
    ds_read_b128 v[160:163], v30 offset:0
    v_mul_f32 v96, v96, v220
    v_mul_f32 v97, v97, v220
    ds_read_b128 v[164:167], v30 offset:1024
    s_waitcnt vmcnt(27)
    ds_write_b128 v26, v[232:235] offset:10240
    buffer_load_dwordx4 a[184:187], v22, s[32:35], s58 offen nt
    v_mul_f32 v98, v98, v220
    v_mul_f32 v99, v99, v220
    ds_read_b128 v[168:171], v30 offset:2048
    v_mul_f32 v100, v100, v220
    v_mfma_f32_32x32x16_bf16 v[80:95], a[76:79], v[212:215], v[80:95]
    v_mul_f32 v101, v101, v220
    ds_read_b128 v[172:175], v30 offset:3072
    v_mul_f32 v102, v102, v220
    s_waitcnt vmcnt(27)
    ds_write_b128 v26, v[236:239] offset:11264
    v_mul_f32 v103, v103, v220
    v_mul_f32 v104, v104, v220
    v_mul_f32 v105, v105, v220
    v_mul_f32 v106, v106, v220
    v_mul_f32 v107, v107, v220
    v_mul_f32 v108, v108, v220
    v_mul_f32 v109, v109, v220
    v_mul_f32 v110, v110, v220
    v_mul_f32 v111, v111, v220
    s_nop 1
    v_mfma_f32_32x32x16_bf16 v[96:111], a[80:83], v[208:211], v[96:111]
    ds_read_b128 v[176:179], v31 offset:0
    v_mul_f32 v112, v112, v220
    v_mul_f32 v113, v113, v220
    ds_read_b128 v[180:183], v31 offset:1024
    s_waitcnt vmcnt(26)
    ds_write_b128 v26, v[240:243] offset:12288
    v_mul_f32 v114, v114, v220
    v_mul_f32 v115, v115, v220
    ds_read_b128 v[184:187], v31 offset:2048
    v_mul_f32 v116, v116, v220
    v_mfma_f32_32x32x16_bf16 v[96:111], a[84:87], v[212:215], v[96:111]
    v_mul_f32 v117, v117, v220
    ds_read_b128 v[188:191], v31 offset:3072
    v_mul_f32 v118, v118, v220
    s_waitcnt vmcnt(25)
    ds_write_b128 v26, v[244:247] offset:13312
    buffer_load_dwordx4 a[188:191], v23, s[32:35], s58 offen nt
    s_add_u32 s58, s58, 16384
    v_mul_f32 v119, v119, v220
    v_mul_f32 v120, v120, v220
    v_mul_f32 v121, v121, v220
    v_mul_f32 v122, v122, v220
    v_mul_f32 v123, v123, v220
    v_mul_f32 v124, v124, v220
    v_mul_f32 v125, v125, v220
    v_mul_f32 v126, v126, v220
    v_mul_f32 v127, v127, v220
    s_nop 1
    v_mfma_f32_32x32x16_bf16 v[112:127], a[88:91], v[208:211], v[112:127]
    v_add_f32 v192, v192, v200
    v_add_f32 v193, v193, v201
    v_add_f32 v194, v194, v202
    v_add_f32 v195, v195, v203
    s_waitcnt vmcnt(25)
    ds_write_b128 v26, v[248:251] offset:14336
    v_add_f32 v196, v196, v204
    v_add_f32 v197, v197, v205
    v_add_f32 v198, v198, v206
    v_add_f32 v199, v199, v207
    v_mfma_f32_32x32x16_bf16 v[112:127], a[92:95], v[212:215], v[112:127]
    v_add_f32 v192, v192, v196
    v_add_f32 v193, v193, v197
    v_add_f32 v194, v194, v198
    s_waitcnt vmcnt(24)
    ds_write_b128 v26, v[252:255] offset:15360
    v_add_f32 v195, v195, v199
    v_add_f32 v192, v192, v193
    v_add_f32 v194, v194, v195
    v_add_f32 v192, v192, v194
    v_add_f32 v217, v217, v192
    ds_read_b128 a[32:35], v32 offset:8192
    ds_read_b128 a[36:39], v33 offset:8192
    ds_read_b128 a[40:43], v34 offset:8192
    ds_read_b128 a[44:47], v35 offset:8192
    ds_read_b128 a[48:51], v36 offset:8192
    ds_read_b128 a[52:55], v37 offset:8192
    ds_read_b128 a[56:59], v38 offset:8192
    ds_read_b128 a[60:63], v39 offset:8192
    s_waitcnt lgkmcnt(8)
    v_add_f32 v144, v144, v128
    v_add_f32 v145, v145, v129
    v_add_f32 v146, v146, v130
    v_add_f32 v147, v147, v131
    buffer_load_dwordx4 a[192:195], v20, s[32:35], s58 offen nt
    v_add_f32 v148, v148, v132
    v_add_f32 v149, v149, v133
    v_add_f32 v150, v150, v134
    v_add_f32 v151, v151, v135
    v_add_f32 v152, v152, v136
    v_add_f32 v153, v153, v137
    v_add_f32 v154, v154, v138
    v_add_f32 v155, v155, v139
    v_add_f32 v156, v156, v140
    v_add_f32 v157, v157, v141
    v_add_f32 v158, v158, v142
    v_add_f32 v159, v159, v143
    s_waitcnt lgkmcnt(0)
    v_mfma_f32_32x32x16_bf16 v[128:143], a[32:35], a[0:3], 0
    ds_read_b64_tr_b16 a[64:65], v40 offset:0
    ds_read_b64_tr_b16 a[66:67], v41 offset:2048
    v_add_f32 v160, v160, v176
    v_add_f32 v161, v161, v177
    v_add_f32 v162, v162, v178
    v_add_f32 v163, v163, v179
    v_add_f32 v164, v164, v180
    v_mfma_f32_32x32x16_bf16 v[128:143], a[36:39], a[4:7], v[128:143]
    ds_read_b64_tr_b16 a[72:73], v42 offset:0
    ds_read_b64_tr_b16 a[74:75], v43 offset:2048
    v_add_f32 v165, v165, v181
    v_add_f32 v166, v166, v182
    v_add_f32 v167, v167, v183
    v_add_f32 v168, v168, v184
    v_add_f32 v169, v169, v185
    v_mfma_f32_32x32x16_bf16 v[128:143], a[40:43], a[8:11], v[128:143]
    ds_read_b64_tr_b16 a[80:81], v44 offset:0
    ds_read_b64_tr_b16 a[82:83], v45 offset:2048
    v_add_f32 v170, v170, v186
    v_add_f32 v171, v171, v187
    v_add_f32 v172, v172, v188
    v_add_f32 v173, v173, v189
    v_add_f32 v174, v174, v190
    v_mfma_f32_32x32x16_bf16 v[128:143], a[44:47], a[12:15], v[128:143]
    ds_read_b64_tr_b16 a[88:89], v46 offset:0
    ds_read_b64_tr_b16 a[90:91], v47 offset:2048
    v_add_f32 v175, v175, v191
    v_add_f32 v144, v144, v160
    v_add_f32 v145, v145, v161
    v_add_f32 v146, v146, v162
    v_add_f32 v147, v147, v163
    v_mfma_f32_32x32x16_bf16 v[128:143], a[48:51], a[16:19], v[128:143]
    ds_read_b64_tr_b16 a[68:69], v40 offset:4096
    ds_read_b64_tr_b16 a[70:71], v41 offset:6144
    v_add_f32 v148, v148, v164
    v_add_f32 v149, v149, v165
    v_add_f32 v150, v150, v166
    v_add_f32 v151, v151, v167
    v_add_f32 v152, v152, v168
    v_mfma_f32_32x32x16_bf16 v[128:143], a[52:55], a[20:23], v[128:143]
    ds_read_b64_tr_b16 a[76:77], v42 offset:4096
    ds_read_b64_tr_b16 a[78:79], v43 offset:6144
    v_add_f32 v153, v153, v169
    v_add_f32 v154, v154, v170
    v_add_f32 v155, v155, v171
    v_add_f32 v156, v156, v172
    v_add_f32 v157, v157, v173
    v_mfma_f32_32x32x16_bf16 v[128:143], a[56:59], a[24:27], v[128:143]
    ds_read_b64_tr_b16 a[84:85], v44 offset:4096
    ds_read_b64_tr_b16 a[86:87], v45 offset:6144
    v_add_f32 v158, v158, v174
    v_add_f32 v159, v159, v175
    v_max3_f32 v218, v144, v145, v146
    v_max3_f32 v219, v147, v148, v149
    v_max3_f32 v220, v150, v151, v152
    v_mfma_f32_32x32x16_bf16 v[128:143], a[60:63], a[28:31], v[128:143]
    ds_read_b64_tr_b16 a[92:93], v46 offset:4096
    ds_read_b64_tr_b16 a[94:95], v47 offset:6144
    v_max3_f32 v221, v153, v154, v155
    v_max3_f32 v218, v218, v156, v157
    v_max3_f32 v219, v219, v158, v159
    v_max3_f32 v218, v218, v219, v220
    v_max_f32 v218, v218, v221
    v_mov_b32 v219, v218
    s_nop 1
    v_permlane32_swap_b32 v218, v219
    v_max3_f32 v218, v218, v219, v216
    v_sub_f32 v220, v216, v218
    v_mov_b32 v216, v218
    v_exp_f32 v220, v220
    v_sub_f32 v192, v144, v218
    v_sub_f32 v193, v145, v218
    buffer_load_dwordx4 a[196:199], v21, s[32:35], s58 offen nt
    v_sub_f32 v194, v146, v218
    v_sub_f32 v195, v147, v218
    v_sub_f32 v196, v148, v218
    v_sub_f32 v197, v149, v218
    v_sub_f32 v198, v150, v218
    buffer_load_dwordx4 a[200:203], v22, s[32:35], s58 offen nt
    v_sub_f32 v199, v151, v218
    v_sub_f32 v200, v152, v218
    v_sub_f32 v201, v153, v218
    v_sub_f32 v202, v154, v218
    v_sub_f32 v203, v155, v218
    v_sub_f32 v204, v156, v218
    v_sub_f32 v205, v157, v218
    v_sub_f32 v206, v158, v218
    v_sub_f32 v207, v159, v218
    ds_write_b128 v28, v[128:131] offset:16384
    v_exp_f32 v192, v192
    v_exp_f32 v193, v193
    v_exp_f32 v194, v194
    v_exp_f32 v195, v195
    ds_write_b128 v28, v[132:135] offset:17408
    v_exp_f32 v196, v196
    v_exp_f32 v197, v197
    v_exp_f32 v198, v198
    v_exp_f32 v199, v199
    ds_write_b128 v28, v[136:139] offset:18432
    v_exp_f32 v200, v200
    v_exp_f32 v201, v201
    v_exp_f32 v202, v202
    v_exp_f32 v203, v203
    ds_write_b128 v28, v[140:143] offset:19456
    v_exp_f32 v204, v204
    v_exp_f32 v205, v205
    v_exp_f32 v206, v206
    v_exp_f32 v207, v207
    v_mul_f32 v217, v217, v220
    v_cvt_pk_bf16_f32 v208, v192, v193
    v_cvt_pk_bf16_f32 v209, v194, v195
    v_cvt_pk_bf16_f32 v210, v196, v197
    v_cvt_pk_bf16_f32 v211, v198, v199
    v_cvt_pk_bf16_f32 v212, v200, v201
    v_cvt_pk_bf16_f32 v213, v202, v203
    v_cvt_pk_bf16_f32 v214, v204, v205
    v_cvt_pk_bf16_f32 v215, v206, v207
    v_mul_f32 v64, v64, v220
    v_mul_f32 v65, v65, v220
    v_mul_f32 v66, v66, v220
    v_mul_f32 v67, v67, v220
    v_mul_f32 v68, v68, v220
    v_mul_f32 v69, v69, v220
    v_mul_f32 v70, v70, v220
    v_mul_f32 v71, v71, v220
    v_mul_f32 v72, v72, v220
    v_mul_f32 v73, v73, v220
    v_mul_f32 v74, v74, v220
    v_mul_f32 v75, v75, v220
    v_mul_f32 v76, v76, v220
    v_mul_f32 v77, v77, v220
    v_mul_f32 v78, v78, v220
    v_mul_f32 v79, v79, v220
    s_waitcnt lgkmcnt(0)
    s_barrier
    v_mfma_f32_32x32x16_bf16 v[64:79], a[64:67], v[208:211], v[64:79]
    ds_read_b128 v[144:147], v29 offset:16384
    v_mul_f32 v80, v80, v220
    v_mul_f32 v81, v81, v220
    ds_read_b128 v[148:151], v29 offset:17408
    s_waitcnt vmcnt(26)
    ds_write_b128 v26, a[96:99] offset:16384
    buffer_load_dwordx4 a[204:207], v23, s[32:35], s58 offen nt
    s_add_u32 s58, s58, 16384
    v_mul_f32 v82, v82, v220
    v_mul_f32 v83, v83, v220
    ds_read_b128 v[152:155], v29 offset:18432
    v_mul_f32 v84, v84, v220
    v_mfma_f32_32x32x16_bf16 v[64:79], a[68:71], v[212:215], v[64:79]
    v_mul_f32 v85, v85, v220
    ds_read_b128 v[156:159], v29 offset:19456
    v_mul_f32 v86, v86, v220
    s_waitcnt vmcnt(26)
    ds_write_b128 v26, a[100:103] offset:17408
    v_mul_f32 v87, v87, v220
    v_mul_f32 v88, v88, v220
    v_mul_f32 v89, v89, v220
    v_mul_f32 v90, v90, v220
    v_mul_f32 v91, v91, v220
    v_mul_f32 v92, v92, v220
    v_mul_f32 v93, v93, v220
    v_mul_f32 v94, v94, v220
    v_mul_f32 v95, v95, v220
    s_nop 1
    v_mfma_f32_32x32x16_bf16 v[80:95], a[72:75], v[208:211], v[80:95]
    ds_read_b128 v[160:163], v30 offset:16384
    v_mul_f32 v96, v96, v220
    v_mul_f32 v97, v97, v220
    ds_read_b128 v[164:167], v30 offset:17408
    s_waitcnt vmcnt(25)
    ds_write_b128 v26, a[104:107] offset:18432
    buffer_load_dwordx4 a[208:211], v20, s[32:35], s58 offen nt
    v_mul_f32 v98, v98, v220
    v_mul_f32 v99, v99, v220
    ds_read_b128 v[168:171], v30 offset:18432
    v_mul_f32 v100, v100, v220
    v_mfma_f32_32x32x16_bf16 v[80:95], a[76:79], v[212:215], v[80:95]
    v_mul_f32 v101, v101, v220
    ds_read_b128 v[172:175], v30 offset:19456
    v_mul_f32 v102, v102, v220
    s_waitcnt vmcnt(25)
    ds_write_b128 v26, a[108:111] offset:19456
    v_mul_f32 v103, v103, v220
    v_mul_f32 v104, v104, v220
    v_mul_f32 v105, v105, v220
    v_mul_f32 v106, v106, v220
    v_mul_f32 v107, v107, v220
    v_mul_f32 v108, v108, v220
    v_mul_f32 v109, v109, v220
    v_mul_f32 v110, v110, v220
    v_mul_f32 v111, v111, v220
    s_nop 1
    v_mfma_f32_32x32x16_bf16 v[96:111], a[80:83], v[208:211], v[96:111]
    ds_read_b128 v[176:179], v31 offset:16384
    v_mul_f32 v112, v112, v220
    v_mul_f32 v113, v113, v220
    ds_read_b128 v[180:183], v31 offset:17408
    s_waitcnt vmcnt(24)
    ds_write_b128 v26, a[112:115] offset:20480
    v_mul_f32 v114, v114, v220
    v_mul_f32 v115, v115, v220
    ds_read_b128 v[184:187], v31 offset:18432
    v_mul_f32 v116, v116, v220
    v_mfma_f32_32x32x16_bf16 v[96:111], a[84:87], v[212:215], v[96:111]
    v_mul_f32 v117, v117, v220
    ds_read_b128 v[188:191], v31 offset:19456
    v_mul_f32 v118, v118, v220
    s_waitcnt vmcnt(23)
    ds_write_b128 v26, a[116:119] offset:21504
    buffer_load_dwordx4 a[212:215], v21, s[32:35], s58 offen nt
    v_mul_f32 v119, v119, v220
    v_mul_f32 v120, v120, v220
    v_mul_f32 v121, v121, v220
    v_mul_f32 v122, v122, v220
    v_mul_f32 v123, v123, v220
    v_mul_f32 v124, v124, v220
    v_mul_f32 v125, v125, v220
    v_mul_f32 v126, v126, v220
    v_mul_f32 v127, v127, v220
    s_nop 1
    v_mfma_f32_32x32x16_bf16 v[112:127], a[88:91], v[208:211], v[112:127]
    v_add_f32 v192, v192, v200
    v_add_f32 v193, v193, v201
    v_add_f32 v194, v194, v202
    v_add_f32 v195, v195, v203
    s_waitcnt vmcnt(23)
    ds_write_b128 v26, a[120:123] offset:22528
    v_add_f32 v196, v196, v204
    v_add_f32 v197, v197, v205
    v_add_f32 v198, v198, v206
    v_add_f32 v199, v199, v207
    v_mfma_f32_32x32x16_bf16 v[112:127], a[92:95], v[212:215], v[112:127]
    v_add_f32 v192, v192, v196
    v_add_f32 v193, v193, v197
    v_add_f32 v194, v194, v198
    s_waitcnt vmcnt(22)
    ds_write_b128 v26, a[124:127] offset:23552
    v_add_f32 v195, v195, v199
    v_add_f32 v192, v192, v193
    v_add_f32 v194, v194, v195
    v_add_f32 v192, v192, v194
    v_add_f32 v217, v217, v192
    ds_read_b128 a[32:35], v32 offset:16384
    ds_read_b128 a[36:39], v33 offset:16384
    ds_read_b128 a[40:43], v34 offset:16384
    ds_read_b128 a[44:47], v35 offset:16384
    ds_read_b128 a[48:51], v36 offset:16384
    ds_read_b128 a[52:55], v37 offset:16384
    ds_read_b128 a[56:59], v38 offset:16384
    ds_read_b128 a[60:63], v39 offset:16384
    s_waitcnt lgkmcnt(8)
    v_add_f32 v144, v144, v128
    v_add_f32 v145, v145, v129
    v_add_f32 v146, v146, v130
    v_add_f32 v147, v147, v131
    buffer_load_dwordx4 a[216:219], v22, s[32:35], s58 offen nt
    v_add_f32 v148, v148, v132
    v_add_f32 v149, v149, v133
    v_add_f32 v150, v150, v134
    v_add_f32 v151, v151, v135
    v_add_f32 v152, v152, v136
    v_add_f32 v153, v153, v137
    v_add_f32 v154, v154, v138
    v_add_f32 v155, v155, v139
    v_add_f32 v156, v156, v140
    v_add_f32 v157, v157, v141
    v_add_f32 v158, v158, v142
    v_add_f32 v159, v159, v143
    s_waitcnt lgkmcnt(0)
    v_mfma_f32_32x32x16_bf16 v[128:143], a[32:35], a[0:3], 0
    ds_read_b64_tr_b16 a[64:65], v40 offset:8192
    ds_read_b64_tr_b16 a[66:67], v41 offset:10240
    v_add_f32 v160, v160, v176
    v_add_f32 v161, v161, v177
    v_add_f32 v162, v162, v178
    v_add_f32 v163, v163, v179
    v_add_f32 v164, v164, v180
    v_mfma_f32_32x32x16_bf16 v[128:143], a[36:39], a[4:7], v[128:143]
    ds_read_b64_tr_b16 a[72:73], v42 offset:8192
    ds_read_b64_tr_b16 a[74:75], v43 offset:10240
    v_add_f32 v165, v165, v181
    v_add_f32 v166, v166, v182
    v_add_f32 v167, v167, v183
    v_add_f32 v168, v168, v184
    v_add_f32 v169, v169, v185
    v_mfma_f32_32x32x16_bf16 v[128:143], a[40:43], a[8:11], v[128:143]
    ds_read_b64_tr_b16 a[80:81], v44 offset:8192
    ds_read_b64_tr_b16 a[82:83], v45 offset:10240
    v_add_f32 v170, v170, v186
    v_add_f32 v171, v171, v187
    v_add_f32 v172, v172, v188
    v_add_f32 v173, v173, v189
    v_add_f32 v174, v174, v190
    v_mfma_f32_32x32x16_bf16 v[128:143], a[44:47], a[12:15], v[128:143]
    ds_read_b64_tr_b16 a[88:89], v46 offset:8192
    ds_read_b64_tr_b16 a[90:91], v47 offset:10240
    v_add_f32 v175, v175, v191
    v_add_f32 v144, v144, v160
    v_add_f32 v145, v145, v161
    v_add_f32 v146, v146, v162
    v_add_f32 v147, v147, v163
    v_mfma_f32_32x32x16_bf16 v[128:143], a[48:51], a[16:19], v[128:143]
    ds_read_b64_tr_b16 a[68:69], v40 offset:12288
    ds_read_b64_tr_b16 a[70:71], v41 offset:14336
    v_add_f32 v148, v148, v164
    v_add_f32 v149, v149, v165
    v_add_f32 v150, v150, v166
    v_add_f32 v151, v151, v167
    v_add_f32 v152, v152, v168
    v_mfma_f32_32x32x16_bf16 v[128:143], a[52:55], a[20:23], v[128:143]
    ds_read_b64_tr_b16 a[76:77], v42 offset:12288
    ds_read_b64_tr_b16 a[78:79], v43 offset:14336
    v_add_f32 v153, v153, v169
    v_add_f32 v154, v154, v170
    v_add_f32 v155, v155, v171
    v_add_f32 v156, v156, v172
    v_add_f32 v157, v157, v173
    v_mfma_f32_32x32x16_bf16 v[128:143], a[56:59], a[24:27], v[128:143]
    ds_read_b64_tr_b16 a[84:85], v44 offset:12288
    ds_read_b64_tr_b16 a[86:87], v45 offset:14336
    v_add_f32 v158, v158, v174
    v_add_f32 v159, v159, v175
    v_max3_f32 v218, v144, v145, v146
    v_max3_f32 v219, v147, v148, v149
    v_max3_f32 v220, v150, v151, v152
    v_mfma_f32_32x32x16_bf16 v[128:143], a[60:63], a[28:31], v[128:143]
    ds_read_b64_tr_b16 a[92:93], v46 offset:12288
    ds_read_b64_tr_b16 a[94:95], v47 offset:14336
    v_max3_f32 v221, v153, v154, v155
    v_max3_f32 v218, v218, v156, v157
    v_max3_f32 v219, v219, v158, v159
    v_max3_f32 v218, v218, v219, v220
    v_max_f32 v218, v218, v221
    v_mov_b32 v219, v218
    s_nop 1
    v_permlane32_swap_b32 v218, v219
    v_max3_f32 v218, v218, v219, v216
    v_sub_f32 v220, v216, v218
    v_mov_b32 v216, v218
    v_exp_f32 v220, v220
    v_sub_f32 v192, v144, v218
    v_sub_f32 v193, v145, v218
    buffer_load_dwordx4 a[220:223], v23, s[32:35], s58 offen nt
    s_add_u32 s58, s58, 16384
    v_sub_f32 v194, v146, v218
    v_sub_f32 v195, v147, v218
    v_sub_f32 v196, v148, v218
    v_sub_f32 v197, v149, v218
    v_sub_f32 v198, v150, v218
    buffer_load_dwordx4 a[224:227], v20, s[32:35], s58 offen nt
    v_sub_f32 v199, v151, v218
    v_sub_f32 v200, v152, v218
    v_sub_f32 v201, v153, v218
    v_sub_f32 v202, v154, v218
    v_sub_f32 v203, v155, v218
    v_sub_f32 v204, v156, v218
    v_sub_f32 v205, v157, v218
    v_sub_f32 v206, v158, v218
    v_sub_f32 v207, v159, v218
    ds_write_b128 v28, v[128:131] offset:0
    v_exp_f32 v192, v192
    v_exp_f32 v193, v193
    v_exp_f32 v194, v194
    v_exp_f32 v195, v195
    ds_write_b128 v28, v[132:135] offset:1024
    v_exp_f32 v196, v196
    v_exp_f32 v197, v197
    v_exp_f32 v198, v198
    v_exp_f32 v199, v199
    ds_write_b128 v28, v[136:139] offset:2048
    v_exp_f32 v200, v200
    v_exp_f32 v201, v201
    v_exp_f32 v202, v202
    v_exp_f32 v203, v203
    ds_write_b128 v28, v[140:143] offset:3072
    v_exp_f32 v204, v204
    v_exp_f32 v205, v205
    v_exp_f32 v206, v206
    v_exp_f32 v207, v207
    v_mul_f32 v217, v217, v220
    v_cvt_pk_bf16_f32 v208, v192, v193
    v_cvt_pk_bf16_f32 v209, v194, v195
    v_cvt_pk_bf16_f32 v210, v196, v197
    v_cvt_pk_bf16_f32 v211, v198, v199
    v_cvt_pk_bf16_f32 v212, v200, v201
    v_cvt_pk_bf16_f32 v213, v202, v203
    v_cvt_pk_bf16_f32 v214, v204, v205
    v_cvt_pk_bf16_f32 v215, v206, v207
    v_mul_f32 v64, v64, v220
    v_mul_f32 v65, v65, v220
    v_mul_f32 v66, v66, v220
    v_mul_f32 v67, v67, v220
    v_mul_f32 v68, v68, v220
    v_mul_f32 v69, v69, v220
    v_mul_f32 v70, v70, v220
    v_mul_f32 v71, v71, v220
    v_mul_f32 v72, v72, v220
    v_mul_f32 v73, v73, v220
    v_mul_f32 v74, v74, v220
    v_mul_f32 v75, v75, v220
    v_mul_f32 v76, v76, v220
    v_mul_f32 v77, v77, v220
    v_mul_f32 v78, v78, v220
    v_mul_f32 v79, v79, v220
    s_waitcnt lgkmcnt(0)
    s_barrier
    v_mfma_f32_32x32x16_bf16 v[64:79], a[64:67], v[208:211], v[64:79]
    ds_read_b128 v[144:147], v29 offset:0
    v_mul_f32 v80, v80, v220
    v_mul_f32 v81, v81, v220
    ds_read_b128 v[148:151], v29 offset:1024
    s_waitcnt vmcnt(24)
    ds_write_b128 v26, a[128:131] offset:24576
    buffer_load_dwordx4 a[228:231], v21, s[32:35], s58 offen nt
    v_mul_f32 v82, v82, v220
    v_mul_f32 v83, v83, v220
    ds_read_b128 v[152:155], v29 offset:2048
    v_mul_f32 v84, v84, v220
    v_mfma_f32_32x32x16_bf16 v[64:79], a[68:71], v[212:215], v[64:79]
    v_mul_f32 v85, v85, v220
    ds_read_b128 v[156:159], v29 offset:3072
    v_mul_f32 v86, v86, v220
    s_waitcnt vmcnt(24)
    ds_write_b128 v26, a[132:135] offset:25600
    v_mul_f32 v87, v87, v220
    v_mul_f32 v88, v88, v220
    v_mul_f32 v89, v89, v220
    v_mul_f32 v90, v90, v220
    v_mul_f32 v91, v91, v220
    v_mul_f32 v92, v92, v220
    v_mul_f32 v93, v93, v220
    v_mul_f32 v94, v94, v220
    v_mul_f32 v95, v95, v220
    s_nop 1
    v_mfma_f32_32x32x16_bf16 v[80:95], a[72:75], v[208:211], v[80:95]
    ds_read_b128 v[160:163], v30 offset:0
    v_mul_f32 v96, v96, v220
    v_mul_f32 v97, v97, v220
    ds_read_b128 v[164:167], v30 offset:1024
    s_waitcnt vmcnt(23)
    ds_write_b128 v26, a[136:139] offset:26624
    buffer_load_dwordx4 a[232:235], v22, s[32:35], s58 offen nt
    v_mul_f32 v98, v98, v220
    v_mul_f32 v99, v99, v220
    ds_read_b128 v[168:171], v30 offset:2048
    v_mul_f32 v100, v100, v220
    v_mfma_f32_32x32x16_bf16 v[80:95], a[76:79], v[212:215], v[80:95]
    v_mul_f32 v101, v101, v220
    ds_read_b128 v[172:175], v30 offset:3072
    v_mul_f32 v102, v102, v220
    s_waitcnt vmcnt(23)
    ds_write_b128 v26, a[140:143] offset:27648
    v_mul_f32 v103, v103, v220
    v_mul_f32 v104, v104, v220
    v_mul_f32 v105, v105, v220
    v_mul_f32 v106, v106, v220
    v_mul_f32 v107, v107, v220
    v_mul_f32 v108, v108, v220
    v_mul_f32 v109, v109, v220
    v_mul_f32 v110, v110, v220
    v_mul_f32 v111, v111, v220
    s_nop 1
    v_mfma_f32_32x32x16_bf16 v[96:111], a[80:83], v[208:211], v[96:111]
    ds_read_b128 v[176:179], v31 offset:0
    v_mul_f32 v112, v112, v220
    v_mul_f32 v113, v113, v220
    ds_read_b128 v[180:183], v31 offset:1024
    s_waitcnt vmcnt(22)
    ds_write_b128 v26, a[144:147] offset:28672
    v_mul_f32 v114, v114, v220
    v_mul_f32 v115, v115, v220
    ds_read_b128 v[184:187], v31 offset:2048
    v_mul_f32 v116, v116, v220
    v_mfma_f32_32x32x16_bf16 v[96:111], a[84:87], v[212:215], v[96:111]
    v_mul_f32 v117, v117, v220
    ds_read_b128 v[188:191], v31 offset:3072
    v_mul_f32 v118, v118, v220
    s_waitcnt vmcnt(21)
    ds_write_b128 v26, a[148:151] offset:29696
    buffer_load_dwordx4 a[236:239], v23, s[32:35], s58 offen nt
    s_add_u32 s58, s58, 16384
    v_mul_f32 v119, v119, v220
    v_mul_f32 v120, v120, v220
    v_mul_f32 v121, v121, v220
    v_mul_f32 v122, v122, v220
    v_mul_f32 v123, v123, v220
    v_mul_f32 v124, v124, v220
    v_mul_f32 v125, v125, v220
    v_mul_f32 v126, v126, v220
    v_mul_f32 v127, v127, v220
    s_nop 1
    v_mfma_f32_32x32x16_bf16 v[112:127], a[88:91], v[208:211], v[112:127]
    v_add_f32 v192, v192, v200
    v_add_f32 v193, v193, v201
    v_add_f32 v194, v194, v202
    v_add_f32 v195, v195, v203
    s_waitcnt vmcnt(21)
    ds_write_b128 v26, a[152:155] offset:30720
    v_add_f32 v196, v196, v204
    v_add_f32 v197, v197, v205
    v_add_f32 v198, v198, v206
    v_add_f32 v199, v199, v207
    v_mfma_f32_32x32x16_bf16 v[112:127], a[92:95], v[212:215], v[112:127]
    v_add_f32 v192, v192, v196
    v_add_f32 v193, v193, v197
    v_add_f32 v194, v194, v198
    s_waitcnt vmcnt(20)
    ds_write_b128 v26, a[156:159] offset:31744
    v_add_f32 v195, v195, v199
    v_add_f32 v192, v192, v193
    v_add_f32 v194, v194, v195
    v_add_f32 v192, v192, v194
    v_add_f32 v217, v217, v192
    ds_read_b128 a[32:35], v32 offset:24576
    ds_read_b128 a[36:39], v33 offset:24576
    ds_read_b128 a[40:43], v34 offset:24576
    ds_read_b128 a[44:47], v35 offset:24576
    ds_read_b128 a[48:51], v36 offset:24576
    ds_read_b128 a[52:55], v37 offset:24576
    ds_read_b128 a[56:59], v38 offset:24576
    ds_read_b128 a[60:63], v39 offset:24576
    s_waitcnt lgkmcnt(8)
    v_add_f32 v144, v144, v128
    v_add_f32 v145, v145, v129
    v_add_f32 v146, v146, v130
    v_add_f32 v147, v147, v131
    buffer_load_dwordx4 a[240:243], v20, s[32:35], s58 offen nt
    v_add_f32 v148, v148, v132
    v_add_f32 v149, v149, v133
    v_add_f32 v150, v150, v134
    v_add_f32 v151, v151, v135
    v_add_f32 v152, v152, v136
    v_add_f32 v153, v153, v137
    v_add_f32 v154, v154, v138
    v_add_f32 v155, v155, v139
    v_add_f32 v156, v156, v140
    v_add_f32 v157, v157, v141
    v_add_f32 v158, v158, v142
    v_add_f32 v159, v159, v143
    s_waitcnt lgkmcnt(0)
    v_mfma_f32_32x32x16_bf16 v[128:143], a[32:35], a[0:3], 0
    ds_read_b64_tr_b16 a[64:65], v40 offset:16384
    ds_read_b64_tr_b16 a[66:67], v41 offset:18432
    v_add_f32 v160, v160, v176
    v_add_f32 v161, v161, v177
    v_add_f32 v162, v162, v178
    v_add_f32 v163, v163, v179
    v_add_f32 v164, v164, v180
    v_mfma_f32_32x32x16_bf16 v[128:143], a[36:39], a[4:7], v[128:143]
    ds_read_b64_tr_b16 a[72:73], v42 offset:16384
    ds_read_b64_tr_b16 a[74:75], v43 offset:18432
    v_add_f32 v165, v165, v181
    v_add_f32 v166, v166, v182
    v_add_f32 v167, v167, v183
    v_add_f32 v168, v168, v184
    v_add_f32 v169, v169, v185
    v_mfma_f32_32x32x16_bf16 v[128:143], a[40:43], a[8:11], v[128:143]
    ds_read_b64_tr_b16 a[80:81], v44 offset:16384
    ds_read_b64_tr_b16 a[82:83], v45 offset:18432
    v_add_f32 v170, v170, v186
    v_add_f32 v171, v171, v187
    v_add_f32 v172, v172, v188
    v_add_f32 v173, v173, v189
    v_add_f32 v174, v174, v190
    v_mfma_f32_32x32x16_bf16 v[128:143], a[44:47], a[12:15], v[128:143]
    ds_read_b64_tr_b16 a[88:89], v46 offset:16384
    ds_read_b64_tr_b16 a[90:91], v47 offset:18432
    v_add_f32 v175, v175, v191
    v_add_f32 v144, v144, v160
    v_add_f32 v145, v145, v161
    v_add_f32 v146, v146, v162
    v_add_f32 v147, v147, v163
    v_mfma_f32_32x32x16_bf16 v[128:143], a[48:51], a[16:19], v[128:143]
    ds_read_b64_tr_b16 a[68:69], v40 offset:20480
    ds_read_b64_tr_b16 a[70:71], v41 offset:22528
    v_add_f32 v148, v148, v164
    v_add_f32 v149, v149, v165
    v_add_f32 v150, v150, v166
    v_add_f32 v151, v151, v167
    v_add_f32 v152, v152, v168
    v_mfma_f32_32x32x16_bf16 v[128:143], a[52:55], a[20:23], v[128:143]
    ds_read_b64_tr_b16 a[76:77], v42 offset:20480
    ds_read_b64_tr_b16 a[78:79], v43 offset:22528
    v_add_f32 v153, v153, v169
    v_add_f32 v154, v154, v170
    v_add_f32 v155, v155, v171
    v_add_f32 v156, v156, v172
    v_add_f32 v157, v157, v173
    v_mfma_f32_32x32x16_bf16 v[128:143], a[56:59], a[24:27], v[128:143]
    ds_read_b64_tr_b16 a[84:85], v44 offset:20480
    ds_read_b64_tr_b16 a[86:87], v45 offset:22528
    v_add_f32 v158, v158, v174
    v_add_f32 v159, v159, v175
    v_max3_f32 v218, v144, v145, v146
    v_max3_f32 v219, v147, v148, v149
    v_max3_f32 v220, v150, v151, v152
    v_mfma_f32_32x32x16_bf16 v[128:143], a[60:63], a[28:31], v[128:143]
    ds_read_b64_tr_b16 a[92:93], v46 offset:20480
    ds_read_b64_tr_b16 a[94:95], v47 offset:22528
    v_max3_f32 v221, v153, v154, v155
    v_max3_f32 v218, v218, v156, v157
    v_max3_f32 v219, v219, v158, v159
    v_max3_f32 v218, v218, v219, v220
    v_max_f32 v218, v218, v221
    v_mov_b32 v219, v218
    s_nop 1
    v_permlane32_swap_b32 v218, v219
    v_max3_f32 v218, v218, v219, v216
    v_sub_f32 v220, v216, v218
    v_mov_b32 v216, v218
    v_exp_f32 v220, v220
    v_sub_f32 v192, v144, v218
    v_sub_f32 v193, v145, v218
    buffer_load_dwordx4 a[244:247], v21, s[32:35], s58 offen nt
    v_sub_f32 v194, v146, v218
    v_sub_f32 v195, v147, v218
    v_sub_f32 v196, v148, v218
    v_sub_f32 v197, v149, v218
    v_sub_f32 v198, v150, v218
    buffer_load_dwordx4 a[248:251], v22, s[32:35], s58 offen nt
    v_sub_f32 v199, v151, v218
    v_sub_f32 v200, v152, v218
    v_sub_f32 v201, v153, v218
    v_sub_f32 v202, v154, v218
    v_sub_f32 v203, v155, v218
    v_sub_f32 v204, v156, v218
    v_sub_f32 v205, v157, v218
    v_sub_f32 v206, v158, v218
    v_sub_f32 v207, v159, v218
    ds_write_b128 v28, v[128:131] offset:16384
    v_exp_f32 v192, v192
    v_exp_f32 v193, v193
    v_exp_f32 v194, v194
    v_exp_f32 v195, v195
    ds_write_b128 v28, v[132:135] offset:17408
    v_exp_f32 v196, v196
    v_exp_f32 v197, v197
    v_exp_f32 v198, v198
    v_exp_f32 v199, v199
    ds_write_b128 v28, v[136:139] offset:18432
    v_exp_f32 v200, v200
    v_exp_f32 v201, v201
    v_exp_f32 v202, v202
    v_exp_f32 v203, v203
    ds_write_b128 v28, v[140:143] offset:19456
    v_exp_f32 v204, v204
    v_exp_f32 v205, v205
    v_exp_f32 v206, v206
    v_exp_f32 v207, v207
    v_mul_f32 v217, v217, v220
    v_cvt_pk_bf16_f32 v208, v192, v193
    v_cvt_pk_bf16_f32 v209, v194, v195
    v_cvt_pk_bf16_f32 v210, v196, v197
    v_cvt_pk_bf16_f32 v211, v198, v199
    v_cvt_pk_bf16_f32 v212, v200, v201
    v_cvt_pk_bf16_f32 v213, v202, v203
    v_cvt_pk_bf16_f32 v214, v204, v205
    v_cvt_pk_bf16_f32 v215, v206, v207
    v_mul_f32 v64, v64, v220
    v_mul_f32 v65, v65, v220
    v_mul_f32 v66, v66, v220
    v_mul_f32 v67, v67, v220
    v_mul_f32 v68, v68, v220
    v_mul_f32 v69, v69, v220
    v_mul_f32 v70, v70, v220
    v_mul_f32 v71, v71, v220
    v_mul_f32 v72, v72, v220
    v_mul_f32 v73, v73, v220
    v_mul_f32 v74, v74, v220
    v_mul_f32 v75, v75, v220
    v_mul_f32 v76, v76, v220
    v_mul_f32 v77, v77, v220
    v_mul_f32 v78, v78, v220
    v_mul_f32 v79, v79, v220
    s_waitcnt lgkmcnt(0)
    s_barrier
    v_mfma_f32_32x32x16_bf16 v[64:79], a[64:67], v[208:211], v[64:79]
    ds_read_b128 v[144:147], v29 offset:16384
    v_mul_f32 v80, v80, v220
    v_mul_f32 v81, v81, v220
    ds_read_b128 v[148:151], v29 offset:17408
    s_waitcnt vmcnt(22)
    ds_write_b128 v26, a[160:163] offset:0
    buffer_load_dwordx4 a[252:255], v23, s[32:35], s58 offen nt
    s_add_u32 s58, s58, 16384
    v_mul_f32 v82, v82, v220
    v_mul_f32 v83, v83, v220
    ds_read_b128 v[152:155], v29 offset:18432
    v_mul_f32 v84, v84, v220
    v_mfma_f32_32x32x16_bf16 v[64:79], a[68:71], v[212:215], v[64:79]
    v_mul_f32 v85, v85, v220
    ds_read_b128 v[156:159], v29 offset:19456
    v_mul_f32 v86, v86, v220
    s_waitcnt vmcnt(22)
    ds_write_b128 v26, a[164:167] offset:1024
    v_mul_f32 v87, v87, v220
    v_mul_f32 v88, v88, v220
    v_mul_f32 v89, v89, v220
    v_mul_f32 v90, v90, v220
    v_mul_f32 v91, v91, v220
    v_mul_f32 v92, v92, v220
    v_mul_f32 v93, v93, v220
    v_mul_f32 v94, v94, v220
    v_mul_f32 v95, v95, v220
    s_nop 1
    v_mfma_f32_32x32x16_bf16 v[80:95], a[72:75], v[208:211], v[80:95]
    ds_read_b128 v[160:163], v30 offset:16384
    v_mul_f32 v96, v96, v220
    v_mul_f32 v97, v97, v220
    ds_read_b128 v[164:167], v30 offset:17408
    s_waitcnt vmcnt(21)
    ds_write_b128 v26, a[168:171] offset:2048
    buffer_load_dwordx4 v[224:227], v20, s[32:35], s58 offen nt
    v_mul_f32 v98, v98, v220
    v_mul_f32 v99, v99, v220
    ds_read_b128 v[168:171], v30 offset:18432
    v_mul_f32 v100, v100, v220
    v_mfma_f32_32x32x16_bf16 v[80:95], a[76:79], v[212:215], v[80:95]
    v_mul_f32 v101, v101, v220
    ds_read_b128 v[172:175], v30 offset:19456
    v_mul_f32 v102, v102, v220
    s_waitcnt vmcnt(21)
    ds_write_b128 v26, a[172:175] offset:3072
    v_mul_f32 v103, v103, v220
    v_mul_f32 v104, v104, v220
    v_mul_f32 v105, v105, v220
    v_mul_f32 v106, v106, v220
    v_mul_f32 v107, v107, v220
    v_mul_f32 v108, v108, v220
    v_mul_f32 v109, v109, v220
    v_mul_f32 v110, v110, v220
    v_mul_f32 v111, v111, v220
    s_nop 1
    v_mfma_f32_32x32x16_bf16 v[96:111], a[80:83], v[208:211], v[96:111]
    ds_read_b128 v[176:179], v31 offset:16384
    v_mul_f32 v112, v112, v220
    v_mul_f32 v113, v113, v220
    ds_read_b128 v[180:183], v31 offset:17408
    s_waitcnt vmcnt(20)
    ds_write_b128 v26, a[176:179] offset:4096
    v_mul_f32 v114, v114, v220
    v_mul_f32 v115, v115, v220
    ds_read_b128 v[184:187], v31 offset:18432
    v_mul_f32 v116, v116, v220
    v_mfma_f32_32x32x16_bf16 v[96:111], a[84:87], v[212:215], v[96:111]
    v_mul_f32 v117, v117, v220
    ds_read_b128 v[188:191], v31 offset:19456
    v_mul_f32 v118, v118, v220
    s_waitcnt vmcnt(19)
    ds_write_b128 v26, a[180:183] offset:5120
    buffer_load_dwordx4 v[228:231], v21, s[32:35], s58 offen nt
    v_mul_f32 v119, v119, v220
    v_mul_f32 v120, v120, v220
    v_mul_f32 v121, v121, v220
    v_mul_f32 v122, v122, v220
    v_mul_f32 v123, v123, v220
    v_mul_f32 v124, v124, v220
    v_mul_f32 v125, v125, v220
    v_mul_f32 v126, v126, v220
    v_mul_f32 v127, v127, v220
    s_nop 1
    v_mfma_f32_32x32x16_bf16 v[112:127], a[88:91], v[208:211], v[112:127]
    v_add_f32 v192, v192, v200
    v_add_f32 v193, v193, v201
    v_add_f32 v194, v194, v202
    v_add_f32 v195, v195, v203
    s_waitcnt vmcnt(19)
    ds_write_b128 v26, a[184:187] offset:6144
    v_add_f32 v196, v196, v204
    v_add_f32 v197, v197, v205
    v_add_f32 v198, v198, v206
    v_add_f32 v199, v199, v207
    v_mfma_f32_32x32x16_bf16 v[112:127], a[92:95], v[212:215], v[112:127]
    v_add_f32 v192, v192, v196
    v_add_f32 v193, v193, v197
    v_add_f32 v194, v194, v198
    s_waitcnt vmcnt(18)
    ds_write_b128 v26, a[188:191] offset:7168
    v_add_f32 v195, v195, v199
    v_add_f32 v192, v192, v193
    v_add_f32 v194, v194, v195
    v_add_f32 v192, v192, v194
    v_add_f32 v217, v217, v192
    ds_read_b128 a[32:35], v32 offset:0
    ds_read_b128 a[36:39], v33 offset:0
    ds_read_b128 a[40:43], v34 offset:0
    ds_read_b128 a[44:47], v35 offset:0
    ds_read_b128 a[48:51], v36 offset:0
    ds_read_b128 a[52:55], v37 offset:0
    ds_read_b128 a[56:59], v38 offset:0
    ds_read_b128 a[60:63], v39 offset:0
    s_waitcnt lgkmcnt(8)
    v_add_f32 v144, v144, v128
    v_add_f32 v145, v145, v129
    v_add_f32 v146, v146, v130
    v_add_f32 v147, v147, v131
    buffer_load_dwordx4 v[232:235], v22, s[32:35], s58 offen nt
    v_add_f32 v148, v148, v132
    v_add_f32 v149, v149, v133
    v_add_f32 v150, v150, v134
    v_add_f32 v151, v151, v135
    v_add_f32 v152, v152, v136
    v_add_f32 v153, v153, v137
    v_add_f32 v154, v154, v138
    v_add_f32 v155, v155, v139
    v_add_f32 v156, v156, v140
    v_add_f32 v157, v157, v141
    v_add_f32 v158, v158, v142
    v_add_f32 v159, v159, v143
    s_waitcnt lgkmcnt(0)
    v_mfma_f32_32x32x16_bf16 v[128:143], a[32:35], a[0:3], 0
    ds_read_b64_tr_b16 a[64:65], v40 offset:24576
    ds_read_b64_tr_b16 a[66:67], v41 offset:26624
    v_add_f32 v160, v160, v176
    v_add_f32 v161, v161, v177
    v_add_f32 v162, v162, v178
    v_add_f32 v163, v163, v179
    v_add_f32 v164, v164, v180
    v_mfma_f32_32x32x16_bf16 v[128:143], a[36:39], a[4:7], v[128:143]
    ds_read_b64_tr_b16 a[72:73], v42 offset:24576
    ds_read_b64_tr_b16 a[74:75], v43 offset:26624
    v_add_f32 v165, v165, v181
    v_add_f32 v166, v166, v182
    v_add_f32 v167, v167, v183
    v_add_f32 v168, v168, v184
    v_add_f32 v169, v169, v185
    v_mfma_f32_32x32x16_bf16 v[128:143], a[40:43], a[8:11], v[128:143]
    ds_read_b64_tr_b16 a[80:81], v44 offset:24576
    ds_read_b64_tr_b16 a[82:83], v45 offset:26624
    v_add_f32 v170, v170, v186
    v_add_f32 v171, v171, v187
    v_add_f32 v172, v172, v188
    v_add_f32 v173, v173, v189
    v_add_f32 v174, v174, v190
    v_mfma_f32_32x32x16_bf16 v[128:143], a[44:47], a[12:15], v[128:143]
    ds_read_b64_tr_b16 a[88:89], v46 offset:24576
    ds_read_b64_tr_b16 a[90:91], v47 offset:26624
    v_add_f32 v175, v175, v191
    v_add_f32 v144, v144, v160
    v_add_f32 v145, v145, v161
    v_add_f32 v146, v146, v162
    v_add_f32 v147, v147, v163
    v_mfma_f32_32x32x16_bf16 v[128:143], a[48:51], a[16:19], v[128:143]
    ds_read_b64_tr_b16 a[68:69], v40 offset:28672
    ds_read_b64_tr_b16 a[70:71], v41 offset:30720
    v_add_f32 v148, v148, v164
    v_add_f32 v149, v149, v165
    v_add_f32 v150, v150, v166
    v_add_f32 v151, v151, v167
    v_add_f32 v152, v152, v168
    v_mfma_f32_32x32x16_bf16 v[128:143], a[52:55], a[20:23], v[128:143]
    ds_read_b64_tr_b16 a[76:77], v42 offset:28672
    ds_read_b64_tr_b16 a[78:79], v43 offset:30720
    v_add_f32 v153, v153, v169
    v_add_f32 v154, v154, v170
    v_add_f32 v155, v155, v171
    v_add_f32 v156, v156, v172
    v_add_f32 v157, v157, v173
    v_mfma_f32_32x32x16_bf16 v[128:143], a[56:59], a[24:27], v[128:143]
    ds_read_b64_tr_b16 a[84:85], v44 offset:28672
    ds_read_b64_tr_b16 a[86:87], v45 offset:30720
    v_add_f32 v158, v158, v174
    v_add_f32 v159, v159, v175
    v_max3_f32 v218, v144, v145, v146
    v_max3_f32 v219, v147, v148, v149
    v_max3_f32 v220, v150, v151, v152
    v_mfma_f32_32x32x16_bf16 v[128:143], a[60:63], a[28:31], v[128:143]
    ds_read_b64_tr_b16 a[92:93], v46 offset:28672
    ds_read_b64_tr_b16 a[94:95], v47 offset:30720
    v_max3_f32 v221, v153, v154, v155
    v_max3_f32 v218, v218, v156, v157
    v_max3_f32 v219, v219, v158, v159
    v_max3_f32 v218, v218, v219, v220
    v_max_f32 v218, v218, v221
    v_mov_b32 v219, v218
    s_nop 1
    v_permlane32_swap_b32 v218, v219
    v_max3_f32 v218, v218, v219, v216
    v_sub_f32 v220, v216, v218
    v_mov_b32 v216, v218
    v_exp_f32 v220, v220
    v_sub_f32 v192, v144, v218
    v_sub_f32 v193, v145, v218
    buffer_load_dwordx4 v[236:239], v23, s[32:35], s58 offen nt
    s_add_u32 s58, s58, 16384
    v_sub_f32 v194, v146, v218
    v_sub_f32 v195, v147, v218
    v_sub_f32 v196, v148, v218
    v_sub_f32 v197, v149, v218
    v_sub_f32 v198, v150, v218
    buffer_load_dwordx4 v[240:243], v20, s[32:35], s58 offen nt
    v_sub_f32 v199, v151, v218
    v_sub_f32 v200, v152, v218
    v_sub_f32 v201, v153, v218
    v_sub_f32 v202, v154, v218
    v_sub_f32 v203, v155, v218
    v_sub_f32 v204, v156, v218
    v_sub_f32 v205, v157, v218
    v_sub_f32 v206, v158, v218
    v_sub_f32 v207, v159, v218
    ds_write_b128 v28, v[128:131] offset:0
    v_exp_f32 v192, v192
    v_exp_f32 v193, v193
    v_exp_f32 v194, v194
    v_exp_f32 v195, v195
    ds_write_b128 v28, v[132:135] offset:1024
    v_exp_f32 v196, v196
    v_exp_f32 v197, v197
    v_exp_f32 v198, v198
    v_exp_f32 v199, v199
    ds_write_b128 v28, v[136:139] offset:2048
    v_exp_f32 v200, v200
    v_exp_f32 v201, v201
    v_exp_f32 v202, v202
    v_exp_f32 v203, v203
    ds_write_b128 v28, v[140:143] offset:3072
    v_exp_f32 v204, v204
    v_exp_f32 v205, v205
    v_exp_f32 v206, v206
    v_exp_f32 v207, v207
    v_mul_f32 v217, v217, v220
    v_cvt_pk_bf16_f32 v208, v192, v193
    v_cvt_pk_bf16_f32 v209, v194, v195
    v_cvt_pk_bf16_f32 v210, v196, v197
    v_cvt_pk_bf16_f32 v211, v198, v199
    v_cvt_pk_bf16_f32 v212, v200, v201
    v_cvt_pk_bf16_f32 v213, v202, v203
    v_cvt_pk_bf16_f32 v214, v204, v205
    v_cvt_pk_bf16_f32 v215, v206, v207
    v_mul_f32 v64, v64, v220
    v_mul_f32 v65, v65, v220
    v_mul_f32 v66, v66, v220
    v_mul_f32 v67, v67, v220
    v_mul_f32 v68, v68, v220
    v_mul_f32 v69, v69, v220
    v_mul_f32 v70, v70, v220
    v_mul_f32 v71, v71, v220
    v_mul_f32 v72, v72, v220
    v_mul_f32 v73, v73, v220
    v_mul_f32 v74, v74, v220
    v_mul_f32 v75, v75, v220
    v_mul_f32 v76, v76, v220
    v_mul_f32 v77, v77, v220
    v_mul_f32 v78, v78, v220
    v_mul_f32 v79, v79, v220
    s_waitcnt lgkmcnt(0)
    s_barrier
    v_mfma_f32_32x32x16_bf16 v[64:79], a[64:67], v[208:211], v[64:79]
    ds_read_b128 v[144:147], v29 offset:0
    v_mul_f32 v80, v80, v220
    v_mul_f32 v81, v81, v220
    ds_read_b128 v[148:151], v29 offset:1024
    s_waitcnt vmcnt(20)
    ds_write_b128 v26, a[192:195] offset:8192
    buffer_load_dwordx4 v[244:247], v21, s[32:35], s58 offen nt
    v_mul_f32 v82, v82, v220
    v_mul_f32 v83, v83, v220
    ds_read_b128 v[152:155], v29 offset:2048
    v_mul_f32 v84, v84, v220
    v_mfma_f32_32x32x16_bf16 v[64:79], a[68:71], v[212:215], v[64:79]
    v_mul_f32 v85, v85, v220
    ds_read_b128 v[156:159], v29 offset:3072
    v_mul_f32 v86, v86, v220
    s_waitcnt vmcnt(20)
    ds_write_b128 v26, a[196:199] offset:9216
    v_mul_f32 v87, v87, v220
    v_mul_f32 v88, v88, v220
    v_mul_f32 v89, v89, v220
    v_mul_f32 v90, v90, v220
    v_mul_f32 v91, v91, v220
    v_mul_f32 v92, v92, v220
    v_mul_f32 v93, v93, v220
    v_mul_f32 v94, v94, v220
    v_mul_f32 v95, v95, v220
    s_nop 1
    v_mfma_f32_32x32x16_bf16 v[80:95], a[72:75], v[208:211], v[80:95]
    ds_read_b128 v[160:163], v30 offset:0
    v_mul_f32 v96, v96, v220
    v_mul_f32 v97, v97, v220
    ds_read_b128 v[164:167], v30 offset:1024
    s_waitcnt vmcnt(19)
    ds_write_b128 v26, a[200:203] offset:10240
    buffer_load_dwordx4 v[248:251], v22, s[32:35], s58 offen nt
    v_mul_f32 v98, v98, v220
    v_mul_f32 v99, v99, v220
    ds_read_b128 v[168:171], v30 offset:2048
    v_mul_f32 v100, v100, v220
    v_mfma_f32_32x32x16_bf16 v[80:95], a[76:79], v[212:215], v[80:95]
    v_mul_f32 v101, v101, v220
    ds_read_b128 v[172:175], v30 offset:3072
    v_mul_f32 v102, v102, v220
    s_waitcnt vmcnt(19)
    ds_write_b128 v26, a[204:207] offset:11264
    v_mul_f32 v103, v103, v220
    v_mul_f32 v104, v104, v220
    v_mul_f32 v105, v105, v220
    v_mul_f32 v106, v106, v220
    v_mul_f32 v107, v107, v220
    v_mul_f32 v108, v108, v220
    v_mul_f32 v109, v109, v220
    v_mul_f32 v110, v110, v220
    v_mul_f32 v111, v111, v220
    s_nop 1
    v_mfma_f32_32x32x16_bf16 v[96:111], a[80:83], v[208:211], v[96:111]
    ds_read_b128 v[176:179], v31 offset:0
    v_mul_f32 v112, v112, v220
    v_mul_f32 v113, v113, v220
    ds_read_b128 v[180:183], v31 offset:1024
    s_waitcnt vmcnt(18)
    ds_write_b128 v26, a[208:211] offset:12288
    v_mul_f32 v114, v114, v220
    v_mul_f32 v115, v115, v220
    ds_read_b128 v[184:187], v31 offset:2048
    v_mul_f32 v116, v116, v220
    v_mfma_f32_32x32x16_bf16 v[96:111], a[84:87], v[212:215], v[96:111]
    v_mul_f32 v117, v117, v220
    ds_read_b128 v[188:191], v31 offset:3072
    v_mul_f32 v118, v118, v220
    s_waitcnt vmcnt(17)
    ds_write_b128 v26, a[212:215] offset:13312
    buffer_load_dwordx4 v[252:255], v23, s[32:35], s58 offen nt
    s_add_u32 s58, s58, 16384
    v_mul_f32 v119, v119, v220
    v_mul_f32 v120, v120, v220
    v_mul_f32 v121, v121, v220
    v_mul_f32 v122, v122, v220
    v_mul_f32 v123, v123, v220
    v_mul_f32 v124, v124, v220
    v_mul_f32 v125, v125, v220
    v_mul_f32 v126, v126, v220
    v_mul_f32 v127, v127, v220
    s_nop 1
    v_mfma_f32_32x32x16_bf16 v[112:127], a[88:91], v[208:211], v[112:127]
    v_add_f32 v192, v192, v200
    v_add_f32 v193, v193, v201
    v_add_f32 v194, v194, v202
    v_add_f32 v195, v195, v203
    s_waitcnt vmcnt(17)
    ds_write_b128 v26, a[216:219] offset:14336
    v_add_f32 v196, v196, v204
    v_add_f32 v197, v197, v205
    v_add_f32 v198, v198, v206
    v_add_f32 v199, v199, v207
    v_mfma_f32_32x32x16_bf16 v[112:127], a[92:95], v[212:215], v[112:127]
    v_add_f32 v192, v192, v196
    v_add_f32 v193, v193, v197
    v_add_f32 v194, v194, v198
    s_waitcnt vmcnt(16)
    ds_write_b128 v26, a[220:223] offset:15360
    v_add_f32 v195, v195, v199
    v_add_f32 v192, v192, v193
    v_add_f32 v194, v194, v195
    v_add_f32 v192, v192, v194
    v_add_f32 v217, v217, v192
    ds_read_b128 a[32:35], v32 offset:8192
    ds_read_b128 a[36:39], v33 offset:8192
    ds_read_b128 a[40:43], v34 offset:8192
    ds_read_b128 a[44:47], v35 offset:8192
    ds_read_b128 a[48:51], v36 offset:8192
    ds_read_b128 a[52:55], v37 offset:8192
    ds_read_b128 a[56:59], v38 offset:8192
    ds_read_b128 a[60:63], v39 offset:8192
    s_waitcnt lgkmcnt(8)
    v_add_f32 v144, v144, v128
    v_add_f32 v145, v145, v129
    v_add_f32 v146, v146, v130
    v_add_f32 v147, v147, v131
    v_add_f32 v148, v148, v132
    v_add_f32 v149, v149, v133
    v_add_f32 v150, v150, v134
    v_add_f32 v151, v151, v135
    v_add_f32 v152, v152, v136
    v_add_f32 v153, v153, v137
    v_add_f32 v154, v154, v138
    v_add_f32 v155, v155, v139
    v_add_f32 v156, v156, v140
    v_add_f32 v157, v157, v141
    v_add_f32 v158, v158, v142
    v_add_f32 v159, v159, v143
    s_waitcnt lgkmcnt(0)
    v_mfma_f32_32x32x16_bf16 v[128:143], a[32:35], a[0:3], 0
    ds_read_b64_tr_b16 a[64:65], v40 offset:0
    ds_read_b64_tr_b16 a[66:67], v41 offset:2048
    v_add_f32 v160, v160, v176
    v_add_f32 v161, v161, v177
    v_add_f32 v162, v162, v178
    v_add_f32 v163, v163, v179
    v_add_f32 v164, v164, v180
    v_mfma_f32_32x32x16_bf16 v[128:143], a[36:39], a[4:7], v[128:143]
    ds_read_b64_tr_b16 a[72:73], v42 offset:0
    ds_read_b64_tr_b16 a[74:75], v43 offset:2048
    v_add_f32 v165, v165, v181
    v_add_f32 v166, v166, v182
    v_add_f32 v167, v167, v183
    v_add_f32 v168, v168, v184
    v_add_f32 v169, v169, v185
    v_mfma_f32_32x32x16_bf16 v[128:143], a[40:43], a[8:11], v[128:143]
    ds_read_b64_tr_b16 a[80:81], v44 offset:0
    ds_read_b64_tr_b16 a[82:83], v45 offset:2048
    v_add_f32 v170, v170, v186
    v_add_f32 v171, v171, v187
    v_add_f32 v172, v172, v188
    v_add_f32 v173, v173, v189
    v_add_f32 v174, v174, v190
    v_mfma_f32_32x32x16_bf16 v[128:143], a[44:47], a[12:15], v[128:143]
    ds_read_b64_tr_b16 a[88:89], v46 offset:0
    ds_read_b64_tr_b16 a[90:91], v47 offset:2048
    v_add_f32 v175, v175, v191
    v_add_f32 v144, v144, v160
    v_add_f32 v145, v145, v161
    v_add_f32 v146, v146, v162
    v_add_f32 v147, v147, v163
    v_mfma_f32_32x32x16_bf16 v[128:143], a[48:51], a[16:19], v[128:143]
    ds_read_b64_tr_b16 a[68:69], v40 offset:4096
    ds_read_b64_tr_b16 a[70:71], v41 offset:6144
    v_add_f32 v148, v148, v164
    v_add_f32 v149, v149, v165
    v_add_f32 v150, v150, v166
    v_add_f32 v151, v151, v167
    v_add_f32 v152, v152, v168
    v_mfma_f32_32x32x16_bf16 v[128:143], a[52:55], a[20:23], v[128:143]
    ds_read_b64_tr_b16 a[76:77], v42 offset:4096
    ds_read_b64_tr_b16 a[78:79], v43 offset:6144
    v_add_f32 v153, v153, v169
    v_add_f32 v154, v154, v170
    v_add_f32 v155, v155, v171
    v_add_f32 v156, v156, v172
    v_add_f32 v157, v157, v173
    v_mfma_f32_32x32x16_bf16 v[128:143], a[56:59], a[24:27], v[128:143]
    ds_read_b64_tr_b16 a[84:85], v44 offset:4096
    ds_read_b64_tr_b16 a[86:87], v45 offset:6144
    v_add_f32 v158, v158, v174
    v_add_f32 v159, v159, v175
    v_max3_f32 v218, v144, v145, v146
    v_max3_f32 v219, v147, v148, v149
    v_max3_f32 v220, v150, v151, v152
    v_mfma_f32_32x32x16_bf16 v[128:143], a[60:63], a[28:31], v[128:143]
    ds_read_b64_tr_b16 a[92:93], v46 offset:4096
    ds_read_b64_tr_b16 a[94:95], v47 offset:6144
    v_max3_f32 v221, v153, v154, v155
    v_max3_f32 v218, v218, v156, v157
    v_max3_f32 v219, v219, v158, v159
    v_max3_f32 v218, v218, v219, v220
    v_max_f32 v218, v218, v221
    v_mov_b32 v219, v218
    s_nop 1
    v_permlane32_swap_b32 v218, v219
    v_max3_f32 v218, v218, v219, v216
    v_sub_f32 v220, v216, v218
    v_mov_b32 v216, v218
    v_exp_f32 v220, v220
    v_sub_f32 v192, v144, v218
    v_sub_f32 v193, v145, v218
    v_sub_f32 v194, v146, v218
    v_sub_f32 v195, v147, v218
    v_sub_f32 v196, v148, v218
    v_sub_f32 v197, v149, v218
    v_sub_f32 v198, v150, v218
    v_sub_f32 v199, v151, v218
    v_sub_f32 v200, v152, v218
    v_sub_f32 v201, v153, v218
    v_sub_f32 v202, v154, v218
    v_sub_f32 v203, v155, v218
    v_sub_f32 v204, v156, v218
    v_sub_f32 v205, v157, v218
    v_sub_f32 v206, v158, v218
    v_sub_f32 v207, v159, v218
    ds_write_b128 v28, v[128:131] offset:16384
    v_exp_f32 v192, v192
    v_exp_f32 v193, v193
    v_exp_f32 v194, v194
    v_exp_f32 v195, v195
    ds_write_b128 v28, v[132:135] offset:17408
    v_exp_f32 v196, v196
    v_exp_f32 v197, v197
    v_exp_f32 v198, v198
    v_exp_f32 v199, v199
    ds_write_b128 v28, v[136:139] offset:18432
    v_exp_f32 v200, v200
    v_exp_f32 v201, v201
    v_exp_f32 v202, v202
    v_exp_f32 v203, v203
    ds_write_b128 v28, v[140:143] offset:19456
    v_exp_f32 v204, v204
    v_exp_f32 v205, v205
    v_exp_f32 v206, v206
    v_exp_f32 v207, v207
    v_mul_f32 v217, v217, v220
    v_cvt_pk_bf16_f32 v208, v192, v193
    v_cvt_pk_bf16_f32 v209, v194, v195
    v_cvt_pk_bf16_f32 v210, v196, v197
    v_cvt_pk_bf16_f32 v211, v198, v199
    v_cvt_pk_bf16_f32 v212, v200, v201
    v_cvt_pk_bf16_f32 v213, v202, v203
    v_cvt_pk_bf16_f32 v214, v204, v205
    v_cvt_pk_bf16_f32 v215, v206, v207
    v_mul_f32 v64, v64, v220
    v_mul_f32 v65, v65, v220
    v_mul_f32 v66, v66, v220
    v_mul_f32 v67, v67, v220
    v_mul_f32 v68, v68, v220
    v_mul_f32 v69, v69, v220
    v_mul_f32 v70, v70, v220
    v_mul_f32 v71, v71, v220
    v_mul_f32 v72, v72, v220
    v_mul_f32 v73, v73, v220
    v_mul_f32 v74, v74, v220
    v_mul_f32 v75, v75, v220
    v_mul_f32 v76, v76, v220
    v_mul_f32 v77, v77, v220
    v_mul_f32 v78, v78, v220
    v_mul_f32 v79, v79, v220
    s_waitcnt lgkmcnt(0)
    s_barrier
    v_mfma_f32_32x32x16_bf16 v[64:79], a[64:67], v[208:211], v[64:79]
    ds_read_b128 v[144:147], v29 offset:16384
    v_mul_f32 v80, v80, v220
    v_mul_f32 v81, v81, v220
    ds_read_b128 v[148:151], v29 offset:17408
    s_waitcnt vmcnt(15)
    ds_write_b128 v26, a[224:227] offset:16384
    v_mul_f32 v82, v82, v220
    v_mul_f32 v83, v83, v220
    ds_read_b128 v[152:155], v29 offset:18432
    v_mul_f32 v84, v84, v220
    v_mfma_f32_32x32x16_bf16 v[64:79], a[68:71], v[212:215], v[64:79]
    v_mul_f32 v85, v85, v220
    ds_read_b128 v[156:159], v29 offset:19456
    v_mul_f32 v86, v86, v220
    s_waitcnt vmcnt(14)
    ds_write_b128 v26, a[228:231] offset:17408
    v_mul_f32 v87, v87, v220
    v_mul_f32 v88, v88, v220
    v_mul_f32 v89, v89, v220
    v_mul_f32 v90, v90, v220
    v_mul_f32 v91, v91, v220
    v_mul_f32 v92, v92, v220
    v_mul_f32 v93, v93, v220
    v_mul_f32 v94, v94, v220
    v_mul_f32 v95, v95, v220
    s_nop 1
    v_mfma_f32_32x32x16_bf16 v[80:95], a[72:75], v[208:211], v[80:95]
    ds_read_b128 v[160:163], v30 offset:16384
    v_mul_f32 v96, v96, v220
    v_mul_f32 v97, v97, v220
    ds_read_b128 v[164:167], v30 offset:17408
    s_waitcnt vmcnt(13)
    ds_write_b128 v26, a[232:235] offset:18432
    v_mul_f32 v98, v98, v220
    v_mul_f32 v99, v99, v220
    ds_read_b128 v[168:171], v30 offset:18432
    v_mul_f32 v100, v100, v220
    v_mfma_f32_32x32x16_bf16 v[80:95], a[76:79], v[212:215], v[80:95]
    v_mul_f32 v101, v101, v220
    ds_read_b128 v[172:175], v30 offset:19456
    v_mul_f32 v102, v102, v220
    s_waitcnt vmcnt(12)
    ds_write_b128 v26, a[236:239] offset:19456
    v_mul_f32 v103, v103, v220
    v_mul_f32 v104, v104, v220
    v_mul_f32 v105, v105, v220
    v_mul_f32 v106, v106, v220
    v_mul_f32 v107, v107, v220
    v_mul_f32 v108, v108, v220
    v_mul_f32 v109, v109, v220
    v_mul_f32 v110, v110, v220
    v_mul_f32 v111, v111, v220
    s_nop 1
    v_mfma_f32_32x32x16_bf16 v[96:111], a[80:83], v[208:211], v[96:111]
    ds_read_b128 v[176:179], v31 offset:16384
    v_mul_f32 v112, v112, v220
    v_mul_f32 v113, v113, v220
    ds_read_b128 v[180:183], v31 offset:17408
    s_waitcnt vmcnt(11)
    ds_write_b128 v26, a[240:243] offset:20480
    v_mul_f32 v114, v114, v220
    v_mul_f32 v115, v115, v220
    ds_read_b128 v[184:187], v31 offset:18432
    v_mul_f32 v116, v116, v220
    v_mfma_f32_32x32x16_bf16 v[96:111], a[84:87], v[212:215], v[96:111]
    v_mul_f32 v117, v117, v220
    ds_read_b128 v[188:191], v31 offset:19456
    v_mul_f32 v118, v118, v220
    s_waitcnt vmcnt(10)
    ds_write_b128 v26, a[244:247] offset:21504
    v_mul_f32 v119, v119, v220
    v_mul_f32 v120, v120, v220
    v_mul_f32 v121, v121, v220
    v_mul_f32 v122, v122, v220
    v_mul_f32 v123, v123, v220
    v_mul_f32 v124, v124, v220
    v_mul_f32 v125, v125, v220
    v_mul_f32 v126, v126, v220
    v_mul_f32 v127, v127, v220
    s_nop 1
    v_mfma_f32_32x32x16_bf16 v[112:127], a[88:91], v[208:211], v[112:127]
    v_add_f32 v192, v192, v200
    v_add_f32 v193, v193, v201
    v_add_f32 v194, v194, v202
    v_add_f32 v195, v195, v203
    s_waitcnt vmcnt(9)
    ds_write_b128 v26, a[248:251] offset:22528
    v_add_f32 v196, v196, v204
    v_add_f32 v197, v197, v205
    v_add_f32 v198, v198, v206
    v_add_f32 v199, v199, v207
    v_mfma_f32_32x32x16_bf16 v[112:127], a[92:95], v[212:215], v[112:127]
    v_add_f32 v192, v192, v196
    v_add_f32 v193, v193, v197
    v_add_f32 v194, v194, v198
    s_waitcnt vmcnt(8)
    ds_write_b128 v26, a[252:255] offset:23552
    v_add_f32 v195, v195, v199
    v_add_f32 v192, v192, v193
    v_add_f32 v194, v194, v195
    v_add_f32 v192, v192, v194
    v_add_f32 v217, v217, v192
    ds_read_b128 a[32:35], v32 offset:16384
    ds_read_b128 a[36:39], v33 offset:16384
    ds_read_b128 a[40:43], v34 offset:16384
    ds_read_b128 a[44:47], v35 offset:16384
    ds_read_b128 a[48:51], v36 offset:16384
    ds_read_b128 a[52:55], v37 offset:16384
    ds_read_b128 a[56:59], v38 offset:16384
    ds_read_b128 a[60:63], v39 offset:16384
    s_waitcnt lgkmcnt(8)
    v_add_f32 v144, v144, v128
    v_add_f32 v145, v145, v129
    v_add_f32 v146, v146, v130
    v_add_f32 v147, v147, v131
    v_add_f32 v148, v148, v132
    v_add_f32 v149, v149, v133
    v_add_f32 v150, v150, v134
    v_add_f32 v151, v151, v135
    v_add_f32 v152, v152, v136
    v_add_f32 v153, v153, v137
    v_add_f32 v154, v154, v138
    v_add_f32 v155, v155, v139
    v_add_f32 v156, v156, v140
    v_add_f32 v157, v157, v141
    v_add_f32 v158, v158, v142
    v_add_f32 v159, v159, v143
    s_waitcnt lgkmcnt(0)
    v_mfma_f32_32x32x16_bf16 v[128:143], a[32:35], a[0:3], 0
    ds_read_b64_tr_b16 a[64:65], v40 offset:8192
    ds_read_b64_tr_b16 a[66:67], v41 offset:10240
    v_add_f32 v160, v160, v176
    v_add_f32 v161, v161, v177
    v_add_f32 v162, v162, v178
    v_add_f32 v163, v163, v179
    v_add_f32 v164, v164, v180
    v_mfma_f32_32x32x16_bf16 v[128:143], a[36:39], a[4:7], v[128:143]
    ds_read_b64_tr_b16 a[72:73], v42 offset:8192
    ds_read_b64_tr_b16 a[74:75], v43 offset:10240
    v_add_f32 v165, v165, v181
    v_add_f32 v166, v166, v182
    v_add_f32 v167, v167, v183
    v_add_f32 v168, v168, v184
    v_add_f32 v169, v169, v185
    v_mfma_f32_32x32x16_bf16 v[128:143], a[40:43], a[8:11], v[128:143]
    ds_read_b64_tr_b16 a[80:81], v44 offset:8192
    ds_read_b64_tr_b16 a[82:83], v45 offset:10240
    v_add_f32 v170, v170, v186
    v_add_f32 v171, v171, v187
    v_add_f32 v172, v172, v188
    v_add_f32 v173, v173, v189
    v_add_f32 v174, v174, v190
    v_mfma_f32_32x32x16_bf16 v[128:143], a[44:47], a[12:15], v[128:143]
    ds_read_b64_tr_b16 a[88:89], v46 offset:8192
    ds_read_b64_tr_b16 a[90:91], v47 offset:10240
    v_add_f32 v175, v175, v191
    v_add_f32 v144, v144, v160
    v_add_f32 v145, v145, v161
    v_add_f32 v146, v146, v162
    v_add_f32 v147, v147, v163
    v_mfma_f32_32x32x16_bf16 v[128:143], a[48:51], a[16:19], v[128:143]
    ds_read_b64_tr_b16 a[68:69], v40 offset:12288
    ds_read_b64_tr_b16 a[70:71], v41 offset:14336
    v_add_f32 v148, v148, v164
    v_add_f32 v149, v149, v165
    v_add_f32 v150, v150, v166
    v_add_f32 v151, v151, v167
    v_add_f32 v152, v152, v168
    v_mfma_f32_32x32x16_bf16 v[128:143], a[52:55], a[20:23], v[128:143]
    ds_read_b64_tr_b16 a[76:77], v42 offset:12288
    ds_read_b64_tr_b16 a[78:79], v43 offset:14336
    v_add_f32 v153, v153, v169
    v_add_f32 v154, v154, v170
    v_add_f32 v155, v155, v171
    v_add_f32 v156, v156, v172
    v_add_f32 v157, v157, v173
    v_mfma_f32_32x32x16_bf16 v[128:143], a[56:59], a[24:27], v[128:143]
    ds_read_b64_tr_b16 a[84:85], v44 offset:12288
    ds_read_b64_tr_b16 a[86:87], v45 offset:14336
    v_add_f32 v158, v158, v174
    v_add_f32 v159, v159, v175
    v_max3_f32 v218, v144, v145, v146
    v_max3_f32 v219, v147, v148, v149
    v_max3_f32 v220, v150, v151, v152
    v_mfma_f32_32x32x16_bf16 v[128:143], a[60:63], a[28:31], v[128:143]
    ds_read_b64_tr_b16 a[92:93], v46 offset:12288
    ds_read_b64_tr_b16 a[94:95], v47 offset:14336
    v_max3_f32 v221, v153, v154, v155
    v_max3_f32 v218, v218, v156, v157
    v_max3_f32 v219, v219, v158, v159
    v_max3_f32 v218, v218, v219, v220
    v_max_f32 v218, v218, v221
    v_mov_b32 v219, v218
    s_nop 1
    v_permlane32_swap_b32 v218, v219
    v_max3_f32 v218, v218, v219, v216
    v_sub_f32 v220, v216, v218
    v_mov_b32 v216, v218
    v_exp_f32 v220, v220
    v_sub_f32 v192, v144, v218
    v_sub_f32 v193, v145, v218
    v_sub_f32 v194, v146, v218
    v_sub_f32 v195, v147, v218
    v_sub_f32 v196, v148, v218
    v_sub_f32 v197, v149, v218
    v_sub_f32 v198, v150, v218
    v_sub_f32 v199, v151, v218
    v_sub_f32 v200, v152, v218
    v_sub_f32 v201, v153, v218
    v_sub_f32 v202, v154, v218
    v_sub_f32 v203, v155, v218
    v_sub_f32 v204, v156, v218
    v_sub_f32 v205, v157, v218
    v_sub_f32 v206, v158, v218
    v_sub_f32 v207, v159, v218
    ds_write_b128 v28, v[128:131] offset:0
    v_exp_f32 v192, v192
    v_exp_f32 v193, v193
    v_exp_f32 v194, v194
    v_exp_f32 v195, v195
    ds_write_b128 v28, v[132:135] offset:1024
    v_exp_f32 v196, v196
    v_exp_f32 v197, v197
    v_exp_f32 v198, v198
    v_exp_f32 v199, v199
    ds_write_b128 v28, v[136:139] offset:2048
    v_exp_f32 v200, v200
    v_exp_f32 v201, v201
    v_exp_f32 v202, v202
    v_exp_f32 v203, v203
    ds_write_b128 v28, v[140:143] offset:3072
    v_exp_f32 v204, v204
    v_exp_f32 v205, v205
    v_exp_f32 v206, v206
    v_exp_f32 v207, v207
    v_mul_f32 v217, v217, v220
    v_cvt_pk_bf16_f32 v208, v192, v193
    v_cvt_pk_bf16_f32 v209, v194, v195
    v_cvt_pk_bf16_f32 v210, v196, v197
    v_cvt_pk_bf16_f32 v211, v198, v199
    v_cvt_pk_bf16_f32 v212, v200, v201
    v_cvt_pk_bf16_f32 v213, v202, v203
    v_cvt_pk_bf16_f32 v214, v204, v205
    v_cvt_pk_bf16_f32 v215, v206, v207
    v_mul_f32 v64, v64, v220
    v_mul_f32 v65, v65, v220
    v_mul_f32 v66, v66, v220
    v_mul_f32 v67, v67, v220
    v_mul_f32 v68, v68, v220
    v_mul_f32 v69, v69, v220
    v_mul_f32 v70, v70, v220
    v_mul_f32 v71, v71, v220
    v_mul_f32 v72, v72, v220
    v_mul_f32 v73, v73, v220
    v_mul_f32 v74, v74, v220
    v_mul_f32 v75, v75, v220
    v_mul_f32 v76, v76, v220
    v_mul_f32 v77, v77, v220
    v_mul_f32 v78, v78, v220
    v_mul_f32 v79, v79, v220
    s_waitcnt lgkmcnt(0)
    s_barrier
    v_mfma_f32_32x32x16_bf16 v[64:79], a[64:67], v[208:211], v[64:79]
    ds_read_b128 v[144:147], v29 offset:0
    v_mul_f32 v80, v80, v220
    v_mul_f32 v81, v81, v220
    ds_read_b128 v[148:151], v29 offset:1024
    s_waitcnt vmcnt(7)
    ds_write_b128 v26, v[224:227] offset:24576
    v_mul_f32 v82, v82, v220
    v_mul_f32 v83, v83, v220
    ds_read_b128 v[152:155], v29 offset:2048
    v_mul_f32 v84, v84, v220
    v_mfma_f32_32x32x16_bf16 v[64:79], a[68:71], v[212:215], v[64:79]
    v_mul_f32 v85, v85, v220
    ds_read_b128 v[156:159], v29 offset:3072
    v_mul_f32 v86, v86, v220
    s_waitcnt vmcnt(6)
    ds_write_b128 v26, v[228:231] offset:25600
    v_mul_f32 v87, v87, v220
    v_mul_f32 v88, v88, v220
    v_mul_f32 v89, v89, v220
    v_mul_f32 v90, v90, v220
    v_mul_f32 v91, v91, v220
    v_mul_f32 v92, v92, v220
    v_mul_f32 v93, v93, v220
    v_mul_f32 v94, v94, v220
    v_mul_f32 v95, v95, v220
    s_nop 1
    v_mfma_f32_32x32x16_bf16 v[80:95], a[72:75], v[208:211], v[80:95]
    ds_read_b128 v[160:163], v30 offset:0
    v_mul_f32 v96, v96, v220
    v_mul_f32 v97, v97, v220
    ds_read_b128 v[164:167], v30 offset:1024
    s_waitcnt vmcnt(5)
    ds_write_b128 v26, v[232:235] offset:26624
    v_mul_f32 v98, v98, v220
    v_mul_f32 v99, v99, v220
    ds_read_b128 v[168:171], v30 offset:2048
    v_mul_f32 v100, v100, v220
    v_mfma_f32_32x32x16_bf16 v[80:95], a[76:79], v[212:215], v[80:95]
    v_mul_f32 v101, v101, v220
    ds_read_b128 v[172:175], v30 offset:3072
    v_mul_f32 v102, v102, v220
    s_waitcnt vmcnt(4)
    ds_write_b128 v26, v[236:239] offset:27648
    v_mul_f32 v103, v103, v220
    v_mul_f32 v104, v104, v220
    v_mul_f32 v105, v105, v220
    v_mul_f32 v106, v106, v220
    v_mul_f32 v107, v107, v220
    v_mul_f32 v108, v108, v220
    v_mul_f32 v109, v109, v220
    v_mul_f32 v110, v110, v220
    v_mul_f32 v111, v111, v220
    s_nop 1
    v_mfma_f32_32x32x16_bf16 v[96:111], a[80:83], v[208:211], v[96:111]
    ds_read_b128 v[176:179], v31 offset:0
    v_mul_f32 v112, v112, v220
    v_mul_f32 v113, v113, v220
    ds_read_b128 v[180:183], v31 offset:1024
    s_waitcnt vmcnt(3)
    ds_write_b128 v26, v[240:243] offset:28672
    v_mul_f32 v114, v114, v220
    v_mul_f32 v115, v115, v220
    ds_read_b128 v[184:187], v31 offset:2048
    v_mul_f32 v116, v116, v220
    v_mfma_f32_32x32x16_bf16 v[96:111], a[84:87], v[212:215], v[96:111]
    v_mul_f32 v117, v117, v220
    ds_read_b128 v[188:191], v31 offset:3072
    v_mul_f32 v118, v118, v220
    s_waitcnt vmcnt(2)
    ds_write_b128 v26, v[244:247] offset:29696
    v_mul_f32 v119, v119, v220
    v_mul_f32 v120, v120, v220
    v_mul_f32 v121, v121, v220
    v_mul_f32 v122, v122, v220
    v_mul_f32 v123, v123, v220
    v_mul_f32 v124, v124, v220
    v_mul_f32 v125, v125, v220
    v_mul_f32 v126, v126, v220
    v_mul_f32 v127, v127, v220
    s_nop 1
    v_mfma_f32_32x32x16_bf16 v[112:127], a[88:91], v[208:211], v[112:127]
    v_add_f32 v192, v192, v200
    v_add_f32 v193, v193, v201
    v_add_f32 v194, v194, v202
    v_add_f32 v195, v195, v203
    s_waitcnt vmcnt(1)
    ds_write_b128 v26, v[248:251] offset:30720
    v_add_f32 v196, v196, v204
    v_add_f32 v197, v197, v205
    v_add_f32 v198, v198, v206
    v_add_f32 v199, v199, v207
    v_mfma_f32_32x32x16_bf16 v[112:127], a[92:95], v[212:215], v[112:127]
    v_add_f32 v192, v192, v196
    v_add_f32 v193, v193, v197
    v_add_f32 v194, v194, v198
    s_waitcnt vmcnt(0)
    ds_write_b128 v26, v[252:255] offset:31744
    v_add_f32 v195, v195, v199
    v_add_f32 v192, v192, v193
    v_add_f32 v194, v194, v195
    v_add_f32 v192, v192, v194
    v_add_f32 v217, v217, v192
    ds_read_b128 a[32:35], v32 offset:24576
    ds_read_b128 a[36:39], v33 offset:24576
    ds_read_b128 a[40:43], v34 offset:24576
    ds_read_b128 a[44:47], v35 offset:24576
    ds_read_b128 a[48:51], v36 offset:24576
    ds_read_b128 a[52:55], v37 offset:24576
    ds_read_b128 a[56:59], v38 offset:24576
    ds_read_b128 a[60:63], v39 offset:24576
    s_waitcnt lgkmcnt(8)
    v_add_f32 v144, v144, v128
    v_add_f32 v145, v145, v129
    v_add_f32 v146, v146, v130
    v_add_f32 v147, v147, v131
    v_add_f32 v148, v148, v132
    v_add_f32 v149, v149, v133
    v_add_f32 v150, v150, v134
    v_add_f32 v151, v151, v135
    v_add_f32 v152, v152, v136
    v_add_f32 v153, v153, v137
    v_add_f32 v154, v154, v138
    v_add_f32 v155, v155, v139
    v_add_f32 v156, v156, v140
    v_add_f32 v157, v157, v141
    v_add_f32 v158, v158, v142
    v_add_f32 v159, v159, v143
    s_waitcnt lgkmcnt(0)
    v_mfma_f32_32x32x16_bf16 v[128:143], a[32:35], a[0:3], 0
    ds_read_b64_tr_b16 a[64:65], v40 offset:16384
    ds_read_b64_tr_b16 a[66:67], v41 offset:18432
    v_add_f32 v160, v160, v176
    v_add_f32 v161, v161, v177
    v_add_f32 v162, v162, v178
    v_add_f32 v163, v163, v179
    v_add_f32 v164, v164, v180
    v_mfma_f32_32x32x16_bf16 v[128:143], a[36:39], a[4:7], v[128:143]
    ds_read_b64_tr_b16 a[72:73], v42 offset:16384
    ds_read_b64_tr_b16 a[74:75], v43 offset:18432
    v_add_f32 v165, v165, v181
    v_add_f32 v166, v166, v182
    v_add_f32 v167, v167, v183
    v_add_f32 v168, v168, v184
    v_add_f32 v169, v169, v185
    v_mfma_f32_32x32x16_bf16 v[128:143], a[40:43], a[8:11], v[128:143]
    ds_read_b64_tr_b16 a[80:81], v44 offset:16384
    ds_read_b64_tr_b16 a[82:83], v45 offset:18432
    v_add_f32 v170, v170, v186
    v_add_f32 v171, v171, v187
    v_add_f32 v172, v172, v188
    v_add_f32 v173, v173, v189
    v_add_f32 v174, v174, v190
    v_mfma_f32_32x32x16_bf16 v[128:143], a[44:47], a[12:15], v[128:143]
    ds_read_b64_tr_b16 a[88:89], v46 offset:16384
    ds_read_b64_tr_b16 a[90:91], v47 offset:18432
    v_add_f32 v175, v175, v191
    v_add_f32 v144, v144, v160
    v_add_f32 v145, v145, v161
    v_add_f32 v146, v146, v162
    v_add_f32 v147, v147, v163
    v_mfma_f32_32x32x16_bf16 v[128:143], a[48:51], a[16:19], v[128:143]
    ds_read_b64_tr_b16 a[68:69], v40 offset:20480
    ds_read_b64_tr_b16 a[70:71], v41 offset:22528
    v_add_f32 v148, v148, v164
    v_add_f32 v149, v149, v165
    v_add_f32 v150, v150, v166
    v_add_f32 v151, v151, v167
    v_add_f32 v152, v152, v168
    v_mfma_f32_32x32x16_bf16 v[128:143], a[52:55], a[20:23], v[128:143]
    ds_read_b64_tr_b16 a[76:77], v42 offset:20480
    ds_read_b64_tr_b16 a[78:79], v43 offset:22528
    v_add_f32 v153, v153, v169
    v_add_f32 v154, v154, v170
    v_add_f32 v155, v155, v171
    v_add_f32 v156, v156, v172
    v_add_f32 v157, v157, v173
    v_mfma_f32_32x32x16_bf16 v[128:143], a[56:59], a[24:27], v[128:143]
    ds_read_b64_tr_b16 a[84:85], v44 offset:20480
    ds_read_b64_tr_b16 a[86:87], v45 offset:22528
    v_add_f32 v158, v158, v174
    v_add_f32 v159, v159, v175
    v_max3_f32 v218, v144, v145, v146
    v_max3_f32 v219, v147, v148, v149
    v_max3_f32 v220, v150, v151, v152
    v_mfma_f32_32x32x16_bf16 v[128:143], a[60:63], a[28:31], v[128:143]
    ds_read_b64_tr_b16 a[92:93], v46 offset:20480
    ds_read_b64_tr_b16 a[94:95], v47 offset:22528
    v_max3_f32 v221, v153, v154, v155
    v_max3_f32 v218, v218, v156, v157
    v_max3_f32 v219, v219, v158, v159
    v_max3_f32 v218, v218, v219, v220
    v_max_f32 v218, v218, v221
    v_mov_b32 v219, v218
    s_nop 1
    v_permlane32_swap_b32 v218, v219
    v_max3_f32 v218, v218, v219, v216
    v_sub_f32 v220, v216, v218
    v_mov_b32 v216, v218
    v_exp_f32 v220, v220
    v_sub_f32 v192, v144, v218
    v_sub_f32 v193, v145, v218
    v_sub_f32 v194, v146, v218
    v_sub_f32 v195, v147, v218
    v_sub_f32 v196, v148, v218
    v_sub_f32 v197, v149, v218
    v_sub_f32 v198, v150, v218
    v_sub_f32 v199, v151, v218
    v_sub_f32 v200, v152, v218
    v_sub_f32 v201, v153, v218
    v_sub_f32 v202, v154, v218
    v_sub_f32 v203, v155, v218
    v_sub_f32 v204, v156, v218
    v_sub_f32 v205, v157, v218
    v_sub_f32 v206, v158, v218
    v_sub_f32 v207, v159, v218
    ds_write_b128 v28, v[128:131] offset:16384
    v_exp_f32 v192, v192
    v_exp_f32 v193, v193
    v_exp_f32 v194, v194
    v_exp_f32 v195, v195
    ds_write_b128 v28, v[132:135] offset:17408
    v_exp_f32 v196, v196
    v_exp_f32 v197, v197
    v_exp_f32 v198, v198
    v_exp_f32 v199, v199
    ds_write_b128 v28, v[136:139] offset:18432
    v_exp_f32 v200, v200
    v_exp_f32 v201, v201
    v_exp_f32 v202, v202
    v_exp_f32 v203, v203
    ds_write_b128 v28, v[140:143] offset:19456
    v_exp_f32 v204, v204
    v_exp_f32 v205, v205
    v_exp_f32 v206, v206
    v_exp_f32 v207, v207
    v_mul_f32 v217, v217, v220
    v_cvt_pk_bf16_f32 v208, v192, v193
    v_cvt_pk_bf16_f32 v209, v194, v195
    v_cvt_pk_bf16_f32 v210, v196, v197
    v_cvt_pk_bf16_f32 v211, v198, v199
    v_cvt_pk_bf16_f32 v212, v200, v201
    v_cvt_pk_bf16_f32 v213, v202, v203
    v_cvt_pk_bf16_f32 v214, v204, v205
    v_cvt_pk_bf16_f32 v215, v206, v207
    v_mul_f32 v64, v64, v220
    v_mul_f32 v65, v65, v220
    v_mul_f32 v66, v66, v220
    v_mul_f32 v67, v67, v220
    v_mul_f32 v68, v68, v220
    v_mul_f32 v69, v69, v220
    v_mul_f32 v70, v70, v220
    v_mul_f32 v71, v71, v220
    v_mul_f32 v72, v72, v220
    v_mul_f32 v73, v73, v220
    v_mul_f32 v74, v74, v220
    v_mul_f32 v75, v75, v220
    v_mul_f32 v76, v76, v220
    v_mul_f32 v77, v77, v220
    v_mul_f32 v78, v78, v220
    v_mul_f32 v79, v79, v220
    s_waitcnt lgkmcnt(0)
    s_barrier
    v_mfma_f32_32x32x16_bf16 v[64:79], a[64:67], v[208:211], v[64:79]
    ds_read_b128 v[144:147], v29 offset:16384
    v_mul_f32 v80, v80, v220
    v_mul_f32 v81, v81, v220
    ds_read_b128 v[148:151], v29 offset:17408
    v_mul_f32 v82, v82, v220
    v_mul_f32 v83, v83, v220
    ds_read_b128 v[152:155], v29 offset:18432
    v_mul_f32 v84, v84, v220
    v_mfma_f32_32x32x16_bf16 v[64:79], a[68:71], v[212:215], v[64:79]
    v_mul_f32 v85, v85, v220
    ds_read_b128 v[156:159], v29 offset:19456
    v_mul_f32 v86, v86, v220
    v_mul_f32 v87, v87, v220
    v_mul_f32 v88, v88, v220
    v_mul_f32 v89, v89, v220
    v_mul_f32 v90, v90, v220
    v_mul_f32 v91, v91, v220
    v_mul_f32 v92, v92, v220
    v_mul_f32 v93, v93, v220
    v_mul_f32 v94, v94, v220
    v_mul_f32 v95, v95, v220
    s_nop 1
    v_mfma_f32_32x32x16_bf16 v[80:95], a[72:75], v[208:211], v[80:95]
    ds_read_b128 v[160:163], v30 offset:16384
    v_mul_f32 v96, v96, v220
    v_mul_f32 v97, v97, v220
    ds_read_b128 v[164:167], v30 offset:17408
    v_mul_f32 v98, v98, v220
    v_mul_f32 v99, v99, v220
    ds_read_b128 v[168:171], v30 offset:18432
    v_mul_f32 v100, v100, v220
    v_mfma_f32_32x32x16_bf16 v[80:95], a[76:79], v[212:215], v[80:95]
    v_mul_f32 v101, v101, v220
    ds_read_b128 v[172:175], v30 offset:19456
    v_mul_f32 v102, v102, v220
    v_mul_f32 v103, v103, v220
    v_mul_f32 v104, v104, v220
    v_mul_f32 v105, v105, v220
    v_mul_f32 v106, v106, v220
    v_mul_f32 v107, v107, v220
    v_mul_f32 v108, v108, v220
    v_mul_f32 v109, v109, v220
    v_mul_f32 v110, v110, v220
    v_mul_f32 v111, v111, v220
    s_nop 1
    v_mfma_f32_32x32x16_bf16 v[96:111], a[80:83], v[208:211], v[96:111]
    ds_read_b128 v[176:179], v31 offset:16384
    v_mul_f32 v112, v112, v220
    v_mul_f32 v113, v113, v220
    ds_read_b128 v[180:183], v31 offset:17408
    v_mul_f32 v114, v114, v220
    v_mul_f32 v115, v115, v220
    ds_read_b128 v[184:187], v31 offset:18432
    v_mul_f32 v116, v116, v220
    v_mfma_f32_32x32x16_bf16 v[96:111], a[84:87], v[212:215], v[96:111]
    v_mul_f32 v117, v117, v220
    ds_read_b128 v[188:191], v31 offset:19456
    v_mul_f32 v118, v118, v220
    v_mul_f32 v119, v119, v220
    v_mul_f32 v120, v120, v220
    v_mul_f32 v121, v121, v220
    v_mul_f32 v122, v122, v220
    v_mul_f32 v123, v123, v220
    v_mul_f32 v124, v124, v220
    v_mul_f32 v125, v125, v220
    v_mul_f32 v126, v126, v220
    v_mul_f32 v127, v127, v220
    s_nop 1
    v_mfma_f32_32x32x16_bf16 v[112:127], a[88:91], v[208:211], v[112:127]
    v_add_f32 v192, v192, v200
    v_add_f32 v193, v193, v201
    v_add_f32 v194, v194, v202
    v_add_f32 v195, v195, v203
    v_add_f32 v196, v196, v204
    v_add_f32 v197, v197, v205
    v_add_f32 v198, v198, v206
    v_add_f32 v199, v199, v207
    v_mfma_f32_32x32x16_bf16 v[112:127], a[92:95], v[212:215], v[112:127]
    v_add_f32 v192, v192, v196
    v_add_f32 v193, v193, v197
    v_add_f32 v194, v194, v198
    v_add_f32 v195, v195, v199
    v_add_f32 v192, v192, v193
    v_add_f32 v194, v194, v195
    v_add_f32 v192, v192, v194
    v_add_f32 v217, v217, v192
    s_waitcnt lgkmcnt(0)
    v_add_f32 v144, v144, v128
    v_add_f32 v145, v145, v129
    v_add_f32 v146, v146, v130
    v_add_f32 v147, v147, v131
    v_add_f32 v148, v148, v132
    v_add_f32 v149, v149, v133
    v_add_f32 v150, v150, v134
    v_add_f32 v151, v151, v135
    v_add_f32 v152, v152, v136
    v_add_f32 v153, v153, v137
    v_add_f32 v154, v154, v138
    v_add_f32 v155, v155, v139
    v_add_f32 v156, v156, v140
    v_add_f32 v157, v157, v141
    v_add_f32 v158, v158, v142
    v_add_f32 v159, v159, v143
    s_waitcnt lgkmcnt(0)
    ds_read_b64_tr_b16 a[64:65], v40 offset:24576
    ds_read_b64_tr_b16 a[66:67], v41 offset:26624
    v_add_f32 v160, v160, v176
    v_add_f32 v161, v161, v177
    v_add_f32 v162, v162, v178
    v_add_f32 v163, v163, v179
    v_add_f32 v164, v164, v180
    ds_read_b64_tr_b16 a[72:73], v42 offset:24576
    ds_read_b64_tr_b16 a[74:75], v43 offset:26624
    v_add_f32 v165, v165, v181
    v_add_f32 v166, v166, v182
    v_add_f32 v167, v167, v183
    v_add_f32 v168, v168, v184
    v_add_f32 v169, v169, v185
    ds_read_b64_tr_b16 a[80:81], v44 offset:24576
    ds_read_b64_tr_b16 a[82:83], v45 offset:26624
    v_add_f32 v170, v170, v186
    v_add_f32 v171, v171, v187
    v_add_f32 v172, v172, v188
    v_add_f32 v173, v173, v189
    v_add_f32 v174, v174, v190
    ds_read_b64_tr_b16 a[88:89], v46 offset:24576
    ds_read_b64_tr_b16 a[90:91], v47 offset:26624
    v_add_f32 v175, v175, v191
    v_add_f32 v144, v144, v160
    v_add_f32 v145, v145, v161
    v_add_f32 v146, v146, v162
    v_add_f32 v147, v147, v163
    ds_read_b64_tr_b16 a[68:69], v40 offset:28672
    ds_read_b64_tr_b16 a[70:71], v41 offset:30720
    v_add_f32 v148, v148, v164
    v_add_f32 v149, v149, v165
    v_add_f32 v150, v150, v166
    v_add_f32 v151, v151, v167
    v_add_f32 v152, v152, v168
    ds_read_b64_tr_b16 a[76:77], v42 offset:28672
    ds_read_b64_tr_b16 a[78:79], v43 offset:30720
    v_add_f32 v153, v153, v169
    v_add_f32 v154, v154, v170
    v_add_f32 v155, v155, v171
    v_add_f32 v156, v156, v172
    v_add_f32 v157, v157, v173
    ds_read_b64_tr_b16 a[84:85], v44 offset:28672
    ds_read_b64_tr_b16 a[86:87], v45 offset:30720
    v_add_f32 v158, v158, v174
    v_add_f32 v159, v159, v175
    v_max3_f32 v218, v144, v145, v146
    v_max3_f32 v219, v147, v148, v149
    v_max3_f32 v220, v150, v151, v152
    ds_read_b64_tr_b16 a[92:93], v46 offset:28672
    ds_read_b64_tr_b16 a[94:95], v47 offset:30720
    v_max3_f32 v221, v153, v154, v155
    v_max3_f32 v218, v218, v156, v157
    v_max3_f32 v219, v219, v158, v159
    v_max3_f32 v218, v218, v219, v220
    v_max_f32 v218, v218, v221
    v_mov_b32 v219, v218
    s_nop 1
    v_permlane32_swap_b32 v218, v219
    v_max3_f32 v218, v218, v219, v216
    v_sub_f32 v220, v216, v218
    v_mov_b32 v216, v218
    v_exp_f32 v220, v220
    v_sub_f32 v192, v144, v218
    v_sub_f32 v193, v145, v218
    v_sub_f32 v194, v146, v218
    v_sub_f32 v195, v147, v218
    v_sub_f32 v196, v148, v218
    v_sub_f32 v197, v149, v218
    v_sub_f32 v198, v150, v218
    v_sub_f32 v199, v151, v218
    v_sub_f32 v200, v152, v218
    v_sub_f32 v201, v153, v218
    v_sub_f32 v202, v154, v218
    v_sub_f32 v203, v155, v218
    v_sub_f32 v204, v156, v218
    v_sub_f32 v205, v157, v218
    v_sub_f32 v206, v158, v218
    v_sub_f32 v207, v159, v218
    v_exp_f32 v192, v192
    v_exp_f32 v193, v193
    v_exp_f32 v194, v194
    v_exp_f32 v195, v195
    v_exp_f32 v196, v196
    v_exp_f32 v197, v197
    v_exp_f32 v198, v198
    v_exp_f32 v199, v199
    v_exp_f32 v200, v200
    v_exp_f32 v201, v201
    v_exp_f32 v202, v202
    v_exp_f32 v203, v203
    v_exp_f32 v204, v204
    v_exp_f32 v205, v205
    v_exp_f32 v206, v206
    v_exp_f32 v207, v207
    v_mul_f32 v217, v217, v220
    v_cvt_pk_bf16_f32 v208, v192, v193
    v_cvt_pk_bf16_f32 v209, v194, v195
    v_cvt_pk_bf16_f32 v210, v196, v197
    v_cvt_pk_bf16_f32 v211, v198, v199
    v_cvt_pk_bf16_f32 v212, v200, v201
    v_cvt_pk_bf16_f32 v213, v202, v203
    v_cvt_pk_bf16_f32 v214, v204, v205
    v_cvt_pk_bf16_f32 v215, v206, v207
    v_mul_f32 v64, v64, v220
    v_mul_f32 v65, v65, v220
    v_mul_f32 v66, v66, v220
    v_mul_f32 v67, v67, v220
    v_mul_f32 v68, v68, v220
    v_mul_f32 v69, v69, v220
    v_mul_f32 v70, v70, v220
    v_mul_f32 v71, v71, v220
    v_mul_f32 v72, v72, v220
    v_mul_f32 v73, v73, v220
    v_mul_f32 v74, v74, v220
    v_mul_f32 v75, v75, v220
    v_mul_f32 v76, v76, v220
    v_mul_f32 v77, v77, v220
    v_mul_f32 v78, v78, v220
    v_mul_f32 v79, v79, v220
    s_waitcnt lgkmcnt(0)
    s_nop 0
    v_mfma_f32_32x32x16_bf16 v[64:79], a[64:67], v[208:211], v[64:79]
    v_mul_f32 v80, v80, v220
    v_mul_f32 v81, v81, v220
    v_mul_f32 v82, v82, v220
    v_mul_f32 v83, v83, v220
    v_mul_f32 v84, v84, v220
    v_mul_f32 v85, v85, v220
    v_mul_f32 v86, v86, v220
    v_mul_f32 v87, v87, v220
    v_mfma_f32_32x32x16_bf16 v[64:79], a[68:71], v[212:215], v[64:79]
    v_mul_f32 v88, v88, v220
    v_mul_f32 v89, v89, v220
    v_mul_f32 v90, v90, v220
    v_mul_f32 v91, v91, v220
    v_mul_f32 v92, v92, v220
    v_mul_f32 v93, v93, v220
    v_mul_f32 v94, v94, v220
    v_mul_f32 v95, v95, v220
    s_nop 1
    v_mfma_f32_32x32x16_bf16 v[80:95], a[72:75], v[208:211], v[80:95]
    v_mul_f32 v96, v96, v220
    v_mul_f32 v97, v97, v220
    v_mul_f32 v98, v98, v220
    v_mul_f32 v99, v99, v220
    v_mul_f32 v100, v100, v220
    v_mul_f32 v101, v101, v220
    v_mul_f32 v102, v102, v220
    v_mul_f32 v103, v103, v220
    v_mfma_f32_32x32x16_bf16 v[80:95], a[76:79], v[212:215], v[80:95]
    v_mul_f32 v104, v104, v220
    v_mul_f32 v105, v105, v220
    v_mul_f32 v106, v106, v220
    v_mul_f32 v107, v107, v220
    v_mul_f32 v108, v108, v220
    v_mul_f32 v109, v109, v220
    v_mul_f32 v110, v110, v220
    v_mul_f32 v111, v111, v220
    s_nop 1
    v_mfma_f32_32x32x16_bf16 v[96:111], a[80:83], v[208:211], v[96:111]
    v_mul_f32 v112, v112, v220
    v_mul_f32 v113, v113, v220
    v_mul_f32 v114, v114, v220
    v_mul_f32 v115, v115, v220
    v_mul_f32 v116, v116, v220
    v_mul_f32 v117, v117, v220
    v_mul_f32 v118, v118, v220
    v_mul_f32 v119, v119, v220
    v_mfma_f32_32x32x16_bf16 v[96:111], a[84:87], v[212:215], v[96:111]
    v_mul_f32 v120, v120, v220
    v_mul_f32 v121, v121, v220
    v_mul_f32 v122, v122, v220
    v_mul_f32 v123, v123, v220
    v_mul_f32 v124, v124, v220
    v_mul_f32 v125, v125, v220
    v_mul_f32 v126, v126, v220
    v_mul_f32 v127, v127, v220
    s_nop 1
    v_mfma_f32_32x32x16_bf16 v[112:127], a[88:91], v[208:211], v[112:127]
    v_add_f32 v192, v192, v200
    v_add_f32 v193, v193, v201
    v_add_f32 v194, v194, v202
    v_add_f32 v195, v195, v203
    v_add_f32 v196, v196, v204
    v_add_f32 v197, v197, v205
    v_add_f32 v198, v198, v206
    v_add_f32 v199, v199, v207
    v_mfma_f32_32x32x16_bf16 v[112:127], a[92:95], v[212:215], v[112:127]
    v_add_f32 v192, v192, v196
    v_add_f32 v193, v193, v197
    v_add_f32 v194, v194, v198
    v_add_f32 v195, v195, v199
    v_add_f32 v192, v192, v193
    v_add_f32 v194, v194, v195
    v_add_f32 v192, v192, v194
    v_add_f32 v217, v217, v192
    s_waitcnt lgkmcnt(0)
    v_mov_b32 v219, v217
    s_nop 1
    v_permlane32_swap_b32 v217, v219
    v_add_f32 v217, v217, v219
    v_rcp_f32 v220, v217
    v_mul_u32_u24 v5, 272, v24
    v_lshl_add_u32 v5, v25, 3, v5
    v_add_u32 v5, s63, v5
    v_mul_f32 v64, v64, v220
    v_mul_f32 v65, v65, v220
    v_mul_f32 v66, v66, v220
    v_mul_f32 v67, v67, v220
    v_mul_f32 v68, v68, v220
    v_mul_f32 v69, v69, v220
    v_mul_f32 v70, v70, v220
    v_mul_f32 v71, v71, v220
    v_mul_f32 v72, v72, v220
    v_mul_f32 v73, v73, v220
    v_mul_f32 v74, v74, v220
    v_mul_f32 v75, v75, v220
    v_mul_f32 v76, v76, v220
    v_mul_f32 v77, v77, v220
    v_mul_f32 v78, v78, v220
    v_mul_f32 v79, v79, v220
    v_mul_f32 v80, v80, v220
    v_mul_f32 v81, v81, v220
    v_mul_f32 v82, v82, v220
    v_mul_f32 v83, v83, v220
    v_mul_f32 v84, v84, v220
    v_mul_f32 v85, v85, v220
    v_mul_f32 v86, v86, v220
    v_mul_f32 v87, v87, v220
    v_mul_f32 v88, v88, v220
    v_mul_f32 v89, v89, v220
    v_mul_f32 v90, v90, v220
    v_mul_f32 v91, v91, v220
    v_mul_f32 v92, v92, v220
    v_mul_f32 v93, v93, v220
    v_mul_f32 v94, v94, v220
    v_mul_f32 v95, v95, v220
    v_mul_f32 v96, v96, v220
    v_mul_f32 v97, v97, v220
    v_mul_f32 v98, v98, v220
    v_mul_f32 v99, v99, v220
    v_mul_f32 v100, v100, v220
    v_mul_f32 v101, v101, v220
    v_mul_f32 v102, v102, v220
    v_mul_f32 v103, v103, v220
    v_mul_f32 v104, v104, v220
    v_mul_f32 v105, v105, v220
    v_mul_f32 v106, v106, v220
    v_mul_f32 v107, v107, v220
    v_mul_f32 v108, v108, v220
    v_mul_f32 v109, v109, v220
    v_mul_f32 v110, v110, v220
    v_mul_f32 v111, v111, v220
    v_mul_f32 v112, v112, v220
    v_mul_f32 v113, v113, v220
    v_mul_f32 v114, v114, v220
    v_mul_f32 v115, v115, v220
    v_mul_f32 v116, v116, v220
    v_mul_f32 v117, v117, v220
    v_mul_f32 v118, v118, v220
    v_mul_f32 v119, v119, v220
    v_mul_f32 v120, v120, v220
    v_mul_f32 v121, v121, v220
    v_mul_f32 v122, v122, v220
    v_mul_f32 v123, v123, v220
    v_mul_f32 v124, v124, v220
    v_mul_f32 v125, v125, v220
    v_mul_f32 v126, v126, v220
    v_mul_f32 v127, v127, v220
    v_cvt_pk_bf16_f32 v128, v64, v65
    v_cvt_pk_bf16_f32 v129, v66, v67
    v_cvt_pk_bf16_f32 v130, v68, v69
    v_cvt_pk_bf16_f32 v131, v70, v71
    v_cvt_pk_bf16_f32 v132, v72, v73
    v_cvt_pk_bf16_f32 v133, v74, v75
    v_cvt_pk_bf16_f32 v134, v76, v77
    v_cvt_pk_bf16_f32 v135, v78, v79
    v_cvt_pk_bf16_f32 v136, v80, v81
    v_cvt_pk_bf16_f32 v137, v82, v83
    v_cvt_pk_bf16_f32 v138, v84, v85
    v_cvt_pk_bf16_f32 v139, v86, v87
    v_cvt_pk_bf16_f32 v140, v88, v89
    v_cvt_pk_bf16_f32 v141, v90, v91
    v_cvt_pk_bf16_f32 v142, v92, v93
    v_cvt_pk_bf16_f32 v143, v94, v95
    v_cvt_pk_bf16_f32 v144, v96, v97
    v_cvt_pk_bf16_f32 v145, v98, v99
    v_cvt_pk_bf16_f32 v146, v100, v101
    v_cvt_pk_bf16_f32 v147, v102, v103
    v_cvt_pk_bf16_f32 v148, v104, v105
    v_cvt_pk_bf16_f32 v149, v106, v107
    v_cvt_pk_bf16_f32 v150, v108, v109
    v_cvt_pk_bf16_f32 v151, v110, v111
    v_cvt_pk_bf16_f32 v152, v112, v113
    v_cvt_pk_bf16_f32 v153, v114, v115
    v_cvt_pk_bf16_f32 v154, v116, v117
    v_cvt_pk_bf16_f32 v155, v118, v119
    v_cvt_pk_bf16_f32 v156, v120, v121
    v_cvt_pk_bf16_f32 v157, v122, v123
    v_cvt_pk_bf16_f32 v158, v124, v125
    v_cvt_pk_bf16_f32 v159, v126, v127
    v_min_u32 v216, -2, v216
    v_min_u32 v217, -2, v217
    s_nop 0
    v_mov_b32_dpp v218, v216 quad_perm:[1,1,3,3] row_mask:0xf bank_mask:0xf
    v_mov_b32_dpp v219, v217 quad_perm:[1,1,3,3] row_mask:0xf bank_mask:0xf
    ds_write_b64 v5, v[128:129] offset:0
    ds_write_b64 v5, v[130:131] offset:16
    ds_write_b64 v5, v[132:133] offset:32
    ds_write_b64 v5, v[134:135] offset:48
    ds_write_b64 v5, v[136:137] offset:64
    ds_write_b64 v5, v[138:139] offset:80
    ds_write_b64 v5, v[140:141] offset:96
    ds_write_b64 v5, v[142:143] offset:112
    ds_write_b64 v5, v[144:145] offset:128
    ds_write_b64 v5, v[146:147] offset:144
    ds_write_b64 v5, v[148:149] offset:160
    ds_write_b64 v5, v[150:151] offset:176
    ds_write_b64 v5, v[152:153] offset:192
    ds_write_b64 v5, v[154:155] offset:208
    ds_write_b64 v5, v[156:157] offset:224
    ds_write_b64 v5, v[158:159] offset:240
    v_mul_u32_u24 v6, 272, v4
    v_lshl_add_u32 v6, v3, 4, v6
    v_add_u32 v6, s63, v6
    s_waitcnt lgkmcnt(0)
    ds_read_b128 v[64:67], v6 offset:0
    ds_read_b128 v[68:71], v6 offset:1088
    ds_read_b128 v[72:75], v6 offset:2176
    ds_read_b128 v[76:79], v6 offset:3264
    ds_read_b128 v[80:83], v6 offset:4352
    ds_read_b128 v[84:87], v6 offset:5440
    ds_read_b128 v[88:91], v6 offset:6528
    ds_read_b128 v[92:95], v6 offset:7616
    v_lshlrev_b32 v7, 10, v4
    v_lshl_add_u32 v7, v3, 4, v7
    s_lshl_b32 s54, s53, 15
    s_lshl_b32 s55, s3, 8
    s_add_u32 s54, s54, s55
    s_add_u32 s54, s54, 2097152
    s_waitcnt lgkmcnt(7)
    buffer_store_dwordx4 v[64:67], v7, s[44:47], s54 offen sc1
    s_add_u32 s54, s54, 4096
    s_waitcnt lgkmcnt(6)
    buffer_store_dwordx4 v[68:71], v7, s[44:47], s54 offen sc1
    s_add_u32 s54, s54, 4096
    s_waitcnt lgkmcnt(5)
    buffer_store_dwordx4 v[72:75], v7, s[44:47], s54 offen sc1
    s_add_u32 s54, s54, 4096
    s_waitcnt lgkmcnt(4)
    buffer_store_dwordx4 v[76:79], v7, s[44:47], s54 offen sc1
    s_add_u32 s54, s54, 4096
    s_waitcnt lgkmcnt(3)
    buffer_store_dwordx4 v[80:83], v7, s[44:47], s54 offen sc1
    s_add_u32 s54, s54, 4096
    s_waitcnt lgkmcnt(2)
    buffer_store_dwordx4 v[84:87], v7, s[44:47], s54 offen sc1
    s_add_u32 s54, s54, 4096
    s_waitcnt lgkmcnt(1)
    buffer_store_dwordx4 v[88:91], v7, s[44:47], s54 offen sc1
    s_add_u32 s54, s54, 4096
    s_waitcnt lgkmcnt(0)
    buffer_store_dwordx4 v[92:95], v7, s[44:47], s54 offen sc1
    s_add_u32 s54, s54, 4096
    v_lshlrev_b32 v5, 3, v1
    s_lshl_b32 s54, s53, 8
    s_add_u32 s54, s54, 3145728
    s_cmp_eq_u32 s3, 0
    s_cselect_b32 s56, 0x55555555, 0
    s_mov_b32 s57, 0
    s_waitcnt vmcnt(0)
    s_barrier
    s_mov_b64 exec, s[56:57]
    buffer_store_dwordx4 v[216:219], v5, s[44:47], s54 offen sc1
    s_mov_b64 exec, -1
    s_mov_b32 s48, s26
    s_mov_b32 s49, s27
    s_mov_b32 s50, 9216
    s_mov_b32 s51, 0x20000
    s_lshl_b32 s54, s3, 5
    s_add_u32 s54, s54, s53
    s_cmp_ge_u32 s54, 72
    s_cbranch_scc1 L_nored_31
    s_waitcnt vmcnt(0)
    v_mov_b32 v48, -1
    v_mov_b32 v49, -1
    v_mov_b32 v50, -1
    v_mov_b32 v51, -1
    v_mov_b32 v52, -1
    v_mov_b32 v53, -1
    v_mov_b32 v54, -1
    v_mov_b32 v55, -1
    v_mov_b32 v56, -1
    v_mov_b32 v57, -1
    v_mov_b32 v58, -1
    v_mov_b32 v59, -1
    v_mov_b32 v60, -1
    v_mov_b32 v61, -1
    v_mov_b32 v62, -1
    v_mov_b32 v63, -1
    s_lshl_b32 s55, s54, 12
    s_add_u32 s55, s55, 4194304
    s_mul_hi_u32 s56, s54, 238609295
    s_add_u32 s56, s56, 0
    s_mul_i32 s56, s56, 1152
    s_lshl_b32 s57, s54, 6
    s_add_u32 s56, s56, s57
    v_lshlrev_b32 v5, 3, v3
    v_lshl_add_u32 v5, v4, 1, v5
    v_mov_b32 v6, 0x4000
    v_cmp_gt_u32 vcc, 8, v3
    s_nop 1
    v_cndmask_b32 v5, v6, v5, vcc
    s_mov_b64 s[4:5], -1
    s_mov_b64 s[6:7], -1
    s_mov_b64 s[8:9], -1
    s_mov_b64 s[10:11], -1
L_mpoll_32:
    s_mov_b64 exec, s[4:5]
    buffer_load_dwordx4 v[48:51], v2, s[44:47], s55 offen offset:0 sc1
    s_mov_b64 exec, s[6:7]
    buffer_load_dwordx4 v[52:55], v2, s[44:47], s55 offen offset:1024 sc1
    s_mov_b64 exec, s[8:9]
    buffer_load_dwordx4 v[56:59], v2, s[44:47], s55 offen offset:2048 sc1
    s_mov_b64 exec, s[10:11]
    buffer_load_dwordx4 v[60:63], v2, s[44:47], s55 offen offset:3072 sc1
    s_mov_b64 exec, -1
    s_waitcnt vmcnt(4)
    v_max3_u32 v32, v48, v49, v50
    v_max3_u32 v33, v52, v53, v54
    v_max3_u32 v34, v56, v57, v58
    v_max3_u32 v35, v60, v61, v62
    v_max_u32 v32, v32, v51
    v_max_u32 v33, v33, v55
    v_max_u32 v34, v34, v59
    v_max_u32 v35, v35, v63
    v_cmp_eq_u32 s[4:5], -1, v32
    v_cmp_eq_u32 s[6:7], -1, v33
    v_cmp_eq_u32 s[8:9], -1, v34
    v_cmp_eq_u32 s[10:11], -1, v35
    s_or_b64 vcc, s[4:5], s[6:7]
    s_or_b64 vcc, vcc, s[8:9]
    s_or_b64 vcc, vcc, s[10:11]
    s_cbranch_scc0 L_mpollok_33
    s_and_b64 vcc, s[4:5], s[6:7]
    s_and_b64 vcc, vcc, s[8:9]
    s_and_b64 vcc, vcc, s[10:11]
    s_cmp_eq_u64 vcc, -1
    s_cbranch_scc0 L_mpoll_32_b
    s_sleep 4
L_mpoll_32_b:
    s_sub_u32 s101, s101, 1
    s_cbranch_scc0 L_mpoll_32
    s_mov_b32 s101, 0
L_mpollok_33:
    v_add_f32 v16, v48, v52
    v_add_f32 v24, v56, v60
    v_add_f32 v18, v50, v54
    v_add_f32 v26, v58, v62
    v_add_f32 v17, v49, v53
    v_add_f32 v25, v57, v61
    v_add_f32 v19, v51, v55
    v_add_f32 v27, v59, v63
    v_add_f32 v16, v16, v24
    v_add_f32 v18, v18, v26
    v_add_f32 v17, v17, v25
    v_add_f32 v19, v19, v27
    v_permlane32_swap_b32 v16, v18
    s_nop 0
    v_permlane32_swap_b32 v17, v19
    v_add_f32 v16, v16, v18
    v_add_f32 v17, v17, v19
    s_nop 1
    v_permlane16_swap_b32 v16, v17
    v_add_f32 v16, v16, v17
    s_nop 1
    v_add_f32_dpp v16, v16, v16 row_ror:8 row_mask:0xf bank_mask:0xf
    v_cvt_pk_bf16_f32 v16, v16, v16
    buffer_store_short v16, v5, s[48:51], s56 offen
L_nored_31:
    s_endpgm
L_roleC_end:
L_exit:
    s_endpgm
.section .rodata,"a"
.p2align 6
.amdhsa_kernel concat_heads__mha_block_cached__compressed_kv_cla__decode_kernel
  .amdhsa_next_free_vgpr 512
  .amdhsa_next_free_sgpr 102
  .amdhsa_accum_offset 256
  .amdhsa_group_segment_fixed_size 0
  .amdhsa_kernarg_size 112
  .amdhsa_user_sgpr_count 2
  .amdhsa_user_sgpr_kernarg_segment_ptr 1
  .amdhsa_system_sgpr_workgroup_id_x 1
.end_amdhsa_kernel
```

```asm
; @launch grid=(256,1,1) block=(256,1,1) lds=163840
.amdgcn_target "amdgcn-amd-amdhsa--gfx950"
.text
.globl concat_heads__mha_block_cached__compressed_kv_cla__decode_kernel
.p2align 12
.p2align 8
.type concat_heads__mha_block_cached__compressed_kv_cla__decode_kernel,@function
concat_heads__mha_block_cached__compressed_kv_cla__decode_kernel:
    s_cmp_ge_u32 s2, 256
    s_cbranch_scc1 L_exit
    s_load_dwordx16 s[4:19], s[0:1], 0
    s_load_dwordx8 s[20:27], s[0:1], 64
    s_load_dwordx4 s[28:31], s[0:1], 96
    v_lshrrev_b32 v2, 6, v0
    v_and_b32 v1, 63, v0
    v_readfirstlane_b32 s3, v2
    v_and_b32 v3, 15, v0
    v_bfe_u32 v4, v0, 4, 2
    v_lshlrev_b32 v2, 4, v1
    s_add_u32 s52, s2, 1
    s_and_b32 s52, s52, 31
    s_mov_b32 s53, s52
    s_cmp_lt_u32 s2, 32
    s_cbranch_scc1 L_roleH
    s_cmp_lt_u32 s2, 64
    s_cbranch_scc1 L_roleC
L_roleA:
    s_sub_u32 s54, s2, 64
    s_mul_hi_u32 s96, s54, 178956971
    s_mul_i32 s56, s96, 24
    s_sub_u32 s97, s54, s56
    s_lshr_b32 s55, s97, 3
    s_add_u32 s3, s3, s97
    s_add_u32 s3, s3, s55
    s_and_b32 s3, s3, 3
    s_add_u32 s56, s96, s3
    s_and_b32 s56, s56, 3
    s_lshr_b32 s55, s97, 3
    s_and_b32 s53, s97, 7
    s_lshl_b32 s96, s96, 2
    s_add_u32 s55, s55, s56
    s_add_u32 s55, s55, 1
    s_and_b32 s55, s55, 3
    s_add_u32 s52, s96, s55
    s_add_u32 s96, s96, s56
    s_lshl_b32 s100, s53, 11
    s_and_b32 s100, s100, 0x800
    s_lshl_b32 s55, s53, 12
    s_and_b32 s55, s55, 0x6000
    s_or_b32 s100, s100, s55
    s_lshl_b32 s55, s3, 25
    s_or_b32 s100, s100, s55
    s_lshl_b32 s55, s52, 20
    s_or_b32 s100, s100, s55
    s_lshl_b32 s58, s52, 2
    s_add_u32 s58, s58, s3
    s_mul_i32 s58, s58, 0
    s_lshl_b32 s61, s58, 9
    s_and_b32 s61, s61, 0x600
    s_lshl_b32 s55, s58, 15
    s_and_b32 s55, s55, 0xe0000
    s_or_b32 s61, s61, s55
    s_mov_b32 s58, 393216
    s_mov_b32 s59, 1048576
    s_and_b32 s99, s96, 28
    s_add_u32 s99, s99, s3
    s_mul_i32 s99, s99, 37
    s_mov_b32 s63, s53
    s_getpc_b64 s[56:57]
L_pc_1:
    s_sub_u32 s56, s56, L_pc_1-L_roleA
    s_subb_u32 s57, s57, 0
    v_lshlrev_b32 v5, 7, v0
    v_min_u32 v6, L_roleA_end-L_roleA-4, v5
    global_load_dword v56, v6, s[56:57]
    s_mov_b32 s53, 536870912
    v_cmp_eq_u32 vcc, 0, v1
    v_lshlrev_b32 v0, 4, v3
    v_and_b32 v5, 1, v4
    v_lshl_add_u32 v0, v5, 8, v0
    v_lshrrev_b32 v5, 1, v4
    v_lshl_add_u32 v0, v5, 12, v0
    v_add_u32 v18, 32768, v0
    v_add_u32 v48, 65536, v0
    v_add_u32 v49, 98304, v0
    s_waitcnt lgkmcnt(0)
    s_mov_b32 s32, s6
    s_mov_b32 s33, s7
    s_mov_b32 s34, 134217728
    s_mov_b32 s35, 0x20000
    s_mov_b32 s36, s8
    s_mov_b32 s37, s9
    s_mov_b32 s38, 134217728
    s_mov_b32 s39, 0x20000
    s_mov_b32 s44, s30
    s_mov_b32 s45, s31
    s_mov_b32 s46, 536870912
    s_mov_b32 s47, 0x20000
    s_or_b32 s60, s61, s100
    s_or_b32 s61, s61, 0xfff1f9ff
    s_add_u32 s61, s61, 1
    s_and_b32 s61, s61, 0xe0600
    buffer_load_dwordx4 v[96:99], v0, s[32:35], s60 offen nt
    buffer_load_dwordx4 v[100:103], v18, s[32:35], s60 offen nt
    buffer_load_dwordx4 v[104:107], v48, s[32:35], s60 offen nt
    buffer_load_dwordx4 v[108:111], v49, s[32:35], s60 offen nt
    buffer_load_dwordx4 a[32:35], v0, s[36:39], s60 offen nt
    buffer_load_dwordx4 a[36:39], v18, s[36:39], s60 offen nt
    buffer_load_dwordx4 a[40:43], v48, s[36:39], s60 offen nt
    buffer_load_dwordx4 a[44:47], v49, s[36:39], s60 offen nt
    s_or_b32 s60, s61, s100
    s_or_b32 s61, s61, 0xfff1f9ff
    s_add_u32 s61, s61, 1
    s_and_b32 s61, s61, 0xe0600
    buffer_load_dwordx4 v[112:115], v0, s[32:35], s60 offen nt
    buffer_load_dwordx4 v[116:119], v18, s[32:35], s60 offen nt
    buffer_load_dwordx4 v[120:123], v48, s[32:35], s60 offen nt
    buffer_load_dwordx4 v[124:127], v49, s[32:35], s60 offen nt
    buffer_load_dwordx4 a[48:51], v0, s[36:39], s60 offen nt
    buffer_load_dwordx4 a[52:55], v18, s[36:39], s60 offen nt
    buffer_load_dwordx4 a[56:59], v48, s[36:39], s60 offen nt
    buffer_load_dwordx4 a[60:63], v49, s[36:39], s60 offen nt
    s_or_b32 s60, s61, s100
    s_or_b32 s61, s61, 0xfff1f9ff
    s_add_u32 s61, s61, 1
    s_and_b32 s61, s61, 0xe0600
    buffer_load_dwordx4 v[128:131], v0, s[32:35], s60 offen nt
    buffer_load_dwordx4 v[132:135], v18, s[32:35], s60 offen nt
    buffer_load_dwordx4 v[136:139], v48, s[32:35], s60 offen nt
    buffer_load_dwordx4 v[140:143], v49, s[32:35], s60 offen nt
    buffer_load_dwordx4 a[64:67], v0, s[36:39], s60 offen nt
    buffer_load_dwordx4 a[68:71], v18, s[36:39], s60 offen nt
    buffer_load_dwordx4 a[72:75], v48, s[36:39], s60 offen nt
    buffer_load_dwordx4 a[76:79], v49, s[36:39], s60 offen nt
    s_or_b32 s60, s61, s100
    s_or_b32 s61, s61, 0xfff1f9ff
    s_add_u32 s61, s61, 1
    s_and_b32 s61, s61, 0xe0600
    buffer_load_dwordx4 v[144:147], v0, s[32:35], s60 offen nt
    buffer_load_dwordx4 v[148:151], v18, s[32:35], s60 offen nt
    buffer_load_dwordx4 v[152:155], v48, s[32:35], s60 offen nt
    buffer_load_dwordx4 v[156:159], v49, s[32:35], s60 offen nt
    buffer_load_dwordx4 a[80:83], v0, s[36:39], s60 offen nt
    buffer_load_dwordx4 a[84:87], v18, s[36:39], s60 offen nt
    buffer_load_dwordx4 a[88:91], v48, s[36:39], s60 offen nt
    buffer_load_dwordx4 a[92:95], v49, s[36:39], s60 offen nt
    s_or_b32 s60, s61, s100
    s_or_b32 s61, s61, 0xfff1f9ff
    s_add_u32 s61, s61, 1
    s_and_b32 s61, s61, 0xe0600
    buffer_load_dwordx4 v[160:163], v0, s[32:35], s60 offen nt
    buffer_load_dwordx4 v[164:167], v18, s[32:35], s60 offen nt
    buffer_load_dwordx4 v[168:171], v48, s[32:35], s60 offen nt
    buffer_load_dwordx4 v[172:175], v49, s[32:35], s60 offen nt
    buffer_load_dwordx4 a[96:99], v0, s[36:39], s60 offen nt
    buffer_load_dwordx4 a[100:103], v18, s[36:39], s60 offen nt
    buffer_load_dwordx4 a[104:107], v48, s[36:39], s60 offen nt
    buffer_load_dwordx4 a[108:111], v49, s[36:39], s60 offen nt
    s_or_b32 s60, s61, s100
    s_or_b32 s61, s61, 0xfff1f9ff
    s_add_u32 s61, s61, 1
    s_and_b32 s61, s61, 0xe0600
    buffer_load_dwordx4 v[176:179], v0, s[32:35], s60 offen nt
    buffer_load_dwordx4 v[180:183], v18, s[32:35], s60 offen nt
    buffer_load_dwordx4 v[184:187], v48, s[32:35], s60 offen nt
    buffer_load_dwordx4 v[188:191], v49, s[32:35], s60 offen nt
    buffer_load_dwordx4 a[112:115], v0, s[36:39], s60 offen nt
    buffer_load_dwordx4 a[116:119], v18, s[36:39], s60 offen nt
    buffer_load_dwordx4 a[120:123], v48, s[36:39], s60 offen nt
    buffer_load_dwordx4 a[124:127], v49, s[36:39], s60 offen nt
    s_or_b32 s60, s61, s100
    s_or_b32 s61, s61, 0xfff1f9ff
    s_add_u32 s61, s61, 1
    s_and_b32 s61, s61, 0xe0600
    buffer_load_dwordx4 v[192:195], v0, s[32:35], s60 offen nt
    buffer_load_dwordx4 v[196:199], v18, s[32:35], s60 offen nt
    buffer_load_dwordx4 v[200:203], v48, s[32:35], s60 offen nt
    buffer_load_dwordx4 v[204:207], v49, s[32:35], s60 offen nt
    buffer_load_dwordx4 a[128:131], v0, s[36:39], s60 offen nt
    buffer_load_dwordx4 a[132:135], v18, s[36:39], s60 offen nt
    buffer_load_dwordx4 a[136:139], v48, s[36:39], s60 offen nt
    buffer_load_dwordx4 a[140:143], v49, s[36:39], s60 offen nt
    s_sub_u32 s23, s2, 64
    s_and_b32 s26, s23, 7
    s_lshr_b32 s23, s23, 3
    s_mul_i32 s27, s23, 43
    s_lshr_b32 s27, s27, 8
    s_lshl_b32 s26, s26, 2
    s_add_u32 s26, s26, s27
    s_mul_i32 s27, s27, 6
    s_sub_u32 s23, s23, s27
    v_mov_b32 v58, 0
    s_load_dword s18, s[28:29], 0
    s_waitcnt vmcnt(48)
    s_or_b32 s60, s61, s100
    s_or_b32 s61, s61, 0xfff1f9ff
    s_add_u32 s61, s61, 1
    s_and_b32 s61, s61, 0xe0600
    buffer_load_dwordx4 v[208:211], v0, s[32:35], s60 offen nt
    buffer_load_dwordx4 v[212:215], v18, s[32:35], s60 offen nt
    buffer_load_dwordx4 v[216:219], v48, s[32:35], s60 offen nt
    buffer_load_dwordx4 v[220:223], v49, s[32:35], s60 offen nt
    buffer_load_dwordx4 a[144:147], v0, s[36:39], s60 offen nt
    buffer_load_dwordx4 a[148:151], v18, s[36:39], s60 offen nt
    buffer_load_dwordx4 a[152:155], v48, s[36:39], s60 offen nt
    buffer_load_dwordx4 a[156:159], v49, s[36:39], s60 offen nt
    s_waitcnt vmcnt(48)
    s_or_b32 s60, s61, s100
    s_or_b32 s61, s61, 0xfff1f9ff
    s_add_u32 s61, s61, 1
    s_and_b32 s61, s61, 0xe0600
    buffer_load_dwordx4 v[224:227], v0, s[32:35], s60 offen nt
    buffer_load_dwordx4 v[228:231], v18, s[32:35], s60 offen nt
    buffer_load_dwordx4 v[232:235], v48, s[32:35], s60 offen nt
    buffer_load_dwordx4 v[236:239], v49, s[32:35], s60 offen nt
    buffer_load_dwordx4 a[160:163], v0, s[36:39], s60 offen nt
    buffer_load_dwordx4 a[164:167], v18, s[36:39], s60 offen nt
    buffer_load_dwordx4 a[168:171], v48, s[36:39], s60 offen nt
    buffer_load_dwordx4 a[172:175], v49, s[36:39], s60 offen nt
    v_and_b32 v5, 1, v3
    v_cmp_eq_u32 vcc, 1, v5
    v_mov_b32 v5, 0xffff
    v_mov_b32 v6, 0xffff0000
    v_cndmask_b32 v5, v5, v6, vcc
    v_lshrrev_b32 v6, 1, v3
    v_cmp_eq_u32 vcc, 0, v6
    s_nop 1
    v_cndmask_b32 v8, 0, v5, vcc
    v_cmp_eq_u32 vcc, 1, v6
    s_nop 1
    v_cndmask_b32 v9, 0, v5, vcc
    v_cmp_eq_u32 vcc, 2, v6
    s_nop 1
    v_cndmask_b32 v10, 0, v5, vcc
    v_cmp_eq_u32 vcc, 3, v6
    s_nop 1
    v_cndmask_b32 v11, 0, v5, vcc
    s_bitcmp1_b32 s23, 0
    s_cselect_b32 s40, s24, s12
    s_cselect_b32 s41, s25, s13
    s_cselect_b32 s25, 524288, 0
    s_add_u32 s25, s25, 4194304
    s_mov_b32 s42, 4718592
    s_mov_b32 s43, 0x20000
    s_lshr_b32 s54, s23, 1
    s_mul_i32 s54, s54, 3
    s_add_u32 s54, s54, s3
    s_and_b32 s23, s23, 1
    s_mul_i32 s24, s26, 147456
    s_lshl_b32 s55, s54, 7
    s_add_u32 s24, s24, s55
    s_lshl_b32 s54, s54, 13
    s_lshl_b32 s55, s26, 7
    s_add_u32 s54, s54, s55
    s_add_u32 s25, s25, s54
    s_lshl_b32 s27, s26, 10
    s_add_u32 s27, s27, 5439488
    s_lshl_b32 s22, s26, 2
    s_add_u32 s22, s22, s3
    s_lshl_b32 s22, s22, 13
    s_add_u32 s22, s22, 8388608
    s_lshr_b32 s55, s26, 2
    s_add_u32 s55, s55, s3
    s_and_b32 s55, s55, 3
    s_and_b32 s54, s26, 3
    s_cmp_eq_u32 s54, s55
    s_cselect_b32 s54, 7, 1
    s_cselect_b32 s55, 5, 1
    s_cselect_b32 s26, 2, 0
    s_or_b32 s23, s23, s26
    v_and_b32 v30, s54, v3
    v_min_u32 v30, s55, v30
    v_lshl_add_u32 v30, v30, 2, v4
    v_lshlrev_b32 v30, 4, v30
    v_add_u32 v30, 6144, v30
    v_lshrrev_b32 v19, 3, v3
    v_lshl_add_u32 v19, v19, 2, v4
    v_mul_u32_u24 v19, 9216, v19
    v_and_b32 v5, 7, v3
    v_lshl_add_u32 v19, v5, 4, v19
    v_mov_b32 v12, 0
    v_mov_b32 v13, 0
    v_mov_b32 v14, 0
    v_mov_b32 v15, 0
    v_mov_b32 v16, 0xff800000
    v_mov_b32 v17, 0
    v_lshlrev_b32 v59, 4, v3
    v_and_b32 v5, 1, v4
    s_lshl_b32 s54, s52, 2
    s_add_u32 s54, s54, s3
    s_lshl_b32 s54, s54, 13
    s_lshl_b32 s55, s96, 2
    s_add_u32 s55, s55, s3
    s_lshl_b32 s55, s55, 13
    v_cmp_eq_u32 vcc, 1, v5
    v_mov_b32 v6, s54
    v_mov_b32 v7, s55
    v_cndmask_b32 v6, v6, v7, vcc
    v_mov_b32 v20, s63
    v_mov_b32 v7, s97
    v_cndmask_b32 v7, v20, v7, vcc
    v_lshl_add_u32 v20, v7, 4, v3
    v_lshl_add_u32 v20, v20, 4, v6
    v_lshl_add_u32 v21, v7, 4, v6
    v_add_u32 v21, 6144, v21
    v_mov_b32 v7, s53
    v_cmp_eq_u32 vcc, 0, v3
    s_nop 1
    v_cndmask_b32 v21, v7, v21, vcc
    v_cmp_gt_u32 vcc, 32, v1
    s_nop 1
    v_cndmask_b32 v3, v21, v20, vcc
    s_mov_b32 s8, 919040
    s_mov_b32 s9, s100
    s_mov_b32 s10, 0xff000
    s_lshl_b32 s11, s3, 25
    s_lshl_b32 s54, s96, 20
    s_add_u32 s11, s11, s54
    s_andn2_b32 s9, s9, 0x6000
    s_lshl_b32 s54, s63, 13
    s_and_b32 s54, s54, 0x4000
    s_or_b32 s9, s9, s54
    s_lshl_b32 s54, s63, 11
    s_lshr_b32 s55, s100, 8
    s_xor_b32 s54, s54, s55
    s_and_b32 s54, s54, 0x2000
    s_or_b32 s9, s9, s54
    s_and_b32 s57, s96, 28
    s_add_u32 s57, s57, s3
    s_mul_i32 s57, s57, 256
    s_add_u32 s57, s57, 16777216
    s_lshl_b32 s54, s3, 8
    s_add_u32 s54, s54, 5242880
    s_lshl_b32 s56, s52, 10
    s_add_u32 s56, s56, s54
    s_lshl_b32 s12, s96, 10
    s_add_u32 s12, s12, s54
    s_mov_b32 s13, 0
    s_add_u32 s15, s59, 65536
    s_sub_u32 s14, s15, 131072
    s_mov_b32 s96, 1035273459
    s_mov_b32 s97, 1069066811
    s_mov_b32 s98, 0xffff0000
    s_mov_b32 s62, 2
    s_mov_b32 s101, 100000
    s_waitcnt lgkmcnt(0)
    s_cmp_lt_u32 s18, 1073741824
    s_cbranch_scc1 L_aflag
L_aflag_ok:
    s_and_b32 s54, s18, 0xfff
    s_bfe_u32 s55, s18, 0xc000c
    s_min_u32 s17, s54, s55
    s_max_u32 s54, s54, s55
    s_xor_b32 s55, s9, 0x2000
    s_cmp_ge_u32 s17, 42
    s_cselect_b32 s9, s9, s100
    s_cmp_le_u32 s54, 22
    s_cselect_b32 s9, s55, s9
    s_mov_b32 s18, 20
    s_mov_b64 s[6:7], s[8:9]
    s_mov_b32 s63, 0
    s_cmp_eq_u32 s3, 3
    s_cselect_b32 s19, -1, 256
    buffer_load_dwordx4 v[60:63], v59, s[44:47], s56 offen sc1
    s_waitcnt vmcnt(49)
    s_or_b32 s60, s61, s100
    s_or_b32 s61, s61, 0xfff1f9ff
    s_add_u32 s61, s61, 1
    s_and_b32 s61, s61, 0xe0600
    buffer_load_dwordx4 v[240:243], v0, s[32:35], s60 offen nt
    buffer_load_dwordx4 v[244:247], v18, s[32:35], s60 offen nt
    buffer_load_dwordx4 v[248:251], v48, s[32:35], s60 offen nt
    buffer_load_dwordx4 v[252:255], v49, s[32:35], s60 offen nt
    buffer_load_dwordx4 a[176:179], v0, s[36:39], s60 offen nt
    buffer_load_dwordx4 a[180:183], v18, s[36:39], s60 offen nt
    buffer_load_dwordx4 a[184:187], v48, s[36:39], s60 offen nt
    buffer_load_dwordx4 a[188:191], v49, s[36:39], s60 offen nt
    s_waitcnt vmcnt(49)
    s_or_b32 s60, s61, s100
    s_or_b32 s61, s61, 0xfff1f9ff
    s_add_u32 s61, s61, 1
    s_and_b32 s61, s61, 0xe0600
    buffer_load_dwordx4 v[64:67], v0, s[32:35], s60 offen nt
    buffer_load_dwordx4 v[68:71], v18, s[32:35], s60 offen nt
    buffer_load_dwordx4 v[72:75], v48, s[32:35], s60 offen nt
    buffer_load_dwordx4 v[76:79], v49, s[32:35], s60 offen nt
    buffer_load_dwordx4 a[0:3], v0, s[36:39], s60 offen nt
    buffer_load_dwordx4 a[4:7], v18, s[36:39], s60 offen nt
    buffer_load_dwordx4 a[8:11], v48, s[36:39], s60 offen nt
    buffer_load_dwordx4 a[12:15], v49, s[36:39], s60 offen nt
    s_waitcnt vmcnt(49)
    s_or_b32 s60, s61, s100
    s_or_b32 s61, s61, 0xfff1f9ff
    s_add_u32 s61, s61, 1
    s_and_b32 s61, s61, 0xe0600
    buffer_load_dwordx4 v[80:83], v0, s[32:35], s60 offen nt
    buffer_load_dwordx4 v[84:87], v18, s[32:35], s60 offen nt
    buffer_load_dwordx4 v[88:91], v48, s[32:35], s60 offen nt
    buffer_load_dwordx4 v[92:95], v49, s[32:35], s60 offen nt
    buffer_load_dwordx4 a[16:19], v0, s[36:39], s60 offen nt
    buffer_load_dwordx4 a[20:23], v18, s[36:39], s60 offen nt
    buffer_load_dwordx4 a[24:27], v48, s[36:39], s60 offen nt
    buffer_load_dwordx4 a[28:31], v49, s[36:39], s60 offen nt
    s_waitcnt vmcnt(24)
L_aq1:
    v_max3_u32 v20, v60, v61, v62
    v_max_u32 v20, v20, v63
    v_cmp_eq_u32 vcc, -1, v20
    s_cbranch_vccz L_aq1_ok
    buffer_load_dwordx4 v[60:63], v59, s[44:47], s56 offen sc1
    s_waitcnt vmcnt(0)
    s_sub_u32 s101, s101, 1
    s_cbranch_scc0 L_aq1
    s_mov_b32 s101, 0
L_aq1_ok:
    v_mov_b32 v4, v60
    v_mov_b32 v5, v61
    v_mov_b32 v6, v62
    v_mov_b32 v7, v63
    s_mov_b32 s56, 1
L_aloop:
    s_waitcnt vmcnt(12)
    v_dot2_f32_bf16 v20, v64, v4, 0
    v_dot2_f32_bf16 v21, v68, v4, 0
    v_dot2_f32_bf16 v22, v72, v4, 0
    v_dot2_f32_bf16 v23, v76, v4, 0
    v_dot2_f32_bf16 v20, v65, v5, v20
    v_dot2_f32_bf16 v21, v69, v5, v21
    v_dot2_f32_bf16 v22, v73, v5, v22
    v_dot2_f32_bf16 v23, v77, v5, v23
    v_dot2_f32_bf16 v20, v66, v6, v20
    v_dot2_f32_bf16 v21, v70, v6, v21
    v_dot2_f32_bf16 v22, v74, v6, v22
    v_dot2_f32_bf16 v23, v78, v6, v23
    v_dot2_f32_bf16 v20, v67, v7, v20
    v_dot2_f32_bf16 v21, v71, v7, v21
    v_dot2_f32_bf16 v22, v75, v7, v22
    v_dot2_f32_bf16 v23, v79, v7, v23
    s_cmp_lg_u32 s18, 0
    s_cbranch_scc1 L_have_2
    s_waitcnt lgkmcnt(0)
    s_mov_b32 s17, s16
    s_mov_b32 s18, 1
    s_min_u32 s54, s16, 68
    s_cselect_b32 s18, 2, s18
    s_mul_i32 s54, s54, 1
    s_add_u32 s17, s17, s54
    s_min_u32 s54, s16, 28
    s_cselect_b32 s18, 4, s18
    s_mul_i32 s54, s54, 2
    s_add_u32 s17, s17, s54
    s_cmp_ge_u32 s17, s19
    s_cbranch_scc1 L_adrain0
    s_add_u32 s54, s17, s99
    s_lshl_b32 s61, s54, 9
    s_and_b32 s61, s61, 0xe00
    s_lshl_b32 s55, s54, 10
    s_and_b32 s55, s55, 0x6000
    s_or_b32 s61, s61, s55
    s_lshl_b32 s55, s54, 12
    s_and_b32 s55, s55, 0xe0000
    s_or_b32 s61, s61, s55
    s_cmp_lt_u32 s17, 256
    s_cselect_b32 s7, s11, 0x8000000
    s_cselect_b32 s18, s18, 9
    s_cselect_b32 s63, 0, 1
    s_mov_b32 s6, 0xe6e00
L_have_2:
    s_or_b32 s60, s61, s7
    buffer_load_dwordx4 v[64:67], v0, s[32:35], s60 offen nt
    buffer_load_dwordx4 v[68:71], v18, s[32:35], s60 offen nt
    buffer_load_dwordx4 v[72:75], v48, s[32:35], s60 offen nt
    buffer_load_dwordx4 v[76:79], v49, s[32:35], s60 offen nt
    s_orn2_b32 s61, s61, s6
    s_add_u32 s61, s61, 1
    s_and_b32 s61, s61, s6
    s_add_u32 s58, s58, 32768
    s_sub_u32 s18, s18, 1
    s_sub_u32 s62, s62, s63
    v_add_f32_dpp v24, v20, v20 row_ror:8 row_mask:0xf bank_mask:0x3
    v_add_f32_dpp v25, v22, v22 row_ror:8 row_mask:0xf bank_mask:0x3
    v_add_f32_dpp v24, v21, v21 row_ror:8 row_mask:0xf bank_mask:0xc
    v_add_f32_dpp v25, v23, v23 row_ror:8 row_mask:0xf bank_mask:0xc
    s_nop 0
    v_add_f32_dpp v26, v24, v24 row_shl:4 row_mask:0xf bank_mask:0x5
    v_add_f32_dpp v26, v25, v25 row_shr:4 row_mask:0xf bank_mask:0xa
    s_nop 1
    v_add_f32_dpp v26, v26, v26 quad_perm:[1,0,3,2] row_mask:0xf bank_mask:0xf
    s_nop 1
    v_add_f32_dpp v26, v26, v26 quad_perm:[2,3,0,1] row_mask:0xf bank_mask:0xf
    v_cvt_pk_bf16_f32 v26, v26, v26
    v_and_b32 v26, s98, v26
    v_mul_f32 v26, s96, v26
    v_cvt_pk_bf16_f32 v26, v26, v26
    v_and_b32 v26, s98, v26
    s_nop 1
    v_max_f32_dpp v27, v26, v26 row_ror:4 row_mask:0xf bank_mask:0xf
    s_nop 1
    v_max_f32_dpp v27, v27, v27 row_ror:8 row_mask:0xf bank_mask:0xf
    v_mov_b32 v28, v27
    s_nop 1
    v_permlane16_swap_b32 v27, v28
    v_max_f32 v27, v27, v28
    v_mov_b32 v28, v27
    s_nop 1
    v_permlane32_swap_b32 v27, v28
    v_max3_f32 v27, v27, v28, v16
    v_sub_f32 v28, v16, v27
    v_sub_f32 v29, v26, v27
    v_mul_f32 v28, s97, v28
    v_mul_f32 v29, s97, v29
    v_exp_f32 v28, v28
    v_exp_f32 v29, v29
    v_mov_b32 v16, v27
    v_fma_f32 v17, v17, v28, v29
    v_cvt_pk_bf16_f32 v29, v29, v29
    v_mul_f32 v12, v12, v28
    v_mul_f32 v13, v13, v28
    v_mul_f32 v14, v14, v28
    v_mul_f32 v15, v15, v28
    s_waitcnt vmcnt(12)
    v_and_b32_dpp v32, v29, v8 row_newbcast:0 row_mask:0xf bank_mask:0xf
    v_and_b32_dpp v33, v29, v9 row_newbcast:0 row_mask:0xf bank_mask:0xf
    v_and_b32_dpp v34, v29, v10 row_newbcast:0 row_mask:0xf bank_mask:0xf
    v_and_b32_dpp v35, v29, v11 row_newbcast:0 row_mask:0xf bank_mask:0xf
    v_and_b32_dpp v36, v29, v8 row_newbcast:8 row_mask:0xf bank_mask:0xf
    v_and_b32_dpp v37, v29, v9 row_newbcast:8 row_mask:0xf bank_mask:0xf
    v_and_b32_dpp v38, v29, v10 row_newbcast:8 row_mask:0xf bank_mask:0xf
    v_and_b32_dpp v39, v29, v11 row_newbcast:8 row_mask:0xf bank_mask:0xf
    v_and_b32_dpp v40, v29, v8 row_newbcast:4 row_mask:0xf bank_mask:0xf
    v_and_b32_dpp v41, v29, v9 row_newbcast:4 row_mask:0xf bank_mask:0xf
    v_and_b32_dpp v42, v29, v10 row_newbcast:4 row_mask:0xf bank_mask:0xf
    v_and_b32_dpp v43, v29, v11 row_newbcast:4 row_mask:0xf bank_mask:0xf
    v_and_b32_dpp v44, v29, v8 row_newbcast:12 row_mask:0xf bank_mask:0xf
    v_and_b32_dpp v45, v29, v9 row_newbcast:12 row_mask:0xf bank_mask:0xf
    v_and_b32_dpp v46, v29, v10 row_newbcast:12 row_mask:0xf bank_mask:0xf
    v_and_b32_dpp v47, v29, v11 row_newbcast:12 row_mask:0xf bank_mask:0xf
    v_mfma_f32_16x16x32_bf16 v[12:15], v[32:35], a[0:3], v[12:15]
    v_mfma_f32_16x16x32_bf16 v[12:15], v[36:39], a[4:7], v[12:15]
    v_mfma_f32_16x16x32_bf16 v[12:15], v[40:43], a[8:11], v[12:15]
    v_mfma_f32_16x16x32_bf16 v[12:15], v[44:47], a[12:15], v[12:15]
    buffer_load_dwordx4 a[0:3], v0, s[36:39], s60 offen nt
    buffer_load_dwordx4 a[4:7], v18, s[36:39], s60 offen nt
    buffer_load_dwordx4 a[8:11], v48, s[36:39], s60 offen nt
    buffer_load_dwordx4 a[12:15], v49, s[36:39], s60 offen nt
    s_cmp_eq_u32 s18, 0
    s_cbranch_scc0 L_notk_3
    s_mov_b32 s16, 1
    s_atomic_add s16, s[30:31], s57 glc
L_notk_3:
    s_cmp_eq_u32 s62, 0
    s_cbranch_scc1 L_adone
    s_cmp_lg_u32 s56, 0
    s_cbranch_scc1 L_aext0
L_aback0:
    s_waitcnt vmcnt(12)
    v_dot2_f32_bf16 v20, v80, v4, 0
    v_dot2_f32_bf16 v21, v84, v4, 0
    v_dot2_f32_bf16 v22, v88, v4, 0
    v_dot2_f32_bf16 v23, v92, v4, 0
    v_dot2_f32_bf16 v20, v81, v5, v20
    v_dot2_f32_bf16 v21, v85, v5, v21
    v_dot2_f32_bf16 v22, v89, v5, v22
    v_dot2_f32_bf16 v23, v93, v5, v23
    v_dot2_f32_bf16 v20, v82, v6, v20
    v_dot2_f32_bf16 v21, v86, v6, v21
    v_dot2_f32_bf16 v22, v90, v6, v22
    v_dot2_f32_bf16 v23, v94, v6, v23
    v_dot2_f32_bf16 v20, v83, v7, v20
    v_dot2_f32_bf16 v21, v87, v7, v21
    v_dot2_f32_bf16 v22, v91, v7, v22
    v_dot2_f32_bf16 v23, v95, v7, v23
    s_cmp_lg_u32 s18, 0
    s_cbranch_scc1 L_have_4
    s_waitcnt lgkmcnt(0)
    s_mov_b32 s17, s16
    s_mov_b32 s18, 1
    s_min_u32 s54, s16, 68
    s_cselect_b32 s18, 2, s18
    s_mul_i32 s54, s54, 1
    s_add_u32 s17, s17, s54
    s_min_u32 s54, s16, 28
    s_cselect_b32 s18, 4, s18
    s_mul_i32 s54, s54, 2
    s_add_u32 s17, s17, s54
    s_cmp_ge_u32 s17, s19
    s_cbranch_scc1 L_adrain1
    s_add_u32 s54, s17, s99
    s_lshl_b32 s61, s54, 9
    s_and_b32 s61, s61, 0xe00
    s_lshl_b32 s55, s54, 10
    s_and_b32 s55, s55, 0x6000
    s_or_b32 s61, s61, s55
    s_lshl_b32 s55, s54, 12
    s_and_b32 s55, s55, 0xe0000
    s_or_b32 s61, s61, s55
    s_cmp_lt_u32 s17, 256
    s_cselect_b32 s7, s11, 0x8000000
    s_cselect_b32 s18, s18, 9
    s_cselect_b32 s63, 0, 1
    s_mov_b32 s6, 0xe6e00
L_have_4:
    s_or_b32 s60, s61, s7
    buffer_load_dwordx4 v[80:83], v0, s[32:35], s60 offen nt
    buffer_load_dwordx4 v[84:87], v18, s[32:35], s60 offen nt
    buffer_load_dwordx4 v[88:91], v48, s[32:35], s60 offen nt
    buffer_load_dwordx4 v[92:95], v49, s[32:35], s60 offen nt
    s_orn2_b32 s61, s61, s6
    s_add_u32 s61, s61, 1
    s_and_b32 s61, s61, s6
    s_add_u32 s58, s58, 32768
    s_sub_u32 s18, s18, 1
    s_sub_u32 s62, s62, s63
    v_add_f32_dpp v24, v20, v20 row_ror:8 row_mask:0xf bank_mask:0x3
    v_add_f32_dpp v25, v22, v22 row_ror:8 row_mask:0xf bank_mask:0x3
    v_add_f32_dpp v24, v21, v21 row_ror:8 row_mask:0xf bank_mask:0xc
    v_add_f32_dpp v25, v23, v23 row_ror:8 row_mask:0xf bank_mask:0xc
    s_nop 0
    v_add_f32_dpp v26, v24, v24 row_shl:4 row_mask:0xf bank_mask:0x5
    v_add_f32_dpp v26, v25, v25 row_shr:4 row_mask:0xf bank_mask:0xa
    s_nop 1
    v_add_f32_dpp v26, v26, v26 quad_perm:[1,0,3,2] row_mask:0xf bank_mask:0xf
    s_nop 1
    v_add_f32_dpp v26, v26, v26 quad_perm:[2,3,0,1] row_mask:0xf bank_mask:0xf
    v_cvt_pk_bf16_f32 v26, v26, v26
    v_and_b32 v26, s98, v26
    v_mul_f32 v26, s96, v26
    v_cvt_pk_bf16_f32 v26, v26, v26
    v_and_b32 v26, s98, v26
    s_nop 1
    v_max_f32_dpp v27, v26, v26 row_ror:4 row_mask:0xf bank_mask:0xf
    s_nop 1
    v_max_f32_dpp v27, v27, v27 row_ror:8 row_mask:0xf bank_mask:0xf
    v_mov_b32 v28, v27
    s_nop 1
    v_permlane16_swap_b32 v27, v28
    v_max_f32 v27, v27, v28
    v_mov_b32 v28, v27
    s_nop 1
    v_permlane32_swap_b32 v27, v28
    v_max3_f32 v27, v27, v28, v16
    v_sub_f32 v28, v16, v27
    v_sub_f32 v29, v26, v27
    v_mul_f32 v28, s97, v28
    v_mul_f32 v29, s97, v29
    v_exp_f32 v28, v28
    v_exp_f32 v29, v29
    v_mov_b32 v16, v27
    v_fma_f32 v17, v17, v28, v29
    v_cvt_pk_bf16_f32 v29, v29, v29
    v_mul_f32 v12, v12, v28
    v_mul_f32 v13, v13, v28
    v_mul_f32 v14, v14, v28
    v_mul_f32 v15, v15, v28
    s_waitcnt vmcnt(12)
    v_and_b32_dpp v32, v29, v8 row_newbcast:0 row_mask:0xf bank_mask:0xf
    v_and_b32_dpp v33, v29, v9 row_newbcast:0 row_mask:0xf bank_mask:0xf
    v_and_b32_dpp v34, v29, v10 row_newbcast:0 row_mask:0xf bank_mask:0xf
    v_and_b32_dpp v35, v29, v11 row_newbcast:0 row_mask:0xf bank_mask:0xf
    v_and_b32_dpp v36, v29, v8 row_newbcast:8 row_mask:0xf bank_mask:0xf
    v_and_b32_dpp v37, v29, v9 row_newbcast:8 row_mask:0xf bank_mask:0xf
    v_and_b32_dpp v38, v29, v10 row_newbcast:8 row_mask:0xf bank_mask:0xf
    v_and_b32_dpp v39, v29, v11 row_newbcast:8 row_mask:0xf bank_mask:0xf
    v_and_b32_dpp v40, v29, v8 row_newbcast:4 row_mask:0xf bank_mask:0xf
    v_and_b32_dpp v41, v29, v9 row_newbcast:4 row_mask:0xf bank_mask:0xf
    v_and_b32_dpp v42, v29, v10 row_newbcast:4 row_mask:0xf bank_mask:0xf
    v_and_b32_dpp v43, v29, v11 row_newbcast:4 row_mask:0xf bank_mask:0xf
    v_and_b32_dpp v44, v29, v8 row_newbcast:12 row_mask:0xf bank_mask:0xf
    v_and_b32_dpp v45, v29, v9 row_newbcast:12 row_mask:0xf bank_mask:0xf
    v_and_b32_dpp v46, v29, v10 row_newbcast:12 row_mask:0xf bank_mask:0xf
    v_and_b32_dpp v47, v29, v11 row_newbcast:12 row_mask:0xf bank_mask:0xf
    v_mfma_f32_16x16x32_bf16 v[12:15], v[32:35], a[16:19], v[12:15]
    v_mfma_f32_16x16x32_bf16 v[12:15], v[36:39], a[20:23], v[12:15]
    v_mfma_f32_16x16x32_bf16 v[12:15], v[40:43], a[24:27], v[12:15]
    v_mfma_f32_16x16x32_bf16 v[12:15], v[44:47], a[28:31], v[12:15]
    buffer_load_dwordx4 a[16:19], v0, s[36:39], s60 offen nt
    buffer_load_dwordx4 a[20:23], v18, s[36:39], s60 offen nt
    buffer_load_dwordx4 a[24:27], v48, s[36:39], s60 offen nt
    buffer_load_dwordx4 a[28:31], v49, s[36:39], s60 offen nt
    s_cmp_eq_u32 s18, 0
    s_cbranch_scc0 L_notk_5
    s_mov_b32 s16, 1
    s_atomic_add s16, s[30:31], s57 glc
L_notk_5:
    s_cmp_eq_u32 s62, 0
    s_cbranch_scc1 L_adone
    s_cmp_lg_u32 s56, 0
    s_cbranch_scc1 L_aext1
L_aback1:
    s_cmp_lg_u32 s58, s14
    s_cbranch_scc1 L_aloop
    s_cmp_eq_u32 s14, s15
    s_cbranch_scc1 L_aswitch
    buffer_load_dwordx4 v[60:63], v59, s[44:47], s12 offen sc1
    s_mov_b32 s14, s15
    s_branch L_aloop
L_aswitch:
    s_nop 11
    v_add_f32_dpp v17, v17, v17 row_ror:4 row_mask:0xf bank_mask:0xf
    s_nop 1
    v_add_f32_dpp v17, v17, v17 row_ror:8 row_mask:0xf bank_mask:0xf
    v_mov_b32 v28, v17
    s_nop 1
    v_permlane16_swap_b32 v17, v28
    v_add_f32 v17, v17, v28
    v_mov_b32 v28, v17
    s_nop 1
    v_permlane32_swap_b32 v17, v28
    v_add_f32 v51, v17, v28
    v_mov_b32 v50, v16
    v_cvt_pk_bf16_f32 v52, v12, v13
    v_cvt_pk_bf16_f32 v53, v14, v15
    v_mov_b32 v12, 0
    v_mov_b32 v13, 0
    v_mov_b32 v14, 0
    v_mov_b32 v15, 0
    v_mov_b32 v16, 0xff800000
    v_mov_b32 v17, 0
    s_mov_b32 s13, 1
    s_cmp_eq_u32 s62, 0
    s_cbranch_scc1 L_adone
L_aq2:
    v_max3_u32 v20, v60, v61, v62
    v_max_u32 v20, v20, v63
    v_cmp_eq_u32 vcc, -1, v20
    s_cbranch_vccz L_aq2_ok
    buffer_load_dwordx4 v[60:63], v59, s[44:47], s12 offen sc1
    s_waitcnt vmcnt(0)
    s_sub_u32 s101, s101, 1
    s_cbranch_scc0 L_aq2
    s_mov_b32 s101, 0
L_aq2_ok:
    v_mov_b32 v4, v60
    v_mov_b32 v5, v61
    v_mov_b32 v6, v62
    v_mov_b32 v7, v63
    s_cmp_lg_u32 s62, 3
    s_cbranch_scc1 L_aloop
    s_branch L_alast0
L_adrain1:
    buffer_load_dwordx4 v[128:131], v19, s[40:43], s24 offen offset:0 nt
    buffer_load_dwordx4 v[132:135], v19, s[40:43], s24 offen offset:1152 nt
    buffer_load_dwordx4 v[136:139], v19, s[40:43], s24 offen offset:2304 nt
    buffer_load_dwordx4 v[140:143], v19, s[40:43], s24 offen offset:3456 nt
    s_add_u32 s24, s24, 4608
    buffer_load_dwordx4 v[144:147], v19, s[40:43], s24 offen offset:0 nt
    buffer_load_dwordx4 v[148:151], v19, s[40:43], s24 offen offset:1152 nt
    buffer_load_dwordx4 v[152:155], v19, s[40:43], s24 offen offset:2304 nt
    buffer_load_dwordx4 v[156:159], v19, s[40:43], s24 offen offset:3456 nt
    s_add_u32 s24, s24, 69120
    v_add_f32_dpp v24, v20, v20 row_ror:8 row_mask:0xf bank_mask:0x3
    v_add_f32_dpp v25, v22, v22 row_ror:8 row_mask:0xf bank_mask:0x3
    v_add_f32_dpp v24, v21, v21 row_ror:8 row_mask:0xf bank_mask:0xc
    v_add_f32_dpp v25, v23, v23 row_ror:8 row_mask:0xf bank_mask:0xc
    s_nop 0
    v_add_f32_dpp v26, v24, v24 row_shl:4 row_mask:0xf bank_mask:0x5
    v_add_f32_dpp v26, v25, v25 row_shr:4 row_mask:0xf bank_mask:0xa
    s_nop 1
    v_add_f32_dpp v26, v26, v26 quad_perm:[1,0,3,2] row_mask:0xf bank_mask:0xf
    s_nop 1
    v_add_f32_dpp v26, v26, v26 quad_perm:[2,3,0,1] row_mask:0xf bank_mask:0xf
    v_cvt_pk_bf16_f32 v26, v26, v26
    v_and_b32 v26, s98, v26
    v_mul_f32 v26, s96, v26
    v_cvt_pk_bf16_f32 v26, v26, v26
    v_and_b32 v26, s98, v26
    s_nop 1
    v_max_f32_dpp v27, v26, v26 row_ror:4 row_mask:0xf bank_mask:0xf
    s_nop 1
    v_max_f32_dpp v27, v27, v27 row_ror:8 row_mask:0xf bank_mask:0xf
    v_mov_b32 v28, v27
    s_nop 1
    v_permlane16_swap_b32 v27, v28
    v_max_f32 v27, v27, v28
    v_mov_b32 v28, v27
    s_nop 1
    v_permlane32_swap_b32 v27, v28
    v_max3_f32 v27, v27, v28, v16
    v_sub_f32 v28, v16, v27
    v_sub_f32 v29, v26, v27
    v_mul_f32 v28, s97, v28
    v_mul_f32 v29, s97, v29
    v_exp_f32 v28, v28
    v_exp_f32 v29, v29
    v_mov_b32 v16, v27
    v_fma_f32 v17, v17, v28, v29
    v_cvt_pk_bf16_f32 v29, v29, v29
    v_mul_f32 v12, v12, v28
    v_mul_f32 v13, v13, v28
    v_mul_f32 v14, v14, v28
    v_mul_f32 v15, v15, v28
    s_waitcnt vmcnt(16)
    v_and_b32_dpp v32, v29, v8 row_newbcast:0 row_mask:0xf bank_mask:0xf
    v_and_b32_dpp v33, v29, v9 row_newbcast:0 row_mask:0xf bank_mask:0xf
    v_and_b32_dpp v34, v29, v10 row_newbcast:0 row_mask:0xf bank_mask:0xf
    v_and_b32_dpp v35, v29, v11 row_newbcast:0 row_mask:0xf bank_mask:0xf
    v_and_b32_dpp v36, v29, v8 row_newbcast:8 row_mask:0xf bank_mask:0xf
    v_and_b32_dpp v37, v29, v9 row_newbcast:8 row_mask:0xf bank_mask:0xf
    v_and_b32_dpp v38, v29, v10 row_newbcast:8 row_mask:0xf bank_mask:0xf
    v_and_b32_dpp v39, v29, v11 row_newbcast:8 row_mask:0xf bank_mask:0xf
    v_and_b32_dpp v40, v29, v8 row_newbcast:4 row_mask:0xf bank_mask:0xf
    v_and_b32_dpp v41, v29, v9 row_newbcast:4 row_mask:0xf bank_mask:0xf
    v_and_b32_dpp v42, v29, v10 row_newbcast:4 row_mask:0xf bank_mask:0xf
    v_and_b32_dpp v43, v29, v11 row_newbcast:4 row_mask:0xf bank_mask:0xf
    v_and_b32_dpp v44, v29, v8 row_newbcast:12 row_mask:0xf bank_mask:0xf
    v_and_b32_dpp v45, v29, v9 row_newbcast:12 row_mask:0xf bank_mask:0xf
    v_and_b32_dpp v46, v29, v10 row_newbcast:12 row_mask:0xf bank_mask:0xf
    v_and_b32_dpp v47, v29, v11 row_newbcast:12 row_mask:0xf bank_mask:0xf
    v_mfma_f32_16x16x32_bf16 v[12:15], v[32:35], a[16:19], v[12:15]
    v_mfma_f32_16x16x32_bf16 v[12:15], v[36:39], a[20:23], v[12:15]
    v_mfma_f32_16x16x32_bf16 v[12:15], v[40:43], a[24:27], v[12:15]
    v_mfma_f32_16x16x32_bf16 v[12:15], v[44:47], a[28:31], v[12:15]
    s_mov_b32 s62, 3
    s_cmp_eq_u32 s13, 0
    s_cbranch_scc1 L_aswitch
L_alast0:
    s_waitcnt vmcnt(12)
    v_dot2_f32_bf16 v20, v64, v4, 0
    v_dot2_f32_bf16 v21, v68, v4, 0
    v_dot2_f32_bf16 v22, v72, v4, 0
    v_dot2_f32_bf16 v23, v76, v4, 0
    v_dot2_f32_bf16 v20, v65, v5, v20
    v_dot2_f32_bf16 v21, v69, v5, v21
    v_dot2_f32_bf16 v22, v73, v5, v22
    v_dot2_f32_bf16 v23, v77, v5, v23
    v_dot2_f32_bf16 v20, v66, v6, v20
    v_dot2_f32_bf16 v21, v70, v6, v21
    v_dot2_f32_bf16 v22, v74, v6, v22
    v_dot2_f32_bf16 v23, v78, v6, v23
    v_dot2_f32_bf16 v20, v67, v7, v20
    v_dot2_f32_bf16 v21, v71, v7, v21
    v_dot2_f32_bf16 v22, v75, v7, v22
    v_dot2_f32_bf16 v23, v79, v7, v23
    buffer_load_dwordx4 v[160:163], v19, s[40:43], s24 offen offset:0 nt
    buffer_load_dwordx4 v[164:167], v19, s[40:43], s24 offen offset:1152 nt
    buffer_load_dwordx4 v[168:171], v19, s[40:43], s24 offen offset:2304 nt
    buffer_load_dwordx4 v[172:175], v19, s[40:43], s24 offen offset:3456 nt
    s_add_u32 s24, s24, 4608
    buffer_load_dwordx4 v[176:179], v19, s[40:43], s24 offen offset:0 nt
    buffer_load_dwordx4 v[180:183], v19, s[40:43], s24 offen offset:1152 nt
    buffer_load_dwordx4 v[184:187], v19, s[40:43], s24 offen offset:2304 nt
    buffer_load_dwordx4 v[188:191], v19, s[40:43], s24 offen offset:3456 nt
    v_add_f32_dpp v24, v20, v20 row_ror:8 row_mask:0xf bank_mask:0x3
    v_add_f32_dpp v25, v22, v22 row_ror:8 row_mask:0xf bank_mask:0x3
    v_add_f32_dpp v24, v21, v21 row_ror:8 row_mask:0xf bank_mask:0xc
    v_add_f32_dpp v25, v23, v23 row_ror:8 row_mask:0xf bank_mask:0xc
    s_nop 0
    v_add_f32_dpp v26, v24, v24 row_shl:4 row_mask:0xf bank_mask:0x5
    v_add_f32_dpp v26, v25, v25 row_shr:4 row_mask:0xf bank_mask:0xa
    s_nop 1
    v_add_f32_dpp v26, v26, v26 quad_perm:[1,0,3,2] row_mask:0xf bank_mask:0xf
    s_nop 1
    v_add_f32_dpp v26, v26, v26 quad_perm:[2,3,0,1] row_mask:0xf bank_mask:0xf
    v_cvt_pk_bf16_f32 v26, v26, v26
    v_and_b32 v26, s98, v26
    v_mul_f32 v26, s96, v26
    v_cvt_pk_bf16_f32 v26, v26, v26
    v_and_b32 v26, s98, v26
    s_nop 1
    v_max_f32_dpp v27, v26, v26 row_ror:4 row_mask:0xf bank_mask:0xf
    s_nop 1
    v_max_f32_dpp v27, v27, v27 row_ror:8 row_mask:0xf bank_mask:0xf
    v_mov_b32 v28, v27
    s_nop 1
    v_permlane16_swap_b32 v27, v28
    v_max_f32 v27, v27, v28
    v_mov_b32 v28, v27
    s_nop 1
    v_permlane32_swap_b32 v27, v28
    v_max3_f32 v27, v27, v28, v16
    v_sub_f32 v28, v16, v27
    v_sub_f32 v29, v26, v27
    v_mul_f32 v28, s97, v28
    v_mul_f32 v29, s97, v29
    v_exp_f32 v28, v28
    v_exp_f32 v29, v29
    v_mov_b32 v16, v27
    v_fma_f32 v17, v17, v28, v29
    v_cvt_pk_bf16_f32 v29, v29, v29
    v_mul_f32 v12, v12, v28
    v_mul_f32 v13, v13, v28
    v_mul_f32 v14, v14, v28
    v_mul_f32 v15, v15, v28
    s_waitcnt vmcnt(16)
    v_and_b32_dpp v32, v29, v8 row_newbcast:0 row_mask:0xf bank_mask:0xf
    v_and_b32_dpp v33, v29, v9 row_newbcast:0 row_mask:0xf bank_mask:0xf
    v_and_b32_dpp v34, v29, v10 row_newbcast:0 row_mask:0xf bank_mask:0xf
    v_and_b32_dpp v35, v29, v11 row_newbcast:0 row_mask:0xf bank_mask:0xf
    v_and_b32_dpp v36, v29, v8 row_newbcast:8 row_mask:0xf bank_mask:0xf
    v_and_b32_dpp v37, v29, v9 row_newbcast:8 row_mask:0xf bank_mask:0xf
    v_and_b32_dpp v38, v29, v10 row_newbcast:8 row_mask:0xf bank_mask:0xf
    v_and_b32_dpp v39, v29, v11 row_newbcast:8 row_mask:0xf bank_mask:0xf
    v_and_b32_dpp v40, v29, v8 row_newbcast:4 row_mask:0xf bank_mask:0xf
    v_and_b32_dpp v41, v29, v9 row_newbcast:4 row_mask:0xf bank_mask:0xf
    v_and_b32_dpp v42, v29, v10 row_newbcast:4 row_mask:0xf bank_mask:0xf
    v_and_b32_dpp v43, v29, v11 row_newbcast:4 row_mask:0xf bank_mask:0xf
    v_and_b32_dpp v44, v29, v8 row_newbcast:12 row_mask:0xf bank_mask:0xf
    v_and_b32_dpp v45, v29, v9 row_newbcast:12 row_mask:0xf bank_mask:0xf
    v_and_b32_dpp v46, v29, v10 row_newbcast:12 row_mask:0xf bank_mask:0xf
    v_and_b32_dpp v47, v29, v11 row_newbcast:12 row_mask:0xf bank_mask:0xf
    v_mfma_f32_16x16x32_bf16 v[12:15], v[32:35], a[0:3], v[12:15]
    v_mfma_f32_16x16x32_bf16 v[12:15], v[36:39], a[4:7], v[12:15]
    v_mfma_f32_16x16x32_bf16 v[12:15], v[40:43], a[8:11], v[12:15]
    v_mfma_f32_16x16x32_bf16 v[12:15], v[44:47], a[12:15], v[12:15]
    s_nop 3
    s_branch L_adone2
L_adrain0:
    buffer_load_dwordx4 v[128:131], v19, s[40:43], s24 offen offset:0 nt
    buffer_load_dwordx4 v[132:135], v19, s[40:43], s24 offen offset:1152 nt
    buffer_load_dwordx4 v[136:139], v19, s[40:43], s24 offen offset:2304 nt
    buffer_load_dwordx4 v[140:143], v19, s[40:43], s24 offen offset:3456 nt
    s_add_u32 s24, s24, 4608
    buffer_load_dwordx4 v[144:147], v19, s[40:43], s24 offen offset:0 nt
    buffer_load_dwordx4 v[148:151], v19, s[40:43], s24 offen offset:1152 nt
    buffer_load_dwordx4 v[152:155], v19, s[40:43], s24 offen offset:2304 nt
    buffer_load_dwordx4 v[156:159], v19, s[40:43], s24 offen offset:3456 nt
    s_add_u32 s24, s24, 69120
    v_add_f32_dpp v24, v20, v20 row_ror:8 row_mask:0xf bank_mask:0x3
    v_add_f32_dpp v25, v22, v22 row_ror:8 row_mask:0xf bank_mask:0x3
    v_add_f32_dpp v24, v21, v21 row_ror:8 row_mask:0xf bank_mask:0xc
    v_add_f32_dpp v25, v23, v23 row_ror:8 row_mask:0xf bank_mask:0xc
    s_nop 0
    v_add_f32_dpp v26, v24, v24 row_shl:4 row_mask:0xf bank_mask:0x5
    v_add_f32_dpp v26, v25, v25 row_shr:4 row_mask:0xf bank_mask:0xa
    s_nop 1
    v_add_f32_dpp v26, v26, v26 quad_perm:[1,0,3,2] row_mask:0xf bank_mask:0xf
    s_nop 1
    v_add_f32_dpp v26, v26, v26 quad_perm:[2,3,0,1] row_mask:0xf bank_mask:0xf
    v_cvt_pk_bf16_f32 v26, v26, v26
    v_and_b32 v26, s98, v26
    v_mul_f32 v26, s96, v26
    v_cvt_pk_bf16_f32 v26, v26, v26
    v_and_b32 v26, s98, v26
    s_nop 1
    v_max_f32_dpp v27, v26, v26 row_ror:4 row_mask:0xf bank_mask:0xf
    s_nop 1
    v_max_f32_dpp v27, v27, v27 row_ror:8 row_mask:0xf bank_mask:0xf
    v_mov_b32 v28, v27
    s_nop 1
    v_permlane16_swap_b32 v27, v28
    v_max_f32 v27, v27, v28
    v_mov_b32 v28, v27
    s_nop 1
    v_permlane32_swap_b32 v27, v28
    v_max3_f32 v27, v27, v28, v16
    v_sub_f32 v28, v16, v27
    v_sub_f32 v29, v26, v27
    v_mul_f32 v28, s97, v28
    v_mul_f32 v29, s97, v29
    v_exp_f32 v28, v28
    v_exp_f32 v29, v29
    v_mov_b32 v16, v27
    v_fma_f32 v17, v17, v28, v29
    v_cvt_pk_bf16_f32 v29, v29, v29
    v_mul_f32 v12, v12, v28
    v_mul_f32 v13, v13, v28
    v_mul_f32 v14, v14, v28
    v_mul_f32 v15, v15, v28
    s_waitcnt vmcnt(16)
    v_and_b32_dpp v32, v29, v8 row_newbcast:0 row_mask:0xf bank_mask:0xf
    v_and_b32_dpp v33, v29, v9 row_newbcast:0 row_mask:0xf bank_mask:0xf
    v_and_b32_dpp v34, v29, v10 row_newbcast:0 row_mask:0xf bank_mask:0xf
    v_and_b32_dpp v35, v29, v11 row_newbcast:0 row_mask:0xf bank_mask:0xf
    v_and_b32_dpp v36, v29, v8 row_newbcast:8 row_mask:0xf bank_mask:0xf
    v_and_b32_dpp v37, v29, v9 row_newbcast:8 row_mask:0xf bank_mask:0xf
    v_and_b32_dpp v38, v29, v10 row_newbcast:8 row_mask:0xf bank_mask:0xf
    v_and_b32_dpp v39, v29, v11 row_newbcast:8 row_mask:0xf bank_mask:0xf
    v_and_b32_dpp v40, v29, v8 row_newbcast:4 row_mask:0xf bank_mask:0xf
    v_and_b32_dpp v41, v29, v9 row_newbcast:4 row_mask:0xf bank_mask:0xf
    v_and_b32_dpp v42, v29, v10 row_newbcast:4 row_mask:0xf bank_mask:0xf
    v_and_b32_dpp v43, v29, v11 row_newbcast:4 row_mask:0xf bank_mask:0xf
    v_and_b32_dpp v44, v29, v8 row_newbcast:12 row_mask:0xf bank_mask:0xf
    v_and_b32_dpp v45, v29, v9 row_newbcast:12 row_mask:0xf bank_mask:0xf
    v_and_b32_dpp v46, v29, v10 row_newbcast:12 row_mask:0xf bank_mask:0xf
    v_and_b32_dpp v47, v29, v11 row_newbcast:12 row_mask:0xf bank_mask:0xf
    v_mfma_f32_16x16x32_bf16 v[12:15], v[32:35], a[0:3], v[12:15]
    v_mfma_f32_16x16x32_bf16 v[12:15], v[36:39], a[4:7], v[12:15]
    v_mfma_f32_16x16x32_bf16 v[12:15], v[40:43], a[8:11], v[12:15]
    v_mfma_f32_16x16x32_bf16 v[12:15], v[44:47], a[12:15], v[12:15]
    s_waitcnt vmcnt(12)
    v_dot2_f32_bf16 v20, v80, v4, 0
    v_dot2_f32_bf16 v21, v84, v4, 0
    v_dot2_f32_bf16 v22, v88, v4, 0
    v_dot2_f32_bf16 v23, v92, v4, 0
    v_dot2_f32_bf16 v20, v81, v5, v20
    v_dot2_f32_bf16 v21, v85, v5, v21
    v_dot2_f32_bf16 v22, v89, v5, v22
    v_dot2_f32_bf16 v23, v93, v5, v23
    v_dot2_f32_bf16 v20, v82, v6, v20
    v_dot2_f32_bf16 v21, v86, v6, v21
    v_dot2_f32_bf16 v22, v90, v6, v22
    v_dot2_f32_bf16 v23, v94, v6, v23
    v_dot2_f32_bf16 v20, v83, v7, v20
    v_dot2_f32_bf16 v21, v87, v7, v21
    v_dot2_f32_bf16 v22, v91, v7, v22
    v_dot2_f32_bf16 v23, v95, v7, v23
    buffer_load_dwordx4 v[160:163], v19, s[40:43], s24 offen offset:0 nt
    buffer_load_dwordx4 v[164:167], v19, s[40:43], s24 offen offset:1152 nt
    buffer_load_dwordx4 v[168:171], v19, s[40:43], s24 offen offset:2304 nt
    buffer_load_dwordx4 v[172:175], v19, s[40:43], s24 offen offset:3456 nt
    s_add_u32 s24, s24, 4608
    buffer_load_dwordx4 v[176:179], v19, s[40:43], s24 offen offset:0 nt
    buffer_load_dwordx4 v[180:183], v19, s[40:43], s24 offen offset:1152 nt
    buffer_load_dwordx4 v[184:187], v19, s[40:43], s24 offen offset:2304 nt
    buffer_load_dwordx4 v[188:191], v19, s[40:43], s24 offen offset:3456 nt
    v_add_f32_dpp v24, v20, v20 row_ror:8 row_mask:0xf bank_mask:0x3
    v_add_f32_dpp v25, v22, v22 row_ror:8 row_mask:0xf bank_mask:0x3
    v_add_f32_dpp v24, v21, v21 row_ror:8 row_mask:0xf bank_mask:0xc
    v_add_f32_dpp v25, v23, v23 row_ror:8 row_mask:0xf bank_mask:0xc
    s_nop 0
    v_add_f32_dpp v26, v24, v24 row_shl:4 row_mask:0xf bank_mask:0x5
    v_add_f32_dpp v26, v25, v25 row_shr:4 row_mask:0xf bank_mask:0xa
    s_nop 1
    v_add_f32_dpp v26, v26, v26 quad_perm:[1,0,3,2] row_mask:0xf bank_mask:0xf
    s_nop 1
    v_add_f32_dpp v26, v26, v26 quad_perm:[2,3,0,1] row_mask:0xf bank_mask:0xf
    v_cvt_pk_bf16_f32 v26, v26, v26
    v_and_b32 v26, s98, v26
    v_mul_f32 v26, s96, v26
    v_cvt_pk_bf16_f32 v26, v26, v26
    v_and_b32 v26, s98, v26
    s_nop 1
    v_max_f32_dpp v27, v26, v26 row_ror:4 row_mask:0xf bank_mask:0xf
    s_nop 1
    v_max_f32_dpp v27, v27, v27 row_ror:8 row_mask:0xf bank_mask:0xf
    v_mov_b32 v28, v27
    s_nop 1
    v_permlane16_swap_b32 v27, v28
    v_max_f32 v27, v27, v28
    v_mov_b32 v28, v27
    s_nop 1
    v_permlane32_swap_b32 v27, v28
    v_max3_f32 v27, v27, v28, v16
    v_sub_f32 v28, v16, v27
    v_sub_f32 v29, v26, v27
    v_mul_f32 v28, s97, v28
    v_mul_f32 v29, s97, v29
    v_exp_f32 v28, v28
    v_exp_f32 v29, v29
    v_mov_b32 v16, v27
    v_fma_f32 v17, v17, v28, v29
    v_cvt_pk_bf16_f32 v29, v29, v29
    v_mul_f32 v12, v12, v28
    v_mul_f32 v13, v13, v28
    v_mul_f32 v14, v14, v28
    v_mul_f32 v15, v15, v28
    s_waitcnt vmcnt(16)
    v_and_b32_dpp v32, v29, v8 row_newbcast:0 row_mask:0xf bank_mask:0xf
    v_and_b32_dpp v33, v29, v9 row_newbcast:0 row_mask:0xf bank_mask:0xf
    v_and_b32_dpp v34, v29, v10 row_newbcast:0 row_mask:0xf bank_mask:0xf
    v_and_b32_dpp v35, v29, v11 row_newbcast:0 row_mask:0xf bank_mask:0xf
    v_and_b32_dpp v36, v29, v8 row_newbcast:8 row_mask:0xf bank_mask:0xf
    v_and_b32_dpp v37, v29, v9 row_newbcast:8 row_mask:0xf bank_mask:0xf
    v_and_b32_dpp v38, v29, v10 row_newbcast:8 row_mask:0xf bank_mask:0xf
    v_and_b32_dpp v39, v29, v11 row_newbcast:8 row_mask:0xf bank_mask:0xf
    v_and_b32_dpp v40, v29, v8 row_newbcast:4 row_mask:0xf bank_mask:0xf
    v_and_b32_dpp v41, v29, v9 row_newbcast:4 row_mask:0xf bank_mask:0xf
    v_and_b32_dpp v42, v29, v10 row_newbcast:4 row_mask:0xf bank_mask:0xf
    v_and_b32_dpp v43, v29, v11 row_newbcast:4 row_mask:0xf bank_mask:0xf
    v_and_b32_dpp v44, v29, v8 row_newbcast:12 row_mask:0xf bank_mask:0xf
    v_and_b32_dpp v45, v29, v9 row_newbcast:12 row_mask:0xf bank_mask:0xf
    v_and_b32_dpp v46, v29, v10 row_newbcast:12 row_mask:0xf bank_mask:0xf
    v_and_b32_dpp v47, v29, v11 row_newbcast:12 row_mask:0xf bank_mask:0xf
    v_mfma_f32_16x16x32_bf16 v[12:15], v[32:35], a[16:19], v[12:15]
    v_mfma_f32_16x16x32_bf16 v[12:15], v[36:39], a[20:23], v[12:15]
    v_mfma_f32_16x16x32_bf16 v[12:15], v[40:43], a[24:27], v[12:15]
    v_mfma_f32_16x16x32_bf16 v[12:15], v[44:47], a[28:31], v[12:15]
    s_mov_b32 s62, 0
L_adone:
    s_cmp_eq_u32 s13, 0
    s_cbranch_scc1 L_aswitch
L_adone2:
    v_add_f32_dpp v17, v17, v17 row_ror:4 row_mask:0xf bank_mask:0xf
    s_nop 1
    v_add_f32_dpp v17, v17, v17 row_ror:8 row_mask:0xf bank_mask:0xf
    v_mov_b32 v28, v17
    s_nop 1
    v_permlane16_swap_b32 v17, v28
    v_add_f32 v17, v17, v28
    v_mov_b32 v28, v17
    s_nop 1
    v_permlane32_swap_b32 v17, v28
    v_add_f32 v17, v17, v28
    v_cvt_pk_bf16_f32 v54, v12, v13
    v_cvt_pk_bf16_f32 v55, v14, v15
    v_cmp_gt_u32 vcc, 48, v1
    s_nop 1
    v_cndmask_b32 v16, v16, v50, vcc
    v_cndmask_b32 v17, v17, v51, vcc
    v_permlane16_swap_b32 v52, v54
    v_permlane16_swap_b32 v53, v55
    v_cmp_gt_u32 vcc, 32, v1
    s_nop 1
    v_cndmask_b32 v52, v16, v52, vcc
    v_cndmask_b32 v53, v17, v53, vcc
    v_cndmask_b32 v54, v16, v54, vcc
    v_cndmask_b32 v55, v17, v55, vcc
    v_min_u32 v52, -2, v52
    v_min_u32 v53, -2, v53
    v_min_u32 v54, -2, v54
    v_min_u32 v55, -2, v55
    s_mov_b32 s54, 8388608
    buffer_store_dwordx4 v[52:55], v3, s[44:47], s54 offen sc1
    s_barrier
    s_mov_b32 s58, s22
    s_add_u32 s59, s22, 4096
    s_cmp_eq_u32 s23, 2
    s_cbranch_scc1 L_eshared
    s_cmp_lg_u32 s23, 0
    s_cbranch_scc1 L_epiB
    buffer_load_dwordx4 v[40:43], v30, s[44:47], s58 offen sc1
    buffer_load_dwordx4 v[192:195], v2, s[44:47], s58 offen offset:0 sc1
    buffer_load_dwordx4 v[196:199], v2, s[44:47], s58 offen offset:1024 sc1
    v_and_b32 v3, 15, v1
    v_lshrrev_b32 v4, 4, v1
    s_mov_b32 s60, 0x05040100
    s_mov_b32 s61, 0x07060302
    v_mul_u32_u24 v0, 73728, v4
    v_bfe_u32 v5, v1, 2, 1
    v_lshl_add_u32 v0, v5, 12, v0
    v_and_b32 v5, 3, v1
    v_lshl_add_u32 v0, v5, 5, v0
    v_bfe_u32 v5, v1, 3, 1
    v_lshl_add_u32 v0, v5, 4, v0
    s_lshl_b32 s54, s3, 9
    v_lshl_add_u32 v5, v3, 4, s54
    v_and_b32 v6, 1, v4
    v_lshl_add_u32 v5, v6, 3, v5
    v_lshrrev_b32 v6, 1, v4
    v_lshl_add_u32 v5, v6, 8, v5
    v_lshrrev_b32 v7, 2, v3
    v_lshlrev_b32 v7, 9, v7
    v_lshl_add_u32 v7, v4, 4, v7
    v_and_b32 v6, 1, v1
    v_lshl_add_u32 v7, v6, 6, v7
    v_and_b32 v6, 1, v3
    v_cmp_gt_u32 s[20:21], 2, v6
    s_waitcnt vmcnt(17)
    v_perm_b32 v64, v132, v128, s60
    v_perm_b32 v68, v132, v128, s61
    v_perm_b32 v72, v133, v129, s60
    v_perm_b32 v76, v133, v129, s61
    v_perm_b32 v80, v134, v130, s60
    v_perm_b32 v84, v134, v130, s61
    v_perm_b32 v88, v135, v131, s60
    v_perm_b32 v92, v135, v131, s61
    s_waitcnt vmcnt(15)
    v_perm_b32 v65, v140, v136, s60
    v_perm_b32 v69, v140, v136, s61
    v_perm_b32 v73, v141, v137, s60
    v_perm_b32 v77, v141, v137, s61
    v_perm_b32 v81, v142, v138, s60
    v_perm_b32 v85, v142, v138, s61
    v_perm_b32 v89, v143, v139, s60
    v_perm_b32 v93, v143, v139, s61
    s_waitcnt vmcnt(13)
    v_perm_b32 v66, v148, v144, s60
    v_perm_b32 v70, v148, v144, s61
    v_perm_b32 v74, v149, v145, s60
    v_perm_b32 v78, v149, v145, s61
    v_perm_b32 v82, v150, v146, s60
    v_perm_b32 v86, v150, v146, s61
    v_perm_b32 v90, v151, v147, s60
    v_perm_b32 v94, v151, v147, s61
    s_waitcnt vmcnt(11)
    v_perm_b32 v67, v156, v152, s60
    v_perm_b32 v71, v156, v152, s61
    v_perm_b32 v75, v157, v153, s60
    v_perm_b32 v79, v157, v153, s61
    v_perm_b32 v83, v158, v154, s60
    v_perm_b32 v87, v158, v154, s61
    v_perm_b32 v91, v159, v155, s60
    v_perm_b32 v95, v159, v155, s61
    s_waitcnt vmcnt(9)
    v_perm_b32 v96, v164, v160, s60
    v_perm_b32 v100, v164, v160, s61
    v_perm_b32 v104, v165, v161, s60
    v_perm_b32 v108, v165, v161, s61
    v_perm_b32 v112, v166, v162, s60
    v_perm_b32 v116, v166, v162, s61
    v_perm_b32 v120, v167, v163, s60
    v_perm_b32 v124, v167, v163, s61
    s_waitcnt vmcnt(7)
    v_perm_b32 v97, v172, v168, s60
    v_perm_b32 v101, v172, v168, s61
    v_perm_b32 v105, v173, v169, s60
    v_perm_b32 v109, v173, v169, s61
    v_perm_b32 v113, v174, v170, s60
    v_perm_b32 v117, v174, v170, s61
    v_perm_b32 v121, v175, v171, s60
    v_perm_b32 v125, v175, v171, s61
    s_waitcnt vmcnt(5)
    v_perm_b32 v98, v180, v176, s60
    v_perm_b32 v102, v180, v176, s61
    v_perm_b32 v106, v181, v177, s60
    v_perm_b32 v110, v181, v177, s61
    v_perm_b32 v114, v182, v178, s60
    v_perm_b32 v118, v182, v178, s61
    v_perm_b32 v122, v183, v179, s60
    v_perm_b32 v126, v183, v179, s61
    s_waitcnt vmcnt(3)
    v_perm_b32 v99, v188, v184, s60
    v_perm_b32 v103, v188, v184, s61
    v_perm_b32 v107, v189, v185, s60
    v_perm_b32 v111, v189, v185, s61
    v_perm_b32 v115, v190, v186, s60
    v_perm_b32 v119, v190, v186, s61
    v_perm_b32 v123, v191, v187, s60
    v_perm_b32 v127, v191, v187, s61
    s_waitcnt vmcnt(0)
    s_branch L_mpoll_8_c
L_mpoll_8:
    s_mov_b64 exec, s[4:5]
    buffer_load_dwordx4 v[40:43], v30, s[44:47], s58 offen sc1
    s_mov_b64 exec, s[6:7]
    buffer_load_dwordx4 v[192:195], v2, s[44:47], s58 offen offset:0 sc1
    s_mov_b64 exec, s[8:9]
    buffer_load_dwordx4 v[196:199], v2, s[44:47], s58 offen offset:1024 sc1
    s_mov_b64 exec, -1
    s_waitcnt vmcnt(3)
L_mpoll_8_c:
    v_max3_u32 v236, v40, v41, v42
    v_max3_u32 v237, v192, v193, v194
    v_max3_u32 v238, v196, v197, v198
    v_max_u32 v236, v236, v43
    v_max_u32 v237, v237, v195
    v_max_u32 v238, v238, v199
    v_cmp_eq_u32 s[4:5], -1, v236
    v_cmp_eq_u32 s[6:7], -1, v237
    v_cmp_eq_u32 s[8:9], -1, v238
    s_or_b64 vcc, s[4:5], s[6:7]
    s_or_b64 vcc, vcc, s[8:9]
    s_cbranch_scc0 L_mpollok_9
    s_sub_u32 s101, s101, 1
    s_cbranch_scc0 L_mpoll_8
    s_mov_b32 s101, 0
L_mpollok_9:
    v_max_f32_dpp v44, v40, v40 row_ror:1 row_mask:0xf bank_mask:0xf
    v_cndmask_b32 v47, 0, v41, s[20:21]
    v_mov_b32 v45, v44
    s_nop 1
    v_permlane16_swap_b32 v44, v45
    v_max_f32 v44, v44, v45
    v_mov_b32 v45, v44
    s_nop 1
    v_permlane32_swap_b32 v44, v45
    v_max_f32 v44, v44, v45
    v_sub_f32 v45, v40, v44
    v_mul_f32 v45, s97, v45
    v_exp_f32 v45, v45
    s_nop 0
    v_cvt_pk_bf16_f32 v46, v45, v45
    v_and_b32 v45, s98, v46
    v_mul_f32 v47, v47, v45
    v_and_b32_dpp v232, v46, v8 row_newbcast:0 row_mask:0xf bank_mask:0xf
    v_and_b32_dpp v233, v46, v9 row_newbcast:0 row_mask:0xf bank_mask:0xf
    v_add_f32_dpp v47, v47, v47 row_ror:1 row_mask:0xf bank_mask:0xf
    v_and_b32_dpp v234, v46, v10 row_newbcast:0 row_mask:0xf bank_mask:0xf
    v_and_b32_dpp v235, v46, v11 row_newbcast:0 row_mask:0xf bank_mask:0xf
    v_and_b32_dpp v236, v46, v8 row_newbcast:1 row_mask:0xf bank_mask:0xf
    v_mov_b32 v45, v47
    v_and_b32_dpp v237, v46, v9 row_newbcast:1 row_mask:0xf bank_mask:0xf
    v_and_b32_dpp v238, v46, v10 row_newbcast:1 row_mask:0xf bank_mask:0xf
    v_and_b32_dpp v239, v46, v11 row_newbcast:1 row_mask:0xf bank_mask:0xf
    v_permlane16_swap_b32 v47, v45
    v_mfma_f32_16x16x32_bf16 v[228:231], v[232:235], v[192:195], 0
    v_add_f32 v47, v47, v45
    v_mfma_f32_16x16x32_bf16 v[228:231], v[236:239], v[196:199], v[228:231]
    v_mov_b32 v45, v47
    s_nop 1
    v_permlane32_swap_b32 v47, v45
    v_add_f32 v47, v47, v45
    v_rcp_f32 v47, v47
    s_nop 1
    v_mul_f32 v228, v228, v47
    v_mul_f32 v229, v229, v47
    v_mul_f32 v230, v230, v47
    v_mul_f32 v231, v231, v47
    v_cvt_pk_bf16_f32 v224, v228, v229
    v_cvt_pk_bf16_f32 v225, v230, v231
    s_branch L_emerged
L_eshared:
    buffer_load_dwordx4 v[40:43], v30, s[44:47], s58 offen sc1
    buffer_load_dwordx4 v[192:195], v2, s[44:47], s58 offen offset:0 sc1
    buffer_load_dwordx4 v[196:199], v2, s[44:47], s58 offen offset:1024 sc1
    buffer_load_dwordx4 v[200:203], v2, s[44:47], s58 offen offset:2048 sc1
    buffer_load_dwordx4 v[204:207], v2, s[44:47], s58 offen offset:3072 sc1
    buffer_load_dwordx4 v[208:211], v2, s[44:47], s59 offen offset:0 sc1
    buffer_load_dwordx4 v[212:215], v2, s[44:47], s59 offen offset:1024 sc1
    v_and_b32 v3, 15, v1
    v_lshrrev_b32 v4, 4, v1
    s_mov_b32 s60, 0x05040100
    s_mov_b32 s61, 0x07060302
    v_mul_u32_u24 v0, 73728, v4
    v_bfe_u32 v5, v1, 2, 1
    v_lshl_add_u32 v0, v5, 12, v0
    v_and_b32 v5, 3, v1
    v_lshl_add_u32 v0, v5, 5, v0
    v_bfe_u32 v5, v1, 3, 1
    v_lshl_add_u32 v0, v5, 4, v0
    s_lshl_b32 s54, s3, 9
    v_lshl_add_u32 v5, v3, 4, s54
    v_and_b32 v6, 1, v4
    v_lshl_add_u32 v5, v6, 3, v5
    v_lshrrev_b32 v6, 1, v4
    v_lshl_add_u32 v5, v6, 8, v5
    v_lshrrev_b32 v7, 2, v3
    v_lshlrev_b32 v7, 9, v7
    v_lshl_add_u32 v7, v4, 4, v7
    v_and_b32 v6, 1, v1
    v_lshl_add_u32 v7, v6, 6, v7
    v_and_b32 v6, 7, v3
    v_cmp_gt_u32 s[20:21], 6, v6
    s_waitcnt vmcnt(21)
    v_perm_b32 v64, v132, v128, s60
    v_perm_b32 v68, v132, v128, s61
    v_perm_b32 v72, v133, v129, s60
    v_perm_b32 v76, v133, v129, s61
    v_perm_b32 v80, v134, v130, s60
    v_perm_b32 v84, v134, v130, s61
    v_perm_b32 v88, v135, v131, s60
    v_perm_b32 v92, v135, v131, s61
    s_waitcnt vmcnt(19)
    v_perm_b32 v65, v140, v136, s60
    v_perm_b32 v69, v140, v136, s61
    v_perm_b32 v73, v141, v137, s60
    v_perm_b32 v77, v141, v137, s61
    v_perm_b32 v81, v142, v138, s60
    v_perm_b32 v85, v142, v138, s61
    v_perm_b32 v89, v143, v139, s60
    v_perm_b32 v93, v143, v139, s61
    s_waitcnt vmcnt(17)
    v_perm_b32 v66, v148, v144, s60
    v_perm_b32 v70, v148, v144, s61
    v_perm_b32 v74, v149, v145, s60
    v_perm_b32 v78, v149, v145, s61
    v_perm_b32 v82, v150, v146, s60
    v_perm_b32 v86, v150, v146, s61
    v_perm_b32 v90, v151, v147, s60
    v_perm_b32 v94, v151, v147, s61
    s_waitcnt vmcnt(15)
    v_perm_b32 v67, v156, v152, s60
    v_perm_b32 v71, v156, v152, s61
    v_perm_b32 v75, v157, v153, s60
    v_perm_b32 v79, v157, v153, s61
    v_perm_b32 v83, v158, v154, s60
    v_perm_b32 v87, v158, v154, s61
    v_perm_b32 v91, v159, v155, s60
    v_perm_b32 v95, v159, v155, s61
    s_waitcnt vmcnt(13)
    v_perm_b32 v96, v164, v160, s60
    v_perm_b32 v100, v164, v160, s61
    v_perm_b32 v104, v165, v161, s60
    v_perm_b32 v108, v165, v161, s61
    v_perm_b32 v112, v166, v162, s60
    v_perm_b32 v116, v166, v162, s61
    v_perm_b32 v120, v167, v163, s60
    v_perm_b32 v124, v167, v163, s61
    s_waitcnt vmcnt(11)
    v_perm_b32 v97, v172, v168, s60
    v_perm_b32 v101, v172, v168, s61
    v_perm_b32 v105, v173, v169, s60
    v_perm_b32 v109, v173, v169, s61
    v_perm_b32 v113, v174, v170, s60
    v_perm_b32 v117, v174, v170, s61
    v_perm_b32 v121, v175, v171, s60
    v_perm_b32 v125, v175, v171, s61
    s_waitcnt vmcnt(9)
    v_perm_b32 v98, v180, v176, s60
    v_perm_b32 v102, v180, v176, s61
    v_perm_b32 v106, v181, v177, s60
    v_perm_b32 v110, v181, v177, s61
    v_perm_b32 v114, v182, v178, s60
    v_perm_b32 v118, v182, v178, s61
    v_perm_b32 v122, v183, v179, s60
    v_perm_b32 v126, v183, v179, s61
    s_waitcnt vmcnt(7)
    v_perm_b32 v99, v188, v184, s60
    v_perm_b32 v103, v188, v184, s61
    v_perm_b32 v107, v189, v185, s60
    v_perm_b32 v111, v189, v185, s61
    v_perm_b32 v115, v190, v186, s60
    v_perm_b32 v119, v190, v186, s61
    v_perm_b32 v123, v191, v187, s60
    v_perm_b32 v127, v191, v187, s61
    s_waitcnt vmcnt(0)
    s_branch L_mpoll_12_c
L_mpoll_12:
    s_mov_b64 exec, s[4:5]
    buffer_load_dwordx4 v[40:43], v30, s[44:47], s58 offen sc1
    s_mov_b64 exec, s[6:7]
    buffer_load_dwordx4 v[192:195], v2, s[44:47], s58 offen offset:0 sc1
    s_mov_b64 exec, s[8:9]
    buffer_load_dwordx4 v[196:199], v2, s[44:47], s58 offen offset:1024 sc1
    s_mov_b64 exec, s[10:11]
    buffer_load_dwordx4 v[200:203], v2, s[44:47], s58 offen offset:2048 sc1
    s_mov_b64 exec, s[12:13]
    buffer_load_dwordx4 v[204:207], v2, s[44:47], s58 offen offset:3072 sc1
    s_mov_b64 exec, s[14:15]
    buffer_load_dwordx4 v[208:211], v2, s[44:47], s59 offen offset:0 sc1
    s_mov_b64 exec, s[16:17]
    buffer_load_dwordx4 v[212:215], v2, s[44:47], s59 offen offset:1024 sc1
    s_mov_b64 exec, -1
    s_waitcnt vmcnt(7)
L_mpoll_12_c:
    v_max3_u32 v236, v40, v41, v42
    v_max3_u32 v237, v192, v193, v194
    v_max3_u32 v238, v196, v197, v198
    v_max3_u32 v239, v200, v201, v202
    v_max3_u32 v240, v204, v205, v206
    v_max3_u32 v241, v208, v209, v210
    v_max3_u32 v242, v212, v213, v214
    v_max_u32 v236, v236, v43
    v_max_u32 v237, v237, v195
    v_max_u32 v238, v238, v199
    v_max_u32 v239, v239, v203
    v_max_u32 v240, v240, v207
    v_max_u32 v241, v241, v211
    v_max_u32 v242, v242, v215
    v_cmp_eq_u32 s[4:5], -1, v236
    v_cmp_eq_u32 s[6:7], -1, v237
    v_cmp_eq_u32 s[8:9], -1, v238
    v_cmp_eq_u32 s[10:11], -1, v239
    v_cmp_eq_u32 s[12:13], -1, v240
    v_cmp_eq_u32 s[14:15], -1, v241
    v_cmp_eq_u32 s[16:17], -1, v242
    s_or_b64 vcc, s[4:5], s[6:7]
    s_or_b64 vcc, vcc, s[8:9]
    s_or_b64 vcc, vcc, s[10:11]
    s_or_b64 vcc, vcc, s[12:13]
    s_or_b64 vcc, vcc, s[14:15]
    s_or_b64 vcc, vcc, s[16:17]
    s_cbranch_scc0 L_mpollok_13
    s_sub_u32 s101, s101, 1
    s_cbranch_scc0 L_mpoll_12
    s_mov_b32 s101, 0
L_mpollok_13:
    v_max_f32_dpp v44, v40, v40 row_ror:1 row_mask:0xf bank_mask:0xf
    v_cndmask_b32 v47, 0, v41, s[20:21]
    s_nop 0
    v_max_f32_dpp v44, v44, v44 row_ror:2 row_mask:0xf bank_mask:0xf
    s_nop 1
    v_max_f32_dpp v44, v44, v44 row_ror:4 row_mask:0xf bank_mask:0xf
    v_mov_b32 v45, v44
    s_nop 1
    v_permlane16_swap_b32 v44, v45
    v_max_f32 v44, v44, v45
    v_mov_b32 v45, v44
    s_nop 1
    v_permlane32_swap_b32 v44, v45
    v_max_f32 v44, v44, v45
    v_sub_f32 v45, v40, v44
    v_mul_f32 v45, s97, v45
    v_exp_f32 v45, v45
    s_nop 0
    v_cvt_pk_bf16_f32 v46, v45, v45
    v_and_b32 v45, s98, v46
    v_mul_f32 v47, v47, v45
    v_and_b32_dpp v232, v46, v8 row_newbcast:0 row_mask:0xf bank_mask:0xf
    v_and_b32_dpp v233, v46, v9 row_newbcast:0 row_mask:0xf bank_mask:0xf
    v_add_f32_dpp v47, v47, v47 row_ror:1 row_mask:0xf bank_mask:0xf
    v_and_b32_dpp v234, v46, v10 row_newbcast:0 row_mask:0xf bank_mask:0xf
    v_and_b32_dpp v235, v46, v11 row_newbcast:0 row_mask:0xf bank_mask:0xf
    v_and_b32_dpp v236, v46, v8 row_newbcast:1 row_mask:0xf bank_mask:0xf
    v_and_b32_dpp v237, v46, v9 row_newbcast:1 row_mask:0xf bank_mask:0xf
    v_add_f32_dpp v47, v47, v47 row_ror:2 row_mask:0xf bank_mask:0xf
    v_and_b32_dpp v238, v46, v10 row_newbcast:1 row_mask:0xf bank_mask:0xf
    v_and_b32_dpp v239, v46, v11 row_newbcast:1 row_mask:0xf bank_mask:0xf
    v_mfma_f32_16x16x32_bf16 v[228:231], v[232:235], v[192:195], 0
    v_and_b32_dpp v240, v46, v8 row_newbcast:2 row_mask:0xf bank_mask:0xf
    v_add_f32_dpp v47, v47, v47 row_ror:4 row_mask:0xf bank_mask:0xf
    v_and_b32_dpp v241, v46, v9 row_newbcast:2 row_mask:0xf bank_mask:0xf
    v_and_b32_dpp v242, v46, v10 row_newbcast:2 row_mask:0xf bank_mask:0xf
    v_and_b32_dpp v243, v46, v11 row_newbcast:2 row_mask:0xf bank_mask:0xf
    v_mfma_f32_16x16x32_bf16 v[228:231], v[236:239], v[196:199], v[228:231]
    v_mov_b32 v45, v47
    v_and_b32_dpp v244, v46, v8 row_newbcast:3 row_mask:0xf bank_mask:0xf
    v_and_b32_dpp v245, v46, v9 row_newbcast:3 row_mask:0xf bank_mask:0xf
    v_and_b32_dpp v246, v46, v10 row_newbcast:3 row_mask:0xf bank_mask:0xf
    v_and_b32_dpp v247, v46, v11 row_newbcast:3 row_mask:0xf bank_mask:0xf
    v_permlane16_swap_b32 v47, v45
    v_mfma_f32_16x16x32_bf16 v[228:231], v[240:243], v[200:203], v[228:231]
    v_and_b32_dpp v248, v46, v8 row_newbcast:4 row_mask:0xf bank_mask:0xf
    v_and_b32_dpp v249, v46, v9 row_newbcast:4 row_mask:0xf bank_mask:0xf
    v_and_b32_dpp v250, v46, v10 row_newbcast:4 row_mask:0xf bank_mask:0xf
    v_add_f32 v47, v47, v45
    v_and_b32_dpp v251, v46, v11 row_newbcast:4 row_mask:0xf bank_mask:0xf
    v_mfma_f32_16x16x32_bf16 v[228:231], v[244:247], v[204:207], v[228:231]
    v_and_b32_dpp v252, v46, v8 row_newbcast:5 row_mask:0xf bank_mask:0xf
    v_and_b32_dpp v253, v46, v9 row_newbcast:5 row_mask:0xf bank_mask:0xf
    v_mov_b32 v45, v47
    v_and_b32_dpp v254, v46, v10 row_newbcast:5 row_mask:0xf bank_mask:0xf
    v_and_b32_dpp v255, v46, v11 row_newbcast:5 row_mask:0xf bank_mask:0xf
    v_mfma_f32_16x16x32_bf16 v[228:231], v[248:251], v[208:211], v[228:231]
    v_permlane32_swap_b32 v47, v45
    v_add_f32 v47, v47, v45
    v_mfma_f32_16x16x32_bf16 v[228:231], v[252:255], v[212:215], v[228:231]
    v_rcp_f32 v47, v47
    s_nop 6
    v_mul_f32 v228, v228, v47
    v_mul_f32 v229, v229, v47
    v_mul_f32 v230, v230, v47
    v_mul_f32 v231, v231, v47
    v_cvt_pk_bf16_f32 v224, v228, v229
    v_cvt_pk_bf16_f32 v225, v230, v231
L_emerged:
    ds_write_b64 v5, v[224:225]
    s_cmp_eq_u32 s3, 3
    s_waitcnt lgkmcnt(0)
    s_barrier
    s_cbranch_scc1 L_eendA
    ds_read_b128 v[48:51], v7 offset:0
    ds_read_b128 v[52:55], v7 offset:128
    s_waitcnt lgkmcnt(1)
    v_mfma_f32_16x16x32_bf16 v[224:227], v[48:51], v[64:67], 0
    v_mfma_f32_16x16x32_bf16 v[228:231], v[48:51], v[68:71], 0
    v_mfma_f32_16x16x32_bf16 v[232:235], v[48:51], v[72:75], 0
    v_mfma_f32_16x16x32_bf16 v[236:239], v[48:51], v[76:79], 0
    v_mfma_f32_16x16x32_bf16 v[240:243], v[48:51], v[80:83], 0
    v_mfma_f32_16x16x32_bf16 v[244:247], v[48:51], v[84:87], 0
    v_mfma_f32_16x16x32_bf16 v[248:251], v[48:51], v[88:91], 0
    v_mfma_f32_16x16x32_bf16 v[252:255], v[48:51], v[92:95], 0
    s_waitcnt lgkmcnt(0)
    v_mfma_f32_16x16x32_bf16 v[224:227], v[52:55], v[96:99], v[224:227]
    s_nop 1
    v_mfma_f32_16x16x32_bf16 v[228:231], v[52:55], v[100:103], v[228:231]
    s_nop 1
    v_mfma_f32_16x16x32_bf16 v[232:235], v[52:55], v[104:107], v[232:235]
    s_nop 1
    v_mfma_f32_16x16x32_bf16 v[236:239], v[52:55], v[108:111], v[236:239]
    s_nop 0
    v_add_f32_dpp v56, v225, v224 row_ror:8 row_mask:0xf bank_mask:0x3
    v_mfma_f32_16x16x32_bf16 v[240:243], v[52:55], v[112:115], v[240:243]
    s_nop 0
    v_add_f32_dpp v57, v229, v228 row_ror:8 row_mask:0xf bank_mask:0x3
    v_mfma_f32_16x16x32_bf16 v[244:247], v[52:55], v[116:119], v[244:247]
    s_nop 0
    v_add_f32_dpp v58, v233, v232 row_ror:8 row_mask:0xf bank_mask:0x3
    v_mfma_f32_16x16x32_bf16 v[248:251], v[52:55], v[120:123], v[248:251]
    s_nop 0
    v_add_f32_dpp v59, v237, v236 row_ror:8 row_mask:0xf bank_mask:0x3
    v_mfma_f32_16x16x32_bf16 v[252:255], v[52:55], v[124:127], v[252:255]
    s_nop 0
    v_add_f32_dpp v56, v240, v241 row_ror:8 row_mask:0xf bank_mask:0xc
    v_add_f32_dpp v57, v244, v245 row_ror:8 row_mask:0xf bank_mask:0xc
    v_min_u32 v56, -2, v56
    s_nop 0
    v_add_f32_dpp v58, v248, v249 row_ror:8 row_mask:0xf bank_mask:0xc
    v_min_u32 v57, -2, v57
    s_nop 0
    v_add_f32_dpp v59, v252, v253 row_ror:8 row_mask:0xf bank_mask:0xc
    v_min_u32 v58, -2, v58
    v_min_u32 v59, -2, v59
    buffer_store_dwordx4 v[56:59], v0, s[44:47], s25 offen sc1
L_eendA:
    s_endpgm
L_epiB:
    s_cmp_eq_u32 s3, 3
    s_cbranch_scc1 L_eendB
    v_bfe_u32 v6, v1, 2, 2
    v_lshlrev_b32 v6, 6, v6
    v_and_b32 v5, 48, v1
    v_add_u32 v6, v6, v5
    v_and_b32 v5, 1, v1
    v_lshl_add_u32 v6, v5, 8, v6
    buffer_load_dwordx4 v[48:51], v6, s[44:47], s27 offen offset:0 sc1
    buffer_load_dwordx4 v[52:55], v6, s[44:47], s27 offen offset:512 sc1
    v_and_b32 v3, 15, v1
    v_lshrrev_b32 v4, 4, v1
    s_mov_b32 s60, 0x05040100
    s_mov_b32 s61, 0x07060302
    v_mul_u32_u24 v0, 73728, v4
    v_bfe_u32 v5, v1, 2, 1
    v_lshl_add_u32 v0, v5, 12, v0
    v_and_b32 v5, 3, v1
    v_lshl_add_u32 v0, v5, 5, v0
    v_bfe_u32 v5, v1, 3, 1
    v_lshl_add_u32 v0, v5, 4, v0
    s_waitcnt vmcnt(16)
    v_perm_b32 v64, v132, v128, s60
    v_perm_b32 v68, v132, v128, s61
    v_perm_b32 v72, v133, v129, s60
    v_perm_b32 v76, v133, v129, s61
    v_perm_b32 v80, v134, v130, s60
    v_perm_b32 v84, v134, v130, s61
    v_perm_b32 v88, v135, v131, s60
    v_perm_b32 v92, v135, v131, s61
    s_waitcnt vmcnt(14)
    v_perm_b32 v65, v140, v136, s60
    v_perm_b32 v69, v140, v136, s61
    v_perm_b32 v73, v141, v137, s60
    v_perm_b32 v77, v141, v137, s61
    v_perm_b32 v81, v142, v138, s60
    v_perm_b32 v85, v142, v138, s61
    v_perm_b32 v89, v143, v139, s60
    v_perm_b32 v93, v143, v139, s61
    s_waitcnt vmcnt(12)
    v_perm_b32 v66, v148, v144, s60
    v_perm_b32 v70, v148, v144, s61
    v_perm_b32 v74, v149, v145, s60
    v_perm_b32 v78, v149, v145, s61
    v_perm_b32 v82, v150, v146, s60
    v_perm_b32 v86, v150, v146, s61
    v_perm_b32 v90, v151, v147, s60
    v_perm_b32 v94, v151, v147, s61
    s_waitcnt vmcnt(10)
    v_perm_b32 v67, v156, v152, s60
    v_perm_b32 v71, v156, v152, s61
    v_perm_b32 v75, v157, v153, s60
    v_perm_b32 v79, v157, v153, s61
    v_perm_b32 v83, v158, v154, s60
    v_perm_b32 v87, v158, v154, s61
    v_perm_b32 v91, v159, v155, s60
    v_perm_b32 v95, v159, v155, s61
    s_waitcnt vmcnt(8)
    v_perm_b32 v96, v164, v160, s60
    v_perm_b32 v100, v164, v160, s61
    v_perm_b32 v104, v165, v161, s60
    v_perm_b32 v108, v165, v161, s61
    v_perm_b32 v112, v166, v162, s60
    v_perm_b32 v116, v166, v162, s61
    v_perm_b32 v120, v167, v163, s60
    v_perm_b32 v124, v167, v163, s61
    s_waitcnt vmcnt(6)
    v_perm_b32 v97, v172, v168, s60
    v_perm_b32 v101, v172, v168, s61
    v_perm_b32 v105, v173, v169, s60
    v_perm_b32 v109, v173, v169, s61
    v_perm_b32 v113, v174, v170, s60
    v_perm_b32 v117, v174, v170, s61
    v_perm_b32 v121, v175, v171, s60
    v_perm_b32 v125, v175, v171, s61
    s_waitcnt vmcnt(4)
    v_perm_b32 v98, v180, v176, s60
    v_perm_b32 v102, v180, v176, s61
    v_perm_b32 v106, v181, v177, s60
    v_perm_b32 v110, v181, v177, s61
    v_perm_b32 v114, v182, v178, s60
    v_perm_b32 v118, v182, v178, s61
    v_perm_b32 v122, v183, v179, s60
    v_perm_b32 v126, v183, v179, s61
    s_waitcnt vmcnt(2)
    v_perm_b32 v99, v188, v184, s60
    v_perm_b32 v103, v188, v184, s61
    v_perm_b32 v107, v189, v185, s60
    v_perm_b32 v111, v189, v185, s61
    v_perm_b32 v115, v190, v186, s60
    v_perm_b32 v119, v190, v186, s61
    v_perm_b32 v123, v191, v187, s60
    v_perm_b32 v127, v191, v187, s61
    s_waitcnt vmcnt(0)
    s_branch L_mpoll_14_c
L_mpoll_14:
    s_mov_b64 exec, s[4:5]
    buffer_load_dwordx4 v[48:51], v6, s[44:47], s27 offen offset:0 sc1
    s_mov_b64 exec, s[6:7]
    buffer_load_dwordx4 v[52:55], v6, s[44:47], s27 offen offset:512 sc1
    s_mov_b64 exec, -1
    s_waitcnt vmcnt(0)
L_mpoll_14_c:
    v_max3_u32 v236, v48, v49, v50
    v_max3_u32 v237, v52, v53, v54
    v_max_u32 v236, v236, v51
    v_max_u32 v237, v237, v55
    v_cmp_eq_u32 s[4:5], -1, v236
    v_cmp_eq_u32 s[6:7], -1, v237
    s_nop 0
    s_or_b64 vcc, s[4:5], s[6:7]
    s_cbranch_scc0 L_mpollok_15
    s_sub_u32 s101, s101, 1
    s_cbranch_scc0 L_mpoll_14
    s_mov_b32 s101, 0
L_mpollok_15:
    v_mfma_f32_16x16x32_bf16 v[224:227], v[48:51], v[64:67], 0
    v_mfma_f32_16x16x32_bf16 v[228:231], v[48:51], v[68:71], 0
    v_mfma_f32_16x16x32_bf16 v[232:235], v[48:51], v[72:75], 0
    v_mfma_f32_16x16x32_bf16 v[236:239], v[48:51], v[76:79], 0
    v_mfma_f32_16x16x32_bf16 v[240:243], v[48:51], v[80:83], 0
    v_mfma_f32_16x16x32_bf16 v[244:247], v[48:51], v[84:87], 0
    v_mfma_f32_16x16x32_bf16 v[248:251], v[48:51], v[88:91], 0
    v_mfma_f32_16x16x32_bf16 v[252:255], v[48:51], v[92:95], 0
    v_mfma_f32_16x16x32_bf16 v[224:227], v[52:55], v[96:99], v[224:227]
    s_nop 1
    v_mfma_f32_16x16x32_bf16 v[228:231], v[52:55], v[100:103], v[228:231]
    s_nop 1
    v_mfma_f32_16x16x32_bf16 v[232:235], v[52:55], v[104:107], v[232:235]
    s_nop 1
    v_mfma_f32_16x16x32_bf16 v[236:239], v[52:55], v[108:111], v[236:239]
    s_nop 0
    v_add_f32_dpp v56, v225, v224 row_ror:8 row_mask:0xf bank_mask:0x3
    v_mfma_f32_16x16x32_bf16 v[240:243], v[52:55], v[112:115], v[240:243]
    s_nop 0
    v_add_f32_dpp v57, v229, v228 row_ror:8 row_mask:0xf bank_mask:0x3
    v_mfma_f32_16x16x32_bf16 v[244:247], v[52:55], v[116:119], v[244:247]
    s_nop 0
    v_add_f32_dpp v58, v233, v232 row_ror:8 row_mask:0xf bank_mask:0x3
    v_mfma_f32_16x16x32_bf16 v[248:251], v[52:55], v[120:123], v[248:251]
    s_nop 0
    v_add_f32_dpp v59, v237, v236 row_ror:8 row_mask:0xf bank_mask:0x3
    v_mfma_f32_16x16x32_bf16 v[252:255], v[52:55], v[124:127], v[252:255]
    s_nop 0
    v_add_f32_dpp v56, v240, v241 row_ror:8 row_mask:0xf bank_mask:0xc
    v_add_f32_dpp v57, v244, v245 row_ror:8 row_mask:0xf bank_mask:0xc
    v_min_u32 v56, -2, v56
    s_nop 0
    v_add_f32_dpp v58, v248, v249 row_ror:8 row_mask:0xf bank_mask:0xc
    v_min_u32 v57, -2, v57
    s_nop 0
    v_add_f32_dpp v59, v252, v253 row_ror:8 row_mask:0xf bank_mask:0xc
    v_min_u32 v58, -2, v58
    v_min_u32 v59, -2, v59
    buffer_store_dwordx4 v[56:59], v0, s[44:47], s25 offen sc1
L_eendB:
    s_endpgm
L_aext0:
    s_cmp_lg_u32 s56, 1
    s_cbranch_scc1 L_aext2
    v_dot2_f32_bf16 v20, v96, v4, 0
    v_dot2_f32_bf16 v21, v100, v4, 0
    v_dot2_f32_bf16 v22, v104, v4, 0
    v_dot2_f32_bf16 v23, v108, v4, 0
    v_dot2_f32_bf16 v20, v97, v5, v20
    v_dot2_f32_bf16 v21, v101, v5, v21
    v_dot2_f32_bf16 v22, v105, v5, v22
    v_dot2_f32_bf16 v23, v109, v5, v23
    v_dot2_f32_bf16 v20, v98, v6, v20
    v_dot2_f32_bf16 v21, v102, v6, v21
    v_dot2_f32_bf16 v22, v106, v6, v22
    v_dot2_f32_bf16 v23, v110, v6, v23
    v_dot2_f32_bf16 v20, v99, v7, v20
    v_dot2_f32_bf16 v21, v103, v7, v21
    v_dot2_f32_bf16 v22, v107, v7, v22
    v_dot2_f32_bf16 v23, v111, v7, v23
    v_add_f32_dpp v24, v20, v20 row_ror:8 row_mask:0xf bank_mask:0x3
    s_nop 0
    v_add_f32_dpp v25, v22, v22 row_ror:8 row_mask:0xf bank_mask:0x3
    v_add_f32_dpp v24, v21, v21 row_ror:8 row_mask:0xf bank_mask:0xc
    v_add_f32_dpp v25, v23, v23 row_ror:8 row_mask:0xf bank_mask:0xc
    s_nop 0
    v_add_f32_dpp v26, v24, v24 row_shl:4 row_mask:0xf bank_mask:0x5
    v_add_f32_dpp v26, v25, v25 row_shr:4 row_mask:0xf bank_mask:0xa
    s_nop 1
    v_add_f32_dpp v26, v26, v26 quad_perm:[1,0,3,2] row_mask:0xf bank_mask:0xf
    s_nop 1
    v_add_f32_dpp v26, v26, v26 quad_perm:[2,3,0,1] row_mask:0xf bank_mask:0xf
    v_cvt_pk_bf16_f32 v26, v26, v26
    v_and_b32 v26, s98, v26
    v_mul_f32 v26, s96, v26
    v_cvt_pk_bf16_f32 v26, v26, v26
    v_and_b32 v26, s98, v26
    s_nop 1
    v_max_f32_dpp v27, v26, v26 row_ror:4 row_mask:0xf bank_mask:0xf
    s_nop 1
    v_max_f32_dpp v27, v27, v27 row_ror:8 row_mask:0xf bank_mask:0xf
    v_mov_b32 v28, v27
    s_nop 1
    v_permlane16_swap_b32 v27, v28
    v_max_f32 v27, v27, v28
    v_mov_b32 v28, v27
    s_nop 1
    v_permlane32_swap_b32 v27, v28
    v_max3_f32 v27, v27, v28, v16
    v_sub_f32 v28, v16, v27
    v_sub_f32 v29, v26, v27
    v_mul_f32 v28, s97, v28
    v_mul_f32 v29, s97, v29
    v_exp_f32 v28, v28
    v_exp_f32 v29, v29
    v_mov_b32 v16, v27
    v_fma_f32 v17, v17, v28, v29
    v_cvt_pk_bf16_f32 v29, v29, v29
    v_mul_f32 v12, v12, v28
    v_mul_f32 v13, v13, v28
    v_mul_f32 v14, v14, v28
    v_mul_f32 v15, v15, v28
    v_and_b32_dpp v32, v29, v8 row_newbcast:0 row_mask:0xf bank_mask:0xf
    v_and_b32_dpp v33, v29, v9 row_newbcast:0 row_mask:0xf bank_mask:0xf
    v_and_b32_dpp v34, v29, v10 row_newbcast:0 row_mask:0xf bank_mask:0xf
    v_and_b32_dpp v35, v29, v11 row_newbcast:0 row_mask:0xf bank_mask:0xf
    v_and_b32_dpp v36, v29, v8 row_newbcast:8 row_mask:0xf bank_mask:0xf
    v_and_b32_dpp v37, v29, v9 row_newbcast:8 row_mask:0xf bank_mask:0xf
    v_and_b32_dpp v38, v29, v10 row_newbcast:8 row_mask:0xf bank_mask:0xf
    v_and_b32_dpp v39, v29, v11 row_newbcast:8 row_mask:0xf bank_mask:0xf
    v_and_b32_dpp v40, v29, v8 row_newbcast:4 row_mask:0xf bank_mask:0xf
    v_and_b32_dpp v41, v29, v9 row_newbcast:4 row_mask:0xf bank_mask:0xf
    v_and_b32_dpp v42, v29, v10 row_newbcast:4 row_mask:0xf bank_mask:0xf
    v_and_b32_dpp v43, v29, v11 row_newbcast:4 row_mask:0xf bank_mask:0xf
    v_and_b32_dpp v44, v29, v8 row_newbcast:12 row_mask:0xf bank_mask:0xf
    v_and_b32_dpp v45, v29, v9 row_newbcast:12 row_mask:0xf bank_mask:0xf
    v_and_b32_dpp v46, v29, v10 row_newbcast:12 row_mask:0xf bank_mask:0xf
    v_and_b32_dpp v47, v29, v11 row_newbcast:12 row_mask:0xf bank_mask:0xf
    v_mfma_f32_16x16x32_bf16 v[12:15], v[32:35], a[32:35], v[12:15]
    v_mfma_f32_16x16x32_bf16 v[12:15], v[36:39], a[36:39], v[12:15]
    v_mfma_f32_16x16x32_bf16 v[12:15], v[40:43], a[40:43], v[12:15]
    v_mfma_f32_16x16x32_bf16 v[12:15], v[44:47], a[44:47], v[12:15]
    s_mov_b32 s56, 2
    s_branch L_aback0
L_aext1:
    s_cmp_lg_u32 s56, 2
    s_cbranch_scc1 L_aext3
    v_dot2_f32_bf16 v20, v112, v4, 0
    v_dot2_f32_bf16 v21, v116, v4, 0
    v_dot2_f32_bf16 v22, v120, v4, 0
    v_dot2_f32_bf16 v23, v124, v4, 0
    v_dot2_f32_bf16 v20, v113, v5, v20
    v_dot2_f32_bf16 v21, v117, v5, v21
    v_dot2_f32_bf16 v22, v121, v5, v22
    v_dot2_f32_bf16 v23, v125, v5, v23
    v_dot2_f32_bf16 v20, v114, v6, v20
    v_dot2_f32_bf16 v21, v118, v6, v21
    v_dot2_f32_bf16 v22, v122, v6, v22
    v_dot2_f32_bf16 v23, v126, v6, v23
    v_dot2_f32_bf16 v20, v115, v7, v20
    v_dot2_f32_bf16 v21, v119, v7, v21
    v_dot2_f32_bf16 v22, v123, v7, v22
    v_dot2_f32_bf16 v23, v127, v7, v23
    v_add_f32_dpp v24, v20, v20 row_ror:8 row_mask:0xf bank_mask:0x3
    s_nop 0
    v_add_f32_dpp v25, v22, v22 row_ror:8 row_mask:0xf bank_mask:0x3
    v_add_f32_dpp v24, v21, v21 row_ror:8 row_mask:0xf bank_mask:0xc
    v_add_f32_dpp v25, v23, v23 row_ror:8 row_mask:0xf bank_mask:0xc
    s_nop 0
    v_add_f32_dpp v26, v24, v24 row_shl:4 row_mask:0xf bank_mask:0x5
    v_add_f32_dpp v26, v25, v25 row_shr:4 row_mask:0xf bank_mask:0xa
    s_nop 1
    v_add_f32_dpp v26, v26, v26 quad_perm:[1,0,3,2] row_mask:0xf bank_mask:0xf
    s_nop 1
    v_add_f32_dpp v26, v26, v26 quad_perm:[2,3,0,1] row_mask:0xf bank_mask:0xf
    v_cvt_pk_bf16_f32 v26, v26, v26
    v_and_b32 v26, s98, v26
    v_mul_f32 v26, s96, v26
    v_cvt_pk_bf16_f32 v26, v26, v26
    v_and_b32 v26, s98, v26
    s_nop 1
    v_max_f32_dpp v27, v26, v26 row_ror:4 row_mask:0xf bank_mask:0xf
    s_nop 1
    v_max_f32_dpp v27, v27, v27 row_ror:8 row_mask:0xf bank_mask:0xf
    v_mov_b32 v28, v27
    s_nop 1
    v_permlane16_swap_b32 v27, v28
    v_max_f32 v27, v27, v28
    v_mov_b32 v28, v27
    s_nop 1
    v_permlane32_swap_b32 v27, v28
    v_max3_f32 v27, v27, v28, v16
    v_sub_f32 v28, v16, v27
    v_sub_f32 v29, v26, v27
    v_mul_f32 v28, s97, v28
    v_mul_f32 v29, s97, v29
    v_exp_f32 v28, v28
    v_exp_f32 v29, v29
    v_mov_b32 v16, v27
    v_fma_f32 v17, v17, v28, v29
    v_cvt_pk_bf16_f32 v29, v29, v29
    v_mul_f32 v12, v12, v28
    v_mul_f32 v13, v13, v28
    v_mul_f32 v14, v14, v28
    v_mul_f32 v15, v15, v28
    v_and_b32_dpp v32, v29, v8 row_newbcast:0 row_mask:0xf bank_mask:0xf
    v_and_b32_dpp v33, v29, v9 row_newbcast:0 row_mask:0xf bank_mask:0xf
    v_and_b32_dpp v34, v29, v10 row_newbcast:0 row_mask:0xf bank_mask:0xf
    v_and_b32_dpp v35, v29, v11 row_newbcast:0 row_mask:0xf bank_mask:0xf
    v_and_b32_dpp v36, v29, v8 row_newbcast:8 row_mask:0xf bank_mask:0xf
    v_and_b32_dpp v37, v29, v9 row_newbcast:8 row_mask:0xf bank_mask:0xf
    v_and_b32_dpp v38, v29, v10 row_newbcast:8 row_mask:0xf bank_mask:0xf
    v_and_b32_dpp v39, v29, v11 row_newbcast:8 row_mask:0xf bank_mask:0xf
    v_and_b32_dpp v40, v29, v8 row_newbcast:4 row_mask:0xf bank_mask:0xf
    v_and_b32_dpp v41, v29, v9 row_newbcast:4 row_mask:0xf bank_mask:0xf
    v_and_b32_dpp v42, v29, v10 row_newbcast:4 row_mask:0xf bank_mask:0xf
    v_and_b32_dpp v43, v29, v11 row_newbcast:4 row_mask:0xf bank_mask:0xf
    v_and_b32_dpp v44, v29, v8 row_newbcast:12 row_mask:0xf bank_mask:0xf
    v_and_b32_dpp v45, v29, v9 row_newbcast:12 row_mask:0xf bank_mask:0xf
    v_and_b32_dpp v46, v29, v10 row_newbcast:12 row_mask:0xf bank_mask:0xf
    v_and_b32_dpp v47, v29, v11 row_newbcast:12 row_mask:0xf bank_mask:0xf
    v_mfma_f32_16x16x32_bf16 v[12:15], v[32:35], a[48:51], v[12:15]
    v_mfma_f32_16x16x32_bf16 v[12:15], v[36:39], a[52:55], v[12:15]
    v_mfma_f32_16x16x32_bf16 v[12:15], v[40:43], a[56:59], v[12:15]
    v_mfma_f32_16x16x32_bf16 v[12:15], v[44:47], a[60:63], v[12:15]
    s_mov_b32 s56, 3
    s_branch L_aback1
L_aext2:
    s_cmp_lg_u32 s56, 3
    s_cbranch_scc1 L_aext4
    v_dot2_f32_bf16 v20, v128, v4, 0
    v_dot2_f32_bf16 v21, v132, v4, 0
    v_dot2_f32_bf16 v22, v136, v4, 0
    v_dot2_f32_bf16 v23, v140, v4, 0
    v_dot2_f32_bf16 v20, v129, v5, v20
    v_dot2_f32_bf16 v21, v133, v5, v21
    v_dot2_f32_bf16 v22, v137, v5, v22
    v_dot2_f32_bf16 v23, v141, v5, v23
    v_dot2_f32_bf16 v20, v130, v6, v20
    v_dot2_f32_bf16 v21, v134, v6, v21
    v_dot2_f32_bf16 v22, v138, v6, v22
    v_dot2_f32_bf16 v23, v142, v6, v23
    v_dot2_f32_bf16 v20, v131, v7, v20
    v_dot2_f32_bf16 v21, v135, v7, v21
    v_dot2_f32_bf16 v22, v139, v7, v22
    v_dot2_f32_bf16 v23, v143, v7, v23
    v_add_f32_dpp v24, v20, v20 row_ror:8 row_mask:0xf bank_mask:0x3
    s_nop 0
    v_add_f32_dpp v25, v22, v22 row_ror:8 row_mask:0xf bank_mask:0x3
    v_add_f32_dpp v24, v21, v21 row_ror:8 row_mask:0xf bank_mask:0xc
    v_add_f32_dpp v25, v23, v23 row_ror:8 row_mask:0xf bank_mask:0xc
    s_nop 0
    v_add_f32_dpp v26, v24, v24 row_shl:4 row_mask:0xf bank_mask:0x5
    v_add_f32_dpp v26, v25, v25 row_shr:4 row_mask:0xf bank_mask:0xa
    s_nop 1
    v_add_f32_dpp v26, v26, v26 quad_perm:[1,0,3,2] row_mask:0xf bank_mask:0xf
    s_nop 1
    v_add_f32_dpp v26, v26, v26 quad_perm:[2,3,0,1] row_mask:0xf bank_mask:0xf
    v_cvt_pk_bf16_f32 v26, v26, v26
    v_and_b32 v26, s98, v26
    v_mul_f32 v26, s96, v26
    v_cvt_pk_bf16_f32 v26, v26, v26
    v_and_b32 v26, s98, v26
    s_nop 1
    v_max_f32_dpp v27, v26, v26 row_ror:4 row_mask:0xf bank_mask:0xf
    s_nop 1
    v_max_f32_dpp v27, v27, v27 row_ror:8 row_mask:0xf bank_mask:0xf
    v_mov_b32 v28, v27
    s_nop 1
    v_permlane16_swap_b32 v27, v28
    v_max_f32 v27, v27, v28
    v_mov_b32 v28, v27
    s_nop 1
    v_permlane32_swap_b32 v27, v28
    v_max3_f32 v27, v27, v28, v16
    v_sub_f32 v28, v16, v27
    v_sub_f32 v29, v26, v27
    v_mul_f32 v28, s97, v28
    v_mul_f32 v29, s97, v29
    v_exp_f32 v28, v28
    v_exp_f32 v29, v29
    v_mov_b32 v16, v27
    v_fma_f32 v17, v17, v28, v29
    v_cvt_pk_bf16_f32 v29, v29, v29
    v_mul_f32 v12, v12, v28
    v_mul_f32 v13, v13, v28
    v_mul_f32 v14, v14, v28
    v_mul_f32 v15, v15, v28
    v_and_b32_dpp v32, v29, v8 row_newbcast:0 row_mask:0xf bank_mask:0xf
    v_and_b32_dpp v33, v29, v9 row_newbcast:0 row_mask:0xf bank_mask:0xf
    v_and_b32_dpp v34, v29, v10 row_newbcast:0 row_mask:0xf bank_mask:0xf
    v_and_b32_dpp v35, v29, v11 row_newbcast:0 row_mask:0xf bank_mask:0xf
    v_and_b32_dpp v36, v29, v8 row_newbcast:8 row_mask:0xf bank_mask:0xf
    v_and_b32_dpp v37, v29, v9 row_newbcast:8 row_mask:0xf bank_mask:0xf
    v_and_b32_dpp v38, v29, v10 row_newbcast:8 row_mask:0xf bank_mask:0xf
    v_and_b32_dpp v39, v29, v11 row_newbcast:8 row_mask:0xf bank_mask:0xf
    v_and_b32_dpp v40, v29, v8 row_newbcast:4 row_mask:0xf bank_mask:0xf
    v_and_b32_dpp v41, v29, v9 row_newbcast:4 row_mask:0xf bank_mask:0xf
    v_and_b32_dpp v42, v29, v10 row_newbcast:4 row_mask:0xf bank_mask:0xf
    v_and_b32_dpp v43, v29, v11 row_newbcast:4 row_mask:0xf bank_mask:0xf
    v_and_b32_dpp v44, v29, v8 row_newbcast:12 row_mask:0xf bank_mask:0xf
    v_and_b32_dpp v45, v29, v9 row_newbcast:12 row_mask:0xf bank_mask:0xf
    v_and_b32_dpp v46, v29, v10 row_newbcast:12 row_mask:0xf bank_mask:0xf
    v_and_b32_dpp v47, v29, v11 row_newbcast:12 row_mask:0xf bank_mask:0xf
    v_mfma_f32_16x16x32_bf16 v[12:15], v[32:35], a[64:67], v[12:15]
    v_mfma_f32_16x16x32_bf16 v[12:15], v[36:39], a[68:71], v[12:15]
    v_mfma_f32_16x16x32_bf16 v[12:15], v[40:43], a[72:75], v[12:15]
    v_mfma_f32_16x16x32_bf16 v[12:15], v[44:47], a[76:79], v[12:15]
    s_mov_b32 s56, 4
    s_branch L_aback0
L_aext3:
    s_cmp_lg_u32 s56, 4
    s_cbranch_scc1 L_aext5
    v_dot2_f32_bf16 v20, v144, v4, 0
    v_dot2_f32_bf16 v21, v148, v4, 0
    v_dot2_f32_bf16 v22, v152, v4, 0
    v_dot2_f32_bf16 v23, v156, v4, 0
    v_dot2_f32_bf16 v20, v145, v5, v20
    v_dot2_f32_bf16 v21, v149, v5, v21
    v_dot2_f32_bf16 v22, v153, v5, v22
    v_dot2_f32_bf16 v23, v157, v5, v23
    v_dot2_f32_bf16 v20, v146, v6, v20
    v_dot2_f32_bf16 v21, v150, v6, v21
    v_dot2_f32_bf16 v22, v154, v6, v22
    v_dot2_f32_bf16 v23, v158, v6, v23
    v_dot2_f32_bf16 v20, v147, v7, v20
    v_dot2_f32_bf16 v21, v151, v7, v21
    v_dot2_f32_bf16 v22, v155, v7, v22
    v_dot2_f32_bf16 v23, v159, v7, v23
    v_add_f32_dpp v24, v20, v20 row_ror:8 row_mask:0xf bank_mask:0x3
    s_nop 0
    v_add_f32_dpp v25, v22, v22 row_ror:8 row_mask:0xf bank_mask:0x3
    v_add_f32_dpp v24, v21, v21 row_ror:8 row_mask:0xf bank_mask:0xc
    v_add_f32_dpp v25, v23, v23 row_ror:8 row_mask:0xf bank_mask:0xc
    s_nop 0
    v_add_f32_dpp v26, v24, v24 row_shl:4 row_mask:0xf bank_mask:0x5
    v_add_f32_dpp v26, v25, v25 row_shr:4 row_mask:0xf bank_mask:0xa
    s_nop 1
    v_add_f32_dpp v26, v26, v26 quad_perm:[1,0,3,2] row_mask:0xf bank_mask:0xf
    s_nop 1
    v_add_f32_dpp v26, v26, v26 quad_perm:[2,3,0,1] row_mask:0xf bank_mask:0xf
    v_cvt_pk_bf16_f32 v26, v26, v26
    v_and_b32 v26, s98, v26
    v_mul_f32 v26, s96, v26
    v_cvt_pk_bf16_f32 v26, v26, v26
    v_and_b32 v26, s98, v26
    s_nop 1
    v_max_f32_dpp v27, v26, v26 row_ror:4 row_mask:0xf bank_mask:0xf
    s_nop 1
    v_max_f32_dpp v27, v27, v27 row_ror:8 row_mask:0xf bank_mask:0xf
    v_mov_b32 v28, v27
    s_nop 1
    v_permlane16_swap_b32 v27, v28
    v_max_f32 v27, v27, v28
    v_mov_b32 v28, v27
    s_nop 1
    v_permlane32_swap_b32 v27, v28
    v_max3_f32 v27, v27, v28, v16
    v_sub_f32 v28, v16, v27
    v_sub_f32 v29, v26, v27
    v_mul_f32 v28, s97, v28
    v_mul_f32 v29, s97, v29
    v_exp_f32 v28, v28
    v_exp_f32 v29, v29
    v_mov_b32 v16, v27
    v_fma_f32 v17, v17, v28, v29
    v_cvt_pk_bf16_f32 v29, v29, v29
    v_mul_f32 v12, v12, v28
    v_mul_f32 v13, v13, v28
    v_mul_f32 v14, v14, v28
    v_mul_f32 v15, v15, v28
    v_and_b32_dpp v32, v29, v8 row_newbcast:0 row_mask:0xf bank_mask:0xf
    v_and_b32_dpp v33, v29, v9 row_newbcast:0 row_mask:0xf bank_mask:0xf
    v_and_b32_dpp v34, v29, v10 row_newbcast:0 row_mask:0xf bank_mask:0xf
    v_and_b32_dpp v35, v29, v11 row_newbcast:0 row_mask:0xf bank_mask:0xf
    v_and_b32_dpp v36, v29, v8 row_newbcast:8 row_mask:0xf bank_mask:0xf
    v_and_b32_dpp v37, v29, v9 row_newbcast:8 row_mask:0xf bank_mask:0xf
    v_and_b32_dpp v38, v29, v10 row_newbcast:8 row_mask:0xf bank_mask:0xf
    v_and_b32_dpp v39, v29, v11 row_newbcast:8 row_mask:0xf bank_mask:0xf
    v_and_b32_dpp v40, v29, v8 row_newbcast:4 row_mask:0xf bank_mask:0xf
    v_and_b32_dpp v41, v29, v9 row_newbcast:4 row_mask:0xf bank_mask:0xf
    v_and_b32_dpp v42, v29, v10 row_newbcast:4 row_mask:0xf bank_mask:0xf
    v_and_b32_dpp v43, v29, v11 row_newbcast:4 row_mask:0xf bank_mask:0xf
    v_and_b32_dpp v44, v29, v8 row_newbcast:12 row_mask:0xf bank_mask:0xf
    v_and_b32_dpp v45, v29, v9 row_newbcast:12 row_mask:0xf bank_mask:0xf
    v_and_b32_dpp v46, v29, v10 row_newbcast:12 row_mask:0xf bank_mask:0xf
    v_and_b32_dpp v47, v29, v11 row_newbcast:12 row_mask:0xf bank_mask:0xf
    v_mfma_f32_16x16x32_bf16 v[12:15], v[32:35], a[80:83], v[12:15]
    v_mfma_f32_16x16x32_bf16 v[12:15], v[36:39], a[84:87], v[12:15]
    v_mfma_f32_16x16x32_bf16 v[12:15], v[40:43], a[88:91], v[12:15]
    v_mfma_f32_16x16x32_bf16 v[12:15], v[44:47], a[92:95], v[12:15]
    s_mov_b32 s56, 5
    s_branch L_aback1
L_aext4:
    s_cmp_lg_u32 s56, 5
    s_cbranch_scc1 L_aext6
    v_dot2_f32_bf16 v20, v160, v4, 0
    v_dot2_f32_bf16 v21, v164, v4, 0
    v_dot2_f32_bf16 v22, v168, v4, 0
    v_dot2_f32_bf16 v23, v172, v4, 0
    v_dot2_f32_bf16 v20, v161, v5, v20
    v_dot2_f32_bf16 v21, v165, v5, v21
    v_dot2_f32_bf16 v22, v169, v5, v22
    v_dot2_f32_bf16 v23, v173, v5, v23
    v_dot2_f32_bf16 v20, v162, v6, v20
    v_dot2_f32_bf16 v21, v166, v6, v21
    v_dot2_f32_bf16 v22, v170, v6, v22
    v_dot2_f32_bf16 v23, v174, v6, v23
    v_dot2_f32_bf16 v20, v163, v7, v20
    v_dot2_f32_bf16 v21, v167, v7, v21
    v_dot2_f32_bf16 v22, v171, v7, v22
    v_dot2_f32_bf16 v23, v175, v7, v23
    v_add_f32_dpp v24, v20, v20 row_ror:8 row_mask:0xf bank_mask:0x3
    s_nop 0
    v_add_f32_dpp v25, v22, v22 row_ror:8 row_mask:0xf bank_mask:0x3
    v_add_f32_dpp v24, v21, v21 row_ror:8 row_mask:0xf bank_mask:0xc
    v_add_f32_dpp v25, v23, v23 row_ror:8 row_mask:0xf bank_mask:0xc
    s_nop 0
    v_add_f32_dpp v26, v24, v24 row_shl:4 row_mask:0xf bank_mask:0x5
    v_add_f32_dpp v26, v25, v25 row_shr:4 row_mask:0xf bank_mask:0xa
    s_nop 1
    v_add_f32_dpp v26, v26, v26 quad_perm:[1,0,3,2] row_mask:0xf bank_mask:0xf
    s_nop 1
    v_add_f32_dpp v26, v26, v26 quad_perm:[2,3,0,1] row_mask:0xf bank_mask:0xf
    v_cvt_pk_bf16_f32 v26, v26, v26
    v_and_b32 v26, s98, v26
    v_mul_f32 v26, s96, v26
    v_cvt_pk_bf16_f32 v26, v26, v26
    v_and_b32 v26, s98, v26
    s_nop 1
    v_max_f32_dpp v27, v26, v26 row_ror:4 row_mask:0xf bank_mask:0xf
    s_nop 1
    v_max_f32_dpp v27, v27, v27 row_ror:8 row_mask:0xf bank_mask:0xf
    v_mov_b32 v28, v27
    s_nop 1
    v_permlane16_swap_b32 v27, v28
    v_max_f32 v27, v27, v28
    v_mov_b32 v28, v27
    s_nop 1
    v_permlane32_swap_b32 v27, v28
    v_max3_f32 v27, v27, v28, v16
    v_sub_f32 v28, v16, v27
    v_sub_f32 v29, v26, v27
    v_mul_f32 v28, s97, v28
    v_mul_f32 v29, s97, v29
    v_exp_f32 v28, v28
    v_exp_f32 v29, v29
    v_mov_b32 v16, v27
    v_fma_f32 v17, v17, v28, v29
    v_cvt_pk_bf16_f32 v29, v29, v29
    v_mul_f32 v12, v12, v28
    v_mul_f32 v13, v13, v28
    v_mul_f32 v14, v14, v28
    v_mul_f32 v15, v15, v28
    v_and_b32_dpp v32, v29, v8 row_newbcast:0 row_mask:0xf bank_mask:0xf
    v_and_b32_dpp v33, v29, v9 row_newbcast:0 row_mask:0xf bank_mask:0xf
    v_and_b32_dpp v34, v29, v10 row_newbcast:0 row_mask:0xf bank_mask:0xf
    v_and_b32_dpp v35, v29, v11 row_newbcast:0 row_mask:0xf bank_mask:0xf
    v_and_b32_dpp v36, v29, v8 row_newbcast:8 row_mask:0xf bank_mask:0xf
    v_and_b32_dpp v37, v29, v9 row_newbcast:8 row_mask:0xf bank_mask:0xf
    v_and_b32_dpp v38, v29, v10 row_newbcast:8 row_mask:0xf bank_mask:0xf
    v_and_b32_dpp v39, v29, v11 row_newbcast:8 row_mask:0xf bank_mask:0xf
    v_and_b32_dpp v40, v29, v8 row_newbcast:4 row_mask:0xf bank_mask:0xf
    v_and_b32_dpp v41, v29, v9 row_newbcast:4 row_mask:0xf bank_mask:0xf
    v_and_b32_dpp v42, v29, v10 row_newbcast:4 row_mask:0xf bank_mask:0xf
    v_and_b32_dpp v43, v29, v11 row_newbcast:4 row_mask:0xf bank_mask:0xf
    v_and_b32_dpp v44, v29, v8 row_newbcast:12 row_mask:0xf bank_mask:0xf
    v_and_b32_dpp v45, v29, v9 row_newbcast:12 row_mask:0xf bank_mask:0xf
    v_and_b32_dpp v46, v29, v10 row_newbcast:12 row_mask:0xf bank_mask:0xf
    v_and_b32_dpp v47, v29, v11 row_newbcast:12 row_mask:0xf bank_mask:0xf
    v_mfma_f32_16x16x32_bf16 v[12:15], v[32:35], a[96:99], v[12:15]
    v_mfma_f32_16x16x32_bf16 v[12:15], v[36:39], a[100:103], v[12:15]
    v_mfma_f32_16x16x32_bf16 v[12:15], v[40:43], a[104:107], v[12:15]
    v_mfma_f32_16x16x32_bf16 v[12:15], v[44:47], a[108:111], v[12:15]
    s_mov_b32 s56, 6
    s_branch L_aback0
L_aext5:
    s_cmp_lg_u32 s56, 6
    s_cbranch_scc1 L_aext7
    v_dot2_f32_bf16 v20, v176, v4, 0
    v_dot2_f32_bf16 v21, v180, v4, 0
    v_dot2_f32_bf16 v22, v184, v4, 0
    v_dot2_f32_bf16 v23, v188, v4, 0
    v_dot2_f32_bf16 v20, v177, v5, v20
    v_dot2_f32_bf16 v21, v181, v5, v21
    v_dot2_f32_bf16 v22, v185, v5, v22
    v_dot2_f32_bf16 v23, v189, v5, v23
    v_dot2_f32_bf16 v20, v178, v6, v20
    v_dot2_f32_bf16 v21, v182, v6, v21
    v_dot2_f32_bf16 v22, v186, v6, v22
    v_dot2_f32_bf16 v23, v190, v6, v23
    v_dot2_f32_bf16 v20, v179, v7, v20
    v_dot2_f32_bf16 v21, v183, v7, v21
    v_dot2_f32_bf16 v22, v187, v7, v22
    v_dot2_f32_bf16 v23, v191, v7, v23
    v_add_f32_dpp v24, v20, v20 row_ror:8 row_mask:0xf bank_mask:0x3
    s_nop 0
    v_add_f32_dpp v25, v22, v22 row_ror:8 row_mask:0xf bank_mask:0x3
    v_add_f32_dpp v24, v21, v21 row_ror:8 row_mask:0xf bank_mask:0xc
    v_add_f32_dpp v25, v23, v23 row_ror:8 row_mask:0xf bank_mask:0xc
    s_nop 0
    v_add_f32_dpp v26, v24, v24 row_shl:4 row_mask:0xf bank_mask:0x5
    v_add_f32_dpp v26, v25, v25 row_shr:4 row_mask:0xf bank_mask:0xa
    s_nop 1
    v_add_f32_dpp v26, v26, v26 quad_perm:[1,0,3,2] row_mask:0xf bank_mask:0xf
    s_nop 1
    v_add_f32_dpp v26, v26, v26 quad_perm:[2,3,0,1] row_mask:0xf bank_mask:0xf
    v_cvt_pk_bf16_f32 v26, v26, v26
    v_and_b32 v26, s98, v26
    v_mul_f32 v26, s96, v26
    v_cvt_pk_bf16_f32 v26, v26, v26
    v_and_b32 v26, s98, v26
    s_nop 1
    v_max_f32_dpp v27, v26, v26 row_ror:4 row_mask:0xf bank_mask:0xf
    s_nop 1
    v_max_f32_dpp v27, v27, v27 row_ror:8 row_mask:0xf bank_mask:0xf
    v_mov_b32 v28, v27
    s_nop 1
    v_permlane16_swap_b32 v27, v28
    v_max_f32 v27, v27, v28
    v_mov_b32 v28, v27
    s_nop 1
    v_permlane32_swap_b32 v27, v28
    v_max3_f32 v27, v27, v28, v16
    v_sub_f32 v28, v16, v27
    v_sub_f32 v29, v26, v27
    v_mul_f32 v28, s97, v28
    v_mul_f32 v29, s97, v29
    v_exp_f32 v28, v28
    v_exp_f32 v29, v29
    v_mov_b32 v16, v27
    v_fma_f32 v17, v17, v28, v29
    v_cvt_pk_bf16_f32 v29, v29, v29
    v_mul_f32 v12, v12, v28
    v_mul_f32 v13, v13, v28
    v_mul_f32 v14, v14, v28
    v_mul_f32 v15, v15, v28
    v_and_b32_dpp v32, v29, v8 row_newbcast:0 row_mask:0xf bank_mask:0xf
    v_and_b32_dpp v33, v29, v9 row_newbcast:0 row_mask:0xf bank_mask:0xf
    v_and_b32_dpp v34, v29, v10 row_newbcast:0 row_mask:0xf bank_mask:0xf
    v_and_b32_dpp v35, v29, v11 row_newbcast:0 row_mask:0xf bank_mask:0xf
    v_and_b32_dpp v36, v29, v8 row_newbcast:8 row_mask:0xf bank_mask:0xf
    v_and_b32_dpp v37, v29, v9 row_newbcast:8 row_mask:0xf bank_mask:0xf
    v_and_b32_dpp v38, v29, v10 row_newbcast:8 row_mask:0xf bank_mask:0xf
    v_and_b32_dpp v39, v29, v11 row_newbcast:8 row_mask:0xf bank_mask:0xf
    v_and_b32_dpp v40, v29, v8 row_newbcast:4 row_mask:0xf bank_mask:0xf
    v_and_b32_dpp v41, v29, v9 row_newbcast:4 row_mask:0xf bank_mask:0xf
    v_and_b32_dpp v42, v29, v10 row_newbcast:4 row_mask:0xf bank_mask:0xf
    v_and_b32_dpp v43, v29, v11 row_newbcast:4 row_mask:0xf bank_mask:0xf
    v_and_b32_dpp v44, v29, v8 row_newbcast:12 row_mask:0xf bank_mask:0xf
    v_and_b32_dpp v45, v29, v9 row_newbcast:12 row_mask:0xf bank_mask:0xf
    v_and_b32_dpp v46, v29, v10 row_newbcast:12 row_mask:0xf bank_mask:0xf
    v_and_b32_dpp v47, v29, v11 row_newbcast:12 row_mask:0xf bank_mask:0xf
    v_mfma_f32_16x16x32_bf16 v[12:15], v[32:35], a[112:115], v[12:15]
    v_mfma_f32_16x16x32_bf16 v[12:15], v[36:39], a[116:119], v[12:15]
    v_mfma_f32_16x16x32_bf16 v[12:15], v[40:43], a[120:123], v[12:15]
    v_mfma_f32_16x16x32_bf16 v[12:15], v[44:47], a[124:127], v[12:15]
    s_mov_b32 s56, 7
    s_branch L_aback1
L_aext6:
    s_cmp_lg_u32 s56, 7
    s_cbranch_scc1 L_aext8
    v_dot2_f32_bf16 v20, v192, v4, 0
    v_dot2_f32_bf16 v21, v196, v4, 0
    v_dot2_f32_bf16 v22, v200, v4, 0
    v_dot2_f32_bf16 v23, v204, v4, 0
    v_dot2_f32_bf16 v20, v193, v5, v20
    v_dot2_f32_bf16 v21, v197, v5, v21
    v_dot2_f32_bf16 v22, v201, v5, v22
    v_dot2_f32_bf16 v23, v205, v5, v23
    v_dot2_f32_bf16 v20, v194, v6, v20
    v_dot2_f32_bf16 v21, v198, v6, v21
    v_dot2_f32_bf16 v22, v202, v6, v22
    v_dot2_f32_bf16 v23, v206, v6, v23
    v_dot2_f32_bf16 v20, v195, v7, v20
    v_dot2_f32_bf16 v21, v199, v7, v21
    v_dot2_f32_bf16 v22, v203, v7, v22
    v_dot2_f32_bf16 v23, v207, v7, v23
    v_add_f32_dpp v24, v20, v20 row_ror:8 row_mask:0xf bank_mask:0x3
    s_nop 0
    v_add_f32_dpp v25, v22, v22 row_ror:8 row_mask:0xf bank_mask:0x3
    v_add_f32_dpp v24, v21, v21 row_ror:8 row_mask:0xf bank_mask:0xc
    v_add_f32_dpp v25, v23, v23 row_ror:8 row_mask:0xf bank_mask:0xc
    s_nop 0
    v_add_f32_dpp v26, v24, v24 row_shl:4 row_mask:0xf bank_mask:0x5
    v_add_f32_dpp v26, v25, v25 row_shr:4 row_mask:0xf bank_mask:0xa
    s_nop 1
    v_add_f32_dpp v26, v26, v26 quad_perm:[1,0,3,2] row_mask:0xf bank_mask:0xf
    s_nop 1
    v_add_f32_dpp v26, v26, v26 quad_perm:[2,3,0,1] row_mask:0xf bank_mask:0xf
    v_cvt_pk_bf16_f32 v26, v26, v26
    v_and_b32 v26, s98, v26
    v_mul_f32 v26, s96, v26
    v_cvt_pk_bf16_f32 v26, v26, v26
    v_and_b32 v26, s98, v26
    s_nop 1
    v_max_f32_dpp v27, v26, v26 row_ror:4 row_mask:0xf bank_mask:0xf
    s_nop 1
    v_max_f32_dpp v27, v27, v27 row_ror:8 row_mask:0xf bank_mask:0xf
    v_mov_b32 v28, v27
    s_nop 1
    v_permlane16_swap_b32 v27, v28
    v_max_f32 v27, v27, v28
    v_mov_b32 v28, v27
    s_nop 1
    v_permlane32_swap_b32 v27, v28
    v_max3_f32 v27, v27, v28, v16
    v_sub_f32 v28, v16, v27
    v_sub_f32 v29, v26, v27
    v_mul_f32 v28, s97, v28
    v_mul_f32 v29, s97, v29
    v_exp_f32 v28, v28
    v_exp_f32 v29, v29
    v_mov_b32 v16, v27
    v_fma_f32 v17, v17, v28, v29
    v_cvt_pk_bf16_f32 v29, v29, v29
    v_mul_f32 v12, v12, v28
    v_mul_f32 v13, v13, v28
    v_mul_f32 v14, v14, v28
    v_mul_f32 v15, v15, v28
    v_and_b32_dpp v32, v29, v8 row_newbcast:0 row_mask:0xf bank_mask:0xf
    v_and_b32_dpp v33, v29, v9 row_newbcast:0 row_mask:0xf bank_mask:0xf
    v_and_b32_dpp v34, v29, v10 row_newbcast:0 row_mask:0xf bank_mask:0xf
    v_and_b32_dpp v35, v29, v11 row_newbcast:0 row_mask:0xf bank_mask:0xf
    v_and_b32_dpp v36, v29, v8 row_newbcast:8 row_mask:0xf bank_mask:0xf
    v_and_b32_dpp v37, v29, v9 row_newbcast:8 row_mask:0xf bank_mask:0xf
    v_and_b32_dpp v38, v29, v10 row_newbcast:8 row_mask:0xf bank_mask:0xf
    v_and_b32_dpp v39, v29, v11 row_newbcast:8 row_mask:0xf bank_mask:0xf
    v_and_b32_dpp v40, v29, v8 row_newbcast:4 row_mask:0xf bank_mask:0xf
    v_and_b32_dpp v41, v29, v9 row_newbcast:4 row_mask:0xf bank_mask:0xf
    v_and_b32_dpp v42, v29, v10 row_newbcast:4 row_mask:0xf bank_mask:0xf
    v_and_b32_dpp v43, v29, v11 row_newbcast:4 row_mask:0xf bank_mask:0xf
    v_and_b32_dpp v44, v29, v8 row_newbcast:12 row_mask:0xf bank_mask:0xf
    v_and_b32_dpp v45, v29, v9 row_newbcast:12 row_mask:0xf bank_mask:0xf
    v_and_b32_dpp v46, v29, v10 row_newbcast:12 row_mask:0xf bank_mask:0xf
    v_and_b32_dpp v47, v29, v11 row_newbcast:12 row_mask:0xf bank_mask:0xf
    v_mfma_f32_16x16x32_bf16 v[12:15], v[32:35], a[128:131], v[12:15]
    v_mfma_f32_16x16x32_bf16 v[12:15], v[36:39], a[132:135], v[12:15]
    v_mfma_f32_16x16x32_bf16 v[12:15], v[40:43], a[136:139], v[12:15]
    v_mfma_f32_16x16x32_bf16 v[12:15], v[44:47], a[140:143], v[12:15]
    s_mov_b32 s56, 8
    s_branch L_aback0
L_aext7:
    s_cmp_lg_u32 s56, 8
    s_cbranch_scc1 L_aext9
    v_dot2_f32_bf16 v20, v208, v4, 0
    v_dot2_f32_bf16 v21, v212, v4, 0
    v_dot2_f32_bf16 v22, v216, v4, 0
    v_dot2_f32_bf16 v23, v220, v4, 0
    v_dot2_f32_bf16 v20, v209, v5, v20
    v_dot2_f32_bf16 v21, v213, v5, v21
    v_dot2_f32_bf16 v22, v217, v5, v22
    v_dot2_f32_bf16 v23, v221, v5, v23
    v_dot2_f32_bf16 v20, v210, v6, v20
    v_dot2_f32_bf16 v21, v214, v6, v21
    v_dot2_f32_bf16 v22, v218, v6, v22
    v_dot2_f32_bf16 v23, v222, v6, v23
    v_dot2_f32_bf16 v20, v211, v7, v20
    v_dot2_f32_bf16 v21, v215, v7, v21
    v_dot2_f32_bf16 v22, v219, v7, v22
    v_dot2_f32_bf16 v23, v223, v7, v23
    v_add_f32_dpp v24, v20, v20 row_ror:8 row_mask:0xf bank_mask:0x3
    s_nop 0
    v_add_f32_dpp v25, v22, v22 row_ror:8 row_mask:0xf bank_mask:0x3
    v_add_f32_dpp v24, v21, v21 row_ror:8 row_mask:0xf bank_mask:0xc
    v_add_f32_dpp v25, v23, v23 row_ror:8 row_mask:0xf bank_mask:0xc
    s_nop 0
    v_add_f32_dpp v26, v24, v24 row_shl:4 row_mask:0xf bank_mask:0x5
    v_add_f32_dpp v26, v25, v25 row_shr:4 row_mask:0xf bank_mask:0xa
    s_nop 1
    v_add_f32_dpp v26, v26, v26 quad_perm:[1,0,3,2] row_mask:0xf bank_mask:0xf
    s_nop 1
    v_add_f32_dpp v26, v26, v26 quad_perm:[2,3,0,1] row_mask:0xf bank_mask:0xf
    v_cvt_pk_bf16_f32 v26, v26, v26
    v_and_b32 v26, s98, v26
    v_mul_f32 v26, s96, v26
    v_cvt_pk_bf16_f32 v26, v26, v26
    v_and_b32 v26, s98, v26
    s_nop 1
    v_max_f32_dpp v27, v26, v26 row_ror:4 row_mask:0xf bank_mask:0xf
    s_nop 1
    v_max_f32_dpp v27, v27, v27 row_ror:8 row_mask:0xf bank_mask:0xf
    v_mov_b32 v28, v27
    s_nop 1
    v_permlane16_swap_b32 v27, v28
    v_max_f32 v27, v27, v28
    v_mov_b32 v28, v27
    s_nop 1
    v_permlane32_swap_b32 v27, v28
    v_max3_f32 v27, v27, v28, v16
    v_sub_f32 v28, v16, v27
    v_sub_f32 v29, v26, v27
    v_mul_f32 v28, s97, v28
    v_mul_f32 v29, s97, v29
    v_exp_f32 v28, v28
    v_exp_f32 v29, v29
    v_mov_b32 v16, v27
    v_fma_f32 v17, v17, v28, v29
    v_cvt_pk_bf16_f32 v29, v29, v29
    v_mul_f32 v12, v12, v28
    v_mul_f32 v13, v13, v28
    v_mul_f32 v14, v14, v28
    v_mul_f32 v15, v15, v28
    v_and_b32_dpp v32, v29, v8 row_newbcast:0 row_mask:0xf bank_mask:0xf
    v_and_b32_dpp v33, v29, v9 row_newbcast:0 row_mask:0xf bank_mask:0xf
    v_and_b32_dpp v34, v29, v10 row_newbcast:0 row_mask:0xf bank_mask:0xf
    v_and_b32_dpp v35, v29, v11 row_newbcast:0 row_mask:0xf bank_mask:0xf
    v_and_b32_dpp v36, v29, v8 row_newbcast:8 row_mask:0xf bank_mask:0xf
    v_and_b32_dpp v37, v29, v9 row_newbcast:8 row_mask:0xf bank_mask:0xf
    v_and_b32_dpp v38, v29, v10 row_newbcast:8 row_mask:0xf bank_mask:0xf
    v_and_b32_dpp v39, v29, v11 row_newbcast:8 row_mask:0xf bank_mask:0xf
    v_and_b32_dpp v40, v29, v8 row_newbcast:4 row_mask:0xf bank_mask:0xf
    v_and_b32_dpp v41, v29, v9 row_newbcast:4 row_mask:0xf bank_mask:0xf
    v_and_b32_dpp v42, v29, v10 row_newbcast:4 row_mask:0xf bank_mask:0xf
    v_and_b32_dpp v43, v29, v11 row_newbcast:4 row_mask:0xf bank_mask:0xf
    v_and_b32_dpp v44, v29, v8 row_newbcast:12 row_mask:0xf bank_mask:0xf
    v_and_b32_dpp v45, v29, v9 row_newbcast:12 row_mask:0xf bank_mask:0xf
    v_and_b32_dpp v46, v29, v10 row_newbcast:12 row_mask:0xf bank_mask:0xf
    v_and_b32_dpp v47, v29, v11 row_newbcast:12 row_mask:0xf bank_mask:0xf
    v_mfma_f32_16x16x32_bf16 v[12:15], v[32:35], a[144:147], v[12:15]
    v_mfma_f32_16x16x32_bf16 v[12:15], v[36:39], a[148:151], v[12:15]
    v_mfma_f32_16x16x32_bf16 v[12:15], v[40:43], a[152:155], v[12:15]
    v_mfma_f32_16x16x32_bf16 v[12:15], v[44:47], a[156:159], v[12:15]
    s_mov_b32 s56, 9
    s_branch L_aback1
L_aext8:
    v_dot2_f32_bf16 v20, v224, v4, 0
    v_dot2_f32_bf16 v21, v228, v4, 0
    v_dot2_f32_bf16 v22, v232, v4, 0
    v_dot2_f32_bf16 v23, v236, v4, 0
    v_dot2_f32_bf16 v20, v225, v5, v20
    v_dot2_f32_bf16 v21, v229, v5, v21
    v_dot2_f32_bf16 v22, v233, v5, v22
    v_dot2_f32_bf16 v23, v237, v5, v23
    v_dot2_f32_bf16 v20, v226, v6, v20
    v_dot2_f32_bf16 v21, v230, v6, v21
    v_dot2_f32_bf16 v22, v234, v6, v22
    v_dot2_f32_bf16 v23, v238, v6, v23
    v_dot2_f32_bf16 v20, v227, v7, v20
    v_dot2_f32_bf16 v21, v231, v7, v21
    v_dot2_f32_bf16 v22, v235, v7, v22
    v_dot2_f32_bf16 v23, v239, v7, v23
    v_add_f32_dpp v24, v20, v20 row_ror:8 row_mask:0xf bank_mask:0x3
    s_nop 0
    v_add_f32_dpp v25, v22, v22 row_ror:8 row_mask:0xf bank_mask:0x3
    v_add_f32_dpp v24, v21, v21 row_ror:8 row_mask:0xf bank_mask:0xc
    v_add_f32_dpp v25, v23, v23 row_ror:8 row_mask:0xf bank_mask:0xc
    s_nop 0
    v_add_f32_dpp v26, v24, v24 row_shl:4 row_mask:0xf bank_mask:0x5
    v_add_f32_dpp v26, v25, v25 row_shr:4 row_mask:0xf bank_mask:0xa
    s_nop 1
    v_add_f32_dpp v26, v26, v26 quad_perm:[1,0,3,2] row_mask:0xf bank_mask:0xf
    s_nop 1
    v_add_f32_dpp v26, v26, v26 quad_perm:[2,3,0,1] row_mask:0xf bank_mask:0xf
    v_cvt_pk_bf16_f32 v26, v26, v26
    v_and_b32 v26, s98, v26
    v_mul_f32 v26, s96, v26
    v_cvt_pk_bf16_f32 v26, v26, v26
    v_and_b32 v26, s98, v26
    s_nop 1
    v_max_f32_dpp v27, v26, v26 row_ror:4 row_mask:0xf bank_mask:0xf
    s_nop 1
    v_max_f32_dpp v27, v27, v27 row_ror:8 row_mask:0xf bank_mask:0xf
    v_mov_b32 v28, v27
    s_nop 1
    v_permlane16_swap_b32 v27, v28
    v_max_f32 v27, v27, v28
    v_mov_b32 v28, v27
    s_nop 1
    v_permlane32_swap_b32 v27, v28
    v_max3_f32 v27, v27, v28, v16
    v_sub_f32 v28, v16, v27
    v_sub_f32 v29, v26, v27
    v_mul_f32 v28, s97, v28
    v_mul_f32 v29, s97, v29
    v_exp_f32 v28, v28
    v_exp_f32 v29, v29
    v_mov_b32 v16, v27
    v_fma_f32 v17, v17, v28, v29
    v_cvt_pk_bf16_f32 v29, v29, v29
    v_mul_f32 v12, v12, v28
    v_mul_f32 v13, v13, v28
    v_mul_f32 v14, v14, v28
    v_mul_f32 v15, v15, v28
    v_and_b32_dpp v32, v29, v8 row_newbcast:0 row_mask:0xf bank_mask:0xf
    v_and_b32_dpp v33, v29, v9 row_newbcast:0 row_mask:0xf bank_mask:0xf
    v_and_b32_dpp v34, v29, v10 row_newbcast:0 row_mask:0xf bank_mask:0xf
    v_and_b32_dpp v35, v29, v11 row_newbcast:0 row_mask:0xf bank_mask:0xf
    v_and_b32_dpp v36, v29, v8 row_newbcast:8 row_mask:0xf bank_mask:0xf
    v_and_b32_dpp v37, v29, v9 row_newbcast:8 row_mask:0xf bank_mask:0xf
    v_and_b32_dpp v38, v29, v10 row_newbcast:8 row_mask:0xf bank_mask:0xf
    v_and_b32_dpp v39, v29, v11 row_newbcast:8 row_mask:0xf bank_mask:0xf
    v_and_b32_dpp v40, v29, v8 row_newbcast:4 row_mask:0xf bank_mask:0xf
    v_and_b32_dpp v41, v29, v9 row_newbcast:4 row_mask:0xf bank_mask:0xf
    v_and_b32_dpp v42, v29, v10 row_newbcast:4 row_mask:0xf bank_mask:0xf
    v_and_b32_dpp v43, v29, v11 row_newbcast:4 row_mask:0xf bank_mask:0xf
    v_and_b32_dpp v44, v29, v8 row_newbcast:12 row_mask:0xf bank_mask:0xf
    v_and_b32_dpp v45, v29, v9 row_newbcast:12 row_mask:0xf bank_mask:0xf
    v_and_b32_dpp v46, v29, v10 row_newbcast:12 row_mask:0xf bank_mask:0xf
    v_and_b32_dpp v47, v29, v11 row_newbcast:12 row_mask:0xf bank_mask:0xf
    v_mfma_f32_16x16x32_bf16 v[12:15], v[32:35], a[160:163], v[12:15]
    v_mfma_f32_16x16x32_bf16 v[12:15], v[36:39], a[164:167], v[12:15]
    v_mfma_f32_16x16x32_bf16 v[12:15], v[40:43], a[168:171], v[12:15]
    v_mfma_f32_16x16x32_bf16 v[12:15], v[44:47], a[172:175], v[12:15]
    s_mov_b32 s56, 10
    s_branch L_aback0
L_aext9:
    v_dot2_f32_bf16 v20, v240, v4, 0
    v_dot2_f32_bf16 v21, v244, v4, 0
    v_dot2_f32_bf16 v22, v248, v4, 0
    v_dot2_f32_bf16 v23, v252, v4, 0
    v_dot2_f32_bf16 v20, v241, v5, v20
    v_dot2_f32_bf16 v21, v245, v5, v21
    v_dot2_f32_bf16 v22, v249, v5, v22
    v_dot2_f32_bf16 v23, v253, v5, v23
    v_dot2_f32_bf16 v20, v242, v6, v20
    v_dot2_f32_bf16 v21, v246, v6, v21
    v_dot2_f32_bf16 v22, v250, v6, v22
    v_dot2_f32_bf16 v23, v254, v6, v23
    v_dot2_f32_bf16 v20, v243, v7, v20
    v_dot2_f32_bf16 v21, v247, v7, v21
    v_dot2_f32_bf16 v22, v251, v7, v22
    v_dot2_f32_bf16 v23, v255, v7, v23
    v_add_f32_dpp v24, v20, v20 row_ror:8 row_mask:0xf bank_mask:0x3
    s_nop 0
    v_add_f32_dpp v25, v22, v22 row_ror:8 row_mask:0xf bank_mask:0x3
    v_add_f32_dpp v24, v21, v21 row_ror:8 row_mask:0xf bank_mask:0xc
    v_add_f32_dpp v25, v23, v23 row_ror:8 row_mask:0xf bank_mask:0xc
    s_nop 0
    v_add_f32_dpp v26, v24, v24 row_shl:4 row_mask:0xf bank_mask:0x5
    v_add_f32_dpp v26, v25, v25 row_shr:4 row_mask:0xf bank_mask:0xa
    s_nop 1
    v_add_f32_dpp v26, v26, v26 quad_perm:[1,0,3,2] row_mask:0xf bank_mask:0xf
    s_nop 1
    v_add_f32_dpp v26, v26, v26 quad_perm:[2,3,0,1] row_mask:0xf bank_mask:0xf
    v_cvt_pk_bf16_f32 v26, v26, v26
    v_and_b32 v26, s98, v26
    v_mul_f32 v26, s96, v26
    v_cvt_pk_bf16_f32 v26, v26, v26
    v_and_b32 v26, s98, v26
    s_nop 1
    v_max_f32_dpp v27, v26, v26 row_ror:4 row_mask:0xf bank_mask:0xf
    s_nop 1
    v_max_f32_dpp v27, v27, v27 row_ror:8 row_mask:0xf bank_mask:0xf
    v_mov_b32 v28, v27
    s_nop 1
    v_permlane16_swap_b32 v27, v28
    v_max_f32 v27, v27, v28
    v_mov_b32 v28, v27
    s_nop 1
    v_permlane32_swap_b32 v27, v28
    v_max3_f32 v27, v27, v28, v16
    v_sub_f32 v28, v16, v27
    v_sub_f32 v29, v26, v27
    v_mul_f32 v28, s97, v28
    v_mul_f32 v29, s97, v29
    v_exp_f32 v28, v28
    v_exp_f32 v29, v29
    v_mov_b32 v16, v27
    v_fma_f32 v17, v17, v28, v29
    v_cvt_pk_bf16_f32 v29, v29, v29
    v_mul_f32 v12, v12, v28
    v_mul_f32 v13, v13, v28
    v_mul_f32 v14, v14, v28
    v_mul_f32 v15, v15, v28
    v_and_b32_dpp v32, v29, v8 row_newbcast:0 row_mask:0xf bank_mask:0xf
    v_and_b32_dpp v33, v29, v9 row_newbcast:0 row_mask:0xf bank_mask:0xf
    v_and_b32_dpp v34, v29, v10 row_newbcast:0 row_mask:0xf bank_mask:0xf
    v_and_b32_dpp v35, v29, v11 row_newbcast:0 row_mask:0xf bank_mask:0xf
    v_and_b32_dpp v36, v29, v8 row_newbcast:8 row_mask:0xf bank_mask:0xf
    v_and_b32_dpp v37, v29, v9 row_newbcast:8 row_mask:0xf bank_mask:0xf
    v_and_b32_dpp v38, v29, v10 row_newbcast:8 row_mask:0xf bank_mask:0xf
    v_and_b32_dpp v39, v29, v11 row_newbcast:8 row_mask:0xf bank_mask:0xf
    v_and_b32_dpp v40, v29, v8 row_newbcast:4 row_mask:0xf bank_mask:0xf
    v_and_b32_dpp v41, v29, v9 row_newbcast:4 row_mask:0xf bank_mask:0xf
    v_and_b32_dpp v42, v29, v10 row_newbcast:4 row_mask:0xf bank_mask:0xf
    v_and_b32_dpp v43, v29, v11 row_newbcast:4 row_mask:0xf bank_mask:0xf
    v_and_b32_dpp v44, v29, v8 row_newbcast:12 row_mask:0xf bank_mask:0xf
    v_and_b32_dpp v45, v29, v9 row_newbcast:12 row_mask:0xf bank_mask:0xf
    v_and_b32_dpp v46, v29, v10 row_newbcast:12 row_mask:0xf bank_mask:0xf
    v_and_b32_dpp v47, v29, v11 row_newbcast:12 row_mask:0xf bank_mask:0xf
    v_mfma_f32_16x16x32_bf16 v[12:15], v[32:35], a[176:179], v[12:15]
    v_mfma_f32_16x16x32_bf16 v[12:15], v[36:39], a[180:183], v[12:15]
    v_mfma_f32_16x16x32_bf16 v[12:15], v[40:43], a[184:187], v[12:15]
    v_mfma_f32_16x16x32_bf16 v[12:15], v[44:47], a[188:191], v[12:15]
    s_mov_b32 s56, 0
    s_branch L_aback1
L_aflag:
    s_sleep 2
    global_load_dword v57, v58, s[28:29] sc1
    s_waitcnt vmcnt(0)
    v_readfirstlane_b32 s18, v57
    v_cmp_gt_u32 vcc, 1073741824, v57
    s_cbranch_vccz L_aflag_ok
    s_sub_u32 s101, s101, 1
    s_cbranch_scc0 L_aflag
    s_mov_b32 s101, 0
    s_branch L_aflag_ok
L_roleA_end:
L_roleH:
    s_mov_b32 s101, 100000
    s_getpc_b64 s[56:57]
L_pc_16:
    s_sub_u32 s56, s56, L_pc_16-L_roleH
    s_subb_u32 s57, s57, 0
    v_lshlrev_b32 v5, 7, v0
    v_min_u32 v6, L_roleH_end-L_roleH-4, v5
    global_load_dword v122, v6, s[56:57]
    v_mov_b32 v20, -1
    v_mov_b32 v21, -1
    v_mov_b32 v22, -1
    v_mov_b32 v23, -1
    v_mul_u32_u24 v7, 73728, v4
    v_lshrrev_b32 v5, 3, v3
    v_lshl_add_u32 v6, v5, 13, v7
    v_and_b32 v5, 7, v3
    v_lshl_add_u32 v6, v5, 4, v6
    v_lshl_add_u32 v7, v3, 3, v7
    v_add_u32 v7, 65536, v7
    s_lshl_b32 s56, s52, 7
    s_add_u32 s56, s56, 4718592
    s_lshl_b32 s54, s3, 14
    s_add_u32 s54, s54, s56
    s_add_u32 s55, s54, 4096
    s_and_b32 s57, s3, 1
    s_lshl_b32 s57, s57, 12
    s_add_u32 s56, s56, s57
    s_waitcnt lgkmcnt(0)
    s_mov_b32 s44, s30
    s_mov_b32 s45, s31
    s_mov_b32 s46, 536870912
    s_mov_b32 s47, 0x20000
    buffer_store_dwordx4 v[20:23], v6, s[44:47], s54 offen sc1
    buffer_store_dwordx4 v[20:23], v6, s[44:47], s55 offen sc1
    buffer_store_dwordx2 v[20:21], v7, s[44:47], s56 offen sc1
    v_lshrrev_b32 v5, 2, v3
    v_lshlrev_b32 v5, 15, v5
    v_lshl_add_u32 v5, v4, 4, v5
    v_and_b32 v6, 3, v3
    v_lshl_add_u32 v5, v6, 6, v5
    s_lshl_b32 s54, s52, 10
    s_lshl_b32 s55, s3, 8
    s_add_u32 s54, s54, s55
    s_add_u32 s54, s54, 1048576
    buffer_store_dwordx4 v[20:23], v5, s[44:47], s54 offen sc1
    v_bfe_u32 v6, v1, 2, 2
    v_lshlrev_b32 v6, 6, v6
    v_and_b32 v5, 48, v1
    v_add_u32 v6, v6, v5
    v_and_b32 v5, 3, v1
    v_lshl_add_u32 v6, v5, 29, v6
    s_lshl_b32 s54, s52, 10
    s_lshl_b32 s55, s3, 8
    s_add_u32 s54, s54, s55
    s_add_u32 s54, s54, 5439488
    buffer_store_dwordx4 v[20:23], v6, s[44:47], s54 offen sc1
    s_mov_b32 s32, s18
    s_mov_b32 s33, s19
    s_mov_b32 s34, 4718592
    s_mov_b32 s35, 0x20000
    s_mov_b32 s36, s14
    s_mov_b32 s37, s15
    s_mov_b32 s38, 4608
    s_mov_b32 s39, 0x20000
    v_lshrrev_b32 v5, 3, v3
    v_mul_u32_u24 v5, 1152, v5
    v_mul_u32_u24 v6, 72, v4
    v_add_u32 v5, v5, v6
    s_mul_i32 s54, s3, 288
    buffer_load_dwordx4 v[48:51], v5, s[36:39], s54 offen offset:0
    buffer_load_dwordx4 v[52:55], v5, s[36:39], s54 offen offset:16
    buffer_load_dwordx4 v[56:59], v5, s[36:39], s54 offen offset:32
    buffer_load_dwordx4 v[60:63], v5, s[36:39], s54 offen offset:48
    buffer_load_dwordx2 v[64:65], v5, s[36:39], s54 offen offset:64
    buffer_load_dwordx4 v[68:71], v5, s[36:39], s54 offen offset:2304
    buffer_load_dwordx4 v[72:75], v5, s[36:39], s54 offen offset:2320
    buffer_load_dwordx4 v[76:79], v5, s[36:39], s54 offen offset:2336
    buffer_load_dwordx4 v[80:83], v5, s[36:39], s54 offen offset:2352
    buffer_load_dwordx2 v[84:85], v5, s[36:39], s54 offen offset:2368
    v_mul_u32_u24 v120, 294912, v4
    v_lshl_add_u32 v120, v3, 4, v120
    s_mul_i32 s61, s3, 1179648
    s_lshl_b32 s54, s52, 8
    s_add_u32 s61, s61, s54
    buffer_load_dwordx4 a[112:115], v120, s[32:35], s61 offen nt
    s_add_u32 s61, s61, 8192
    buffer_load_dwordx4 a[116:119], v120, s[32:35], s61 offen nt
    s_add_u32 s61, s61, 8192
    buffer_load_dwordx4 a[120:123], v120, s[32:35], s61 offen nt
    s_add_u32 s61, s61, 8192
    buffer_load_dwordx4 a[124:127], v120, s[32:35], s61 offen nt
    s_add_u32 s61, s61, 8192
    buffer_load_dwordx4 a[128:131], v120, s[32:35], s61 offen nt
    s_add_u32 s61, s61, 8192
    buffer_load_dwordx4 a[132:135], v120, s[32:35], s61 offen nt
    s_add_u32 s61, s61, 8192
    buffer_load_dwordx4 a[136:139], v120, s[32:35], s61 offen nt
    s_add_u32 s61, s61, 8192
    buffer_load_dwordx4 a[140:143], v120, s[32:35], s61 offen nt
    s_add_u32 s61, s61, 8192
    buffer_load_dwordx4 a[144:147], v120, s[32:35], s61 offen nt
    s_add_u32 s61, s61, 8192
    s_cmp_lg_u32 s3, 0
    s_cbranch_scc1 L_norace_17
    s_sub_u32 s84, s52, 1
    s_lshl_b32 s84, s84, 11
    s_lshl_b32 s85, s52, 12
    s_xor_b32 s84, s84, s85
    s_lshl_b32 s85, s52, 10
    s_xor_b32 s84, s84, s85
    s_and_b32 s84, s84, 0x2000
    s_lshr_b32 s85, s52, 2
    s_xor_b32 s85, s85, s52
    s_and_b32 s85, s85, 3
    s_lshl_b32 s85, s85, 25
    s_or_b32 s84, s84, s85
    s_lshl_b32 s85, s52, 20
    s_or_b32 s84, s84, s85
    s_xor_b32 s85, s84, 0x2000
    s_mov_b32 s86, -1
    s_mov_b32 s87, -1
    s_load_dword s87, s[6:7], s85 offset:0x80500
    s_load_dword s86, s[6:7], s84 offset:0x80000
    s_mov_b32 s97, 1
    s_waitcnt lgkmcnt(1)
    s_cmp_lg_u32 s87, -1
    s_subb_u32 s97, s97, 0
    s_cmp_lg_u32 s86, -1
    s_addc_u32 s97, s97, 0
    s_sub_u32 s96, 2, s97
    s_bitcmp1_b32 s52, 3
    s_cselect_b32 s97, s96, s97
    s_lshl_b32 s97, s97, 0
    s_or_b32 s97, s97, 0x1000000
L_norace_17:
    s_waitcnt vmcnt(19)
    s_barrier
    s_cmp_lg_u32 s3, 0
    s_cbranch_scc1 L_nosig_18
    s_atomic_add s97, s[28:29], 0 glc
L_nosig_18:
    buffer_load_dwordx4 a[148:151], v120, s[32:35], s61 offen nt
    s_add_u32 s61, s61, 8192
    buffer_load_dwordx4 a[152:155], v120, s[32:35], s61 offen nt
    s_add_u32 s61, s61, 8192
    buffer_load_dwordx4 a[156:159], v120, s[32:35], s61 offen nt
    s_add_u32 s61, s61, 8192
    buffer_load_dwordx4 a[160:163], v120, s[32:35], s61 offen nt
    s_add_u32 s61, s61, 8192
    buffer_load_dwordx4 a[164:167], v120, s[32:35], s61 offen nt
    s_add_u32 s61, s61, 8192
    buffer_load_dwordx4 a[168:171], v120, s[32:35], s61 offen nt
    s_add_u32 s61, s61, 8192
    buffer_load_dwordx4 a[172:175], v120, s[32:35], s61 offen nt
    s_add_u32 s61, s61, 8192
    buffer_load_dwordx4 a[176:179], v120, s[32:35], s61 offen nt
    s_add_u32 s61, s61, 8192
    buffer_load_dwordx4 a[180:183], v120, s[32:35], s61 offen nt
    s_add_u32 s61, s61, 8192
    s_mov_b32 s36, s20
    s_mov_b32 s37, s21
    s_mov_b32 s38, 4194304
    s_mov_b32 s39, 0x20000
    s_mov_b32 s40, s22
    s_mov_b32 s41, s23
    s_mov_b32 s42, 4194304
    s_mov_b32 s43, 0x20000
    v_lshlrev_b32 v5, 2, v4
    v_xor_b32 v5, v5, v3
    v_lshlrev_b32 v6, 13, v4
    v_xor_b32 v7, 0, v5
    v_lshl_add_u32 v88, v7, 4, v6
    v_xor_b32 v7, 1, v5
    v_lshl_add_u32 v89, v7, 4, v6
    v_xor_b32 v7, 2, v5
    v_lshl_add_u32 v90, v7, 4, v6
    v_xor_b32 v7, 3, v5
    v_lshl_add_u32 v91, v7, 4, v6
    s_lshl_b32 s62, s3, 20
    s_lshl_b32 s54, s52, 8
    s_add_u32 s62, s62, s54
    s_mov_b32 s60, s62
    s_lshl_b32 s63, s3, 15
    v_lshlrev_b32 v121, 18, v4
    v_lshl_add_u32 v121, v3, 4, v121
    v_lshrrev_b32 v5, 2, v3
    v_and_b32 v6, 3, v3
    v_lshl_add_u32 v7, v5, 3, v6
    v_lshlrev_b32 v92, 8, v7
    v_lshl_or_b32 v5, v6, 2, v5
    v_xor_b32 v5, v5, v4
    v_lshl_add_u32 v92, v5, 4, v92
    v_add_u32 v92, s63, v92
    v_xor_b32 v93, 64, v92
    v_xor_b32 v94, 128, v92
    v_xor_b32 v95, 192, v92
    v_and_b32 v5, 1, v3
    v_cmp_eq_u32 vcc, 1, v5
    v_mov_b32 v5, 0x0c0c0100
    v_mov_b32 v6, 0x01000c0c
    v_cndmask_b32 v5, v5, v6, vcc
    v_mov_b32 v6, 0x0c0c0302
    v_mov_b32 v7, 0x03020c0c
    v_cndmask_b32 v6, v6, v7, vcc
    v_bfe_u32 v7, v3, 1, 2
    v_mov_b32 v16, 0x0c0c0c0c
    v_cmp_eq_u32 vcc, 0, v7
    s_nop 1
    v_cndmask_b32 v8, v16, v5, vcc
    v_cndmask_b32 v9, v16, v6, vcc
    v_cmp_eq_u32 vcc, 1, v7
    s_nop 1
    v_cndmask_b32 v10, v16, v5, vcc
    v_cndmask_b32 v11, v16, v6, vcc
    v_cmp_eq_u32 vcc, 2, v7
    s_nop 1
    v_cndmask_b32 v12, v16, v5, vcc
    v_cndmask_b32 v13, v16, v6, vcc
    v_cmp_eq_u32 vcc, 3, v7
    s_nop 1
    v_cndmask_b32 v14, v16, v5, vcc
    v_cndmask_b32 v15, v16, v6, vcc
    s_waitcnt vmcnt(9)
    buffer_load_dwordx4 a[184:187], v120, s[32:35], s61 offen nt
    s_add_u32 s61, s61, 8192
    buffer_load_dwordx4 a[188:191], v120, s[32:35], s61 offen nt
    s_add_u32 s61, s61, 8192
    buffer_load_dwordx4 a[192:195], v120, s[32:35], s61 offen nt
    s_add_u32 s61, s61, 8192
    buffer_load_dwordx4 a[196:199], v120, s[32:35], s61 offen nt
    s_add_u32 s61, s61, 8192
    buffer_load_dwordx4 a[200:203], v120, s[32:35], s61 offen nt
    s_add_u32 s61, s61, 8192
    buffer_load_dwordx4 a[204:207], v120, s[32:35], s61 offen nt
    s_add_u32 s61, s61, 8192
    buffer_load_dwordx4 a[208:211], v120, s[32:35], s61 offen nt
    s_add_u32 s61, s61, 8192
    buffer_load_dwordx4 a[212:215], v120, s[32:35], s61 offen nt
    s_add_u32 s61, s61, 8192
    buffer_load_dwordx4 a[216:219], v120, s[32:35], s61 offen nt
    s_add_u32 s61, s61, 8192
    buffer_load_dwordx4 a[220:223], v120, s[32:35], s61 offen nt
    s_add_u32 s61, s61, 8192
    buffer_load_dwordx4 a[224:227], v120, s[32:35], s61 offen nt
    s_add_u32 s61, s61, 8192
    buffer_load_dwordx4 a[228:231], v120, s[32:35], s61 offen nt
    s_add_u32 s61, s61, 8192
    buffer_load_dwordx4 a[232:235], v120, s[32:35], s61 offen nt
    s_add_u32 s61, s61, 8192
    buffer_load_dwordx4 a[236:239], v120, s[32:35], s61 offen nt
    s_add_u32 s61, s61, 8192
    buffer_load_dwordx4 a[240:243], v120, s[32:35], s61 offen nt
    s_add_u32 s61, s61, 8192
    buffer_load_dwordx4 a[244:247], v120, s[32:35], s61 offen nt
    s_add_u32 s61, s61, 8192
    buffer_load_dwordx4 a[248:251], v120, s[32:35], s61 offen nt
    s_add_u32 s61, s61, 8192
    buffer_load_dwordx4 a[252:255], v120, s[32:35], s61 offen nt
    s_add_u32 s61, s61, 8192
    s_add_u32 m0, s63, 0
    s_nop 0
    buffer_load_dwordx4 v88, s[36:39], s60 offen nt lds
    s_add_u32 s60, s60, 32768
    v_perm_b32 v96, v48, v48, v8
    v_perm_b32 v97, v48, v48, v10
    v_perm_b32 v98, v48, v48, v12
    v_perm_b32 v99, v48, v48, v14
    s_nop 1
    v_mfma_f32_16x16x32_bf16 v[112:115], v[96:99], a[112:115], 0
    v_perm_b32 v100, v68, v68, v8
    v_perm_b32 v101, v68, v68, v10
    v_perm_b32 v102, v68, v68, v12
    v_perm_b32 v103, v68, v68, v14
    s_nop 1
    v_mfma_f32_16x16x32_bf16 v[116:119], v[100:103], a[112:115], 0
    v_perm_b32 v104, v48, v48, v9
    v_perm_b32 v105, v48, v48, v11
    v_perm_b32 v106, v48, v48, v13
    v_perm_b32 v107, v48, v48, v15
    s_nop 1
    v_mfma_f32_16x16x32_bf16 v[112:115], v[104:107], a[116:119], v[112:115]
    v_perm_b32 v108, v68, v68, v9
    v_perm_b32 v109, v68, v68, v11
    v_perm_b32 v110, v68, v68, v13
    v_perm_b32 v111, v68, v68, v15
    s_nop 1
    v_mfma_f32_16x16x32_bf16 v[116:119], v[108:111], a[116:119], v[116:119]
    v_perm_b32 v96, v49, v49, v8
    v_perm_b32 v97, v49, v49, v10
    v_perm_b32 v98, v49, v49, v12
    v_perm_b32 v99, v49, v49, v14
    s_nop 1
    v_mfma_f32_16x16x32_bf16 v[112:115], v[96:99], a[120:123], v[112:115]
    v_perm_b32 v100, v69, v69, v8
    v_perm_b32 v101, v69, v69, v10
    v_perm_b32 v102, v69, v69, v12
    v_perm_b32 v103, v69, v69, v14
    s_nop 1
    v_mfma_f32_16x16x32_bf16 v[116:119], v[100:103], a[120:123], v[116:119]
    v_perm_b32 v104, v49, v49, v9
    v_perm_b32 v105, v49, v49, v11
    v_perm_b32 v106, v49, v49, v13
    v_perm_b32 v107, v49, v49, v15
    s_nop 1
    v_mfma_f32_16x16x32_bf16 v[112:115], v[104:107], a[124:127], v[112:115]
    v_perm_b32 v108, v69, v69, v9
    v_perm_b32 v109, v69, v69, v11
    v_perm_b32 v110, v69, v69, v13
    v_perm_b32 v111, v69, v69, v15
    s_nop 1
    v_mfma_f32_16x16x32_bf16 v[116:119], v[108:111], a[124:127], v[116:119]
    v_perm_b32 v96, v50, v50, v8
    v_perm_b32 v97, v50, v50, v10
    v_perm_b32 v98, v50, v50, v12
    v_perm_b32 v99, v50, v50, v14
    s_nop 1
    v_mfma_f32_16x16x32_bf16 v[112:115], v[96:99], a[128:131], v[112:115]
    v_perm_b32 v100, v70, v70, v8
    v_perm_b32 v101, v70, v70, v10
    v_perm_b32 v102, v70, v70, v12
    v_perm_b32 v103, v70, v70, v14
    s_nop 1
    v_mfma_f32_16x16x32_bf16 v[116:119], v[100:103], a[128:131], v[116:119]
    v_perm_b32 v104, v50, v50, v9
    v_perm_b32 v105, v50, v50, v11
    v_perm_b32 v106, v50, v50, v13
    v_perm_b32 v107, v50, v50, v15
    s_nop 1
    v_mfma_f32_16x16x32_bf16 v[112:115], v[104:107], a[132:135], v[112:115]
    v_perm_b32 v108, v70, v70, v9
    v_perm_b32 v109, v70, v70, v11
    v_perm_b32 v110, v70, v70, v13
    v_perm_b32 v111, v70, v70, v15
    s_nop 1
    v_mfma_f32_16x16x32_bf16 v[116:119], v[108:111], a[132:135], v[116:119]
    v_perm_b32 v96, v51, v51, v8
    v_perm_b32 v97, v51, v51, v10
    v_perm_b32 v98, v51, v51, v12
    v_perm_b32 v99, v51, v51, v14
    s_nop 1
    v_mfma_f32_16x16x32_bf16 v[112:115], v[96:99], a[136:139], v[112:115]
    v_perm_b32 v100, v71, v71, v8
    v_perm_b32 v101, v71, v71, v10
    v_perm_b32 v102, v71, v71, v12
    v_perm_b32 v103, v71, v71, v14
    s_nop 1
    v_mfma_f32_16x16x32_bf16 v[116:119], v[100:103], a[136:139], v[116:119]
    v_perm_b32 v104, v51, v51, v9
    v_perm_b32 v105, v51, v51, v11
    v_perm_b32 v106, v51, v51, v13
    v_perm_b32 v107, v51, v51, v15
    s_nop 1
    v_mfma_f32_16x16x32_bf16 v[112:115], v[104:107], a[140:143], v[112:115]
    v_perm_b32 v108, v71, v71, v9
    v_perm_b32 v109, v71, v71, v11
    v_perm_b32 v110, v71, v71, v13
    v_perm_b32 v111, v71, v71, v15
    s_nop 1
    v_mfma_f32_16x16x32_bf16 v[116:119], v[108:111], a[140:143], v[116:119]
    v_perm_b32 v96, v52, v52, v8
    v_perm_b32 v97, v52, v52, v10
    v_perm_b32 v98, v52, v52, v12
    v_perm_b32 v99, v52, v52, v14
    s_nop 1
    v_mfma_f32_16x16x32_bf16 v[112:115], v[96:99], a[144:147], v[112:115]
    v_perm_b32 v100, v72, v72, v8
    v_perm_b32 v101, v72, v72, v10
    v_perm_b32 v102, v72, v72, v12
    v_perm_b32 v103, v72, v72, v14
    s_nop 1
    v_mfma_f32_16x16x32_bf16 v[116:119], v[100:103], a[144:147], v[116:119]
    s_waitcnt vmcnt(19)
    s_add_u32 m0, s63, 1024
    s_nop 0
    buffer_load_dwordx4 v88, s[36:39], s60 offen nt lds
    s_add_u32 s60, s60, 32768
    s_add_u32 m0, s63, 2048
    s_nop 0
    buffer_load_dwordx4 v89, s[36:39], s60 offen nt lds
    s_add_u32 s60, s60, 32768
    s_add_u32 m0, s63, 3072
    s_nop 0
    buffer_load_dwordx4 v89, s[36:39], s60 offen nt lds
    s_add_u32 s60, s60, 32768
    s_add_u32 m0, s63, 4096
    s_nop 0
    buffer_load_dwordx4 v90, s[36:39], s60 offen nt lds
    s_add_u32 s60, s60, 32768
    s_add_u32 m0, s63, 5120
    s_nop 0
    buffer_load_dwordx4 v90, s[36:39], s60 offen nt lds
    s_add_u32 s60, s60, 32768
    s_add_u32 m0, s63, 6144
    s_nop 0
    buffer_load_dwordx4 v91, s[36:39], s60 offen nt lds
    s_add_u32 s60, s60, 32768
    s_add_u32 m0, s63, 7168
    s_nop 0
    buffer_load_dwordx4 v91, s[36:39], s60 offen nt lds
    s_add_u32 s60, s60, 32768
    s_add_u32 m0, s63, 8192
    s_nop 0
    buffer_load_dwordx4 v88, s[36:39], s60 offen nt lds
    s_add_u32 s60, s60, 32768
    s_add_u32 m0, s63, 9216
    s_nop 0
    buffer_load_dwordx4 v88, s[36:39], s60 offen nt lds
    s_add_u32 s60, s60, 32768
    v_perm_b32 v104, v52, v52, v9
    v_perm_b32 v105, v52, v52, v11
    v_perm_b32 v106, v52, v52, v13
    v_perm_b32 v107, v52, v52, v15
    s_nop 1
    v_mfma_f32_16x16x32_bf16 v[112:115], v[104:107], a[148:151], v[112:115]
    v_perm_b32 v108, v72, v72, v9
    v_perm_b32 v109, v72, v72, v11
    v_perm_b32 v110, v72, v72, v13
    v_perm_b32 v111, v72, v72, v15
    s_nop 1
    v_mfma_f32_16x16x32_bf16 v[116:119], v[108:111], a[148:151], v[116:119]
    v_perm_b32 v96, v53, v53, v8
    v_perm_b32 v97, v53, v53, v10
    v_perm_b32 v98, v53, v53, v12
    v_perm_b32 v99, v53, v53, v14
    s_nop 1
    v_mfma_f32_16x16x32_bf16 v[112:115], v[96:99], a[152:155], v[112:115]
    v_perm_b32 v100, v73, v73, v8
    v_perm_b32 v101, v73, v73, v10
    v_perm_b32 v102, v73, v73, v12
    v_perm_b32 v103, v73, v73, v14
    s_nop 1
    v_mfma_f32_16x16x32_bf16 v[116:119], v[100:103], a[152:155], v[116:119]
    v_perm_b32 v104, v53, v53, v9
    v_perm_b32 v105, v53, v53, v11
    v_perm_b32 v106, v53, v53, v13
    v_perm_b32 v107, v53, v53, v15
    s_nop 1
    v_mfma_f32_16x16x32_bf16 v[112:115], v[104:107], a[156:159], v[112:115]
    v_perm_b32 v108, v73, v73, v9
    v_perm_b32 v109, v73, v73, v11
    v_perm_b32 v110, v73, v73, v13
    v_perm_b32 v111, v73, v73, v15
    s_nop 1
    v_mfma_f32_16x16x32_bf16 v[116:119], v[108:111], a[156:159], v[116:119]
    v_perm_b32 v96, v54, v54, v8
    v_perm_b32 v97, v54, v54, v10
    v_perm_b32 v98, v54, v54, v12
    v_perm_b32 v99, v54, v54, v14
    s_nop 1
    v_mfma_f32_16x16x32_bf16 v[112:115], v[96:99], a[160:163], v[112:115]
    v_perm_b32 v100, v74, v74, v8
    v_perm_b32 v101, v74, v74, v10
    v_perm_b32 v102, v74, v74, v12
    v_perm_b32 v103, v74, v74, v14
    s_nop 1
    v_mfma_f32_16x16x32_bf16 v[116:119], v[100:103], a[160:163], v[116:119]
    v_perm_b32 v104, v54, v54, v9
    v_perm_b32 v105, v54, v54, v11
    v_perm_b32 v106, v54, v54, v13
    v_perm_b32 v107, v54, v54, v15
    s_nop 1
    v_mfma_f32_16x16x32_bf16 v[112:115], v[104:107], a[164:167], v[112:115]
    v_perm_b32 v108, v74, v74, v9
    v_perm_b32 v109, v74, v74, v11
    v_perm_b32 v110, v74, v74, v13
    v_perm_b32 v111, v74, v74, v15
    s_nop 1
    v_mfma_f32_16x16x32_bf16 v[116:119], v[108:111], a[164:167], v[116:119]
    v_perm_b32 v96, v55, v55, v8
    v_perm_b32 v97, v55, v55, v10
    v_perm_b32 v98, v55, v55, v12
    v_perm_b32 v99, v55, v55, v14
    s_nop 1
    v_mfma_f32_16x16x32_bf16 v[112:115], v[96:99], a[168:171], v[112:115]
    v_perm_b32 v100, v75, v75, v8
    v_perm_b32 v101, v75, v75, v10
    v_perm_b32 v102, v75, v75, v12
    v_perm_b32 v103, v75, v75, v14
    s_nop 1
    v_mfma_f32_16x16x32_bf16 v[116:119], v[100:103], a[168:171], v[116:119]
    v_perm_b32 v104, v55, v55, v9
    v_perm_b32 v105, v55, v55, v11
    v_perm_b32 v106, v55, v55, v13
    v_perm_b32 v107, v55, v55, v15
    s_nop 1
    v_mfma_f32_16x16x32_bf16 v[112:115], v[104:107], a[172:175], v[112:115]
    v_perm_b32 v108, v75, v75, v9
    v_perm_b32 v109, v75, v75, v11
    v_perm_b32 v110, v75, v75, v13
    v_perm_b32 v111, v75, v75, v15
    s_nop 1
    v_mfma_f32_16x16x32_bf16 v[116:119], v[108:111], a[172:175], v[116:119]
    v_perm_b32 v96, v56, v56, v8
    v_perm_b32 v97, v56, v56, v10
    v_perm_b32 v98, v56, v56, v12
    v_perm_b32 v99, v56, v56, v14
    s_nop 1
    v_mfma_f32_16x16x32_bf16 v[112:115], v[96:99], a[176:179], v[112:115]
    v_perm_b32 v100, v76, v76, v8
    v_perm_b32 v101, v76, v76, v10
    v_perm_b32 v102, v76, v76, v12
    v_perm_b32 v103, v76, v76, v14
    s_nop 1
    v_mfma_f32_16x16x32_bf16 v[116:119], v[100:103], a[176:179], v[116:119]
    v_perm_b32 v104, v56, v56, v9
    v_perm_b32 v105, v56, v56, v11
    v_perm_b32 v106, v56, v56, v13
    v_perm_b32 v107, v56, v56, v15
    s_nop 1
    v_mfma_f32_16x16x32_bf16 v[112:115], v[104:107], a[180:183], v[112:115]
    v_perm_b32 v108, v76, v76, v9
    v_perm_b32 v109, v76, v76, v11
    v_perm_b32 v110, v76, v76, v13
    v_perm_b32 v111, v76, v76, v15
    s_nop 1
    v_mfma_f32_16x16x32_bf16 v[116:119], v[108:111], a[180:183], v[116:119]
    s_waitcnt vmcnt(19)
    s_add_u32 m0, s63, 10240
    s_nop 0
    buffer_load_dwordx4 v89, s[36:39], s60 offen nt lds
    s_add_u32 s60, s60, 32768
    s_add_u32 m0, s63, 11264
    s_nop 0
    buffer_load_dwordx4 v89, s[36:39], s60 offen nt lds
    s_add_u32 s60, s60, 32768
    s_add_u32 m0, s63, 12288
    s_nop 0
    buffer_load_dwordx4 v90, s[36:39], s60 offen nt lds
    s_add_u32 s60, s60, 32768
    s_add_u32 m0, s63, 13312
    s_nop 0
    buffer_load_dwordx4 v90, s[36:39], s60 offen nt lds
    s_add_u32 s60, s60, 32768
    s_add_u32 m0, s63, 14336
    s_nop 0
    buffer_load_dwordx4 v91, s[36:39], s60 offen nt lds
    s_add_u32 s60, s60, 32768
    s_add_u32 m0, s63, 15360
    s_nop 0
    buffer_load_dwordx4 v91, s[36:39], s60 offen nt lds
    s_add_u32 s60, s60, 32768
    s_add_u32 m0, s63, 16384
    s_nop 0
    buffer_load_dwordx4 v88, s[36:39], s60 offen nt lds
    s_add_u32 s60, s60, 32768
    s_add_u32 m0, s63, 17408
    s_nop 0
    buffer_load_dwordx4 v88, s[36:39], s60 offen nt lds
    s_add_u32 s60, s60, 32768
    s_add_u32 m0, s63, 18432
    s_nop 0
    buffer_load_dwordx4 v89, s[36:39], s60 offen nt lds
    s_add_u32 s60, s60, 32768
    v_perm_b32 v96, v57, v57, v8
    v_perm_b32 v97, v57, v57, v10
    v_perm_b32 v98, v57, v57, v12
    v_perm_b32 v99, v57, v57, v14
    s_nop 1
    v_mfma_f32_16x16x32_bf16 v[112:115], v[96:99], a[184:187], v[112:115]
    v_perm_b32 v100, v77, v77, v8
    v_perm_b32 v101, v77, v77, v10
    v_perm_b32 v102, v77, v77, v12
    v_perm_b32 v103, v77, v77, v14
    s_nop 1
    v_mfma_f32_16x16x32_bf16 v[116:119], v[100:103], a[184:187], v[116:119]
    v_perm_b32 v104, v57, v57, v9
    v_perm_b32 v105, v57, v57, v11
    v_perm_b32 v106, v57, v57, v13
    v_perm_b32 v107, v57, v57, v15
    s_nop 1
    v_mfma_f32_16x16x32_bf16 v[112:115], v[104:107], a[188:191], v[112:115]
    v_perm_b32 v108, v77, v77, v9
    v_perm_b32 v109, v77, v77, v11
    v_perm_b32 v110, v77, v77, v13
    v_perm_b32 v111, v77, v77, v15
    s_nop 1
    v_mfma_f32_16x16x32_bf16 v[116:119], v[108:111], a[188:191], v[116:119]
    v_perm_b32 v96, v58, v58, v8
    v_perm_b32 v97, v58, v58, v10
    v_perm_b32 v98, v58, v58, v12
    v_perm_b32 v99, v58, v58, v14
    s_nop 1
    v_mfma_f32_16x16x32_bf16 v[112:115], v[96:99], a[192:195], v[112:115]
    v_perm_b32 v100, v78, v78, v8
    v_perm_b32 v101, v78, v78, v10
    v_perm_b32 v102, v78, v78, v12
    v_perm_b32 v103, v78, v78, v14
    s_nop 1
    v_mfma_f32_16x16x32_bf16 v[116:119], v[100:103], a[192:195], v[116:119]
    v_perm_b32 v104, v58, v58, v9
    v_perm_b32 v105, v58, v58, v11
    v_perm_b32 v106, v58, v58, v13
    v_perm_b32 v107, v58, v58, v15
    s_nop 1
    v_mfma_f32_16x16x32_bf16 v[112:115], v[104:107], a[196:199], v[112:115]
    v_perm_b32 v108, v78, v78, v9
    v_perm_b32 v109, v78, v78, v11
    v_perm_b32 v110, v78, v78, v13
    v_perm_b32 v111, v78, v78, v15
    s_nop 1
    v_mfma_f32_16x16x32_bf16 v[116:119], v[108:111], a[196:199], v[116:119]
    v_perm_b32 v96, v59, v59, v8
    v_perm_b32 v97, v59, v59, v10
    v_perm_b32 v98, v59, v59, v12
    v_perm_b32 v99, v59, v59, v14
    s_nop 1
    v_mfma_f32_16x16x32_bf16 v[112:115], v[96:99], a[200:203], v[112:115]
    v_perm_b32 v100, v79, v79, v8
    v_perm_b32 v101, v79, v79, v10
    v_perm_b32 v102, v79, v79, v12
    v_perm_b32 v103, v79, v79, v14
    s_nop 1
    v_mfma_f32_16x16x32_bf16 v[116:119], v[100:103], a[200:203], v[116:119]
    v_perm_b32 v104, v59, v59, v9
    v_perm_b32 v105, v59, v59, v11
    v_perm_b32 v106, v59, v59, v13
    v_perm_b32 v107, v59, v59, v15
    s_nop 1
    v_mfma_f32_16x16x32_bf16 v[112:115], v[104:107], a[204:207], v[112:115]
    v_perm_b32 v108, v79, v79, v9
    v_perm_b32 v109, v79, v79, v11
    v_perm_b32 v110, v79, v79, v13
    v_perm_b32 v111, v79, v79, v15
    s_nop 1
    v_mfma_f32_16x16x32_bf16 v[116:119], v[108:111], a[204:207], v[116:119]
    v_perm_b32 v96, v60, v60, v8
    v_perm_b32 v97, v60, v60, v10
    v_perm_b32 v98, v60, v60, v12
    v_perm_b32 v99, v60, v60, v14
    s_nop 1
    v_mfma_f32_16x16x32_bf16 v[112:115], v[96:99], a[208:211], v[112:115]
    v_perm_b32 v100, v80, v80, v8
    v_perm_b32 v101, v80, v80, v10
    v_perm_b32 v102, v80, v80, v12
    v_perm_b32 v103, v80, v80, v14
    s_nop 1
    v_mfma_f32_16x16x32_bf16 v[116:119], v[100:103], a[208:211], v[116:119]
    v_perm_b32 v104, v60, v60, v9
    v_perm_b32 v105, v60, v60, v11
    v_perm_b32 v106, v60, v60, v13
    v_perm_b32 v107, v60, v60, v15
    s_nop 1
    v_mfma_f32_16x16x32_bf16 v[112:115], v[104:107], a[212:215], v[112:115]
    v_perm_b32 v108, v80, v80, v9
    v_perm_b32 v109, v80, v80, v11
    v_perm_b32 v110, v80, v80, v13
    v_perm_b32 v111, v80, v80, v15
    s_nop 1
    v_mfma_f32_16x16x32_bf16 v[116:119], v[108:111], a[212:215], v[116:119]
    v_perm_b32 v96, v61, v61, v8
    v_perm_b32 v97, v61, v61, v10
    v_perm_b32 v98, v61, v61, v12
    v_perm_b32 v99, v61, v61, v14
    s_nop 1
    v_mfma_f32_16x16x32_bf16 v[112:115], v[96:99], a[216:219], v[112:115]
    v_perm_b32 v100, v81, v81, v8
    v_perm_b32 v101, v81, v81, v10
    v_perm_b32 v102, v81, v81, v12
    v_perm_b32 v103, v81, v81, v14
    s_nop 1
    v_mfma_f32_16x16x32_bf16 v[116:119], v[100:103], a[216:219], v[116:119]
    s_waitcnt vmcnt(19)
    s_add_u32 m0, s63, 19456
    s_nop 0
    buffer_load_dwordx4 v89, s[36:39], s60 offen nt lds
    s_add_u32 s60, s60, 32768
    s_add_u32 m0, s63, 20480
    s_nop 0
    buffer_load_dwordx4 v90, s[36:39], s60 offen nt lds
    s_add_u32 s60, s60, 32768
    s_add_u32 m0, s63, 21504
    s_nop 0
    buffer_load_dwordx4 v90, s[36:39], s60 offen nt lds
    s_add_u32 s60, s60, 32768
    s_add_u32 m0, s63, 22528
    s_nop 0
    buffer_load_dwordx4 v91, s[36:39], s60 offen nt lds
    s_add_u32 s60, s60, 32768
    s_add_u32 m0, s63, 23552
    s_nop 0
    buffer_load_dwordx4 v91, s[36:39], s60 offen nt lds
    s_add_u32 s60, s60, 32768
    s_add_u32 m0, s63, 24576
    s_nop 0
    buffer_load_dwordx4 v88, s[36:39], s60 offen nt lds
    s_add_u32 s60, s60, 32768
    s_add_u32 m0, s63, 25600
    s_nop 0
    buffer_load_dwordx4 v88, s[36:39], s60 offen nt lds
    s_add_u32 s60, s60, 32768
    s_add_u32 m0, s63, 26624
    s_nop 0
    buffer_load_dwordx4 v89, s[36:39], s60 offen nt lds
    s_add_u32 s60, s60, 32768
    s_add_u32 m0, s63, 27648
    s_nop 0
    buffer_load_dwordx4 v89, s[36:39], s60 offen nt lds
    s_add_u32 s60, s60, 32768
    v_perm_b32 v104, v61, v61, v9
    v_perm_b32 v105, v61, v61, v11
    v_perm_b32 v106, v61, v61, v13
    v_perm_b32 v107, v61, v61, v15
    s_nop 1
    v_mfma_f32_16x16x32_bf16 v[112:115], v[104:107], a[220:223], v[112:115]
    v_perm_b32 v108, v81, v81, v9
    v_perm_b32 v109, v81, v81, v11
    v_perm_b32 v110, v81, v81, v13
    v_perm_b32 v111, v81, v81, v15
    s_nop 1
    v_mfma_f32_16x16x32_bf16 v[116:119], v[108:111], a[220:223], v[116:119]
    v_perm_b32 v96, v62, v62, v8
    v_perm_b32 v97, v62, v62, v10
    v_perm_b32 v98, v62, v62, v12
    v_perm_b32 v99, v62, v62, v14
    s_nop 1
    v_mfma_f32_16x16x32_bf16 v[112:115], v[96:99], a[224:227], v[112:115]
    v_perm_b32 v100, v82, v82, v8
    v_perm_b32 v101, v82, v82, v10
    v_perm_b32 v102, v82, v82, v12
    v_perm_b32 v103, v82, v82, v14
    s_nop 1
    v_mfma_f32_16x16x32_bf16 v[116:119], v[100:103], a[224:227], v[116:119]
    v_perm_b32 v104, v62, v62, v9
    v_perm_b32 v105, v62, v62, v11
    v_perm_b32 v106, v62, v62, v13
    v_perm_b32 v107, v62, v62, v15
    s_nop 1
    v_mfma_f32_16x16x32_bf16 v[112:115], v[104:107], a[228:231], v[112:115]
    v_perm_b32 v108, v82, v82, v9
    v_perm_b32 v109, v82, v82, v11
    v_perm_b32 v110, v82, v82, v13
    v_perm_b32 v111, v82, v82, v15
    s_nop 1
    v_mfma_f32_16x16x32_bf16 v[116:119], v[108:111], a[228:231], v[116:119]
    v_perm_b32 v96, v63, v63, v8
    v_perm_b32 v97, v63, v63, v10
    v_perm_b32 v98, v63, v63, v12
    v_perm_b32 v99, v63, v63, v14
    s_nop 1
    v_mfma_f32_16x16x32_bf16 v[112:115], v[96:99], a[232:235], v[112:115]
    v_perm_b32 v100, v83, v83, v8
    v_perm_b32 v101, v83, v83, v10
    v_perm_b32 v102, v83, v83, v12
    v_perm_b32 v103, v83, v83, v14
    s_nop 1
    v_mfma_f32_16x16x32_bf16 v[116:119], v[100:103], a[232:235], v[116:119]
    v_perm_b32 v104, v63, v63, v9
    v_perm_b32 v105, v63, v63, v11
    v_perm_b32 v106, v63, v63, v13
    v_perm_b32 v107, v63, v63, v15
    s_nop 1
    v_mfma_f32_16x16x32_bf16 v[112:115], v[104:107], a[236:239], v[112:115]
    v_perm_b32 v108, v83, v83, v9
    v_perm_b32 v109, v83, v83, v11
    v_perm_b32 v110, v83, v83, v13
    v_perm_b32 v111, v83, v83, v15
    s_nop 1
    v_mfma_f32_16x16x32_bf16 v[116:119], v[108:111], a[236:239], v[116:119]
    v_perm_b32 v96, v64, v64, v8
    v_perm_b32 v97, v64, v64, v10
    v_perm_b32 v98, v64, v64, v12
    v_perm_b32 v99, v64, v64, v14
    s_nop 1
    v_mfma_f32_16x16x32_bf16 v[112:115], v[96:99], a[240:243], v[112:115]
    v_perm_b32 v100, v84, v84, v8
    v_perm_b32 v101, v84, v84, v10
    v_perm_b32 v102, v84, v84, v12
    v_perm_b32 v103, v84, v84, v14
    s_nop 1
    v_mfma_f32_16x16x32_bf16 v[116:119], v[100:103], a[240:243], v[116:119]
    v_perm_b32 v104, v64, v64, v9
    v_perm_b32 v105, v64, v64, v11
    v_perm_b32 v106, v64, v64, v13
    v_perm_b32 v107, v64, v64, v15
    s_nop 1
    v_mfma_f32_16x16x32_bf16 v[112:115], v[104:107], a[244:247], v[112:115]
    v_perm_b32 v108, v84, v84, v9
    v_perm_b32 v109, v84, v84, v11
    v_perm_b32 v110, v84, v84, v13
    v_perm_b32 v111, v84, v84, v15
    s_nop 1
    v_mfma_f32_16x16x32_bf16 v[116:119], v[108:111], a[244:247], v[116:119]
    v_perm_b32 v96, v65, v65, v8
    v_perm_b32 v97, v65, v65, v10
    v_perm_b32 v98, v65, v65, v12
    v_perm_b32 v99, v65, v65, v14
    s_nop 1
    v_mfma_f32_16x16x32_bf16 v[112:115], v[96:99], a[248:251], v[112:115]
    v_perm_b32 v100, v85, v85, v8
    v_perm_b32 v101, v85, v85, v10
    v_perm_b32 v102, v85, v85, v12
    v_perm_b32 v103, v85, v85, v14
    s_nop 1
    v_mfma_f32_16x16x32_bf16 v[116:119], v[100:103], a[248:251], v[116:119]
    v_perm_b32 v104, v65, v65, v9
    v_perm_b32 v105, v65, v65, v11
    v_perm_b32 v106, v65, v65, v13
    v_perm_b32 v107, v65, v65, v15
    s_nop 1
    v_mfma_f32_16x16x32_bf16 v[112:115], v[104:107], a[252:255], v[112:115]
    v_perm_b32 v108, v85, v85, v9
    v_perm_b32 v109, v85, v85, v11
    v_perm_b32 v110, v85, v85, v13
    v_perm_b32 v111, v85, v85, v15
    s_nop 1
    v_mfma_f32_16x16x32_bf16 v[116:119], v[108:111], a[252:255], v[116:119]
    v_lshrrev_b32 v5, 1, v4
    v_lshlrev_b32 v5, 9, v5
    v_lshl_add_u32 v5, v3, 5, v5
    v_and_b32 v6, 1, v4
    v_lshl_add_u32 v5, v6, 4, v5
    s_lshl_b32 s54, s3, 11
    s_add_u32 s54, s54, 131072
    v_add_u32 v5, s54, v5
    ds_write_b128 v5, v[112:115]
    ds_write_b128 v5, v[116:119] offset:1024
    s_waitcnt lgkmcnt(0)
    s_barrier
    s_add_u32 m0, s63, 28672
    s_nop 0
    buffer_load_dwordx4 v90, s[36:39], s60 offen nt lds
    s_add_u32 s60, s60, 32768
    s_add_u32 m0, s63, 29696
    s_nop 0
    buffer_load_dwordx4 v90, s[36:39], s60 offen nt lds
    s_add_u32 s60, s60, 32768
    s_add_u32 m0, s63, 30720
    s_nop 0
    buffer_load_dwordx4 v91, s[36:39], s60 offen nt lds
    s_add_u32 s60, s60, 32768
    s_add_u32 m0, s63, 31744
    s_nop 0
    buffer_load_dwordx4 v91, s[36:39], s60 offen nt lds
    s_add_u32 s60, s60, 32768
    v_lshrrev_b32 v5, 2, v3
    v_lshlrev_b32 v5, 9, v5
    v_lshl_add_u32 v5, v4, 5, v5
    v_add_u32 v5, 131072, v5
    ds_read_b128 v[48:51], v5 offset:0
    ds_read_b128 v[52:55], v5 offset:16
    ds_read_b128 v[56:59], v5 offset:2048
    ds_read_b128 v[60:63], v5 offset:2064
    ds_read_b128 v[64:67], v5 offset:4096
    ds_read_b128 v[68:71], v5 offset:4112
    ds_read_b128 v[72:75], v5 offset:6144
    ds_read_b128 v[76:79], v5 offset:6160
    s_waitcnt lgkmcnt(0)
    v_add_f32 v48, v48, v56
    v_add_f32 v64, v64, v72
    v_add_f32 v49, v49, v57
    v_add_f32 v65, v65, v73
    v_add_f32 v50, v50, v58
    v_add_f32 v66, v66, v74
    v_add_f32 v51, v51, v59
    v_add_f32 v67, v67, v75
    v_add_f32 v52, v52, v60
    v_add_f32 v68, v68, v76
    v_add_f32 v53, v53, v61
    v_add_f32 v69, v69, v77
    v_add_f32 v54, v54, v62
    v_add_f32 v70, v70, v78
    v_add_f32 v55, v55, v63
    v_add_f32 v71, v71, v79
    v_add_f32 v48, v48, v64
    v_add_f32 v49, v49, v65
    v_add_f32 v50, v50, v66
    v_add_f32 v51, v51, v67
    v_add_f32 v52, v52, v68
    v_add_f32 v53, v53, v69
    v_add_f32 v54, v54, v70
    v_add_f32 v55, v55, v71
    v_cvt_pk_bf16_f32 v96, v48, v49
    v_cvt_pk_bf16_f32 v97, v50, v51
    v_cvt_pk_bf16_f32 v98, v52, v53
    v_cvt_pk_bf16_f32 v99, v54, v55
    ds_read_b128 v[48:51], v5 offset:128
    ds_read_b128 v[52:55], v5 offset:144
    ds_read_b128 v[56:59], v5 offset:2176
    ds_read_b128 v[60:63], v5 offset:2192
    ds_read_b128 v[64:67], v5 offset:4224
    ds_read_b128 v[68:71], v5 offset:4240
    ds_read_b128 v[72:75], v5 offset:6272
    ds_read_b128 v[76:79], v5 offset:6288
    s_waitcnt lgkmcnt(0)
    v_add_f32 v48, v48, v56
    v_add_f32 v64, v64, v72
    v_add_f32 v49, v49, v57
    v_add_f32 v65, v65, v73
    v_add_f32 v50, v50, v58
    v_add_f32 v66, v66, v74
    v_add_f32 v51, v51, v59
    v_add_f32 v67, v67, v75
    v_add_f32 v52, v52, v60
    v_add_f32 v68, v68, v76
    v_add_f32 v53, v53, v61
    v_add_f32 v69, v69, v77
    v_add_f32 v54, v54, v62
    v_add_f32 v70, v70, v78
    v_add_f32 v55, v55, v63
    v_add_f32 v71, v71, v79
    v_add_f32 v48, v48, v64
    v_add_f32 v49, v49, v65
    v_add_f32 v50, v50, v66
    v_add_f32 v51, v51, v67
    v_add_f32 v52, v52, v68
    v_add_f32 v53, v53, v69
    v_add_f32 v54, v54, v70
    v_add_f32 v55, v55, v71
    v_cvt_pk_bf16_f32 v100, v48, v49
    v_cvt_pk_bf16_f32 v101, v50, v51
    v_cvt_pk_bf16_f32 v102, v52, v53
    v_cvt_pk_bf16_f32 v103, v54, v55
    ds_read_b128 v[48:51], v5 offset:256
    ds_read_b128 v[52:55], v5 offset:272
    ds_read_b128 v[56:59], v5 offset:2304
    ds_read_b128 v[60:63], v5 offset:2320
    ds_read_b128 v[64:67], v5 offset:4352
    ds_read_b128 v[68:71], v5 offset:4368
    ds_read_b128 v[72:75], v5 offset:6400
    ds_read_b128 v[76:79], v5 offset:6416
    s_waitcnt lgkmcnt(0)
    v_add_f32 v48, v48, v56
    v_add_f32 v64, v64, v72
    v_add_f32 v49, v49, v57
    v_add_f32 v65, v65, v73
    v_add_f32 v50, v50, v58
    v_add_f32 v66, v66, v74
    v_add_f32 v51, v51, v59
    v_add_f32 v67, v67, v75
    v_add_f32 v52, v52, v60
    v_add_f32 v68, v68, v76
    v_add_f32 v53, v53, v61
    v_add_f32 v69, v69, v77
    v_add_f32 v54, v54, v62
    v_add_f32 v70, v70, v78
    v_add_f32 v55, v55, v63
    v_add_f32 v71, v71, v79
    v_add_f32 v48, v48, v64
    v_add_f32 v49, v49, v65
    v_add_f32 v50, v50, v66
    v_add_f32 v51, v51, v67
    v_add_f32 v52, v52, v68
    v_add_f32 v53, v53, v69
    v_add_f32 v54, v54, v70
    v_add_f32 v55, v55, v71
    v_cvt_pk_bf16_f32 v104, v48, v49
    v_cvt_pk_bf16_f32 v105, v50, v51
    v_cvt_pk_bf16_f32 v106, v52, v53
    v_cvt_pk_bf16_f32 v107, v54, v55
    ds_read_b128 v[48:51], v5 offset:384
    ds_read_b128 v[52:55], v5 offset:400
    ds_read_b128 v[56:59], v5 offset:2432
    ds_read_b128 v[60:63], v5 offset:2448
    ds_read_b128 v[64:67], v5 offset:4480
    ds_read_b128 v[68:71], v5 offset:4496
    ds_read_b128 v[72:75], v5 offset:6528
    ds_read_b128 v[76:79], v5 offset:6544
    s_waitcnt lgkmcnt(0)
    v_add_f32 v48, v48, v56
    v_add_f32 v64, v64, v72
    v_add_f32 v49, v49, v57
    v_add_f32 v65, v65, v73
    v_add_f32 v50, v50, v58
    v_add_f32 v66, v66, v74
    v_add_f32 v51, v51, v59
    v_add_f32 v67, v67, v75
    v_add_f32 v52, v52, v60
    v_add_f32 v68, v68, v76
    v_add_f32 v53, v53, v61
    v_add_f32 v69, v69, v77
    v_add_f32 v54, v54, v62
    v_add_f32 v70, v70, v78
    v_add_f32 v55, v55, v63
    v_add_f32 v71, v71, v79
    v_add_f32 v48, v48, v64
    v_add_f32 v49, v49, v65
    v_add_f32 v50, v50, v66
    v_add_f32 v51, v51, v67
    v_add_f32 v52, v52, v68
    v_add_f32 v53, v53, v69
    v_add_f32 v54, v54, v70
    v_add_f32 v55, v55, v71
    v_cvt_pk_bf16_f32 v108, v48, v49
    v_cvt_pk_bf16_f32 v109, v50, v51
    v_cvt_pk_bf16_f32 v110, v52, v53
    v_cvt_pk_bf16_f32 v111, v54, v55
    s_waitcnt vmcnt(24)
    ds_read_b128 v[128:131], v92 offset:0
    ds_read_b128 v[132:135], v93 offset:0
    ds_read_b128 v[136:139], v94 offset:0
    ds_read_b128 v[140:143], v95 offset:0
    ds_read_b128 v[144:147], v92 offset:1024
    ds_read_b128 v[148:151], v93 offset:1024
    ds_read_b128 v[152:155], v94 offset:1024
    ds_read_b128 v[156:159], v95 offset:1024
    s_waitcnt lgkmcnt(7)
    v_mfma_f32_16x16x32_bf16 v[48:51], v[128:131], v[96:99], 0
    s_waitcnt lgkmcnt(6)
    v_mfma_f32_16x16x32_bf16 v[48:51], v[132:135], v[100:103], v[48:51]
    s_waitcnt lgkmcnt(5)
    v_mfma_f32_16x16x32_bf16 v[48:51], v[136:139], v[104:107], v[48:51]
    s_waitcnt lgkmcnt(4)
    v_mfma_f32_16x16x32_bf16 v[48:51], v[140:143], v[108:111], v[48:51]
    s_waitcnt lgkmcnt(3)
    v_mfma_f32_16x16x32_bf16 v[52:55], v[144:147], v[96:99], 0
    s_waitcnt lgkmcnt(2)
    v_mfma_f32_16x16x32_bf16 v[52:55], v[148:151], v[100:103], v[52:55]
    s_waitcnt lgkmcnt(1)
    v_mfma_f32_16x16x32_bf16 v[52:55], v[152:155], v[104:107], v[52:55]
    s_waitcnt lgkmcnt(0)
    v_mfma_f32_16x16x32_bf16 v[52:55], v[156:159], v[108:111], v[52:55]
    s_waitcnt vmcnt(16)
    ds_read_b128 v[160:163], v92 offset:8192
    ds_read_b128 v[164:167], v93 offset:8192
    ds_read_b128 v[168:171], v94 offset:8192
    ds_read_b128 v[172:175], v95 offset:8192
    ds_read_b128 v[176:179], v92 offset:9216
    ds_read_b128 v[180:183], v93 offset:9216
    ds_read_b128 v[184:187], v94 offset:9216
    ds_read_b128 v[188:191], v95 offset:9216
    s_waitcnt lgkmcnt(7)
    v_mfma_f32_16x16x32_bf16 v[56:59], v[160:163], v[96:99], 0
    s_waitcnt lgkmcnt(6)
    v_mfma_f32_16x16x32_bf16 v[56:59], v[164:167], v[100:103], v[56:59]
    s_waitcnt lgkmcnt(5)
    v_mfma_f32_16x16x32_bf16 v[56:59], v[168:171], v[104:107], v[56:59]
    s_waitcnt lgkmcnt(4)
    v_mfma_f32_16x16x32_bf16 v[56:59], v[172:175], v[108:111], v[56:59]
    s_waitcnt lgkmcnt(3)
    v_mfma_f32_16x16x32_bf16 v[60:63], v[176:179], v[96:99], 0
    s_waitcnt lgkmcnt(2)
    v_mfma_f32_16x16x32_bf16 v[60:63], v[180:183], v[100:103], v[60:63]
    s_waitcnt lgkmcnt(1)
    v_mfma_f32_16x16x32_bf16 v[60:63], v[184:187], v[104:107], v[60:63]
    s_waitcnt lgkmcnt(0)
    v_mfma_f32_16x16x32_bf16 v[60:63], v[188:191], v[108:111], v[60:63]
    s_waitcnt vmcnt(8)
    ds_read_b128 v[128:131], v92 offset:16384
    ds_read_b128 v[132:135], v93 offset:16384
    ds_read_b128 v[136:139], v94 offset:16384
    ds_read_b128 v[140:143], v95 offset:16384
    ds_read_b128 v[144:147], v92 offset:17408
    ds_read_b128 v[148:151], v93 offset:17408
    ds_read_b128 v[152:155], v94 offset:17408
    ds_read_b128 v[156:159], v95 offset:17408
    s_waitcnt lgkmcnt(7)
    v_mfma_f32_16x16x32_bf16 v[64:67], v[128:131], v[96:99], 0
    s_waitcnt lgkmcnt(6)
    v_mfma_f32_16x16x32_bf16 v[64:67], v[132:135], v[100:103], v[64:67]
    s_waitcnt lgkmcnt(5)
    v_mfma_f32_16x16x32_bf16 v[64:67], v[136:139], v[104:107], v[64:67]
    s_waitcnt lgkmcnt(4)
    v_mfma_f32_16x16x32_bf16 v[64:67], v[140:143], v[108:111], v[64:67]
    s_waitcnt lgkmcnt(3)
    v_mfma_f32_16x16x32_bf16 v[68:71], v[144:147], v[96:99], 0
    s_waitcnt lgkmcnt(2)
    v_mfma_f32_16x16x32_bf16 v[68:71], v[148:151], v[100:103], v[68:71]
    s_waitcnt lgkmcnt(1)
    v_mfma_f32_16x16x32_bf16 v[68:71], v[152:155], v[104:107], v[68:71]
    s_waitcnt lgkmcnt(0)
    v_mfma_f32_16x16x32_bf16 v[68:71], v[156:159], v[108:111], v[68:71]
    s_waitcnt vmcnt(0)
    ds_read_b128 v[160:163], v92 offset:24576
    ds_read_b128 v[164:167], v93 offset:24576
    ds_read_b128 v[168:171], v94 offset:24576
    ds_read_b128 v[172:175], v95 offset:24576
    ds_read_b128 v[176:179], v92 offset:25600
    ds_read_b128 v[180:183], v93 offset:25600
    ds_read_b128 v[184:187], v94 offset:25600
    ds_read_b128 v[188:191], v95 offset:25600
    s_waitcnt lgkmcnt(7)
    v_mfma_f32_16x16x32_bf16 v[72:75], v[160:163], v[96:99], 0
    s_waitcnt lgkmcnt(6)
    v_mfma_f32_16x16x32_bf16 v[72:75], v[164:167], v[100:103], v[72:75]
    s_waitcnt lgkmcnt(5)
    v_mfma_f32_16x16x32_bf16 v[72:75], v[168:171], v[104:107], v[72:75]
    s_waitcnt lgkmcnt(4)
    v_mfma_f32_16x16x32_bf16 v[72:75], v[172:175], v[108:111], v[72:75]
    s_waitcnt lgkmcnt(3)
    v_mfma_f32_16x16x32_bf16 v[76:79], v[176:179], v[96:99], 0
    s_waitcnt lgkmcnt(2)
    v_mfma_f32_16x16x32_bf16 v[76:79], v[180:183], v[100:103], v[76:79]
    s_waitcnt lgkmcnt(1)
    v_mfma_f32_16x16x32_bf16 v[76:79], v[184:187], v[104:107], v[76:79]
    s_waitcnt lgkmcnt(0)
    v_mfma_f32_16x16x32_bf16 v[76:79], v[188:191], v[108:111], v[76:79]
    s_mov_b32 s96, 1040356334
    v_and_b32 v6, 3, v3
    v_cmp_eq_u32 vcc, 1, v6
    s_nop 1
    v_cndmask_b32 v48, v48, v56, vcc
    v_cndmask_b32 v49, v49, v57, vcc
    v_cndmask_b32 v50, v50, v58, vcc
    v_cndmask_b32 v51, v51, v59, vcc
    v_cndmask_b32 v52, v52, v60, vcc
    v_cndmask_b32 v53, v53, v61, vcc
    v_cndmask_b32 v54, v54, v62, vcc
    v_cndmask_b32 v55, v55, v63, vcc
    v_cmp_eq_u32 vcc, 2, v6
    s_nop 1
    v_cndmask_b32 v48, v48, v64, vcc
    v_cndmask_b32 v49, v49, v65, vcc
    v_cndmask_b32 v50, v50, v66, vcc
    v_cndmask_b32 v51, v51, v67, vcc
    v_cndmask_b32 v52, v52, v68, vcc
    v_cndmask_b32 v53, v53, v69, vcc
    v_cndmask_b32 v54, v54, v70, vcc
    v_cndmask_b32 v55, v55, v71, vcc
    v_cmp_eq_u32 vcc, 3, v6
    s_nop 1
    v_cndmask_b32 v48, v48, v72, vcc
    v_cndmask_b32 v49, v49, v73, vcc
    v_cndmask_b32 v50, v50, v74, vcc
    v_cndmask_b32 v51, v51, v75, vcc
    v_cndmask_b32 v52, v52, v76, vcc
    v_cndmask_b32 v53, v53, v77, vcc
    v_cndmask_b32 v54, v54, v78, vcc
    v_cndmask_b32 v55, v55, v79, vcc
    v_mul_f32 v48, s96, v48
    v_mul_f32 v49, s96, v49
    v_mul_f32 v50, s96, v50
    v_mul_f32 v51, s96, v51
    v_mul_f32 v52, s96, v52
    v_mul_f32 v53, s96, v53
    v_mul_f32 v54, s96, v54
    v_mul_f32 v55, s96, v55
    v_cvt_pk_bf16_f32 v24, v48, v49
    v_cvt_pk_bf16_f32 v25, v50, v51
    v_cvt_pk_bf16_f32 v26, v52, v53
    v_cvt_pk_bf16_f32 v27, v54, v55
    v_min_u32 v24, -2, v24
    v_min_u32 v25, -2, v25
    v_min_u32 v26, -2, v26
    v_min_u32 v27, -2, v27
    v_lshrrev_b32 v5, 2, v3
    v_lshlrev_b32 v5, 15, v5
    v_lshl_add_u32 v5, v4, 4, v5
    v_and_b32 v6, 3, v3
    v_lshl_add_u32 v5, v6, 6, v5
    s_lshl_b32 s54, s52, 10
    s_lshl_b32 s55, s3, 8
    s_add_u32 s54, s54, s55
    s_add_u32 s54, s54, 1048576
    buffer_store_dwordx4 v[24:27], v5, s[44:47], s54 offen sc1
    buffer_load_dwordx4 a[0:3], v121, s[40:43], s62 offen nt
    s_add_u32 s62, s62, 8192
    buffer_load_dwordx4 a[4:7], v121, s[40:43], s62 offen nt
    s_add_u32 s62, s62, 8192
    buffer_load_dwordx4 a[8:11], v121, s[40:43], s62 offen nt
    s_add_u32 s62, s62, 8192
    buffer_load_dwordx4 a[12:15], v121, s[40:43], s62 offen nt
    s_add_u32 s62, s62, 8192
    buffer_load_dwordx4 a[16:19], v121, s[40:43], s62 offen nt
    s_add_u32 s62, s62, 8192
    buffer_load_dwordx4 a[20:23], v121, s[40:43], s62 offen nt
    s_add_u32 s62, s62, 8192
    buffer_load_dwordx4 a[24:27], v121, s[40:43], s62 offen nt
    s_add_u32 s62, s62, 8192
    buffer_load_dwordx4 a[28:31], v121, s[40:43], s62 offen nt
    s_add_u32 s62, s62, 8192
    buffer_load_dwordx4 a[32:35], v121, s[40:43], s62 offen nt
    s_add_u32 s62, s62, 8192
    buffer_load_dwordx4 a[36:39], v121, s[40:43], s62 offen nt
    s_add_u32 s62, s62, 8192
    buffer_load_dwordx4 a[40:43], v121, s[40:43], s62 offen nt
    s_add_u32 s62, s62, 8192
    buffer_load_dwordx4 a[44:47], v121, s[40:43], s62 offen nt
    s_add_u32 s62, s62, 8192
    buffer_load_dwordx4 a[48:51], v121, s[40:43], s62 offen nt
    s_add_u32 s62, s62, 8192
    buffer_load_dwordx4 a[52:55], v121, s[40:43], s62 offen nt
    s_add_u32 s62, s62, 8192
    buffer_load_dwordx4 a[56:59], v121, s[40:43], s62 offen nt
    s_add_u32 s62, s62, 8192
    buffer_load_dwordx4 a[60:63], v121, s[40:43], s62 offen nt
    s_add_u32 s62, s62, 8192
    buffer_load_dwordx4 a[64:67], v121, s[40:43], s62 offen nt
    s_add_u32 s62, s62, 8192
    buffer_load_dwordx4 a[68:71], v121, s[40:43], s62 offen nt
    s_add_u32 s62, s62, 8192
    buffer_load_dwordx4 a[72:75], v121, s[40:43], s62 offen nt
    s_add_u32 s62, s62, 8192
    buffer_load_dwordx4 a[76:79], v121, s[40:43], s62 offen nt
    s_add_u32 s62, s62, 8192
    buffer_load_dwordx4 a[80:83], v121, s[40:43], s62 offen nt
    s_add_u32 s62, s62, 8192
    buffer_load_dwordx4 a[84:87], v121, s[40:43], s62 offen nt
    s_add_u32 s62, s62, 8192
    buffer_load_dwordx4 a[88:91], v121, s[40:43], s62 offen nt
    s_add_u32 s62, s62, 8192
    buffer_load_dwordx4 a[92:95], v121, s[40:43], s62 offen nt
    s_add_u32 s62, s62, 8192
    buffer_load_dwordx4 a[96:99], v121, s[40:43], s62 offen nt
    s_add_u32 s62, s62, 8192
    buffer_load_dwordx4 a[100:103], v121, s[40:43], s62 offen nt
    s_add_u32 s62, s62, 8192
    buffer_load_dwordx4 a[104:107], v121, s[40:43], s62 offen nt
    s_add_u32 s62, s62, 8192
    buffer_load_dwordx4 a[108:111], v121, s[40:43], s62 offen nt
    s_add_u32 s62, s62, 8192
    buffer_load_dwordx4 a[112:115], v121, s[40:43], s62 offen nt
    s_add_u32 s62, s62, 8192
    buffer_load_dwordx4 a[116:119], v121, s[40:43], s62 offen nt
    s_add_u32 s62, s62, 8192
    buffer_load_dwordx4 a[120:123], v121, s[40:43], s62 offen nt
    s_add_u32 s62, s62, 8192
    buffer_load_dwordx4 a[124:127], v121, s[40:43], s62 offen nt
    s_add_u32 s62, s62, 8192
    v_mov_b32 v16, 0
    global_load_dword v17, v16, s[28:29] sc1
    s_waitcnt vmcnt(0)
    s_barrier
L_flags_19:
    v_cmp_gt_u32 vcc, 1073741824, v17
    s_cbranch_vccz L_flagsok_20
    s_sleep 2
    global_load_dword v17, v16, s[28:29] sc1
    s_waitcnt vmcnt(0)
    s_sub_u32 s101, s101, 1
    s_cbranch_scc0 L_flags_19
    s_mov_b32 s101, 0
L_flagsok_20:
    s_lshl_b32 s58, s3, 18
    s_lshl_b32 s54, s52, 10
    s_add_u32 s58, s58, s54
    s_add_u32 s58, s58, 2097152
    s_lshl_b32 s59, s3, 11
    s_lshl_b32 s54, s52, 3
    s_add_u32 s59, s59, s54
    s_add_u32 s59, s59, 3145728
    s_mov_b32 s98, 0xffff0000
    v_and_b32 v5, 7, v1
    v_lshlrev_b32 v5, 8, v5
L_blight_21:
    buffer_load_dwordx2 v[232:233], v5, s[44:47], s59 offen sc1
    s_waitcnt vmcnt(0)
    v_max_u32 v6, v232, v233
    v_cmp_eq_u32 vcc, -1, v6
    s_cbranch_vccz L_bheavy_22
    s_sleep 2
    s_sub_u32 s101, s101, 1
    s_cbranch_scc0 L_blight_21
    s_mov_b32 s101, 0
L_bheavy_22:
    buffer_load_dwordx4 v[16:19], v2, s[44:47], s58 offen sc1 nt
    s_add_u32 s58, s58, 32768
    buffer_load_dwordx4 v[20:23], v2, s[44:47], s58 offen sc1 nt
    s_add_u32 s58, s58, 32768
    buffer_load_dwordx4 v[24:27], v2, s[44:47], s58 offen sc1 nt
    s_add_u32 s58, s58, 32768
    buffer_load_dwordx4 v[28:31], v2, s[44:47], s58 offen sc1 nt
    s_add_u32 s58, s58, 32768
    buffer_load_dwordx4 v[32:35], v2, s[44:47], s58 offen sc1 nt
    s_add_u32 s58, s58, 32768
    buffer_load_dwordx4 v[36:39], v2, s[44:47], s58 offen sc1 nt
    s_add_u32 s58, s58, 32768
    buffer_load_dwordx4 v[40:43], v2, s[44:47], s58 offen sc1 nt
    s_add_u32 s58, s58, 32768
    buffer_load_dwordx4 v[44:47], v2, s[44:47], s58 offen sc1 nt
    s_add_u32 s58, s58, 32768
    v_max_f32_dpp v234, v232, v232 row_ror:1 row_mask:0xf bank_mask:0xf
    s_nop 1
    v_max_f32_dpp v234, v234, v234 row_ror:2 row_mask:0xf bank_mask:0xf
    s_nop 1
    v_max_f32_dpp v234, v234, v234 row_ror:4 row_mask:0xf bank_mask:0xf
    v_sub_f32 v232, v232, v234
    v_exp_f32 v232, v232
    s_nop 0
    v_mul_f32 v232, v232, v233
    s_nop 1
    v_add_f32_dpp v234, v232, v232 row_ror:1 row_mask:0xf bank_mask:0xf
    s_nop 1
    v_add_f32_dpp v234, v234, v234 row_ror:2 row_mask:0xf bank_mask:0xf
    s_nop 1
    v_add_f32_dpp v234, v234, v234 row_ror:4 row_mask:0xf bank_mask:0xf
    v_rcp_f32 v234, v234
    s_nop 0
    v_mul_f32 v232, v232, v234
    s_waitcnt vmcnt(7)
    v_lshlrev_b32 v240, 16, v16
    v_and_b32 v16, s98, v16
    v_lshlrev_b32 v241, 16, v17
    v_and_b32 v17, s98, v17
    v_lshlrev_b32 v242, 16, v18
    v_and_b32 v18, s98, v18
    v_lshlrev_b32 v243, 16, v19
    v_and_b32 v19, s98, v19
    v_mul_f32_dpp v224, v232, v240 row_newbcast:0 row_mask:0xf bank_mask:0xf
    v_mul_f32_dpp v225, v232, v16 row_newbcast:0 row_mask:0xf bank_mask:0xf
    v_mul_f32_dpp v226, v232, v241 row_newbcast:0 row_mask:0xf bank_mask:0xf
    v_mul_f32_dpp v227, v232, v17 row_newbcast:0 row_mask:0xf bank_mask:0xf
    v_mul_f32_dpp v228, v232, v242 row_newbcast:0 row_mask:0xf bank_mask:0xf
    v_mul_f32_dpp v229, v232, v18 row_newbcast:0 row_mask:0xf bank_mask:0xf
    v_mul_f32_dpp v230, v232, v243 row_newbcast:0 row_mask:0xf bank_mask:0xf
    v_mul_f32_dpp v231, v232, v19 row_newbcast:0 row_mask:0xf bank_mask:0xf
    s_waitcnt vmcnt(6)
    v_lshlrev_b32 v240, 16, v20
    v_and_b32 v20, s98, v20
    v_lshlrev_b32 v241, 16, v21
    v_and_b32 v21, s98, v21
    v_lshlrev_b32 v242, 16, v22
    v_and_b32 v22, s98, v22
    v_lshlrev_b32 v243, 16, v23
    v_and_b32 v23, s98, v23
    v_fmac_f32_dpp v224, v232, v240 row_newbcast:1 row_mask:0xf bank_mask:0xf
    v_fmac_f32_dpp v225, v232, v20 row_newbcast:1 row_mask:0xf bank_mask:0xf
    v_fmac_f32_dpp v226, v232, v241 row_newbcast:1 row_mask:0xf bank_mask:0xf
    v_fmac_f32_dpp v227, v232, v21 row_newbcast:1 row_mask:0xf bank_mask:0xf
    v_fmac_f32_dpp v228, v232, v242 row_newbcast:1 row_mask:0xf bank_mask:0xf
    v_fmac_f32_dpp v229, v232, v22 row_newbcast:1 row_mask:0xf bank_mask:0xf
    v_fmac_f32_dpp v230, v232, v243 row_newbcast:1 row_mask:0xf bank_mask:0xf
    v_fmac_f32_dpp v231, v232, v23 row_newbcast:1 row_mask:0xf bank_mask:0xf
    s_waitcnt vmcnt(5)
    v_lshlrev_b32 v240, 16, v24
    v_and_b32 v24, s98, v24
    v_lshlrev_b32 v241, 16, v25
    v_and_b32 v25, s98, v25
    v_lshlrev_b32 v242, 16, v26
    v_and_b32 v26, s98, v26
    v_lshlrev_b32 v243, 16, v27
    v_and_b32 v27, s98, v27
    v_fmac_f32_dpp v224, v232, v240 row_newbcast:2 row_mask:0xf bank_mask:0xf
    v_fmac_f32_dpp v225, v232, v24 row_newbcast:2 row_mask:0xf bank_mask:0xf
    v_fmac_f32_dpp v226, v232, v241 row_newbcast:2 row_mask:0xf bank_mask:0xf
    v_fmac_f32_dpp v227, v232, v25 row_newbcast:2 row_mask:0xf bank_mask:0xf
    v_fmac_f32_dpp v228, v232, v242 row_newbcast:2 row_mask:0xf bank_mask:0xf
    v_fmac_f32_dpp v229, v232, v26 row_newbcast:2 row_mask:0xf bank_mask:0xf
    v_fmac_f32_dpp v230, v232, v243 row_newbcast:2 row_mask:0xf bank_mask:0xf
    v_fmac_f32_dpp v231, v232, v27 row_newbcast:2 row_mask:0xf bank_mask:0xf
    s_waitcnt vmcnt(4)
    v_lshlrev_b32 v240, 16, v28
    v_and_b32 v28, s98, v28
    v_lshlrev_b32 v241, 16, v29
    v_and_b32 v29, s98, v29
    v_lshlrev_b32 v242, 16, v30
    v_and_b32 v30, s98, v30
    v_lshlrev_b32 v243, 16, v31
    v_and_b32 v31, s98, v31
    v_fmac_f32_dpp v224, v232, v240 row_newbcast:3 row_mask:0xf bank_mask:0xf
    v_fmac_f32_dpp v225, v232, v28 row_newbcast:3 row_mask:0xf bank_mask:0xf
    v_fmac_f32_dpp v226, v232, v241 row_newbcast:3 row_mask:0xf bank_mask:0xf
    v_fmac_f32_dpp v227, v232, v29 row_newbcast:3 row_mask:0xf bank_mask:0xf
    v_fmac_f32_dpp v228, v232, v242 row_newbcast:3 row_mask:0xf bank_mask:0xf
    v_fmac_f32_dpp v229, v232, v30 row_newbcast:3 row_mask:0xf bank_mask:0xf
    v_fmac_f32_dpp v230, v232, v243 row_newbcast:3 row_mask:0xf bank_mask:0xf
    v_fmac_f32_dpp v231, v232, v31 row_newbcast:3 row_mask:0xf bank_mask:0xf
    s_waitcnt vmcnt(3)
    v_lshlrev_b32 v240, 16, v32
    v_and_b32 v32, s98, v32
    v_lshlrev_b32 v241, 16, v33
    v_and_b32 v33, s98, v33
    v_lshlrev_b32 v242, 16, v34
    v_and_b32 v34, s98, v34
    v_lshlrev_b32 v243, 16, v35
    v_and_b32 v35, s98, v35
    v_fmac_f32_dpp v224, v232, v240 row_newbcast:4 row_mask:0xf bank_mask:0xf
    v_fmac_f32_dpp v225, v232, v32 row_newbcast:4 row_mask:0xf bank_mask:0xf
    v_fmac_f32_dpp v226, v232, v241 row_newbcast:4 row_mask:0xf bank_mask:0xf
    v_fmac_f32_dpp v227, v232, v33 row_newbcast:4 row_mask:0xf bank_mask:0xf
    v_fmac_f32_dpp v228, v232, v242 row_newbcast:4 row_mask:0xf bank_mask:0xf
    v_fmac_f32_dpp v229, v232, v34 row_newbcast:4 row_mask:0xf bank_mask:0xf
    v_fmac_f32_dpp v230, v232, v243 row_newbcast:4 row_mask:0xf bank_mask:0xf
    v_fmac_f32_dpp v231, v232, v35 row_newbcast:4 row_mask:0xf bank_mask:0xf
    s_waitcnt vmcnt(2)
    v_lshlrev_b32 v240, 16, v36
    v_and_b32 v36, s98, v36
    v_lshlrev_b32 v241, 16, v37
    v_and_b32 v37, s98, v37
    v_lshlrev_b32 v242, 16, v38
    v_and_b32 v38, s98, v38
    v_lshlrev_b32 v243, 16, v39
    v_and_b32 v39, s98, v39
    v_fmac_f32_dpp v224, v232, v240 row_newbcast:5 row_mask:0xf bank_mask:0xf
    v_fmac_f32_dpp v225, v232, v36 row_newbcast:5 row_mask:0xf bank_mask:0xf
    v_fmac_f32_dpp v226, v232, v241 row_newbcast:5 row_mask:0xf bank_mask:0xf
    v_fmac_f32_dpp v227, v232, v37 row_newbcast:5 row_mask:0xf bank_mask:0xf
    v_fmac_f32_dpp v228, v232, v242 row_newbcast:5 row_mask:0xf bank_mask:0xf
    v_fmac_f32_dpp v229, v232, v38 row_newbcast:5 row_mask:0xf bank_mask:0xf
    v_fmac_f32_dpp v230, v232, v243 row_newbcast:5 row_mask:0xf bank_mask:0xf
    v_fmac_f32_dpp v231, v232, v39 row_newbcast:5 row_mask:0xf bank_mask:0xf
    s_waitcnt vmcnt(1)
    v_lshlrev_b32 v240, 16, v40
    v_and_b32 v40, s98, v40
    v_lshlrev_b32 v241, 16, v41
    v_and_b32 v41, s98, v41
    v_lshlrev_b32 v242, 16, v42
    v_and_b32 v42, s98, v42
    v_lshlrev_b32 v243, 16, v43
    v_and_b32 v43, s98, v43
    v_fmac_f32_dpp v224, v232, v240 row_newbcast:6 row_mask:0xf bank_mask:0xf
    v_fmac_f32_dpp v225, v232, v40 row_newbcast:6 row_mask:0xf bank_mask:0xf
    v_fmac_f32_dpp v226, v232, v241 row_newbcast:6 row_mask:0xf bank_mask:0xf
    v_fmac_f32_dpp v227, v232, v41 row_newbcast:6 row_mask:0xf bank_mask:0xf
    v_fmac_f32_dpp v228, v232, v242 row_newbcast:6 row_mask:0xf bank_mask:0xf
    v_fmac_f32_dpp v229, v232, v42 row_newbcast:6 row_mask:0xf bank_mask:0xf
    v_fmac_f32_dpp v230, v232, v243 row_newbcast:6 row_mask:0xf bank_mask:0xf
    v_fmac_f32_dpp v231, v232, v43 row_newbcast:6 row_mask:0xf bank_mask:0xf
    s_waitcnt vmcnt(0)
    v_lshlrev_b32 v240, 16, v44
    v_and_b32 v44, s98, v44
    v_lshlrev_b32 v241, 16, v45
    v_and_b32 v45, s98, v45
    v_lshlrev_b32 v242, 16, v46
    v_and_b32 v46, s98, v46
    v_lshlrev_b32 v243, 16, v47
    v_and_b32 v47, s98, v47
    v_fmac_f32_dpp v224, v232, v240 row_newbcast:7 row_mask:0xf bank_mask:0xf
    v_fmac_f32_dpp v225, v232, v44 row_newbcast:7 row_mask:0xf bank_mask:0xf
    v_fmac_f32_dpp v226, v232, v241 row_newbcast:7 row_mask:0xf bank_mask:0xf
    v_fmac_f32_dpp v227, v232, v45 row_newbcast:7 row_mask:0xf bank_mask:0xf
    v_fmac_f32_dpp v228, v232, v242 row_newbcast:7 row_mask:0xf bank_mask:0xf
    v_fmac_f32_dpp v229, v232, v46 row_newbcast:7 row_mask:0xf bank_mask:0xf
    v_fmac_f32_dpp v230, v232, v243 row_newbcast:7 row_mask:0xf bank_mask:0xf
    v_fmac_f32_dpp v231, v232, v47 row_newbcast:7 row_mask:0xf bank_mask:0xf
    v_cvt_pk_bf16_f32 v244, v224, v225
    v_cvt_pk_bf16_f32 v245, v226, v227
    v_cvt_pk_bf16_f32 v246, v228, v229
    v_cvt_pk_bf16_f32 v247, v230, v231
    s_lshl_b32 s54, s3, 10
    v_add_u32 v5, s54, v2
    ds_write_b128 v5, v[244:247]
    v_lshrrev_b32 v5, 3, v3
    v_lshlrev_b32 v5, 10, v5
    v_lshl_add_u32 v5, v4, 6, v5
    s_lshl_b32 s54, s3, 8
    v_add_u32 v5, s54, v5
    s_waitcnt lgkmcnt(0)
    s_barrier
    ds_read_b128 v[16:19], v5 offset:0
    ds_read_b128 v[20:23], v5 offset:16
    ds_read_b128 v[24:27], v5 offset:32
    ds_read_b128 v[28:31], v5 offset:48
    ds_read_b128 v[32:35], v5 offset:2048
    ds_read_b128 v[36:39], v5 offset:2064
    ds_read_b128 v[40:43], v5 offset:2080
    ds_read_b128 v[44:47], v5 offset:2096
    s_waitcnt lgkmcnt(0)
    v_perm_b32 v48, v16, v16, v8
    v_perm_b32 v49, v16, v16, v10
    v_perm_b32 v50, v16, v16, v12
    v_perm_b32 v51, v16, v16, v14
    s_nop 1
    v_mfma_f32_16x16x32_bf16 v[224:227], v[48:51], a[0:3], 0
    v_perm_b32 v52, v32, v32, v8
    v_perm_b32 v53, v32, v32, v10
    v_perm_b32 v54, v32, v32, v12
    v_perm_b32 v55, v32, v32, v14
    s_nop 1
    v_mfma_f32_16x16x32_bf16 v[228:231], v[52:55], a[0:3], 0
    v_perm_b32 v56, v16, v16, v9
    v_perm_b32 v57, v16, v16, v11
    v_perm_b32 v58, v16, v16, v13
    v_perm_b32 v59, v16, v16, v15
    s_nop 1
    v_mfma_f32_16x16x32_bf16 v[224:227], v[56:59], a[4:7], v[224:227]
    v_perm_b32 v60, v32, v32, v9
    v_perm_b32 v61, v32, v32, v11
    v_perm_b32 v62, v32, v32, v13
    v_perm_b32 v63, v32, v32, v15
    s_nop 1
    v_mfma_f32_16x16x32_bf16 v[228:231], v[60:63], a[4:7], v[228:231]
    v_perm_b32 v48, v17, v17, v8
    v_perm_b32 v49, v17, v17, v10
    v_perm_b32 v50, v17, v17, v12
    v_perm_b32 v51, v17, v17, v14
    s_nop 1
    v_mfma_f32_16x16x32_bf16 v[224:227], v[48:51], a[8:11], v[224:227]
    v_perm_b32 v52, v33, v33, v8
    v_perm_b32 v53, v33, v33, v10
    v_perm_b32 v54, v33, v33, v12
    v_perm_b32 v55, v33, v33, v14
    s_nop 1
    v_mfma_f32_16x16x32_bf16 v[228:231], v[52:55], a[8:11], v[228:231]
    v_perm_b32 v56, v17, v17, v9
    v_perm_b32 v57, v17, v17, v11
    v_perm_b32 v58, v17, v17, v13
    v_perm_b32 v59, v17, v17, v15
    s_nop 1
    v_mfma_f32_16x16x32_bf16 v[224:227], v[56:59], a[12:15], v[224:227]
    v_perm_b32 v60, v33, v33, v9
    v_perm_b32 v61, v33, v33, v11
    v_perm_b32 v62, v33, v33, v13
    v_perm_b32 v63, v33, v33, v15
    s_nop 1
    v_mfma_f32_16x16x32_bf16 v[228:231], v[60:63], a[12:15], v[228:231]
    v_perm_b32 v48, v18, v18, v8
    v_perm_b32 v49, v18, v18, v10
    v_perm_b32 v50, v18, v18, v12
    v_perm_b32 v51, v18, v18, v14
    s_nop 1
    v_mfma_f32_16x16x32_bf16 v[224:227], v[48:51], a[16:19], v[224:227]
    v_perm_b32 v52, v34, v34, v8
    v_perm_b32 v53, v34, v34, v10
    v_perm_b32 v54, v34, v34, v12
    v_perm_b32 v55, v34, v34, v14
    s_nop 1
    v_mfma_f32_16x16x32_bf16 v[228:231], v[52:55], a[16:19], v[228:231]
    v_perm_b32 v56, v18, v18, v9
    v_perm_b32 v57, v18, v18, v11
    v_perm_b32 v58, v18, v18, v13
    v_perm_b32 v59, v18, v18, v15
    s_nop 1
    v_mfma_f32_16x16x32_bf16 v[224:227], v[56:59], a[20:23], v[224:227]
    v_perm_b32 v60, v34, v34, v9
    v_perm_b32 v61, v34, v34, v11
    v_perm_b32 v62, v34, v34, v13
    v_perm_b32 v63, v34, v34, v15
    s_nop 1
    v_mfma_f32_16x16x32_bf16 v[228:231], v[60:63], a[20:23], v[228:231]
    v_perm_b32 v48, v19, v19, v8
    v_perm_b32 v49, v19, v19, v10
    v_perm_b32 v50, v19, v19, v12
    v_perm_b32 v51, v19, v19, v14
    s_nop 1
    v_mfma_f32_16x16x32_bf16 v[224:227], v[48:51], a[24:27], v[224:227]
    v_perm_b32 v52, v35, v35, v8
    v_perm_b32 v53, v35, v35, v10
    v_perm_b32 v54, v35, v35, v12
    v_perm_b32 v55, v35, v35, v14
    s_nop 1
    v_mfma_f32_16x16x32_bf16 v[228:231], v[52:55], a[24:27], v[228:231]
    v_perm_b32 v56, v19, v19, v9
    v_perm_b32 v57, v19, v19, v11
    v_perm_b32 v58, v19, v19, v13
    v_perm_b32 v59, v19, v19, v15
    s_nop 1
    v_mfma_f32_16x16x32_bf16 v[224:227], v[56:59], a[28:31], v[224:227]
    v_perm_b32 v60, v35, v35, v9
    v_perm_b32 v61, v35, v35, v11
    v_perm_b32 v62, v35, v35, v13
    v_perm_b32 v63, v35, v35, v15
    s_nop 1
    v_mfma_f32_16x16x32_bf16 v[228:231], v[60:63], a[28:31], v[228:231]
    v_perm_b32 v48, v20, v20, v8
    v_perm_b32 v49, v20, v20, v10
    v_perm_b32 v50, v20, v20, v12
    v_perm_b32 v51, v20, v20, v14
    s_nop 1
    v_mfma_f32_16x16x32_bf16 v[224:227], v[48:51], a[32:35], v[224:227]
    v_perm_b32 v52, v36, v36, v8
    v_perm_b32 v53, v36, v36, v10
    v_perm_b32 v54, v36, v36, v12
    v_perm_b32 v55, v36, v36, v14
    s_nop 1
    v_mfma_f32_16x16x32_bf16 v[228:231], v[52:55], a[32:35], v[228:231]
    v_perm_b32 v56, v20, v20, v9
    v_perm_b32 v57, v20, v20, v11
    v_perm_b32 v58, v20, v20, v13
    v_perm_b32 v59, v20, v20, v15
    s_nop 1
    v_mfma_f32_16x16x32_bf16 v[224:227], v[56:59], a[36:39], v[224:227]
    v_perm_b32 v60, v36, v36, v9
    v_perm_b32 v61, v36, v36, v11
    v_perm_b32 v62, v36, v36, v13
    v_perm_b32 v63, v36, v36, v15
    s_nop 1
    v_mfma_f32_16x16x32_bf16 v[228:231], v[60:63], a[36:39], v[228:231]
    v_perm_b32 v48, v21, v21, v8
    v_perm_b32 v49, v21, v21, v10
    v_perm_b32 v50, v21, v21, v12
    v_perm_b32 v51, v21, v21, v14
    s_nop 1
    v_mfma_f32_16x16x32_bf16 v[224:227], v[48:51], a[40:43], v[224:227]
    v_perm_b32 v52, v37, v37, v8
    v_perm_b32 v53, v37, v37, v10
    v_perm_b32 v54, v37, v37, v12
    v_perm_b32 v55, v37, v37, v14
    s_nop 1
    v_mfma_f32_16x16x32_bf16 v[228:231], v[52:55], a[40:43], v[228:231]
    v_perm_b32 v56, v21, v21, v9
    v_perm_b32 v57, v21, v21, v11
    v_perm_b32 v58, v21, v21, v13
    v_perm_b32 v59, v21, v21, v15
    s_nop 1
    v_mfma_f32_16x16x32_bf16 v[224:227], v[56:59], a[44:47], v[224:227]
    v_perm_b32 v60, v37, v37, v9
    v_perm_b32 v61, v37, v37, v11
    v_perm_b32 v62, v37, v37, v13
    v_perm_b32 v63, v37, v37, v15
    s_nop 1
    v_mfma_f32_16x16x32_bf16 v[228:231], v[60:63], a[44:47], v[228:231]
    v_perm_b32 v48, v22, v22, v8
    v_perm_b32 v49, v22, v22, v10
    v_perm_b32 v50, v22, v22, v12
    v_perm_b32 v51, v22, v22, v14
    s_nop 1
    v_mfma_f32_16x16x32_bf16 v[224:227], v[48:51], a[48:51], v[224:227]
    v_perm_b32 v52, v38, v38, v8
    v_perm_b32 v53, v38, v38, v10
    v_perm_b32 v54, v38, v38, v12
    v_perm_b32 v55, v38, v38, v14
    s_nop 1
    v_mfma_f32_16x16x32_bf16 v[228:231], v[52:55], a[48:51], v[228:231]
    v_perm_b32 v56, v22, v22, v9
    v_perm_b32 v57, v22, v22, v11
    v_perm_b32 v58, v22, v22, v13
    v_perm_b32 v59, v22, v22, v15
    s_nop 1
    v_mfma_f32_16x16x32_bf16 v[224:227], v[56:59], a[52:55], v[224:227]
    v_perm_b32 v60, v38, v38, v9
    v_perm_b32 v61, v38, v38, v11
    v_perm_b32 v62, v38, v38, v13
    v_perm_b32 v63, v38, v38, v15
    s_nop 1
    v_mfma_f32_16x16x32_bf16 v[228:231], v[60:63], a[52:55], v[228:231]
    v_perm_b32 v48, v23, v23, v8
    v_perm_b32 v49, v23, v23, v10
    v_perm_b32 v50, v23, v23, v12
    v_perm_b32 v51, v23, v23, v14
    s_nop 1
    v_mfma_f32_16x16x32_bf16 v[224:227], v[48:51], a[56:59], v[224:227]
    v_perm_b32 v52, v39, v39, v8
    v_perm_b32 v53, v39, v39, v10
    v_perm_b32 v54, v39, v39, v12
    v_perm_b32 v55, v39, v39, v14
    s_nop 1
    v_mfma_f32_16x16x32_bf16 v[228:231], v[52:55], a[56:59], v[228:231]
    v_perm_b32 v56, v23, v23, v9
    v_perm_b32 v57, v23, v23, v11
    v_perm_b32 v58, v23, v23, v13
    v_perm_b32 v59, v23, v23, v15
    s_nop 1
    v_mfma_f32_16x16x32_bf16 v[224:227], v[56:59], a[60:63], v[224:227]
    v_perm_b32 v60, v39, v39, v9
    v_perm_b32 v61, v39, v39, v11
    v_perm_b32 v62, v39, v39, v13
    v_perm_b32 v63, v39, v39, v15
    s_nop 1
    v_mfma_f32_16x16x32_bf16 v[228:231], v[60:63], a[60:63], v[228:231]
    v_perm_b32 v48, v24, v24, v8
    v_perm_b32 v49, v24, v24, v10
    v_perm_b32 v50, v24, v24, v12
    v_perm_b32 v51, v24, v24, v14
    s_nop 1
    v_mfma_f32_16x16x32_bf16 v[224:227], v[48:51], a[64:67], v[224:227]
    v_perm_b32 v52, v40, v40, v8
    v_perm_b32 v53, v40, v40, v10
    v_perm_b32 v54, v40, v40, v12
    v_perm_b32 v55, v40, v40, v14
    s_nop 1
    v_mfma_f32_16x16x32_bf16 v[228:231], v[52:55], a[64:67], v[228:231]
    v_perm_b32 v56, v24, v24, v9
    v_perm_b32 v57, v24, v24, v11
    v_perm_b32 v58, v24, v24, v13
    v_perm_b32 v59, v24, v24, v15
    s_nop 1
    v_mfma_f32_16x16x32_bf16 v[224:227], v[56:59], a[68:71], v[224:227]
    v_perm_b32 v60, v40, v40, v9
    v_perm_b32 v61, v40, v40, v11
    v_perm_b32 v62, v40, v40, v13
    v_perm_b32 v63, v40, v40, v15
    s_nop 1
    v_mfma_f32_16x16x32_bf16 v[228:231], v[60:63], a[68:71], v[228:231]
    v_perm_b32 v48, v25, v25, v8
    v_perm_b32 v49, v25, v25, v10
    v_perm_b32 v50, v25, v25, v12
    v_perm_b32 v51, v25, v25, v14
    s_nop 1
    v_mfma_f32_16x16x32_bf16 v[224:227], v[48:51], a[72:75], v[224:227]
    v_perm_b32 v52, v41, v41, v8
    v_perm_b32 v53, v41, v41, v10
    v_perm_b32 v54, v41, v41, v12
    v_perm_b32 v55, v41, v41, v14
    s_nop 1
    v_mfma_f32_16x16x32_bf16 v[228:231], v[52:55], a[72:75], v[228:231]
    v_perm_b32 v56, v25, v25, v9
    v_perm_b32 v57, v25, v25, v11
    v_perm_b32 v58, v25, v25, v13
    v_perm_b32 v59, v25, v25, v15
    s_nop 1
    v_mfma_f32_16x16x32_bf16 v[224:227], v[56:59], a[76:79], v[224:227]
    v_perm_b32 v60, v41, v41, v9
    v_perm_b32 v61, v41, v41, v11
    v_perm_b32 v62, v41, v41, v13
    v_perm_b32 v63, v41, v41, v15
    s_nop 1
    v_mfma_f32_16x16x32_bf16 v[228:231], v[60:63], a[76:79], v[228:231]
    v_perm_b32 v48, v26, v26, v8
    v_perm_b32 v49, v26, v26, v10
    v_perm_b32 v50, v26, v26, v12
    v_perm_b32 v51, v26, v26, v14
    s_nop 1
    v_mfma_f32_16x16x32_bf16 v[224:227], v[48:51], a[80:83], v[224:227]
    v_perm_b32 v52, v42, v42, v8
    v_perm_b32 v53, v42, v42, v10
    v_perm_b32 v54, v42, v42, v12
    v_perm_b32 v55, v42, v42, v14
    s_nop 1
    v_mfma_f32_16x16x32_bf16 v[228:231], v[52:55], a[80:83], v[228:231]
    v_perm_b32 v56, v26, v26, v9
    v_perm_b32 v57, v26, v26, v11
    v_perm_b32 v58, v26, v26, v13
    v_perm_b32 v59, v26, v26, v15
    s_nop 1
    v_mfma_f32_16x16x32_bf16 v[224:227], v[56:59], a[84:87], v[224:227]
    v_perm_b32 v60, v42, v42, v9
    v_perm_b32 v61, v42, v42, v11
    v_perm_b32 v62, v42, v42, v13
    v_perm_b32 v63, v42, v42, v15
    s_nop 1
    v_mfma_f32_16x16x32_bf16 v[228:231], v[60:63], a[84:87], v[228:231]
    v_perm_b32 v48, v27, v27, v8
    v_perm_b32 v49, v27, v27, v10
    v_perm_b32 v50, v27, v27, v12
    v_perm_b32 v51, v27, v27, v14
    s_nop 1
    v_mfma_f32_16x16x32_bf16 v[224:227], v[48:51], a[88:91], v[224:227]
    v_perm_b32 v52, v43, v43, v8
    v_perm_b32 v53, v43, v43, v10
    v_perm_b32 v54, v43, v43, v12
    v_perm_b32 v55, v43, v43, v14
    s_nop 1
    v_mfma_f32_16x16x32_bf16 v[228:231], v[52:55], a[88:91], v[228:231]
    v_perm_b32 v56, v27, v27, v9
    v_perm_b32 v57, v27, v27, v11
    v_perm_b32 v58, v27, v27, v13
    v_perm_b32 v59, v27, v27, v15
    s_nop 1
    v_mfma_f32_16x16x32_bf16 v[224:227], v[56:59], a[92:95], v[224:227]
    v_perm_b32 v60, v43, v43, v9
    v_perm_b32 v61, v43, v43, v11
    v_perm_b32 v62, v43, v43, v13
    v_perm_b32 v63, v43, v43, v15
    s_nop 1
    v_mfma_f32_16x16x32_bf16 v[228:231], v[60:63], a[92:95], v[228:231]
    v_perm_b32 v48, v28, v28, v8
    v_perm_b32 v49, v28, v28, v10
    v_perm_b32 v50, v28, v28, v12
    v_perm_b32 v51, v28, v28, v14
    s_nop 1
    v_mfma_f32_16x16x32_bf16 v[224:227], v[48:51], a[96:99], v[224:227]
    v_perm_b32 v52, v44, v44, v8
    v_perm_b32 v53, v44, v44, v10
    v_perm_b32 v54, v44, v44, v12
    v_perm_b32 v55, v44, v44, v14
    s_nop 1
    v_mfma_f32_16x16x32_bf16 v[228:231], v[52:55], a[96:99], v[228:231]
    v_perm_b32 v56, v28, v28, v9
    v_perm_b32 v57, v28, v28, v11
    v_perm_b32 v58, v28, v28, v13
    v_perm_b32 v59, v28, v28, v15
    s_nop 1
    v_mfma_f32_16x16x32_bf16 v[224:227], v[56:59], a[100:103], v[224:227]
    v_perm_b32 v60, v44, v44, v9
    v_perm_b32 v61, v44, v44, v11
    v_perm_b32 v62, v44, v44, v13
    v_perm_b32 v63, v44, v44, v15
    s_nop 1
    v_mfma_f32_16x16x32_bf16 v[228:231], v[60:63], a[100:103], v[228:231]
    v_perm_b32 v48, v29, v29, v8
    v_perm_b32 v49, v29, v29, v10
    v_perm_b32 v50, v29, v29, v12
    v_perm_b32 v51, v29, v29, v14
    s_nop 1
    v_mfma_f32_16x16x32_bf16 v[224:227], v[48:51], a[104:107], v[224:227]
    v_perm_b32 v52, v45, v45, v8
    v_perm_b32 v53, v45, v45, v10
    v_perm_b32 v54, v45, v45, v12
    v_perm_b32 v55, v45, v45, v14
    s_nop 1
    v_mfma_f32_16x16x32_bf16 v[228:231], v[52:55], a[104:107], v[228:231]
    v_perm_b32 v56, v29, v29, v9
    v_perm_b32 v57, v29, v29, v11
    v_perm_b32 v58, v29, v29, v13
    v_perm_b32 v59, v29, v29, v15
    s_nop 1
    v_mfma_f32_16x16x32_bf16 v[224:227], v[56:59], a[108:111], v[224:227]
    v_perm_b32 v60, v45, v45, v9
    v_perm_b32 v61, v45, v45, v11
    v_perm_b32 v62, v45, v45, v13
    v_perm_b32 v63, v45, v45, v15
    s_nop 1
    v_mfma_f32_16x16x32_bf16 v[228:231], v[60:63], a[108:111], v[228:231]
    v_perm_b32 v48, v30, v30, v8
    v_perm_b32 v49, v30, v30, v10
    v_perm_b32 v50, v30, v30, v12
    v_perm_b32 v51, v30, v30, v14
    s_nop 1
    v_mfma_f32_16x16x32_bf16 v[224:227], v[48:51], a[112:115], v[224:227]
    v_perm_b32 v52, v46, v46, v8
    v_perm_b32 v53, v46, v46, v10
    v_perm_b32 v54, v46, v46, v12
    v_perm_b32 v55, v46, v46, v14
    s_nop 1
    v_mfma_f32_16x16x32_bf16 v[228:231], v[52:55], a[112:115], v[228:231]
    v_perm_b32 v56, v30, v30, v9
    v_perm_b32 v57, v30, v30, v11
    v_perm_b32 v58, v30, v30, v13
    v_perm_b32 v59, v30, v30, v15
    s_nop 1
    v_mfma_f32_16x16x32_bf16 v[224:227], v[56:59], a[116:119], v[224:227]
    v_perm_b32 v60, v46, v46, v9
    v_perm_b32 v61, v46, v46, v11
    v_perm_b32 v62, v46, v46, v13
    v_perm_b32 v63, v46, v46, v15
    s_nop 1
    v_mfma_f32_16x16x32_bf16 v[228:231], v[60:63], a[116:119], v[228:231]
    v_perm_b32 v48, v31, v31, v8
    v_perm_b32 v49, v31, v31, v10
    v_perm_b32 v50, v31, v31, v12
    v_perm_b32 v51, v31, v31, v14
    s_nop 1
    v_mfma_f32_16x16x32_bf16 v[224:227], v[48:51], a[120:123], v[224:227]
    v_perm_b32 v52, v47, v47, v8
    v_perm_b32 v53, v47, v47, v10
    v_perm_b32 v54, v47, v47, v12
    v_perm_b32 v55, v47, v47, v14
    s_nop 1
    v_mfma_f32_16x16x32_bf16 v[228:231], v[52:55], a[120:123], v[228:231]
    v_perm_b32 v56, v31, v31, v9
    v_perm_b32 v57, v31, v31, v11
    v_perm_b32 v58, v31, v31, v13
    v_perm_b32 v59, v31, v31, v15
    s_nop 1
    v_mfma_f32_16x16x32_bf16 v[224:227], v[56:59], a[124:127], v[224:227]
    v_perm_b32 v60, v47, v47, v9
    v_perm_b32 v61, v47, v47, v11
    v_perm_b32 v62, v47, v47, v13
    v_perm_b32 v63, v47, v47, v15
    s_nop 1
    v_mfma_f32_16x16x32_bf16 v[228:231], v[60:63], a[124:127], v[228:231]
    v_lshrrev_b32 v5, 1, v4
    v_lshlrev_b32 v5, 9, v5
    v_lshl_add_u32 v5, v3, 5, v5
    v_and_b32 v6, 1, v4
    v_lshl_add_u32 v5, v6, 4, v5
    s_lshl_b32 s54, s3, 11
    s_add_u32 s54, s54, 131072
    v_add_u32 v5, s54, v5
    ds_write_b128 v5, v[224:227]
    ds_write_b128 v5, v[228:231] offset:1024
    s_waitcnt lgkmcnt(0)
    s_barrier
    v_lshrrev_b32 v5, 2, v3
    v_lshlrev_b32 v5, 9, v5
    v_lshl_add_u32 v5, v4, 5, v5
    s_lshl_b32 s54, s3, 7
    s_add_u32 s54, s54, 131072
    v_add_u32 v5, s54, v5
    ds_read_b128 v[16:19], v5 offset:0
    ds_read_b128 v[20:23], v5 offset:16
    ds_read_b128 v[24:27], v5 offset:2048
    ds_read_b128 v[28:31], v5 offset:2064
    ds_read_b128 v[32:35], v5 offset:4096
    ds_read_b128 v[36:39], v5 offset:4112
    ds_read_b128 v[40:43], v5 offset:6144
    ds_read_b128 v[44:47], v5 offset:6160
    s_waitcnt lgkmcnt(0)
    v_add_f32 v16, v16, v24
    v_add_f32 v32, v32, v40
    v_add_f32 v17, v17, v25
    v_add_f32 v33, v33, v41
    v_add_f32 v18, v18, v26
    v_add_f32 v34, v34, v42
    v_add_f32 v19, v19, v27
    v_add_f32 v35, v35, v43
    v_add_f32 v20, v20, v28
    v_add_f32 v36, v36, v44
    v_add_f32 v21, v21, v29
    v_add_f32 v37, v37, v45
    v_add_f32 v22, v22, v30
    v_add_f32 v38, v38, v46
    v_add_f32 v23, v23, v31
    v_add_f32 v39, v39, v47
    v_add_f32 v16, v16, v32
    v_add_f32 v17, v17, v33
    v_add_f32 v18, v18, v34
    v_add_f32 v19, v19, v35
    v_add_f32 v20, v20, v36
    v_add_f32 v21, v21, v37
    v_add_f32 v22, v22, v38
    v_add_f32 v23, v23, v39
    v_cvt_pk_bf16_f32 v64, v16, v17
    v_cvt_pk_bf16_f32 v65, v18, v19
    v_cvt_pk_bf16_f32 v66, v20, v21
    v_cvt_pk_bf16_f32 v67, v22, v23
    v_min_u32 v64, -2, v64
    v_min_u32 v65, -2, v65
    v_min_u32 v66, -2, v66
    v_min_u32 v67, -2, v67
    v_bfe_u32 v6, v1, 2, 2
    v_lshlrev_b32 v6, 6, v6
    v_and_b32 v5, 48, v1
    v_add_u32 v6, v6, v5
    v_and_b32 v5, 3, v1
    v_lshl_add_u32 v6, v5, 29, v6
    s_lshl_b32 s54, s52, 10
    s_lshl_b32 s55, s3, 8
    s_add_u32 s54, s54, s55
    s_add_u32 s54, s54, 5439488
    buffer_store_dwordx4 v[64:67], v6, s[44:47], s54 offen sc1
    s_mov_b32 s48, s26
    s_mov_b32 s49, s27
    s_mov_b32 s50, 9216
    s_mov_b32 s51, 0x20000
    s_lshl_b32 s54, s3, 5
    s_add_u32 s54, s54, s53
    s_cmp_ge_u32 s54, 72
    s_cbranch_scc1 L_nored_23
    v_mov_b32 v48, -1
    v_mov_b32 v49, -1
    v_mov_b32 v50, -1
    v_mov_b32 v51, -1
    v_mov_b32 v52, -1
    v_mov_b32 v53, -1
    v_mov_b32 v54, -1
    v_mov_b32 v55, -1
    v_mov_b32 v56, -1
    v_mov_b32 v57, -1
    v_mov_b32 v58, -1
    v_mov_b32 v59, -1
    v_mov_b32 v60, -1
    v_mov_b32 v61, -1
    v_mov_b32 v62, -1
    v_mov_b32 v63, -1
    s_lshl_b32 s55, s54, 12
    s_add_u32 s55, s55, 4718592
    s_mul_hi_u32 s56, s54, 238609295
    s_add_u32 s56, s56, 1
    s_mul_i32 s56, s56, 1152
    s_lshl_b32 s57, s54, 6
    s_add_u32 s56, s56, s57
    v_lshlrev_b32 v5, 3, v3
    v_lshl_add_u32 v5, v4, 1, v5
    v_mov_b32 v6, 0x4000
    v_cmp_gt_u32 vcc, 8, v3
    s_nop 1
    v_cndmask_b32 v5, v6, v5, vcc
    s_mov_b64 s[4:5], -1
    s_mov_b64 s[6:7], -1
    s_mov_b64 s[8:9], -1
    s_mov_b64 s[10:11], -1
L_mpoll_24:
    s_mov_b64 exec, s[4:5]
    buffer_load_dwordx4 v[48:51], v2, s[44:47], s55 offen offset:0 sc1
    s_mov_b64 exec, s[6:7]
    buffer_load_dwordx4 v[52:55], v2, s[44:47], s55 offen offset:1024 sc1
    s_mov_b64 exec, s[8:9]
    buffer_load_dwordx4 v[56:59], v2, s[44:47], s55 offen offset:2048 sc1
    s_mov_b64 exec, s[10:11]
    buffer_load_dwordx4 v[60:63], v2, s[44:47], s55 offen offset:3072 sc1
    s_mov_b64 exec, -1
    s_waitcnt vmcnt(4)
    v_max3_u32 v32, v48, v49, v50
    v_max3_u32 v33, v52, v53, v54
    v_max3_u32 v34, v56, v57, v58
    v_max3_u32 v35, v60, v61, v62
    v_max_u32 v32, v32, v51
    v_max_u32 v33, v33, v55
    v_max_u32 v34, v34, v59
    v_max_u32 v35, v35, v63
    v_cmp_eq_u32 s[4:5], -1, v32
    v_cmp_eq_u32 s[6:7], -1, v33
    v_cmp_eq_u32 s[8:9], -1, v34
    v_cmp_eq_u32 s[10:11], -1, v35
    s_or_b64 vcc, s[4:5], s[6:7]
    s_or_b64 vcc, vcc, s[8:9]
    s_or_b64 vcc, vcc, s[10:11]
    s_cbranch_scc0 L_mpollok_25
    s_and_b64 vcc, s[4:5], s[6:7]
    s_and_b64 vcc, vcc, s[8:9]
    s_and_b64 vcc, vcc, s[10:11]
    s_cmp_eq_u64 vcc, -1
    s_cbranch_scc0 L_mpoll_24_b
    s_sleep 4
L_mpoll_24_b:
    s_sub_u32 s101, s101, 1
    s_cbranch_scc0 L_mpoll_24
    s_mov_b32 s101, 0
L_mpollok_25:
    v_add_f32 v16, v48, v52
    v_add_f32 v24, v56, v60
    v_add_f32 v18, v50, v54
    v_add_f32 v26, v58, v62
    v_add_f32 v17, v49, v53
    v_add_f32 v25, v57, v61
    v_add_f32 v19, v51, v55
    v_add_f32 v27, v59, v63
    v_add_f32 v16, v16, v24
    v_add_f32 v18, v18, v26
    v_add_f32 v17, v17, v25
    v_add_f32 v19, v19, v27
    v_permlane32_swap_b32 v16, v18
    s_nop 0
    v_permlane32_swap_b32 v17, v19
    v_add_f32 v16, v16, v18
    v_add_f32 v17, v17, v19
    s_nop 1
    v_permlane16_swap_b32 v16, v17
    v_add_f32 v16, v16, v17
    s_nop 1
    v_add_f32_dpp v16, v16, v16 row_ror:8 row_mask:0xf bank_mask:0xf
    v_cvt_pk_bf16_f32 v16, v16, v16
    buffer_store_short v16, v5, s[48:51], s56 offen
L_nored_23:
    s_endpgm
L_roleH_end:
L_roleC:
    s_mov_b32 s101, 100000
    s_getpc_b64 s[56:57]
L_pc_26:
    s_sub_u32 s56, s56, L_pc_26-L_roleC
    s_subb_u32 s57, s57, 0
    v_lshlrev_b32 v5, 7, v0
    v_min_u32 v6, L_roleC_end-L_roleC-4, v5
    global_load_dword v122, v6, s[56:57]
    v_add_u32 v5, 32768, v5
    v_min_u32 v6, L_roleC_end-L_roleC-4, v5
    global_load_dword v122, v6, s[56:57]
    v_mov_b32 v20, -1
    v_mov_b32 v21, -1
    v_mov_b32 v22, -1
    v_mov_b32 v23, -1
    v_mul_u32_u24 v7, 73728, v4
    v_lshrrev_b32 v5, 3, v3
    v_lshl_add_u32 v6, v5, 13, v7
    v_and_b32 v5, 7, v3
    v_lshl_add_u32 v6, v5, 4, v6
    v_lshl_add_u32 v7, v3, 3, v7
    v_add_u32 v7, 65536, v7
    s_lshl_b32 s56, s52, 7
    s_add_u32 s56, s56, 4194304
    s_lshl_b32 s54, s3, 14
    s_add_u32 s54, s54, s56
    s_add_u32 s55, s54, 4096
    s_and_b32 s57, s3, 1
    s_lshl_b32 s57, s57, 12
    s_add_u32 s56, s56, s57
    s_waitcnt lgkmcnt(0)
    s_mov_b32 s44, s30
    s_mov_b32 s45, s31
    s_mov_b32 s46, 536870912
    s_mov_b32 s47, 0x20000
    buffer_store_dwordx4 v[20:23], v6, s[44:47], s54 offen sc1
    buffer_store_dwordx4 v[20:23], v6, s[44:47], s55 offen sc1
    buffer_store_dwordx2 v[20:21], v7, s[44:47], s56 offen sc1
    v_mov_b32 v7, 536870912
    v_cmp_gt_u32 vcc, 16, v1
    s_nop 1
    v_cndmask_b32 v123, v7, v2, vcc
    s_lshl_b32 s98, s52, 10
    s_lshl_b32 s54, s3, 8
    s_add_u32 s98, s98, s54
    s_add_u32 s98, s98, 5242880
    buffer_store_dwordx4 v[20:23], v123, s[44:47], s98 offen sc1
    s_lshl_b32 s58, s52, 2
    s_add_u32 s58, s58, s3
    s_lshl_b32 s58, s58, 13
    s_add_u32 s58, s58, 8388608
    s_add_u32 s59, s58, 4096
    v_min_u32 v6, 1, v3
    v_lshl_add_u32 v6, v6, 2, v4
    v_lshlrev_b32 v6, 4, v6
    s_lshr_b32 s55, s52, 2
    s_add_u32 s55, s55, s3
    s_and_b32 s55, s55, 3
    s_and_b32 s54, s52, 3
    s_cmp_eq_u32 s54, s55
    s_mov_b32 s56, 255
    s_cselect_b32 s56, 16777215, s56
    s_mov_b32 s57, 0
    s_cbranch_scc0 L_cclr
    buffer_store_dwordx4 v[20:23], v2, s[44:47], s58 offen offset:2048 sc1
    buffer_store_dwordx4 v[20:23], v2, s[44:47], s58 offen offset:3072 sc1
    buffer_store_dwordx4 v[20:23], v2, s[44:47], s59 offen offset:0 sc1
    buffer_store_dwordx4 v[20:23], v2, s[44:47], s59 offen offset:1024 sc1
    s_and_b32 s55, s52, 28
    s_add_u32 s55, s55, s3
    s_mul_i32 s55, s55, 256
    s_add_u32 s55, s55, 16777216
    v_mov_b32 v5, 0
    s_mov_b64 exec, 1
    buffer_store_dword v5, v5, s[44:47], s55 offen sc1
    s_lshl_b32 s55, s53, 8
    s_add_u32 s55, s55, 3145728
    s_mov_b64 exec, 0xffff
    buffer_store_dwordx4 v[20:23], v2, s[44:47], s55 offen sc1
    s_mov_b64 exec, -1
L_cclr:
    buffer_store_dwordx4 v[20:23], v2, s[44:47], s58 offen offset:0 sc1
    buffer_store_dwordx4 v[20:23], v2, s[44:47], s58 offen offset:1024 sc1
    s_mov_b64 exec, s[56:57]
    buffer_store_dwordx4 v[20:23], v2, s[44:47], s59 offen offset:2048 sc1
    s_mov_b64 exec, -1
    s_mov_b32 s40, s10
    s_mov_b32 s41, s11
    s_mov_b32 s42, 4718592
    s_mov_b32 s43, 0x20000
    s_mov_b32 s48, s4
    s_mov_b32 s49, s5
    s_mov_b32 s50, 4608
    s_mov_b32 s51, 0x20000
    s_mov_b32 s32, s16
    s_mov_b32 s33, s17
    s_mov_b32 s34, 16777216
    s_mov_b32 s35, 0x20000
    v_lshrrev_b32 v5, 3, v3
    v_mul_u32_u24 v5, 1152, v5
    v_mul_u32_u24 v6, 72, v4
    v_add_u32 v5, v5, v6
    s_mul_i32 s54, s3, 288
    buffer_load_dwordx4 v[48:51], v5, s[48:51], s54 offen offset:0
    buffer_load_dwordx4 v[52:55], v5, s[48:51], s54 offen offset:16
    buffer_load_dwordx4 v[56:59], v5, s[48:51], s54 offen offset:32
    buffer_load_dwordx4 v[60:63], v5, s[48:51], s54 offen offset:48
    buffer_load_dwordx2 v[64:65], v5, s[48:51], s54 offen offset:64
    buffer_load_dwordx4 v[68:71], v5, s[48:51], s54 offen offset:2304
    buffer_load_dwordx4 v[72:75], v5, s[48:51], s54 offen offset:2320
    buffer_load_dwordx4 v[76:79], v5, s[48:51], s54 offen offset:2336
    buffer_load_dwordx4 v[80:83], v5, s[48:51], s54 offen offset:2352
    buffer_load_dwordx2 v[84:85], v5, s[48:51], s54 offen offset:2368
    v_mul_u32_u24 v120, 294912, v4
    v_lshl_add_u32 v120, v3, 4, v120
    s_mul_i32 s61, s3, 1179648
    s_lshl_b32 s54, s52, 8
    s_add_u32 s61, s61, s54
    buffer_load_dwordx4 a[0:3], v120, s[40:43], s61 offen nt
    s_add_u32 s61, s61, 8192
    buffer_load_dwordx4 a[4:7], v120, s[40:43], s61 offen nt
    s_add_u32 s61, s61, 8192
    buffer_load_dwordx4 a[8:11], v120, s[40:43], s61 offen nt
    s_add_u32 s61, s61, 8192
    buffer_load_dwordx4 a[12:15], v120, s[40:43], s61 offen nt
    s_add_u32 s61, s61, 8192
    buffer_load_dwordx4 a[16:19], v120, s[40:43], s61 offen nt
    s_add_u32 s61, s61, 8192
    buffer_load_dwordx4 a[20:23], v120, s[40:43], s61 offen nt
    s_add_u32 s61, s61, 8192
    buffer_load_dwordx4 a[24:27], v120, s[40:43], s61 offen nt
    s_add_u32 s61, s61, 8192
    buffer_load_dwordx4 a[28:31], v120, s[40:43], s61 offen nt
    s_add_u32 s61, s61, 8192
    buffer_load_dwordx4 a[32:35], v120, s[40:43], s61 offen nt
    s_add_u32 s61, s61, 8192
    s_cmp_lg_u32 s3, 0
    s_cbranch_scc1 L_norace_27
    s_sub_u32 s84, s52, 1
    s_lshl_b32 s84, s84, 11
    s_lshl_b32 s85, s52, 12
    s_xor_b32 s84, s84, s85
    s_lshl_b32 s85, s52, 10
    s_xor_b32 s84, s84, s85
    s_and_b32 s84, s84, 0x2000
    s_lshr_b32 s85, s52, 2
    s_xor_b32 s85, s85, s52
    s_and_b32 s85, s85, 3
    s_lshl_b32 s85, s85, 25
    s_or_b32 s84, s84, s85
    s_lshl_b32 s85, s52, 20
    s_or_b32 s84, s84, s85
    s_xor_b32 s85, s84, 0x2000
    s_mov_b32 s86, -1
    s_mov_b32 s87, -1
    s_load_dword s87, s[8:9], s85 offset:0x80500
    s_load_dword s86, s[8:9], s84 offset:0x80000
    s_mov_b32 s97, 1
    s_waitcnt lgkmcnt(1)
    s_cmp_lg_u32 s87, -1
    s_subb_u32 s97, s97, 0
    s_cmp_lg_u32 s86, -1
    s_addc_u32 s97, s97, 0
    s_sub_u32 s96, 2, s97
    s_bitcmp1_b32 s52, 3
    s_cselect_b32 s97, s96, s97
    s_lshl_b32 s97, s97, 12
    s_or_b32 s97, s97, 0x1000000
L_norace_27:
    s_waitcnt vmcnt(19)
    s_barrier
    s_cmp_lg_u32 s3, 0
    s_cbranch_scc1 L_nosig_28
    s_atomic_add s97, s[28:29], 0 glc
L_nosig_28:
    buffer_load_dwordx4 a[36:39], v120, s[40:43], s61 offen nt
    s_add_u32 s61, s61, 8192
    buffer_load_dwordx4 a[40:43], v120, s[40:43], s61 offen nt
    s_add_u32 s61, s61, 8192
    buffer_load_dwordx4 a[44:47], v120, s[40:43], s61 offen nt
    s_add_u32 s61, s61, 8192
    buffer_load_dwordx4 a[48:51], v120, s[40:43], s61 offen nt
    s_add_u32 s61, s61, 8192
    buffer_load_dwordx4 a[52:55], v120, s[40:43], s61 offen nt
    s_add_u32 s61, s61, 8192
    buffer_load_dwordx4 a[56:59], v120, s[40:43], s61 offen nt
    s_add_u32 s61, s61, 8192
    buffer_load_dwordx4 a[60:63], v120, s[40:43], s61 offen nt
    s_add_u32 s61, s61, 8192
    buffer_load_dwordx4 a[64:67], v120, s[40:43], s61 offen nt
    s_add_u32 s61, s61, 8192
    buffer_load_dwordx4 a[68:71], v120, s[40:43], s61 offen nt
    s_add_u32 s61, s61, 8192
    buffer_load_dwordx4 a[72:75], v120, s[40:43], s61 offen nt
    s_add_u32 s61, s61, 8192
    buffer_load_dwordx4 a[76:79], v120, s[40:43], s61 offen nt
    s_add_u32 s61, s61, 8192
    buffer_load_dwordx4 a[80:83], v120, s[40:43], s61 offen nt
    s_add_u32 s61, s61, 8192
    buffer_load_dwordx4 a[84:87], v120, s[40:43], s61 offen nt
    s_add_u32 s61, s61, 8192
    buffer_load_dwordx4 a[88:91], v120, s[40:43], s61 offen nt
    s_add_u32 s61, s61, 8192
    buffer_load_dwordx4 a[92:95], v120, s[40:43], s61 offen nt
    s_add_u32 s61, s61, 8192
    buffer_load_dwordx4 a[96:99], v120, s[40:43], s61 offen nt
    s_add_u32 s61, s61, 8192
    buffer_load_dwordx4 a[100:103], v120, s[40:43], s61 offen nt
    s_add_u32 s61, s61, 8192
    buffer_load_dwordx4 a[104:107], v120, s[40:43], s61 offen nt
    s_add_u32 s61, s61, 8192
    buffer_load_dwordx4 a[108:111], v120, s[40:43], s61 offen nt
    s_add_u32 s61, s61, 8192
    buffer_load_dwordx4 a[112:115], v120, s[40:43], s61 offen nt
    s_add_u32 s61, s61, 8192
    buffer_load_dwordx4 a[116:119], v120, s[40:43], s61 offen nt
    s_add_u32 s61, s61, 8192
    buffer_load_dwordx4 a[120:123], v120, s[40:43], s61 offen nt
    s_add_u32 s61, s61, 8192
    buffer_load_dwordx4 a[124:127], v120, s[40:43], s61 offen nt
    s_add_u32 s61, s61, 8192
    buffer_load_dwordx4 a[128:131], v120, s[40:43], s61 offen nt
    s_add_u32 s61, s61, 8192
    buffer_load_dwordx4 a[132:135], v120, s[40:43], s61 offen nt
    s_add_u32 s61, s61, 8192
    buffer_load_dwordx4 a[136:139], v120, s[40:43], s61 offen nt
    s_add_u32 s61, s61, 8192
    buffer_load_dwordx4 a[140:143], v120, s[40:43], s61 offen nt
    s_add_u32 s61, s61, 8192
    v_and_b32 v5, 1, v3
    v_cmp_eq_u32 vcc, 1, v5
    v_mov_b32 v5, 0x0c0c0100
    v_mov_b32 v6, 0x01000c0c
    v_cndmask_b32 v5, v5, v6, vcc
    v_mov_b32 v6, 0x0c0c0302
    v_mov_b32 v7, 0x03020c0c
    v_cndmask_b32 v6, v6, v7, vcc
    v_bfe_u32 v7, v3, 1, 2
    v_mov_b32 v16, 0x0c0c0c0c
    v_cmp_eq_u32 vcc, 0, v7
    s_nop 1
    v_cndmask_b32 v8, v16, v5, vcc
    v_cndmask_b32 v9, v16, v6, vcc
    v_cmp_eq_u32 vcc, 1, v7
    s_nop 1
    v_cndmask_b32 v10, v16, v5, vcc
    v_cndmask_b32 v11, v16, v6, vcc
    v_cmp_eq_u32 vcc, 2, v7
    s_nop 1
    v_cndmask_b32 v12, v16, v5, vcc
    v_cndmask_b32 v13, v16, v6, vcc
    v_cmp_eq_u32 vcc, 3, v7
    s_nop 1
    v_cndmask_b32 v14, v16, v5, vcc
    v_cndmask_b32 v15, v16, v6, vcc
    v_lshlrev_b32 v5, 2, v4
    v_xor_b32 v5, v5, v3
    v_lshlrev_b32 v6, 10, v4
    v_xor_b32 v7, 0, v5
    v_lshl_add_u32 v20, v7, 4, v6
    v_xor_b32 v7, 1, v5
    v_lshl_add_u32 v21, v7, 4, v6
    v_add_u32 v21, 4096, v21
    v_xor_b32 v7, 2, v5
    v_lshl_add_u32 v22, v7, 4, v6
    v_add_u32 v22, 8192, v22
    v_xor_b32 v7, 3, v5
    v_lshl_add_u32 v23, v7, 4, v6
    v_add_u32 v23, 12288, v23
    s_lshl_b32 s58, s53, 19
    s_lshl_b32 s54, s3, 8
    s_add_u32 s58, s58, s54
    s_lshl_b32 s63, s3, 15
    s_mov_b32 s59, s63
    s_add_u32 m0, s59, 0
    s_add_u32 s54, s58, 0
    buffer_load_dwordx4 v20, s[32:35], s54 offen nt lds
    s_add_u32 m0, s59, 1024
    s_add_u32 s54, s58, 0
    buffer_load_dwordx4 v21, s[32:35], s54 offen nt lds
    s_add_u32 m0, s59, 2048
    s_add_u32 s54, s58, 0
    buffer_load_dwordx4 v22, s[32:35], s54 offen nt lds
    s_add_u32 m0, s59, 3072
    s_add_u32 s54, s58, 0
    buffer_load_dwordx4 v23, s[32:35], s54 offen nt lds
    s_add_u32 m0, s59, 4096
    s_add_u32 s54, s58, 16384
    buffer_load_dwordx4 v20, s[32:35], s54 offen nt lds
    s_add_u32 m0, s59, 5120
    s_add_u32 s54, s58, 16384
    buffer_load_dwordx4 v21, s[32:35], s54 offen nt lds
    s_add_u32 m0, s59, 6144
    s_add_u32 s54, s58, 16384
    buffer_load_dwordx4 v22, s[32:35], s54 offen nt lds
    s_add_u32 m0, s59, 7168
    s_add_u32 s54, s58, 16384
    buffer_load_dwordx4 v23, s[32:35], s54 offen nt lds
    s_add_u32 s58, s58, 32768
    s_add_u32 s59, s59, 8192
    s_waitcnt vmcnt(35)
    v_perm_b32 v96, v48, v48, v8
    v_perm_b32 v97, v48, v48, v10
    v_perm_b32 v98, v48, v48, v12
    v_perm_b32 v99, v48, v48, v14
    s_nop 1
    v_mfma_f32_16x16x32_bf16 v[112:115], v[96:99], a[0:3], 0
    v_perm_b32 v100, v68, v68, v8
    v_perm_b32 v101, v68, v68, v10
    v_perm_b32 v102, v68, v68, v12
    v_perm_b32 v103, v68, v68, v14
    s_nop 1
    v_mfma_f32_16x16x32_bf16 v[116:119], v[100:103], a[0:3], 0
    v_perm_b32 v104, v48, v48, v9
    v_perm_b32 v105, v48, v48, v11
    v_perm_b32 v106, v48, v48, v13
    v_perm_b32 v107, v48, v48, v15
    s_nop 1
    v_mfma_f32_16x16x32_bf16 v[112:115], v[104:107], a[4:7], v[112:115]
    v_perm_b32 v108, v68, v68, v9
    v_perm_b32 v109, v68, v68, v11
    v_perm_b32 v110, v68, v68, v13
    v_perm_b32 v111, v68, v68, v15
    s_nop 1
    v_mfma_f32_16x16x32_bf16 v[116:119], v[108:111], a[4:7], v[116:119]
    v_perm_b32 v96, v49, v49, v8
    v_perm_b32 v97, v49, v49, v10
    v_perm_b32 v98, v49, v49, v12
    v_perm_b32 v99, v49, v49, v14
    s_nop 1
    v_mfma_f32_16x16x32_bf16 v[112:115], v[96:99], a[8:11], v[112:115]
    v_perm_b32 v100, v69, v69, v8
    v_perm_b32 v101, v69, v69, v10
    v_perm_b32 v102, v69, v69, v12
    v_perm_b32 v103, v69, v69, v14
    s_nop 1
    v_mfma_f32_16x16x32_bf16 v[116:119], v[100:103], a[8:11], v[116:119]
    v_perm_b32 v104, v49, v49, v9
    v_perm_b32 v105, v49, v49, v11
    v_perm_b32 v106, v49, v49, v13
    v_perm_b32 v107, v49, v49, v15
    s_nop 1
    v_mfma_f32_16x16x32_bf16 v[112:115], v[104:107], a[12:15], v[112:115]
    v_perm_b32 v108, v69, v69, v9
    v_perm_b32 v109, v69, v69, v11
    v_perm_b32 v110, v69, v69, v13
    v_perm_b32 v111, v69, v69, v15
    s_nop 1
    v_mfma_f32_16x16x32_bf16 v[116:119], v[108:111], a[12:15], v[116:119]
    v_perm_b32 v96, v50, v50, v8
    v_perm_b32 v97, v50, v50, v10
    v_perm_b32 v98, v50, v50, v12
    v_perm_b32 v99, v50, v50, v14
    s_nop 1
    v_mfma_f32_16x16x32_bf16 v[112:115], v[96:99], a[16:19], v[112:115]
    v_perm_b32 v100, v70, v70, v8
    v_perm_b32 v101, v70, v70, v10
    v_perm_b32 v102, v70, v70, v12
    v_perm_b32 v103, v70, v70, v14
    s_nop 1
    v_mfma_f32_16x16x32_bf16 v[116:119], v[100:103], a[16:19], v[116:119]
    v_perm_b32 v104, v50, v50, v9
    v_perm_b32 v105, v50, v50, v11
    v_perm_b32 v106, v50, v50, v13
    v_perm_b32 v107, v50, v50, v15
    s_nop 1
    v_mfma_f32_16x16x32_bf16 v[112:115], v[104:107], a[20:23], v[112:115]
    v_perm_b32 v108, v70, v70, v9
    v_perm_b32 v109, v70, v70, v11
    v_perm_b32 v110, v70, v70, v13
    v_perm_b32 v111, v70, v70, v15
    s_nop 1
    v_mfma_f32_16x16x32_bf16 v[116:119], v[108:111], a[20:23], v[116:119]
    v_perm_b32 v96, v51, v51, v8
    v_perm_b32 v97, v51, v51, v10
    v_perm_b32 v98, v51, v51, v12
    v_perm_b32 v99, v51, v51, v14
    s_nop 1
    v_mfma_f32_16x16x32_bf16 v[112:115], v[96:99], a[24:27], v[112:115]
    v_perm_b32 v100, v71, v71, v8
    v_perm_b32 v101, v71, v71, v10
    v_perm_b32 v102, v71, v71, v12
    v_perm_b32 v103, v71, v71, v14
    s_nop 1
    v_mfma_f32_16x16x32_bf16 v[116:119], v[100:103], a[24:27], v[116:119]
    v_perm_b32 v104, v51, v51, v9
    v_perm_b32 v105, v51, v51, v11
    v_perm_b32 v106, v51, v51, v13
    v_perm_b32 v107, v51, v51, v15
    s_nop 1
    v_mfma_f32_16x16x32_bf16 v[112:115], v[104:107], a[28:31], v[112:115]
    v_perm_b32 v108, v71, v71, v9
    v_perm_b32 v109, v71, v71, v11
    v_perm_b32 v110, v71, v71, v13
    v_perm_b32 v111, v71, v71, v15
    s_nop 1
    v_mfma_f32_16x16x32_bf16 v[116:119], v[108:111], a[28:31], v[116:119]
    v_perm_b32 v96, v52, v52, v8
    v_perm_b32 v97, v52, v52, v10
    v_perm_b32 v98, v52, v52, v12
    v_perm_b32 v99, v52, v52, v14
    s_nop 1
    v_mfma_f32_16x16x32_bf16 v[112:115], v[96:99], a[32:35], v[112:115]
    v_perm_b32 v100, v72, v72, v8
    v_perm_b32 v101, v72, v72, v10
    v_perm_b32 v102, v72, v72, v12
    v_perm_b32 v103, v72, v72, v14
    s_nop 1
    v_mfma_f32_16x16x32_bf16 v[116:119], v[100:103], a[32:35], v[116:119]
    s_waitcnt vmcnt(26)
    v_perm_b32 v104, v52, v52, v9
    v_perm_b32 v105, v52, v52, v11
    v_perm_b32 v106, v52, v52, v13
    v_perm_b32 v107, v52, v52, v15
    s_nop 1
    v_mfma_f32_16x16x32_bf16 v[112:115], v[104:107], a[36:39], v[112:115]
    v_perm_b32 v108, v72, v72, v9
    v_perm_b32 v109, v72, v72, v11
    v_perm_b32 v110, v72, v72, v13
    v_perm_b32 v111, v72, v72, v15
    s_nop 1
    v_mfma_f32_16x16x32_bf16 v[116:119], v[108:111], a[36:39], v[116:119]
    v_perm_b32 v96, v53, v53, v8
    v_perm_b32 v97, v53, v53, v10
    v_perm_b32 v98, v53, v53, v12
    v_perm_b32 v99, v53, v53, v14
    s_nop 1
    v_mfma_f32_16x16x32_bf16 v[112:115], v[96:99], a[40:43], v[112:115]
    v_perm_b32 v100, v73, v73, v8
    v_perm_b32 v101, v73, v73, v10
    v_perm_b32 v102, v73, v73, v12
    v_perm_b32 v103, v73, v73, v14
    s_nop 1
    v_mfma_f32_16x16x32_bf16 v[116:119], v[100:103], a[40:43], v[116:119]
    v_perm_b32 v104, v53, v53, v9
    v_perm_b32 v105, v53, v53, v11
    v_perm_b32 v106, v53, v53, v13
    v_perm_b32 v107, v53, v53, v15
    s_nop 1
    v_mfma_f32_16x16x32_bf16 v[112:115], v[104:107], a[44:47], v[112:115]
    v_perm_b32 v108, v73, v73, v9
    v_perm_b32 v109, v73, v73, v11
    v_perm_b32 v110, v73, v73, v13
    v_perm_b32 v111, v73, v73, v15
    s_nop 1
    v_mfma_f32_16x16x32_bf16 v[116:119], v[108:111], a[44:47], v[116:119]
    v_perm_b32 v96, v54, v54, v8
    v_perm_b32 v97, v54, v54, v10
    v_perm_b32 v98, v54, v54, v12
    v_perm_b32 v99, v54, v54, v14
    s_nop 1
    v_mfma_f32_16x16x32_bf16 v[112:115], v[96:99], a[48:51], v[112:115]
    v_perm_b32 v100, v74, v74, v8
    v_perm_b32 v101, v74, v74, v10
    v_perm_b32 v102, v74, v74, v12
    v_perm_b32 v103, v74, v74, v14
    s_nop 1
    v_mfma_f32_16x16x32_bf16 v[116:119], v[100:103], a[48:51], v[116:119]
    v_perm_b32 v104, v54, v54, v9
    v_perm_b32 v105, v54, v54, v11
    v_perm_b32 v106, v54, v54, v13
    v_perm_b32 v107, v54, v54, v15
    s_nop 1
    v_mfma_f32_16x16x32_bf16 v[112:115], v[104:107], a[52:55], v[112:115]
    v_perm_b32 v108, v74, v74, v9
    v_perm_b32 v109, v74, v74, v11
    v_perm_b32 v110, v74, v74, v13
    v_perm_b32 v111, v74, v74, v15
    s_nop 1
    v_mfma_f32_16x16x32_bf16 v[116:119], v[108:111], a[52:55], v[116:119]
    v_perm_b32 v96, v55, v55, v8
    v_perm_b32 v97, v55, v55, v10
    v_perm_b32 v98, v55, v55, v12
    v_perm_b32 v99, v55, v55, v14
    s_nop 1
    v_mfma_f32_16x16x32_bf16 v[112:115], v[96:99], a[56:59], v[112:115]
    v_perm_b32 v100, v75, v75, v8
    v_perm_b32 v101, v75, v75, v10
    v_perm_b32 v102, v75, v75, v12
    v_perm_b32 v103, v75, v75, v14
    s_nop 1
    v_mfma_f32_16x16x32_bf16 v[116:119], v[100:103], a[56:59], v[116:119]
    v_perm_b32 v104, v55, v55, v9
    v_perm_b32 v105, v55, v55, v11
    v_perm_b32 v106, v55, v55, v13
    v_perm_b32 v107, v55, v55, v15
    s_nop 1
    v_mfma_f32_16x16x32_bf16 v[112:115], v[104:107], a[60:63], v[112:115]
    v_perm_b32 v108, v75, v75, v9
    v_perm_b32 v109, v75, v75, v11
    v_perm_b32 v110, v75, v75, v13
    v_perm_b32 v111, v75, v75, v15
    s_nop 1
    v_mfma_f32_16x16x32_bf16 v[116:119], v[108:111], a[60:63], v[116:119]
    v_perm_b32 v96, v56, v56, v8
    v_perm_b32 v97, v56, v56, v10
    v_perm_b32 v98, v56, v56, v12
    v_perm_b32 v99, v56, v56, v14
    s_nop 1
    v_mfma_f32_16x16x32_bf16 v[112:115], v[96:99], a[64:67], v[112:115]
    v_perm_b32 v100, v76, v76, v8
    v_perm_b32 v101, v76, v76, v10
    v_perm_b32 v102, v76, v76, v12
    v_perm_b32 v103, v76, v76, v14
    s_nop 1
    v_mfma_f32_16x16x32_bf16 v[116:119], v[100:103], a[64:67], v[116:119]
    v_perm_b32 v104, v56, v56, v9
    v_perm_b32 v105, v56, v56, v11
    v_perm_b32 v106, v56, v56, v13
    v_perm_b32 v107, v56, v56, v15
    s_nop 1
    v_mfma_f32_16x16x32_bf16 v[112:115], v[104:107], a[68:71], v[112:115]
    v_perm_b32 v108, v76, v76, v9
    v_perm_b32 v109, v76, v76, v11
    v_perm_b32 v110, v76, v76, v13
    v_perm_b32 v111, v76, v76, v15
    s_nop 1
    v_mfma_f32_16x16x32_bf16 v[116:119], v[108:111], a[68:71], v[116:119]
    s_waitcnt vmcnt(17)
    v_perm_b32 v96, v57, v57, v8
    v_perm_b32 v97, v57, v57, v10
    v_perm_b32 v98, v57, v57, v12
    v_perm_b32 v99, v57, v57, v14
    s_nop 1
    v_mfma_f32_16x16x32_bf16 v[112:115], v[96:99], a[72:75], v[112:115]
    v_perm_b32 v100, v77, v77, v8
    v_perm_b32 v101, v77, v77, v10
    v_perm_b32 v102, v77, v77, v12
    v_perm_b32 v103, v77, v77, v14
    s_nop 1
    v_mfma_f32_16x16x32_bf16 v[116:119], v[100:103], a[72:75], v[116:119]
    v_perm_b32 v104, v57, v57, v9
    v_perm_b32 v105, v57, v57, v11
    v_perm_b32 v106, v57, v57, v13
    v_perm_b32 v107, v57, v57, v15
    s_nop 1
    v_mfma_f32_16x16x32_bf16 v[112:115], v[104:107], a[76:79], v[112:115]
    v_perm_b32 v108, v77, v77, v9
    v_perm_b32 v109, v77, v77, v11
    v_perm_b32 v110, v77, v77, v13
    v_perm_b32 v111, v77, v77, v15
    s_nop 1
    v_mfma_f32_16x16x32_bf16 v[116:119], v[108:111], a[76:79], v[116:119]
    v_perm_b32 v96, v58, v58, v8
    v_perm_b32 v97, v58, v58, v10
    v_perm_b32 v98, v58, v58, v12
    v_perm_b32 v99, v58, v58, v14
    s_nop 1
    v_mfma_f32_16x16x32_bf16 v[112:115], v[96:99], a[80:83], v[112:115]
    v_perm_b32 v100, v78, v78, v8
    v_perm_b32 v101, v78, v78, v10
    v_perm_b32 v102, v78, v78, v12
    v_perm_b32 v103, v78, v78, v14
    s_nop 1
    v_mfma_f32_16x16x32_bf16 v[116:119], v[100:103], a[80:83], v[116:119]
    v_perm_b32 v104, v58, v58, v9
    v_perm_b32 v105, v58, v58, v11
    v_perm_b32 v106, v58, v58, v13
    v_perm_b32 v107, v58, v58, v15
    s_nop 1
    v_mfma_f32_16x16x32_bf16 v[112:115], v[104:107], a[84:87], v[112:115]
    v_perm_b32 v108, v78, v78, v9
    v_perm_b32 v109, v78, v78, v11
    v_perm_b32 v110, v78, v78, v13
    v_perm_b32 v111, v78, v78, v15
    s_nop 1
    v_mfma_f32_16x16x32_bf16 v[116:119], v[108:111], a[84:87], v[116:119]
    v_perm_b32 v96, v59, v59, v8
    v_perm_b32 v97, v59, v59, v10
    v_perm_b32 v98, v59, v59, v12
    v_perm_b32 v99, v59, v59, v14
    s_nop 1
    v_mfma_f32_16x16x32_bf16 v[112:115], v[96:99], a[88:91], v[112:115]
    v_perm_b32 v100, v79, v79, v8
    v_perm_b32 v101, v79, v79, v10
    v_perm_b32 v102, v79, v79, v12
    v_perm_b32 v103, v79, v79, v14
    s_nop 1
    v_mfma_f32_16x16x32_bf16 v[116:119], v[100:103], a[88:91], v[116:119]
    v_perm_b32 v104, v59, v59, v9
    v_perm_b32 v105, v59, v59, v11
    v_perm_b32 v106, v59, v59, v13
    v_perm_b32 v107, v59, v59, v15
    s_nop 1
    v_mfma_f32_16x16x32_bf16 v[112:115], v[104:107], a[92:95], v[112:115]
    v_perm_b32 v108, v79, v79, v9
    v_perm_b32 v109, v79, v79, v11
    v_perm_b32 v110, v79, v79, v13
    v_perm_b32 v111, v79, v79, v15
    s_nop 1
    v_mfma_f32_16x16x32_bf16 v[116:119], v[108:111], a[92:95], v[116:119]
    v_perm_b32 v96, v60, v60, v8
    v_perm_b32 v97, v60, v60, v10
    v_perm_b32 v98, v60, v60, v12
    v_perm_b32 v99, v60, v60, v14
    s_nop 1
    v_mfma_f32_16x16x32_bf16 v[112:115], v[96:99], a[96:99], v[112:115]
    v_perm_b32 v100, v80, v80, v8
    v_perm_b32 v101, v80, v80, v10
    v_perm_b32 v102, v80, v80, v12
    v_perm_b32 v103, v80, v80, v14
    s_nop 1
    v_mfma_f32_16x16x32_bf16 v[116:119], v[100:103], a[96:99], v[116:119]
    v_perm_b32 v104, v60, v60, v9
    v_perm_b32 v105, v60, v60, v11
    v_perm_b32 v106, v60, v60, v13
    v_perm_b32 v107, v60, v60, v15
    s_nop 1
    v_mfma_f32_16x16x32_bf16 v[112:115], v[104:107], a[100:103], v[112:115]
    v_perm_b32 v108, v80, v80, v9
    v_perm_b32 v109, v80, v80, v11
    v_perm_b32 v110, v80, v80, v13
    v_perm_b32 v111, v80, v80, v15
    s_nop 1
    v_mfma_f32_16x16x32_bf16 v[116:119], v[108:111], a[100:103], v[116:119]
    v_perm_b32 v96, v61, v61, v8
    v_perm_b32 v97, v61, v61, v10
    v_perm_b32 v98, v61, v61, v12
    v_perm_b32 v99, v61, v61, v14
    s_nop 1
    v_mfma_f32_16x16x32_bf16 v[112:115], v[96:99], a[104:107], v[112:115]
    v_perm_b32 v100, v81, v81, v8
    v_perm_b32 v101, v81, v81, v10
    v_perm_b32 v102, v81, v81, v12
    v_perm_b32 v103, v81, v81, v14
    s_nop 1
    v_mfma_f32_16x16x32_bf16 v[116:119], v[100:103], a[104:107], v[116:119]
    s_waitcnt vmcnt(8)
    v_perm_b32 v104, v61, v61, v9
    v_perm_b32 v105, v61, v61, v11
    v_perm_b32 v106, v61, v61, v13
    v_perm_b32 v107, v61, v61, v15
    s_nop 1
    v_mfma_f32_16x16x32_bf16 v[112:115], v[104:107], a[108:111], v[112:115]
    v_perm_b32 v108, v81, v81, v9
    v_perm_b32 v109, v81, v81, v11
    v_perm_b32 v110, v81, v81, v13
    v_perm_b32 v111, v81, v81, v15
    s_nop 1
    v_mfma_f32_16x16x32_bf16 v[116:119], v[108:111], a[108:111], v[116:119]
    v_perm_b32 v96, v62, v62, v8
    v_perm_b32 v97, v62, v62, v10
    v_perm_b32 v98, v62, v62, v12
    v_perm_b32 v99, v62, v62, v14
    s_nop 1
    v_mfma_f32_16x16x32_bf16 v[112:115], v[96:99], a[112:115], v[112:115]
    v_perm_b32 v100, v82, v82, v8
    v_perm_b32 v101, v82, v82, v10
    v_perm_b32 v102, v82, v82, v12
    v_perm_b32 v103, v82, v82, v14
    s_nop 1
    v_mfma_f32_16x16x32_bf16 v[116:119], v[100:103], a[112:115], v[116:119]
    v_perm_b32 v104, v62, v62, v9
    v_perm_b32 v105, v62, v62, v11
    v_perm_b32 v106, v62, v62, v13
    v_perm_b32 v107, v62, v62, v15
    s_nop 1
    v_mfma_f32_16x16x32_bf16 v[112:115], v[104:107], a[116:119], v[112:115]
    v_perm_b32 v108, v82, v82, v9
    v_perm_b32 v109, v82, v82, v11
    v_perm_b32 v110, v82, v82, v13
    v_perm_b32 v111, v82, v82, v15
    s_nop 1
    v_mfma_f32_16x16x32_bf16 v[116:119], v[108:111], a[116:119], v[116:119]
    v_perm_b32 v96, v63, v63, v8
    v_perm_b32 v97, v63, v63, v10
    v_perm_b32 v98, v63, v63, v12
    v_perm_b32 v99, v63, v63, v14
    s_nop 1
    v_mfma_f32_16x16x32_bf16 v[112:115], v[96:99], a[120:123], v[112:115]
    v_perm_b32 v100, v83, v83, v8
    v_perm_b32 v101, v83, v83, v10
    v_perm_b32 v102, v83, v83, v12
    v_perm_b32 v103, v83, v83, v14
    s_nop 1
    v_mfma_f32_16x16x32_bf16 v[116:119], v[100:103], a[120:123], v[116:119]
    v_perm_b32 v104, v63, v63, v9
    v_perm_b32 v105, v63, v63, v11
    v_perm_b32 v106, v63, v63, v13
    v_perm_b32 v107, v63, v63, v15
    s_nop 1
    v_mfma_f32_16x16x32_bf16 v[112:115], v[104:107], a[124:127], v[112:115]
    v_perm_b32 v108, v83, v83, v9
    v_perm_b32 v109, v83, v83, v11
    v_perm_b32 v110, v83, v83, v13
    v_perm_b32 v111, v83, v83, v15
    s_nop 1
    v_mfma_f32_16x16x32_bf16 v[116:119], v[108:111], a[124:127], v[116:119]
    v_perm_b32 v96, v64, v64, v8
    v_perm_b32 v97, v64, v64, v10
    v_perm_b32 v98, v64, v64, v12
    v_perm_b32 v99, v64, v64, v14
    s_nop 1
    v_mfma_f32_16x16x32_bf16 v[112:115], v[96:99], a[128:131], v[112:115]
    v_perm_b32 v100, v84, v84, v8
    v_perm_b32 v101, v84, v84, v10
    v_perm_b32 v102, v84, v84, v12
    v_perm_b32 v103, v84, v84, v14
    s_nop 1
    v_mfma_f32_16x16x32_bf16 v[116:119], v[100:103], a[128:131], v[116:119]
    v_perm_b32 v104, v64, v64, v9
    v_perm_b32 v105, v64, v64, v11
    v_perm_b32 v106, v64, v64, v13
    v_perm_b32 v107, v64, v64, v15
    s_nop 1
    v_mfma_f32_16x16x32_bf16 v[112:115], v[104:107], a[132:135], v[112:115]
    v_perm_b32 v108, v84, v84, v9
    v_perm_b32 v109, v84, v84, v11
    v_perm_b32 v110, v84, v84, v13
    v_perm_b32 v111, v84, v84, v15
    s_nop 1
    v_mfma_f32_16x16x32_bf16 v[116:119], v[108:111], a[132:135], v[116:119]
    v_perm_b32 v96, v65, v65, v8
    v_perm_b32 v97, v65, v65, v10
    v_perm_b32 v98, v65, v65, v12
    v_perm_b32 v99, v65, v65, v14
    s_nop 1
    v_mfma_f32_16x16x32_bf16 v[112:115], v[96:99], a[136:139], v[112:115]
    v_perm_b32 v100, v85, v85, v8
    v_perm_b32 v101, v85, v85, v10
    v_perm_b32 v102, v85, v85, v12
    v_perm_b32 v103, v85, v85, v14
    s_nop 1
    v_mfma_f32_16x16x32_bf16 v[116:119], v[100:103], a[136:139], v[116:119]
    v_perm_b32 v104, v65, v65, v9
    v_perm_b32 v105, v65, v65, v11
    v_perm_b32 v106, v65, v65, v13
    v_perm_b32 v107, v65, v65, v15
    s_nop 1
    v_mfma_f32_16x16x32_bf16 v[112:115], v[104:107], a[140:143], v[112:115]
    v_perm_b32 v108, v85, v85, v9
    v_perm_b32 v109, v85, v85, v11
    v_perm_b32 v110, v85, v85, v13
    v_perm_b32 v111, v85, v85, v15
    s_nop 1
    v_mfma_f32_16x16x32_bf16 v[116:119], v[108:111], a[140:143], v[116:119]
    v_lshrrev_b32 v5, 1, v4
    v_lshlrev_b32 v5, 9, v5
    v_lshl_add_u32 v5, v3, 5, v5
    v_and_b32 v6, 1, v4
    v_lshl_add_u32 v5, v6, 4, v5
    s_lshl_b32 s54, s3, 11
    s_add_u32 s54, s54, 139264
    v_add_u32 v5, s54, v5
    ds_write_b128 v5, v[112:115]
    ds_write_b128 v5, v[116:119] offset:1024
    s_waitcnt lgkmcnt(0)
    s_barrier
    s_lshl_b32 s54, s3, 9
    s_add_u32 s54, s54, 139264
    v_lshl_add_u32 v5, v3, 5, s54
    ds_read_b128 v[48:51], v5 offset:0
    ds_read_b128 v[52:55], v5 offset:16
    ds_read_b128 v[56:59], v5 offset:2048
    ds_read_b128 v[60:63], v5 offset:2064
    ds_read_b128 v[64:67], v5 offset:4096
    ds_read_b128 v[68:71], v5 offset:4112
    ds_read_b128 v[72:75], v5 offset:6144
    ds_read_b128 v[76:79], v5 offset:6160
    s_waitcnt lgkmcnt(0)
    v_add_f32 v48, v48, v56
    v_add_f32 v64, v64, v72
    v_add_f32 v49, v49, v57
    v_add_f32 v65, v65, v73
    v_add_f32 v50, v50, v58
    v_add_f32 v66, v66, v74
    v_add_f32 v51, v51, v59
    v_add_f32 v67, v67, v75
    v_add_f32 v52, v52, v60
    v_add_f32 v68, v68, v76
    v_add_f32 v53, v53, v61
    v_add_f32 v69, v69, v77
    v_add_f32 v54, v54, v62
    v_add_f32 v70, v70, v78
    v_add_f32 v55, v55, v63
    v_add_f32 v71, v71, v79
    v_add_f32 v48, v48, v64
    v_add_f32 v49, v49, v65
    v_add_f32 v50, v50, v66
    v_add_f32 v51, v51, v67
    v_add_f32 v52, v52, v68
    v_add_f32 v53, v53, v69
    v_add_f32 v54, v54, v70
    v_add_f32 v55, v55, v71
    v_cvt_pk_bf16_f32 v124, v48, v49
    v_cvt_pk_bf16_f32 v125, v50, v51
    v_cvt_pk_bf16_f32 v126, v52, v53
    v_cvt_pk_bf16_f32 v127, v54, v55
    v_min_u32 v124, -2, v124
    v_min_u32 v125, -2, v125
    v_min_u32 v126, -2, v126
    v_min_u32 v127, -2, v127
    buffer_store_dwordx4 v[124:127], v123, s[44:47], s98 offen sc1
    s_add_u32 m0, s59, 0
    s_add_u32 s54, s58, 0
    buffer_load_dwordx4 v20, s[32:35], s54 offen nt lds
    s_add_u32 m0, s59, 1024
    s_add_u32 s54, s58, 0
    buffer_load_dwordx4 v21, s[32:35], s54 offen nt lds
    s_add_u32 m0, s59, 2048
    s_add_u32 s54, s58, 0
    buffer_load_dwordx4 v22, s[32:35], s54 offen nt lds
    s_add_u32 m0, s59, 3072
    s_add_u32 s54, s58, 0
    buffer_load_dwordx4 v23, s[32:35], s54 offen nt lds
    s_add_u32 m0, s59, 4096
    s_add_u32 s54, s58, 16384
    buffer_load_dwordx4 v20, s[32:35], s54 offen nt lds
    s_add_u32 m0, s59, 5120
    s_add_u32 s54, s58, 16384
    buffer_load_dwordx4 v21, s[32:35], s54 offen nt lds
    s_add_u32 m0, s59, 6144
    s_add_u32 s54, s58, 16384
    buffer_load_dwordx4 v22, s[32:35], s54 offen nt lds
    s_add_u32 m0, s59, 7168
    s_add_u32 s54, s58, 16384
    buffer_load_dwordx4 v23, s[32:35], s54 offen nt lds
    s_add_u32 s58, s58, 32768
    s_add_u32 s59, s59, 8192
    s_add_u32 m0, s59, 0
    s_add_u32 s54, s58, 0
    buffer_load_dwordx4 v20, s[32:35], s54 offen nt lds
    s_add_u32 m0, s59, 1024
    s_add_u32 s54, s58, 0
    buffer_load_dwordx4 v21, s[32:35], s54 offen nt lds
    s_add_u32 m0, s59, 2048
    s_add_u32 s54, s58, 0
    buffer_load_dwordx4 v22, s[32:35], s54 offen nt lds
    s_add_u32 m0, s59, 3072
    s_add_u32 s54, s58, 0
    buffer_load_dwordx4 v23, s[32:35], s54 offen nt lds
    s_add_u32 m0, s59, 4096
    s_add_u32 s54, s58, 16384
    buffer_load_dwordx4 v20, s[32:35], s54 offen nt lds
    s_add_u32 m0, s59, 5120
    s_add_u32 s54, s58, 16384
    buffer_load_dwordx4 v21, s[32:35], s54 offen nt lds
    s_add_u32 m0, s59, 6144
    s_add_u32 s54, s58, 16384
    buffer_load_dwordx4 v22, s[32:35], s54 offen nt lds
    s_add_u32 m0, s59, 7168
    s_add_u32 s54, s58, 16384
    buffer_load_dwordx4 v23, s[32:35], s54 offen nt lds
    s_add_u32 s58, s58, 32768
    s_add_u32 s59, s59, 8192
    s_add_u32 m0, s59, 0
    s_add_u32 s54, s58, 0
    buffer_load_dwordx4 v20, s[32:35], s54 offen nt lds
    s_add_u32 m0, s59, 1024
    s_add_u32 s54, s58, 0
    buffer_load_dwordx4 v21, s[32:35], s54 offen nt lds
    s_add_u32 m0, s59, 2048
    s_add_u32 s54, s58, 0
    buffer_load_dwordx4 v22, s[32:35], s54 offen nt lds
    s_add_u32 m0, s59, 3072
    s_add_u32 s54, s58, 0
    buffer_load_dwordx4 v23, s[32:35], s54 offen nt lds
    s_add_u32 m0, s59, 4096
    s_add_u32 s54, s58, 16384
    buffer_load_dwordx4 v20, s[32:35], s54 offen nt lds
    s_add_u32 m0, s59, 5120
    s_add_u32 s54, s58, 16384
    buffer_load_dwordx4 v21, s[32:35], s54 offen nt lds
    s_add_u32 m0, s59, 6144
    s_add_u32 s54, s58, 16384
    buffer_load_dwordx4 v22, s[32:35], s54 offen nt lds
    s_add_u32 m0, s59, 7168
    s_add_u32 s54, s58, 16384
    buffer_load_dwordx4 v23, s[32:35], s54 offen nt lds
    s_add_u32 s58, s58, 32768
    s_add_u32 s59, s59, 8192
    s_waitcnt vmcnt(40)
    v_mov_b32 v27, 0
    global_load_dword v18, v27, s[28:29] sc1
    buffer_load_dwordx4 a[96:99], v20, s[32:35], s58 offen nt
    buffer_load_dwordx4 a[100:103], v21, s[32:35], s58 offen nt
    buffer_load_dwordx4 a[104:107], v22, s[32:35], s58 offen nt
    buffer_load_dwordx4 a[108:111], v23, s[32:35], s58 offen nt
    s_add_u32 s58, s58, 16384
    buffer_load_dwordx4 a[112:115], v20, s[32:35], s58 offen nt
    buffer_load_dwordx4 a[116:119], v21, s[32:35], s58 offen nt
    buffer_load_dwordx4 a[120:123], v22, s[32:35], s58 offen nt
    buffer_load_dwordx4 a[124:127], v23, s[32:35], s58 offen nt
    s_add_u32 s58, s58, 16384
    s_waitcnt vmcnt(40)
    buffer_load_dwordx4 a[128:131], v20, s[32:35], s58 offen nt
    buffer_load_dwordx4 a[132:135], v21, s[32:35], s58 offen nt
    buffer_load_dwordx4 a[136:139], v22, s[32:35], s58 offen nt
    buffer_load_dwordx4 a[140:143], v23, s[32:35], s58 offen nt
    s_add_u32 s58, s58, 16384
    buffer_load_dwordx4 a[144:147], v20, s[32:35], s58 offen nt
    buffer_load_dwordx4 a[148:151], v21, s[32:35], s58 offen nt
    buffer_load_dwordx4 a[152:155], v22, s[32:35], s58 offen nt
    buffer_load_dwordx4 a[156:159], v23, s[32:35], s58 offen nt
    s_add_u32 s58, s58, 16384
    s_mov_b32 s36, s12
    s_mov_b32 s37, s13
    s_mov_b32 s38, 4718592
    s_mov_b32 s39, 0x20000
    v_mul_u32_u24 v49, 9216, v4
    v_lshl_add_u32 v48, v3, 4, v49
    v_lshl_add_u32 v49, v3, 2, v49
    s_mul_i32 s100, s52, 147456
    s_lshl_b32 s54, s3, 8
    s_add_u32 s99, s100, s54
    s_and_b32 s54, s3, 1
    s_lshl_b32 s54, s54, 6
    s_add_u32 s100, s100, s54
    s_add_u32 s100, s100, 1024
    v_add_u32 v26, s63, v2
    v_and_b32 v24, 31, v1
    v_lshrrev_b32 v25, 5, v1
    v_lshlrev_b32 v19, 10, v24
    v_lshl_add_u32 v19, v25, 4, v19
    s_lshr_b32 s96, s53, 3
    s_lshl_b32 s96, s96, 15
    s_lshl_b32 s55, s3, 8
    s_add_u32 s96, s96, s55
    s_add_u32 s96, s96, 1048576
    v_and_b32 v5, 3, v24
    v_lshlrev_b32 v5, 2, v5
    v_bfe_u32 v6, v24, 2, 2
    v_or_b32 v5, v5, v6
    v_xor_b32 v5, v5, v25
    v_lshlrev_b32 v32, 8, v24
    v_lshl_add_u32 v32, v5, 4, v32
    v_add_u32 v32, s63, v32
    v_bfe_u32 v5, v1, 2, 2
    v_lshl_add_u32 v6, v25, 2, v5
    v_lshlrev_b32 v40, 8, v6
    v_and_b32 v6, 1, v1
    v_lshl_add_u32 v40, v6, 3, v40
    v_bfe_u32 v6, v1, 4, 1
    v_lshlrev_b32 v6, 1, v6
    v_bfe_u32 v7, v1, 1, 1
    v_or_b32 v6, v6, v7
    v_xor_b32 v6, v6, v25
    v_lshl_or_b32 v6, v5, 2, v6
    v_lshl_add_u32 v40, v6, 4, v40
    v_add_u32 v40, s63, v40
    v_xor_b32 v33, 32, v32
    v_xor_b32 v41, 32, v40
    v_xor_b32 v34, 64, v32
    v_xor_b32 v42, 64, v40
    v_xor_b32 v35, 96, v32
    v_xor_b32 v43, 96, v40
    v_xor_b32 v36, 128, v32
    v_xor_b32 v44, 128, v40
    v_xor_b32 v37, 160, v32
    v_xor_b32 v45, 160, v40
    v_xor_b32 v38, 192, v32
    v_xor_b32 v46, 192, v40
    v_xor_b32 v39, 224, v32
    v_xor_b32 v47, 224, v40
    s_lshl_b32 s54, s3, 12
    s_add_u32 s54, s54, 131072
    v_add_u32 v28, s54, v2
    v_xor_b32 v29, 4096, v28
    v_xor_b32 v30, 8192, v28
    v_xor_b32 v31, 12288, v28
    v_lshlrev_b32 v192, 10, v4
    v_lshl_add_u32 v192, v3, 4, v192
    v_add_u32 v193, 4096, v192
    v_add_u32 v194, 8192, v192
    v_add_u32 v195, 12288, v192
    v_add_u32 v196, 16384, v192
    v_add_u32 v197, 20480, v192
    v_add_u32 v198, 24576, v192
    v_add_u32 v199, 28672, v192
    v_xor_b32 v5, v3, v4
    v_lshlrev_b32 v200, 8, v4
    v_lshl_add_u32 v200, v5, 4, v200
    v_add_u32 v200, s54, v200
    v_xor_b32 v201, 64, v200
    v_xor_b32 v202, 128, v200
    v_xor_b32 v203, 192, v200
    v_xor_b32 v5, v3, v25
    v_lshlrev_b32 v204, 8, v3
    v_lshl_add_u32 v204, v5, 4, v204
    v_and_b32 v5, 1, v4
    v_lshl_add_u32 v204, v5, 14, v204
    v_add_u32 v204, s54, v204
    v_mov_b32 v64, 0
    v_mov_b32 v65, 0
    v_mov_b32 v66, 0
    v_mov_b32 v67, 0
    v_mov_b32 v68, 0
    v_mov_b32 v69, 0
    v_mov_b32 v70, 0
    v_mov_b32 v71, 0
    v_mov_b32 v72, 0
    v_mov_b32 v73, 0
    v_mov_b32 v74, 0
    v_mov_b32 v75, 0
    v_mov_b32 v76, 0
    v_mov_b32 v77, 0
    v_mov_b32 v78, 0
    v_mov_b32 v79, 0
    v_mov_b32 v80, 0
    v_mov_b32 v81, 0
    v_mov_b32 v82, 0
    v_mov_b32 v83, 0
    v_mov_b32 v84, 0
    v_mov_b32 v85, 0
    v_mov_b32 v86, 0
    v_mov_b32 v87, 0
    v_mov_b32 v88, 0
    v_mov_b32 v89, 0
    v_mov_b32 v90, 0
    v_mov_b32 v91, 0
    v_mov_b32 v92, 0
    v_mov_b32 v93, 0
    v_mov_b32 v94, 0
    v_mov_b32 v95, 0
    v_mov_b32 v96, 0
    v_mov_b32 v97, 0
    v_mov_b32 v98, 0
    v_mov_b32 v99, 0
    v_mov_b32 v100, 0
    v_mov_b32 v101, 0
    v_mov_b32 v102, 0
    v_mov_b32 v103, 0
    v_mov_b32 v104, 0
    v_mov_b32 v105, 0
    v_mov_b32 v106, 0
    v_mov_b32 v107, 0
    v_mov_b32 v108, 0
    v_mov_b32 v109, 0
    v_mov_b32 v110, 0
    v_mov_b32 v111, 0
    v_mov_b32 v112, 0
    v_mov_b32 v113, 0
    v_mov_b32 v114, 0
    v_mov_b32 v115, 0
    v_mov_b32 v116, 0
    v_mov_b32 v117, 0
    v_mov_b32 v118, 0
    v_mov_b32 v119, 0
    v_mov_b32 v120, 0
    v_mov_b32 v121, 0
    v_mov_b32 v122, 0
    v_mov_b32 v123, 0
    v_mov_b32 v124, 0
    v_mov_b32 v125, 0
    v_mov_b32 v126, 0
    v_mov_b32 v127, 0
    v_mov_b32 v216, 0xff800000
    v_mov_b32 v217, 0
    s_waitcnt vmcnt(16)
L_flags_29:
    v_cmp_gt_u32 vcc, 1073741824, v18
    s_cbranch_vccz L_flagsok_30
    s_sleep 2
    global_load_dword v18, v27, s[28:29] sc1
    s_waitcnt vmcnt(0)
    s_sub_u32 s101, s101, 1
    s_cbranch_scc0 L_flags_29
    s_mov_b32 s101, 0
L_flagsok_30:
    s_barrier
    ds_read_b128 a[32:35], v32 offset:0
    ds_read_b128 a[36:39], v33 offset:0
    ds_read_b128 a[40:43], v34 offset:0
    ds_read_b128 a[44:47], v35 offset:0
    ds_read_b128 a[48:51], v36 offset:0
    ds_read_b128 a[52:55], v37 offset:0
    ds_read_b128 a[56:59], v38 offset:0
    ds_read_b128 a[60:63], v39 offset:0
    buffer_load_dwordx4 v[128:131], v192, s[44:47], s96 offen sc1
    buffer_load_dwordx4 v[132:135], v193, s[44:47], s96 offen sc1
    buffer_load_dwordx4 v[136:139], v194, s[44:47], s96 offen sc1
    buffer_load_dwordx4 v[140:143], v195, s[44:47], s96 offen sc1
    buffer_load_dwordx4 v[144:147], v196, s[44:47], s96 offen sc1
    buffer_load_dwordx4 v[148:151], v197, s[44:47], s96 offen sc1
    buffer_load_dwordx4 v[152:155], v198, s[44:47], s96 offen sc1
    buffer_load_dwordx4 v[156:159], v199, s[44:47], s96 offen sc1
    buffer_load_dwordx4 a[160:163], v20, s[32:35], s58 offen nt
    buffer_load_dwordx4 a[164:167], v21, s[32:35], s58 offen nt
    buffer_load_dwordx4 a[168:171], v22, s[32:35], s58 offen nt
    buffer_load_dwordx4 a[172:175], v23, s[32:35], s58 offen nt
    s_add_u32 s58, s58, 16384
    buffer_load_dwordx4 a[176:179], v20, s[32:35], s58 offen nt
    buffer_load_dwordx4 a[180:183], v21, s[32:35], s58 offen nt
    buffer_load_dwordx4 a[184:187], v22, s[32:35], s58 offen nt
    buffer_load_dwordx4 a[188:191], v23, s[32:35], s58 offen nt
    s_add_u32 s58, s58, 16384
    s_waitcnt vmcnt(8)
    s_branch L_qpoll_31_c
L_qpoll_31:
    s_sleep 4
    buffer_load_dwordx4 v[128:131], v192, s[44:47], s96 offen sc1
    buffer_load_dwordx4 v[132:135], v193, s[44:47], s96 offen sc1
    buffer_load_dwordx4 v[136:139], v194, s[44:47], s96 offen sc1
    buffer_load_dwordx4 v[140:143], v195, s[44:47], s96 offen sc1
    buffer_load_dwordx4 v[144:147], v196, s[44:47], s96 offen sc1
    buffer_load_dwordx4 v[148:151], v197, s[44:47], s96 offen sc1
    buffer_load_dwordx4 v[152:155], v198, s[44:47], s96 offen sc1
    buffer_load_dwordx4 v[156:159], v199, s[44:47], s96 offen sc1
    s_waitcnt vmcnt(0)
L_qpoll_31_c:
    v_max3_u32 v5, v128, v129, v130
    v_max3_u32 v6, v144, v145, v146
    v_max3_u32 v5, v5, v131, v132
    v_max3_u32 v6, v6, v147, v148
    v_max3_u32 v5, v5, v133, v134
    v_max3_u32 v6, v6, v149, v150
    v_max3_u32 v5, v5, v135, v136
    v_max3_u32 v6, v6, v151, v152
    v_max3_u32 v5, v5, v137, v138
    v_max3_u32 v6, v6, v153, v154
    v_max3_u32 v5, v5, v139, v140
    v_max3_u32 v6, v6, v155, v156
    v_max3_u32 v5, v5, v141, v142
    v_max3_u32 v6, v6, v157, v158
    v_max3_u32 v5, v5, v143, v159
    v_max_u32 v5, v5, v6
    v_cmp_eq_u32 vcc, -1, v5
    s_nop 0
    s_mov_b64 exec, vcc
    s_cbranch_execz L_qok_32
    s_sub_u32 s101, s101, 1
    s_cbranch_scc0 L_qpoll_31
    s_mov_b32 s101, 0
L_qok_32:
    s_mov_b64 exec, -1
    ds_write_b128 v200, v[128:131] offset:0
    ds_write_b128 v201, v[132:135] offset:1024
    ds_write_b128 v202, v[136:139] offset:2048
    ds_write_b128 v203, v[140:143] offset:3072
    ds_write_b128 v200, v[144:147] offset:16384
    ds_write_b128 v201, v[148:151] offset:17408
    ds_write_b128 v202, v[152:155] offset:18432
    ds_write_b128 v203, v[156:159] offset:19456
    v_xor_b32 v192, 0, v204
    v_xor_b32 v193, 32, v204
    v_xor_b32 v194, 64, v204
    v_xor_b32 v195, 96, v204
    v_xor_b32 v196, 128, v204
    v_xor_b32 v197, 160, v204
    v_xor_b32 v198, 192, v204
    v_xor_b32 v199, 224, v204
    s_waitcnt lgkmcnt(0)
    ds_read_b128 a[0:3], v192
    ds_read_b128 a[4:7], v193
    ds_read_b128 a[8:11], v194
    ds_read_b128 a[12:15], v195
    ds_read_b128 a[16:19], v196
    ds_read_b128 a[20:23], v197
    ds_read_b128 a[24:27], v198
    ds_read_b128 a[28:31], v199
    s_waitcnt lgkmcnt(0)
    v_mfma_f32_32x32x16_bf16 v[128:143], a[32:35], a[0:3], 0
    v_mfma_f32_32x32x16_bf16 v[128:143], a[36:39], a[4:7], v[128:143]
    v_mfma_f32_32x32x16_bf16 v[128:143], a[40:43], a[8:11], v[128:143]
    v_mfma_f32_32x32x16_bf16 v[128:143], a[44:47], a[12:15], v[128:143]
    v_mfma_f32_32x32x16_bf16 v[128:143], a[48:51], a[16:19], v[128:143]
    v_mfma_f32_32x32x16_bf16 v[128:143], a[52:55], a[20:23], v[128:143]
    v_mfma_f32_32x32x16_bf16 v[128:143], a[56:59], a[24:27], v[128:143]
    v_mfma_f32_32x32x16_bf16 v[128:143], a[60:63], a[28:31], v[128:143]
    s_nop 11
    ds_write_b128 v28, v[128:131] offset:0
    ds_write_b128 v28, v[132:135] offset:1024
    ds_write_b128 v28, v[136:139] offset:2048
    ds_write_b128 v28, v[140:143] offset:3072
    s_waitcnt lgkmcnt(0)
    s_barrier
    ds_read_b128 v[144:147], v29 offset:0
    ds_read_b128 v[148:151], v29 offset:1024
    ds_read_b128 v[152:155], v29 offset:2048
    ds_read_b128 v[156:159], v29 offset:3072
    ds_read_b128 v[160:163], v30 offset:0
    ds_read_b128 v[164:167], v30 offset:1024
    ds_read_b128 v[168:171], v30 offset:2048
    ds_read_b128 v[172:175], v30 offset:3072
    ds_read_b128 v[176:179], v31 offset:0
    ds_read_b128 v[180:183], v31 offset:1024
    ds_read_b128 v[184:187], v31 offset:2048
    ds_read_b128 v[188:191], v31 offset:3072
    ds_read_b128 a[32:35], v32 offset:8192
    ds_read_b128 a[36:39], v33 offset:8192
    ds_read_b128 a[40:43], v34 offset:8192
    ds_read_b128 a[44:47], v35 offset:8192
    ds_read_b128 a[48:51], v36 offset:8192
    ds_read_b128 a[52:55], v37 offset:8192
    ds_read_b128 a[56:59], v38 offset:8192
    ds_read_b128 a[60:63], v39 offset:8192
    s_waitcnt lgkmcnt(8)
    v_add_f32 v144, v144, v128
    v_add_f32 v145, v145, v129
    v_add_f32 v146, v146, v130
    v_add_f32 v147, v147, v131
    buffer_load_dwordx4 a[192:195], v20, s[32:35], s58 offen nt
    v_add_f32 v148, v148, v132
    v_add_f32 v149, v149, v133
    v_add_f32 v150, v150, v134
    v_add_f32 v151, v151, v135
    v_add_f32 v152, v152, v136
    v_add_f32 v153, v153, v137
    v_add_f32 v154, v154, v138
    v_add_f32 v155, v155, v139
    v_add_f32 v156, v156, v140
    v_add_f32 v157, v157, v141
    v_add_f32 v158, v158, v142
    v_add_f32 v159, v159, v143
    s_waitcnt lgkmcnt(0)
    v_mfma_f32_32x32x16_bf16 v[128:143], a[32:35], a[0:3], 0
    ds_read_b64_tr_b16 a[64:65], v40 offset:0
    ds_read_b64_tr_b16 a[66:67], v41 offset:2048
    v_add_f32 v160, v160, v176
    v_add_f32 v161, v161, v177
    v_add_f32 v162, v162, v178
    v_add_f32 v163, v163, v179
    v_add_f32 v164, v164, v180
    v_mfma_f32_32x32x16_bf16 v[128:143], a[36:39], a[4:7], v[128:143]
    ds_read_b64_tr_b16 a[72:73], v42 offset:0
    ds_read_b64_tr_b16 a[74:75], v43 offset:2048
    v_add_f32 v165, v165, v181
    v_add_f32 v166, v166, v182
    v_add_f32 v167, v167, v183
    v_add_f32 v168, v168, v184
    v_add_f32 v169, v169, v185
    v_mfma_f32_32x32x16_bf16 v[128:143], a[40:43], a[8:11], v[128:143]
    ds_read_b64_tr_b16 a[80:81], v44 offset:0
    ds_read_b64_tr_b16 a[82:83], v45 offset:2048
    v_add_f32 v170, v170, v186
    v_add_f32 v171, v171, v187
    v_add_f32 v172, v172, v188
    v_add_f32 v173, v173, v189
    v_add_f32 v174, v174, v190
    v_mfma_f32_32x32x16_bf16 v[128:143], a[44:47], a[12:15], v[128:143]
    ds_read_b64_tr_b16 a[88:89], v46 offset:0
    ds_read_b64_tr_b16 a[90:91], v47 offset:2048
    v_add_f32 v175, v175, v191
    v_add_f32 v144, v144, v160
    v_add_f32 v145, v145, v161
    v_add_f32 v146, v146, v162
    v_add_f32 v147, v147, v163
    v_mfma_f32_32x32x16_bf16 v[128:143], a[48:51], a[16:19], v[128:143]
    ds_read_b64_tr_b16 a[68:69], v40 offset:4096
    ds_read_b64_tr_b16 a[70:71], v41 offset:6144
    v_add_f32 v148, v148, v164
    v_add_f32 v149, v149, v165
    v_add_f32 v150, v150, v166
    v_add_f32 v151, v151, v167
    v_add_f32 v152, v152, v168
    v_mfma_f32_32x32x16_bf16 v[128:143], a[52:55], a[20:23], v[128:143]
    ds_read_b64_tr_b16 a[76:77], v42 offset:4096
    ds_read_b64_tr_b16 a[78:79], v43 offset:6144
    v_add_f32 v153, v153, v169
    v_add_f32 v154, v154, v170
    v_add_f32 v155, v155, v171
    v_add_f32 v156, v156, v172
    v_add_f32 v157, v157, v173
    v_mfma_f32_32x32x16_bf16 v[128:143], a[56:59], a[24:27], v[128:143]
    ds_read_b64_tr_b16 a[84:85], v44 offset:4096
    ds_read_b64_tr_b16 a[86:87], v45 offset:6144
    v_add_f32 v158, v158, v174
    v_add_f32 v159, v159, v175
    v_max3_f32 v218, v144, v145, v146
    v_max3_f32 v219, v147, v148, v149
    v_max3_f32 v220, v150, v151, v152
    v_mfma_f32_32x32x16_bf16 v[128:143], a[60:63], a[28:31], v[128:143]
    ds_read_b64_tr_b16 a[92:93], v46 offset:4096
    ds_read_b64_tr_b16 a[94:95], v47 offset:6144
    v_max3_f32 v221, v153, v154, v155
    v_max3_f32 v218, v218, v156, v157
    v_max3_f32 v219, v219, v158, v159
    v_max3_f32 v218, v218, v219, v220
    v_max_f32 v218, v218, v221
    v_mov_b32 v219, v218
    s_nop 1
    v_permlane32_swap_b32 v218, v219
    v_max3_f32 v218, v218, v219, v216
    v_sub_f32 v220, v216, v218
    v_mov_b32 v216, v218
    v_exp_f32 v220, v220
    v_sub_f32 v192, v144, v218
    v_sub_f32 v193, v145, v218
    buffer_load_dwordx4 a[196:199], v21, s[32:35], s58 offen nt
    v_sub_f32 v194, v146, v218
    v_sub_f32 v195, v147, v218
    v_sub_f32 v196, v148, v218
    v_sub_f32 v197, v149, v218
    v_sub_f32 v198, v150, v218
    buffer_load_dwordx4 a[200:203], v22, s[32:35], s58 offen nt
    v_sub_f32 v199, v151, v218
    v_sub_f32 v200, v152, v218
    v_sub_f32 v201, v153, v218
    v_sub_f32 v202, v154, v218
    v_sub_f32 v203, v155, v218
    v_sub_f32 v204, v156, v218
    v_sub_f32 v205, v157, v218
    v_sub_f32 v206, v158, v218
    v_sub_f32 v207, v159, v218
    ds_write_b128 v28, v[128:131] offset:16384
    v_exp_f32 v192, v192
    v_exp_f32 v193, v193
    v_exp_f32 v194, v194
    v_exp_f32 v195, v195
    ds_write_b128 v28, v[132:135] offset:17408
    v_exp_f32 v196, v196
    v_exp_f32 v197, v197
    v_exp_f32 v198, v198
    v_exp_f32 v199, v199
    ds_write_b128 v28, v[136:139] offset:18432
    v_exp_f32 v200, v200
    v_exp_f32 v201, v201
    v_exp_f32 v202, v202
    v_exp_f32 v203, v203
    ds_write_b128 v28, v[140:143] offset:19456
    v_exp_f32 v204, v204
    v_exp_f32 v205, v205
    v_exp_f32 v206, v206
    v_exp_f32 v207, v207
    v_mul_f32 v217, v217, v220
    v_cvt_pk_bf16_f32 v208, v192, v193
    v_cvt_pk_bf16_f32 v209, v194, v195
    v_cvt_pk_bf16_f32 v210, v196, v197
    v_cvt_pk_bf16_f32 v211, v198, v199
    v_cvt_pk_bf16_f32 v212, v200, v201
    v_cvt_pk_bf16_f32 v213, v202, v203
    v_cvt_pk_bf16_f32 v214, v204, v205
    v_cvt_pk_bf16_f32 v215, v206, v207
    v_mul_f32 v64, v64, v220
    v_mul_f32 v65, v65, v220
    v_mul_f32 v66, v66, v220
    v_mul_f32 v67, v67, v220
    v_mul_f32 v68, v68, v220
    v_mul_f32 v69, v69, v220
    v_mul_f32 v70, v70, v220
    v_mul_f32 v71, v71, v220
    v_mul_f32 v72, v72, v220
    v_mul_f32 v73, v73, v220
    v_mul_f32 v74, v74, v220
    v_mul_f32 v75, v75, v220
    v_mul_f32 v76, v76, v220
    v_mul_f32 v77, v77, v220
    v_mul_f32 v78, v78, v220
    v_mul_f32 v79, v79, v220
    s_waitcnt lgkmcnt(0)
    s_barrier
    v_mfma_f32_32x32x16_bf16 v[64:79], a[64:67], v[208:211], v[64:79]
    ds_read_b128 v[144:147], v29 offset:16384
    v_mul_f32 v80, v80, v220
    v_mul_f32 v81, v81, v220
    ds_read_b128 v[148:151], v29 offset:17408
    ds_write_b128 v26, a[96:99] offset:0
    buffer_load_dwordx4 a[204:207], v23, s[32:35], s58 offen nt
    s_add_u32 s58, s58, 16384
    v_mul_f32 v82, v82, v220
    v_mul_f32 v83, v83, v220
    ds_read_b128 v[152:155], v29 offset:18432
    v_mul_f32 v84, v84, v220
    v_mfma_f32_32x32x16_bf16 v[64:79], a[68:71], v[212:215], v[64:79]
    v_mul_f32 v85, v85, v220
    ds_read_b128 v[156:159], v29 offset:19456
    v_mul_f32 v86, v86, v220
    ds_write_b128 v26, a[100:103] offset:1024
    v_mul_f32 v87, v87, v220
    v_mul_f32 v88, v88, v220
    v_mul_f32 v89, v89, v220
    v_mul_f32 v90, v90, v220
    v_mul_f32 v91, v91, v220
    v_mul_f32 v92, v92, v220
    v_mul_f32 v93, v93, v220
    v_mul_f32 v94, v94, v220
    v_mul_f32 v95, v95, v220
    s_nop 1
    v_mfma_f32_32x32x16_bf16 v[80:95], a[72:75], v[208:211], v[80:95]
    ds_read_b128 v[160:163], v30 offset:16384
    v_mul_f32 v96, v96, v220
    v_mul_f32 v97, v97, v220
    ds_read_b128 v[164:167], v30 offset:17408
    ds_write_b128 v26, a[104:107] offset:2048
    buffer_load_dwordx4 a[208:211], v20, s[32:35], s58 offen nt
    v_mul_f32 v98, v98, v220
    v_mul_f32 v99, v99, v220
    ds_read_b128 v[168:171], v30 offset:18432
    v_mul_f32 v100, v100, v220
    v_mfma_f32_32x32x16_bf16 v[80:95], a[76:79], v[212:215], v[80:95]
    v_mul_f32 v101, v101, v220
    ds_read_b128 v[172:175], v30 offset:19456
    v_mul_f32 v102, v102, v220
    ds_write_b128 v26, a[108:111] offset:3072
    v_mul_f32 v103, v103, v220
    v_mul_f32 v104, v104, v220
    v_mul_f32 v105, v105, v220
    v_mul_f32 v106, v106, v220
    v_mul_f32 v107, v107, v220
    v_mul_f32 v108, v108, v220
    v_mul_f32 v109, v109, v220
    v_mul_f32 v110, v110, v220
    v_mul_f32 v111, v111, v220
    s_nop 1
    v_mfma_f32_32x32x16_bf16 v[96:111], a[80:83], v[208:211], v[96:111]
    ds_read_b128 v[176:179], v31 offset:16384
    v_mul_f32 v112, v112, v220
    v_mul_f32 v113, v113, v220
    ds_read_b128 v[180:183], v31 offset:17408
    ds_write_b128 v26, a[112:115] offset:4096
    v_mul_f32 v114, v114, v220
    v_mul_f32 v115, v115, v220
    ds_read_b128 v[184:187], v31 offset:18432
    v_mul_f32 v116, v116, v220
    v_mfma_f32_32x32x16_bf16 v[96:111], a[84:87], v[212:215], v[96:111]
    v_mul_f32 v117, v117, v220
    ds_read_b128 v[188:191], v31 offset:19456
    v_mul_f32 v118, v118, v220
    ds_write_b128 v26, a[116:119] offset:5120
    buffer_load_dwordx4 a[212:215], v21, s[32:35], s58 offen nt
    v_mul_f32 v119, v119, v220
    v_mul_f32 v120, v120, v220
    v_mul_f32 v121, v121, v220
    v_mul_f32 v122, v122, v220
    v_mul_f32 v123, v123, v220
    v_mul_f32 v124, v124, v220
    v_mul_f32 v125, v125, v220
    v_mul_f32 v126, v126, v220
    v_mul_f32 v127, v127, v220
    s_nop 1
    v_mfma_f32_32x32x16_bf16 v[112:127], a[88:91], v[208:211], v[112:127]
    v_add_f32 v192, v192, v200
    v_add_f32 v193, v193, v201
    v_add_f32 v194, v194, v202
    v_add_f32 v195, v195, v203
    ds_write_b128 v26, a[120:123] offset:6144
    v_add_f32 v196, v196, v204
    v_add_f32 v197, v197, v205
    v_add_f32 v198, v198, v206
    v_add_f32 v199, v199, v207
    v_mfma_f32_32x32x16_bf16 v[112:127], a[92:95], v[212:215], v[112:127]
    v_add_f32 v192, v192, v196
    v_add_f32 v193, v193, v197
    v_add_f32 v194, v194, v198
    ds_write_b128 v26, a[124:127] offset:7168
    v_add_f32 v195, v195, v199
    v_add_f32 v192, v192, v193
    v_add_f32 v194, v194, v195
    v_add_f32 v192, v192, v194
    v_add_f32 v217, v217, v192
    ds_read_b128 a[32:35], v32 offset:16384
    ds_read_b128 a[36:39], v33 offset:16384
    ds_read_b128 a[40:43], v34 offset:16384
    ds_read_b128 a[44:47], v35 offset:16384
    ds_read_b128 a[48:51], v36 offset:16384
    ds_read_b128 a[52:55], v37 offset:16384
    ds_read_b128 a[56:59], v38 offset:16384
    ds_read_b128 a[60:63], v39 offset:16384
    s_waitcnt lgkmcnt(8)
    v_add_f32 v144, v144, v128
    v_add_f32 v145, v145, v129
    v_add_f32 v146, v146, v130
    v_add_f32 v147, v147, v131
    buffer_load_dwordx4 a[216:219], v22, s[32:35], s58 offen nt
    v_add_f32 v148, v148, v132
    v_add_f32 v149, v149, v133
    v_add_f32 v150, v150, v134
    v_add_f32 v151, v151, v135
    v_add_f32 v152, v152, v136
    v_add_f32 v153, v153, v137
    v_add_f32 v154, v154, v138
    v_add_f32 v155, v155, v139
    v_add_f32 v156, v156, v140
    v_add_f32 v157, v157, v141
    v_add_f32 v158, v158, v142
    v_add_f32 v159, v159, v143
    s_waitcnt lgkmcnt(0)
    v_mfma_f32_32x32x16_bf16 v[128:143], a[32:35], a[0:3], 0
    ds_read_b64_tr_b16 a[64:65], v40 offset:8192
    ds_read_b64_tr_b16 a[66:67], v41 offset:10240
    v_add_f32 v160, v160, v176
    v_add_f32 v161, v161, v177
    v_add_f32 v162, v162, v178
    v_add_f32 v163, v163, v179
    v_add_f32 v164, v164, v180
    v_mfma_f32_32x32x16_bf16 v[128:143], a[36:39], a[4:7], v[128:143]
    ds_read_b64_tr_b16 a[72:73], v42 offset:8192
    ds_read_b64_tr_b16 a[74:75], v43 offset:10240
    v_add_f32 v165, v165, v181
    v_add_f32 v166, v166, v182
    v_add_f32 v167, v167, v183
    v_add_f32 v168, v168, v184
    v_add_f32 v169, v169, v185
    v_mfma_f32_32x32x16_bf16 v[128:143], a[40:43], a[8:11], v[128:143]
    ds_read_b64_tr_b16 a[80:81], v44 offset:8192
    ds_read_b64_tr_b16 a[82:83], v45 offset:10240
    v_add_f32 v170, v170, v186
    v_add_f32 v171, v171, v187
    v_add_f32 v172, v172, v188
    v_add_f32 v173, v173, v189
    v_add_f32 v174, v174, v190
    v_mfma_f32_32x32x16_bf16 v[128:143], a[44:47], a[12:15], v[128:143]
    ds_read_b64_tr_b16 a[88:89], v46 offset:8192
    ds_read_b64_tr_b16 a[90:91], v47 offset:10240
    v_add_f32 v175, v175, v191
    v_add_f32 v144, v144, v160
    v_add_f32 v145, v145, v161
    v_add_f32 v146, v146, v162
    v_add_f32 v147, v147, v163
    v_mfma_f32_32x32x16_bf16 v[128:143], a[48:51], a[16:19], v[128:143]
    ds_read_b64_tr_b16 a[68:69], v40 offset:12288
    ds_read_b64_tr_b16 a[70:71], v41 offset:14336
    v_add_f32 v148, v148, v164
    v_add_f32 v149, v149, v165
    v_add_f32 v150, v150, v166
    v_add_f32 v151, v151, v167
    v_add_f32 v152, v152, v168
    v_mfma_f32_32x32x16_bf16 v[128:143], a[52:55], a[20:23], v[128:143]
    ds_read_b64_tr_b16 a[76:77], v42 offset:12288
    ds_read_b64_tr_b16 a[78:79], v43 offset:14336
    v_add_f32 v153, v153, v169
    v_add_f32 v154, v154, v170
    v_add_f32 v155, v155, v171
    v_add_f32 v156, v156, v172
    v_add_f32 v157, v157, v173
    v_mfma_f32_32x32x16_bf16 v[128:143], a[56:59], a[24:27], v[128:143]
    ds_read_b64_tr_b16 a[84:85], v44 offset:12288
    ds_read_b64_tr_b16 a[86:87], v45 offset:14336
    v_add_f32 v158, v158, v174
    v_add_f32 v159, v159, v175
    v_max3_f32 v218, v144, v145, v146
    v_max3_f32 v219, v147, v148, v149
    v_max3_f32 v220, v150, v151, v152
    v_mfma_f32_32x32x16_bf16 v[128:143], a[60:63], a[28:31], v[128:143]
    ds_read_b64_tr_b16 a[92:93], v46 offset:12288
    ds_read_b64_tr_b16 a[94:95], v47 offset:14336
    v_max3_f32 v221, v153, v154, v155
    v_max3_f32 v218, v218, v156, v157
    v_max3_f32 v219, v219, v158, v159
    v_max3_f32 v218, v218, v219, v220
    v_max_f32 v218, v218, v221
    v_mov_b32 v219, v218
    s_nop 1
    v_permlane32_swap_b32 v218, v219
    v_max3_f32 v218, v218, v219, v216
    v_sub_f32 v220, v216, v218
    v_mov_b32 v216, v218
    v_exp_f32 v220, v220
    v_sub_f32 v192, v144, v218
    v_sub_f32 v193, v145, v218
    buffer_load_dwordx4 a[220:223], v23, s[32:35], s58 offen nt
    s_add_u32 s58, s58, 16384
    v_sub_f32 v194, v146, v218
    v_sub_f32 v195, v147, v218
    v_sub_f32 v196, v148, v218
    v_sub_f32 v197, v149, v218
    v_sub_f32 v198, v150, v218
    buffer_load_dwordx4 a[224:227], v20, s[32:35], s58 offen nt
    v_sub_f32 v199, v151, v218
    v_sub_f32 v200, v152, v218
    v_sub_f32 v201, v153, v218
    v_sub_f32 v202, v154, v218
    v_sub_f32 v203, v155, v218
    v_sub_f32 v204, v156, v218
    v_sub_f32 v205, v157, v218
    v_sub_f32 v206, v158, v218
    v_sub_f32 v207, v159, v218
    ds_write_b128 v28, v[128:131] offset:0
    v_exp_f32 v192, v192
    v_exp_f32 v193, v193
    v_exp_f32 v194, v194
    v_exp_f32 v195, v195
    ds_write_b128 v28, v[132:135] offset:1024
    v_exp_f32 v196, v196
    v_exp_f32 v197, v197
    v_exp_f32 v198, v198
    v_exp_f32 v199, v199
    ds_write_b128 v28, v[136:139] offset:2048
    v_exp_f32 v200, v200
    v_exp_f32 v201, v201
    v_exp_f32 v202, v202
    v_exp_f32 v203, v203
    ds_write_b128 v28, v[140:143] offset:3072
    v_exp_f32 v204, v204
    v_exp_f32 v205, v205
    v_exp_f32 v206, v206
    v_exp_f32 v207, v207
    v_mul_f32 v217, v217, v220
    v_cvt_pk_bf16_f32 v208, v192, v193
    v_cvt_pk_bf16_f32 v209, v194, v195
    v_cvt_pk_bf16_f32 v210, v196, v197
    v_cvt_pk_bf16_f32 v211, v198, v199
    v_cvt_pk_bf16_f32 v212, v200, v201
    v_cvt_pk_bf16_f32 v213, v202, v203
    v_cvt_pk_bf16_f32 v214, v204, v205
    v_cvt_pk_bf16_f32 v215, v206, v207
    v_mul_f32 v64, v64, v220
    v_mul_f32 v65, v65, v220
    v_mul_f32 v66, v66, v220
    v_mul_f32 v67, v67, v220
    v_mul_f32 v68, v68, v220
    v_mul_f32 v69, v69, v220
    v_mul_f32 v70, v70, v220
    v_mul_f32 v71, v71, v220
    v_mul_f32 v72, v72, v220
    v_mul_f32 v73, v73, v220
    v_mul_f32 v74, v74, v220
    v_mul_f32 v75, v75, v220
    v_mul_f32 v76, v76, v220
    v_mul_f32 v77, v77, v220
    v_mul_f32 v78, v78, v220
    v_mul_f32 v79, v79, v220
    s_waitcnt lgkmcnt(0)
    s_barrier
    v_mfma_f32_32x32x16_bf16 v[64:79], a[64:67], v[208:211], v[64:79]
    ds_read_b128 v[144:147], v29 offset:0
    v_mul_f32 v80, v80, v220
    v_mul_f32 v81, v81, v220
    ds_read_b128 v[148:151], v29 offset:1024
    ds_write_b128 v26, a[128:131] offset:8192
    buffer_load_dwordx4 a[228:231], v21, s[32:35], s58 offen nt
    v_mul_f32 v82, v82, v220
    v_mul_f32 v83, v83, v220
    ds_read_b128 v[152:155], v29 offset:2048
    v_mul_f32 v84, v84, v220
    v_mfma_f32_32x32x16_bf16 v[64:79], a[68:71], v[212:215], v[64:79]
    v_mul_f32 v85, v85, v220
    ds_read_b128 v[156:159], v29 offset:3072
    v_mul_f32 v86, v86, v220
    ds_write_b128 v26, a[132:135] offset:9216
    v_mul_f32 v87, v87, v220
    v_mul_f32 v88, v88, v220
    v_mul_f32 v89, v89, v220
    v_mul_f32 v90, v90, v220
    v_mul_f32 v91, v91, v220
    v_mul_f32 v92, v92, v220
    v_mul_f32 v93, v93, v220
    v_mul_f32 v94, v94, v220
    v_mul_f32 v95, v95, v220
    s_nop 1
    v_mfma_f32_32x32x16_bf16 v[80:95], a[72:75], v[208:211], v[80:95]
    ds_read_b128 v[160:163], v30 offset:0
    v_mul_f32 v96, v96, v220
    v_mul_f32 v97, v97, v220
    ds_read_b128 v[164:167], v30 offset:1024
    ds_write_b128 v26, a[136:139] offset:10240
    buffer_load_dwordx4 a[232:235], v22, s[32:35], s58 offen nt
    v_mul_f32 v98, v98, v220
    v_mul_f32 v99, v99, v220
    ds_read_b128 v[168:171], v30 offset:2048
    v_mul_f32 v100, v100, v220
    v_mfma_f32_32x32x16_bf16 v[80:95], a[76:79], v[212:215], v[80:95]
    v_mul_f32 v101, v101, v220
    ds_read_b128 v[172:175], v30 offset:3072
    v_mul_f32 v102, v102, v220
    ds_write_b128 v26, a[140:143] offset:11264
    v_mul_f32 v103, v103, v220
    v_mul_f32 v104, v104, v220
    v_mul_f32 v105, v105, v220
    v_mul_f32 v106, v106, v220
    v_mul_f32 v107, v107, v220
    v_mul_f32 v108, v108, v220
    v_mul_f32 v109, v109, v220
    v_mul_f32 v110, v110, v220
    v_mul_f32 v111, v111, v220
    s_nop 1
    v_mfma_f32_32x32x16_bf16 v[96:111], a[80:83], v[208:211], v[96:111]
    ds_read_b128 v[176:179], v31 offset:0
    v_mul_f32 v112, v112, v220
    v_mul_f32 v113, v113, v220
    ds_read_b128 v[180:183], v31 offset:1024
    ds_write_b128 v26, a[144:147] offset:12288
    v_mul_f32 v114, v114, v220
    v_mul_f32 v115, v115, v220
    ds_read_b128 v[184:187], v31 offset:2048
    v_mul_f32 v116, v116, v220
    v_mfma_f32_32x32x16_bf16 v[96:111], a[84:87], v[212:215], v[96:111]
    v_mul_f32 v117, v117, v220
    ds_read_b128 v[188:191], v31 offset:3072
    v_mul_f32 v118, v118, v220
    ds_write_b128 v26, a[148:151] offset:13312
    buffer_load_dwordx4 a[236:239], v23, s[32:35], s58 offen nt
    s_add_u32 s58, s58, 16384
    v_mul_f32 v119, v119, v220
    v_mul_f32 v120, v120, v220
    v_mul_f32 v121, v121, v220
    v_mul_f32 v122, v122, v220
    v_mul_f32 v123, v123, v220
    v_mul_f32 v124, v124, v220
    v_mul_f32 v125, v125, v220
    v_mul_f32 v126, v126, v220
    v_mul_f32 v127, v127, v220
    s_nop 1
    v_mfma_f32_32x32x16_bf16 v[112:127], a[88:91], v[208:211], v[112:127]
    v_add_f32 v192, v192, v200
    v_add_f32 v193, v193, v201
    v_add_f32 v194, v194, v202
    v_add_f32 v195, v195, v203
    ds_write_b128 v26, a[152:155] offset:14336
    v_add_f32 v196, v196, v204
    v_add_f32 v197, v197, v205
    v_add_f32 v198, v198, v206
    v_add_f32 v199, v199, v207
    v_mfma_f32_32x32x16_bf16 v[112:127], a[92:95], v[212:215], v[112:127]
    v_add_f32 v192, v192, v196
    v_add_f32 v193, v193, v197
    v_add_f32 v194, v194, v198
    ds_write_b128 v26, a[156:159] offset:15360
    v_add_f32 v195, v195, v199
    v_add_f32 v192, v192, v193
    v_add_f32 v194, v194, v195
    v_add_f32 v192, v192, v194
    v_add_f32 v217, v217, v192
    ds_read_b128 a[32:35], v32 offset:24576
    ds_read_b128 a[36:39], v33 offset:24576
    ds_read_b128 a[40:43], v34 offset:24576
    ds_read_b128 a[44:47], v35 offset:24576
    ds_read_b128 a[48:51], v36 offset:24576
    ds_read_b128 a[52:55], v37 offset:24576
    ds_read_b128 a[56:59], v38 offset:24576
    ds_read_b128 a[60:63], v39 offset:24576
    s_waitcnt lgkmcnt(8)
    v_add_f32 v144, v144, v128
    v_add_f32 v145, v145, v129
    v_add_f32 v146, v146, v130
    v_add_f32 v147, v147, v131
    buffer_load_dwordx4 a[240:243], v20, s[32:35], s58 offen nt
    v_add_f32 v148, v148, v132
    v_add_f32 v149, v149, v133
    v_add_f32 v150, v150, v134
    v_add_f32 v151, v151, v135
    v_add_f32 v152, v152, v136
    v_add_f32 v153, v153, v137
    v_add_f32 v154, v154, v138
    v_add_f32 v155, v155, v139
    v_add_f32 v156, v156, v140
    v_add_f32 v157, v157, v141
    v_add_f32 v158, v158, v142
    v_add_f32 v159, v159, v143
    s_waitcnt lgkmcnt(0)
    v_mfma_f32_32x32x16_bf16 v[128:143], a[32:35], a[0:3], 0
    ds_read_b64_tr_b16 a[64:65], v40 offset:16384
    ds_read_b64_tr_b16 a[66:67], v41 offset:18432
    v_add_f32 v160, v160, v176
    v_add_f32 v161, v161, v177
    v_add_f32 v162, v162, v178
    v_add_f32 v163, v163, v179
    v_add_f32 v164, v164, v180
    v_mfma_f32_32x32x16_bf16 v[128:143], a[36:39], a[4:7], v[128:143]
    ds_read_b64_tr_b16 a[72:73], v42 offset:16384
    ds_read_b64_tr_b16 a[74:75], v43 offset:18432
    v_add_f32 v165, v165, v181
    v_add_f32 v166, v166, v182
    v_add_f32 v167, v167, v183
    v_add_f32 v168, v168, v184
    v_add_f32 v169, v169, v185
    v_mfma_f32_32x32x16_bf16 v[128:143], a[40:43], a[8:11], v[128:143]
    ds_read_b64_tr_b16 a[80:81], v44 offset:16384
    ds_read_b64_tr_b16 a[82:83], v45 offset:18432
    v_add_f32 v170, v170, v186
    v_add_f32 v171, v171, v187
    v_add_f32 v172, v172, v188
    v_add_f32 v173, v173, v189
    v_add_f32 v174, v174, v190
    v_mfma_f32_32x32x16_bf16 v[128:143], a[44:47], a[12:15], v[128:143]
    ds_read_b64_tr_b16 a[88:89], v46 offset:16384
    ds_read_b64_tr_b16 a[90:91], v47 offset:18432
    v_add_f32 v175, v175, v191
    v_add_f32 v144, v144, v160
    v_add_f32 v145, v145, v161
    v_add_f32 v146, v146, v162
    v_add_f32 v147, v147, v163
    v_mfma_f32_32x32x16_bf16 v[128:143], a[48:51], a[16:19], v[128:143]
    ds_read_b64_tr_b16 a[68:69], v40 offset:20480
    ds_read_b64_tr_b16 a[70:71], v41 offset:22528
    v_add_f32 v148, v148, v164
    v_add_f32 v149, v149, v165
    v_add_f32 v150, v150, v166
    v_add_f32 v151, v151, v167
    v_add_f32 v152, v152, v168
    v_mfma_f32_32x32x16_bf16 v[128:143], a[52:55], a[20:23], v[128:143]
    ds_read_b64_tr_b16 a[76:77], v42 offset:20480
    ds_read_b64_tr_b16 a[78:79], v43 offset:22528
    v_add_f32 v153, v153, v169
    v_add_f32 v154, v154, v170
    v_add_f32 v155, v155, v171
    v_add_f32 v156, v156, v172
    v_add_f32 v157, v157, v173
    v_mfma_f32_32x32x16_bf16 v[128:143], a[56:59], a[24:27], v[128:143]
    ds_read_b64_tr_b16 a[84:85], v44 offset:20480
    ds_read_b64_tr_b16 a[86:87], v45 offset:22528
    v_add_f32 v158, v158, v174
    v_add_f32 v159, v159, v175
    v_max3_f32 v218, v144, v145, v146
    v_max3_f32 v219, v147, v148, v149
    v_max3_f32 v220, v150, v151, v152
    v_mfma_f32_32x32x16_bf16 v[128:143], a[60:63], a[28:31], v[128:143]
    ds_read_b64_tr_b16 a[92:93], v46 offset:20480
    ds_read_b64_tr_b16 a[94:95], v47 offset:22528
    v_max3_f32 v221, v153, v154, v155
    v_max3_f32 v218, v218, v156, v157
    v_max3_f32 v219, v219, v158, v159
    v_max3_f32 v218, v218, v219, v220
    v_max_f32 v218, v218, v221
    v_mov_b32 v219, v218
    s_nop 1
    v_permlane32_swap_b32 v218, v219
    v_max3_f32 v218, v218, v219, v216
    v_sub_f32 v220, v216, v218
    v_mov_b32 v216, v218
    v_exp_f32 v220, v220
    v_sub_f32 v192, v144, v218
    v_sub_f32 v193, v145, v218
    buffer_load_dwordx4 a[244:247], v21, s[32:35], s58 offen nt
    v_sub_f32 v194, v146, v218
    v_sub_f32 v195, v147, v218
    v_sub_f32 v196, v148, v218
    v_sub_f32 v197, v149, v218
    v_sub_f32 v198, v150, v218
    buffer_load_dwordx4 a[248:251], v22, s[32:35], s58 offen nt
    v_sub_f32 v199, v151, v218
    v_sub_f32 v200, v152, v218
    v_sub_f32 v201, v153, v218
    v_sub_f32 v202, v154, v218
    v_sub_f32 v203, v155, v218
    v_sub_f32 v204, v156, v218
    v_sub_f32 v205, v157, v218
    v_sub_f32 v206, v158, v218
    v_sub_f32 v207, v159, v218
    ds_write_b128 v28, v[128:131] offset:16384
    v_exp_f32 v192, v192
    v_exp_f32 v193, v193
    v_exp_f32 v194, v194
    v_exp_f32 v195, v195
    ds_write_b128 v28, v[132:135] offset:17408
    v_exp_f32 v196, v196
    v_exp_f32 v197, v197
    v_exp_f32 v198, v198
    v_exp_f32 v199, v199
    ds_write_b128 v28, v[136:139] offset:18432
    v_exp_f32 v200, v200
    v_exp_f32 v201, v201
    v_exp_f32 v202, v202
    v_exp_f32 v203, v203
    ds_write_b128 v28, v[140:143] offset:19456
    v_exp_f32 v204, v204
    v_exp_f32 v205, v205
    v_exp_f32 v206, v206
    v_exp_f32 v207, v207
    v_mul_f32 v217, v217, v220
    v_cvt_pk_bf16_f32 v208, v192, v193
    v_cvt_pk_bf16_f32 v209, v194, v195
    v_cvt_pk_bf16_f32 v210, v196, v197
    v_cvt_pk_bf16_f32 v211, v198, v199
    v_cvt_pk_bf16_f32 v212, v200, v201
    v_cvt_pk_bf16_f32 v213, v202, v203
    v_cvt_pk_bf16_f32 v214, v204, v205
    v_cvt_pk_bf16_f32 v215, v206, v207
    v_mul_f32 v64, v64, v220
    v_mul_f32 v65, v65, v220
    v_mul_f32 v66, v66, v220
    v_mul_f32 v67, v67, v220
    v_mul_f32 v68, v68, v220
    v_mul_f32 v69, v69, v220
    v_mul_f32 v70, v70, v220
    v_mul_f32 v71, v71, v220
    v_mul_f32 v72, v72, v220
    v_mul_f32 v73, v73, v220
    v_mul_f32 v74, v74, v220
    v_mul_f32 v75, v75, v220
    v_mul_f32 v76, v76, v220
    v_mul_f32 v77, v77, v220
    v_mul_f32 v78, v78, v220
    v_mul_f32 v79, v79, v220
    s_waitcnt lgkmcnt(0)
    s_barrier
    v_mfma_f32_32x32x16_bf16 v[64:79], a[64:67], v[208:211], v[64:79]
    ds_read_b128 v[144:147], v29 offset:16384
    v_mul_f32 v80, v80, v220
    v_mul_f32 v81, v81, v220
    ds_read_b128 v[148:151], v29 offset:17408
    s_waitcnt vmcnt(22)
    ds_write_b128 v26, a[160:163] offset:16384
    buffer_load_dwordx4 a[252:255], v23, s[32:35], s58 offen nt
    s_add_u32 s58, s58, 16384
    v_mul_f32 v82, v82, v220
    v_mul_f32 v83, v83, v220
    ds_read_b128 v[152:155], v29 offset:18432
    v_mul_f32 v84, v84, v220
    v_mfma_f32_32x32x16_bf16 v[64:79], a[68:71], v[212:215], v[64:79]
    v_mul_f32 v85, v85, v220
    ds_read_b128 v[156:159], v29 offset:19456
    v_mul_f32 v86, v86, v220
    s_waitcnt vmcnt(22)
    ds_write_b128 v26, a[164:167] offset:17408
    v_mul_f32 v87, v87, v220
    v_mul_f32 v88, v88, v220
    v_mul_f32 v89, v89, v220
    v_mul_f32 v90, v90, v220
    v_mul_f32 v91, v91, v220
    v_mul_f32 v92, v92, v220
    v_mul_f32 v93, v93, v220
    v_mul_f32 v94, v94, v220
    v_mul_f32 v95, v95, v220
    s_nop 1
    v_mfma_f32_32x32x16_bf16 v[80:95], a[72:75], v[208:211], v[80:95]
    ds_read_b128 v[160:163], v30 offset:16384
    v_mul_f32 v96, v96, v220
    v_mul_f32 v97, v97, v220
    ds_read_b128 v[164:167], v30 offset:17408
    s_waitcnt vmcnt(21)
    ds_write_b128 v26, a[168:171] offset:18432
    buffer_load_dwordx4 v[224:227], v20, s[32:35], s58 offen nt
    v_mul_f32 v98, v98, v220
    v_mul_f32 v99, v99, v220
    ds_read_b128 v[168:171], v30 offset:18432
    v_mul_f32 v100, v100, v220
    v_mfma_f32_32x32x16_bf16 v[80:95], a[76:79], v[212:215], v[80:95]
    v_mul_f32 v101, v101, v220
    ds_read_b128 v[172:175], v30 offset:19456
    v_mul_f32 v102, v102, v220
    s_waitcnt vmcnt(21)
    ds_write_b128 v26, a[172:175] offset:19456
    v_mul_f32 v103, v103, v220
    v_mul_f32 v104, v104, v220
    v_mul_f32 v105, v105, v220
    v_mul_f32 v106, v106, v220
    v_mul_f32 v107, v107, v220
    v_mul_f32 v108, v108, v220
    v_mul_f32 v109, v109, v220
    v_mul_f32 v110, v110, v220
    v_mul_f32 v111, v111, v220
    s_nop 1
    v_mfma_f32_32x32x16_bf16 v[96:111], a[80:83], v[208:211], v[96:111]
    ds_read_b128 v[176:179], v31 offset:16384
    v_mul_f32 v112, v112, v220
    v_mul_f32 v113, v113, v220
    ds_read_b128 v[180:183], v31 offset:17408
    s_waitcnt vmcnt(20)
    ds_write_b128 v26, a[176:179] offset:20480
    v_mul_f32 v114, v114, v220
    v_mul_f32 v115, v115, v220
    ds_read_b128 v[184:187], v31 offset:18432
    v_mul_f32 v116, v116, v220
    v_mfma_f32_32x32x16_bf16 v[96:111], a[84:87], v[212:215], v[96:111]
    v_mul_f32 v117, v117, v220
    ds_read_b128 v[188:191], v31 offset:19456
    v_mul_f32 v118, v118, v220
    s_waitcnt vmcnt(19)
    ds_write_b128 v26, a[180:183] offset:21504
    buffer_load_dwordx4 v[228:231], v21, s[32:35], s58 offen nt
    v_mul_f32 v119, v119, v220
    v_mul_f32 v120, v120, v220
    v_mul_f32 v121, v121, v220
    v_mul_f32 v122, v122, v220
    v_mul_f32 v123, v123, v220
    v_mul_f32 v124, v124, v220
    v_mul_f32 v125, v125, v220
    v_mul_f32 v126, v126, v220
    v_mul_f32 v127, v127, v220
    s_nop 1
    v_mfma_f32_32x32x16_bf16 v[112:127], a[88:91], v[208:211], v[112:127]
    v_add_f32 v192, v192, v200
    v_add_f32 v193, v193, v201
    v_add_f32 v194, v194, v202
    v_add_f32 v195, v195, v203
    s_waitcnt vmcnt(19)
    ds_write_b128 v26, a[184:187] offset:22528
    v_add_f32 v196, v196, v204
    v_add_f32 v197, v197, v205
    v_add_f32 v198, v198, v206
    v_add_f32 v199, v199, v207
    v_mfma_f32_32x32x16_bf16 v[112:127], a[92:95], v[212:215], v[112:127]
    v_add_f32 v192, v192, v196
    v_add_f32 v193, v193, v197
    v_add_f32 v194, v194, v198
    s_waitcnt vmcnt(18)
    ds_write_b128 v26, a[188:191] offset:23552
    v_add_f32 v195, v195, v199
    v_add_f32 v192, v192, v193
    v_add_f32 v194, v194, v195
    v_add_f32 v192, v192, v194
    v_add_f32 v217, v217, v192
    ds_read_b128 a[32:35], v32 offset:0
    ds_read_b128 a[36:39], v33 offset:0
    ds_read_b128 a[40:43], v34 offset:0
    ds_read_b128 a[44:47], v35 offset:0
    ds_read_b128 a[48:51], v36 offset:0
    ds_read_b128 a[52:55], v37 offset:0
    ds_read_b128 a[56:59], v38 offset:0
    ds_read_b128 a[60:63], v39 offset:0
    s_waitcnt lgkmcnt(8)
    v_add_f32 v144, v144, v128
    v_add_f32 v145, v145, v129
    v_add_f32 v146, v146, v130
    v_add_f32 v147, v147, v131
    buffer_load_dwordx4 v[232:235], v22, s[32:35], s58 offen nt
    v_add_f32 v148, v148, v132
    v_add_f32 v149, v149, v133
    v_add_f32 v150, v150, v134
    v_add_f32 v151, v151, v135
    v_add_f32 v152, v152, v136
    v_add_f32 v153, v153, v137
    v_add_f32 v154, v154, v138
    v_add_f32 v155, v155, v139
    v_add_f32 v156, v156, v140
    v_add_f32 v157, v157, v141
    v_add_f32 v158, v158, v142
    v_add_f32 v159, v159, v143
    s_waitcnt lgkmcnt(0)
    v_mfma_f32_32x32x16_bf16 v[128:143], a[32:35], a[0:3], 0
    ds_read_b64_tr_b16 a[64:65], v40 offset:24576
    ds_read_b64_tr_b16 a[66:67], v41 offset:26624
    v_add_f32 v160, v160, v176
    v_add_f32 v161, v161, v177
    v_add_f32 v162, v162, v178
    v_add_f32 v163, v163, v179
    v_add_f32 v164, v164, v180
    v_mfma_f32_32x32x16_bf16 v[128:143], a[36:39], a[4:7], v[128:143]
    ds_read_b64_tr_b16 a[72:73], v42 offset:24576
    ds_read_b64_tr_b16 a[74:75], v43 offset:26624
    v_add_f32 v165, v165, v181
    v_add_f32 v166, v166, v182
    v_add_f32 v167, v167, v183
    v_add_f32 v168, v168, v184
    v_add_f32 v169, v169, v185
    v_mfma_f32_32x32x16_bf16 v[128:143], a[40:43], a[8:11], v[128:143]
    ds_read_b64_tr_b16 a[80:81], v44 offset:24576
    ds_read_b64_tr_b16 a[82:83], v45 offset:26624
    v_add_f32 v170, v170, v186
    v_add_f32 v171, v171, v187
    v_add_f32 v172, v172, v188
    v_add_f32 v173, v173, v189
    v_add_f32 v174, v174, v190
    v_mfma_f32_32x32x16_bf16 v[128:143], a[44:47], a[12:15], v[128:143]
    ds_read_b64_tr_b16 a[88:89], v46 offset:24576
    ds_read_b64_tr_b16 a[90:91], v47 offset:26624
    v_add_f32 v175, v175, v191
    v_add_f32 v144, v144, v160
    v_add_f32 v145, v145, v161
    v_add_f32 v146, v146, v162
    v_add_f32 v147, v147, v163
    v_mfma_f32_32x32x16_bf16 v[128:143], a[48:51], a[16:19], v[128:143]
    ds_read_b64_tr_b16 a[68:69], v40 offset:28672
    ds_read_b64_tr_b16 a[70:71], v41 offset:30720
    v_add_f32 v148, v148, v164
    v_add_f32 v149, v149, v165
    v_add_f32 v150, v150, v166
    v_add_f32 v151, v151, v167
    v_add_f32 v152, v152, v168
    v_mfma_f32_32x32x16_bf16 v[128:143], a[52:55], a[20:23], v[128:143]
    ds_read_b64_tr_b16 a[76:77], v42 offset:28672
    ds_read_b64_tr_b16 a[78:79], v43 offset:30720
    v_add_f32 v153, v153, v169
    v_add_f32 v154, v154, v170
    v_add_f32 v155, v155, v171
    v_add_f32 v156, v156, v172
    v_add_f32 v157, v157, v173
    v_mfma_f32_32x32x16_bf16 v[128:143], a[56:59], a[24:27], v[128:143]
    ds_read_b64_tr_b16 a[84:85], v44 offset:28672
    ds_read_b64_tr_b16 a[86:87], v45 offset:30720
    v_add_f32 v158, v158, v174
    v_add_f32 v159, v159, v175
    v_max3_f32 v218, v144, v145, v146
    v_max3_f32 v219, v147, v148, v149
    v_max3_f32 v220, v150, v151, v152
    v_mfma_f32_32x32x16_bf16 v[128:143], a[60:63], a[28:31], v[128:143]
    ds_read_b64_tr_b16 a[92:93], v46 offset:28672
    ds_read_b64_tr_b16 a[94:95], v47 offset:30720
    v_max3_f32 v221, v153, v154, v155
    v_max3_f32 v218, v218, v156, v157
    v_max3_f32 v219, v219, v158, v159
    v_max3_f32 v218, v218, v219, v220
    v_max_f32 v218, v218, v221
    v_mov_b32 v219, v218
    s_nop 1
    v_permlane32_swap_b32 v218, v219
    v_max3_f32 v218, v218, v219, v216
    v_sub_f32 v220, v216, v218
    v_mov_b32 v216, v218
    v_exp_f32 v220, v220
    v_sub_f32 v192, v144, v218
    v_sub_f32 v193, v145, v218
    buffer_load_dwordx4 v[236:239], v23, s[32:35], s58 offen nt
    s_add_u32 s58, s58, 16384
    v_sub_f32 v194, v146, v218
    v_sub_f32 v195, v147, v218
    v_sub_f32 v196, v148, v218
    v_sub_f32 v197, v149, v218
    v_sub_f32 v198, v150, v218
    buffer_load_dwordx4 v[240:243], v20, s[32:35], s58 offen nt
    v_sub_f32 v199, v151, v218
    v_sub_f32 v200, v152, v218
    v_sub_f32 v201, v153, v218
    v_sub_f32 v202, v154, v218
    v_sub_f32 v203, v155, v218
    v_sub_f32 v204, v156, v218
    v_sub_f32 v205, v157, v218
    v_sub_f32 v206, v158, v218
    v_sub_f32 v207, v159, v218
    ds_write_b128 v28, v[128:131] offset:0
    v_exp_f32 v192, v192
    v_exp_f32 v193, v193
    v_exp_f32 v194, v194
    v_exp_f32 v195, v195
    ds_write_b128 v28, v[132:135] offset:1024
    v_exp_f32 v196, v196
    v_exp_f32 v197, v197
    v_exp_f32 v198, v198
    v_exp_f32 v199, v199
    ds_write_b128 v28, v[136:139] offset:2048
    v_exp_f32 v200, v200
    v_exp_f32 v201, v201
    v_exp_f32 v202, v202
    v_exp_f32 v203, v203
    ds_write_b128 v28, v[140:143] offset:3072
    v_exp_f32 v204, v204
    v_exp_f32 v205, v205
    v_exp_f32 v206, v206
    v_exp_f32 v207, v207
    v_mul_f32 v217, v217, v220
    v_cvt_pk_bf16_f32 v208, v192, v193
    v_cvt_pk_bf16_f32 v209, v194, v195
    v_cvt_pk_bf16_f32 v210, v196, v197
    v_cvt_pk_bf16_f32 v211, v198, v199
    v_cvt_pk_bf16_f32 v212, v200, v201
    v_cvt_pk_bf16_f32 v213, v202, v203
    v_cvt_pk_bf16_f32 v214, v204, v205
    v_cvt_pk_bf16_f32 v215, v206, v207
    v_mul_f32 v64, v64, v220
    v_mul_f32 v65, v65, v220
    v_mul_f32 v66, v66, v220
    v_mul_f32 v67, v67, v220
    v_mul_f32 v68, v68, v220
    v_mul_f32 v69, v69, v220
    v_mul_f32 v70, v70, v220
    v_mul_f32 v71, v71, v220
    v_mul_f32 v72, v72, v220
    v_mul_f32 v73, v73, v220
    v_mul_f32 v74, v74, v220
    v_mul_f32 v75, v75, v220
    v_mul_f32 v76, v76, v220
    v_mul_f32 v77, v77, v220
    v_mul_f32 v78, v78, v220
    v_mul_f32 v79, v79, v220
    s_waitcnt lgkmcnt(0)
    s_barrier
    v_mfma_f32_32x32x16_bf16 v[64:79], a[64:67], v[208:211], v[64:79]
    ds_read_b128 v[144:147], v29 offset:0
    v_mul_f32 v80, v80, v220
    v_mul_f32 v81, v81, v220
    ds_read_b128 v[148:151], v29 offset:1024
    buffer_load_dwordx4 v[244:247], v21, s[32:35], s58 offen nt
    v_mul_f32 v82, v82, v220
    v_mul_f32 v83, v83, v220
    ds_read_b128 v[152:155], v29 offset:2048
    v_mul_f32 v84, v84, v220
    v_mfma_f32_32x32x16_bf16 v[64:79], a[68:71], v[212:215], v[64:79]
    v_mul_f32 v85, v85, v220
    ds_read_b128 v[156:159], v29 offset:3072
    v_mul_f32 v86, v86, v220
    v_mul_f32 v87, v87, v220
    v_mul_f32 v88, v88, v220
    v_mul_f32 v89, v89, v220
    v_mul_f32 v90, v90, v220
    v_mul_f32 v91, v91, v220
    v_mul_f32 v92, v92, v220
    v_mul_f32 v93, v93, v220
    v_mul_f32 v94, v94, v220
    v_mul_f32 v95, v95, v220
    s_nop 1
    v_mfma_f32_32x32x16_bf16 v[80:95], a[72:75], v[208:211], v[80:95]
    ds_read_b128 v[160:163], v30 offset:0
    v_mul_f32 v96, v96, v220
    v_mul_f32 v97, v97, v220
    ds_read_b128 v[164:167], v30 offset:1024
    buffer_load_dwordx4 v[248:251], v22, s[32:35], s58 offen nt
    v_mul_f32 v98, v98, v220
    v_mul_f32 v99, v99, v220
    ds_read_b128 v[168:171], v30 offset:2048
    v_mul_f32 v100, v100, v220
    v_mfma_f32_32x32x16_bf16 v[80:95], a[76:79], v[212:215], v[80:95]
    v_mul_f32 v101, v101, v220
    ds_read_b128 v[172:175], v30 offset:3072
    v_mul_f32 v102, v102, v220
    v_mul_f32 v103, v103, v220
    v_mul_f32 v104, v104, v220
    v_mul_f32 v105, v105, v220
    v_mul_f32 v106, v106, v220
    v_mul_f32 v107, v107, v220
    v_mul_f32 v108, v108, v220
    v_mul_f32 v109, v109, v220
    v_mul_f32 v110, v110, v220
    v_mul_f32 v111, v111, v220
    s_nop 1
    v_mfma_f32_32x32x16_bf16 v[96:111], a[80:83], v[208:211], v[96:111]
    ds_read_b128 v[176:179], v31 offset:0
    v_mul_f32 v112, v112, v220
    v_mul_f32 v113, v113, v220
    ds_read_b128 v[180:183], v31 offset:1024
    v_mul_f32 v114, v114, v220
    v_mul_f32 v115, v115, v220
    ds_read_b128 v[184:187], v31 offset:2048
    v_mul_f32 v116, v116, v220
    v_mfma_f32_32x32x16_bf16 v[96:111], a[84:87], v[212:215], v[96:111]
    v_mul_f32 v117, v117, v220
    ds_read_b128 v[188:191], v31 offset:3072
    v_mul_f32 v118, v118, v220
    buffer_load_dwordx4 v[252:255], v23, s[32:35], s58 offen nt
    s_add_u32 s58, s58, 16384
    v_mul_f32 v119, v119, v220
    v_mul_f32 v120, v120, v220
    v_mul_f32 v121, v121, v220
    v_mul_f32 v122, v122, v220
    v_mul_f32 v123, v123, v220
    v_mul_f32 v124, v124, v220
    v_mul_f32 v125, v125, v220
    v_mul_f32 v126, v126, v220
    v_mul_f32 v127, v127, v220
    s_nop 1
    v_mfma_f32_32x32x16_bf16 v[112:127], a[88:91], v[208:211], v[112:127]
    v_add_f32 v192, v192, v200
    v_add_f32 v193, v193, v201
    v_add_f32 v194, v194, v202
    v_add_f32 v195, v195, v203
    v_add_f32 v196, v196, v204
    v_add_f32 v197, v197, v205
    v_add_f32 v198, v198, v206
    v_add_f32 v199, v199, v207
    v_mfma_f32_32x32x16_bf16 v[112:127], a[92:95], v[212:215], v[112:127]
    v_add_f32 v192, v192, v196
    v_add_f32 v193, v193, v197
    v_add_f32 v194, v194, v198
    v_add_f32 v195, v195, v199
    v_add_f32 v192, v192, v193
    v_add_f32 v194, v194, v195
    v_add_f32 v192, v192, v194
    v_add_f32 v217, v217, v192
    ds_read_b128 a[32:35], v32 offset:8192
    ds_read_b128 a[36:39], v33 offset:8192
    ds_read_b128 a[40:43], v34 offset:8192
    ds_read_b128 a[44:47], v35 offset:8192
    ds_read_b128 a[48:51], v36 offset:8192
    ds_read_b128 a[52:55], v37 offset:8192
    ds_read_b128 a[56:59], v38 offset:8192
    ds_read_b128 a[60:63], v39 offset:8192
    s_waitcnt lgkmcnt(8)
    v_add_f32 v144, v144, v128
    v_add_f32 v145, v145, v129
    v_add_f32 v146, v146, v130
    v_add_f32 v147, v147, v131
    buffer_load_dwordx4 a[96:99], v20, s[32:35], s58 offen nt
    v_add_f32 v148, v148, v132
    v_add_f32 v149, v149, v133
    v_add_f32 v150, v150, v134
    v_add_f32 v151, v151, v135
    v_add_f32 v152, v152, v136
    v_add_f32 v153, v153, v137
    v_add_f32 v154, v154, v138
    v_add_f32 v155, v155, v139
    v_add_f32 v156, v156, v140
    v_add_f32 v157, v157, v141
    v_add_f32 v158, v158, v142
    v_add_f32 v159, v159, v143
    s_waitcnt lgkmcnt(0)
    v_mfma_f32_32x32x16_bf16 v[128:143], a[32:35], a[0:3], 0
    ds_read_b64_tr_b16 a[64:65], v40 offset:0
    ds_read_b64_tr_b16 a[66:67], v41 offset:2048
    v_add_f32 v160, v160, v176
    v_add_f32 v161, v161, v177
    v_add_f32 v162, v162, v178
    v_add_f32 v163, v163, v179
    v_add_f32 v164, v164, v180
    v_mfma_f32_32x32x16_bf16 v[128:143], a[36:39], a[4:7], v[128:143]
    ds_read_b64_tr_b16 a[72:73], v42 offset:0
    ds_read_b64_tr_b16 a[74:75], v43 offset:2048
    v_add_f32 v165, v165, v181
    v_add_f32 v166, v166, v182
    v_add_f32 v167, v167, v183
    v_add_f32 v168, v168, v184
    v_add_f32 v169, v169, v185
    v_mfma_f32_32x32x16_bf16 v[128:143], a[40:43], a[8:11], v[128:143]
    ds_read_b64_tr_b16 a[80:81], v44 offset:0
    ds_read_b64_tr_b16 a[82:83], v45 offset:2048
    v_add_f32 v170, v170, v186
    v_add_f32 v171, v171, v187
    v_add_f32 v172, v172, v188
    v_add_f32 v173, v173, v189
    v_add_f32 v174, v174, v190
    v_mfma_f32_32x32x16_bf16 v[128:143], a[44:47], a[12:15], v[128:143]
    ds_read_b64_tr_b16 a[88:89], v46 offset:0
    ds_read_b64_tr_b16 a[90:91], v47 offset:2048
    v_add_f32 v175, v175, v191
    v_add_f32 v144, v144, v160
    v_add_f32 v145, v145, v161
    v_add_f32 v146, v146, v162
    v_add_f32 v147, v147, v163
    v_mfma_f32_32x32x16_bf16 v[128:143], a[48:51], a[16:19], v[128:143]
    ds_read_b64_tr_b16 a[68:69], v40 offset:4096
    ds_read_b64_tr_b16 a[70:71], v41 offset:6144
    v_add_f32 v148, v148, v164
    v_add_f32 v149, v149, v165
    v_add_f32 v150, v150, v166
    v_add_f32 v151, v151, v167
    v_add_f32 v152, v152, v168
    v_mfma_f32_32x32x16_bf16 v[128:143], a[52:55], a[20:23], v[128:143]
    ds_read_b64_tr_b16 a[76:77], v42 offset:4096
    ds_read_b64_tr_b16 a[78:79], v43 offset:6144
    v_add_f32 v153, v153, v169
    v_add_f32 v154, v154, v170
    v_add_f32 v155, v155, v171
    v_add_f32 v156, v156, v172
    v_add_f32 v157, v157, v173
    v_mfma_f32_32x32x16_bf16 v[128:143], a[56:59], a[24:27], v[128:143]
    ds_read_b64_tr_b16 a[84:85], v44 offset:4096
    ds_read_b64_tr_b16 a[86:87], v45 offset:6144
    v_add_f32 v158, v158, v174
    v_add_f32 v159, v159, v175
    v_max3_f32 v218, v144, v145, v146
    v_max3_f32 v219, v147, v148, v149
    v_max3_f32 v220, v150, v151, v152
    v_mfma_f32_32x32x16_bf16 v[128:143], a[60:63], a[28:31], v[128:143]
    ds_read_b64_tr_b16 a[92:93], v46 offset:4096
    ds_read_b64_tr_b16 a[94:95], v47 offset:6144
    v_max3_f32 v221, v153, v154, v155
    v_max3_f32 v218, v218, v156, v157
    v_max3_f32 v219, v219, v158, v159
    v_max3_f32 v218, v218, v219, v220
    v_max_f32 v218, v218, v221
    v_mov_b32 v219, v218
    s_nop 1
    v_permlane32_swap_b32 v218, v219
    v_max3_f32 v218, v218, v219, v216
    v_sub_f32 v220, v216, v218
    v_mov_b32 v216, v218
    v_exp_f32 v220, v220
    v_sub_f32 v192, v144, v218
    v_sub_f32 v193, v145, v218
    buffer_load_dwordx4 a[100:103], v21, s[32:35], s58 offen nt
    v_sub_f32 v194, v146, v218
    v_sub_f32 v195, v147, v218
    v_sub_f32 v196, v148, v218
    v_sub_f32 v197, v149, v218
    v_sub_f32 v198, v150, v218
    buffer_load_dwordx4 a[104:107], v22, s[32:35], s58 offen nt
    v_sub_f32 v199, v151, v218
    v_sub_f32 v200, v152, v218
    v_sub_f32 v201, v153, v218
    v_sub_f32 v202, v154, v218
    v_sub_f32 v203, v155, v218
    v_sub_f32 v204, v156, v218
    v_sub_f32 v205, v157, v218
    v_sub_f32 v206, v158, v218
    v_sub_f32 v207, v159, v218
    ds_write_b128 v28, v[128:131] offset:16384
    v_exp_f32 v192, v192
    v_exp_f32 v193, v193
    v_exp_f32 v194, v194
    v_exp_f32 v195, v195
    ds_write_b128 v28, v[132:135] offset:17408
    v_exp_f32 v196, v196
    v_exp_f32 v197, v197
    v_exp_f32 v198, v198
    v_exp_f32 v199, v199
    ds_write_b128 v28, v[136:139] offset:18432
    v_exp_f32 v200, v200
    v_exp_f32 v201, v201
    v_exp_f32 v202, v202
    v_exp_f32 v203, v203
    ds_write_b128 v28, v[140:143] offset:19456
    v_exp_f32 v204, v204
    v_exp_f32 v205, v205
    v_exp_f32 v206, v206
    v_exp_f32 v207, v207
    v_mul_f32 v217, v217, v220
    v_cvt_pk_bf16_f32 v208, v192, v193
    v_cvt_pk_bf16_f32 v209, v194, v195
    v_cvt_pk_bf16_f32 v210, v196, v197
    v_cvt_pk_bf16_f32 v211, v198, v199
    v_cvt_pk_bf16_f32 v212, v200, v201
    v_cvt_pk_bf16_f32 v213, v202, v203
    v_cvt_pk_bf16_f32 v214, v204, v205
    v_cvt_pk_bf16_f32 v215, v206, v207
    v_mul_f32 v64, v64, v220
    v_mul_f32 v65, v65, v220
    v_mul_f32 v66, v66, v220
    v_mul_f32 v67, v67, v220
    v_mul_f32 v68, v68, v220
    v_mul_f32 v69, v69, v220
    v_mul_f32 v70, v70, v220
    v_mul_f32 v71, v71, v220
    v_mul_f32 v72, v72, v220
    v_mul_f32 v73, v73, v220
    v_mul_f32 v74, v74, v220
    v_mul_f32 v75, v75, v220
    v_mul_f32 v76, v76, v220
    v_mul_f32 v77, v77, v220
    v_mul_f32 v78, v78, v220
    v_mul_f32 v79, v79, v220
    s_waitcnt lgkmcnt(0)
    s_barrier
    v_mfma_f32_32x32x16_bf16 v[64:79], a[64:67], v[208:211], v[64:79]
    ds_read_b128 v[144:147], v29 offset:16384
    v_mul_f32 v80, v80, v220
    v_mul_f32 v81, v81, v220
    ds_read_b128 v[148:151], v29 offset:17408
    buffer_load_dwordx4 a[108:111], v23, s[32:35], s58 offen nt
    s_add_u32 s58, s58, 16384
    v_mul_f32 v82, v82, v220
    v_mul_f32 v83, v83, v220
    ds_read_b128 v[152:155], v29 offset:18432
    v_mul_f32 v84, v84, v220
    v_mfma_f32_32x32x16_bf16 v[64:79], a[68:71], v[212:215], v[64:79]
    v_mul_f32 v85, v85, v220
    ds_read_b128 v[156:159], v29 offset:19456
    v_mul_f32 v86, v86, v220
    v_mul_f32 v87, v87, v220
    v_mul_f32 v88, v88, v220
    v_mul_f32 v89, v89, v220
    v_mul_f32 v90, v90, v220
    v_mul_f32 v91, v91, v220
    v_mul_f32 v92, v92, v220
    v_mul_f32 v93, v93, v220
    v_mul_f32 v94, v94, v220
    v_mul_f32 v95, v95, v220
    s_nop 1
    v_mfma_f32_32x32x16_bf16 v[80:95], a[72:75], v[208:211], v[80:95]
    ds_read_b128 v[160:163], v30 offset:16384
    v_mul_f32 v96, v96, v220
    v_mul_f32 v97, v97, v220
    ds_read_b128 v[164:167], v30 offset:17408
    buffer_load_dwordx4 a[112:115], v20, s[32:35], s58 offen nt
    v_mul_f32 v98, v98, v220
    v_mul_f32 v99, v99, v220
    ds_read_b128 v[168:171], v30 offset:18432
    v_mul_f32 v100, v100, v220
    v_mfma_f32_32x32x16_bf16 v[80:95], a[76:79], v[212:215], v[80:95]
    v_mul_f32 v101, v101, v220
    ds_read_b128 v[172:175], v30 offset:19456
    v_mul_f32 v102, v102, v220
    v_mul_f32 v103, v103, v220
    v_mul_f32 v104, v104, v220
    v_mul_f32 v105, v105, v220
    v_mul_f32 v106, v106, v220
    v_mul_f32 v107, v107, v220
    v_mul_f32 v108, v108, v220
    v_mul_f32 v109, v109, v220
    v_mul_f32 v110, v110, v220
    v_mul_f32 v111, v111, v220
    s_nop 1
    v_mfma_f32_32x32x16_bf16 v[96:111], a[80:83], v[208:211], v[96:111]
    ds_read_b128 v[176:179], v31 offset:16384
    v_mul_f32 v112, v112, v220
    v_mul_f32 v113, v113, v220
    ds_read_b128 v[180:183], v31 offset:17408
    v_mul_f32 v114, v114, v220
    v_mul_f32 v115, v115, v220
    ds_read_b128 v[184:187], v31 offset:18432
    v_mul_f32 v116, v116, v220
    v_mfma_f32_32x32x16_bf16 v[96:111], a[84:87], v[212:215], v[96:111]
    v_mul_f32 v117, v117, v220
    ds_read_b128 v[188:191], v31 offset:19456
    v_mul_f32 v118, v118, v220
    buffer_load_dwordx4 a[116:119], v21, s[32:35], s58 offen nt
    v_mul_f32 v119, v119, v220
    v_mul_f32 v120, v120, v220
    v_mul_f32 v121, v121, v220
    v_mul_f32 v122, v122, v220
    v_mul_f32 v123, v123, v220
    v_mul_f32 v124, v124, v220
    v_mul_f32 v125, v125, v220
    v_mul_f32 v126, v126, v220
    v_mul_f32 v127, v127, v220
    s_nop 1
    v_mfma_f32_32x32x16_bf16 v[112:127], a[88:91], v[208:211], v[112:127]
    v_add_f32 v192, v192, v200
    v_add_f32 v193, v193, v201
    v_add_f32 v194, v194, v202
    v_add_f32 v195, v195, v203
    v_add_f32 v196, v196, v204
    v_add_f32 v197, v197, v205
    v_add_f32 v198, v198, v206
    v_add_f32 v199, v199, v207
    v_mfma_f32_32x32x16_bf16 v[112:127], a[92:95], v[212:215], v[112:127]
    v_add_f32 v192, v192, v196
    v_add_f32 v193, v193, v197
    v_add_f32 v194, v194, v198
    v_add_f32 v195, v195, v199
    v_add_f32 v192, v192, v193
    v_add_f32 v194, v194, v195
    v_add_f32 v192, v192, v194
    v_add_f32 v217, v217, v192
    ds_read_b128 a[32:35], v32 offset:16384
    ds_read_b128 a[36:39], v33 offset:16384
    ds_read_b128 a[40:43], v34 offset:16384
    ds_read_b128 a[44:47], v35 offset:16384
    ds_read_b128 a[48:51], v36 offset:16384
    ds_read_b128 a[52:55], v37 offset:16384
    ds_read_b128 a[56:59], v38 offset:16384
    ds_read_b128 a[60:63], v39 offset:16384
    s_waitcnt lgkmcnt(8)
    v_add_f32 v144, v144, v128
    v_add_f32 v145, v145, v129
    v_add_f32 v146, v146, v130
    v_add_f32 v147, v147, v131
    buffer_load_dwordx4 a[120:123], v22, s[32:35], s58 offen nt
    v_add_f32 v148, v148, v132
    v_add_f32 v149, v149, v133
    v_add_f32 v150, v150, v134
    v_add_f32 v151, v151, v135
    v_add_f32 v152, v152, v136
    v_add_f32 v153, v153, v137
    v_add_f32 v154, v154, v138
    v_add_f32 v155, v155, v139
    v_add_f32 v156, v156, v140
    v_add_f32 v157, v157, v141
    v_add_f32 v158, v158, v142
    v_add_f32 v159, v159, v143
    s_waitcnt lgkmcnt(0)
    v_mfma_f32_32x32x16_bf16 v[128:143], a[32:35], a[0:3], 0
    ds_read_b64_tr_b16 a[64:65], v40 offset:8192
    ds_read_b64_tr_b16 a[66:67], v41 offset:10240
    v_add_f32 v160, v160, v176
    v_add_f32 v161, v161, v177
    v_add_f32 v162, v162, v178
    v_add_f32 v163, v163, v179
    v_add_f32 v164, v164, v180
    v_mfma_f32_32x32x16_bf16 v[128:143], a[36:39], a[4:7], v[128:143]
    ds_read_b64_tr_b16 a[72:73], v42 offset:8192
    ds_read_b64_tr_b16 a[74:75], v43 offset:10240
    v_add_f32 v165, v165, v181
    v_add_f32 v166, v166, v182
    v_add_f32 v167, v167, v183
    v_add_f32 v168, v168, v184
    v_add_f32 v169, v169, v185
    v_mfma_f32_32x32x16_bf16 v[128:143], a[40:43], a[8:11], v[128:143]
    ds_read_b64_tr_b16 a[80:81], v44 offset:8192
    ds_read_b64_tr_b16 a[82:83], v45 offset:10240
    v_add_f32 v170, v170, v186
    v_add_f32 v171, v171, v187
    v_add_f32 v172, v172, v188
    v_add_f32 v173, v173, v189
    v_add_f32 v174, v174, v190
    v_mfma_f32_32x32x16_bf16 v[128:143], a[44:47], a[12:15], v[128:143]
    ds_read_b64_tr_b16 a[88:89], v46 offset:8192
    ds_read_b64_tr_b16 a[90:91], v47 offset:10240
    v_add_f32 v175, v175, v191
    v_add_f32 v144, v144, v160
    v_add_f32 v145, v145, v161
    v_add_f32 v146, v146, v162
    v_add_f32 v147, v147, v163
    v_mfma_f32_32x32x16_bf16 v[128:143], a[48:51], a[16:19], v[128:143]
    ds_read_b64_tr_b16 a[68:69], v40 offset:12288
    ds_read_b64_tr_b16 a[70:71], v41 offset:14336
    v_add_f32 v148, v148, v164
    v_add_f32 v149, v149, v165
    v_add_f32 v150, v150, v166
    v_add_f32 v151, v151, v167
    v_add_f32 v152, v152, v168
    v_mfma_f32_32x32x16_bf16 v[128:143], a[52:55], a[20:23], v[128:143]
    ds_read_b64_tr_b16 a[76:77], v42 offset:12288
    ds_read_b64_tr_b16 a[78:79], v43 offset:14336
    v_add_f32 v153, v153, v169
    v_add_f32 v154, v154, v170
    v_add_f32 v155, v155, v171
    v_add_f32 v156, v156, v172
    v_add_f32 v157, v157, v173
    v_mfma_f32_32x32x16_bf16 v[128:143], a[56:59], a[24:27], v[128:143]
    ds_read_b64_tr_b16 a[84:85], v44 offset:12288
    ds_read_b64_tr_b16 a[86:87], v45 offset:14336
    v_add_f32 v158, v158, v174
    v_add_f32 v159, v159, v175
    v_max3_f32 v218, v144, v145, v146
    v_max3_f32 v219, v147, v148, v149
    v_max3_f32 v220, v150, v151, v152
    v_mfma_f32_32x32x16_bf16 v[128:143], a[60:63], a[28:31], v[128:143]
    ds_read_b64_tr_b16 a[92:93], v46 offset:12288
    ds_read_b64_tr_b16 a[94:95], v47 offset:14336
    v_max3_f32 v221, v153, v154, v155
    v_max3_f32 v218, v218, v156, v157
    v_max3_f32 v219, v219, v158, v159
    v_max3_f32 v218, v218, v219, v220
    v_max_f32 v218, v218, v221
    v_mov_b32 v219, v218
    s_nop 1
    v_permlane32_swap_b32 v218, v219
    v_max3_f32 v218, v218, v219, v216
    v_sub_f32 v220, v216, v218
    v_mov_b32 v216, v218
    v_exp_f32 v220, v220
    v_sub_f32 v192, v144, v218
    v_sub_f32 v193, v145, v218
    buffer_load_dwordx4 a[124:127], v23, s[32:35], s58 offen nt
    s_add_u32 s58, s58, 16384
    v_sub_f32 v194, v146, v218
    v_sub_f32 v195, v147, v218
    v_sub_f32 v196, v148, v218
    v_sub_f32 v197, v149, v218
    v_sub_f32 v198, v150, v218
    buffer_load_dwordx4 a[128:131], v20, s[32:35], s58 offen nt
    v_sub_f32 v199, v151, v218
    v_sub_f32 v200, v152, v218
    v_sub_f32 v201, v153, v218
    v_sub_f32 v202, v154, v218
    v_sub_f32 v203, v155, v218
    v_sub_f32 v204, v156, v218
    v_sub_f32 v205, v157, v218
    v_sub_f32 v206, v158, v218
    v_sub_f32 v207, v159, v218
    ds_write_b128 v28, v[128:131] offset:0
    v_exp_f32 v192, v192
    v_exp_f32 v193, v193
    v_exp_f32 v194, v194
    v_exp_f32 v195, v195
    ds_write_b128 v28, v[132:135] offset:1024
    v_exp_f32 v196, v196
    v_exp_f32 v197, v197
    v_exp_f32 v198, v198
    v_exp_f32 v199, v199
    ds_write_b128 v28, v[136:139] offset:2048
    v_exp_f32 v200, v200
    v_exp_f32 v201, v201
    v_exp_f32 v202, v202
    v_exp_f32 v203, v203
    ds_write_b128 v28, v[140:143] offset:3072
    v_exp_f32 v204, v204
    v_exp_f32 v205, v205
    v_exp_f32 v206, v206
    v_exp_f32 v207, v207
    v_mul_f32 v217, v217, v220
    v_cvt_pk_bf16_f32 v208, v192, v193
    v_cvt_pk_bf16_f32 v209, v194, v195
    v_cvt_pk_bf16_f32 v210, v196, v197
    v_cvt_pk_bf16_f32 v211, v198, v199
    v_cvt_pk_bf16_f32 v212, v200, v201
    v_cvt_pk_bf16_f32 v213, v202, v203
    v_cvt_pk_bf16_f32 v214, v204, v205
    v_cvt_pk_bf16_f32 v215, v206, v207
    v_mul_f32 v64, v64, v220
    v_mul_f32 v65, v65, v220
    v_mul_f32 v66, v66, v220
    v_mul_f32 v67, v67, v220
    v_mul_f32 v68, v68, v220
    v_mul_f32 v69, v69, v220
    v_mul_f32 v70, v70, v220
    v_mul_f32 v71, v71, v220
    v_mul_f32 v72, v72, v220
    v_mul_f32 v73, v73, v220
    v_mul_f32 v74, v74, v220
    v_mul_f32 v75, v75, v220
    v_mul_f32 v76, v76, v220
    v_mul_f32 v77, v77, v220
    v_mul_f32 v78, v78, v220
    v_mul_f32 v79, v79, v220
    s_waitcnt lgkmcnt(0)
    s_barrier
    v_mfma_f32_32x32x16_bf16 v[64:79], a[64:67], v[208:211], v[64:79]
    ds_read_b128 v[144:147], v29 offset:0
    v_mul_f32 v80, v80, v220
    v_mul_f32 v81, v81, v220
    ds_read_b128 v[148:151], v29 offset:1024
    s_waitcnt vmcnt(32)
    ds_write_b128 v26, a[192:195] offset:24576
    buffer_load_dwordx4 a[132:135], v21, s[32:35], s58 offen nt
    v_mul_f32 v82, v82, v220
    v_mul_f32 v83, v83, v220
    ds_read_b128 v[152:155], v29 offset:2048
    v_mul_f32 v84, v84, v220
    v_mfma_f32_32x32x16_bf16 v[64:79], a[68:71], v[212:215], v[64:79]
    v_mul_f32 v85, v85, v220
    ds_read_b128 v[156:159], v29 offset:3072
    v_mul_f32 v86, v86, v220
    s_waitcnt vmcnt(32)
    ds_write_b128 v26, a[196:199] offset:25600
    v_mul_f32 v87, v87, v220
    v_mul_f32 v88, v88, v220
    v_mul_f32 v89, v89, v220
    v_mul_f32 v90, v90, v220
    v_mul_f32 v91, v91, v220
    v_mul_f32 v92, v92, v220
    v_mul_f32 v93, v93, v220
    v_mul_f32 v94, v94, v220
    v_mul_f32 v95, v95, v220
    s_nop 1
    v_mfma_f32_32x32x16_bf16 v[80:95], a[72:75], v[208:211], v[80:95]
    ds_read_b128 v[160:163], v30 offset:0
    v_mul_f32 v96, v96, v220
    v_mul_f32 v97, v97, v220
    ds_read_b128 v[164:167], v30 offset:1024
    s_waitcnt vmcnt(31)
    ds_write_b128 v26, a[200:203] offset:26624
    buffer_load_dwordx4 a[136:139], v22, s[32:35], s58 offen nt
    v_mul_f32 v98, v98, v220
    v_mul_f32 v99, v99, v220
    ds_read_b128 v[168:171], v30 offset:2048
    v_mul_f32 v100, v100, v220
    v_mfma_f32_32x32x16_bf16 v[80:95], a[76:79], v[212:215], v[80:95]
    v_mul_f32 v101, v101, v220
    ds_read_b128 v[172:175], v30 offset:3072
    v_mul_f32 v102, v102, v220
    s_waitcnt vmcnt(31)
    ds_write_b128 v26, a[204:207] offset:27648
    v_mul_f32 v103, v103, v220
    v_mul_f32 v104, v104, v220
    v_mul_f32 v105, v105, v220
    v_mul_f32 v106, v106, v220
    v_mul_f32 v107, v107, v220
    v_mul_f32 v108, v108, v220
    v_mul_f32 v109, v109, v220
    v_mul_f32 v110, v110, v220
    v_mul_f32 v111, v111, v220
    s_nop 1
    v_mfma_f32_32x32x16_bf16 v[96:111], a[80:83], v[208:211], v[96:111]
    ds_read_b128 v[176:179], v31 offset:0
    v_mul_f32 v112, v112, v220
    v_mul_f32 v113, v113, v220
    ds_read_b128 v[180:183], v31 offset:1024
    s_waitcnt vmcnt(30)
    ds_write_b128 v26, a[208:211] offset:28672
    v_mul_f32 v114, v114, v220
    v_mul_f32 v115, v115, v220
    ds_read_b128 v[184:187], v31 offset:2048
    v_mul_f32 v116, v116, v220
    v_mfma_f32_32x32x16_bf16 v[96:111], a[84:87], v[212:215], v[96:111]
    v_mul_f32 v117, v117, v220
    ds_read_b128 v[188:191], v31 offset:3072
    v_mul_f32 v118, v118, v220
    s_waitcnt vmcnt(29)
    ds_write_b128 v26, a[212:215] offset:29696
    buffer_load_dwordx4 a[140:143], v23, s[32:35], s58 offen nt
    s_add_u32 s58, s58, 16384
    v_mul_f32 v119, v119, v220
    v_mul_f32 v120, v120, v220
    v_mul_f32 v121, v121, v220
    v_mul_f32 v122, v122, v220
    v_mul_f32 v123, v123, v220
    v_mul_f32 v124, v124, v220
    v_mul_f32 v125, v125, v220
    v_mul_f32 v126, v126, v220
    v_mul_f32 v127, v127, v220
    s_nop 1
    v_mfma_f32_32x32x16_bf16 v[112:127], a[88:91], v[208:211], v[112:127]
    v_add_f32 v192, v192, v200
    v_add_f32 v193, v193, v201
    v_add_f32 v194, v194, v202
    v_add_f32 v195, v195, v203
    s_waitcnt vmcnt(29)
    ds_write_b128 v26, a[216:219] offset:30720
    v_add_f32 v196, v196, v204
    v_add_f32 v197, v197, v205
    v_add_f32 v198, v198, v206
    v_add_f32 v199, v199, v207
    v_mfma_f32_32x32x16_bf16 v[112:127], a[92:95], v[212:215], v[112:127]
    v_add_f32 v192, v192, v196
    v_add_f32 v193, v193, v197
    v_add_f32 v194, v194, v198
    s_waitcnt vmcnt(28)
    ds_write_b128 v26, a[220:223] offset:31744
    v_add_f32 v195, v195, v199
    v_add_f32 v192, v192, v193
    v_add_f32 v194, v194, v195
    v_add_f32 v192, v192, v194
    v_add_f32 v217, v217, v192
    ds_read_b128 a[32:35], v32 offset:24576
    ds_read_b128 a[36:39], v33 offset:24576
    ds_read_b128 a[40:43], v34 offset:24576
    ds_read_b128 a[44:47], v35 offset:24576
    ds_read_b128 a[48:51], v36 offset:24576
    ds_read_b128 a[52:55], v37 offset:24576
    ds_read_b128 a[56:59], v38 offset:24576
    ds_read_b128 a[60:63], v39 offset:24576
    s_waitcnt lgkmcnt(8)
    v_add_f32 v144, v144, v128
    v_add_f32 v145, v145, v129
    v_add_f32 v146, v146, v130
    v_add_f32 v147, v147, v131
    buffer_load_dwordx4 a[144:147], v20, s[32:35], s58 offen nt
    v_add_f32 v148, v148, v132
    v_add_f32 v149, v149, v133
    v_add_f32 v150, v150, v134
    v_add_f32 v151, v151, v135
    v_add_f32 v152, v152, v136
    v_add_f32 v153, v153, v137
    v_add_f32 v154, v154, v138
    v_add_f32 v155, v155, v139
    v_add_f32 v156, v156, v140
    v_add_f32 v157, v157, v141
    v_add_f32 v158, v158, v142
    v_add_f32 v159, v159, v143
    s_waitcnt lgkmcnt(0)
    v_mfma_f32_32x32x16_bf16 v[128:143], a[32:35], a[0:3], 0
    ds_read_b64_tr_b16 a[64:65], v40 offset:16384
    ds_read_b64_tr_b16 a[66:67], v41 offset:18432
    v_add_f32 v160, v160, v176
    v_add_f32 v161, v161, v177
    v_add_f32 v162, v162, v178
    v_add_f32 v163, v163, v179
    v_add_f32 v164, v164, v180
    v_mfma_f32_32x32x16_bf16 v[128:143], a[36:39], a[4:7], v[128:143]
    ds_read_b64_tr_b16 a[72:73], v42 offset:16384
    ds_read_b64_tr_b16 a[74:75], v43 offset:18432
    v_add_f32 v165, v165, v181
    v_add_f32 v166, v166, v182
    v_add_f32 v167, v167, v183
    v_add_f32 v168, v168, v184
    v_add_f32 v169, v169, v185
    v_mfma_f32_32x32x16_bf16 v[128:143], a[40:43], a[8:11], v[128:143]
    ds_read_b64_tr_b16 a[80:81], v44 offset:16384
    ds_read_b64_tr_b16 a[82:83], v45 offset:18432
    v_add_f32 v170, v170, v186
    v_add_f32 v171, v171, v187
    v_add_f32 v172, v172, v188
    v_add_f32 v173, v173, v189
    v_add_f32 v174, v174, v190
    v_mfma_f32_32x32x16_bf16 v[128:143], a[44:47], a[12:15], v[128:143]
    ds_read_b64_tr_b16 a[88:89], v46 offset:16384
    ds_read_b64_tr_b16 a[90:91], v47 offset:18432
    v_add_f32 v175, v175, v191
    v_add_f32 v144, v144, v160
    v_add_f32 v145, v145, v161
    v_add_f32 v146, v146, v162
    v_add_f32 v147, v147, v163
    v_mfma_f32_32x32x16_bf16 v[128:143], a[48:51], a[16:19], v[128:143]
    ds_read_b64_tr_b16 a[68:69], v40 offset:20480
    ds_read_b64_tr_b16 a[70:71], v41 offset:22528
    v_add_f32 v148, v148, v164
    v_add_f32 v149, v149, v165
    v_add_f32 v150, v150, v166
    v_add_f32 v151, v151, v167
    v_add_f32 v152, v152, v168
    v_mfma_f32_32x32x16_bf16 v[128:143], a[52:55], a[20:23], v[128:143]
    ds_read_b64_tr_b16 a[76:77], v42 offset:20480
    ds_read_b64_tr_b16 a[78:79], v43 offset:22528
    v_add_f32 v153, v153, v169
    v_add_f32 v154, v154, v170
    v_add_f32 v155, v155, v171
    v_add_f32 v156, v156, v172
    v_add_f32 v157, v157, v173
    v_mfma_f32_32x32x16_bf16 v[128:143], a[56:59], a[24:27], v[128:143]
    ds_read_b64_tr_b16 a[84:85], v44 offset:20480
    ds_read_b64_tr_b16 a[86:87], v45 offset:22528
    v_add_f32 v158, v158, v174
    v_add_f32 v159, v159, v175
    v_max3_f32 v218, v144, v145, v146
    v_max3_f32 v219, v147, v148, v149
    v_max3_f32 v220, v150, v151, v152
    v_mfma_f32_32x32x16_bf16 v[128:143], a[60:63], a[28:31], v[128:143]
    ds_read_b64_tr_b16 a[92:93], v46 offset:20480
    ds_read_b64_tr_b16 a[94:95], v47 offset:22528
    v_max3_f32 v221, v153, v154, v155
    v_max3_f32 v218, v218, v156, v157
    v_max3_f32 v219, v219, v158, v159
    v_max3_f32 v218, v218, v219, v220
    v_max_f32 v218, v218, v221
    v_mov_b32 v219, v218
    s_nop 1
    v_permlane32_swap_b32 v218, v219
    v_max3_f32 v218, v218, v219, v216
    v_sub_f32 v220, v216, v218
    v_mov_b32 v216, v218
    v_exp_f32 v220, v220
    v_sub_f32 v192, v144, v218
    v_sub_f32 v193, v145, v218
    buffer_load_dwordx4 a[148:151], v21, s[32:35], s58 offen nt
    v_sub_f32 v194, v146, v218
    v_sub_f32 v195, v147, v218
    v_sub_f32 v196, v148, v218
    v_sub_f32 v197, v149, v218
    v_sub_f32 v198, v150, v218
    buffer_load_dwordx4 a[152:155], v22, s[32:35], s58 offen nt
    v_sub_f32 v199, v151, v218
    v_sub_f32 v200, v152, v218
    v_sub_f32 v201, v153, v218
    v_sub_f32 v202, v154, v218
    v_sub_f32 v203, v155, v218
    v_sub_f32 v204, v156, v218
    v_sub_f32 v205, v157, v218
    v_sub_f32 v206, v158, v218
    v_sub_f32 v207, v159, v218
    ds_write_b128 v28, v[128:131] offset:16384
    v_exp_f32 v192, v192
    v_exp_f32 v193, v193
    v_exp_f32 v194, v194
    v_exp_f32 v195, v195
    ds_write_b128 v28, v[132:135] offset:17408
    v_exp_f32 v196, v196
    v_exp_f32 v197, v197
    v_exp_f32 v198, v198
    v_exp_f32 v199, v199
    ds_write_b128 v28, v[136:139] offset:18432
    v_exp_f32 v200, v200
    v_exp_f32 v201, v201
    v_exp_f32 v202, v202
    v_exp_f32 v203, v203
    ds_write_b128 v28, v[140:143] offset:19456
    v_exp_f32 v204, v204
    v_exp_f32 v205, v205
    v_exp_f32 v206, v206
    v_exp_f32 v207, v207
    v_mul_f32 v217, v217, v220
    v_cvt_pk_bf16_f32 v208, v192, v193
    v_cvt_pk_bf16_f32 v209, v194, v195
    v_cvt_pk_bf16_f32 v210, v196, v197
    v_cvt_pk_bf16_f32 v211, v198, v199
    v_cvt_pk_bf16_f32 v212, v200, v201
    v_cvt_pk_bf16_f32 v213, v202, v203
    v_cvt_pk_bf16_f32 v214, v204, v205
    v_cvt_pk_bf16_f32 v215, v206, v207
    v_mul_f32 v64, v64, v220
    v_mul_f32 v65, v65, v220
    v_mul_f32 v66, v66, v220
    v_mul_f32 v67, v67, v220
    v_mul_f32 v68, v68, v220
    v_mul_f32 v69, v69, v220
    v_mul_f32 v70, v70, v220
    v_mul_f32 v71, v71, v220
    v_mul_f32 v72, v72, v220
    v_mul_f32 v73, v73, v220
    v_mul_f32 v74, v74, v220
    v_mul_f32 v75, v75, v220
    v_mul_f32 v76, v76, v220
    v_mul_f32 v77, v77, v220
    v_mul_f32 v78, v78, v220
    v_mul_f32 v79, v79, v220
    s_waitcnt lgkmcnt(0)
    s_barrier
    v_mfma_f32_32x32x16_bf16 v[64:79], a[64:67], v[208:211], v[64:79]
    ds_read_b128 v[144:147], v29 offset:16384
    v_mul_f32 v80, v80, v220
    v_mul_f32 v81, v81, v220
    ds_read_b128 v[148:151], v29 offset:17408
    s_waitcnt vmcnt(30)
    ds_write_b128 v26, a[224:227] offset:0
    buffer_load_dwordx4 a[156:159], v23, s[32:35], s58 offen nt
    s_add_u32 s58, s58, 16384
    v_mul_f32 v82, v82, v220
    v_mul_f32 v83, v83, v220
    ds_read_b128 v[152:155], v29 offset:18432
    v_mul_f32 v84, v84, v220
    v_mfma_f32_32x32x16_bf16 v[64:79], a[68:71], v[212:215], v[64:79]
    v_mul_f32 v85, v85, v220
    ds_read_b128 v[156:159], v29 offset:19456
    v_mul_f32 v86, v86, v220
    s_waitcnt vmcnt(30)
    ds_write_b128 v26, a[228:231] offset:1024
    v_mul_f32 v87, v87, v220
    v_mul_f32 v88, v88, v220
    v_mul_f32 v89, v89, v220
    v_mul_f32 v90, v90, v220
    v_mul_f32 v91, v91, v220
    v_mul_f32 v92, v92, v220
    v_mul_f32 v93, v93, v220
    v_mul_f32 v94, v94, v220
    v_mul_f32 v95, v95, v220
    s_nop 1
    v_mfma_f32_32x32x16_bf16 v[80:95], a[72:75], v[208:211], v[80:95]
    ds_read_b128 v[160:163], v30 offset:16384
    v_mul_f32 v96, v96, v220
    v_mul_f32 v97, v97, v220
    ds_read_b128 v[164:167], v30 offset:17408
    s_waitcnt vmcnt(29)
    ds_write_b128 v26, a[232:235] offset:2048
    buffer_load_dwordx4 a[160:163], v20, s[32:35], s58 offen nt
    v_mul_f32 v98, v98, v220
    v_mul_f32 v99, v99, v220
    ds_read_b128 v[168:171], v30 offset:18432
    v_mul_f32 v100, v100, v220
    v_mfma_f32_32x32x16_bf16 v[80:95], a[76:79], v[212:215], v[80:95]
    v_mul_f32 v101, v101, v220
    ds_read_b128 v[172:175], v30 offset:19456
    v_mul_f32 v102, v102, v220
    s_waitcnt vmcnt(29)
    ds_write_b128 v26, a[236:239] offset:3072
    v_mul_f32 v103, v103, v220
    v_mul_f32 v104, v104, v220
    v_mul_f32 v105, v105, v220
    v_mul_f32 v106, v106, v220
    v_mul_f32 v107, v107, v220
    v_mul_f32 v108, v108, v220
    v_mul_f32 v109, v109, v220
    v_mul_f32 v110, v110, v220
    v_mul_f32 v111, v111, v220
    s_nop 1
    v_mfma_f32_32x32x16_bf16 v[96:111], a[80:83], v[208:211], v[96:111]
    ds_read_b128 v[176:179], v31 offset:16384
    v_mul_f32 v112, v112, v220
    v_mul_f32 v113, v113, v220
    ds_read_b128 v[180:183], v31 offset:17408
    s_waitcnt vmcnt(28)
    ds_write_b128 v26, a[240:243] offset:4096
    v_mul_f32 v114, v114, v220
    v_mul_f32 v115, v115, v220
    ds_read_b128 v[184:187], v31 offset:18432
    v_mul_f32 v116, v116, v220
    v_mfma_f32_32x32x16_bf16 v[96:111], a[84:87], v[212:215], v[96:111]
    v_mul_f32 v117, v117, v220
    ds_read_b128 v[188:191], v31 offset:19456
    v_mul_f32 v118, v118, v220
    s_waitcnt vmcnt(27)
    ds_write_b128 v26, a[244:247] offset:5120
    buffer_load_dwordx4 a[164:167], v21, s[32:35], s58 offen nt
    v_mul_f32 v119, v119, v220
    v_mul_f32 v120, v120, v220
    v_mul_f32 v121, v121, v220
    v_mul_f32 v122, v122, v220
    v_mul_f32 v123, v123, v220
    v_mul_f32 v124, v124, v220
    v_mul_f32 v125, v125, v220
    v_mul_f32 v126, v126, v220
    v_mul_f32 v127, v127, v220
    s_nop 1
    v_mfma_f32_32x32x16_bf16 v[112:127], a[88:91], v[208:211], v[112:127]
    v_add_f32 v192, v192, v200
    v_add_f32 v193, v193, v201
    v_add_f32 v194, v194, v202
    v_add_f32 v195, v195, v203
    s_waitcnt vmcnt(27)
    ds_write_b128 v26, a[248:251] offset:6144
    v_add_f32 v196, v196, v204
    v_add_f32 v197, v197, v205
    v_add_f32 v198, v198, v206
    v_add_f32 v199, v199, v207
    v_mfma_f32_32x32x16_bf16 v[112:127], a[92:95], v[212:215], v[112:127]
    v_add_f32 v192, v192, v196
    v_add_f32 v193, v193, v197
    v_add_f32 v194, v194, v198
    s_waitcnt vmcnt(26)
    ds_write_b128 v26, a[252:255] offset:7168
    v_add_f32 v195, v195, v199
    v_add_f32 v192, v192, v193
    v_add_f32 v194, v194, v195
    v_add_f32 v192, v192, v194
    v_add_f32 v217, v217, v192
    ds_read_b128 a[32:35], v32 offset:0
    ds_read_b128 a[36:39], v33 offset:0
    ds_read_b128 a[40:43], v34 offset:0
    ds_read_b128 a[44:47], v35 offset:0
    ds_read_b128 a[48:51], v36 offset:0
    ds_read_b128 a[52:55], v37 offset:0
    ds_read_b128 a[56:59], v38 offset:0
    ds_read_b128 a[60:63], v39 offset:0
    s_waitcnt lgkmcnt(8)
    v_add_f32 v144, v144, v128
    v_add_f32 v145, v145, v129
    v_add_f32 v146, v146, v130
    v_add_f32 v147, v147, v131
    buffer_load_dwordx4 a[168:171], v22, s[32:35], s58 offen nt
    v_add_f32 v148, v148, v132
    v_add_f32 v149, v149, v133
    v_add_f32 v150, v150, v134
    v_add_f32 v151, v151, v135
    v_add_f32 v152, v152, v136
    v_add_f32 v153, v153, v137
    v_add_f32 v154, v154, v138
    v_add_f32 v155, v155, v139
    v_add_f32 v156, v156, v140
    v_add_f32 v157, v157, v141
    v_add_f32 v158, v158, v142
    v_add_f32 v159, v159, v143
    s_waitcnt lgkmcnt(0)
    v_mfma_f32_32x32x16_bf16 v[128:143], a[32:35], a[0:3], 0
    ds_read_b64_tr_b16 a[64:65], v40 offset:24576
    ds_read_b64_tr_b16 a[66:67], v41 offset:26624
    v_add_f32 v160, v160, v176
    v_add_f32 v161, v161, v177
    v_add_f32 v162, v162, v178
    v_add_f32 v163, v163, v179
    v_add_f32 v164, v164, v180
    v_mfma_f32_32x32x16_bf16 v[128:143], a[36:39], a[4:7], v[128:143]
    ds_read_b64_tr_b16 a[72:73], v42 offset:24576
    ds_read_b64_tr_b16 a[74:75], v43 offset:26624
    v_add_f32 v165, v165, v181
    v_add_f32 v166, v166, v182
    v_add_f32 v167, v167, v183
    v_add_f32 v168, v168, v184
    v_add_f32 v169, v169, v185
    v_mfma_f32_32x32x16_bf16 v[128:143], a[40:43], a[8:11], v[128:143]
    ds_read_b64_tr_b16 a[80:81], v44 offset:24576
    ds_read_b64_tr_b16 a[82:83], v45 offset:26624
    v_add_f32 v170, v170, v186
    v_add_f32 v171, v171, v187
    v_add_f32 v172, v172, v188
    v_add_f32 v173, v173, v189
    v_add_f32 v174, v174, v190
    v_mfma_f32_32x32x16_bf16 v[128:143], a[44:47], a[12:15], v[128:143]
    ds_read_b64_tr_b16 a[88:89], v46 offset:24576
    ds_read_b64_tr_b16 a[90:91], v47 offset:26624
    v_add_f32 v175, v175, v191
    v_add_f32 v144, v144, v160
    v_add_f32 v145, v145, v161
    v_add_f32 v146, v146, v162
    v_add_f32 v147, v147, v163
    v_mfma_f32_32x32x16_bf16 v[128:143], a[48:51], a[16:19], v[128:143]
    ds_read_b64_tr_b16 a[68:69], v40 offset:28672
    ds_read_b64_tr_b16 a[70:71], v41 offset:30720
    v_add_f32 v148, v148, v164
    v_add_f32 v149, v149, v165
    v_add_f32 v150, v150, v166
    v_add_f32 v151, v151, v167
    v_add_f32 v152, v152, v168
    v_mfma_f32_32x32x16_bf16 v[128:143], a[52:55], a[20:23], v[128:143]
    ds_read_b64_tr_b16 a[76:77], v42 offset:28672
    ds_read_b64_tr_b16 a[78:79], v43 offset:30720
    v_add_f32 v153, v153, v169
    v_add_f32 v154, v154, v170
    v_add_f32 v155, v155, v171
    v_add_f32 v156, v156, v172
    v_add_f32 v157, v157, v173
    v_mfma_f32_32x32x16_bf16 v[128:143], a[56:59], a[24:27], v[128:143]
    ds_read_b64_tr_b16 a[84:85], v44 offset:28672
    ds_read_b64_tr_b16 a[86:87], v45 offset:30720
    v_add_f32 v158, v158, v174
    v_add_f32 v159, v159, v175
    v_max3_f32 v218, v144, v145, v146
    v_max3_f32 v219, v147, v148, v149
    v_max3_f32 v220, v150, v151, v152
    v_mfma_f32_32x32x16_bf16 v[128:143], a[60:63], a[28:31], v[128:143]
    ds_read_b64_tr_b16 a[92:93], v46 offset:28672
    ds_read_b64_tr_b16 a[94:95], v47 offset:30720
    v_max3_f32 v221, v153, v154, v155
    v_max3_f32 v218, v218, v156, v157
    v_max3_f32 v219, v219, v158, v159
    v_max3_f32 v218, v218, v219, v220
    v_max_f32 v218, v218, v221
    v_mov_b32 v219, v218
    s_nop 1
    v_permlane32_swap_b32 v218, v219
    v_max3_f32 v218, v218, v219, v216
    v_sub_f32 v220, v216, v218
    v_mov_b32 v216, v218
    v_exp_f32 v220, v220
    v_sub_f32 v192, v144, v218
    v_sub_f32 v193, v145, v218
    buffer_load_dwordx4 a[172:175], v23, s[32:35], s58 offen nt
    s_add_u32 s58, s58, 16384
    v_sub_f32 v194, v146, v218
    v_sub_f32 v195, v147, v218
    v_sub_f32 v196, v148, v218
    v_sub_f32 v197, v149, v218
    v_sub_f32 v198, v150, v218
    buffer_load_dwordx4 a[176:179], v20, s[32:35], s58 offen nt
    v_sub_f32 v199, v151, v218
    v_sub_f32 v200, v152, v218
    v_sub_f32 v201, v153, v218
    v_sub_f32 v202, v154, v218
    v_sub_f32 v203, v155, v218
    v_sub_f32 v204, v156, v218
    v_sub_f32 v205, v157, v218
    v_sub_f32 v206, v158, v218
    v_sub_f32 v207, v159, v218
    ds_write_b128 v28, v[128:131] offset:0
    v_exp_f32 v192, v192
    v_exp_f32 v193, v193
    v_exp_f32 v194, v194
    v_exp_f32 v195, v195
    ds_write_b128 v28, v[132:135] offset:1024
    v_exp_f32 v196, v196
    v_exp_f32 v197, v197
    v_exp_f32 v198, v198
    v_exp_f32 v199, v199
    ds_write_b128 v28, v[136:139] offset:2048
    v_exp_f32 v200, v200
    v_exp_f32 v201, v201
    v_exp_f32 v202, v202
    v_exp_f32 v203, v203
    ds_write_b128 v28, v[140:143] offset:3072
    v_exp_f32 v204, v204
    v_exp_f32 v205, v205
    v_exp_f32 v206, v206
    v_exp_f32 v207, v207
    v_mul_f32 v217, v217, v220
    v_cvt_pk_bf16_f32 v208, v192, v193
    v_cvt_pk_bf16_f32 v209, v194, v195
    v_cvt_pk_bf16_f32 v210, v196, v197
    v_cvt_pk_bf16_f32 v211, v198, v199
    v_cvt_pk_bf16_f32 v212, v200, v201
    v_cvt_pk_bf16_f32 v213, v202, v203
    v_cvt_pk_bf16_f32 v214, v204, v205
    v_cvt_pk_bf16_f32 v215, v206, v207
    v_mul_f32 v64, v64, v220
    v_mul_f32 v65, v65, v220
    v_mul_f32 v66, v66, v220
    v_mul_f32 v67, v67, v220
    v_mul_f32 v68, v68, v220
    v_mul_f32 v69, v69, v220
    v_mul_f32 v70, v70, v220
    v_mul_f32 v71, v71, v220
    v_mul_f32 v72, v72, v220
    v_mul_f32 v73, v73, v220
    v_mul_f32 v74, v74, v220
    v_mul_f32 v75, v75, v220
    v_mul_f32 v76, v76, v220
    v_mul_f32 v77, v77, v220
    v_mul_f32 v78, v78, v220
    v_mul_f32 v79, v79, v220
    s_waitcnt lgkmcnt(0)
    s_barrier
    v_mfma_f32_32x32x16_bf16 v[64:79], a[64:67], v[208:211], v[64:79]
    ds_read_b128 v[144:147], v29 offset:0
    v_mul_f32 v80, v80, v220
    v_mul_f32 v81, v81, v220
    ds_read_b128 v[148:151], v29 offset:1024
    s_waitcnt vmcnt(28)
    ds_write_b128 v26, v[224:227] offset:8192
    buffer_load_dwordx4 a[180:183], v21, s[32:35], s58 offen nt
    v_mul_f32 v82, v82, v220
    v_mul_f32 v83, v83, v220
    ds_read_b128 v[152:155], v29 offset:2048
    v_mul_f32 v84, v84, v220
    v_mfma_f32_32x32x16_bf16 v[64:79], a[68:71], v[212:215], v[64:79]
    v_mul_f32 v85, v85, v220
    ds_read_b128 v[156:159], v29 offset:3072
    v_mul_f32 v86, v86, v220
    s_waitcnt vmcnt(28)
    ds_write_b128 v26, v[228:231] offset:9216
    v_mul_f32 v87, v87, v220
    v_mul_f32 v88, v88, v220
    v_mul_f32 v89, v89, v220
    v_mul_f32 v90, v90, v220
    v_mul_f32 v91, v91, v220
    v_mul_f32 v92, v92, v220
    v_mul_f32 v93, v93, v220
    v_mul_f32 v94, v94, v220
    v_mul_f32 v95, v95, v220
    s_nop 1
    v_mfma_f32_32x32x16_bf16 v[80:95], a[72:75], v[208:211], v[80:95]
    ds_read_b128 v[160:163], v30 offset:0
    v_mul_f32 v96, v96, v220
    v_mul_f32 v97, v97, v220
    ds_read_b128 v[164:167], v30 offset:1024
    s_waitcnt vmcnt(27)
    ds_write_b128 v26, v[232:235] offset:10240
    buffer_load_dwordx4 a[184:187], v22, s[32:35], s58 offen nt
    v_mul_f32 v98, v98, v220
    v_mul_f32 v99, v99, v220
    ds_read_b128 v[168:171], v30 offset:2048
    v_mul_f32 v100, v100, v220
    v_mfma_f32_32x32x16_bf16 v[80:95], a[76:79], v[212:215], v[80:95]
    v_mul_f32 v101, v101, v220
    ds_read_b128 v[172:175], v30 offset:3072
    v_mul_f32 v102, v102, v220
    s_waitcnt vmcnt(27)
    ds_write_b128 v26, v[236:239] offset:11264
    v_mul_f32 v103, v103, v220
    v_mul_f32 v104, v104, v220
    v_mul_f32 v105, v105, v220
    v_mul_f32 v106, v106, v220
    v_mul_f32 v107, v107, v220
    v_mul_f32 v108, v108, v220
    v_mul_f32 v109, v109, v220
    v_mul_f32 v110, v110, v220
    v_mul_f32 v111, v111, v220
    s_nop 1
    v_mfma_f32_32x32x16_bf16 v[96:111], a[80:83], v[208:211], v[96:111]
    ds_read_b128 v[176:179], v31 offset:0
    v_mul_f32 v112, v112, v220
    v_mul_f32 v113, v113, v220
    ds_read_b128 v[180:183], v31 offset:1024
    s_waitcnt vmcnt(26)
    ds_write_b128 v26, v[240:243] offset:12288
    v_mul_f32 v114, v114, v220
    v_mul_f32 v115, v115, v220
    ds_read_b128 v[184:187], v31 offset:2048
    v_mul_f32 v116, v116, v220
    v_mfma_f32_32x32x16_bf16 v[96:111], a[84:87], v[212:215], v[96:111]
    v_mul_f32 v117, v117, v220
    ds_read_b128 v[188:191], v31 offset:3072
    v_mul_f32 v118, v118, v220
    s_waitcnt vmcnt(25)
    ds_write_b128 v26, v[244:247] offset:13312
    buffer_load_dwordx4 a[188:191], v23, s[32:35], s58 offen nt
    s_add_u32 s58, s58, 16384
    v_mul_f32 v119, v119, v220
    v_mul_f32 v120, v120, v220
    v_mul_f32 v121, v121, v220
    v_mul_f32 v122, v122, v220
    v_mul_f32 v123, v123, v220
    v_mul_f32 v124, v124, v220
    v_mul_f32 v125, v125, v220
    v_mul_f32 v126, v126, v220
    v_mul_f32 v127, v127, v220
    s_nop 1
    v_mfma_f32_32x32x16_bf16 v[112:127], a[88:91], v[208:211], v[112:127]
    v_add_f32 v192, v192, v200
    v_add_f32 v193, v193, v201
    v_add_f32 v194, v194, v202
    v_add_f32 v195, v195, v203
    s_waitcnt vmcnt(25)
    ds_write_b128 v26, v[248:251] offset:14336
    v_add_f32 v196, v196, v204
    v_add_f32 v197, v197, v205
    v_add_f32 v198, v198, v206
    v_add_f32 v199, v199, v207
    v_mfma_f32_32x32x16_bf16 v[112:127], a[92:95], v[212:215], v[112:127]
    v_add_f32 v192, v192, v196
    v_add_f32 v193, v193, v197
    v_add_f32 v194, v194, v198
    s_waitcnt vmcnt(24)
    ds_write_b128 v26, v[252:255] offset:15360
    v_add_f32 v195, v195, v199
    v_add_f32 v192, v192, v193
    v_add_f32 v194, v194, v195
    v_add_f32 v192, v192, v194
    v_add_f32 v217, v217, v192
    ds_read_b128 a[32:35], v32 offset:8192
    ds_read_b128 a[36:39], v33 offset:8192
    ds_read_b128 a[40:43], v34 offset:8192
    ds_read_b128 a[44:47], v35 offset:8192
    ds_read_b128 a[48:51], v36 offset:8192
    ds_read_b128 a[52:55], v37 offset:8192
    ds_read_b128 a[56:59], v38 offset:8192
    ds_read_b128 a[60:63], v39 offset:8192
    s_waitcnt lgkmcnt(8)
    v_add_f32 v144, v144, v128
    v_add_f32 v145, v145, v129
    v_add_f32 v146, v146, v130
    v_add_f32 v147, v147, v131
    buffer_load_dwordx4 a[192:195], v20, s[32:35], s58 offen nt
    v_add_f32 v148, v148, v132
    v_add_f32 v149, v149, v133
    v_add_f32 v150, v150, v134
    v_add_f32 v151, v151, v135
    v_add_f32 v152, v152, v136
    v_add_f32 v153, v153, v137
    v_add_f32 v154, v154, v138
    v_add_f32 v155, v155, v139
    v_add_f32 v156, v156, v140
    v_add_f32 v157, v157, v141
    v_add_f32 v158, v158, v142
    v_add_f32 v159, v159, v143
    s_waitcnt lgkmcnt(0)
    v_mfma_f32_32x32x16_bf16 v[128:143], a[32:35], a[0:3], 0
    ds_read_b64_tr_b16 a[64:65], v40 offset:0
    ds_read_b64_tr_b16 a[66:67], v41 offset:2048
    v_add_f32 v160, v160, v176
    v_add_f32 v161, v161, v177
    v_add_f32 v162, v162, v178
    v_add_f32 v163, v163, v179
    v_add_f32 v164, v164, v180
    v_mfma_f32_32x32x16_bf16 v[128:143], a[36:39], a[4:7], v[128:143]
    ds_read_b64_tr_b16 a[72:73], v42 offset:0
    ds_read_b64_tr_b16 a[74:75], v43 offset:2048
    v_add_f32 v165, v165, v181
    v_add_f32 v166, v166, v182
    v_add_f32 v167, v167, v183
    v_add_f32 v168, v168, v184
    v_add_f32 v169, v169, v185
    v_mfma_f32_32x32x16_bf16 v[128:143], a[40:43], a[8:11], v[128:143]
    ds_read_b64_tr_b16 a[80:81], v44 offset:0
    ds_read_b64_tr_b16 a[82:83], v45 offset:2048
    v_add_f32 v170, v170, v186
    v_add_f32 v171, v171, v187
    v_add_f32 v172, v172, v188
    v_add_f32 v173, v173, v189
    v_add_f32 v174, v174, v190
    v_mfma_f32_32x32x16_bf16 v[128:143], a[44:47], a[12:15], v[128:143]
    ds_read_b64_tr_b16 a[88:89], v46 offset:0
    ds_read_b64_tr_b16 a[90:91], v47 offset:2048
    v_add_f32 v175, v175, v191
    v_add_f32 v144, v144, v160
    v_add_f32 v145, v145, v161
    v_add_f32 v146, v146, v162
    v_add_f32 v147, v147, v163
    v_mfma_f32_32x32x16_bf16 v[128:143], a[48:51], a[16:19], v[128:143]
    ds_read_b64_tr_b16 a[68:69], v40 offset:4096
    ds_read_b64_tr_b16 a[70:71], v41 offset:6144
    v_add_f32 v148, v148, v164
    v_add_f32 v149, v149, v165
    v_add_f32 v150, v150, v166
    v_add_f32 v151, v151, v167
    v_add_f32 v152, v152, v168
    v_mfma_f32_32x32x16_bf16 v[128:143], a[52:55], a[20:23], v[128:143]
    ds_read_b64_tr_b16 a[76:77], v42 offset:4096
    ds_read_b64_tr_b16 a[78:79], v43 offset:6144
    v_add_f32 v153, v153, v169
    v_add_f32 v154, v154, v170
    v_add_f32 v155, v155, v171
    v_add_f32 v156, v156, v172
    v_add_f32 v157, v157, v173
    v_mfma_f32_32x32x16_bf16 v[128:143], a[56:59], a[24:27], v[128:143]
    ds_read_b64_tr_b16 a[84:85], v44 offset:4096
    ds_read_b64_tr_b16 a[86:87], v45 offset:6144
    v_add_f32 v158, v158, v174
    v_add_f32 v159, v159, v175
    v_max3_f32 v218, v144, v145, v146
    v_max3_f32 v219, v147, v148, v149
    v_max3_f32 v220, v150, v151, v152
    v_mfma_f32_32x32x16_bf16 v[128:143], a[60:63], a[28:31], v[128:143]
    ds_read_b64_tr_b16 a[92:93], v46 offset:4096
    ds_read_b64_tr_b16 a[94:95], v47 offset:6144
    v_max3_f32 v221, v153, v154, v155
    v_max3_f32 v218, v218, v156, v157
    v_max3_f32 v219, v219, v158, v159
    v_max3_f32 v218, v218, v219, v220
    v_max_f32 v218, v218, v221
    v_mov_b32 v219, v218
    s_nop 1
    v_permlane32_swap_b32 v218, v219
    v_max3_f32 v218, v218, v219, v216
    v_sub_f32 v220, v216, v218
    v_mov_b32 v216, v218
    v_exp_f32 v220, v220
    v_sub_f32 v192, v144, v218
    v_sub_f32 v193, v145, v218
    buffer_load_dwordx4 a[196:199], v21, s[32:35], s58 offen nt
    v_sub_f32 v194, v146, v218
    v_sub_f32 v195, v147, v218
    v_sub_f32 v196, v148, v218
    v_sub_f32 v197, v149, v218
    v_sub_f32 v198, v150, v218
    buffer_load_dwordx4 a[200:203], v22, s[32:35], s58 offen nt
    v_sub_f32 v199, v151, v218
    v_sub_f32 v200, v152, v218
    v_sub_f32 v201, v153, v218
    v_sub_f32 v202, v154, v218
    v_sub_f32 v203, v155, v218
    v_sub_f32 v204, v156, v218
    v_sub_f32 v205, v157, v218
    v_sub_f32 v206, v158, v218
    v_sub_f32 v207, v159, v218
    ds_write_b128 v28, v[128:131] offset:16384
    v_exp_f32 v192, v192
    v_exp_f32 v193, v193
    v_exp_f32 v194, v194
    v_exp_f32 v195, v195
    ds_write_b128 v28, v[132:135] offset:17408
    v_exp_f32 v196, v196
    v_exp_f32 v197, v197
    v_exp_f32 v198, v198
    v_exp_f32 v199, v199
    ds_write_b128 v28, v[136:139] offset:18432
    v_exp_f32 v200, v200
    v_exp_f32 v201, v201
    v_exp_f32 v202, v202
    v_exp_f32 v203, v203
    ds_write_b128 v28, v[140:143] offset:19456
    v_exp_f32 v204, v204
    v_exp_f32 v205, v205
    v_exp_f32 v206, v206
    v_exp_f32 v207, v207
    v_mul_f32 v217, v217, v220
    v_cvt_pk_bf16_f32 v208, v192, v193
    v_cvt_pk_bf16_f32 v209, v194, v195
    v_cvt_pk_bf16_f32 v210, v196, v197
    v_cvt_pk_bf16_f32 v211, v198, v199
    v_cvt_pk_bf16_f32 v212, v200, v201
    v_cvt_pk_bf16_f32 v213, v202, v203
    v_cvt_pk_bf16_f32 v214, v204, v205
    v_cvt_pk_bf16_f32 v215, v206, v207
    v_mul_f32 v64, v64, v220
    v_mul_f32 v65, v65, v220
    v_mul_f32 v66, v66, v220
    v_mul_f32 v67, v67, v220
    v_mul_f32 v68, v68, v220
    v_mul_f32 v69, v69, v220
    v_mul_f32 v70, v70, v220
    v_mul_f32 v71, v71, v220
    v_mul_f32 v72, v72, v220
    v_mul_f32 v73, v73, v220
    v_mul_f32 v74, v74, v220
    v_mul_f32 v75, v75, v220
    v_mul_f32 v76, v76, v220
    v_mul_f32 v77, v77, v220
    v_mul_f32 v78, v78, v220
    v_mul_f32 v79, v79, v220
    s_waitcnt lgkmcnt(0)
    s_barrier
    v_mfma_f32_32x32x16_bf16 v[64:79], a[64:67], v[208:211], v[64:79]
    ds_read_b128 v[144:147], v29 offset:16384
    v_mul_f32 v80, v80, v220
    v_mul_f32 v81, v81, v220
    ds_read_b128 v[148:151], v29 offset:17408
    s_waitcnt vmcnt(26)
    ds_write_b128 v26, a[96:99] offset:16384
    buffer_load_dwordx4 a[204:207], v23, s[32:35], s58 offen nt
    s_add_u32 s58, s58, 16384
    v_mul_f32 v82, v82, v220
    v_mul_f32 v83, v83, v220
    ds_read_b128 v[152:155], v29 offset:18432
    v_mul_f32 v84, v84, v220
    v_mfma_f32_32x32x16_bf16 v[64:79], a[68:71], v[212:215], v[64:79]
    v_mul_f32 v85, v85, v220
    ds_read_b128 v[156:159], v29 offset:19456
    v_mul_f32 v86, v86, v220
    s_waitcnt vmcnt(26)
    ds_write_b128 v26, a[100:103] offset:17408
    v_mul_f32 v87, v87, v220
    v_mul_f32 v88, v88, v220
    v_mul_f32 v89, v89, v220
    v_mul_f32 v90, v90, v220
    v_mul_f32 v91, v91, v220
    v_mul_f32 v92, v92, v220
    v_mul_f32 v93, v93, v220
    v_mul_f32 v94, v94, v220
    v_mul_f32 v95, v95, v220
    s_nop 1
    v_mfma_f32_32x32x16_bf16 v[80:95], a[72:75], v[208:211], v[80:95]
    ds_read_b128 v[160:163], v30 offset:16384
    v_mul_f32 v96, v96, v220
    v_mul_f32 v97, v97, v220
    ds_read_b128 v[164:167], v30 offset:17408
    s_waitcnt vmcnt(25)
    ds_write_b128 v26, a[104:107] offset:18432
    buffer_load_dwordx4 a[208:211], v20, s[32:35], s58 offen nt
    v_mul_f32 v98, v98, v220
    v_mul_f32 v99, v99, v220
    ds_read_b128 v[168:171], v30 offset:18432
    v_mul_f32 v100, v100, v220
    v_mfma_f32_32x32x16_bf16 v[80:95], a[76:79], v[212:215], v[80:95]
    v_mul_f32 v101, v101, v220
    ds_read_b128 v[172:175], v30 offset:19456
    v_mul_f32 v102, v102, v220
    s_waitcnt vmcnt(25)
    ds_write_b128 v26, a[108:111] offset:19456
    v_mul_f32 v103, v103, v220
    v_mul_f32 v104, v104, v220
    v_mul_f32 v105, v105, v220
    v_mul_f32 v106, v106, v220
    v_mul_f32 v107, v107, v220
    v_mul_f32 v108, v108, v220
    v_mul_f32 v109, v109, v220
    v_mul_f32 v110, v110, v220
    v_mul_f32 v111, v111, v220
    s_nop 1
    v_mfma_f32_32x32x16_bf16 v[96:111], a[80:83], v[208:211], v[96:111]
    ds_read_b128 v[176:179], v31 offset:16384
    v_mul_f32 v112, v112, v220
    v_mul_f32 v113, v113, v220
    ds_read_b128 v[180:183], v31 offset:17408
    s_waitcnt vmcnt(24)
    ds_write_b128 v26, a[112:115] offset:20480
    v_mul_f32 v114, v114, v220
    v_mul_f32 v115, v115, v220
    ds_read_b128 v[184:187], v31 offset:18432
    v_mul_f32 v116, v116, v220
    v_mfma_f32_32x32x16_bf16 v[96:111], a[84:87], v[212:215], v[96:111]
    v_mul_f32 v117, v117, v220
    ds_read_b128 v[188:191], v31 offset:19456
    v_mul_f32 v118, v118, v220
    s_waitcnt vmcnt(23)
    ds_write_b128 v26, a[116:119] offset:21504
    buffer_load_dwordx4 a[212:215], v21, s[32:35], s58 offen nt
    v_mul_f32 v119, v119, v220
    v_mul_f32 v120, v120, v220
    v_mul_f32 v121, v121, v220
    v_mul_f32 v122, v122, v220
    v_mul_f32 v123, v123, v220
    v_mul_f32 v124, v124, v220
    v_mul_f32 v125, v125, v220
    v_mul_f32 v126, v126, v220
    v_mul_f32 v127, v127, v220
    s_nop 1
    v_mfma_f32_32x32x16_bf16 v[112:127], a[88:91], v[208:211], v[112:127]
    v_add_f32 v192, v192, v200
    v_add_f32 v193, v193, v201
    v_add_f32 v194, v194, v202
    v_add_f32 v195, v195, v203
    s_waitcnt vmcnt(23)
    ds_write_b128 v26, a[120:123] offset:22528
    v_add_f32 v196, v196, v204
    v_add_f32 v197, v197, v205
    v_add_f32 v198, v198, v206
    v_add_f32 v199, v199, v207
    v_mfma_f32_32x32x16_bf16 v[112:127], a[92:95], v[212:215], v[112:127]
    v_add_f32 v192, v192, v196
    v_add_f32 v193, v193, v197
    v_add_f32 v194, v194, v198
    s_waitcnt vmcnt(22)
    ds_write_b128 v26, a[124:127] offset:23552
    v_add_f32 v195, v195, v199
    v_add_f32 v192, v192, v193
    v_add_f32 v194, v194, v195
    v_add_f32 v192, v192, v194
    v_add_f32 v217, v217, v192
    ds_read_b128 a[32:35], v32 offset:16384
    ds_read_b128 a[36:39], v33 offset:16384
    ds_read_b128 a[40:43], v34 offset:16384
    ds_read_b128 a[44:47], v35 offset:16384
    ds_read_b128 a[48:51], v36 offset:16384
    ds_read_b128 a[52:55], v37 offset:16384
    ds_read_b128 a[56:59], v38 offset:16384
    ds_read_b128 a[60:63], v39 offset:16384
    s_waitcnt lgkmcnt(8)
    v_add_f32 v144, v144, v128
    v_add_f32 v145, v145, v129
    v_add_f32 v146, v146, v130
    v_add_f32 v147, v147, v131
    buffer_load_dwordx4 a[216:219], v22, s[32:35], s58 offen nt
    v_add_f32 v148, v148, v132
    v_add_f32 v149, v149, v133
    v_add_f32 v150, v150, v134
    v_add_f32 v151, v151, v135
    v_add_f32 v152, v152, v136
    v_add_f32 v153, v153, v137
    v_add_f32 v154, v154, v138
    v_add_f32 v155, v155, v139
    v_add_f32 v156, v156, v140
    v_add_f32 v157, v157, v141
    v_add_f32 v158, v158, v142
    v_add_f32 v159, v159, v143
    s_waitcnt lgkmcnt(0)
    v_mfma_f32_32x32x16_bf16 v[128:143], a[32:35], a[0:3], 0
    ds_read_b64_tr_b16 a[64:65], v40 offset:8192
    ds_read_b64_tr_b16 a[66:67], v41 offset:10240
    v_add_f32 v160, v160, v176
    v_add_f32 v161, v161, v177
    v_add_f32 v162, v162, v178
    v_add_f32 v163, v163, v179
    v_add_f32 v164, v164, v180
    v_mfma_f32_32x32x16_bf16 v[128:143], a[36:39], a[4:7], v[128:143]
    ds_read_b64_tr_b16 a[72:73], v42 offset:8192
    ds_read_b64_tr_b16 a[74:75], v43 offset:10240
    v_add_f32 v165, v165, v181
    v_add_f32 v166, v166, v182
    v_add_f32 v167, v167, v183
    v_add_f32 v168, v168, v184
    v_add_f32 v169, v169, v185
    v_mfma_f32_32x32x16_bf16 v[128:143], a[40:43], a[8:11], v[128:143]
    ds_read_b64_tr_b16 a[80:81], v44 offset:8192
    ds_read_b64_tr_b16 a[82:83], v45 offset:10240
    v_add_f32 v170, v170, v186
    v_add_f32 v171, v171, v187
    v_add_f32 v172, v172, v188
    v_add_f32 v173, v173, v189
    v_add_f32 v174, v174, v190
    v_mfma_f32_32x32x16_bf16 v[128:143], a[44:47], a[12:15], v[128:143]
    ds_read_b64_tr_b16 a[88:89], v46 offset:8192
    ds_read_b64_tr_b16 a[90:91], v47 offset:10240
    v_add_f32 v175, v175, v191
    v_add_f32 v144, v144, v160
    v_add_f32 v145, v145, v161
    v_add_f32 v146, v146, v162
    v_add_f32 v147, v147, v163
    v_mfma_f32_32x32x16_bf16 v[128:143], a[48:51], a[16:19], v[128:143]
    ds_read_b64_tr_b16 a[68:69], v40 offset:12288
    ds_read_b64_tr_b16 a[70:71], v41 offset:14336
    v_add_f32 v148, v148, v164
    v_add_f32 v149, v149, v165
    v_add_f32 v150, v150, v166
    v_add_f32 v151, v151, v167
    v_add_f32 v152, v152, v168
    v_mfma_f32_32x32x16_bf16 v[128:143], a[52:55], a[20:23], v[128:143]
    ds_read_b64_tr_b16 a[76:77], v42 offset:12288
    ds_read_b64_tr_b16 a[78:79], v43 offset:14336
    v_add_f32 v153, v153, v169
    v_add_f32 v154, v154, v170
    v_add_f32 v155, v155, v171
    v_add_f32 v156, v156, v172
    v_add_f32 v157, v157, v173
    v_mfma_f32_32x32x16_bf16 v[128:143], a[56:59], a[24:27], v[128:143]
    ds_read_b64_tr_b16 a[84:85], v44 offset:12288
    ds_read_b64_tr_b16 a[86:87], v45 offset:14336
    v_add_f32 v158, v158, v174
    v_add_f32 v159, v159, v175
    v_max3_f32 v218, v144, v145, v146
    v_max3_f32 v219, v147, v148, v149
    v_max3_f32 v220, v150, v151, v152
    v_mfma_f32_32x32x16_bf16 v[128:143], a[60:63], a[28:31], v[128:143]
    ds_read_b64_tr_b16 a[92:93], v46 offset:12288
    ds_read_b64_tr_b16 a[94:95], v47 offset:14336
    v_max3_f32 v221, v153, v154, v155
    v_max3_f32 v218, v218, v156, v157
    v_max3_f32 v219, v219, v158, v159
    v_max3_f32 v218, v218, v219, v220
    v_max_f32 v218, v218, v221
    v_mov_b32 v219, v218
    s_nop 1
    v_permlane32_swap_b32 v218, v219
    v_max3_f32 v218, v218, v219, v216
    v_sub_f32 v220, v216, v218
    v_mov_b32 v216, v218
    v_exp_f32 v220, v220
    v_sub_f32 v192, v144, v218
    v_sub_f32 v193, v145, v218
    buffer_load_dwordx4 a[220:223], v23, s[32:35], s58 offen nt
    s_add_u32 s58, s58, 16384
    v_sub_f32 v194, v146, v218
    v_sub_f32 v195, v147, v218
    v_sub_f32 v196, v148, v218
    v_sub_f32 v197, v149, v218
    v_sub_f32 v198, v150, v218
    buffer_load_dwordx4 a[224:227], v20, s[32:35], s58 offen nt
    v_sub_f32 v199, v151, v218
    v_sub_f32 v200, v152, v218
    v_sub_f32 v201, v153, v218
    v_sub_f32 v202, v154, v218
    v_sub_f32 v203, v155, v218
    v_sub_f32 v204, v156, v218
    v_sub_f32 v205, v157, v218
    v_sub_f32 v206, v158, v218
    v_sub_f32 v207, v159, v218
    ds_write_b128 v28, v[128:131] offset:0
    v_exp_f32 v192, v192
    v_exp_f32 v193, v193
    v_exp_f32 v194, v194
    v_exp_f32 v195, v195
    ds_write_b128 v28, v[132:135] offset:1024
    v_exp_f32 v196, v196
    v_exp_f32 v197, v197
    v_exp_f32 v198, v198
    v_exp_f32 v199, v199
    ds_write_b128 v28, v[136:139] offset:2048
    v_exp_f32 v200, v200
    v_exp_f32 v201, v201
    v_exp_f32 v202, v202
    v_exp_f32 v203, v203
    ds_write_b128 v28, v[140:143] offset:3072
    v_exp_f32 v204, v204
    v_exp_f32 v205, v205
    v_exp_f32 v206, v206
    v_exp_f32 v207, v207
    v_mul_f32 v217, v217, v220
    v_cvt_pk_bf16_f32 v208, v192, v193
    v_cvt_pk_bf16_f32 v209, v194, v195
    v_cvt_pk_bf16_f32 v210, v196, v197
    v_cvt_pk_bf16_f32 v211, v198, v199
    v_cvt_pk_bf16_f32 v212, v200, v201
    v_cvt_pk_bf16_f32 v213, v202, v203
    v_cvt_pk_bf16_f32 v214, v204, v205
    v_cvt_pk_bf16_f32 v215, v206, v207
    v_mul_f32 v64, v64, v220
    v_mul_f32 v65, v65, v220
    v_mul_f32 v66, v66, v220
    v_mul_f32 v67, v67, v220
    v_mul_f32 v68, v68, v220
    v_mul_f32 v69, v69, v220
    v_mul_f32 v70, v70, v220
    v_mul_f32 v71, v71, v220
    v_mul_f32 v72, v72, v220
    v_mul_f32 v73, v73, v220
    v_mul_f32 v74, v74, v220
    v_mul_f32 v75, v75, v220
    v_mul_f32 v76, v76, v220
    v_mul_f32 v77, v77, v220
    v_mul_f32 v78, v78, v220
    v_mul_f32 v79, v79, v220
    s_waitcnt lgkmcnt(0)
    s_barrier
    v_mfma_f32_32x32x16_bf16 v[64:79], a[64:67], v[208:211], v[64:79]
    ds_read_b128 v[144:147], v29 offset:0
    v_mul_f32 v80, v80, v220
    v_mul_f32 v81, v81, v220
    ds_read_b128 v[148:151], v29 offset:1024
    s_waitcnt vmcnt(24)
    ds_write_b128 v26, a[128:131] offset:24576
    buffer_load_dwordx4 a[228:231], v21, s[32:35], s58 offen nt
    v_mul_f32 v82, v82, v220
    v_mul_f32 v83, v83, v220
    ds_read_b128 v[152:155], v29 offset:2048
    v_mul_f32 v84, v84, v220
    v_mfma_f32_32x32x16_bf16 v[64:79], a[68:71], v[212:215], v[64:79]
    v_mul_f32 v85, v85, v220
    ds_read_b128 v[156:159], v29 offset:3072
    v_mul_f32 v86, v86, v220
    s_waitcnt vmcnt(24)
    ds_write_b128 v26, a[132:135] offset:25600
    v_mul_f32 v87, v87, v220
    v_mul_f32 v88, v88, v220
    v_mul_f32 v89, v89, v220
    v_mul_f32 v90, v90, v220
    v_mul_f32 v91, v91, v220
    v_mul_f32 v92, v92, v220
    v_mul_f32 v93, v93, v220
    v_mul_f32 v94, v94, v220
    v_mul_f32 v95, v95, v220
    s_nop 1
    v_mfma_f32_32x32x16_bf16 v[80:95], a[72:75], v[208:211], v[80:95]
    ds_read_b128 v[160:163], v30 offset:0
    v_mul_f32 v96, v96, v220
    v_mul_f32 v97, v97, v220
    ds_read_b128 v[164:167], v30 offset:1024
    s_waitcnt vmcnt(23)
    ds_write_b128 v26, a[136:139] offset:26624
    buffer_load_dwordx4 a[232:235], v22, s[32:35], s58 offen nt
    v_mul_f32 v98, v98, v220
    v_mul_f32 v99, v99, v220
    ds_read_b128 v[168:171], v30 offset:2048
    v_mul_f32 v100, v100, v220
    v_mfma_f32_32x32x16_bf16 v[80:95], a[76:79], v[212:215], v[80:95]
    v_mul_f32 v101, v101, v220
    ds_read_b128 v[172:175], v30 offset:3072
    v_mul_f32 v102, v102, v220
    s_waitcnt vmcnt(23)
    ds_write_b128 v26, a[140:143] offset:27648
    v_mul_f32 v103, v103, v220
    v_mul_f32 v104, v104, v220
    v_mul_f32 v105, v105, v220
    v_mul_f32 v106, v106, v220
    v_mul_f32 v107, v107, v220
    v_mul_f32 v108, v108, v220
    v_mul_f32 v109, v109, v220
    v_mul_f32 v110, v110, v220
    v_mul_f32 v111, v111, v220
    s_nop 1
    v_mfma_f32_32x32x16_bf16 v[96:111], a[80:83], v[208:211], v[96:111]
    ds_read_b128 v[176:179], v31 offset:0
    v_mul_f32 v112, v112, v220
    v_mul_f32 v113, v113, v220
    ds_read_b128 v[180:183], v31 offset:1024
    s_waitcnt vmcnt(22)
    ds_write_b128 v26, a[144:147] offset:28672
    v_mul_f32 v114, v114, v220
    v_mul_f32 v115, v115, v220
    ds_read_b128 v[184:187], v31 offset:2048
    v_mul_f32 v116, v116, v220
    v_mfma_f32_32x32x16_bf16 v[96:111], a[84:87], v[212:215], v[96:111]
    v_mul_f32 v117, v117, v220
    ds_read_b128 v[188:191], v31 offset:3072
    v_mul_f32 v118, v118, v220
    s_waitcnt vmcnt(21)
    ds_write_b128 v26, a[148:151] offset:29696
    buffer_load_dwordx4 a[236:239], v23, s[32:35], s58 offen nt
    s_add_u32 s58, s58, 16384
    v_mul_f32 v119, v119, v220
    v_mul_f32 v120, v120, v220
    v_mul_f32 v121, v121, v220
    v_mul_f32 v122, v122, v220
    v_mul_f32 v123, v123, v220
    v_mul_f32 v124, v124, v220
    v_mul_f32 v125, v125, v220
    v_mul_f32 v126, v126, v220
    v_mul_f32 v127, v127, v220
    s_nop 1
    v_mfma_f32_32x32x16_bf16 v[112:127], a[88:91], v[208:211], v[112:127]
    v_add_f32 v192, v192, v200
    v_add_f32 v193, v193, v201
    v_add_f32 v194, v194, v202
    v_add_f32 v195, v195, v203
    s_waitcnt vmcnt(21)
    ds_write_b128 v26, a[152:155] offset:30720
    v_add_f32 v196, v196, v204
    v_add_f32 v197, v197, v205
    v_add_f32 v198, v198, v206
    v_add_f32 v199, v199, v207
    v_mfma_f32_32x32x16_bf16 v[112:127], a[92:95], v[212:215], v[112:127]
    v_add_f32 v192, v192, v196
    v_add_f32 v193, v193, v197
    v_add_f32 v194, v194, v198
    s_waitcnt vmcnt(20)
    ds_write_b128 v26, a[156:159] offset:31744
    v_add_f32 v195, v195, v199
    v_add_f32 v192, v192, v193
    v_add_f32 v194, v194, v195
    v_add_f32 v192, v192, v194
    v_add_f32 v217, v217, v192
    ds_read_b128 a[32:35], v32 offset:24576
    ds_read_b128 a[36:39], v33 offset:24576
    ds_read_b128 a[40:43], v34 offset:24576
    ds_read_b128 a[44:47], v35 offset:24576
    ds_read_b128 a[48:51], v36 offset:24576
    ds_read_b128 a[52:55], v37 offset:24576
    ds_read_b128 a[56:59], v38 offset:24576
    ds_read_b128 a[60:63], v39 offset:24576
    s_waitcnt lgkmcnt(8)
    v_add_f32 v144, v144, v128
    v_add_f32 v145, v145, v129
    v_add_f32 v146, v146, v130
    v_add_f32 v147, v147, v131
    buffer_load_dwordx4 a[240:243], v20, s[32:35], s58 offen nt
    v_add_f32 v148, v148, v132
    v_add_f32 v149, v149, v133
    v_add_f32 v150, v150, v134
    v_add_f32 v151, v151, v135
    v_add_f32 v152, v152, v136
    v_add_f32 v153, v153, v137
    v_add_f32 v154, v154, v138
    v_add_f32 v155, v155, v139
    v_add_f32 v156, v156, v140
    v_add_f32 v157, v157, v141
    v_add_f32 v158, v158, v142
    v_add_f32 v159, v159, v143
    s_waitcnt lgkmcnt(0)
    v_mfma_f32_32x32x16_bf16 v[128:143], a[32:35], a[0:3], 0
    ds_read_b64_tr_b16 a[64:65], v40 offset:16384
    ds_read_b64_tr_b16 a[66:67], v41 offset:18432
    v_add_f32 v160, v160, v176
    v_add_f32 v161, v161, v177
    v_add_f32 v162, v162, v178
    v_add_f32 v163, v163, v179
    v_add_f32 v164, v164, v180
    v_mfma_f32_32x32x16_bf16 v[128:143], a[36:39], a[4:7], v[128:143]
    ds_read_b64_tr_b16 a[72:73], v42 offset:16384
    ds_read_b64_tr_b16 a[74:75], v43 offset:18432
    v_add_f32 v165, v165, v181
    v_add_f32 v166, v166, v182
    v_add_f32 v167, v167, v183
    v_add_f32 v168, v168, v184
    v_add_f32 v169, v169, v185
    v_mfma_f32_32x32x16_bf16 v[128:143], a[40:43], a[8:11], v[128:143]
    ds_read_b64_tr_b16 a[80:81], v44 offset:16384
    ds_read_b64_tr_b16 a[82:83], v45 offset:18432
    v_add_f32 v170, v170, v186
    v_add_f32 v171, v171, v187
    v_add_f32 v172, v172, v188
    v_add_f32 v173, v173, v189
    v_add_f32 v174, v174, v190
    v_mfma_f32_32x32x16_bf16 v[128:143], a[44:47], a[12:15], v[128:143]
    ds_read_b64_tr_b16 a[88:89], v46 offset:16384
    ds_read_b64_tr_b16 a[90:91], v47 offset:18432
    v_add_f32 v175, v175, v191
    v_add_f32 v144, v144, v160
    v_add_f32 v145, v145, v161
    v_add_f32 v146, v146, v162
    v_add_f32 v147, v147, v163
    v_mfma_f32_32x32x16_bf16 v[128:143], a[48:51], a[16:19], v[128:143]
    ds_read_b64_tr_b16 a[68:69], v40 offset:20480
    ds_read_b64_tr_b16 a[70:71], v41 offset:22528
    v_add_f32 v148, v148, v164
    v_add_f32 v149, v149, v165
    v_add_f32 v150, v150, v166
    v_add_f32 v151, v151, v167
    v_add_f32 v152, v152, v168
    v_mfma_f32_32x32x16_bf16 v[128:143], a[52:55], a[20:23], v[128:143]
    ds_read_b64_tr_b16 a[76:77], v42 offset:20480
    ds_read_b64_tr_b16 a[78:79], v43 offset:22528
    v_add_f32 v153, v153, v169
    v_add_f32 v154, v154, v170
    v_add_f32 v155, v155, v171
    v_add_f32 v156, v156, v172
    v_add_f32 v157, v157, v173
    v_mfma_f32_32x32x16_bf16 v[128:143], a[56:59], a[24:27], v[128:143]
    ds_read_b64_tr_b16 a[84:85], v44 offset:20480
    ds_read_b64_tr_b16 a[86:87], v45 offset:22528
    v_add_f32 v158, v158, v174
    v_add_f32 v159, v159, v175
    v_max3_f32 v218, v144, v145, v146
    v_max3_f32 v219, v147, v148, v149
    v_max3_f32 v220, v150, v151, v152
    v_mfma_f32_32x32x16_bf16 v[128:143], a[60:63], a[28:31], v[128:143]
    ds_read_b64_tr_b16 a[92:93], v46 offset:20480
    ds_read_b64_tr_b16 a[94:95], v47 offset:22528
    v_max3_f32 v221, v153, v154, v155
    v_max3_f32 v218, v218, v156, v157
    v_max3_f32 v219, v219, v158, v159
    v_max3_f32 v218, v218, v219, v220
    v_max_f32 v218, v218, v221
    v_mov_b32 v219, v218
    s_nop 1
    v_permlane32_swap_b32 v218, v219
    v_max3_f32 v218, v218, v219, v216
    v_sub_f32 v220, v216, v218
    v_mov_b32 v216, v218
    v_exp_f32 v220, v220
    v_sub_f32 v192, v144, v218
    v_sub_f32 v193, v145, v218
    buffer_load_dwordx4 a[244:247], v21, s[32:35], s58 offen nt
    v_sub_f32 v194, v146, v218
    v_sub_f32 v195, v147, v218
    v_sub_f32 v196, v148, v218
    v_sub_f32 v197, v149, v218
    v_sub_f32 v198, v150, v218
    buffer_load_dwordx4 a[248:251], v22, s[32:35], s58 offen nt
    v_sub_f32 v199, v151, v218
    v_sub_f32 v200, v152, v218
    v_sub_f32 v201, v153, v218
    v_sub_f32 v202, v154, v218
    v_sub_f32 v203, v155, v218
    v_sub_f32 v204, v156, v218
    v_sub_f32 v205, v157, v218
    v_sub_f32 v206, v158, v218
    v_sub_f32 v207, v159, v218
    ds_write_b128 v28, v[128:131] offset:16384
    v_exp_f32 v192, v192
    v_exp_f32 v193, v193
    v_exp_f32 v194, v194
    v_exp_f32 v195, v195
    ds_write_b128 v28, v[132:135] offset:17408
    v_exp_f32 v196, v196
    v_exp_f32 v197, v197
    v_exp_f32 v198, v198
    v_exp_f32 v199, v199
    ds_write_b128 v28, v[136:139] offset:18432
    v_exp_f32 v200, v200
    v_exp_f32 v201, v201
    v_exp_f32 v202, v202
    v_exp_f32 v203, v203
    ds_write_b128 v28, v[140:143] offset:19456
    v_exp_f32 v204, v204
    v_exp_f32 v205, v205
    v_exp_f32 v206, v206
    v_exp_f32 v207, v207
    v_mul_f32 v217, v217, v220
    v_cvt_pk_bf16_f32 v208, v192, v193
    v_cvt_pk_bf16_f32 v209, v194, v195
    v_cvt_pk_bf16_f32 v210, v196, v197
    v_cvt_pk_bf16_f32 v211, v198, v199
    v_cvt_pk_bf16_f32 v212, v200, v201
    v_cvt_pk_bf16_f32 v213, v202, v203
    v_cvt_pk_bf16_f32 v214, v204, v205
    v_cvt_pk_bf16_f32 v215, v206, v207
    v_mul_f32 v64, v64, v220
    v_mul_f32 v65, v65, v220
    v_mul_f32 v66, v66, v220
    v_mul_f32 v67, v67, v220
    v_mul_f32 v68, v68, v220
    v_mul_f32 v69, v69, v220
    v_mul_f32 v70, v70, v220
    v_mul_f32 v71, v71, v220
    v_mul_f32 v72, v72, v220
    v_mul_f32 v73, v73, v220
    v_mul_f32 v74, v74, v220
    v_mul_f32 v75, v75, v220
    v_mul_f32 v76, v76, v220
    v_mul_f32 v77, v77, v220
    v_mul_f32 v78, v78, v220
    v_mul_f32 v79, v79, v220
    s_waitcnt lgkmcnt(0)
    s_barrier
    v_mfma_f32_32x32x16_bf16 v[64:79], a[64:67], v[208:211], v[64:79]
    ds_read_b128 v[144:147], v29 offset:16384
    v_mul_f32 v80, v80, v220
    v_mul_f32 v81, v81, v220
    ds_read_b128 v[148:151], v29 offset:17408
    s_waitcnt vmcnt(22)
    ds_write_b128 v26, a[160:163] offset:0
    buffer_load_dwordx4 a[252:255], v23, s[32:35], s58 offen nt
    s_add_u32 s58, s58, 16384
    v_mul_f32 v82, v82, v220
    v_mul_f32 v83, v83, v220
    ds_read_b128 v[152:155], v29 offset:18432
    v_mul_f32 v84, v84, v220
    v_mfma_f32_32x32x16_bf16 v[64:79], a[68:71], v[212:215], v[64:79]
    v_mul_f32 v85, v85, v220
    ds_read_b128 v[156:159], v29 offset:19456
    v_mul_f32 v86, v86, v220
    s_waitcnt vmcnt(22)
    ds_write_b128 v26, a[164:167] offset:1024
    v_mul_f32 v87, v87, v220
    v_mul_f32 v88, v88, v220
    v_mul_f32 v89, v89, v220
    v_mul_f32 v90, v90, v220
    v_mul_f32 v91, v91, v220
    v_mul_f32 v92, v92, v220
    v_mul_f32 v93, v93, v220
    v_mul_f32 v94, v94, v220
    v_mul_f32 v95, v95, v220
    s_nop 1
    v_mfma_f32_32x32x16_bf16 v[80:95], a[72:75], v[208:211], v[80:95]
    ds_read_b128 v[160:163], v30 offset:16384
    v_mul_f32 v96, v96, v220
    v_mul_f32 v97, v97, v220
    ds_read_b128 v[164:167], v30 offset:17408
    s_waitcnt vmcnt(21)
    ds_write_b128 v26, a[168:171] offset:2048
    buffer_load_dwordx4 v[224:227], v20, s[32:35], s58 offen nt
    v_mul_f32 v98, v98, v220
    v_mul_f32 v99, v99, v220
    ds_read_b128 v[168:171], v30 offset:18432
    v_mul_f32 v100, v100, v220
    v_mfma_f32_32x32x16_bf16 v[80:95], a[76:79], v[212:215], v[80:95]
    v_mul_f32 v101, v101, v220
    ds_read_b128 v[172:175], v30 offset:19456
    v_mul_f32 v102, v102, v220
    s_waitcnt vmcnt(21)
    ds_write_b128 v26, a[172:175] offset:3072
    v_mul_f32 v103, v103, v220
    v_mul_f32 v104, v104, v220
    v_mul_f32 v105, v105, v220
    v_mul_f32 v106, v106, v220
    v_mul_f32 v107, v107, v220
    v_mul_f32 v108, v108, v220
    v_mul_f32 v109, v109, v220
    v_mul_f32 v110, v110, v220
    v_mul_f32 v111, v111, v220
    s_nop 1
    v_mfma_f32_32x32x16_bf16 v[96:111], a[80:83], v[208:211], v[96:111]
    ds_read_b128 v[176:179], v31 offset:16384
    v_mul_f32 v112, v112, v220
    v_mul_f32 v113, v113, v220
    ds_read_b128 v[180:183], v31 offset:17408
    s_waitcnt vmcnt(20)
    ds_write_b128 v26, a[176:179] offset:4096
    v_mul_f32 v114, v114, v220
    v_mul_f32 v115, v115, v220
    ds_read_b128 v[184:187], v31 offset:18432
    v_mul_f32 v116, v116, v220
    v_mfma_f32_32x32x16_bf16 v[96:111], a[84:87], v[212:215], v[96:111]
    v_mul_f32 v117, v117, v220
    ds_read_b128 v[188:191], v31 offset:19456
    v_mul_f32 v118, v118, v220
    s_waitcnt vmcnt(19)
    ds_write_b128 v26, a[180:183] offset:5120
    buffer_load_dwordx4 v[228:231], v21, s[32:35], s58 offen nt
    v_mul_f32 v119, v119, v220
    v_mul_f32 v120, v120, v220
    v_mul_f32 v121, v121, v220
    v_mul_f32 v122, v122, v220
    v_mul_f32 v123, v123, v220
    v_mul_f32 v124, v124, v220
    v_mul_f32 v125, v125, v220
    v_mul_f32 v126, v126, v220
    v_mul_f32 v127, v127, v220
    s_nop 1
    v_mfma_f32_32x32x16_bf16 v[112:127], a[88:91], v[208:211], v[112:127]
    v_add_f32 v192, v192, v200
    v_add_f32 v193, v193, v201
    v_add_f32 v194, v194, v202
    v_add_f32 v195, v195, v203
    s_waitcnt vmcnt(19)
    ds_write_b128 v26, a[184:187] offset:6144
    v_add_f32 v196, v196, v204
    v_add_f32 v197, v197, v205
    v_add_f32 v198, v198, v206
    v_add_f32 v199, v199, v207
    v_mfma_f32_32x32x16_bf16 v[112:127], a[92:95], v[212:215], v[112:127]
    v_add_f32 v192, v192, v196
    v_add_f32 v193, v193, v197
    v_add_f32 v194, v194, v198
    s_waitcnt vmcnt(18)
    ds_write_b128 v26, a[188:191] offset:7168
    v_add_f32 v195, v195, v199
    v_add_f32 v192, v192, v193
    v_add_f32 v194, v194, v195
    v_add_f32 v192, v192, v194
    v_add_f32 v217, v217, v192
    ds_read_b128 a[32:35], v32 offset:0
    ds_read_b128 a[36:39], v33 offset:0
    ds_read_b128 a[40:43], v34 offset:0
    ds_read_b128 a[44:47], v35 offset:0
    ds_read_b128 a[48:51], v36 offset:0
    ds_read_b128 a[52:55], v37 offset:0
    ds_read_b128 a[56:59], v38 offset:0
    ds_read_b128 a[60:63], v39 offset:0
    s_waitcnt lgkmcnt(8)
    v_add_f32 v144, v144, v128
    v_add_f32 v145, v145, v129
    v_add_f32 v146, v146, v130
    v_add_f32 v147, v147, v131
    buffer_load_dwordx4 v[232:235], v22, s[32:35], s58 offen nt
    v_add_f32 v148, v148, v132
    v_add_f32 v149, v149, v133
    v_add_f32 v150, v150, v134
    v_add_f32 v151, v151, v135
    v_add_f32 v152, v152, v136
    v_add_f32 v153, v153, v137
    v_add_f32 v154, v154, v138
    v_add_f32 v155, v155, v139
    v_add_f32 v156, v156, v140
    v_add_f32 v157, v157, v141
    v_add_f32 v158, v158, v142
    v_add_f32 v159, v159, v143
    s_waitcnt lgkmcnt(0)
    v_mfma_f32_32x32x16_bf16 v[128:143], a[32:35], a[0:3], 0
    ds_read_b64_tr_b16 a[64:65], v40 offset:24576
    ds_read_b64_tr_b16 a[66:67], v41 offset:26624
    v_add_f32 v160, v160, v176
    v_add_f32 v161, v161, v177
    v_add_f32 v162, v162, v178
    v_add_f32 v163, v163, v179
    v_add_f32 v164, v164, v180
    v_mfma_f32_32x32x16_bf16 v[128:143], a[36:39], a[4:7], v[128:143]
    ds_read_b64_tr_b16 a[72:73], v42 offset:24576
    ds_read_b64_tr_b16 a[74:75], v43 offset:26624
    v_add_f32 v165, v165, v181
    v_add_f32 v166, v166, v182
    v_add_f32 v167, v167, v183
    v_add_f32 v168, v168, v184
    v_add_f32 v169, v169, v185
    v_mfma_f32_32x32x16_bf16 v[128:143], a[40:43], a[8:11], v[128:143]
    ds_read_b64_tr_b16 a[80:81], v44 offset:24576
    ds_read_b64_tr_b16 a[82:83], v45 offset:26624
    v_add_f32 v170, v170, v186
    v_add_f32 v171, v171, v187
    v_add_f32 v172, v172, v188
    v_add_f32 v173, v173, v189
    v_add_f32 v174, v174, v190
    v_mfma_f32_32x32x16_bf16 v[128:143], a[44:47], a[12:15], v[128:143]
    ds_read_b64_tr_b16 a[88:89], v46 offset:24576
    ds_read_b64_tr_b16 a[90:91], v47 offset:26624
    v_add_f32 v175, v175, v191
    v_add_f32 v144, v144, v160
    v_add_f32 v145, v145, v161
    v_add_f32 v146, v146, v162
    v_add_f32 v147, v147, v163
    v_mfma_f32_32x32x16_bf16 v[128:143], a[48:51], a[16:19], v[128:143]
    ds_read_b64_tr_b16 a[68:69], v40 offset:28672
    ds_read_b64_tr_b16 a[70:71], v41 offset:30720
    v_add_f32 v148, v148, v164
    v_add_f32 v149, v149, v165
    v_add_f32 v150, v150, v166
    v_add_f32 v151, v151, v167
    v_add_f32 v152, v152, v168
    v_mfma_f32_32x32x16_bf16 v[128:143], a[52:55], a[20:23], v[128:143]
    ds_read_b64_tr_b16 a[76:77], v42 offset:28672
    ds_read_b64_tr_b16 a[78:79], v43 offset:30720
    v_add_f32 v153, v153, v169
    v_add_f32 v154, v154, v170
    v_add_f32 v155, v155, v171
    v_add_f32 v156, v156, v172
    v_add_f32 v157, v157, v173
    v_mfma_f32_32x32x16_bf16 v[128:143], a[56:59], a[24:27], v[128:143]
    ds_read_b64_tr_b16 a[84:85], v44 offset:28672
    ds_read_b64_tr_b16 a[86:87], v45 offset:30720
    v_add_f32 v158, v158, v174
    v_add_f32 v159, v159, v175
    v_max3_f32 v218, v144, v145, v146
    v_max3_f32 v219, v147, v148, v149
    v_max3_f32 v220, v150, v151, v152
    v_mfma_f32_32x32x16_bf16 v[128:143], a[60:63], a[28:31], v[128:143]
    ds_read_b64_tr_b16 a[92:93], v46 offset:28672
    ds_read_b64_tr_b16 a[94:95], v47 offset:30720
    v_max3_f32 v221, v153, v154, v155
    v_max3_f32 v218, v218, v156, v157
    v_max3_f32 v219, v219, v158, v159
    v_max3_f32 v218, v218, v219, v220
    v_max_f32 v218, v218, v221
    v_mov_b32 v219, v218
    s_nop 1
    v_permlane32_swap_b32 v218, v219
    v_max3_f32 v218, v218, v219, v216
    v_sub_f32 v220, v216, v218
    v_mov_b32 v216, v218
    v_exp_f32 v220, v220
    v_sub_f32 v192, v144, v218
    v_sub_f32 v193, v145, v218
    buffer_load_dwordx4 v[236:239], v23, s[32:35], s58 offen nt
    s_add_u32 s58, s58, 16384
    v_sub_f32 v194, v146, v218
    v_sub_f32 v195, v147, v218
    v_sub_f32 v196, v148, v218
    v_sub_f32 v197, v149, v218
    v_sub_f32 v198, v150, v218
    buffer_load_dwordx4 v[240:243], v20, s[32:35], s58 offen nt
    v_sub_f32 v199, v151, v218
    v_sub_f32 v200, v152, v218
    v_sub_f32 v201, v153, v218
    v_sub_f32 v202, v154, v218
    v_sub_f32 v203, v155, v218
    v_sub_f32 v204, v156, v218
    v_sub_f32 v205, v157, v218
    v_sub_f32 v206, v158, v218
    v_sub_f32 v207, v159, v218
    ds_write_b128 v28, v[128:131] offset:0
    v_exp_f32 v192, v192
    v_exp_f32 v193, v193
    v_exp_f32 v194, v194
    v_exp_f32 v195, v195
    ds_write_b128 v28, v[132:135] offset:1024
    v_exp_f32 v196, v196
    v_exp_f32 v197, v197
    v_exp_f32 v198, v198
    v_exp_f32 v199, v199
    ds_write_b128 v28, v[136:139] offset:2048
    v_exp_f32 v200, v200
    v_exp_f32 v201, v201
    v_exp_f32 v202, v202
    v_exp_f32 v203, v203
    ds_write_b128 v28, v[140:143] offset:3072
    v_exp_f32 v204, v204
    v_exp_f32 v205, v205
    v_exp_f32 v206, v206
    v_exp_f32 v207, v207
    v_mul_f32 v217, v217, v220
    v_cvt_pk_bf16_f32 v208, v192, v193
    v_cvt_pk_bf16_f32 v209, v194, v195
    v_cvt_pk_bf16_f32 v210, v196, v197
    v_cvt_pk_bf16_f32 v211, v198, v199
    v_cvt_pk_bf16_f32 v212, v200, v201
    v_cvt_pk_bf16_f32 v213, v202, v203
    v_cvt_pk_bf16_f32 v214, v204, v205
    v_cvt_pk_bf16_f32 v215, v206, v207
    v_mul_f32 v64, v64, v220
    v_mul_f32 v65, v65, v220
    v_mul_f32 v66, v66, v220
    v_mul_f32 v67, v67, v220
    v_mul_f32 v68, v68, v220
    v_mul_f32 v69, v69, v220
    v_mul_f32 v70, v70, v220
    v_mul_f32 v71, v71, v220
    v_mul_f32 v72, v72, v220
    v_mul_f32 v73, v73, v220
    v_mul_f32 v74, v74, v220
    v_mul_f32 v75, v75, v220
    v_mul_f32 v76, v76, v220
    v_mul_f32 v77, v77, v220
    v_mul_f32 v78, v78, v220
    v_mul_f32 v79, v79, v220
    s_waitcnt lgkmcnt(0)
    s_barrier
    v_mfma_f32_32x32x16_bf16 v[64:79], a[64:67], v[208:211], v[64:79]
    ds_read_b128 v[144:147], v29 offset:0
    v_mul_f32 v80, v80, v220
    v_mul_f32 v81, v81, v220
    ds_read_b128 v[148:151], v29 offset:1024
    s_waitcnt vmcnt(20)
    ds_write_b128 v26, a[192:195] offset:8192
    buffer_load_dwordx4 v[244:247], v21, s[32:35], s58 offen nt
    v_mul_f32 v82, v82, v220
    v_mul_f32 v83, v83, v220
    ds_read_b128 v[152:155], v29 offset:2048
    v_mul_f32 v84, v84, v220
    v_mfma_f32_32x32x16_bf16 v[64:79], a[68:71], v[212:215], v[64:79]
    v_mul_f32 v85, v85, v220
    ds_read_b128 v[156:159], v29 offset:3072
    v_mul_f32 v86, v86, v220
    s_waitcnt vmcnt(20)
    ds_write_b128 v26, a[196:199] offset:9216
    v_mul_f32 v87, v87, v220
    v_mul_f32 v88, v88, v220
    v_mul_f32 v89, v89, v220
    v_mul_f32 v90, v90, v220
    v_mul_f32 v91, v91, v220
    v_mul_f32 v92, v92, v220
    v_mul_f32 v93, v93, v220
    v_mul_f32 v94, v94, v220
    v_mul_f32 v95, v95, v220
    s_nop 1
    v_mfma_f32_32x32x16_bf16 v[80:95], a[72:75], v[208:211], v[80:95]
    ds_read_b128 v[160:163], v30 offset:0
    v_mul_f32 v96, v96, v220
    v_mul_f32 v97, v97, v220
    ds_read_b128 v[164:167], v30 offset:1024
    s_waitcnt vmcnt(19)
    ds_write_b128 v26, a[200:203] offset:10240
    buffer_load_dwordx4 v[248:251], v22, s[32:35], s58 offen nt
    v_mul_f32 v98, v98, v220
    v_mul_f32 v99, v99, v220
    ds_read_b128 v[168:171], v30 offset:2048
    v_mul_f32 v100, v100, v220
    v_mfma_f32_32x32x16_bf16 v[80:95], a[76:79], v[212:215], v[80:95]
    v_mul_f32 v101, v101, v220
    ds_read_b128 v[172:175], v30 offset:3072
    v_mul_f32 v102, v102, v220
    s_waitcnt vmcnt(19)
    ds_write_b128 v26, a[204:207] offset:11264
    v_mul_f32 v103, v103, v220
    v_mul_f32 v104, v104, v220
    v_mul_f32 v105, v105, v220
    v_mul_f32 v106, v106, v220
    v_mul_f32 v107, v107, v220
    v_mul_f32 v108, v108, v220
    v_mul_f32 v109, v109, v220
    v_mul_f32 v110, v110, v220
    v_mul_f32 v111, v111, v220
    s_nop 1
    v_mfma_f32_32x32x16_bf16 v[96:111], a[80:83], v[208:211], v[96:111]
    ds_read_b128 v[176:179], v31 offset:0
    v_mul_f32 v112, v112, v220
    v_mul_f32 v113, v113, v220
    ds_read_b128 v[180:183], v31 offset:1024
    s_waitcnt vmcnt(18)
    ds_write_b128 v26, a[208:211] offset:12288
    v_mul_f32 v114, v114, v220
    v_mul_f32 v115, v115, v220
    ds_read_b128 v[184:187], v31 offset:2048
    v_mul_f32 v116, v116, v220
    v_mfma_f32_32x32x16_bf16 v[96:111], a[84:87], v[212:215], v[96:111]
    v_mul_f32 v117, v117, v220
    ds_read_b128 v[188:191], v31 offset:3072
    v_mul_f32 v118, v118, v220
    s_waitcnt vmcnt(17)
    ds_write_b128 v26, a[212:215] offset:13312
    buffer_load_dwordx4 v[252:255], v23, s[32:35], s58 offen nt
    s_add_u32 s58, s58, 16384
    v_mul_f32 v119, v119, v220
    v_mul_f32 v120, v120, v220
    v_mul_f32 v121, v121, v220
    v_mul_f32 v122, v122, v220
    v_mul_f32 v123, v123, v220
    v_mul_f32 v124, v124, v220
    v_mul_f32 v125, v125, v220
    v_mul_f32 v126, v126, v220
    v_mul_f32 v127, v127, v220
    s_nop 1
    v_mfma_f32_32x32x16_bf16 v[112:127], a[88:91], v[208:211], v[112:127]
    v_add_f32 v192, v192, v200
    v_add_f32 v193, v193, v201
    v_add_f32 v194, v194, v202
    v_add_f32 v195, v195, v203
    s_waitcnt vmcnt(17)
    ds_write_b128 v26, a[216:219] offset:14336
    v_add_f32 v196, v196, v204
    v_add_f32 v197, v197, v205
    v_add_f32 v198, v198, v206
    v_add_f32 v199, v199, v207
    v_mfma_f32_32x32x16_bf16 v[112:127], a[92:95], v[212:215], v[112:127]
    v_add_f32 v192, v192, v196
    v_add_f32 v193, v193, v197
    v_add_f32 v194, v194, v198
    s_waitcnt vmcnt(16)
    ds_write_b128 v26, a[220:223] offset:15360
    v_add_f32 v195, v195, v199
    v_add_f32 v192, v192, v193
    v_add_f32 v194, v194, v195
    v_add_f32 v192, v192, v194
    v_add_f32 v217, v217, v192
    ds_read_b128 a[32:35], v32 offset:8192
    ds_read_b128 a[36:39], v33 offset:8192
    ds_read_b128 a[40:43], v34 offset:8192
    ds_read_b128 a[44:47], v35 offset:8192
    ds_read_b128 a[48:51], v36 offset:8192
    ds_read_b128 a[52:55], v37 offset:8192
    ds_read_b128 a[56:59], v38 offset:8192
    ds_read_b128 a[60:63], v39 offset:8192
    s_waitcnt lgkmcnt(8)
    v_add_f32 v144, v144, v128
    v_add_f32 v145, v145, v129
    v_add_f32 v146, v146, v130
    v_add_f32 v147, v147, v131
    v_add_f32 v148, v148, v132
    v_add_f32 v149, v149, v133
    v_add_f32 v150, v150, v134
    v_add_f32 v151, v151, v135
    v_add_f32 v152, v152, v136
    v_add_f32 v153, v153, v137
    v_add_f32 v154, v154, v138
    v_add_f32 v155, v155, v139
    v_add_f32 v156, v156, v140
    v_add_f32 v157, v157, v141
    v_add_f32 v158, v158, v142
    v_add_f32 v159, v159, v143
    s_waitcnt lgkmcnt(0)
    v_mfma_f32_32x32x16_bf16 v[128:143], a[32:35], a[0:3], 0
    ds_read_b64_tr_b16 a[64:65], v40 offset:0
    ds_read_b64_tr_b16 a[66:67], v41 offset:2048
    v_add_f32 v160, v160, v176
    v_add_f32 v161, v161, v177
    v_add_f32 v162, v162, v178
    v_add_f32 v163, v163, v179
    v_add_f32 v164, v164, v180
    v_mfma_f32_32x32x16_bf16 v[128:143], a[36:39], a[4:7], v[128:143]
    ds_read_b64_tr_b16 a[72:73], v42 offset:0
    ds_read_b64_tr_b16 a[74:75], v43 offset:2048
    v_add_f32 v165, v165, v181
    v_add_f32 v166, v166, v182
    v_add_f32 v167, v167, v183
    v_add_f32 v168, v168, v184
    v_add_f32 v169, v169, v185
    v_mfma_f32_32x32x16_bf16 v[128:143], a[40:43], a[8:11], v[128:143]
    ds_read_b64_tr_b16 a[80:81], v44 offset:0
    ds_read_b64_tr_b16 a[82:83], v45 offset:2048
    v_add_f32 v170, v170, v186
    v_add_f32 v171, v171, v187
    v_add_f32 v172, v172, v188
    v_add_f32 v173, v173, v189
    v_add_f32 v174, v174, v190
    v_mfma_f32_32x32x16_bf16 v[128:143], a[44:47], a[12:15], v[128:143]
    ds_read_b64_tr_b16 a[88:89], v46 offset:0
    ds_read_b64_tr_b16 a[90:91], v47 offset:2048
    v_add_f32 v175, v175, v191
    v_add_f32 v144, v144, v160
    v_add_f32 v145, v145, v161
    v_add_f32 v146, v146, v162
    v_add_f32 v147, v147, v163
    v_mfma_f32_32x32x16_bf16 v[128:143], a[48:51], a[16:19], v[128:143]
    ds_read_b64_tr_b16 a[68:69], v40 offset:4096
    ds_read_b64_tr_b16 a[70:71], v41 offset:6144
    v_add_f32 v148, v148, v164
    v_add_f32 v149, v149, v165
    v_add_f32 v150, v150, v166
    v_add_f32 v151, v151, v167
    v_add_f32 v152, v152, v168
    v_mfma_f32_32x32x16_bf16 v[128:143], a[52:55], a[20:23], v[128:143]
    ds_read_b64_tr_b16 a[76:77], v42 offset:4096
    ds_read_b64_tr_b16 a[78:79], v43 offset:6144
    v_add_f32 v153, v153, v169
    v_add_f32 v154, v154, v170
    v_add_f32 v155, v155, v171
    v_add_f32 v156, v156, v172
    v_add_f32 v157, v157, v173
    v_mfma_f32_32x32x16_bf16 v[128:143], a[56:59], a[24:27], v[128:143]
    ds_read_b64_tr_b16 a[84:85], v44 offset:4096
    ds_read_b64_tr_b16 a[86:87], v45 offset:6144
    v_add_f32 v158, v158, v174
    v_add_f32 v159, v159, v175
    v_max3_f32 v218, v144, v145, v146
    v_max3_f32 v219, v147, v148, v149
    v_max3_f32 v220, v150, v151, v152
    v_mfma_f32_32x32x16_bf16 v[128:143], a[60:63], a[28:31], v[128:143]
    ds_read_b64_tr_b16 a[92:93], v46 offset:4096
    ds_read_b64_tr_b16 a[94:95], v47 offset:6144
    v_max3_f32 v221, v153, v154, v155
    v_max3_f32 v218, v218, v156, v157
    v_max3_f32 v219, v219, v158, v159
    v_max3_f32 v218, v218, v219, v220
    v_max_f32 v218, v218, v221
    v_mov_b32 v219, v218
    s_nop 1
    v_permlane32_swap_b32 v218, v219
    v_max3_f32 v218, v218, v219, v216
    v_sub_f32 v220, v216, v218
    v_mov_b32 v216, v218
    v_exp_f32 v220, v220
    v_sub_f32 v192, v144, v218
    v_sub_f32 v193, v145, v218
    v_sub_f32 v194, v146, v218
    v_sub_f32 v195, v147, v218
    v_sub_f32 v196, v148, v218
    v_sub_f32 v197, v149, v218
    v_sub_f32 v198, v150, v218
    v_sub_f32 v199, v151, v218
    v_sub_f32 v200, v152, v218
    v_sub_f32 v201, v153, v218
    v_sub_f32 v202, v154, v218
    v_sub_f32 v203, v155, v218
    v_sub_f32 v204, v156, v218
    v_sub_f32 v205, v157, v218
    v_sub_f32 v206, v158, v218
    v_sub_f32 v207, v159, v218
    ds_write_b128 v28, v[128:131] offset:16384
    v_exp_f32 v192, v192
    v_exp_f32 v193, v193
    v_exp_f32 v194, v194
    v_exp_f32 v195, v195
    ds_write_b128 v28, v[132:135] offset:17408
    v_exp_f32 v196, v196
    v_exp_f32 v197, v197
    v_exp_f32 v198, v198
    v_exp_f32 v199, v199
    ds_write_b128 v28, v[136:139] offset:18432
    v_exp_f32 v200, v200
    v_exp_f32 v201, v201
    v_exp_f32 v202, v202
    v_exp_f32 v203, v203
    ds_write_b128 v28, v[140:143] offset:19456
    v_exp_f32 v204, v204
    v_exp_f32 v205, v205
    v_exp_f32 v206, v206
    v_exp_f32 v207, v207
    v_mul_f32 v217, v217, v220
    v_cvt_pk_bf16_f32 v208, v192, v193
    v_cvt_pk_bf16_f32 v209, v194, v195
    v_cvt_pk_bf16_f32 v210, v196, v197
    v_cvt_pk_bf16_f32 v211, v198, v199
    v_cvt_pk_bf16_f32 v212, v200, v201
    v_cvt_pk_bf16_f32 v213, v202, v203
    v_cvt_pk_bf16_f32 v214, v204, v205
    v_cvt_pk_bf16_f32 v215, v206, v207
    v_mul_f32 v64, v64, v220
    v_mul_f32 v65, v65, v220
    v_mul_f32 v66, v66, v220
    v_mul_f32 v67, v67, v220
    v_mul_f32 v68, v68, v220
    v_mul_f32 v69, v69, v220
    v_mul_f32 v70, v70, v220
    v_mul_f32 v71, v71, v220
    v_mul_f32 v72, v72, v220
    v_mul_f32 v73, v73, v220
    v_mul_f32 v74, v74, v220
    v_mul_f32 v75, v75, v220
    v_mul_f32 v76, v76, v220
    v_mul_f32 v77, v77, v220
    v_mul_f32 v78, v78, v220
    v_mul_f32 v79, v79, v220
    s_waitcnt lgkmcnt(0)
    s_barrier
    v_mfma_f32_32x32x16_bf16 v[64:79], a[64:67], v[208:211], v[64:79]
    ds_read_b128 v[144:147], v29 offset:16384
    v_mul_f32 v80, v80, v220
    v_mul_f32 v81, v81, v220
    ds_read_b128 v[148:151], v29 offset:17408
    s_waitcnt vmcnt(15)
    ds_write_b128 v26, a[224:227] offset:16384
    v_mul_f32 v82, v82, v220
    v_mul_f32 v83, v83, v220
    ds_read_b128 v[152:155], v29 offset:18432
    v_mul_f32 v84, v84, v220
    v_mfma_f32_32x32x16_bf16 v[64:79], a[68:71], v[212:215], v[64:79]
    v_mul_f32 v85, v85, v220
    ds_read_b128 v[156:159], v29 offset:19456
    v_mul_f32 v86, v86, v220
    s_waitcnt vmcnt(14)
    ds_write_b128 v26, a[228:231] offset:17408
    v_mul_f32 v87, v87, v220
    v_mul_f32 v88, v88, v220
    v_mul_f32 v89, v89, v220
    v_mul_f32 v90, v90, v220
    v_mul_f32 v91, v91, v220
    v_mul_f32 v92, v92, v220
    v_mul_f32 v93, v93, v220
    v_mul_f32 v94, v94, v220
    v_mul_f32 v95, v95, v220
    s_nop 1
    v_mfma_f32_32x32x16_bf16 v[80:95], a[72:75], v[208:211], v[80:95]
    ds_read_b128 v[160:163], v30 offset:16384
    v_mul_f32 v96, v96, v220
    v_mul_f32 v97, v97, v220
    ds_read_b128 v[164:167], v30 offset:17408
    s_waitcnt vmcnt(13)
    ds_write_b128 v26, a[232:235] offset:18432
    v_mul_f32 v98, v98, v220
    v_mul_f32 v99, v99, v220
    ds_read_b128 v[168:171], v30 offset:18432
    v_mul_f32 v100, v100, v220
    v_mfma_f32_32x32x16_bf16 v[80:95], a[76:79], v[212:215], v[80:95]
    v_mul_f32 v101, v101, v220
    ds_read_b128 v[172:175], v30 offset:19456
    v_mul_f32 v102, v102, v220
    s_waitcnt vmcnt(12)
    ds_write_b128 v26, a[236:239] offset:19456
    v_mul_f32 v103, v103, v220
    v_mul_f32 v104, v104, v220
    v_mul_f32 v105, v105, v220
    v_mul_f32 v106, v106, v220
    v_mul_f32 v107, v107, v220
    v_mul_f32 v108, v108, v220
    v_mul_f32 v109, v109, v220
    v_mul_f32 v110, v110, v220
    v_mul_f32 v111, v111, v220
    s_nop 1
    v_mfma_f32_32x32x16_bf16 v[96:111], a[80:83], v[208:211], v[96:111]
    ds_read_b128 v[176:179], v31 offset:16384
    v_mul_f32 v112, v112, v220
    v_mul_f32 v113, v113, v220
    ds_read_b128 v[180:183], v31 offset:17408
    s_waitcnt vmcnt(11)
    ds_write_b128 v26, a[240:243] offset:20480
    v_mul_f32 v114, v114, v220
    v_mul_f32 v115, v115, v220
    ds_read_b128 v[184:187], v31 offset:18432
    v_mul_f32 v116, v116, v220
    v_mfma_f32_32x32x16_bf16 v[96:111], a[84:87], v[212:215], v[96:111]
    v_mul_f32 v117, v117, v220
    ds_read_b128 v[188:191], v31 offset:19456
    v_mul_f32 v118, v118, v220
    s_waitcnt vmcnt(10)
    ds_write_b128 v26, a[244:247] offset:21504
    v_mul_f32 v119, v119, v220
    v_mul_f32 v120, v120, v220
    v_mul_f32 v121, v121, v220
    v_mul_f32 v122, v122, v220
    v_mul_f32 v123, v123, v220
    v_mul_f32 v124, v124, v220
    v_mul_f32 v125, v125, v220
    v_mul_f32 v126, v126, v220
    v_mul_f32 v127, v127, v220
    s_nop 1
    v_mfma_f32_32x32x16_bf16 v[112:127], a[88:91], v[208:211], v[112:127]
    v_add_f32 v192, v192, v200
    v_add_f32 v193, v193, v201
    v_add_f32 v194, v194, v202
    v_add_f32 v195, v195, v203
    s_waitcnt vmcnt(9)
    ds_write_b128 v26, a[248:251] offset:22528
    v_add_f32 v196, v196, v204
    v_add_f32 v197, v197, v205
    v_add_f32 v198, v198, v206
    v_add_f32 v199, v199, v207
    v_mfma_f32_32x32x16_bf16 v[112:127], a[92:95], v[212:215], v[112:127]
    v_add_f32 v192, v192, v196
    v_add_f32 v193, v193, v197
    v_add_f32 v194, v194, v198
    s_waitcnt vmcnt(8)
    ds_write_b128 v26, a[252:255] offset:23552
    v_add_f32 v195, v195, v199
    v_add_f32 v192, v192, v193
    v_add_f32 v194, v194, v195
    v_add_f32 v192, v192, v194
    v_add_f32 v217, v217, v192
    ds_read_b128 a[32:35], v32 offset:16384
    ds_read_b128 a[36:39], v33 offset:16384
    ds_read_b128 a[40:43], v34 offset:16384
    ds_read_b128 a[44:47], v35 offset:16384
    ds_read_b128 a[48:51], v36 offset:16384
    ds_read_b128 a[52:55], v37 offset:16384
    ds_read_b128 a[56:59], v38 offset:16384
    ds_read_b128 a[60:63], v39 offset:16384
    s_waitcnt lgkmcnt(8)
    v_add_f32 v144, v144, v128
    v_add_f32 v145, v145, v129
    v_add_f32 v146, v146, v130
    v_add_f32 v147, v147, v131
    v_add_f32 v148, v148, v132
    v_add_f32 v149, v149, v133
    v_add_f32 v150, v150, v134
    v_add_f32 v151, v151, v135
    v_add_f32 v152, v152, v136
    v_add_f32 v153, v153, v137
    v_add_f32 v154, v154, v138
    v_add_f32 v155, v155, v139
    v_add_f32 v156, v156, v140
    v_add_f32 v157, v157, v141
    v_add_f32 v158, v158, v142
    v_add_f32 v159, v159, v143
    s_waitcnt lgkmcnt(0)
    v_mfma_f32_32x32x16_bf16 v[128:143], a[32:35], a[0:3], 0
    ds_read_b64_tr_b16 a[64:65], v40 offset:8192
    ds_read_b64_tr_b16 a[66:67], v41 offset:10240
    v_add_f32 v160, v160, v176
    v_add_f32 v161, v161, v177
    v_add_f32 v162, v162, v178
    v_add_f32 v163, v163, v179
    v_add_f32 v164, v164, v180
    v_mfma_f32_32x32x16_bf16 v[128:143], a[36:39], a[4:7], v[128:143]
    ds_read_b64_tr_b16 a[72:73], v42 offset:8192
    ds_read_b64_tr_b16 a[74:75], v43 offset:10240
    v_add_f32 v165, v165, v181
    v_add_f32 v166, v166, v182
    v_add_f32 v167, v167, v183
    v_add_f32 v168, v168, v184
    v_add_f32 v169, v169, v185
    v_mfma_f32_32x32x16_bf16 v[128:143], a[40:43], a[8:11], v[128:143]
    ds_read_b64_tr_b16 a[80:81], v44 offset:8192
    ds_read_b64_tr_b16 a[82:83], v45 offset:10240
    v_add_f32 v170, v170, v186
    v_add_f32 v171, v171, v187
    v_add_f32 v172, v172, v188
    v_add_f32 v173, v173, v189
    v_add_f32 v174, v174, v190
    v_mfma_f32_32x32x16_bf16 v[128:143], a[44:47], a[12:15], v[128:143]
    ds_read_b64_tr_b16 a[88:89], v46 offset:8192
    ds_read_b64_tr_b16 a[90:91], v47 offset:10240
    v_add_f32 v175, v175, v191
    v_add_f32 v144, v144, v160
    v_add_f32 v145, v145, v161
    v_add_f32 v146, v146, v162
    v_add_f32 v147, v147, v163
    v_mfma_f32_32x32x16_bf16 v[128:143], a[48:51], a[16:19], v[128:143]
    ds_read_b64_tr_b16 a[68:69], v40 offset:12288
    ds_read_b64_tr_b16 a[70:71], v41 offset:14336
    v_add_f32 v148, v148, v164
    v_add_f32 v149, v149, v165
    v_add_f32 v150, v150, v166
    v_add_f32 v151, v151, v167
    v_add_f32 v152, v152, v168
    v_mfma_f32_32x32x16_bf16 v[128:143], a[52:55], a[20:23], v[128:143]
    ds_read_b64_tr_b16 a[76:77], v42 offset:12288
    ds_read_b64_tr_b16 a[78:79], v43 offset:14336
    v_add_f32 v153, v153, v169
    v_add_f32 v154, v154, v170
    v_add_f32 v155, v155, v171
    v_add_f32 v156, v156, v172
    v_add_f32 v157, v157, v173
    v_mfma_f32_32x32x16_bf16 v[128:143], a[56:59], a[24:27], v[128:143]
    ds_read_b64_tr_b16 a[84:85], v44 offset:12288
    ds_read_b64_tr_b16 a[86:87], v45 offset:14336
    v_add_f32 v158, v158, v174
    v_add_f32 v159, v159, v175
    v_max3_f32 v218, v144, v145, v146
    v_max3_f32 v219, v147, v148, v149
    v_max3_f32 v220, v150, v151, v152
    v_mfma_f32_32x32x16_bf16 v[128:143], a[60:63], a[28:31], v[128:143]
    ds_read_b64_tr_b16 a[92:93], v46 offset:12288
    ds_read_b64_tr_b16 a[94:95], v47 offset:14336
    v_max3_f32 v221, v153, v154, v155
    v_max3_f32 v218, v218, v156, v157
    v_max3_f32 v219, v219, v158, v159
    v_max3_f32 v218, v218, v219, v220
    v_max_f32 v218, v218, v221
    v_mov_b32 v219, v218
    s_nop 1
    v_permlane32_swap_b32 v218, v219
    v_max3_f32 v218, v218, v219, v216
    v_sub_f32 v220, v216, v218
    v_mov_b32 v216, v218
    v_exp_f32 v220, v220
    v_sub_f32 v192, v144, v218
    v_sub_f32 v193, v145, v218
    v_sub_f32 v194, v146, v218
    v_sub_f32 v195, v147, v218
    v_sub_f32 v196, v148, v218
    v_sub_f32 v197, v149, v218
    v_sub_f32 v198, v150, v218
    v_sub_f32 v199, v151, v218
    v_sub_f32 v200, v152, v218
    v_sub_f32 v201, v153, v218
    v_sub_f32 v202, v154, v218
    v_sub_f32 v203, v155, v218
    v_sub_f32 v204, v156, v218
    v_sub_f32 v205, v157, v218
    v_sub_f32 v206, v158, v218
    v_sub_f32 v207, v159, v218
    ds_write_b128 v28, v[128:131] offset:0
    v_exp_f32 v192, v192
    v_exp_f32 v193, v193
    v_exp_f32 v194, v194
    v_exp_f32 v195, v195
    ds_write_b128 v28, v[132:135] offset:1024
    v_exp_f32 v196, v196
    v_exp_f32 v197, v197
    v_exp_f32 v198, v198
    v_exp_f32 v199, v199
    ds_write_b128 v28, v[136:139] offset:2048
    v_exp_f32 v200, v200
    v_exp_f32 v201, v201
    v_exp_f32 v202, v202
    v_exp_f32 v203, v203
    ds_write_b128 v28, v[140:143] offset:3072
    v_exp_f32 v204, v204
    v_exp_f32 v205, v205
    v_exp_f32 v206, v206
    v_exp_f32 v207, v207
    v_mul_f32 v217, v217, v220
    v_cvt_pk_bf16_f32 v208, v192, v193
    v_cvt_pk_bf16_f32 v209, v194, v195
    v_cvt_pk_bf16_f32 v210, v196, v197
    v_cvt_pk_bf16_f32 v211, v198, v199
    v_cvt_pk_bf16_f32 v212, v200, v201
    v_cvt_pk_bf16_f32 v213, v202, v203
    v_cvt_pk_bf16_f32 v214, v204, v205
    v_cvt_pk_bf16_f32 v215, v206, v207
    v_mul_f32 v64, v64, v220
    v_mul_f32 v65, v65, v220
    v_mul_f32 v66, v66, v220
    v_mul_f32 v67, v67, v220
    v_mul_f32 v68, v68, v220
    v_mul_f32 v69, v69, v220
    v_mul_f32 v70, v70, v220
    v_mul_f32 v71, v71, v220
    v_mul_f32 v72, v72, v220
    v_mul_f32 v73, v73, v220
    v_mul_f32 v74, v74, v220
    v_mul_f32 v75, v75, v220
    v_mul_f32 v76, v76, v220
    v_mul_f32 v77, v77, v220
    v_mul_f32 v78, v78, v220
    v_mul_f32 v79, v79, v220
    s_waitcnt lgkmcnt(0)
    s_barrier
    v_mfma_f32_32x32x16_bf16 v[64:79], a[64:67], v[208:211], v[64:79]
    ds_read_b128 v[144:147], v29 offset:0
    v_mul_f32 v80, v80, v220
    v_mul_f32 v81, v81, v220
    ds_read_b128 v[148:151], v29 offset:1024
    s_waitcnt vmcnt(7)
    ds_write_b128 v26, v[224:227] offset:24576
    v_mul_f32 v82, v82, v220
    v_mul_f32 v83, v83, v220
    ds_read_b128 v[152:155], v29 offset:2048
    v_mul_f32 v84, v84, v220
    v_mfma_f32_32x32x16_bf16 v[64:79], a[68:71], v[212:215], v[64:79]
    v_mul_f32 v85, v85, v220
    ds_read_b128 v[156:159], v29 offset:3072
    v_mul_f32 v86, v86, v220
    s_waitcnt vmcnt(6)
    ds_write_b128 v26, v[228:231] offset:25600
    v_mul_f32 v87, v87, v220
    v_mul_f32 v88, v88, v220
    v_mul_f32 v89, v89, v220
    v_mul_f32 v90, v90, v220
    v_mul_f32 v91, v91, v220
    v_mul_f32 v92, v92, v220
    v_mul_f32 v93, v93, v220
    v_mul_f32 v94, v94, v220
    v_mul_f32 v95, v95, v220
    s_nop 1
    v_mfma_f32_32x32x16_bf16 v[80:95], a[72:75], v[208:211], v[80:95]
    ds_read_b128 v[160:163], v30 offset:0
    v_mul_f32 v96, v96, v220
    v_mul_f32 v97, v97, v220
    ds_read_b128 v[164:167], v30 offset:1024
    s_waitcnt vmcnt(5)
    ds_write_b128 v26, v[232:235] offset:26624
    v_mul_f32 v98, v98, v220
    v_mul_f32 v99, v99, v220
    ds_read_b128 v[168:171], v30 offset:2048
    v_mul_f32 v100, v100, v220
    v_mfma_f32_32x32x16_bf16 v[80:95], a[76:79], v[212:215], v[80:95]
    v_mul_f32 v101, v101, v220
    ds_read_b128 v[172:175], v30 offset:3072
    v_mul_f32 v102, v102, v220
    s_waitcnt vmcnt(4)
    ds_write_b128 v26, v[236:239] offset:27648
    v_mul_f32 v103, v103, v220
    v_mul_f32 v104, v104, v220
    v_mul_f32 v105, v105, v220
    v_mul_f32 v106, v106, v220
    v_mul_f32 v107, v107, v220
    v_mul_f32 v108, v108, v220
    v_mul_f32 v109, v109, v220
    v_mul_f32 v110, v110, v220
    v_mul_f32 v111, v111, v220
    s_nop 1
    v_mfma_f32_32x32x16_bf16 v[96:111], a[80:83], v[208:211], v[96:111]
    ds_read_b128 v[176:179], v31 offset:0
    v_mul_f32 v112, v112, v220
    v_mul_f32 v113, v113, v220
    ds_read_b128 v[180:183], v31 offset:1024
    s_waitcnt vmcnt(3)
    ds_write_b128 v26, v[240:243] offset:28672
    v_mul_f32 v114, v114, v220
    v_mul_f32 v115, v115, v220
    ds_read_b128 v[184:187], v31 offset:2048
    v_mul_f32 v116, v116, v220
    v_mfma_f32_32x32x16_bf16 v[96:111], a[84:87], v[212:215], v[96:111]
    v_mul_f32 v117, v117, v220
    ds_read_b128 v[188:191], v31 offset:3072
    v_mul_f32 v118, v118, v220
    s_waitcnt vmcnt(2)
    ds_write_b128 v26, v[244:247] offset:29696
    v_mul_f32 v119, v119, v220
    v_mul_f32 v120, v120, v220
    v_mul_f32 v121, v121, v220
    v_mul_f32 v122, v122, v220
    v_mul_f32 v123, v123, v220
    v_mul_f32 v124, v124, v220
    v_mul_f32 v125, v125, v220
    v_mul_f32 v126, v126, v220
    v_mul_f32 v127, v127, v220
    s_nop 1
    v_mfma_f32_32x32x16_bf16 v[112:127], a[88:91], v[208:211], v[112:127]
    v_add_f32 v192, v192, v200
    v_add_f32 v193, v193, v201
    v_add_f32 v194, v194, v202
    v_add_f32 v195, v195, v203
    s_waitcnt vmcnt(1)
    ds_write_b128 v26, v[248:251] offset:30720
    v_add_f32 v196, v196, v204
    v_add_f32 v197, v197, v205
    v_add_f32 v198, v198, v206
    v_add_f32 v199, v199, v207
    v_mfma_f32_32x32x16_bf16 v[112:127], a[92:95], v[212:215], v[112:127]
    v_add_f32 v192, v192, v196
    v_add_f32 v193, v193, v197
    v_add_f32 v194, v194, v198
    s_waitcnt vmcnt(0)
    ds_write_b128 v26, v[252:255] offset:31744
    v_add_f32 v195, v195, v199
    v_add_f32 v192, v192, v193
    v_add_f32 v194, v194, v195
    v_add_f32 v192, v192, v194
    v_add_f32 v217, v217, v192
    ds_read_b128 a[32:35], v32 offset:24576
    ds_read_b128 a[36:39], v33 offset:24576
    ds_read_b128 a[40:43], v34 offset:24576
    ds_read_b128 a[44:47], v35 offset:24576
    ds_read_b128 a[48:51], v36 offset:24576
    ds_read_b128 a[52:55], v37 offset:24576
    ds_read_b128 a[56:59], v38 offset:24576
    ds_read_b128 a[60:63], v39 offset:24576
    s_waitcnt lgkmcnt(8)
    v_add_f32 v144, v144, v128
    v_add_f32 v145, v145, v129
    v_add_f32 v146, v146, v130
    v_add_f32 v147, v147, v131
    v_add_f32 v148, v148, v132
    v_add_f32 v149, v149, v133
    v_add_f32 v150, v150, v134
    v_add_f32 v151, v151, v135
    v_add_f32 v152, v152, v136
    v_add_f32 v153, v153, v137
    v_add_f32 v154, v154, v138
    v_add_f32 v155, v155, v139
    v_add_f32 v156, v156, v140
    v_add_f32 v157, v157, v141
    v_add_f32 v158, v158, v142
    v_add_f32 v159, v159, v143
    s_waitcnt lgkmcnt(0)
    v_mfma_f32_32x32x16_bf16 v[128:143], a[32:35], a[0:3], 0
    ds_read_b64_tr_b16 a[64:65], v40 offset:16384
    ds_read_b64_tr_b16 a[66:67], v41 offset:18432
    v_add_f32 v160, v160, v176
    v_add_f32 v161, v161, v177
    v_add_f32 v162, v162, v178
    v_add_f32 v163, v163, v179
    v_add_f32 v164, v164, v180
    v_mfma_f32_32x32x16_bf16 v[128:143], a[36:39], a[4:7], v[128:143]
    ds_read_b64_tr_b16 a[72:73], v42 offset:16384
    ds_read_b64_tr_b16 a[74:75], v43 offset:18432
    v_add_f32 v165, v165, v181
    v_add_f32 v166, v166, v182
    v_add_f32 v167, v167, v183
    v_add_f32 v168, v168, v184
    v_add_f32 v169, v169, v185
    v_mfma_f32_32x32x16_bf16 v[128:143], a[40:43], a[8:11], v[128:143]
    ds_read_b64_tr_b16 a[80:81], v44 offset:16384
    ds_read_b64_tr_b16 a[82:83], v45 offset:18432
    v_add_f32 v170, v170, v186
    v_add_f32 v171, v171, v187
    v_add_f32 v172, v172, v188
    v_add_f32 v173, v173, v189
    v_add_f32 v174, v174, v190
    v_mfma_f32_32x32x16_bf16 v[128:143], a[44:47], a[12:15], v[128:143]
    ds_read_b64_tr_b16 a[88:89], v46 offset:16384
    ds_read_b64_tr_b16 a[90:91], v47 offset:18432
    v_add_f32 v175, v175, v191
    v_add_f32 v144, v144, v160
    v_add_f32 v145, v145, v161
    v_add_f32 v146, v146, v162
    v_add_f32 v147, v147, v163
    v_mfma_f32_32x32x16_bf16 v[128:143], a[48:51], a[16:19], v[128:143]
    ds_read_b64_tr_b16 a[68:69], v40 offset:20480
    ds_read_b64_tr_b16 a[70:71], v41 offset:22528
    v_add_f32 v148, v148, v164
    v_add_f32 v149, v149, v165
    v_add_f32 v150, v150, v166
    v_add_f32 v151, v151, v167
    v_add_f32 v152, v152, v168
    v_mfma_f32_32x32x16_bf16 v[128:143], a[52:55], a[20:23], v[128:143]
    ds_read_b64_tr_b16 a[76:77], v42 offset:20480
    ds_read_b64_tr_b16 a[78:79], v43 offset:22528
    v_add_f32 v153, v153, v169
    v_add_f32 v154, v154, v170
    v_add_f32 v155, v155, v171
    v_add_f32 v156, v156, v172
    v_add_f32 v157, v157, v173
    v_mfma_f32_32x32x16_bf16 v[128:143], a[56:59], a[24:27], v[128:143]
    ds_read_b64_tr_b16 a[84:85], v44 offset:20480
    ds_read_b64_tr_b16 a[86:87], v45 offset:22528
    v_add_f32 v158, v158, v174
    v_add_f32 v159, v159, v175
    v_max3_f32 v218, v144, v145, v146
    v_max3_f32 v219, v147, v148, v149
    v_max3_f32 v220, v150, v151, v152
    v_mfma_f32_32x32x16_bf16 v[128:143], a[60:63], a[28:31], v[128:143]
    ds_read_b64_tr_b16 a[92:93], v46 offset:20480
    ds_read_b64_tr_b16 a[94:95], v47 offset:22528
    v_max3_f32 v221, v153, v154, v155
    v_max3_f32 v218, v218, v156, v157
    v_max3_f32 v219, v219, v158, v159
    v_max3_f32 v218, v218, v219, v220
    v_max_f32 v218, v218, v221
    v_mov_b32 v219, v218
    s_nop 1
    v_permlane32_swap_b32 v218, v219
    v_max3_f32 v218, v218, v219, v216
    v_sub_f32 v220, v216, v218
    v_mov_b32 v216, v218
    v_exp_f32 v220, v220
    v_sub_f32 v192, v144, v218
    v_sub_f32 v193, v145, v218
    v_sub_f32 v194, v146, v218
    v_sub_f32 v195, v147, v218
    v_sub_f32 v196, v148, v218
    v_sub_f32 v197, v149, v218
    v_sub_f32 v198, v150, v218
    v_sub_f32 v199, v151, v218
    v_sub_f32 v200, v152, v218
    v_sub_f32 v201, v153, v218
    v_sub_f32 v202, v154, v218
    v_sub_f32 v203, v155, v218
    v_sub_f32 v204, v156, v218
    v_sub_f32 v205, v157, v218
    v_sub_f32 v206, v158, v218
    v_sub_f32 v207, v159, v218
    ds_write_b128 v28, v[128:131] offset:16384
    v_exp_f32 v192, v192
    v_exp_f32 v193, v193
    v_exp_f32 v194, v194
    v_exp_f32 v195, v195
    ds_write_b128 v28, v[132:135] offset:17408
    v_exp_f32 v196, v196
    v_exp_f32 v197, v197
    v_exp_f32 v198, v198
    v_exp_f32 v199, v199
    ds_write_b128 v28, v[136:139] offset:18432
    v_exp_f32 v200, v200
    v_exp_f32 v201, v201
    v_exp_f32 v202, v202
    v_exp_f32 v203, v203
    ds_write_b128 v28, v[140:143] offset:19456
    v_exp_f32 v204, v204
    v_exp_f32 v205, v205
    v_exp_f32 v206, v206
    v_exp_f32 v207, v207
    v_mul_f32 v217, v217, v220
    v_cvt_pk_bf16_f32 v208, v192, v193
    v_cvt_pk_bf16_f32 v209, v194, v195
    v_cvt_pk_bf16_f32 v210, v196, v197
    v_cvt_pk_bf16_f32 v211, v198, v199
    v_cvt_pk_bf16_f32 v212, v200, v201
    v_cvt_pk_bf16_f32 v213, v202, v203
    v_cvt_pk_bf16_f32 v214, v204, v205
    v_cvt_pk_bf16_f32 v215, v206, v207
    v_mul_f32 v64, v64, v220
    v_mul_f32 v65, v65, v220
    v_mul_f32 v66, v66, v220
    v_mul_f32 v67, v67, v220
    v_mul_f32 v68, v68, v220
    v_mul_f32 v69, v69, v220
    v_mul_f32 v70, v70, v220
    v_mul_f32 v71, v71, v220
    v_mul_f32 v72, v72, v220
    v_mul_f32 v73, v73, v220
    v_mul_f32 v74, v74, v220
    v_mul_f32 v75, v75, v220
    v_mul_f32 v76, v76, v220
    v_mul_f32 v77, v77, v220
    v_mul_f32 v78, v78, v220
    v_mul_f32 v79, v79, v220
    s_waitcnt lgkmcnt(0)
    s_barrier
    v_mfma_f32_32x32x16_bf16 v[64:79], a[64:67], v[208:211], v[64:79]
    ds_read_b128 v[144:147], v29 offset:16384
    v_mul_f32 v80, v80, v220
    v_mul_f32 v81, v81, v220
    ds_read_b128 v[148:151], v29 offset:17408
    v_mul_f32 v82, v82, v220
    v_mul_f32 v83, v83, v220
    ds_read_b128 v[152:155], v29 offset:18432
    v_mul_f32 v84, v84, v220
    v_mfma_f32_32x32x16_bf16 v[64:79], a[68:71], v[212:215], v[64:79]
    v_mul_f32 v85, v85, v220
    ds_read_b128 v[156:159], v29 offset:19456
    v_mul_f32 v86, v86, v220
    v_mul_f32 v87, v87, v220
    v_mul_f32 v88, v88, v220
    v_mul_f32 v89, v89, v220
    v_mul_f32 v90, v90, v220
    v_mul_f32 v91, v91, v220
    v_mul_f32 v92, v92, v220
    v_mul_f32 v93, v93, v220
    v_mul_f32 v94, v94, v220
    v_mul_f32 v95, v95, v220
    s_nop 1
    v_mfma_f32_32x32x16_bf16 v[80:95], a[72:75], v[208:211], v[80:95]
    ds_read_b128 v[160:163], v30 offset:16384
    v_mul_f32 v96, v96, v220
    v_mul_f32 v97, v97, v220
    ds_read_b128 v[164:167], v30 offset:17408
    v_mul_f32 v98, v98, v220
    v_mul_f32 v99, v99, v220
    ds_read_b128 v[168:171], v30 offset:18432
    v_mul_f32 v100, v100, v220
    v_mfma_f32_32x32x16_bf16 v[80:95], a[76:79], v[212:215], v[80:95]
    v_mul_f32 v101, v101, v220
    ds_read_b128 v[172:175], v30 offset:19456
    v_mul_f32 v102, v102, v220
    v_mul_f32 v103, v103, v220
    v_mul_f32 v104, v104, v220
    v_mul_f32 v105, v105, v220
    v_mul_f32 v106, v106, v220
    v_mul_f32 v107, v107, v220
    v_mul_f32 v108, v108, v220
    v_mul_f32 v109, v109, v220
    v_mul_f32 v110, v110, v220
    v_mul_f32 v111, v111, v220
    s_nop 1
    v_mfma_f32_32x32x16_bf16 v[96:111], a[80:83], v[208:211], v[96:111]
    ds_read_b128 v[176:179], v31 offset:16384
    v_mul_f32 v112, v112, v220
    v_mul_f32 v113, v113, v220
    ds_read_b128 v[180:183], v31 offset:17408
    v_mul_f32 v114, v114, v220
    v_mul_f32 v115, v115, v220
    ds_read_b128 v[184:187], v31 offset:18432
    v_mul_f32 v116, v116, v220
    v_mfma_f32_32x32x16_bf16 v[96:111], a[84:87], v[212:215], v[96:111]
    v_mul_f32 v117, v117, v220
    ds_read_b128 v[188:191], v31 offset:19456
    v_mul_f32 v118, v118, v220
    v_mul_f32 v119, v119, v220
    v_mul_f32 v120, v120, v220
    v_mul_f32 v121, v121, v220
    v_mul_f32 v122, v122, v220
    v_mul_f32 v123, v123, v220
    v_mul_f32 v124, v124, v220
    v_mul_f32 v125, v125, v220
    v_mul_f32 v126, v126, v220
    v_mul_f32 v127, v127, v220
    s_nop 1
    v_mfma_f32_32x32x16_bf16 v[112:127], a[88:91], v[208:211], v[112:127]
    v_add_f32 v192, v192, v200
    v_add_f32 v193, v193, v201
    v_add_f32 v194, v194, v202
    v_add_f32 v195, v195, v203
    v_add_f32 v196, v196, v204
    v_add_f32 v197, v197, v205
    v_add_f32 v198, v198, v206
    v_add_f32 v199, v199, v207
    v_mfma_f32_32x32x16_bf16 v[112:127], a[92:95], v[212:215], v[112:127]
    v_add_f32 v192, v192, v196
    v_add_f32 v193, v193, v197
    v_add_f32 v194, v194, v198
    v_add_f32 v195, v195, v199
    v_add_f32 v192, v192, v193
    v_add_f32 v194, v194, v195
    v_add_f32 v192, v192, v194
    v_add_f32 v217, v217, v192
    s_waitcnt lgkmcnt(0)
    v_add_f32 v144, v144, v128
    v_add_f32 v145, v145, v129
    v_add_f32 v146, v146, v130
    v_add_f32 v147, v147, v131
    v_add_f32 v148, v148, v132
    v_add_f32 v149, v149, v133
    v_add_f32 v150, v150, v134
    v_add_f32 v151, v151, v135
    v_add_f32 v152, v152, v136
    v_add_f32 v153, v153, v137
    v_add_f32 v154, v154, v138
    v_add_f32 v155, v155, v139
    v_add_f32 v156, v156, v140
    v_add_f32 v157, v157, v141
    v_add_f32 v158, v158, v142
    v_add_f32 v159, v159, v143
    s_waitcnt lgkmcnt(0)
    ds_read_b64_tr_b16 a[64:65], v40 offset:24576
    ds_read_b64_tr_b16 a[66:67], v41 offset:26624
    v_add_f32 v160, v160, v176
    v_add_f32 v161, v161, v177
    v_add_f32 v162, v162, v178
    v_add_f32 v163, v163, v179
    v_add_f32 v164, v164, v180
    ds_read_b64_tr_b16 a[72:73], v42 offset:24576
    ds_read_b64_tr_b16 a[74:75], v43 offset:26624
    v_add_f32 v165, v165, v181
    v_add_f32 v166, v166, v182
    v_add_f32 v167, v167, v183
    v_add_f32 v168, v168, v184
    v_add_f32 v169, v169, v185
    ds_read_b64_tr_b16 a[80:81], v44 offset:24576
    ds_read_b64_tr_b16 a[82:83], v45 offset:26624
    v_add_f32 v170, v170, v186
    v_add_f32 v171, v171, v187
    v_add_f32 v172, v172, v188
    v_add_f32 v173, v173, v189
    v_add_f32 v174, v174, v190
    ds_read_b64_tr_b16 a[88:89], v46 offset:24576
    ds_read_b64_tr_b16 a[90:91], v47 offset:26624
    v_add_f32 v175, v175, v191
    v_add_f32 v144, v144, v160
    v_add_f32 v145, v145, v161
    v_add_f32 v146, v146, v162
    v_add_f32 v147, v147, v163
    ds_read_b64_tr_b16 a[68:69], v40 offset:28672
    ds_read_b64_tr_b16 a[70:71], v41 offset:30720
    v_add_f32 v148, v148, v164
    v_add_f32 v149, v149, v165
    v_add_f32 v150, v150, v166
    v_add_f32 v151, v151, v167
    v_add_f32 v152, v152, v168
    ds_read_b64_tr_b16 a[76:77], v42 offset:28672
    ds_read_b64_tr_b16 a[78:79], v43 offset:30720
    v_add_f32 v153, v153, v169
    v_add_f32 v154, v154, v170
    v_add_f32 v155, v155, v171
    v_add_f32 v156, v156, v172
    v_add_f32 v157, v157, v173
    ds_read_b64_tr_b16 a[84:85], v44 offset:28672
    ds_read_b64_tr_b16 a[86:87], v45 offset:30720
    v_add_f32 v158, v158, v174
    v_add_f32 v159, v159, v175
    v_max3_f32 v218, v144, v145, v146
    v_max3_f32 v219, v147, v148, v149
    v_max3_f32 v220, v150, v151, v152
    ds_read_b64_tr_b16 a[92:93], v46 offset:28672
    ds_read_b64_tr_b16 a[94:95], v47 offset:30720
    v_max3_f32 v221, v153, v154, v155
    v_max3_f32 v218, v218, v156, v157
    v_max3_f32 v219, v219, v158, v159
    v_max3_f32 v218, v218, v219, v220
    v_max_f32 v218, v218, v221
    v_mov_b32 v219, v218
    s_nop 1
    v_permlane32_swap_b32 v218, v219
    v_max3_f32 v218, v218, v219, v216
    v_sub_f32 v220, v216, v218
    v_mov_b32 v216, v218
    v_exp_f32 v220, v220
    v_sub_f32 v192, v144, v218
    v_sub_f32 v193, v145, v218
    v_sub_f32 v194, v146, v218
    v_sub_f32 v195, v147, v218
    v_sub_f32 v196, v148, v218
    v_sub_f32 v197, v149, v218
    v_sub_f32 v198, v150, v218
    v_sub_f32 v199, v151, v218
    v_sub_f32 v200, v152, v218
    v_sub_f32 v201, v153, v218
    v_sub_f32 v202, v154, v218
    v_sub_f32 v203, v155, v218
    v_sub_f32 v204, v156, v218
    v_sub_f32 v205, v157, v218
    v_sub_f32 v206, v158, v218
    v_sub_f32 v207, v159, v218
    v_exp_f32 v192, v192
    v_exp_f32 v193, v193
    v_exp_f32 v194, v194
    v_exp_f32 v195, v195
    v_exp_f32 v196, v196
    v_exp_f32 v197, v197
    v_exp_f32 v198, v198
    v_exp_f32 v199, v199
    v_exp_f32 v200, v200
    v_exp_f32 v201, v201
    v_exp_f32 v202, v202
    v_exp_f32 v203, v203
    v_exp_f32 v204, v204
    v_exp_f32 v205, v205
    v_exp_f32 v206, v206
    v_exp_f32 v207, v207
    v_mul_f32 v217, v217, v220
    v_cvt_pk_bf16_f32 v208, v192, v193
    v_cvt_pk_bf16_f32 v209, v194, v195
    v_cvt_pk_bf16_f32 v210, v196, v197
    v_cvt_pk_bf16_f32 v211, v198, v199
    v_cvt_pk_bf16_f32 v212, v200, v201
    v_cvt_pk_bf16_f32 v213, v202, v203
    v_cvt_pk_bf16_f32 v214, v204, v205
    v_cvt_pk_bf16_f32 v215, v206, v207
    v_mul_f32 v64, v64, v220
    v_mul_f32 v65, v65, v220
    v_mul_f32 v66, v66, v220
    v_mul_f32 v67, v67, v220
    v_mul_f32 v68, v68, v220
    v_mul_f32 v69, v69, v220
    v_mul_f32 v70, v70, v220
    v_mul_f32 v71, v71, v220
    v_mul_f32 v72, v72, v220
    v_mul_f32 v73, v73, v220
    v_mul_f32 v74, v74, v220
    v_mul_f32 v75, v75, v220
    v_mul_f32 v76, v76, v220
    v_mul_f32 v77, v77, v220
    v_mul_f32 v78, v78, v220
    v_mul_f32 v79, v79, v220
    s_waitcnt lgkmcnt(0)
    s_nop 0
    v_mfma_f32_32x32x16_bf16 v[64:79], a[64:67], v[208:211], v[64:79]
    v_mul_f32 v80, v80, v220
    v_mul_f32 v81, v81, v220
    v_mul_f32 v82, v82, v220
    v_mul_f32 v83, v83, v220
    v_mul_f32 v84, v84, v220
    v_mul_f32 v85, v85, v220
    v_mul_f32 v86, v86, v220
    v_mul_f32 v87, v87, v220
    v_mfma_f32_32x32x16_bf16 v[64:79], a[68:71], v[212:215], v[64:79]
    v_mul_f32 v88, v88, v220
    v_mul_f32 v89, v89, v220
    v_mul_f32 v90, v90, v220
    v_mul_f32 v91, v91, v220
    v_mul_f32 v92, v92, v220
    v_mul_f32 v93, v93, v220
    v_mul_f32 v94, v94, v220
    v_mul_f32 v95, v95, v220
    s_nop 1
    v_mfma_f32_32x32x16_bf16 v[80:95], a[72:75], v[208:211], v[80:95]
    v_mul_f32 v96, v96, v220
    v_mul_f32 v97, v97, v220
    v_mul_f32 v98, v98, v220
    v_mul_f32 v99, v99, v220
    v_mul_f32 v100, v100, v220
    v_mul_f32 v101, v101, v220
    v_mul_f32 v102, v102, v220
    v_mul_f32 v103, v103, v220
    v_mfma_f32_32x32x16_bf16 v[80:95], a[76:79], v[212:215], v[80:95]
    v_mul_f32 v104, v104, v220
    v_mul_f32 v105, v105, v220
    v_mul_f32 v106, v106, v220
    v_mul_f32 v107, v107, v220
    v_mul_f32 v108, v108, v220
    v_mul_f32 v109, v109, v220
    v_mul_f32 v110, v110, v220
    v_mul_f32 v111, v111, v220
    s_nop 1
    v_mfma_f32_32x32x16_bf16 v[96:111], a[80:83], v[208:211], v[96:111]
    v_mul_f32 v112, v112, v220
    v_mul_f32 v113, v113, v220
    v_mul_f32 v114, v114, v220
    v_mul_f32 v115, v115, v220
    v_mul_f32 v116, v116, v220
    v_mul_f32 v117, v117, v220
    v_mul_f32 v118, v118, v220
    v_mul_f32 v119, v119, v220
    v_mfma_f32_32x32x16_bf16 v[96:111], a[84:87], v[212:215], v[96:111]
    v_mul_f32 v120, v120, v220
    v_mul_f32 v121, v121, v220
    v_mul_f32 v122, v122, v220
    v_mul_f32 v123, v123, v220
    v_mul_f32 v124, v124, v220
    v_mul_f32 v125, v125, v220
    v_mul_f32 v126, v126, v220
    v_mul_f32 v127, v127, v220
    s_nop 1
    v_mfma_f32_32x32x16_bf16 v[112:127], a[88:91], v[208:211], v[112:127]
    v_add_f32 v192, v192, v200
    v_add_f32 v193, v193, v201
    v_add_f32 v194, v194, v202
    v_add_f32 v195, v195, v203
    v_add_f32 v196, v196, v204
    v_add_f32 v197, v197, v205
    v_add_f32 v198, v198, v206
    v_add_f32 v199, v199, v207
    v_mfma_f32_32x32x16_bf16 v[112:127], a[92:95], v[212:215], v[112:127]
    v_add_f32 v192, v192, v196
    v_add_f32 v193, v193, v197
    v_add_f32 v194, v194, v198
    v_add_f32 v195, v195, v199
    v_add_f32 v192, v192, v193
    v_add_f32 v194, v194, v195
    v_add_f32 v192, v192, v194
    v_add_f32 v217, v217, v192
    s_waitcnt lgkmcnt(0)
    v_mov_b32 v219, v217
    s_nop 1
    v_permlane32_swap_b32 v217, v219
    v_add_f32 v217, v217, v219
    v_rcp_f32 v220, v217
    v_mul_u32_u24 v5, 272, v24
    v_lshl_add_u32 v5, v25, 3, v5
    v_add_u32 v5, s63, v5
    v_mul_f32 v64, v64, v220
    v_mul_f32 v65, v65, v220
    v_mul_f32 v66, v66, v220
    v_mul_f32 v67, v67, v220
    v_mul_f32 v68, v68, v220
    v_mul_f32 v69, v69, v220
    v_mul_f32 v70, v70, v220
    v_mul_f32 v71, v71, v220
    v_mul_f32 v72, v72, v220
    v_mul_f32 v73, v73, v220
    v_mul_f32 v74, v74, v220
    v_mul_f32 v75, v75, v220
    v_mul_f32 v76, v76, v220
    v_mul_f32 v77, v77, v220
    v_mul_f32 v78, v78, v220
    v_mul_f32 v79, v79, v220
    v_mul_f32 v80, v80, v220
    v_mul_f32 v81, v81, v220
    v_mul_f32 v82, v82, v220
    v_mul_f32 v83, v83, v220
    v_mul_f32 v84, v84, v220
    v_mul_f32 v85, v85, v220
    v_mul_f32 v86, v86, v220
    v_mul_f32 v87, v87, v220
    v_mul_f32 v88, v88, v220
    v_mul_f32 v89, v89, v220
    v_mul_f32 v90, v90, v220
    v_mul_f32 v91, v91, v220
    v_mul_f32 v92, v92, v220
    v_mul_f32 v93, v93, v220
    v_mul_f32 v94, v94, v220
    v_mul_f32 v95, v95, v220
    v_mul_f32 v96, v96, v220
    v_mul_f32 v97, v97, v220
    v_mul_f32 v98, v98, v220
    v_mul_f32 v99, v99, v220
    v_mul_f32 v100, v100, v220
    v_mul_f32 v101, v101, v220
    v_mul_f32 v102, v102, v220
    v_mul_f32 v103, v103, v220
    v_mul_f32 v104, v104, v220
    v_mul_f32 v105, v105, v220
    v_mul_f32 v106, v106, v220
    v_mul_f32 v107, v107, v220
    v_mul_f32 v108, v108, v220
    v_mul_f32 v109, v109, v220
    v_mul_f32 v110, v110, v220
    v_mul_f32 v111, v111, v220
    v_mul_f32 v112, v112, v220
    v_mul_f32 v113, v113, v220
    v_mul_f32 v114, v114, v220
    v_mul_f32 v115, v115, v220
    v_mul_f32 v116, v116, v220
    v_mul_f32 v117, v117, v220
    v_mul_f32 v118, v118, v220
    v_mul_f32 v119, v119, v220
    v_mul_f32 v120, v120, v220
    v_mul_f32 v121, v121, v220
    v_mul_f32 v122, v122, v220
    v_mul_f32 v123, v123, v220
    v_mul_f32 v124, v124, v220
    v_mul_f32 v125, v125, v220
    v_mul_f32 v126, v126, v220
    v_mul_f32 v127, v127, v220
    v_cvt_pk_bf16_f32 v128, v64, v65
    v_cvt_pk_bf16_f32 v129, v66, v67
    v_cvt_pk_bf16_f32 v130, v68, v69
    v_cvt_pk_bf16_f32 v131, v70, v71
    v_cvt_pk_bf16_f32 v132, v72, v73
    v_cvt_pk_bf16_f32 v133, v74, v75
    v_cvt_pk_bf16_f32 v134, v76, v77
    v_cvt_pk_bf16_f32 v135, v78, v79
    v_cvt_pk_bf16_f32 v136, v80, v81
    v_cvt_pk_bf16_f32 v137, v82, v83
    v_cvt_pk_bf16_f32 v138, v84, v85
    v_cvt_pk_bf16_f32 v139, v86, v87
    v_cvt_pk_bf16_f32 v140, v88, v89
    v_cvt_pk_bf16_f32 v141, v90, v91
    v_cvt_pk_bf16_f32 v142, v92, v93
    v_cvt_pk_bf16_f32 v143, v94, v95
    v_cvt_pk_bf16_f32 v144, v96, v97
    v_cvt_pk_bf16_f32 v145, v98, v99
    v_cvt_pk_bf16_f32 v146, v100, v101
    v_cvt_pk_bf16_f32 v147, v102, v103
    v_cvt_pk_bf16_f32 v148, v104, v105
    v_cvt_pk_bf16_f32 v149, v106, v107
    v_cvt_pk_bf16_f32 v150, v108, v109
    v_cvt_pk_bf16_f32 v151, v110, v111
    v_cvt_pk_bf16_f32 v152, v112, v113
    v_cvt_pk_bf16_f32 v153, v114, v115
    v_cvt_pk_bf16_f32 v154, v116, v117
    v_cvt_pk_bf16_f32 v155, v118, v119
    v_cvt_pk_bf16_f32 v156, v120, v121
    v_cvt_pk_bf16_f32 v157, v122, v123
    v_cvt_pk_bf16_f32 v158, v124, v125
    v_cvt_pk_bf16_f32 v159, v126, v127
    v_min_u32 v216, -2, v216
    v_min_u32 v217, -2, v217
    s_nop 0
    v_mov_b32_dpp v218, v216 quad_perm:[1,1,3,3] row_mask:0xf bank_mask:0xf
    v_mov_b32_dpp v219, v217 quad_perm:[1,1,3,3] row_mask:0xf bank_mask:0xf
    ds_write_b64 v5, v[128:129] offset:0
    ds_write_b64 v5, v[130:131] offset:16
    ds_write_b64 v5, v[132:133] offset:32
    ds_write_b64 v5, v[134:135] offset:48
    ds_write_b64 v5, v[136:137] offset:64
    ds_write_b64 v5, v[138:139] offset:80
    ds_write_b64 v5, v[140:141] offset:96
    ds_write_b64 v5, v[142:143] offset:112
    ds_write_b64 v5, v[144:145] offset:128
    ds_write_b64 v5, v[146:147] offset:144
    ds_write_b64 v5, v[148:149] offset:160
    ds_write_b64 v5, v[150:151] offset:176
    ds_write_b64 v5, v[152:153] offset:192
    ds_write_b64 v5, v[154:155] offset:208
    ds_write_b64 v5, v[156:157] offset:224
    ds_write_b64 v5, v[158:159] offset:240
    v_mul_u32_u24 v6, 272, v4
    v_lshl_add_u32 v6, v3, 4, v6
    v_add_u32 v6, s63, v6
    s_waitcnt lgkmcnt(0)
    ds_read_b128 v[64:67], v6 offset:0
    ds_read_b128 v[68:71], v6 offset:1088
    ds_read_b128 v[72:75], v6 offset:2176
    ds_read_b128 v[76:79], v6 offset:3264
    ds_read_b128 v[80:83], v6 offset:4352
    ds_read_b128 v[84:87], v6 offset:5440
    ds_read_b128 v[88:91], v6 offset:6528
    ds_read_b128 v[92:95], v6 offset:7616
    v_lshlrev_b32 v7, 10, v4
    v_lshl_add_u32 v7, v3, 4, v7
    s_lshl_b32 s54, s53, 15
    s_lshl_b32 s55, s3, 8
    s_add_u32 s54, s54, s55
    s_add_u32 s54, s54, 2097152
    s_waitcnt lgkmcnt(7)
    buffer_store_dwordx4 v[64:67], v7, s[44:47], s54 offen sc1
    s_add_u32 s54, s54, 4096
    s_waitcnt lgkmcnt(6)
    buffer_store_dwordx4 v[68:71], v7, s[44:47], s54 offen sc1
    s_add_u32 s54, s54, 4096
    s_waitcnt lgkmcnt(5)
    buffer_store_dwordx4 v[72:75], v7, s[44:47], s54 offen sc1
    s_add_u32 s54, s54, 4096
    s_waitcnt lgkmcnt(4)
    buffer_store_dwordx4 v[76:79], v7, s[44:47], s54 offen sc1
    s_add_u32 s54, s54, 4096
    s_waitcnt lgkmcnt(3)
    buffer_store_dwordx4 v[80:83], v7, s[44:47], s54 offen sc1
    s_add_u32 s54, s54, 4096
    s_waitcnt lgkmcnt(2)
    buffer_store_dwordx4 v[84:87], v7, s[44:47], s54 offen sc1
    s_add_u32 s54, s54, 4096
    s_waitcnt lgkmcnt(1)
    buffer_store_dwordx4 v[88:91], v7, s[44:47], s54 offen sc1
    s_add_u32 s54, s54, 4096
    s_waitcnt lgkmcnt(0)
    buffer_store_dwordx4 v[92:95], v7, s[44:47], s54 offen sc1
    s_add_u32 s54, s54, 4096
    v_lshlrev_b32 v5, 3, v1
    s_lshl_b32 s54, s53, 8
    s_add_u32 s54, s54, 3145728
    s_cmp_eq_u32 s3, 0
    s_cselect_b32 s56, 0x55555555, 0
    s_mov_b32 s57, 0
    s_waitcnt vmcnt(0)
    s_barrier
    s_mov_b64 exec, s[56:57]
    buffer_store_dwordx4 v[216:219], v5, s[44:47], s54 offen sc1
    s_mov_b64 exec, -1
    s_mov_b32 s48, s26
    s_mov_b32 s49, s27
    s_mov_b32 s50, 9216
    s_mov_b32 s51, 0x20000
    s_lshl_b32 s54, s3, 5
    s_add_u32 s54, s54, s53
    s_cmp_ge_u32 s54, 72
    s_cbranch_scc1 L_nored_33
    s_waitcnt vmcnt(0)
    v_mov_b32 v48, -1
    v_mov_b32 v49, -1
    v_mov_b32 v50, -1
    v_mov_b32 v51, -1
    v_mov_b32 v52, -1
    v_mov_b32 v53, -1
    v_mov_b32 v54, -1
    v_mov_b32 v55, -1
    v_mov_b32 v56, -1
    v_mov_b32 v57, -1
    v_mov_b32 v58, -1
    v_mov_b32 v59, -1
    v_mov_b32 v60, -1
    v_mov_b32 v61, -1
    v_mov_b32 v62, -1
    v_mov_b32 v63, -1
    s_lshl_b32 s55, s54, 12
    s_add_u32 s55, s55, 4194304
    s_mul_hi_u32 s56, s54, 238609295
    s_add_u32 s56, s56, 0
    s_mul_i32 s56, s56, 1152
    s_lshl_b32 s57, s54, 6
    s_add_u32 s56, s56, s57
    v_lshlrev_b32 v5, 3, v3
    v_lshl_add_u32 v5, v4, 1, v5
    v_mov_b32 v6, 0x4000
    v_cmp_gt_u32 vcc, 8, v3
    s_nop 1
    v_cndmask_b32 v5, v6, v5, vcc
    s_mov_b64 s[4:5], -1
    s_mov_b64 s[6:7], -1
    s_mov_b64 s[8:9], -1
    s_mov_b64 s[10:11], -1
L_mpoll_34:
    s_mov_b64 exec, s[4:5]
    buffer_load_dwordx4 v[48:51], v2, s[44:47], s55 offen offset:0 sc1
    s_mov_b64 exec, s[6:7]
    buffer_load_dwordx4 v[52:55], v2, s[44:47], s55 offen offset:1024 sc1
    s_mov_b64 exec, s[8:9]
    buffer_load_dwordx4 v[56:59], v2, s[44:47], s55 offen offset:2048 sc1
    s_mov_b64 exec, s[10:11]
    buffer_load_dwordx4 v[60:63], v2, s[44:47], s55 offen offset:3072 sc1
    s_mov_b64 exec, -1
    s_waitcnt vmcnt(4)
    v_max3_u32 v32, v48, v49, v50
    v_max3_u32 v33, v52, v53, v54
    v_max3_u32 v34, v56, v57, v58
    v_max3_u32 v35, v60, v61, v62
    v_max_u32 v32, v32, v51
    v_max_u32 v33, v33, v55
    v_max_u32 v34, v34, v59
    v_max_u32 v35, v35, v63
    v_cmp_eq_u32 s[4:5], -1, v32
    v_cmp_eq_u32 s[6:7], -1, v33
    v_cmp_eq_u32 s[8:9], -1, v34
    v_cmp_eq_u32 s[10:11], -1, v35
    s_or_b64 vcc, s[4:5], s[6:7]
    s_or_b64 vcc, vcc, s[8:9]
    s_or_b64 vcc, vcc, s[10:11]
    s_cbranch_scc0 L_mpollok_35
    s_and_b64 vcc, s[4:5], s[6:7]
    s_and_b64 vcc, vcc, s[8:9]
    s_and_b64 vcc, vcc, s[10:11]
    s_cmp_eq_u64 vcc, -1
    s_cbranch_scc0 L_mpoll_34_b
    s_sleep 4
L_mpoll_34_b:
    s_sub_u32 s101, s101, 1
    s_cbranch_scc0 L_mpoll_34
    s_mov_b32 s101, 0
L_mpollok_35:
    v_add_f32 v16, v48, v52
    v_add_f32 v24, v56, v60
    v_add_f32 v18, v50, v54
    v_add_f32 v26, v58, v62
    v_add_f32 v17, v49, v53
    v_add_f32 v25, v57, v61
    v_add_f32 v19, v51, v55
    v_add_f32 v27, v59, v63
    v_add_f32 v16, v16, v24
    v_add_f32 v18, v18, v26
    v_add_f32 v17, v17, v25
    v_add_f32 v19, v19, v27
    v_permlane32_swap_b32 v16, v18
    s_nop 0
    v_permlane32_swap_b32 v17, v19
    v_add_f32 v16, v16, v18
    v_add_f32 v17, v17, v19
    s_nop 1
    v_permlane16_swap_b32 v16, v17
    v_add_f32 v16, v16, v17
    s_nop 1
    v_add_f32_dpp v16, v16, v16 row_ror:8 row_mask:0xf bank_mask:0xf
    v_cvt_pk_bf16_f32 v16, v16, v16
    buffer_store_short v16, v5, s[48:51], s56 offen
L_nored_33:
    s_endpgm
L_roleC_end:
L_exit:
    s_endpgm
.section .rodata,"a"
.p2align 6
.amdhsa_kernel concat_heads__mha_block_cached__compressed_kv_cla__decode_kernel
  .amdhsa_next_free_vgpr 512
  .amdhsa_next_free_sgpr 102
  .amdhsa_accum_offset 256
  .amdhsa_group_segment_fixed_size 0
  .amdhsa_kernarg_size 112
  .amdhsa_user_sgpr_count 2
  .amdhsa_user_sgpr_kernarg_segment_ptr 1
  .amdhsa_system_sgpr_workgroup_id_x 1
.end_amdhsa_kernel
```

```asm
; @launch grid=(256,1,1) block=(256,1,1) lds=163840
.amdgcn_target "amdgcn-amd-amdhsa--gfx950"
.text
.globl concat_heads__mha_block_cached__compressed_kv_cla__decode_kernel
.p2align 12
.p2align 8
.type concat_heads__mha_block_cached__compressed_kv_cla__decode_kernel,@function
concat_heads__mha_block_cached__compressed_kv_cla__decode_kernel:
    s_cmp_ge_u32 s2, 256
    s_cbranch_scc1 L_exit
    s_load_dwordx16 s[4:19], s[0:1], 0
    s_load_dwordx8 s[20:27], s[0:1], 64
    s_load_dwordx4 s[28:31], s[0:1], 96
    v_lshrrev_b32 v2, 6, v0
    v_and_b32 v1, 63, v0
    v_readfirstlane_b32 s3, v2
    v_and_b32 v3, 15, v0
    v_bfe_u32 v4, v0, 4, 2
    v_lshlrev_b32 v2, 4, v1
    s_add_u32 s52, s2, 1
    s_and_b32 s52, s52, 31
    s_mov_b32 s53, s52
    s_cmp_lt_u32 s2, 32
    s_cbranch_scc1 L_roleH
    s_cmp_lt_u32 s2, 64
    s_cbranch_scc1 L_roleC
L_roleA:
    s_sub_u32 s54, s2, 64
    s_mul_hi_u32 s96, s54, 178956971
    s_mul_i32 s56, s96, 24
    s_sub_u32 s97, s54, s56
    s_lshr_b32 s55, s97, 3
    s_add_u32 s3, s3, s97
    s_add_u32 s3, s3, s55
    s_and_b32 s3, s3, 3
    s_add_u32 s56, s96, s3
    s_and_b32 s56, s56, 3
    s_lshr_b32 s55, s97, 3
    s_and_b32 s53, s97, 7
    s_lshl_b32 s96, s96, 2
    s_add_u32 s55, s55, s56
    s_add_u32 s55, s55, 1
    s_and_b32 s55, s55, 3
    s_add_u32 s52, s96, s55
    s_add_u32 s96, s96, s56
    s_lshl_b32 s100, s53, 11
    s_and_b32 s100, s100, 0x800
    s_lshl_b32 s55, s53, 12
    s_and_b32 s55, s55, 0x6000
    s_or_b32 s100, s100, s55
    s_lshl_b32 s55, s3, 25
    s_or_b32 s100, s100, s55
    s_lshl_b32 s55, s52, 20
    s_or_b32 s100, s100, s55
    s_lshl_b32 s58, s52, 2
    s_add_u32 s58, s58, s3
    s_mul_i32 s58, s58, 0
    s_lshl_b32 s61, s58, 9
    s_and_b32 s61, s61, 0x600
    s_lshl_b32 s55, s58, 15
    s_and_b32 s55, s55, 0xe0000
    s_or_b32 s61, s61, s55
    s_mov_b32 s58, 393216
    s_mov_b32 s59, 1048576
    s_and_b32 s99, s96, 28
    s_add_u32 s99, s99, s3
    s_mul_i32 s99, s99, 0
    s_mov_b32 s63, s53
    s_getpc_b64 s[56:57]
L_pc_1:
    s_sub_u32 s56, s56, L_pc_1-L_roleA
    s_subb_u32 s57, s57, 0
    v_lshlrev_b32 v5, 7, v0
    v_min_u32 v6, L_roleA_end-L_roleA-4, v5
    global_load_dword v56, v6, s[56:57]
    s_mov_b32 s53, 536870912
    v_cmp_eq_u32 vcc, 0, v1
    v_lshlrev_b32 v0, 4, v3
    v_and_b32 v5, 1, v4
    v_lshl_add_u32 v0, v5, 8, v0
    v_lshrrev_b32 v5, 1, v4
    v_lshl_add_u32 v0, v5, 12, v0
    v_add_u32 v18, 32768, v0
    v_add_u32 v48, 65536, v0
    v_add_u32 v49, 98304, v0
    s_waitcnt lgkmcnt(0)
    s_mov_b32 s32, s6
    s_mov_b32 s33, s7
    s_mov_b32 s34, 134217728
    s_mov_b32 s35, 0x20000
    s_mov_b32 s36, s8
    s_mov_b32 s37, s9
    s_mov_b32 s38, 134217728
    s_mov_b32 s39, 0x20000
    s_mov_b32 s44, s30
    s_mov_b32 s45, s31
    s_mov_b32 s46, 536870912
    s_mov_b32 s47, 0x20000
    s_or_b32 s60, s61, s100
    s_or_b32 s61, s61, 0xfff1f9ff
    s_add_u32 s61, s61, 1
    s_and_b32 s61, s61, 0xe0600
    buffer_load_dwordx4 v[64:67], v0, s[32:35], s60 offen nt
    buffer_load_dwordx4 v[68:71], v18, s[32:35], s60 offen nt
    buffer_load_dwordx4 v[72:75], v48, s[32:35], s60 offen nt
    buffer_load_dwordx4 v[76:79], v49, s[32:35], s60 offen nt
    s_or_b32 s60, s61, s100
    s_or_b32 s61, s61, 0xfff1f9ff
    s_add_u32 s61, s61, 1
    s_and_b32 s61, s61, 0xe0600
    buffer_load_dwordx4 v[80:83], v0, s[32:35], s60 offen nt
    buffer_load_dwordx4 v[84:87], v18, s[32:35], s60 offen nt
    buffer_load_dwordx4 v[88:91], v48, s[32:35], s60 offen nt
    buffer_load_dwordx4 v[92:95], v49, s[32:35], s60 offen nt
    s_or_b32 s60, s61, s100
    s_or_b32 s61, s61, 0xfff1f9ff
    s_add_u32 s61, s61, 1
    s_and_b32 s61, s61, 0xe0600
    buffer_load_dwordx4 v[96:99], v0, s[32:35], s60 offen nt
    buffer_load_dwordx4 v[100:103], v18, s[32:35], s60 offen nt
    buffer_load_dwordx4 v[104:107], v48, s[32:35], s60 offen nt
    buffer_load_dwordx4 v[108:111], v49, s[32:35], s60 offen nt
    s_or_b32 s60, s61, s100
    s_or_b32 s61, s61, 0xfff1f9ff
    s_add_u32 s61, s61, 1
    s_and_b32 s61, s61, 0xe0600
    buffer_load_dwordx4 v[112:115], v0, s[32:35], s60 offen nt
    buffer_load_dwordx4 v[116:119], v18, s[32:35], s60 offen nt
    buffer_load_dwordx4 v[120:123], v48, s[32:35], s60 offen nt
    buffer_load_dwordx4 v[124:127], v49, s[32:35], s60 offen nt
    s_or_b32 s60, s61, s100
    s_or_b32 s61, s61, 0xfff1f9ff
    s_add_u32 s61, s61, 1
    s_and_b32 s61, s61, 0xe0600
    buffer_load_dwordx4 v[128:131], v0, s[32:35], s60 offen nt
    buffer_load_dwordx4 v[132:135], v18, s[32:35], s60 offen nt
    buffer_load_dwordx4 v[136:139], v48, s[32:35], s60 offen nt
    buffer_load_dwordx4 v[140:143], v49, s[32:35], s60 offen nt
    s_or_b32 s60, s61, s100
    s_or_b32 s61, s61, 0xfff1f9ff
    s_add_u32 s61, s61, 1
    s_and_b32 s61, s61, 0xe0600
    buffer_load_dwordx4 v[144:147], v0, s[32:35], s60 offen nt
    buffer_load_dwordx4 v[148:151], v18, s[32:35], s60 offen nt
    buffer_load_dwordx4 v[152:155], v48, s[32:35], s60 offen nt
    buffer_load_dwordx4 v[156:159], v49, s[32:35], s60 offen nt
    s_or_b32 s60, s61, s100
    s_or_b32 s61, s61, 0xfff1f9ff
    s_add_u32 s61, s61, 1
    s_and_b32 s61, s61, 0xe0600
    buffer_load_dwordx4 v[160:163], v0, s[32:35], s60 offen nt
    buffer_load_dwordx4 v[164:167], v18, s[32:35], s60 offen nt
    buffer_load_dwordx4 v[168:171], v48, s[32:35], s60 offen nt
    buffer_load_dwordx4 v[172:175], v49, s[32:35], s60 offen nt
    s_or_b32 s60, s61, s100
    s_or_b32 s61, s61, 0xfff1f9ff
    s_add_u32 s61, s61, 1
    s_and_b32 s61, s61, 0xe0600
    buffer_load_dwordx4 v[176:179], v0, s[32:35], s60 offen nt
    buffer_load_dwordx4 v[180:183], v18, s[32:35], s60 offen nt
    buffer_load_dwordx4 v[184:187], v48, s[32:35], s60 offen nt
    buffer_load_dwordx4 v[188:191], v49, s[32:35], s60 offen nt
    s_or_b32 s60, s61, s100
    s_or_b32 s61, s61, 0xfff1f9ff
    s_add_u32 s61, s61, 1
    s_and_b32 s61, s61, 0xe0600
    buffer_load_dwordx4 v[192:195], v0, s[32:35], s60 offen nt
    buffer_load_dwordx4 v[196:199], v18, s[32:35], s60 offen nt
    buffer_load_dwordx4 v[200:203], v48, s[32:35], s60 offen nt
    buffer_load_dwordx4 v[204:207], v49, s[32:35], s60 offen nt
    s_or_b32 s60, s61, s100
    s_or_b32 s61, s61, 0xfff1f9ff
    s_add_u32 s61, s61, 1
    s_and_b32 s61, s61, 0xe0600
    buffer_load_dwordx4 v[208:211], v0, s[32:35], s60 offen nt
    buffer_load_dwordx4 v[212:215], v18, s[32:35], s60 offen nt
    buffer_load_dwordx4 v[216:219], v48, s[32:35], s60 offen nt
    buffer_load_dwordx4 v[220:223], v49, s[32:35], s60 offen nt
    s_or_b32 s60, s61, s100
    s_or_b32 s61, s61, 0xfff1f9ff
    s_add_u32 s61, s61, 1
    s_and_b32 s61, s61, 0xe0600
    buffer_load_dwordx4 v[224:227], v0, s[32:35], s60 offen nt
    buffer_load_dwordx4 v[228:231], v18, s[32:35], s60 offen nt
    buffer_load_dwordx4 v[232:235], v48, s[32:35], s60 offen nt
    buffer_load_dwordx4 v[236:239], v49, s[32:35], s60 offen nt
    s_or_b32 s60, s61, s100
    s_or_b32 s61, s61, 0xfff1f9ff
    s_add_u32 s61, s61, 1
    s_and_b32 s61, s61, 0xe0600
    buffer_load_dwordx4 v[240:243], v0, s[32:35], s60 offen nt
    buffer_load_dwordx4 v[244:247], v18, s[32:35], s60 offen nt
    buffer_load_dwordx4 v[248:251], v48, s[32:35], s60 offen nt
    buffer_load_dwordx4 v[252:255], v49, s[32:35], s60 offen nt
    s_or_b32 s60, s61, s100
    s_or_b32 s61, s61, 0xfff1f9ff
    s_add_u32 s61, s61, 1
    s_and_b32 s61, s61, 0xe0600
    buffer_load_dwordx4 a[0:3], v0, s[32:35], s60 offen nt
    buffer_load_dwordx4 a[4:7], v18, s[32:35], s60 offen nt
    buffer_load_dwordx4 a[8:11], v48, s[32:35], s60 offen nt
    buffer_load_dwordx4 a[12:15], v49, s[32:35], s60 offen nt
    s_or_b32 s60, s61, s100
    s_or_b32 s61, s61, 0xfff1f9ff
    s_add_u32 s61, s61, 1
    s_and_b32 s61, s61, 0xe0600
    buffer_load_dwordx4 a[16:19], v0, s[32:35], s60 offen nt
    buffer_load_dwordx4 a[20:23], v18, s[32:35], s60 offen nt
    buffer_load_dwordx4 a[24:27], v48, s[32:35], s60 offen nt
    buffer_load_dwordx4 a[28:31], v49, s[32:35], s60 offen nt
    s_sub_u32 s23, s2, 64
    s_and_b32 s26, s23, 7
    s_lshr_b32 s23, s23, 3
    s_mul_i32 s27, s23, 43
    s_lshr_b32 s27, s27, 8
    s_lshl_b32 s26, s26, 2
    s_add_u32 s26, s26, s27
    s_mul_i32 s27, s27, 6
    s_sub_u32 s23, s23, s27
    v_mov_b32 v58, 0
    s_load_dword s18, s[28:29], 0
    s_or_b32 s60, s61, s100
    s_or_b32 s61, s61, 0xfff1f9ff
    s_add_u32 s61, s61, 1
    s_and_b32 s61, s61, 0xe0600
    buffer_load_dwordx4 a[32:35], v0, s[32:35], s60 offen nt
    buffer_load_dwordx4 a[36:39], v18, s[32:35], s60 offen nt
    buffer_load_dwordx4 a[40:43], v48, s[32:35], s60 offen nt
    buffer_load_dwordx4 a[44:47], v49, s[32:35], s60 offen nt
    s_waitcnt vmcnt(56)
    s_or_b32 s60, s61, s100
    s_or_b32 s61, s61, 0xfff1f9ff
    s_add_u32 s61, s61, 1
    s_and_b32 s61, s61, 0xe0600
    buffer_load_dwordx4 a[48:51], v0, s[32:35], s60 offen nt
    buffer_load_dwordx4 a[52:55], v18, s[32:35], s60 offen nt
    buffer_load_dwordx4 a[56:59], v48, s[32:35], s60 offen nt
    buffer_load_dwordx4 a[60:63], v49, s[32:35], s60 offen nt
    s_waitcnt vmcnt(56)
    s_or_b32 s60, s61, s100
    s_or_b32 s61, s61, 0xfff1f9ff
    s_add_u32 s61, s61, 1
    s_and_b32 s61, s61, 0xe0600
    buffer_load_dwordx4 a[64:67], v0, s[32:35], s60 offen nt
    buffer_load_dwordx4 a[68:71], v18, s[32:35], s60 offen nt
    buffer_load_dwordx4 a[72:75], v48, s[32:35], s60 offen nt
    buffer_load_dwordx4 a[76:79], v49, s[32:35], s60 offen nt
    s_waitcnt vmcnt(56)
    s_or_b32 s60, s61, s100
    s_or_b32 s61, s61, 0xfff1f9ff
    s_add_u32 s61, s61, 1
    s_and_b32 s61, s61, 0xe0600
    buffer_load_dwordx4 a[80:83], v0, s[32:35], s60 offen nt
    buffer_load_dwordx4 a[84:87], v18, s[32:35], s60 offen nt
    buffer_load_dwordx4 a[88:91], v48, s[32:35], s60 offen nt
    buffer_load_dwordx4 a[92:95], v49, s[32:35], s60 offen nt
    v_and_b32 v5, 1, v3
    v_cmp_eq_u32 vcc, 1, v5
    v_mov_b32 v5, 0xffff
    v_mov_b32 v6, 0xffff0000
    v_cndmask_b32 v5, v5, v6, vcc
    v_lshrrev_b32 v6, 1, v3
    v_cmp_eq_u32 vcc, 0, v6
    s_nop 1
    v_cndmask_b32 v8, 0, v5, vcc
    v_cmp_eq_u32 vcc, 1, v6
    s_nop 1
    v_cndmask_b32 v9, 0, v5, vcc
    v_cmp_eq_u32 vcc, 2, v6
    s_nop 1
    v_cndmask_b32 v10, 0, v5, vcc
    v_cmp_eq_u32 vcc, 3, v6
    s_nop 1
    v_cndmask_b32 v11, 0, v5, vcc
    s_bitcmp1_b32 s23, 0
    s_cselect_b32 s40, s24, s12
    s_cselect_b32 s41, s25, s13
    s_cselect_b32 s25, 524288, 0
    s_add_u32 s25, s25, 4194304
    s_mov_b32 s42, 4718592
    s_mov_b32 s43, 0x20000
    s_lshr_b32 s54, s23, 1
    s_mul_i32 s54, s54, 3
    s_add_u32 s54, s54, s3
    s_and_b32 s23, s23, 1
    s_mul_i32 s24, s26, 147456
    s_lshl_b32 s55, s54, 7
    s_add_u32 s24, s24, s55
    s_lshl_b32 s54, s54, 13
    s_lshl_b32 s55, s26, 7
    s_add_u32 s54, s54, s55
    s_add_u32 s25, s25, s54
    s_lshl_b32 s27, s26, 10
    s_add_u32 s27, s27, 5439488
    s_lshl_b32 s22, s26, 2
    s_add_u32 s22, s22, s3
    s_lshl_b32 s22, s22, 13
    s_add_u32 s22, s22, 8388608
    s_lshr_b32 s55, s26, 2
    s_add_u32 s55, s55, s3
    s_and_b32 s55, s55, 3
    s_and_b32 s54, s26, 3
    s_cmp_eq_u32 s54, s55
    s_cselect_b32 s54, 7, 1
    s_cselect_b32 s55, 5, 1
    s_cselect_b32 s26, 2, 0
    s_or_b32 s23, s23, s26
    v_and_b32 v30, s54, v3
    v_min_u32 v30, s55, v30
    v_lshl_add_u32 v30, v30, 2, v4
    v_lshlrev_b32 v30, 4, v30
    v_add_u32 v30, 6144, v30
    v_lshrrev_b32 v19, 3, v3
    v_lshl_add_u32 v19, v19, 2, v4
    v_mul_u32_u24 v19, 9216, v19
    v_and_b32 v5, 7, v3
    v_lshl_add_u32 v19, v5, 4, v19
    v_mov_b32 v12, 0
    v_mov_b32 v13, 0
    v_mov_b32 v14, 0
    v_mov_b32 v15, 0
    v_mov_b32 v16, 0xff800000
    v_mov_b32 v17, 0
    v_lshlrev_b32 v59, 4, v3
    v_and_b32 v5, 1, v4
    s_lshl_b32 s54, s52, 2
    s_add_u32 s54, s54, s3
    s_lshl_b32 s54, s54, 13
    s_lshl_b32 s55, s96, 2
    s_add_u32 s55, s55, s3
    s_lshl_b32 s55, s55, 13
    v_cmp_eq_u32 vcc, 1, v5
    v_mov_b32 v6, s54
    v_mov_b32 v7, s55
    v_cndmask_b32 v6, v6, v7, vcc
    v_mov_b32 v20, s63
    v_mov_b32 v7, s97
    v_cndmask_b32 v7, v20, v7, vcc
    v_lshl_add_u32 v20, v7, 4, v3
    v_lshl_add_u32 v20, v20, 4, v6
    v_lshl_add_u32 v21, v7, 4, v6
    v_add_u32 v21, 6144, v21
    v_mov_b32 v7, s53
    v_cmp_eq_u32 vcc, 0, v3
    s_nop 1
    v_cndmask_b32 v21, v7, v21, vcc
    v_cmp_gt_u32 vcc, 32, v1
    s_nop 1
    v_cndmask_b32 v3, v21, v20, vcc
    s_mov_b32 s8, 919040
    s_mov_b32 s9, s100
    s_mov_b32 s10, 0xff000
    s_lshl_b32 s11, s3, 25
    s_lshl_b32 s54, s96, 20
    s_add_u32 s11, s11, s54
    s_andn2_b32 s9, s9, 0x6000
    s_lshl_b32 s54, s63, 13
    s_and_b32 s54, s54, 0x4000
    s_or_b32 s9, s9, s54
    s_lshl_b32 s54, s63, 11
    s_lshr_b32 s55, s100, 8
    s_xor_b32 s54, s54, s55
    s_and_b32 s54, s54, 0x2000
    s_or_b32 s9, s9, s54
    s_and_b32 s57, s96, 28
    s_add_u32 s57, s57, s3
    s_mul_i32 s57, s57, 256
    s_add_u32 s57, s57, 16777216
    s_lshl_b32 s54, s3, 8
    s_add_u32 s54, s54, 5242880
    s_lshl_b32 s56, s52, 10
    s_add_u32 s56, s56, s54
    s_lshl_b32 s12, s96, 10
    s_add_u32 s12, s12, s54
    s_mov_b32 s13, 0
    s_lshr_b32 s54, s97, 1
    s_mul_i32 s54, s54, 12
    s_bitcmp1_b32 s97, 0
    s_cselect_b32 s55, 8, 0
    s_cselect_b32 s20, 36, 40
    s_add_u32 s54, s54, s55
    s_add_u32 s54, s54, s99
    s_lshl_b32 s21, s54, 9
    s_and_b32 s21, s21, 0xe00
    s_lshl_b32 s55, s54, 10
    s_and_b32 s55, s55, 0x6000
    s_or_b32 s21, s21, s55
    s_lshl_b32 s55, s54, 12
    s_and_b32 s55, s55, 0xe0000
    s_or_b32 s21, s21, s55
    s_add_u32 s15, s59, 65536
    s_sub_u32 s14, s15, 131072
    s_mov_b32 s96, 1035273459
    s_mov_b32 s97, 1069066811
    s_mov_b32 s98, 0xffff0000
    s_mov_b32 s62, 2
    s_mov_b32 s101, 100000
    s_waitcnt lgkmcnt(0)
    s_cmp_lt_u32 s18, 1073741824
    s_cbranch_scc1 L_aflag
L_aflag_ok:
    s_and_b32 s54, s18, 0xfff
    s_bfe_u32 s55, s18, 0xc000c
    s_min_u32 s17, s54, s55
    s_max_u32 s54, s54, s55
    s_xor_b32 s55, s9, 0x2000
    s_cmp_ge_u32 s17, 42
    s_cselect_b32 s9, s9, s100
    s_cmp_le_u32 s54, 22
    s_cselect_b32 s9, s55, s9
    s_mov_b32 s18, 20
    s_mov_b64 s[6:7], s[8:9]
    s_mov_b32 s63, 0
    s_cmp_eq_u32 s3, 3
    s_cselect_b32 s19, -1, 256
    buffer_load_dwordx4 v[60:63], v59, s[44:47], s56 offen sc1
    s_waitcnt vmcnt(57)
    s_or_b32 s60, s61, s100
    s_or_b32 s61, s61, 0xfff1f9ff
    s_add_u32 s61, s61, 1
    s_and_b32 s61, s61, 0xe0600
    buffer_load_dwordx4 a[96:99], v0, s[32:35], s60 offen nt
    buffer_load_dwordx4 a[100:103], v18, s[32:35], s60 offen nt
    buffer_load_dwordx4 a[104:107], v48, s[32:35], s60 offen nt
    buffer_load_dwordx4 a[108:111], v49, s[32:35], s60 offen nt
    s_waitcnt vmcnt(57)
    s_or_b32 s60, s61, s100
    s_or_b32 s61, s61, 0xfff1f9ff
    s_add_u32 s61, s61, 1
    s_and_b32 s61, s61, 0xe0600
    buffer_load_dwordx4 a[112:115], v0, s[32:35], s60 offen nt
    buffer_load_dwordx4 a[116:119], v18, s[32:35], s60 offen nt
    buffer_load_dwordx4 a[120:123], v48, s[32:35], s60 offen nt
    buffer_load_dwordx4 a[124:127], v49, s[32:35], s60 offen nt
    s_waitcnt vmcnt(57)
    s_or_b32 s60, s61, s9
    s_or_b32 s61, s61, 0xfff1f9ff
    s_add_u32 s61, s61, 1
    s_and_b32 s61, s61, 0xe0600
    buffer_load_dwordx4 a[128:131], v0, s[32:35], s60 offen nt
    buffer_load_dwordx4 a[132:135], v18, s[32:35], s60 offen nt
    buffer_load_dwordx4 a[136:139], v48, s[32:35], s60 offen nt
    buffer_load_dwordx4 a[140:143], v49, s[32:35], s60 offen nt
    s_waitcnt vmcnt(57)
    s_or_b32 s60, s61, s9
    s_or_b32 s61, s61, 0xfff1f9ff
    s_add_u32 s61, s61, 1
    s_and_b32 s61, s61, 0xe0600
    buffer_load_dwordx4 a[144:147], v0, s[32:35], s60 offen nt
    buffer_load_dwordx4 a[148:151], v18, s[32:35], s60 offen nt
    buffer_load_dwordx4 a[152:155], v48, s[32:35], s60 offen nt
    buffer_load_dwordx4 a[156:159], v49, s[32:35], s60 offen nt
    s_waitcnt vmcnt(57)
    s_or_b32 s60, s61, s9
    s_or_b32 s61, s61, 0xfff1f9ff
    s_add_u32 s61, s61, 1
    s_and_b32 s61, s61, 0xe0600
    buffer_load_dwordx4 a[160:163], v0, s[32:35], s60 offen nt
    buffer_load_dwordx4 a[164:167], v18, s[32:35], s60 offen nt
    buffer_load_dwordx4 a[168:171], v48, s[32:35], s60 offen nt
    buffer_load_dwordx4 a[172:175], v49, s[32:35], s60 offen nt
    s_waitcnt vmcnt(57)
    s_or_b32 s60, s61, s9
    s_or_b32 s61, s61, 0xfff1f9ff
    s_add_u32 s61, s61, 1
    s_and_b32 s61, s61, 0xe0600
    buffer_load_dwordx4 a[176:179], v0, s[32:35], s60 offen nt
    buffer_load_dwordx4 a[180:183], v18, s[32:35], s60 offen nt
    buffer_load_dwordx4 a[184:187], v48, s[32:35], s60 offen nt
    buffer_load_dwordx4 a[188:191], v49, s[32:35], s60 offen nt
    s_waitcnt vmcnt(24)
L_aq1:
    v_max3_u32 v20, v60, v61, v62
    v_max_u32 v20, v20, v63
    v_cmp_eq_u32 vcc, -1, v20
    s_cbranch_vccz L_aq1_ok
    buffer_load_dwordx4 v[60:63], v59, s[44:47], s56 offen sc1
    s_waitcnt vmcnt(0)
    s_sub_u32 s101, s101, 1
    s_cbranch_scc0 L_aq1
    s_mov_b32 s101, 0
L_aq1_ok:
    v_mov_b32 v4, v60
    v_mov_b32 v5, v61
    v_mov_b32 v6, v62
    v_mov_b32 v7, v63
    s_mov_b32 s56, 1
    v_mov_b32 v57, v16
    buffer_load_dwordx4 v[60:63], v59, s[44:47], s12 offen sc1
    v_dot2_f32_bf16 v20, v64, v4, 0
    v_dot2_f32_bf16 v21, v68, v4, 0
    v_dot2_f32_bf16 v22, v72, v4, 0
    v_dot2_f32_bf16 v23, v76, v4, 0
    v_dot2_f32_bf16 v20, v65, v5, v20
    v_dot2_f32_bf16 v21, v69, v5, v21
    v_dot2_f32_bf16 v22, v73, v5, v22
    v_dot2_f32_bf16 v23, v77, v5, v23
    v_dot2_f32_bf16 v20, v66, v6, v20
    v_dot2_f32_bf16 v21, v70, v6, v21
    v_dot2_f32_bf16 v22, v74, v6, v22
    v_dot2_f32_bf16 v23, v78, v6, v23
    v_dot2_f32_bf16 v20, v67, v7, v20
    v_dot2_f32_bf16 v21, v71, v7, v21
    v_dot2_f32_bf16 v22, v75, v7, v22
    v_dot2_f32_bf16 v23, v79, v7, v23
    s_waitcnt vmcnt(12)
    s_or_b32 s60, s61, s9
    s_or_b32 s61, s61, 0xfff1f9ff
    s_add_u32 s61, s61, 1
    s_and_b32 s61, s61, 0xe0600
    buffer_load_dwordx4 v[64:67], v0, s[32:35], s60 offen nt
    buffer_load_dwordx4 v[68:71], v18, s[32:35], s60 offen nt
    buffer_load_dwordx4 v[72:75], v48, s[32:35], s60 offen nt
    buffer_load_dwordx4 v[76:79], v49, s[32:35], s60 offen nt
    v_add_f32_dpp v24, v20, v20 row_ror:8 row_mask:0xf bank_mask:0x3
    v_add_f32_dpp v25, v22, v22 row_ror:8 row_mask:0xf bank_mask:0x3
    v_add_f32_dpp v24, v21, v21 row_ror:8 row_mask:0xf bank_mask:0xc
    v_add_f32_dpp v25, v23, v23 row_ror:8 row_mask:0xf bank_mask:0xc
    s_nop 0
    v_add_f32_dpp v26, v24, v24 row_shl:4 row_mask:0xf bank_mask:0x5
    v_add_f32_dpp v26, v25, v25 row_shr:4 row_mask:0xf bank_mask:0xa
    s_nop 1
    v_add_f32_dpp v26, v26, v26 quad_perm:[1,0,3,2] row_mask:0xf bank_mask:0xf
    s_nop 1
    v_add_f32_dpp v26, v26, v26 quad_perm:[2,3,0,1] row_mask:0xf bank_mask:0xf
    v_cvt_pk_bf16_f32 v26, v26, v26
    v_and_b32 v26, s98, v26
    v_mul_f32 v26, s96, v26
    v_cvt_pk_bf16_f32 v26, v26, v26
    v_and_b32 v26, s98, v26
    v_max_f32 v16, v16, v26
    v_accvgpr_write_b32 a192, v26
    v_dot2_f32_bf16 v20, v80, v4, 0
    v_dot2_f32_bf16 v21, v84, v4, 0
    v_dot2_f32_bf16 v22, v88, v4, 0
    v_dot2_f32_bf16 v23, v92, v4, 0
    v_dot2_f32_bf16 v20, v81, v5, v20
    v_dot2_f32_bf16 v21, v85, v5, v21
    v_dot2_f32_bf16 v22, v89, v5, v22
    v_dot2_f32_bf16 v23, v93, v5, v23
    v_dot2_f32_bf16 v20, v82, v6, v20
    v_dot2_f32_bf16 v21, v86, v6, v21
    v_dot2_f32_bf16 v22, v90, v6, v22
    v_dot2_f32_bf16 v23, v94, v6, v23
    v_dot2_f32_bf16 v20, v83, v7, v20
    v_dot2_f32_bf16 v21, v87, v7, v21
    v_dot2_f32_bf16 v22, v91, v7, v22
    v_dot2_f32_bf16 v23, v95, v7, v23
    s_waitcnt vmcnt(12)
    s_or_b32 s60, s61, s9
    s_or_b32 s61, s61, 0xfff1f9ff
    s_add_u32 s61, s61, 1
    s_and_b32 s61, s61, 0xe0600
    buffer_load_dwordx4 v[80:83], v0, s[32:35], s60 offen nt
    buffer_load_dwordx4 v[84:87], v18, s[32:35], s60 offen nt
    buffer_load_dwordx4 v[88:91], v48, s[32:35], s60 offen nt
    buffer_load_dwordx4 v[92:95], v49, s[32:35], s60 offen nt
    v_add_f32_dpp v24, v20, v20 row_ror:8 row_mask:0xf bank_mask:0x3
    v_add_f32_dpp v25, v22, v22 row_ror:8 row_mask:0xf bank_mask:0x3
    v_add_f32_dpp v24, v21, v21 row_ror:8 row_mask:0xf bank_mask:0xc
    v_add_f32_dpp v25, v23, v23 row_ror:8 row_mask:0xf bank_mask:0xc
    s_nop 0
    v_add_f32_dpp v26, v24, v24 row_shl:4 row_mask:0xf bank_mask:0x5
    v_add_f32_dpp v26, v25, v25 row_shr:4 row_mask:0xf bank_mask:0xa
    s_nop 1
    v_add_f32_dpp v26, v26, v26 quad_perm:[1,0,3,2] row_mask:0xf bank_mask:0xf
    s_nop 1
    v_add_f32_dpp v26, v26, v26 quad_perm:[2,3,0,1] row_mask:0xf bank_mask:0xf
    v_cvt_pk_bf16_f32 v26, v26, v26
    v_and_b32 v26, s98, v26
    v_mul_f32 v26, s96, v26
    v_cvt_pk_bf16_f32 v26, v26, v26
    v_and_b32 v26, s98, v26
    v_max_f32 v16, v16, v26
    v_accvgpr_write_b32 a193, v26
    v_dot2_f32_bf16 v20, v96, v4, 0
    v_dot2_f32_bf16 v21, v100, v4, 0
    v_dot2_f32_bf16 v22, v104, v4, 0
    v_dot2_f32_bf16 v23, v108, v4, 0
    v_dot2_f32_bf16 v20, v97, v5, v20
    v_dot2_f32_bf16 v21, v101, v5, v21
    v_dot2_f32_bf16 v22, v105, v5, v22
    v_dot2_f32_bf16 v23, v109, v5, v23
    v_dot2_f32_bf16 v20, v98, v6, v20
    v_dot2_f32_bf16 v21, v102, v6, v21
    v_dot2_f32_bf16 v22, v106, v6, v22
    v_dot2_f32_bf16 v23, v110, v6, v23
    v_dot2_f32_bf16 v20, v99, v7, v20
    v_dot2_f32_bf16 v21, v103, v7, v21
    v_dot2_f32_bf16 v22, v107, v7, v22
    v_dot2_f32_bf16 v23, v111, v7, v23
    s_waitcnt vmcnt(12)
    s_or_b32 s60, s61, s9
    s_or_b32 s61, s61, 0xfff1f9ff
    s_add_u32 s61, s61, 1
    s_and_b32 s61, s61, 0xe0600
    buffer_load_dwordx4 v[96:99], v0, s[32:35], s60 offen nt
    buffer_load_dwordx4 v[100:103], v18, s[32:35], s60 offen nt
    buffer_load_dwordx4 v[104:107], v48, s[32:35], s60 offen nt
    buffer_load_dwordx4 v[108:111], v49, s[32:35], s60 offen nt
    v_add_f32_dpp v24, v20, v20 row_ror:8 row_mask:0xf bank_mask:0x3
    v_add_f32_dpp v25, v22, v22 row_ror:8 row_mask:0xf bank_mask:0x3
    v_add_f32_dpp v24, v21, v21 row_ror:8 row_mask:0xf bank_mask:0xc
    v_add_f32_dpp v25, v23, v23 row_ror:8 row_mask:0xf bank_mask:0xc
    s_nop 0
    v_add_f32_dpp v26, v24, v24 row_shl:4 row_mask:0xf bank_mask:0x5
    v_add_f32_dpp v26, v25, v25 row_shr:4 row_mask:0xf bank_mask:0xa
    s_nop 1
    v_add_f32_dpp v26, v26, v26 quad_perm:[1,0,3,2] row_mask:0xf bank_mask:0xf
    s_nop 1
    v_add_f32_dpp v26, v26, v26 quad_perm:[2,3,0,1] row_mask:0xf bank_mask:0xf
    v_cvt_pk_bf16_f32 v26, v26, v26
    v_and_b32 v26, s98, v26
    v_mul_f32 v26, s96, v26
    v_cvt_pk_bf16_f32 v26, v26, v26
    v_and_b32 v26, s98, v26
    v_max_f32 v16, v16, v26
    v_accvgpr_write_b32 a194, v26
    v_dot2_f32_bf16 v20, v112, v4, 0
    v_dot2_f32_bf16 v21, v116, v4, 0
    v_dot2_f32_bf16 v22, v120, v4, 0
    v_dot2_f32_bf16 v23, v124, v4, 0
    v_dot2_f32_bf16 v20, v113, v5, v20
    v_dot2_f32_bf16 v21, v117, v5, v21
    v_dot2_f32_bf16 v22, v121, v5, v22
    v_dot2_f32_bf16 v23, v125, v5, v23
    v_dot2_f32_bf16 v20, v114, v6, v20
    v_dot2_f32_bf16 v21, v118, v6, v21
    v_dot2_f32_bf16 v22, v122, v6, v22
    v_dot2_f32_bf16 v23, v126, v6, v23
    v_dot2_f32_bf16 v20, v115, v7, v20
    v_dot2_f32_bf16 v21, v119, v7, v21
    v_dot2_f32_bf16 v22, v123, v7, v22
    v_dot2_f32_bf16 v23, v127, v7, v23
    s_waitcnt vmcnt(12)
    s_or_b32 s60, s61, s9
    s_or_b32 s61, s61, 0xfff1f9ff
    s_add_u32 s61, s61, 1
    s_and_b32 s61, s61, 0xe0600
    buffer_load_dwordx4 v[112:115], v0, s[32:35], s60 offen nt
    buffer_load_dwordx4 v[116:119], v18, s[32:35], s60 offen nt
    buffer_load_dwordx4 v[120:123], v48, s[32:35], s60 offen nt
    buffer_load_dwordx4 v[124:127], v49, s[32:35], s60 offen nt
    v_add_f32_dpp v24, v20, v20 row_ror:8 row_mask:0xf bank_mask:0x3
    v_add_f32_dpp v25, v22, v22 row_ror:8 row_mask:0xf bank_mask:0x3
    v_add_f32_dpp v24, v21, v21 row_ror:8 row_mask:0xf bank_mask:0xc
    v_add_f32_dpp v25, v23, v23 row_ror:8 row_mask:0xf bank_mask:0xc
    s_nop 0
    v_add_f32_dpp v26, v24, v24 row_shl:4 row_mask:0xf bank_mask:0x5
    v_add_f32_dpp v26, v25, v25 row_shr:4 row_mask:0xf bank_mask:0xa
    s_nop 1
    v_add_f32_dpp v26, v26, v26 quad_perm:[1,0,3,2] row_mask:0xf bank_mask:0xf
    s_nop 1
    v_add_f32_dpp v26, v26, v26 quad_perm:[2,3,0,1] row_mask:0xf bank_mask:0xf
    v_cvt_pk_bf16_f32 v26, v26, v26
    v_and_b32 v26, s98, v26
    v_mul_f32 v26, s96, v26
    v_cvt_pk_bf16_f32 v26, v26, v26
    v_and_b32 v26, s98, v26
    v_max_f32 v16, v16, v26
    v_accvgpr_write_b32 a195, v26
    v_dot2_f32_bf16 v20, v128, v4, 0
    v_dot2_f32_bf16 v21, v132, v4, 0
    v_dot2_f32_bf16 v22, v136, v4, 0
    v_dot2_f32_bf16 v23, v140, v4, 0
    v_dot2_f32_bf16 v20, v129, v5, v20
    v_dot2_f32_bf16 v21, v133, v5, v21
    v_dot2_f32_bf16 v22, v137, v5, v22
    v_dot2_f32_bf16 v23, v141, v5, v23
    v_dot2_f32_bf16 v20, v130, v6, v20
    v_dot2_f32_bf16 v21, v134, v6, v21
    v_dot2_f32_bf16 v22, v138, v6, v22
    v_dot2_f32_bf16 v23, v142, v6, v23
    v_dot2_f32_bf16 v20, v131, v7, v20
    v_dot2_f32_bf16 v21, v135, v7, v21
    v_dot2_f32_bf16 v22, v139, v7, v22
    v_dot2_f32_bf16 v23, v143, v7, v23
    v_add_f32_dpp v24, v20, v20 row_ror:8 row_mask:0xf bank_mask:0x3
    s_nop 0
    v_add_f32_dpp v25, v22, v22 row_ror:8 row_mask:0xf bank_mask:0x3
    v_add_f32_dpp v24, v21, v21 row_ror:8 row_mask:0xf bank_mask:0xc
    v_add_f32_dpp v25, v23, v23 row_ror:8 row_mask:0xf bank_mask:0xc
    s_nop 0
    v_add_f32_dpp v26, v24, v24 row_shl:4 row_mask:0xf bank_mask:0x5
    v_add_f32_dpp v26, v25, v25 row_shr:4 row_mask:0xf bank_mask:0xa
    s_nop 1
    v_add_f32_dpp v26, v26, v26 quad_perm:[1,0,3,2] row_mask:0xf bank_mask:0xf
    s_nop 1
    v_add_f32_dpp v26, v26, v26 quad_perm:[2,3,0,1] row_mask:0xf bank_mask:0xf
    v_cvt_pk_bf16_f32 v26, v26, v26
    v_and_b32 v26, s98, v26
    v_mul_f32 v26, s96, v26
    v_cvt_pk_bf16_f32 v26, v26, v26
    v_and_b32 v26, s98, v26
    v_max_f32 v16, v16, v26
    v_accvgpr_write_b32 a196, v26
    v_dot2_f32_bf16 v20, v144, v4, 0
    v_dot2_f32_bf16 v21, v148, v4, 0
    v_dot2_f32_bf16 v22, v152, v4, 0
    v_dot2_f32_bf16 v23, v156, v4, 0
    v_dot2_f32_bf16 v20, v145, v5, v20
    v_dot2_f32_bf16 v21, v149, v5, v21
    v_dot2_f32_bf16 v22, v153, v5, v22
    v_dot2_f32_bf16 v23, v157, v5, v23
    v_dot2_f32_bf16 v20, v146, v6, v20
    v_dot2_f32_bf16 v21, v150, v6, v21
    v_dot2_f32_bf16 v22, v154, v6, v22
    v_dot2_f32_bf16 v23, v158, v6, v23
    v_dot2_f32_bf16 v20, v147, v7, v20
    v_dot2_f32_bf16 v21, v151, v7, v21
    v_dot2_f32_bf16 v22, v155, v7, v22
    v_dot2_f32_bf16 v23, v159, v7, v23
    v_add_f32_dpp v24, v20, v20 row_ror:8 row_mask:0xf bank_mask:0x3
    s_nop 0
    v_add_f32_dpp v25, v22, v22 row_ror:8 row_mask:0xf bank_mask:0x3
    v_add_f32_dpp v24, v21, v21 row_ror:8 row_mask:0xf bank_mask:0xc
    v_add_f32_dpp v25, v23, v23 row_ror:8 row_mask:0xf bank_mask:0xc
    s_nop 0
    v_add_f32_dpp v26, v24, v24 row_shl:4 row_mask:0xf bank_mask:0x5
    v_add_f32_dpp v26, v25, v25 row_shr:4 row_mask:0xf bank_mask:0xa
    s_nop 1
    v_add_f32_dpp v26, v26, v26 quad_perm:[1,0,3,2] row_mask:0xf bank_mask:0xf
    s_nop 1
    v_add_f32_dpp v26, v26, v26 quad_perm:[2,3,0,1] row_mask:0xf bank_mask:0xf
    v_cvt_pk_bf16_f32 v26, v26, v26
    v_and_b32 v26, s98, v26
    v_mul_f32 v26, s96, v26
    v_cvt_pk_bf16_f32 v26, v26, v26
    v_and_b32 v26, s98, v26
    v_max_f32 v16, v16, v26
    v_accvgpr_write_b32 a197, v26
    v_dot2_f32_bf16 v20, v160, v4, 0
    v_dot2_f32_bf16 v21, v164, v4, 0
    v_dot2_f32_bf16 v22, v168, v4, 0
    v_dot2_f32_bf16 v23, v172, v4, 0
    v_dot2_f32_bf16 v20, v161, v5, v20
    v_dot2_f32_bf16 v21, v165, v5, v21
    v_dot2_f32_bf16 v22, v169, v5, v22
    v_dot2_f32_bf16 v23, v173, v5, v23
    v_dot2_f32_bf16 v20, v162, v6, v20
    v_dot2_f32_bf16 v21, v166, v6, v21
    v_dot2_f32_bf16 v22, v170, v6, v22
    v_dot2_f32_bf16 v23, v174, v6, v23
    v_dot2_f32_bf16 v20, v163, v7, v20
    v_dot2_f32_bf16 v21, v167, v7, v21
    v_dot2_f32_bf16 v22, v171, v7, v22
    v_dot2_f32_bf16 v23, v175, v7, v23
    v_add_f32_dpp v24, v20, v20 row_ror:8 row_mask:0xf bank_mask:0x3
    s_nop 0
    v_add_f32_dpp v25, v22, v22 row_ror:8 row_mask:0xf bank_mask:0x3
    v_add_f32_dpp v24, v21, v21 row_ror:8 row_mask:0xf bank_mask:0xc
    v_add_f32_dpp v25, v23, v23 row_ror:8 row_mask:0xf bank_mask:0xc
    s_nop 0
    v_add_f32_dpp v26, v24, v24 row_shl:4 row_mask:0xf bank_mask:0x5
    v_add_f32_dpp v26, v25, v25 row_shr:4 row_mask:0xf bank_mask:0xa
    s_nop 1
    v_add_f32_dpp v26, v26, v26 quad_perm:[1,0,3,2] row_mask:0xf bank_mask:0xf
    s_nop 1
    v_add_f32_dpp v26, v26, v26 quad_perm:[2,3,0,1] row_mask:0xf bank_mask:0xf
    v_cvt_pk_bf16_f32 v26, v26, v26
    v_and_b32 v26, s98, v26
    v_mul_f32 v26, s96, v26
    v_cvt_pk_bf16_f32 v26, v26, v26
    v_and_b32 v26, s98, v26
    v_max_f32 v16, v16, v26
    v_accvgpr_write_b32 a198, v26
    s_waitcnt vmcnt(12)
    s_or_b32 s60, s61, s9
    s_or_b32 s61, s61, 0xfff1f9ff
    s_add_u32 s61, s61, 1
    s_and_b32 s61, s61, 0xe0600
    buffer_load_dwordx4 v[128:131], v0, s[32:35], s60 offen nt
    buffer_load_dwordx4 v[132:135], v18, s[32:35], s60 offen nt
    buffer_load_dwordx4 v[136:139], v48, s[32:35], s60 offen nt
    buffer_load_dwordx4 v[140:143], v49, s[32:35], s60 offen nt
    v_dot2_f32_bf16 v20, v176, v4, 0
    v_dot2_f32_bf16 v21, v180, v4, 0
    v_dot2_f32_bf16 v22, v184, v4, 0
    v_dot2_f32_bf16 v23, v188, v4, 0
    v_dot2_f32_bf16 v20, v177, v5, v20
    v_dot2_f32_bf16 v21, v181, v5, v21
    v_dot2_f32_bf16 v22, v185, v5, v22
    v_dot2_f32_bf16 v23, v189, v5, v23
    v_dot2_f32_bf16 v20, v178, v6, v20
    v_dot2_f32_bf16 v21, v182, v6, v21
    v_dot2_f32_bf16 v22, v186, v6, v22
    v_dot2_f32_bf16 v23, v190, v6, v23
    v_dot2_f32_bf16 v20, v179, v7, v20
    v_dot2_f32_bf16 v21, v183, v7, v21
    v_dot2_f32_bf16 v22, v187, v7, v22
    v_dot2_f32_bf16 v23, v191, v7, v23
    v_add_f32_dpp v24, v20, v20 row_ror:8 row_mask:0xf bank_mask:0x3
    s_nop 0
    v_add_f32_dpp v25, v22, v22 row_ror:8 row_mask:0xf bank_mask:0x3
    v_add_f32_dpp v24, v21, v21 row_ror:8 row_mask:0xf bank_mask:0xc
    v_add_f32_dpp v25, v23, v23 row_ror:8 row_mask:0xf bank_mask:0xc
    s_nop 0
    v_add_f32_dpp v26, v24, v24 row_shl:4 row_mask:0xf bank_mask:0x5
    v_add_f32_dpp v26, v25, v25 row_shr:4 row_mask:0xf bank_mask:0xa
    s_nop 1
    v_add_f32_dpp v26, v26, v26 quad_perm:[1,0,3,2] row_mask:0xf bank_mask:0xf
    s_nop 1
    v_add_f32_dpp v26, v26, v26 quad_perm:[2,3,0,1] row_mask:0xf bank_mask:0xf
    v_cvt_pk_bf16_f32 v26, v26, v26
    v_and_b32 v26, s98, v26
    v_mul_f32 v26, s96, v26
    v_cvt_pk_bf16_f32 v26, v26, v26
    v_and_b32 v26, s98, v26
    v_max_f32 v16, v16, v26
    v_accvgpr_write_b32 a199, v26
    v_dot2_f32_bf16 v20, v192, v4, 0
    v_dot2_f32_bf16 v21, v196, v4, 0
    v_dot2_f32_bf16 v22, v200, v4, 0
    v_dot2_f32_bf16 v23, v204, v4, 0
    v_dot2_f32_bf16 v20, v193, v5, v20
    v_dot2_f32_bf16 v21, v197, v5, v21
    v_dot2_f32_bf16 v22, v201, v5, v22
    v_dot2_f32_bf16 v23, v205, v5, v23
    v_dot2_f32_bf16 v20, v194, v6, v20
    v_dot2_f32_bf16 v21, v198, v6, v21
    v_dot2_f32_bf16 v22, v202, v6, v22
    v_dot2_f32_bf16 v23, v206, v6, v23
    v_dot2_f32_bf16 v20, v195, v7, v20
    v_dot2_f32_bf16 v21, v199, v7, v21
    v_dot2_f32_bf16 v22, v203, v7, v22
    v_dot2_f32_bf16 v23, v207, v7, v23
    v_add_f32_dpp v24, v20, v20 row_ror:8 row_mask:0xf bank_mask:0x3
    s_nop 0
    v_add_f32_dpp v25, v22, v22 row_ror:8 row_mask:0xf bank_mask:0x3
    v_add_f32_dpp v24, v21, v21 row_ror:8 row_mask:0xf bank_mask:0xc
    v_add_f32_dpp v25, v23, v23 row_ror:8 row_mask:0xf bank_mask:0xc
    s_nop 0
    v_add_f32_dpp v26, v24, v24 row_shl:4 row_mask:0xf bank_mask:0x5
    v_add_f32_dpp v26, v25, v25 row_shr:4 row_mask:0xf bank_mask:0xa
    s_nop 1
    v_add_f32_dpp v26, v26, v26 quad_perm:[1,0,3,2] row_mask:0xf bank_mask:0xf
    s_nop 1
    v_add_f32_dpp v26, v26, v26 quad_perm:[2,3,0,1] row_mask:0xf bank_mask:0xf
    v_cvt_pk_bf16_f32 v26, v26, v26
    v_and_b32 v26, s98, v26
    v_mul_f32 v26, s96, v26
    v_cvt_pk_bf16_f32 v26, v26, v26
    v_and_b32 v26, s98, v26
    v_max_f32 v16, v16, v26
    v_accvgpr_write_b32 a200, v26
    v_dot2_f32_bf16 v20, v208, v4, 0
    v_dot2_f32_bf16 v21, v212, v4, 0
    v_dot2_f32_bf16 v22, v216, v4, 0
    v_dot2_f32_bf16 v23, v220, v4, 0
    v_dot2_f32_bf16 v20, v209, v5, v20
    v_dot2_f32_bf16 v21, v213, v5, v21
    v_dot2_f32_bf16 v22, v217, v5, v22
    v_dot2_f32_bf16 v23, v221, v5, v23
    v_dot2_f32_bf16 v20, v210, v6, v20
    v_dot2_f32_bf16 v21, v214, v6, v21
    v_dot2_f32_bf16 v22, v218, v6, v22
    v_dot2_f32_bf16 v23, v222, v6, v23
    v_dot2_f32_bf16 v20, v211, v7, v20
    v_dot2_f32_bf16 v21, v215, v7, v21
    v_dot2_f32_bf16 v22, v219, v7, v22
    v_dot2_f32_bf16 v23, v223, v7, v23
    v_add_f32_dpp v24, v20, v20 row_ror:8 row_mask:0xf bank_mask:0x3
    s_nop 0
    v_add_f32_dpp v25, v22, v22 row_ror:8 row_mask:0xf bank_mask:0x3
    v_add_f32_dpp v24, v21, v21 row_ror:8 row_mask:0xf bank_mask:0xc
    v_add_f32_dpp v25, v23, v23 row_ror:8 row_mask:0xf bank_mask:0xc
    s_nop 0
    v_add_f32_dpp v26, v24, v24 row_shl:4 row_mask:0xf bank_mask:0x5
    v_add_f32_dpp v26, v25, v25 row_shr:4 row_mask:0xf bank_mask:0xa
    s_nop 1
    v_add_f32_dpp v26, v26, v26 quad_perm:[1,0,3,2] row_mask:0xf bank_mask:0xf
    s_nop 1
    v_add_f32_dpp v26, v26, v26 quad_perm:[2,3,0,1] row_mask:0xf bank_mask:0xf
    v_cvt_pk_bf16_f32 v26, v26, v26
    v_and_b32 v26, s98, v26
    v_mul_f32 v26, s96, v26
    v_cvt_pk_bf16_f32 v26, v26, v26
    v_and_b32 v26, s98, v26
    v_max_f32 v16, v16, v26
    v_accvgpr_write_b32 a201, v26
    s_waitcnt vmcnt(12)
    s_or_b32 s60, s61, s9
    s_or_b32 s61, s61, 0xfff1f9ff
    s_add_u32 s61, s61, 1
    s_and_b32 s61, s61, 0xe0600
    buffer_load_dwordx4 v[144:147], v0, s[32:35], s60 offen nt
    buffer_load_dwordx4 v[148:151], v18, s[32:35], s60 offen nt
    buffer_load_dwordx4 v[152:155], v48, s[32:35], s60 offen nt
    buffer_load_dwordx4 v[156:159], v49, s[32:35], s60 offen nt
    v_dot2_f32_bf16 v20, v224, v4, 0
    v_dot2_f32_bf16 v21, v228, v4, 0
    v_dot2_f32_bf16 v22, v232, v4, 0
    v_dot2_f32_bf16 v23, v236, v4, 0
    v_dot2_f32_bf16 v20, v225, v5, v20
    v_dot2_f32_bf16 v21, v229, v5, v21
    v_dot2_f32_bf16 v22, v233, v5, v22
    v_dot2_f32_bf16 v23, v237, v5, v23
    v_dot2_f32_bf16 v20, v226, v6, v20
    v_dot2_f32_bf16 v21, v230, v6, v21
    v_dot2_f32_bf16 v22, v234, v6, v22
    v_dot2_f32_bf16 v23, v238, v6, v23
    v_dot2_f32_bf16 v20, v227, v7, v20
    v_dot2_f32_bf16 v21, v231, v7, v21
    v_dot2_f32_bf16 v22, v235, v7, v22
    v_dot2_f32_bf16 v23, v239, v7, v23
    v_add_f32_dpp v24, v20, v20 row_ror:8 row_mask:0xf bank_mask:0x3
    s_nop 0
    v_add_f32_dpp v25, v22, v22 row_ror:8 row_mask:0xf bank_mask:0x3
    v_add_f32_dpp v24, v21, v21 row_ror:8 row_mask:0xf bank_mask:0xc
    v_add_f32_dpp v25, v23, v23 row_ror:8 row_mask:0xf bank_mask:0xc
    s_nop 0
    v_add_f32_dpp v26, v24, v24 row_shl:4 row_mask:0xf bank_mask:0x5
    v_add_f32_dpp v26, v25, v25 row_shr:4 row_mask:0xf bank_mask:0xa
    s_nop 1
    v_add_f32_dpp v26, v26, v26 quad_perm:[1,0,3,2] row_mask:0xf bank_mask:0xf
    s_nop 1
    v_add_f32_dpp v26, v26, v26 quad_perm:[2,3,0,1] row_mask:0xf bank_mask:0xf
    v_cvt_pk_bf16_f32 v26, v26, v26
    v_and_b32 v26, s98, v26
    v_mul_f32 v26, s96, v26
    v_cvt_pk_bf16_f32 v26, v26, v26
    v_and_b32 v26, s98, v26
    v_max_f32 v16, v16, v26
    v_accvgpr_write_b32 a202, v26
    v_dot2_f32_bf16 v20, v240, v4, 0
    v_dot2_f32_bf16 v21, v244, v4, 0
    v_dot2_f32_bf16 v22, v248, v4, 0
    v_dot2_f32_bf16 v23, v252, v4, 0
    v_dot2_f32_bf16 v20, v241, v5, v20
    v_dot2_f32_bf16 v21, v245, v5, v21
    v_dot2_f32_bf16 v22, v249, v5, v22
    v_dot2_f32_bf16 v23, v253, v5, v23
    v_dot2_f32_bf16 v20, v242, v6, v20
    v_dot2_f32_bf16 v21, v246, v6, v21
    v_dot2_f32_bf16 v22, v250, v6, v22
    v_dot2_f32_bf16 v23, v254, v6, v23
    v_dot2_f32_bf16 v20, v243, v7, v20
    v_dot2_f32_bf16 v21, v247, v7, v21
    v_dot2_f32_bf16 v22, v251, v7, v22
    v_dot2_f32_bf16 v23, v255, v7, v23
    v_add_f32_dpp v24, v20, v20 row_ror:8 row_mask:0xf bank_mask:0x3
    s_nop 0
    v_add_f32_dpp v25, v22, v22 row_ror:8 row_mask:0xf bank_mask:0x3
    v_add_f32_dpp v24, v21, v21 row_ror:8 row_mask:0xf bank_mask:0xc
    v_add_f32_dpp v25, v23, v23 row_ror:8 row_mask:0xf bank_mask:0xc
    s_nop 0
    v_add_f32_dpp v26, v24, v24 row_shl:4 row_mask:0xf bank_mask:0x5
    v_add_f32_dpp v26, v25, v25 row_shr:4 row_mask:0xf bank_mask:0xa
    s_nop 1
    v_add_f32_dpp v26, v26, v26 quad_perm:[1,0,3,2] row_mask:0xf bank_mask:0xf
    s_nop 1
    v_add_f32_dpp v26, v26, v26 quad_perm:[2,3,0,1] row_mask:0xf bank_mask:0xf
    v_cvt_pk_bf16_f32 v26, v26, v26
    v_and_b32 v26, s98, v26
    v_mul_f32 v26, s96, v26
    v_cvt_pk_bf16_f32 v26, v26, v26
    v_and_b32 v26, s98, v26
    v_max_f32 v16, v16, v26
    v_accvgpr_write_b32 a203, v26
    v_accvgpr_read_b32 v32, a0
    v_accvgpr_read_b32 v33, a1
    v_accvgpr_read_b32 v34, a2
    v_accvgpr_read_b32 v35, a3
    v_accvgpr_read_b32 v36, a4
    v_accvgpr_read_b32 v37, a5
    v_accvgpr_read_b32 v38, a6
    v_accvgpr_read_b32 v39, a7
    v_accvgpr_read_b32 v40, a8
    v_accvgpr_read_b32 v41, a9
    v_accvgpr_read_b32 v42, a10
    v_accvgpr_read_b32 v43, a11
    v_accvgpr_read_b32 v44, a12
    v_accvgpr_read_b32 v45, a13
    v_accvgpr_read_b32 v46, a14
    v_accvgpr_read_b32 v47, a15
    v_dot2_f32_bf16 v20, v32, v4, 0
    v_dot2_f32_bf16 v21, v36, v4, 0
    v_dot2_f32_bf16 v22, v40, v4, 0
    v_dot2_f32_bf16 v23, v44, v4, 0
    v_dot2_f32_bf16 v20, v33, v5, v20
    v_dot2_f32_bf16 v21, v37, v5, v21
    v_dot2_f32_bf16 v22, v41, v5, v22
    v_dot2_f32_bf16 v23, v45, v5, v23
    v_dot2_f32_bf16 v20, v34, v6, v20
    v_dot2_f32_bf16 v21, v38, v6, v21
    v_dot2_f32_bf16 v22, v42, v6, v22
    v_dot2_f32_bf16 v23, v46, v6, v23
    v_dot2_f32_bf16 v20, v35, v7, v20
    v_dot2_f32_bf16 v21, v39, v7, v21
    v_dot2_f32_bf16 v22, v43, v7, v22
    v_dot2_f32_bf16 v23, v47, v7, v23
    v_add_f32_dpp v24, v20, v20 row_ror:8 row_mask:0xf bank_mask:0x3
    s_nop 0
    v_add_f32_dpp v25, v22, v22 row_ror:8 row_mask:0xf bank_mask:0x3
    v_add_f32_dpp v24, v21, v21 row_ror:8 row_mask:0xf bank_mask:0xc
    v_add_f32_dpp v25, v23, v23 row_ror:8 row_mask:0xf bank_mask:0xc
    s_nop 0
    v_add_f32_dpp v26, v24, v24 row_shl:4 row_mask:0xf bank_mask:0x5
    v_add_f32_dpp v26, v25, v25 row_shr:4 row_mask:0xf bank_mask:0xa
    s_nop 1
    v_add_f32_dpp v26, v26, v26 quad_perm:[1,0,3,2] row_mask:0xf bank_mask:0xf
    s_nop 1
    v_add_f32_dpp v26, v26, v26 quad_perm:[2,3,0,1] row_mask:0xf bank_mask:0xf
    v_cvt_pk_bf16_f32 v26, v26, v26
    v_and_b32 v26, s98, v26
    v_mul_f32 v26, s96, v26
    v_cvt_pk_bf16_f32 v26, v26, v26
    v_and_b32 v26, s98, v26
    v_max_f32 v16, v16, v26
    v_accvgpr_write_b32 a204, v26
    s_waitcnt vmcnt(12)
    s_or_b32 s60, s61, s9
    s_or_b32 s61, s61, 0xfff1f9ff
    s_add_u32 s61, s61, 1
    s_and_b32 s61, s61, 0xe0600
    buffer_load_dwordx4 v[160:163], v0, s[32:35], s60 offen nt
    buffer_load_dwordx4 v[164:167], v18, s[32:35], s60 offen nt
    buffer_load_dwordx4 v[168:171], v48, s[32:35], s60 offen nt
    buffer_load_dwordx4 v[172:175], v49, s[32:35], s60 offen nt
    v_accvgpr_read_b32 v32, a16
    v_accvgpr_read_b32 v33, a17
    v_accvgpr_read_b32 v34, a18
    v_accvgpr_read_b32 v35, a19
    v_accvgpr_read_b32 v36, a20
    v_accvgpr_read_b32 v37, a21
    v_accvgpr_read_b32 v38, a22
    v_accvgpr_read_b32 v39, a23
    v_accvgpr_read_b32 v40, a24
    v_accvgpr_read_b32 v41, a25
    v_accvgpr_read_b32 v42, a26
    v_accvgpr_read_b32 v43, a27
    v_accvgpr_read_b32 v44, a28
    v_accvgpr_read_b32 v45, a29
    v_accvgpr_read_b32 v46, a30
    v_accvgpr_read_b32 v47, a31
    v_dot2_f32_bf16 v20, v32, v4, 0
    v_dot2_f32_bf16 v21, v36, v4, 0
    v_dot2_f32_bf16 v22, v40, v4, 0
    v_dot2_f32_bf16 v23, v44, v4, 0
    v_dot2_f32_bf16 v20, v33, v5, v20
    v_dot2_f32_bf16 v21, v37, v5, v21
    v_dot2_f32_bf16 v22, v41, v5, v22
    v_dot2_f32_bf16 v23, v45, v5, v23
    v_dot2_f32_bf16 v20, v34, v6, v20
    v_dot2_f32_bf16 v21, v38, v6, v21
    v_dot2_f32_bf16 v22, v42, v6, v22
    v_dot2_f32_bf16 v23, v46, v6, v23
    v_dot2_f32_bf16 v20, v35, v7, v20
    v_dot2_f32_bf16 v21, v39, v7, v21
    v_dot2_f32_bf16 v22, v43, v7, v22
    v_dot2_f32_bf16 v23, v47, v7, v23
    v_add_f32_dpp v24, v20, v20 row_ror:8 row_mask:0xf bank_mask:0x3
    s_nop 0
    v_add_f32_dpp v25, v22, v22 row_ror:8 row_mask:0xf bank_mask:0x3
    v_add_f32_dpp v24, v21, v21 row_ror:8 row_mask:0xf bank_mask:0xc
    v_add_f32_dpp v25, v23, v23 row_ror:8 row_mask:0xf bank_mask:0xc
    s_nop 0
    v_add_f32_dpp v26, v24, v24 row_shl:4 row_mask:0xf bank_mask:0x5
    v_add_f32_dpp v26, v25, v25 row_shr:4 row_mask:0xf bank_mask:0xa
    s_nop 1
    v_add_f32_dpp v26, v26, v26 quad_perm:[1,0,3,2] row_mask:0xf bank_mask:0xf
    s_nop 1
    v_add_f32_dpp v26, v26, v26 quad_perm:[2,3,0,1] row_mask:0xf bank_mask:0xf
    v_cvt_pk_bf16_f32 v26, v26, v26
    v_and_b32 v26, s98, v26
    v_mul_f32 v26, s96, v26
    v_cvt_pk_bf16_f32 v26, v26, v26
    v_and_b32 v26, s98, v26
    v_max_f32 v16, v16, v26
    v_accvgpr_write_b32 a205, v26
    v_accvgpr_read_b32 v32, a32
    v_accvgpr_read_b32 v33, a33
    v_accvgpr_read_b32 v34, a34
    v_accvgpr_read_b32 v35, a35
    v_accvgpr_read_b32 v36, a36
    v_accvgpr_read_b32 v37, a37
    v_accvgpr_read_b32 v38, a38
    v_accvgpr_read_b32 v39, a39
    v_accvgpr_read_b32 v40, a40
    v_accvgpr_read_b32 v41, a41
    v_accvgpr_read_b32 v42, a42
    v_accvgpr_read_b32 v43, a43
    v_accvgpr_read_b32 v44, a44
    v_accvgpr_read_b32 v45, a45
    v_accvgpr_read_b32 v46, a46
    v_accvgpr_read_b32 v47, a47
    v_dot2_f32_bf16 v20, v32, v4, 0
    v_dot2_f32_bf16 v21, v36, v4, 0
    v_dot2_f32_bf16 v22, v40, v4, 0
    v_dot2_f32_bf16 v23, v44, v4, 0
    v_dot2_f32_bf16 v20, v33, v5, v20
    v_dot2_f32_bf16 v21, v37, v5, v21
    v_dot2_f32_bf16 v22, v41, v5, v22
    v_dot2_f32_bf16 v23, v45, v5, v23
    v_dot2_f32_bf16 v20, v34, v6, v20
    v_dot2_f32_bf16 v21, v38, v6, v21
    v_dot2_f32_bf16 v22, v42, v6, v22
    v_dot2_f32_bf16 v23, v46, v6, v23
    v_dot2_f32_bf16 v20, v35, v7, v20
    v_dot2_f32_bf16 v21, v39, v7, v21
    v_dot2_f32_bf16 v22, v43, v7, v22
    v_dot2_f32_bf16 v23, v47, v7, v23
    v_add_f32_dpp v24, v20, v20 row_ror:8 row_mask:0xf bank_mask:0x3
    s_nop 0
    v_add_f32_dpp v25, v22, v22 row_ror:8 row_mask:0xf bank_mask:0x3
    v_add_f32_dpp v24, v21, v21 row_ror:8 row_mask:0xf bank_mask:0xc
    v_add_f32_dpp v25, v23, v23 row_ror:8 row_mask:0xf bank_mask:0xc
    s_nop 0
    v_add_f32_dpp v26, v24, v24 row_shl:4 row_mask:0xf bank_mask:0x5
    v_add_f32_dpp v26, v25, v25 row_shr:4 row_mask:0xf bank_mask:0xa
    s_nop 1
    v_add_f32_dpp v26, v26, v26 quad_perm:[1,0,3,2] row_mask:0xf bank_mask:0xf
    s_nop 1
    v_add_f32_dpp v26, v26, v26 quad_perm:[2,3,0,1] row_mask:0xf bank_mask:0xf
    v_cvt_pk_bf16_f32 v26, v26, v26
    v_and_b32 v26, s98, v26
    v_mul_f32 v26, s96, v26
    v_cvt_pk_bf16_f32 v26, v26, v26
    v_and_b32 v26, s98, v26
    v_max_f32 v16, v16, v26
    v_accvgpr_write_b32 a206, v26
    v_accvgpr_read_b32 v32, a48
    v_accvgpr_read_b32 v33, a49
    v_accvgpr_read_b32 v34, a50
    v_accvgpr_read_b32 v35, a51
    v_accvgpr_read_b32 v36, a52
    v_accvgpr_read_b32 v37, a53
    v_accvgpr_read_b32 v38, a54
    v_accvgpr_read_b32 v39, a55
    v_accvgpr_read_b32 v40, a56
    v_accvgpr_read_b32 v41, a57
    v_accvgpr_read_b32 v42, a58
    v_accvgpr_read_b32 v43, a59
    v_accvgpr_read_b32 v44, a60
    v_accvgpr_read_b32 v45, a61
    v_accvgpr_read_b32 v46, a62
    v_accvgpr_read_b32 v47, a63
    v_dot2_f32_bf16 v20, v32, v4, 0
    v_dot2_f32_bf16 v21, v36, v4, 0
    v_dot2_f32_bf16 v22, v40, v4, 0
    v_dot2_f32_bf16 v23, v44, v4, 0
    v_dot2_f32_bf16 v20, v33, v5, v20
    v_dot2_f32_bf16 v21, v37, v5, v21
    v_dot2_f32_bf16 v22, v41, v5, v22
    v_dot2_f32_bf16 v23, v45, v5, v23
    v_dot2_f32_bf16 v20, v34, v6, v20
    v_dot2_f32_bf16 v21, v38, v6, v21
    v_dot2_f32_bf16 v22, v42, v6, v22
    v_dot2_f32_bf16 v23, v46, v6, v23
    v_dot2_f32_bf16 v20, v35, v7, v20
    v_dot2_f32_bf16 v21, v39, v7, v21
    v_dot2_f32_bf16 v22, v43, v7, v22
    v_dot2_f32_bf16 v23, v47, v7, v23
    v_add_f32_dpp v24, v20, v20 row_ror:8 row_mask:0xf bank_mask:0x3
    s_nop 0
    v_add_f32_dpp v25, v22, v22 row_ror:8 row_mask:0xf bank_mask:0x3
    v_add_f32_dpp v24, v21, v21 row_ror:8 row_mask:0xf bank_mask:0xc
    v_add_f32_dpp v25, v23, v23 row_ror:8 row_mask:0xf bank_mask:0xc
    s_nop 0
    v_add_f32_dpp v26, v24, v24 row_shl:4 row_mask:0xf bank_mask:0x5
    v_add_f32_dpp v26, v25, v25 row_shr:4 row_mask:0xf bank_mask:0xa
    s_nop 1
    v_add_f32_dpp v26, v26, v26 quad_perm:[1,0,3,2] row_mask:0xf bank_mask:0xf
    s_nop 1
    v_add_f32_dpp v26, v26, v26 quad_perm:[2,3,0,1] row_mask:0xf bank_mask:0xf
    v_cvt_pk_bf16_f32 v26, v26, v26
    v_and_b32 v26, s98, v26
    v_mul_f32 v26, s96, v26
    v_cvt_pk_bf16_f32 v26, v26, v26
    v_and_b32 v26, s98, v26
    v_max_f32 v16, v16, v26
    v_accvgpr_write_b32 a207, v26
    s_waitcnt vmcnt(12)
    s_or_b32 s60, s61, s9
    s_or_b32 s61, s61, 0xfff1f9ff
    s_add_u32 s61, s61, 1
    s_and_b32 s61, s61, 0xe0600
    buffer_load_dwordx4 v[176:179], v0, s[32:35], s60 offen nt
    buffer_load_dwordx4 v[180:183], v18, s[32:35], s60 offen nt
    buffer_load_dwordx4 v[184:187], v48, s[32:35], s60 offen nt
    buffer_load_dwordx4 v[188:191], v49, s[32:35], s60 offen nt
    v_accvgpr_read_b32 v32, a64
    v_accvgpr_read_b32 v33, a65
    v_accvgpr_read_b32 v34, a66
    v_accvgpr_read_b32 v35, a67
    v_accvgpr_read_b32 v36, a68
    v_accvgpr_read_b32 v37, a69
    v_accvgpr_read_b32 v38, a70
    v_accvgpr_read_b32 v39, a71
    v_accvgpr_read_b32 v40, a72
    v_accvgpr_read_b32 v41, a73
    v_accvgpr_read_b32 v42, a74
    v_accvgpr_read_b32 v43, a75
    v_accvgpr_read_b32 v44, a76
    v_accvgpr_read_b32 v45, a77
    v_accvgpr_read_b32 v46, a78
    v_accvgpr_read_b32 v47, a79
    v_dot2_f32_bf16 v20, v32, v4, 0
    v_dot2_f32_bf16 v21, v36, v4, 0
    v_dot2_f32_bf16 v22, v40, v4, 0
    v_dot2_f32_bf16 v23, v44, v4, 0
    v_dot2_f32_bf16 v20, v33, v5, v20
    v_dot2_f32_bf16 v21, v37, v5, v21
    v_dot2_f32_bf16 v22, v41, v5, v22
    v_dot2_f32_bf16 v23, v45, v5, v23
    v_dot2_f32_bf16 v20, v34, v6, v20
    v_dot2_f32_bf16 v21, v38, v6, v21
    v_dot2_f32_bf16 v22, v42, v6, v22
    v_dot2_f32_bf16 v23, v46, v6, v23
    v_dot2_f32_bf16 v20, v35, v7, v20
    v_dot2_f32_bf16 v21, v39, v7, v21
    v_dot2_f32_bf16 v22, v43, v7, v22
    v_dot2_f32_bf16 v23, v47, v7, v23
    v_add_f32_dpp v24, v20, v20 row_ror:8 row_mask:0xf bank_mask:0x3
    s_nop 0
    v_add_f32_dpp v25, v22, v22 row_ror:8 row_mask:0xf bank_mask:0x3
    v_add_f32_dpp v24, v21, v21 row_ror:8 row_mask:0xf bank_mask:0xc
    v_add_f32_dpp v25, v23, v23 row_ror:8 row_mask:0xf bank_mask:0xc
    s_nop 0
    v_add_f32_dpp v26, v24, v24 row_shl:4 row_mask:0xf bank_mask:0x5
    v_add_f32_dpp v26, v25, v25 row_shr:4 row_mask:0xf bank_mask:0xa
    s_nop 1
    v_add_f32_dpp v26, v26, v26 quad_perm:[1,0,3,2] row_mask:0xf bank_mask:0xf
    s_nop 1
    v_add_f32_dpp v26, v26, v26 quad_perm:[2,3,0,1] row_mask:0xf bank_mask:0xf
    v_cvt_pk_bf16_f32 v26, v26, v26
    v_and_b32 v26, s98, v26
    v_mul_f32 v26, s96, v26
    v_cvt_pk_bf16_f32 v26, v26, v26
    v_and_b32 v26, s98, v26
    v_max_f32 v16, v16, v26
    v_accvgpr_write_b32 a208, v26
    v_accvgpr_read_b32 v32, a80
    v_accvgpr_read_b32 v33, a81
    v_accvgpr_read_b32 v34, a82
    v_accvgpr_read_b32 v35, a83
    v_accvgpr_read_b32 v36, a84
    v_accvgpr_read_b32 v37, a85
    v_accvgpr_read_b32 v38, a86
    v_accvgpr_read_b32 v39, a87
    v_accvgpr_read_b32 v40, a88
    v_accvgpr_read_b32 v41, a89
    v_accvgpr_read_b32 v42, a90
    v_accvgpr_read_b32 v43, a91
    v_accvgpr_read_b32 v44, a92
    v_accvgpr_read_b32 v45, a93
    v_accvgpr_read_b32 v46, a94
    v_accvgpr_read_b32 v47, a95
    v_dot2_f32_bf16 v20, v32, v4, 0
    v_dot2_f32_bf16 v21, v36, v4, 0
    v_dot2_f32_bf16 v22, v40, v4, 0
    v_dot2_f32_bf16 v23, v44, v4, 0
    v_dot2_f32_bf16 v20, v33, v5, v20
    v_dot2_f32_bf16 v21, v37, v5, v21
    v_dot2_f32_bf16 v22, v41, v5, v22
    v_dot2_f32_bf16 v23, v45, v5, v23
    v_dot2_f32_bf16 v20, v34, v6, v20
    v_dot2_f32_bf16 v21, v38, v6, v21
    v_dot2_f32_bf16 v22, v42, v6, v22
    v_dot2_f32_bf16 v23, v46, v6, v23
    v_dot2_f32_bf16 v20, v35, v7, v20
    v_dot2_f32_bf16 v21, v39, v7, v21
    v_dot2_f32_bf16 v22, v43, v7, v22
    v_dot2_f32_bf16 v23, v47, v7, v23
    v_add_f32_dpp v24, v20, v20 row_ror:8 row_mask:0xf bank_mask:0x3
    s_nop 0
    v_add_f32_dpp v25, v22, v22 row_ror:8 row_mask:0xf bank_mask:0x3
    v_add_f32_dpp v24, v21, v21 row_ror:8 row_mask:0xf bank_mask:0xc
    v_add_f32_dpp v25, v23, v23 row_ror:8 row_mask:0xf bank_mask:0xc
    s_nop 0
    v_add_f32_dpp v26, v24, v24 row_shl:4 row_mask:0xf bank_mask:0x5
    v_add_f32_dpp v26, v25, v25 row_shr:4 row_mask:0xf bank_mask:0xa
    s_nop 1
    v_add_f32_dpp v26, v26, v26 quad_perm:[1,0,3,2] row_mask:0xf bank_mask:0xf
    s_nop 1
    v_add_f32_dpp v26, v26, v26 quad_perm:[2,3,0,1] row_mask:0xf bank_mask:0xf
    v_cvt_pk_bf16_f32 v26, v26, v26
    v_and_b32 v26, s98, v26
    v_mul_f32 v26, s96, v26
    v_cvt_pk_bf16_f32 v26, v26, v26
    v_and_b32 v26, s98, v26
    v_max_f32 v16, v16, v26
    v_accvgpr_write_b32 a209, v26
    v_accvgpr_read_b32 v32, a96
    v_accvgpr_read_b32 v33, a97
    v_accvgpr_read_b32 v34, a98
    v_accvgpr_read_b32 v35, a99
    v_accvgpr_read_b32 v36, a100
    v_accvgpr_read_b32 v37, a101
    v_accvgpr_read_b32 v38, a102
    v_accvgpr_read_b32 v39, a103
    v_accvgpr_read_b32 v40, a104
    v_accvgpr_read_b32 v41, a105
    v_accvgpr_read_b32 v42, a106
    v_accvgpr_read_b32 v43, a107
    v_accvgpr_read_b32 v44, a108
    v_accvgpr_read_b32 v45, a109
    v_accvgpr_read_b32 v46, a110
    v_accvgpr_read_b32 v47, a111
    v_dot2_f32_bf16 v20, v32, v4, 0
    v_dot2_f32_bf16 v21, v36, v4, 0
    v_dot2_f32_bf16 v22, v40, v4, 0
    v_dot2_f32_bf16 v23, v44, v4, 0
    v_dot2_f32_bf16 v20, v33, v5, v20
    v_dot2_f32_bf16 v21, v37, v5, v21
    v_dot2_f32_bf16 v22, v41, v5, v22
    v_dot2_f32_bf16 v23, v45, v5, v23
    v_dot2_f32_bf16 v20, v34, v6, v20
    v_dot2_f32_bf16 v21, v38, v6, v21
    v_dot2_f32_bf16 v22, v42, v6, v22
    v_dot2_f32_bf16 v23, v46, v6, v23
    v_dot2_f32_bf16 v20, v35, v7, v20
    v_dot2_f32_bf16 v21, v39, v7, v21
    v_dot2_f32_bf16 v22, v43, v7, v22
    v_dot2_f32_bf16 v23, v47, v7, v23
    v_add_f32_dpp v24, v20, v20 row_ror:8 row_mask:0xf bank_mask:0x3
    s_nop 0
    v_add_f32_dpp v25, v22, v22 row_ror:8 row_mask:0xf bank_mask:0x3
    v_add_f32_dpp v24, v21, v21 row_ror:8 row_mask:0xf bank_mask:0xc
    v_add_f32_dpp v25, v23, v23 row_ror:8 row_mask:0xf bank_mask:0xc
    s_nop 0
    v_add_f32_dpp v26, v24, v24 row_shl:4 row_mask:0xf bank_mask:0x5
    v_add_f32_dpp v26, v25, v25 row_shr:4 row_mask:0xf bank_mask:0xa
    s_nop 1
    v_add_f32_dpp v26, v26, v26 quad_perm:[1,0,3,2] row_mask:0xf bank_mask:0xf
    s_nop 1
    v_add_f32_dpp v26, v26, v26 quad_perm:[2,3,0,1] row_mask:0xf bank_mask:0xf
    v_cvt_pk_bf16_f32 v26, v26, v26
    v_and_b32 v26, s98, v26
    v_mul_f32 v26, s96, v26
    v_cvt_pk_bf16_f32 v26, v26, v26
    v_and_b32 v26, s98, v26
    v_max_f32 v16, v16, v26
    v_accvgpr_write_b32 a210, v26
    s_waitcnt vmcnt(12)
    s_mov_b32 s15, s61
    s_mov_b32 s61, s21
    s_mov_b32 s6, 0xe6e00
    s_mov_b32 s7, s11
    s_or_b32 s60, s61, s7
    s_orn2_b32 s61, s61, s6
    s_add_u32 s61, s61, 1
    s_and_b32 s61, s61, s6
    buffer_load_dwordx4 v[192:195], v0, s[32:35], s60 offen nt
    buffer_load_dwordx4 v[196:199], v18, s[32:35], s60 offen nt
    buffer_load_dwordx4 v[200:203], v48, s[32:35], s60 offen nt
    buffer_load_dwordx4 v[204:207], v49, s[32:35], s60 offen nt
    v_accvgpr_read_b32 v32, a112
    v_accvgpr_read_b32 v33, a113
    v_accvgpr_read_b32 v34, a114
    v_accvgpr_read_b32 v35, a115
    v_accvgpr_read_b32 v36, a116
    v_accvgpr_read_b32 v37, a117
    v_accvgpr_read_b32 v38, a118
    v_accvgpr_read_b32 v39, a119
    v_accvgpr_read_b32 v40, a120
    v_accvgpr_read_b32 v41, a121
    v_accvgpr_read_b32 v42, a122
    v_accvgpr_read_b32 v43, a123
    v_accvgpr_read_b32 v44, a124
    v_accvgpr_read_b32 v45, a125
    v_accvgpr_read_b32 v46, a126
    v_accvgpr_read_b32 v47, a127
    v_dot2_f32_bf16 v20, v32, v4, 0
    v_dot2_f32_bf16 v21, v36, v4, 0
    v_dot2_f32_bf16 v22, v40, v4, 0
    v_dot2_f32_bf16 v23, v44, v4, 0
    v_dot2_f32_bf16 v20, v33, v5, v20
    v_dot2_f32_bf16 v21, v37, v5, v21
    v_dot2_f32_bf16 v22, v41, v5, v22
    v_dot2_f32_bf16 v23, v45, v5, v23
    v_dot2_f32_bf16 v20, v34, v6, v20
    v_dot2_f32_bf16 v21, v38, v6, v21
    v_dot2_f32_bf16 v22, v42, v6, v22
    v_dot2_f32_bf16 v23, v46, v6, v23
    v_dot2_f32_bf16 v20, v35, v7, v20
    v_dot2_f32_bf16 v21, v39, v7, v21
    v_dot2_f32_bf16 v22, v43, v7, v22
    v_dot2_f32_bf16 v23, v47, v7, v23
    v_add_f32_dpp v24, v20, v20 row_ror:8 row_mask:0xf bank_mask:0x3
    s_nop 0
    v_add_f32_dpp v25, v22, v22 row_ror:8 row_mask:0xf bank_mask:0x3
    v_add_f32_dpp v24, v21, v21 row_ror:8 row_mask:0xf bank_mask:0xc
    v_add_f32_dpp v25, v23, v23 row_ror:8 row_mask:0xf bank_mask:0xc
    s_nop 0
    v_add_f32_dpp v26, v24, v24 row_shl:4 row_mask:0xf bank_mask:0x5
    v_add_f32_dpp v26, v25, v25 row_shr:4 row_mask:0xf bank_mask:0xa
    s_nop 1
    v_add_f32_dpp v26, v26, v26 quad_perm:[1,0,3,2] row_mask:0xf bank_mask:0xf
    s_nop 1
    v_add_f32_dpp v26, v26, v26 quad_perm:[2,3,0,1] row_mask:0xf bank_mask:0xf
    v_cvt_pk_bf16_f32 v26, v26, v26
    v_and_b32 v26, s98, v26
    v_mul_f32 v26, s96, v26
    v_cvt_pk_bf16_f32 v26, v26, v26
    v_and_b32 v26, s98, v26
    v_max_f32 v16, v16, v26
    v_accvgpr_write_b32 a211, v26
    v_accvgpr_read_b32 v32, a128
    v_accvgpr_read_b32 v33, a129
    v_accvgpr_read_b32 v34, a130
    v_accvgpr_read_b32 v35, a131
    v_accvgpr_read_b32 v36, a132
    v_accvgpr_read_b32 v37, a133
    v_accvgpr_read_b32 v38, a134
    v_accvgpr_read_b32 v39, a135
    v_accvgpr_read_b32 v40, a136
    v_accvgpr_read_b32 v41, a137
    v_accvgpr_read_b32 v42, a138
    v_accvgpr_read_b32 v43, a139
    v_accvgpr_read_b32 v44, a140
    v_accvgpr_read_b32 v45, a141
    v_accvgpr_read_b32 v46, a142
    v_accvgpr_read_b32 v47, a143
    v_dot2_f32_bf16 v20, v32, v4, 0
    v_dot2_f32_bf16 v21, v36, v4, 0
    v_dot2_f32_bf16 v22, v40, v4, 0
    v_dot2_f32_bf16 v23, v44, v4, 0
    v_dot2_f32_bf16 v20, v33, v5, v20
    v_dot2_f32_bf16 v21, v37, v5, v21
    v_dot2_f32_bf16 v22, v41, v5, v22
    v_dot2_f32_bf16 v23, v45, v5, v23
    v_dot2_f32_bf16 v20, v34, v6, v20
    v_dot2_f32_bf16 v21, v38, v6, v21
    v_dot2_f32_bf16 v22, v42, v6, v22
    v_dot2_f32_bf16 v23, v46, v6, v23
    v_dot2_f32_bf16 v20, v35, v7, v20
    v_dot2_f32_bf16 v21, v39, v7, v21
    v_dot2_f32_bf16 v22, v43, v7, v22
    v_dot2_f32_bf16 v23, v47, v7, v23
    v_add_f32_dpp v24, v20, v20 row_ror:8 row_mask:0xf bank_mask:0x3
    s_nop 0
    v_add_f32_dpp v25, v22, v22 row_ror:8 row_mask:0xf bank_mask:0x3
    v_add_f32_dpp v24, v21, v21 row_ror:8 row_mask:0xf bank_mask:0xc
    v_add_f32_dpp v25, v23, v23 row_ror:8 row_mask:0xf bank_mask:0xc
    s_nop 0
    v_add_f32_dpp v26, v24, v24 row_shl:4 row_mask:0xf bank_mask:0x5
    v_add_f32_dpp v26, v25, v25 row_shr:4 row_mask:0xf bank_mask:0xa
    s_nop 1
    v_add_f32_dpp v26, v26, v26 quad_perm:[1,0,3,2] row_mask:0xf bank_mask:0xf
    s_nop 1
    v_add_f32_dpp v26, v26, v26 quad_perm:[2,3,0,1] row_mask:0xf bank_mask:0xf
    v_cvt_pk_bf16_f32 v26, v26, v26
    v_and_b32 v26, s98, v26
    v_mul_f32 v26, s96, v26
    v_cvt_pk_bf16_f32 v26, v26, v26
    v_and_b32 v26, s98, v26
    v_max_f32 v16, v16, v26
    v_accvgpr_write_b32 a212, v26
    v_accvgpr_read_b32 v32, a144
    v_accvgpr_read_b32 v33, a145
    v_accvgpr_read_b32 v34, a146
    v_accvgpr_read_b32 v35, a147
    v_accvgpr_read_b32 v36, a148
    v_accvgpr_read_b32 v37, a149
    v_accvgpr_read_b32 v38, a150
    v_accvgpr_read_b32 v39, a151
    v_accvgpr_read_b32 v40, a152
    v_accvgpr_read_b32 v41, a153
    v_accvgpr_read_b32 v42, a154
    v_accvgpr_read_b32 v43, a155
    v_accvgpr_read_b32 v44, a156
    v_accvgpr_read_b32 v45, a157
    v_accvgpr_read_b32 v46, a158
    v_accvgpr_read_b32 v47, a159
    v_dot2_f32_bf16 v20, v32, v4, 0
    v_dot2_f32_bf16 v21, v36, v4, 0
    v_dot2_f32_bf16 v22, v40, v4, 0
    v_dot2_f32_bf16 v23, v44, v4, 0
    v_dot2_f32_bf16 v20, v33, v5, v20
    v_dot2_f32_bf16 v21, v37, v5, v21
    v_dot2_f32_bf16 v22, v41, v5, v22
    v_dot2_f32_bf16 v23, v45, v5, v23
    v_dot2_f32_bf16 v20, v34, v6, v20
    v_dot2_f32_bf16 v21, v38, v6, v21
    v_dot2_f32_bf16 v22, v42, v6, v22
    v_dot2_f32_bf16 v23, v46, v6, v23
    v_dot2_f32_bf16 v20, v35, v7, v20
    v_dot2_f32_bf16 v21, v39, v7, v21
    v_dot2_f32_bf16 v22, v43, v7, v22
    v_dot2_f32_bf16 v23, v47, v7, v23
    v_add_f32_dpp v24, v20, v20 row_ror:8 row_mask:0xf bank_mask:0x3
    s_nop 0
    v_add_f32_dpp v25, v22, v22 row_ror:8 row_mask:0xf bank_mask:0x3
    v_add_f32_dpp v24, v21, v21 row_ror:8 row_mask:0xf bank_mask:0xc
    v_add_f32_dpp v25, v23, v23 row_ror:8 row_mask:0xf bank_mask:0xc
    s_nop 0
    v_add_f32_dpp v26, v24, v24 row_shl:4 row_mask:0xf bank_mask:0x5
    v_add_f32_dpp v26, v25, v25 row_shr:4 row_mask:0xf bank_mask:0xa
    s_nop 1
    v_add_f32_dpp v26, v26, v26 quad_perm:[1,0,3,2] row_mask:0xf bank_mask:0xf
    s_nop 1
    v_add_f32_dpp v26, v26, v26 quad_perm:[2,3,0,1] row_mask:0xf bank_mask:0xf
    v_cvt_pk_bf16_f32 v26, v26, v26
    v_and_b32 v26, s98, v26
    v_mul_f32 v26, s96, v26
    v_cvt_pk_bf16_f32 v26, v26, v26
    v_and_b32 v26, s98, v26
    v_max_f32 v16, v16, v26
    v_accvgpr_write_b32 a213, v26
    s_waitcnt vmcnt(12)
    s_or_b32 s60, s61, s7
    s_orn2_b32 s61, s61, s6
    s_add_u32 s61, s61, 1
    s_and_b32 s61, s61, s6
    buffer_load_dwordx4 v[208:211], v0, s[32:35], s60 offen nt
    buffer_load_dwordx4 v[212:215], v18, s[32:35], s60 offen nt
    buffer_load_dwordx4 v[216:219], v48, s[32:35], s60 offen nt
    buffer_load_dwordx4 v[220:223], v49, s[32:35], s60 offen nt
    v_accvgpr_read_b32 v32, a160
    v_accvgpr_read_b32 v33, a161
    v_accvgpr_read_b32 v34, a162
    v_accvgpr_read_b32 v35, a163
    v_accvgpr_read_b32 v36, a164
    v_accvgpr_read_b32 v37, a165
    v_accvgpr_read_b32 v38, a166
    v_accvgpr_read_b32 v39, a167
    v_accvgpr_read_b32 v40, a168
    v_accvgpr_read_b32 v41, a169
    v_accvgpr_read_b32 v42, a170
    v_accvgpr_read_b32 v43, a171
    v_accvgpr_read_b32 v44, a172
    v_accvgpr_read_b32 v45, a173
    v_accvgpr_read_b32 v46, a174
    v_accvgpr_read_b32 v47, a175
    v_dot2_f32_bf16 v20, v32, v4, 0
    v_dot2_f32_bf16 v21, v36, v4, 0
    v_dot2_f32_bf16 v22, v40, v4, 0
    v_dot2_f32_bf16 v23, v44, v4, 0
    v_dot2_f32_bf16 v20, v33, v5, v20
    v_dot2_f32_bf16 v21, v37, v5, v21
    v_dot2_f32_bf16 v22, v41, v5, v22
    v_dot2_f32_bf16 v23, v45, v5, v23
    v_dot2_f32_bf16 v20, v34, v6, v20
    v_dot2_f32_bf16 v21, v38, v6, v21
    v_dot2_f32_bf16 v22, v42, v6, v22
    v_dot2_f32_bf16 v23, v46, v6, v23
    v_dot2_f32_bf16 v20, v35, v7, v20
    v_dot2_f32_bf16 v21, v39, v7, v21
    v_dot2_f32_bf16 v22, v43, v7, v22
    v_dot2_f32_bf16 v23, v47, v7, v23
    v_add_f32_dpp v24, v20, v20 row_ror:8 row_mask:0xf bank_mask:0x3
    s_nop 0
    v_add_f32_dpp v25, v22, v22 row_ror:8 row_mask:0xf bank_mask:0x3
    v_add_f32_dpp v24, v21, v21 row_ror:8 row_mask:0xf bank_mask:0xc
    v_add_f32_dpp v25, v23, v23 row_ror:8 row_mask:0xf bank_mask:0xc
    s_nop 0
    v_add_f32_dpp v26, v24, v24 row_shl:4 row_mask:0xf bank_mask:0x5
    v_add_f32_dpp v26, v25, v25 row_shr:4 row_mask:0xf bank_mask:0xa
    s_nop 1
    v_add_f32_dpp v26, v26, v26 quad_perm:[1,0,3,2] row_mask:0xf bank_mask:0xf
    s_nop 1
    v_add_f32_dpp v26, v26, v26 quad_perm:[2,3,0,1] row_mask:0xf bank_mask:0xf
    v_cvt_pk_bf16_f32 v26, v26, v26
    v_and_b32 v26, s98, v26
    v_mul_f32 v26, s96, v26
    v_cvt_pk_bf16_f32 v26, v26, v26
    v_and_b32 v26, s98, v26
    v_max_f32 v16, v16, v26
    v_accvgpr_write_b32 a214, v26
    v_accvgpr_read_b32 v32, a176
    v_accvgpr_read_b32 v33, a177
    v_accvgpr_read_b32 v34, a178
    v_accvgpr_read_b32 v35, a179
    v_accvgpr_read_b32 v36, a180
    v_accvgpr_read_b32 v37, a181
    v_accvgpr_read_b32 v38, a182
    v_accvgpr_read_b32 v39, a183
    v_accvgpr_read_b32 v40, a184
    v_accvgpr_read_b32 v41, a185
    v_accvgpr_read_b32 v42, a186
    v_accvgpr_read_b32 v43, a187
    v_accvgpr_read_b32 v44, a188
    v_accvgpr_read_b32 v45, a189
    v_accvgpr_read_b32 v46, a190
    v_accvgpr_read_b32 v47, a191
    v_dot2_f32_bf16 v20, v32, v4, 0
    v_dot2_f32_bf16 v21, v36, v4, 0
    v_dot2_f32_bf16 v22, v40, v4, 0
    v_dot2_f32_bf16 v23, v44, v4, 0
    v_dot2_f32_bf16 v20, v33, v5, v20
    v_dot2_f32_bf16 v21, v37, v5, v21
    v_dot2_f32_bf16 v22, v41, v5, v22
    v_dot2_f32_bf16 v23, v45, v5, v23
    v_dot2_f32_bf16 v20, v34, v6, v20
    v_dot2_f32_bf16 v21, v38, v6, v21
    v_dot2_f32_bf16 v22, v42, v6, v22
    v_dot2_f32_bf16 v23, v46, v6, v23
    v_dot2_f32_bf16 v20, v35, v7, v20
    v_dot2_f32_bf16 v21, v39, v7, v21
    v_dot2_f32_bf16 v22, v43, v7, v22
    v_dot2_f32_bf16 v23, v47, v7, v23
    v_add_f32_dpp v24, v20, v20 row_ror:8 row_mask:0xf bank_mask:0x3
    s_nop 0
    v_add_f32_dpp v25, v22, v22 row_ror:8 row_mask:0xf bank_mask:0x3
    v_add_f32_dpp v24, v21, v21 row_ror:8 row_mask:0xf bank_mask:0xc
    v_add_f32_dpp v25, v23, v23 row_ror:8 row_mask:0xf bank_mask:0xc
    s_nop 0
    v_add_f32_dpp v26, v24, v24 row_shl:4 row_mask:0xf bank_mask:0x5
    v_add_f32_dpp v26, v25, v25 row_shr:4 row_mask:0xf bank_mask:0xa
    s_nop 1
    v_add_f32_dpp v26, v26, v26 quad_perm:[1,0,3,2] row_mask:0xf bank_mask:0xf
    s_nop 1
    v_add_f32_dpp v26, v26, v26 quad_perm:[2,3,0,1] row_mask:0xf bank_mask:0xf
    v_cvt_pk_bf16_f32 v26, v26, v26
    v_and_b32 v26, s98, v26
    v_mul_f32 v26, s96, v26
    v_cvt_pk_bf16_f32 v26, v26, v26
    v_and_b32 v26, s98, v26
    v_max_f32 v16, v16, v26
    v_accvgpr_write_b32 a215, v26
    v_dot2_f32_bf16 v20, v64, v4, 0
    v_dot2_f32_bf16 v21, v68, v4, 0
    v_dot2_f32_bf16 v22, v72, v4, 0
    v_dot2_f32_bf16 v23, v76, v4, 0
    v_dot2_f32_bf16 v20, v65, v5, v20
    v_dot2_f32_bf16 v21, v69, v5, v21
    v_dot2_f32_bf16 v22, v73, v5, v22
    v_dot2_f32_bf16 v23, v77, v5, v23
    v_dot2_f32_bf16 v20, v66, v6, v20
    v_dot2_f32_bf16 v21, v70, v6, v21
    v_dot2_f32_bf16 v22, v74, v6, v22
    v_dot2_f32_bf16 v23, v78, v6, v23
    v_dot2_f32_bf16 v20, v67, v7, v20
    v_dot2_f32_bf16 v21, v71, v7, v21
    v_dot2_f32_bf16 v22, v75, v7, v22
    v_dot2_f32_bf16 v23, v79, v7, v23
    v_add_f32_dpp v24, v20, v20 row_ror:8 row_mask:0xf bank_mask:0x3
    s_nop 0
    v_add_f32_dpp v25, v22, v22 row_ror:8 row_mask:0xf bank_mask:0x3
    v_add_f32_dpp v24, v21, v21 row_ror:8 row_mask:0xf bank_mask:0xc
    v_add_f32_dpp v25, v23, v23 row_ror:8 row_mask:0xf bank_mask:0xc
    s_nop 0
    v_add_f32_dpp v26, v24, v24 row_shl:4 row_mask:0xf bank_mask:0x5
    v_add_f32_dpp v26, v25, v25 row_shr:4 row_mask:0xf bank_mask:0xa
    s_nop 1
    v_add_f32_dpp v26, v26, v26 quad_perm:[1,0,3,2] row_mask:0xf bank_mask:0xf
    s_nop 1
    v_add_f32_dpp v26, v26, v26 quad_perm:[2,3,0,1] row_mask:0xf bank_mask:0xf
    v_cvt_pk_bf16_f32 v26, v26, v26
    v_and_b32 v26, s98, v26
    v_mul_f32 v26, s96, v26
    v_cvt_pk_bf16_f32 v26, v26, v26
    v_and_b32 v26, s98, v26
    v_max_f32 v16, v16, v26
    v_accvgpr_write_b32 a216, v26
    s_waitcnt vmcnt(12)
    s_or_b32 s60, s61, s7
    s_orn2_b32 s61, s61, s6
    s_add_u32 s61, s61, 1
    s_and_b32 s61, s61, s6
    buffer_load_dwordx4 v[224:227], v0, s[32:35], s60 offen nt
    buffer_load_dwordx4 v[228:231], v18, s[32:35], s60 offen nt
    buffer_load_dwordx4 v[232:235], v48, s[32:35], s60 offen nt
    buffer_load_dwordx4 v[236:239], v49, s[32:35], s60 offen nt
    v_dot2_f32_bf16 v20, v80, v4, 0
    v_dot2_f32_bf16 v21, v84, v4, 0
    v_dot2_f32_bf16 v22, v88, v4, 0
    v_dot2_f32_bf16 v23, v92, v4, 0
    v_dot2_f32_bf16 v20, v81, v5, v20
    v_dot2_f32_bf16 v21, v85, v5, v21
    v_dot2_f32_bf16 v22, v89, v5, v22
    v_dot2_f32_bf16 v23, v93, v5, v23
    v_dot2_f32_bf16 v20, v82, v6, v20
    v_dot2_f32_bf16 v21, v86, v6, v21
    v_dot2_f32_bf16 v22, v90, v6, v22
    v_dot2_f32_bf16 v23, v94, v6, v23
    v_dot2_f32_bf16 v20, v83, v7, v20
    v_dot2_f32_bf16 v21, v87, v7, v21
    v_dot2_f32_bf16 v22, v91, v7, v22
    v_dot2_f32_bf16 v23, v95, v7, v23
    v_add_f32_dpp v24, v20, v20 row_ror:8 row_mask:0xf bank_mask:0x3
    s_nop 0
    v_add_f32_dpp v25, v22, v22 row_ror:8 row_mask:0xf bank_mask:0x3
    v_add_f32_dpp v24, v21, v21 row_ror:8 row_mask:0xf bank_mask:0xc
    v_add_f32_dpp v25, v23, v23 row_ror:8 row_mask:0xf bank_mask:0xc
    s_nop 0
    v_add_f32_dpp v26, v24, v24 row_shl:4 row_mask:0xf bank_mask:0x5
    v_add_f32_dpp v26, v25, v25 row_shr:4 row_mask:0xf bank_mask:0xa
    s_nop 1
    v_add_f32_dpp v26, v26, v26 quad_perm:[1,0,3,2] row_mask:0xf bank_mask:0xf
    s_nop 1
    v_add_f32_dpp v26, v26, v26 quad_perm:[2,3,0,1] row_mask:0xf bank_mask:0xf
    v_cvt_pk_bf16_f32 v26, v26, v26
    v_and_b32 v26, s98, v26
    v_mul_f32 v26, s96, v26
    v_cvt_pk_bf16_f32 v26, v26, v26
    v_and_b32 v26, s98, v26
    v_max_f32 v16, v16, v26
    v_accvgpr_write_b32 a217, v26
    v_dot2_f32_bf16 v20, v96, v4, 0
    v_dot2_f32_bf16 v21, v100, v4, 0
    v_dot2_f32_bf16 v22, v104, v4, 0
    v_dot2_f32_bf16 v23, v108, v4, 0
    v_dot2_f32_bf16 v20, v97, v5, v20
    v_dot2_f32_bf16 v21, v101, v5, v21
    v_dot2_f32_bf16 v22, v105, v5, v22
    v_dot2_f32_bf16 v23, v109, v5, v23
    v_dot2_f32_bf16 v20, v98, v6, v20
    v_dot2_f32_bf16 v21, v102, v6, v21
    v_dot2_f32_bf16 v22, v106, v6, v22
    v_dot2_f32_bf16 v23, v110, v6, v23
    v_dot2_f32_bf16 v20, v99, v7, v20
    v_dot2_f32_bf16 v21, v103, v7, v21
    v_dot2_f32_bf16 v22, v107, v7, v22
    v_dot2_f32_bf16 v23, v111, v7, v23
    v_add_f32_dpp v24, v20, v20 row_ror:8 row_mask:0xf bank_mask:0x3
    s_nop 0
    v_add_f32_dpp v25, v22, v22 row_ror:8 row_mask:0xf bank_mask:0x3
    v_add_f32_dpp v24, v21, v21 row_ror:8 row_mask:0xf bank_mask:0xc
    v_add_f32_dpp v25, v23, v23 row_ror:8 row_mask:0xf bank_mask:0xc
    s_nop 0
    v_add_f32_dpp v26, v24, v24 row_shl:4 row_mask:0xf bank_mask:0x5
    v_add_f32_dpp v26, v25, v25 row_shr:4 row_mask:0xf bank_mask:0xa
    s_nop 1
    v_add_f32_dpp v26, v26, v26 quad_perm:[1,0,3,2] row_mask:0xf bank_mask:0xf
    s_nop 1
    v_add_f32_dpp v26, v26, v26 quad_perm:[2,3,0,1] row_mask:0xf bank_mask:0xf
    v_cvt_pk_bf16_f32 v26, v26, v26
    v_and_b32 v26, s98, v26
    v_mul_f32 v26, s96, v26
    v_cvt_pk_bf16_f32 v26, v26, v26
    v_and_b32 v26, s98, v26
    v_max_f32 v16, v16, v26
    v_accvgpr_write_b32 a218, v26
    v_dot2_f32_bf16 v20, v112, v4, 0
    v_dot2_f32_bf16 v21, v116, v4, 0
    v_dot2_f32_bf16 v22, v120, v4, 0
    v_dot2_f32_bf16 v23, v124, v4, 0
    v_dot2_f32_bf16 v20, v113, v5, v20
    v_dot2_f32_bf16 v21, v117, v5, v21
    v_dot2_f32_bf16 v22, v121, v5, v22
    v_dot2_f32_bf16 v23, v125, v5, v23
    v_dot2_f32_bf16 v20, v114, v6, v20
    v_dot2_f32_bf16 v21, v118, v6, v21
    v_dot2_f32_bf16 v22, v122, v6, v22
    v_dot2_f32_bf16 v23, v126, v6, v23
    v_dot2_f32_bf16 v20, v115, v7, v20
    v_dot2_f32_bf16 v21, v119, v7, v21
    v_dot2_f32_bf16 v22, v123, v7, v22
    v_dot2_f32_bf16 v23, v127, v7, v23
    v_add_f32_dpp v24, v20, v20 row_ror:8 row_mask:0xf bank_mask:0x3
    s_nop 0
    v_add_f32_dpp v25, v22, v22 row_ror:8 row_mask:0xf bank_mask:0x3
    v_add_f32_dpp v24, v21, v21 row_ror:8 row_mask:0xf bank_mask:0xc
    v_add_f32_dpp v25, v23, v23 row_ror:8 row_mask:0xf bank_mask:0xc
    s_nop 0
    v_add_f32_dpp v26, v24, v24 row_shl:4 row_mask:0xf bank_mask:0x5
    v_add_f32_dpp v26, v25, v25 row_shr:4 row_mask:0xf bank_mask:0xa
    s_nop 1
    v_add_f32_dpp v26, v26, v26 quad_perm:[1,0,3,2] row_mask:0xf bank_mask:0xf
    s_nop 1
    v_add_f32_dpp v26, v26, v26 quad_perm:[2,3,0,1] row_mask:0xf bank_mask:0xf
    v_cvt_pk_bf16_f32 v26, v26, v26
    v_and_b32 v26, s98, v26
    v_mul_f32 v26, s96, v26
    v_cvt_pk_bf16_f32 v26, v26, v26
    v_and_b32 v26, s98, v26
    v_max_f32 v16, v16, v26
    v_accvgpr_write_b32 a219, v26
    s_waitcnt vmcnt(12)
    s_or_b32 s60, s61, s7
    s_orn2_b32 s61, s61, s6
    s_add_u32 s61, s61, 1
    s_and_b32 s61, s61, s6
    buffer_load_dwordx4 v[240:243], v0, s[32:35], s60 offen nt
    buffer_load_dwordx4 v[244:247], v18, s[32:35], s60 offen nt
    buffer_load_dwordx4 v[248:251], v48, s[32:35], s60 offen nt
    buffer_load_dwordx4 v[252:255], v49, s[32:35], s60 offen nt
    s_cmp_eq_u32 s20, 36
    s_cbranch_scc1 L_x4
    s_waitcnt vmcnt(12)
    s_or_b32 s60, s61, s7
    s_orn2_b32 s61, s61, s6
    s_add_u32 s61, s61, 1
    s_and_b32 s61, s61, s6
    buffer_load_dwordx4 v[64:67], v0, s[32:35], s60 offen nt
    buffer_load_dwordx4 v[68:71], v18, s[32:35], s60 offen nt
    buffer_load_dwordx4 v[72:75], v48, s[32:35], s60 offen nt
    buffer_load_dwordx4 v[76:79], v49, s[32:35], s60 offen nt
    s_waitcnt vmcnt(12)
    s_or_b32 s60, s61, s7
    s_orn2_b32 s61, s61, s6
    s_add_u32 s61, s61, 1
    s_and_b32 s61, s61, s6
    buffer_load_dwordx4 v[80:83], v0, s[32:35], s60 offen nt
    buffer_load_dwordx4 v[84:87], v18, s[32:35], s60 offen nt
    buffer_load_dwordx4 v[88:91], v48, s[32:35], s60 offen nt
    buffer_load_dwordx4 v[92:95], v49, s[32:35], s60 offen nt
    s_waitcnt vmcnt(12)
    s_or_b32 s60, s61, s7
    s_orn2_b32 s61, s61, s6
    s_add_u32 s61, s61, 1
    s_and_b32 s61, s61, s6
    buffer_load_dwordx4 v[96:99], v0, s[32:35], s60 offen nt
    buffer_load_dwordx4 v[100:103], v18, s[32:35], s60 offen nt
    buffer_load_dwordx4 v[104:107], v48, s[32:35], s60 offen nt
    buffer_load_dwordx4 v[108:111], v49, s[32:35], s60 offen nt
    s_waitcnt vmcnt(12)
    s_or_b32 s60, s61, s7
    s_orn2_b32 s61, s61, s6
    s_add_u32 s61, s61, 1
    s_and_b32 s61, s61, s6
    buffer_load_dwordx4 v[112:115], v0, s[32:35], s60 offen nt
    buffer_load_dwordx4 v[116:119], v18, s[32:35], s60 offen nt
    buffer_load_dwordx4 v[120:123], v48, s[32:35], s60 offen nt
    buffer_load_dwordx4 v[124:127], v49, s[32:35], s60 offen nt
L_x4:
    s_mov_b32 s61, s15
    s_mov_b32 s6, s8
    v_dot2_f32_bf16 v20, v128, v4, 0
    v_dot2_f32_bf16 v21, v132, v4, 0
    v_dot2_f32_bf16 v22, v136, v4, 0
    v_dot2_f32_bf16 v23, v140, v4, 0
    v_dot2_f32_bf16 v20, v129, v5, v20
    v_dot2_f32_bf16 v21, v133, v5, v21
    v_dot2_f32_bf16 v22, v137, v5, v22
    v_dot2_f32_bf16 v23, v141, v5, v23
    v_dot2_f32_bf16 v20, v130, v6, v20
    v_dot2_f32_bf16 v21, v134, v6, v21
    v_dot2_f32_bf16 v22, v138, v6, v22
    v_dot2_f32_bf16 v23, v142, v6, v23
    v_dot2_f32_bf16 v20, v131, v7, v20
    v_dot2_f32_bf16 v21, v135, v7, v21
    v_dot2_f32_bf16 v22, v139, v7, v22
    v_dot2_f32_bf16 v23, v143, v7, v23
    v_add_f32_dpp v24, v20, v20 row_ror:8 row_mask:0xf bank_mask:0x3
    s_nop 0
    v_add_f32_dpp v25, v22, v22 row_ror:8 row_mask:0xf bank_mask:0x3
    v_add_f32_dpp v24, v21, v21 row_ror:8 row_mask:0xf bank_mask:0xc
    v_add_f32_dpp v25, v23, v23 row_ror:8 row_mask:0xf bank_mask:0xc
    s_nop 0
    v_add_f32_dpp v26, v24, v24 row_shl:4 row_mask:0xf bank_mask:0x5
    v_add_f32_dpp v26, v25, v25 row_shr:4 row_mask:0xf bank_mask:0xa
    s_nop 1
    v_add_f32_dpp v26, v26, v26 quad_perm:[1,0,3,2] row_mask:0xf bank_mask:0xf
    s_nop 1
    v_add_f32_dpp v26, v26, v26 quad_perm:[2,3,0,1] row_mask:0xf bank_mask:0xf
    v_cvt_pk_bf16_f32 v26, v26, v26
    v_and_b32 v26, s98, v26
    v_mul_f32 v26, s96, v26
    v_cvt_pk_bf16_f32 v26, v26, v26
    v_and_b32 v26, s98, v26
    v_max_f32 v16, v16, v26
    v_accvgpr_write_b32 a220, v26
    s_waitcnt vmcnt(12)
    s_or_b32 s60, s61, s100
    s_or_b32 s61, s61, 0xfff1f9ff
    s_add_u32 s61, s61, 1
    s_and_b32 s61, s61, 0xe0600
    buffer_load_dwordx4 a[0:3], v0, s[36:39], s60 offen nt
    buffer_load_dwordx4 a[4:7], v18, s[36:39], s60 offen nt
    buffer_load_dwordx4 a[8:11], v48, s[36:39], s60 offen nt
    buffer_load_dwordx4 a[12:15], v49, s[36:39], s60 offen nt
    v_dot2_f32_bf16 v20, v144, v4, 0
    v_dot2_f32_bf16 v21, v148, v4, 0
    v_dot2_f32_bf16 v22, v152, v4, 0
    v_dot2_f32_bf16 v23, v156, v4, 0
    v_dot2_f32_bf16 v20, v145, v5, v20
    v_dot2_f32_bf16 v21, v149, v5, v21
    v_dot2_f32_bf16 v22, v153, v5, v22
    v_dot2_f32_bf16 v23, v157, v5, v23
    v_dot2_f32_bf16 v20, v146, v6, v20
    v_dot2_f32_bf16 v21, v150, v6, v21
    v_dot2_f32_bf16 v22, v154, v6, v22
    v_dot2_f32_bf16 v23, v158, v6, v23
    v_dot2_f32_bf16 v20, v147, v7, v20
    v_dot2_f32_bf16 v21, v151, v7, v21
    v_dot2_f32_bf16 v22, v155, v7, v22
    v_dot2_f32_bf16 v23, v159, v7, v23
    v_add_f32_dpp v24, v20, v20 row_ror:8 row_mask:0xf bank_mask:0x3
    s_nop 0
    v_add_f32_dpp v25, v22, v22 row_ror:8 row_mask:0xf bank_mask:0x3
    v_add_f32_dpp v24, v21, v21 row_ror:8 row_mask:0xf bank_mask:0xc
    v_add_f32_dpp v25, v23, v23 row_ror:8 row_mask:0xf bank_mask:0xc
    s_nop 0
    v_add_f32_dpp v26, v24, v24 row_shl:4 row_mask:0xf bank_mask:0x5
    v_add_f32_dpp v26, v25, v25 row_shr:4 row_mask:0xf bank_mask:0xa
    s_nop 1
    v_add_f32_dpp v26, v26, v26 quad_perm:[1,0,3,2] row_mask:0xf bank_mask:0xf
    s_nop 1
    v_add_f32_dpp v26, v26, v26 quad_perm:[2,3,0,1] row_mask:0xf bank_mask:0xf
    v_cvt_pk_bf16_f32 v26, v26, v26
    v_and_b32 v26, s98, v26
    v_mul_f32 v26, s96, v26
    v_cvt_pk_bf16_f32 v26, v26, v26
    v_and_b32 v26, s98, v26
    v_max_f32 v16, v16, v26
    v_accvgpr_write_b32 a221, v26
    s_waitcnt vmcnt(12)
    s_or_b32 s60, s61, s100
    s_or_b32 s61, s61, 0xfff1f9ff
    s_add_u32 s61, s61, 1
    s_and_b32 s61, s61, 0xe0600
    buffer_load_dwordx4 a[16:19], v0, s[36:39], s60 offen nt
    buffer_load_dwordx4 a[20:23], v18, s[36:39], s60 offen nt
    buffer_load_dwordx4 a[24:27], v48, s[36:39], s60 offen nt
    buffer_load_dwordx4 a[28:31], v49, s[36:39], s60 offen nt
    v_dot2_f32_bf16 v20, v160, v4, 0
    v_dot2_f32_bf16 v21, v164, v4, 0
    v_dot2_f32_bf16 v22, v168, v4, 0
    v_dot2_f32_bf16 v23, v172, v4, 0
    v_dot2_f32_bf16 v20, v161, v5, v20
    v_dot2_f32_bf16 v21, v165, v5, v21
    v_dot2_f32_bf16 v22, v169, v5, v22
    v_dot2_f32_bf16 v23, v173, v5, v23
    v_dot2_f32_bf16 v20, v162, v6, v20
    v_dot2_f32_bf16 v21, v166, v6, v21
    v_dot2_f32_bf16 v22, v170, v6, v22
    v_dot2_f32_bf16 v23, v174, v6, v23
    v_dot2_f32_bf16 v20, v163, v7, v20
    v_dot2_f32_bf16 v21, v167, v7, v21
    v_dot2_f32_bf16 v22, v171, v7, v22
    v_dot2_f32_bf16 v23, v175, v7, v23
    v_add_f32_dpp v24, v20, v20 row_ror:8 row_mask:0xf bank_mask:0x3
    s_nop 0
    v_add_f32_dpp v25, v22, v22 row_ror:8 row_mask:0xf bank_mask:0x3
    v_add_f32_dpp v24, v21, v21 row_ror:8 row_mask:0xf bank_mask:0xc
    v_add_f32_dpp v25, v23, v23 row_ror:8 row_mask:0xf bank_mask:0xc
    s_nop 0
    v_add_f32_dpp v26, v24, v24 row_shl:4 row_mask:0xf bank_mask:0x5
    v_add_f32_dpp v26, v25, v25 row_shr:4 row_mask:0xf bank_mask:0xa
    s_nop 1
    v_add_f32_dpp v26, v26, v26 quad_perm:[1,0,3,2] row_mask:0xf bank_mask:0xf
    s_nop 1
    v_add_f32_dpp v26, v26, v26 quad_perm:[2,3,0,1] row_mask:0xf bank_mask:0xf
    v_cvt_pk_bf16_f32 v26, v26, v26
    v_and_b32 v26, s98, v26
    v_mul_f32 v26, s96, v26
    v_cvt_pk_bf16_f32 v26, v26, v26
    v_and_b32 v26, s98, v26
    v_max_f32 v16, v16, v26
    v_accvgpr_write_b32 a222, v26
    s_waitcnt vmcnt(12)
    s_or_b32 s60, s61, s100
    s_or_b32 s61, s61, 0xfff1f9ff
    s_add_u32 s61, s61, 1
    s_and_b32 s61, s61, 0xe0600
    buffer_load_dwordx4 a[32:35], v0, s[36:39], s60 offen nt
    buffer_load_dwordx4 a[36:39], v18, s[36:39], s60 offen nt
    buffer_load_dwordx4 a[40:43], v48, s[36:39], s60 offen nt
    buffer_load_dwordx4 a[44:47], v49, s[36:39], s60 offen nt
    v_dot2_f32_bf16 v20, v176, v4, 0
    v_dot2_f32_bf16 v21, v180, v4, 0
    v_dot2_f32_bf16 v22, v184, v4, 0
    v_dot2_f32_bf16 v23, v188, v4, 0
    v_dot2_f32_bf16 v20, v177, v5, v20
    v_dot2_f32_bf16 v21, v181, v5, v21
    v_dot2_f32_bf16 v22, v185, v5, v22
    v_dot2_f32_bf16 v23, v189, v5, v23
    v_dot2_f32_bf16 v20, v178, v6, v20
    v_dot2_f32_bf16 v21, v182, v6, v21
    v_dot2_f32_bf16 v22, v186, v6, v22
    v_dot2_f32_bf16 v23, v190, v6, v23
    v_dot2_f32_bf16 v20, v179, v7, v20
    v_dot2_f32_bf16 v21, v183, v7, v21
    v_dot2_f32_bf16 v22, v187, v7, v22
    v_dot2_f32_bf16 v23, v191, v7, v23
    v_add_f32_dpp v24, v20, v20 row_ror:8 row_mask:0xf bank_mask:0x3
    s_nop 0
    v_add_f32_dpp v25, v22, v22 row_ror:8 row_mask:0xf bank_mask:0x3
    v_add_f32_dpp v24, v21, v21 row_ror:8 row_mask:0xf bank_mask:0xc
    v_add_f32_dpp v25, v23, v23 row_ror:8 row_mask:0xf bank_mask:0xc
    s_nop 0
    v_add_f32_dpp v26, v24, v24 row_shl:4 row_mask:0xf bank_mask:0x5
    v_add_f32_dpp v26, v25, v25 row_shr:4 row_mask:0xf bank_mask:0xa
    s_nop 1
    v_add_f32_dpp v26, v26, v26 quad_perm:[1,0,3,2] row_mask:0xf bank_mask:0xf
    s_nop 1
    v_add_f32_dpp v26, v26, v26 quad_perm:[2,3,0,1] row_mask:0xf bank_mask:0xf
    v_cvt_pk_bf16_f32 v26, v26, v26
    v_and_b32 v26, s98, v26
    v_mul_f32 v26, s96, v26
    v_cvt_pk_bf16_f32 v26, v26, v26
    v_and_b32 v26, s98, v26
    v_max_f32 v16, v16, v26
    v_accvgpr_write_b32 a223, v26
    s_waitcnt vmcnt(12)
    s_or_b32 s60, s61, s100
    s_or_b32 s61, s61, 0xfff1f9ff
    s_add_u32 s61, s61, 1
    s_and_b32 s61, s61, 0xe0600
    buffer_load_dwordx4 a[48:51], v0, s[36:39], s60 offen nt
    buffer_load_dwordx4 a[52:55], v18, s[36:39], s60 offen nt
    buffer_load_dwordx4 a[56:59], v48, s[36:39], s60 offen nt
    buffer_load_dwordx4 a[60:63], v49, s[36:39], s60 offen nt
    v_max_f32_dpp v27, v16, v16 row_ror:4 row_mask:0xf bank_mask:0xf
    s_nop 1
    v_max_f32_dpp v27, v27, v27 row_ror:8 row_mask:0xf bank_mask:0xf
    v_mov_b32 v28, v27
    s_nop 1
    v_permlane16_swap_b32 v27, v28
    v_max_f32 v27, v27, v28
    v_mov_b32 v28, v27
    s_nop 1
    v_permlane32_swap_b32 v27, v28
    v_max_f32 v16, v27, v28
L_aq2:
    v_max3_u32 v20, v60, v61, v62
    v_max_u32 v20, v20, v63
    v_cmp_eq_u32 vcc, -1, v20
    s_cbranch_vccz L_aq2_ok
    buffer_load_dwordx4 v[60:63], v59, s[44:47], s12 offen sc1
    s_waitcnt vmcnt(0)
    s_sub_u32 s101, s101, 1
    s_cbranch_scc0 L_aq2
    s_mov_b32 s101, 0
L_aq2_ok:
    v_mov_b32 v4, v60
    v_mov_b32 v5, v61
    v_mov_b32 v6, v62
    v_mov_b32 v7, v63
    v_dot2_f32_bf16 v20, v192, v4, 0
    v_dot2_f32_bf16 v21, v196, v4, 0
    v_dot2_f32_bf16 v22, v200, v4, 0
    v_dot2_f32_bf16 v23, v204, v4, 0
    v_dot2_f32_bf16 v20, v193, v5, v20
    v_dot2_f32_bf16 v21, v197, v5, v21
    v_dot2_f32_bf16 v22, v201, v5, v22
    v_dot2_f32_bf16 v23, v205, v5, v23
    v_dot2_f32_bf16 v20, v194, v6, v20
    v_dot2_f32_bf16 v21, v198, v6, v21
    v_dot2_f32_bf16 v22, v202, v6, v22
    v_dot2_f32_bf16 v23, v206, v6, v23
    v_dot2_f32_bf16 v20, v195, v7, v20
    v_dot2_f32_bf16 v21, v199, v7, v21
    v_dot2_f32_bf16 v22, v203, v7, v22
    v_dot2_f32_bf16 v23, v207, v7, v23
    v_add_f32_dpp v24, v20, v20 row_ror:8 row_mask:0xf bank_mask:0x3
    s_nop 0
    v_add_f32_dpp v25, v22, v22 row_ror:8 row_mask:0xf bank_mask:0x3
    v_add_f32_dpp v24, v21, v21 row_ror:8 row_mask:0xf bank_mask:0xc
    v_add_f32_dpp v25, v23, v23 row_ror:8 row_mask:0xf bank_mask:0xc
    s_nop 0
    v_add_f32_dpp v26, v24, v24 row_shl:4 row_mask:0xf bank_mask:0x5
    v_add_f32_dpp v26, v25, v25 row_shr:4 row_mask:0xf bank_mask:0xa
    s_nop 1
    v_add_f32_dpp v26, v26, v26 quad_perm:[1,0,3,2] row_mask:0xf bank_mask:0xf
    s_nop 1
    v_add_f32_dpp v26, v26, v26 quad_perm:[2,3,0,1] row_mask:0xf bank_mask:0xf
    v_cvt_pk_bf16_f32 v26, v26, v26
    v_and_b32 v26, s98, v26
    v_mul_f32 v26, s96, v26
    v_cvt_pk_bf16_f32 v26, v26, v26
    v_and_b32 v26, s98, v26
    v_max_f32 v57, v57, v26
    v_accvgpr_write_b32 a224, v26
    v_dot2_f32_bf16 v20, v208, v4, 0
    v_dot2_f32_bf16 v21, v212, v4, 0
    v_dot2_f32_bf16 v22, v216, v4, 0
    v_dot2_f32_bf16 v23, v220, v4, 0
    v_dot2_f32_bf16 v20, v209, v5, v20
    v_dot2_f32_bf16 v21, v213, v5, v21
    v_dot2_f32_bf16 v22, v217, v5, v22
    v_dot2_f32_bf16 v23, v221, v5, v23
    v_dot2_f32_bf16 v20, v210, v6, v20
    v_dot2_f32_bf16 v21, v214, v6, v21
    v_dot2_f32_bf16 v22, v218, v6, v22
    v_dot2_f32_bf16 v23, v222, v6, v23
    v_dot2_f32_bf16 v20, v211, v7, v20
    v_dot2_f32_bf16 v21, v215, v7, v21
    v_dot2_f32_bf16 v22, v219, v7, v22
    v_dot2_f32_bf16 v23, v223, v7, v23
    v_add_f32_dpp v24, v20, v20 row_ror:8 row_mask:0xf bank_mask:0x3
    s_nop 0
    v_add_f32_dpp v25, v22, v22 row_ror:8 row_mask:0xf bank_mask:0x3
    v_add_f32_dpp v24, v21, v21 row_ror:8 row_mask:0xf bank_mask:0xc
    v_add_f32_dpp v25, v23, v23 row_ror:8 row_mask:0xf bank_mask:0xc
    s_nop 0
    v_add_f32_dpp v26, v24, v24 row_shl:4 row_mask:0xf bank_mask:0x5
    v_add_f32_dpp v26, v25, v25 row_shr:4 row_mask:0xf bank_mask:0xa
    s_nop 1
    v_add_f32_dpp v26, v26, v26 quad_perm:[1,0,3,2] row_mask:0xf bank_mask:0xf
    s_nop 1
    v_add_f32_dpp v26, v26, v26 quad_perm:[2,3,0,1] row_mask:0xf bank_mask:0xf
    v_cvt_pk_bf16_f32 v26, v26, v26
    v_and_b32 v26, s98, v26
    v_mul_f32 v26, s96, v26
    v_cvt_pk_bf16_f32 v26, v26, v26
    v_and_b32 v26, s98, v26
    v_max_f32 v57, v57, v26
    v_accvgpr_write_b32 a225, v26
    v_dot2_f32_bf16 v20, v224, v4, 0
    v_dot2_f32_bf16 v21, v228, v4, 0
    v_dot2_f32_bf16 v22, v232, v4, 0
    v_dot2_f32_bf16 v23, v236, v4, 0
    v_dot2_f32_bf16 v20, v225, v5, v20
    v_dot2_f32_bf16 v21, v229, v5, v21
    v_dot2_f32_bf16 v22, v233, v5, v22
    v_dot2_f32_bf16 v23, v237, v5, v23
    v_dot2_f32_bf16 v20, v226, v6, v20
    v_dot2_f32_bf16 v21, v230, v6, v21
    v_dot2_f32_bf16 v22, v234, v6, v22
    v_dot2_f32_bf16 v23, v238, v6, v23
    v_dot2_f32_bf16 v20, v227, v7, v20
    v_dot2_f32_bf16 v21, v231, v7, v21
    v_dot2_f32_bf16 v22, v235, v7, v22
    v_dot2_f32_bf16 v23, v239, v7, v23
    v_add_f32_dpp v24, v20, v20 row_ror:8 row_mask:0xf bank_mask:0x3
    s_nop 0
    v_add_f32_dpp v25, v22, v22 row_ror:8 row_mask:0xf bank_mask:0x3
    v_add_f32_dpp v24, v21, v21 row_ror:8 row_mask:0xf bank_mask:0xc
    v_add_f32_dpp v25, v23, v23 row_ror:8 row_mask:0xf bank_mask:0xc
    s_nop 0
    v_add_f32_dpp v26, v24, v24 row_shl:4 row_mask:0xf bank_mask:0x5
    v_add_f32_dpp v26, v25, v25 row_shr:4 row_mask:0xf bank_mask:0xa
    s_nop 1
    v_add_f32_dpp v26, v26, v26 quad_perm:[1,0,3,2] row_mask:0xf bank_mask:0xf
    s_nop 1
    v_add_f32_dpp v26, v26, v26 quad_perm:[2,3,0,1] row_mask:0xf bank_mask:0xf
    v_cvt_pk_bf16_f32 v26, v26, v26
    v_and_b32 v26, s98, v26
    v_mul_f32 v26, s96, v26
    v_cvt_pk_bf16_f32 v26, v26, v26
    v_and_b32 v26, s98, v26
    v_max_f32 v57, v57, v26
    v_accvgpr_write_b32 a226, v26
    v_dot2_f32_bf16 v20, v240, v4, 0
    v_dot2_f32_bf16 v21, v244, v4, 0
    v_dot2_f32_bf16 v22, v248, v4, 0
    v_dot2_f32_bf16 v23, v252, v4, 0
    v_dot2_f32_bf16 v20, v241, v5, v20
    v_dot2_f32_bf16 v21, v245, v5, v21
    v_dot2_f32_bf16 v22, v249, v5, v22
    v_dot2_f32_bf16 v23, v253, v5, v23
    v_dot2_f32_bf16 v20, v242, v6, v20
    v_dot2_f32_bf16 v21, v246, v6, v21
    v_dot2_f32_bf16 v22, v250, v6, v22
    v_dot2_f32_bf16 v23, v254, v6, v23
    v_dot2_f32_bf16 v20, v243, v7, v20
    v_dot2_f32_bf16 v21, v247, v7, v21
    v_dot2_f32_bf16 v22, v251, v7, v22
    v_dot2_f32_bf16 v23, v255, v7, v23
    v_add_f32_dpp v24, v20, v20 row_ror:8 row_mask:0xf bank_mask:0x3
    s_nop 0
    v_add_f32_dpp v25, v22, v22 row_ror:8 row_mask:0xf bank_mask:0x3
    v_add_f32_dpp v24, v21, v21 row_ror:8 row_mask:0xf bank_mask:0xc
    v_add_f32_dpp v25, v23, v23 row_ror:8 row_mask:0xf bank_mask:0xc
    s_nop 0
    v_add_f32_dpp v26, v24, v24 row_shl:4 row_mask:0xf bank_mask:0x5
    v_add_f32_dpp v26, v25, v25 row_shr:4 row_mask:0xf bank_mask:0xa
    s_nop 1
    v_add_f32_dpp v26, v26, v26 quad_perm:[1,0,3,2] row_mask:0xf bank_mask:0xf
    s_nop 1
    v_add_f32_dpp v26, v26, v26 quad_perm:[2,3,0,1] row_mask:0xf bank_mask:0xf
    v_cvt_pk_bf16_f32 v26, v26, v26
    v_and_b32 v26, s98, v26
    v_mul_f32 v26, s96, v26
    v_cvt_pk_bf16_f32 v26, v26, v26
    v_and_b32 v26, s98, v26
    v_max_f32 v57, v57, v26
    v_accvgpr_write_b32 a227, v26
    s_mov_b32 s56, 4
    s_cmp_eq_u32 s20, 36
    s_cbranch_scc1 L_vloop
    v_dot2_f32_bf16 v20, v64, v4, 0
    v_dot2_f32_bf16 v21, v68, v4, 0
    v_dot2_f32_bf16 v22, v72, v4, 0
    v_dot2_f32_bf16 v23, v76, v4, 0
    v_dot2_f32_bf16 v20, v65, v5, v20
    v_dot2_f32_bf16 v21, v69, v5, v21
    v_dot2_f32_bf16 v22, v73, v5, v22
    v_dot2_f32_bf16 v23, v77, v5, v23
    v_dot2_f32_bf16 v20, v66, v6, v20
    v_dot2_f32_bf16 v21, v70, v6, v21
    v_dot2_f32_bf16 v22, v74, v6, v22
    v_dot2_f32_bf16 v23, v78, v6, v23
    v_dot2_f32_bf16 v20, v67, v7, v20
    v_dot2_f32_bf16 v21, v71, v7, v21
    v_dot2_f32_bf16 v22, v75, v7, v22
    v_dot2_f32_bf16 v23, v79, v7, v23
    v_add_f32_dpp v24, v20, v20 row_ror:8 row_mask:0xf bank_mask:0x3
    s_nop 0
    v_add_f32_dpp v25, v22, v22 row_ror:8 row_mask:0xf bank_mask:0x3
    v_add_f32_dpp v24, v21, v21 row_ror:8 row_mask:0xf bank_mask:0xc
    v_add_f32_dpp v25, v23, v23 row_ror:8 row_mask:0xf bank_mask:0xc
    s_nop 0
    v_add_f32_dpp v26, v24, v24 row_shl:4 row_mask:0xf bank_mask:0x5
    v_add_f32_dpp v26, v25, v25 row_shr:4 row_mask:0xf bank_mask:0xa
    s_nop 1
    v_add_f32_dpp v26, v26, v26 quad_perm:[1,0,3,2] row_mask:0xf bank_mask:0xf
    s_nop 1
    v_add_f32_dpp v26, v26, v26 quad_perm:[2,3,0,1] row_mask:0xf bank_mask:0xf
    v_cvt_pk_bf16_f32 v26, v26, v26
    v_and_b32 v26, s98, v26
    v_mul_f32 v26, s96, v26
    v_cvt_pk_bf16_f32 v26, v26, v26
    v_and_b32 v26, s98, v26
    v_max_f32 v57, v57, v26
    v_accvgpr_write_b32 a228, v26
    v_dot2_f32_bf16 v20, v80, v4, 0
    v_dot2_f32_bf16 v21, v84, v4, 0
    v_dot2_f32_bf16 v22, v88, v4, 0
    v_dot2_f32_bf16 v23, v92, v4, 0
    v_dot2_f32_bf16 v20, v81, v5, v20
    v_dot2_f32_bf16 v21, v85, v5, v21
    v_dot2_f32_bf16 v22, v89, v5, v22
    v_dot2_f32_bf16 v23, v93, v5, v23
    v_dot2_f32_bf16 v20, v82, v6, v20
    v_dot2_f32_bf16 v21, v86, v6, v21
    v_dot2_f32_bf16 v22, v90, v6, v22
    v_dot2_f32_bf16 v23, v94, v6, v23
    v_dot2_f32_bf16 v20, v83, v7, v20
    v_dot2_f32_bf16 v21, v87, v7, v21
    v_dot2_f32_bf16 v22, v91, v7, v22
    v_dot2_f32_bf16 v23, v95, v7, v23
    v_add_f32_dpp v24, v20, v20 row_ror:8 row_mask:0xf bank_mask:0x3
    s_nop 0
    v_add_f32_dpp v25, v22, v22 row_ror:8 row_mask:0xf bank_mask:0x3
    v_add_f32_dpp v24, v21, v21 row_ror:8 row_mask:0xf bank_mask:0xc
    v_add_f32_dpp v25, v23, v23 row_ror:8 row_mask:0xf bank_mask:0xc
    s_nop 0
    v_add_f32_dpp v26, v24, v24 row_shl:4 row_mask:0xf bank_mask:0x5
    v_add_f32_dpp v26, v25, v25 row_shr:4 row_mask:0xf bank_mask:0xa
    s_nop 1
    v_add_f32_dpp v26, v26, v26 quad_perm:[1,0,3,2] row_mask:0xf bank_mask:0xf
    s_nop 1
    v_add_f32_dpp v26, v26, v26 quad_perm:[2,3,0,1] row_mask:0xf bank_mask:0xf
    v_cvt_pk_bf16_f32 v26, v26, v26
    v_and_b32 v26, s98, v26
    v_mul_f32 v26, s96, v26
    v_cvt_pk_bf16_f32 v26, v26, v26
    v_and_b32 v26, s98, v26
    v_max_f32 v57, v57, v26
    v_accvgpr_write_b32 a229, v26
    v_dot2_f32_bf16 v20, v96, v4, 0
    v_dot2_f32_bf16 v21, v100, v4, 0
    v_dot2_f32_bf16 v22, v104, v4, 0
    v_dot2_f32_bf16 v23, v108, v4, 0
    v_dot2_f32_bf16 v20, v97, v5, v20
    v_dot2_f32_bf16 v21, v101, v5, v21
    v_dot2_f32_bf16 v22, v105, v5, v22
    v_dot2_f32_bf16 v23, v109, v5, v23
    v_dot2_f32_bf16 v20, v98, v6, v20
    v_dot2_f32_bf16 v21, v102, v6, v21
    v_dot2_f32_bf16 v22, v106, v6, v22
    v_dot2_f32_bf16 v23, v110, v6, v23
    v_dot2_f32_bf16 v20, v99, v7, v20
    v_dot2_f32_bf16 v21, v103, v7, v21
    v_dot2_f32_bf16 v22, v107, v7, v22
    v_dot2_f32_bf16 v23, v111, v7, v23
    v_add_f32_dpp v24, v20, v20 row_ror:8 row_mask:0xf bank_mask:0x3
    s_nop 0
    v_add_f32_dpp v25, v22, v22 row_ror:8 row_mask:0xf bank_mask:0x3
    v_add_f32_dpp v24, v21, v21 row_ror:8 row_mask:0xf bank_mask:0xc
    v_add_f32_dpp v25, v23, v23 row_ror:8 row_mask:0xf bank_mask:0xc
    s_nop 0
    v_add_f32_dpp v26, v24, v24 row_shl:4 row_mask:0xf bank_mask:0x5
    v_add_f32_dpp v26, v25, v25 row_shr:4 row_mask:0xf bank_mask:0xa
    s_nop 1
    v_add_f32_dpp v26, v26, v26 quad_perm:[1,0,3,2] row_mask:0xf bank_mask:0xf
    s_nop 1
    v_add_f32_dpp v26, v26, v26 quad_perm:[2,3,0,1] row_mask:0xf bank_mask:0xf
    v_cvt_pk_bf16_f32 v26, v26, v26
    v_and_b32 v26, s98, v26
    v_mul_f32 v26, s96, v26
    v_cvt_pk_bf16_f32 v26, v26, v26
    v_and_b32 v26, s98, v26
    v_max_f32 v57, v57, v26
    v_accvgpr_write_b32 a230, v26
    v_dot2_f32_bf16 v20, v112, v4, 0
    v_dot2_f32_bf16 v21, v116, v4, 0
    v_dot2_f32_bf16 v22, v120, v4, 0
    v_dot2_f32_bf16 v23, v124, v4, 0
    v_dot2_f32_bf16 v20, v113, v5, v20
    v_dot2_f32_bf16 v21, v117, v5, v21
    v_dot2_f32_bf16 v22, v121, v5, v22
    v_dot2_f32_bf16 v23, v125, v5, v23
    v_dot2_f32_bf16 v20, v114, v6, v20
    v_dot2_f32_bf16 v21, v118, v6, v21
    v_dot2_f32_bf16 v22, v122, v6, v22
    v_dot2_f32_bf16 v23, v126, v6, v23
    v_dot2_f32_bf16 v20, v115, v7, v20
    v_dot2_f32_bf16 v21, v119, v7, v21
    v_dot2_f32_bf16 v22, v123, v7, v22
    v_dot2_f32_bf16 v23, v127, v7, v23
    v_add_f32_dpp v24, v20, v20 row_ror:8 row_mask:0xf bank_mask:0x3
    s_nop 0
    v_add_f32_dpp v25, v22, v22 row_ror:8 row_mask:0xf bank_mask:0x3
    v_add_f32_dpp v24, v21, v21 row_ror:8 row_mask:0xf bank_mask:0xc
    v_add_f32_dpp v25, v23, v23 row_ror:8 row_mask:0xf bank_mask:0xc
    s_nop 0
    v_add_f32_dpp v26, v24, v24 row_shl:4 row_mask:0xf bank_mask:0x5
    v_add_f32_dpp v26, v25, v25 row_shr:4 row_mask:0xf bank_mask:0xa
    s_nop 1
    v_add_f32_dpp v26, v26, v26 quad_perm:[1,0,3,2] row_mask:0xf bank_mask:0xf
    s_nop 1
    v_add_f32_dpp v26, v26, v26 quad_perm:[2,3,0,1] row_mask:0xf bank_mask:0xf
    v_cvt_pk_bf16_f32 v26, v26, v26
    v_and_b32 v26, s98, v26
    v_mul_f32 v26, s96, v26
    v_cvt_pk_bf16_f32 v26, v26, v26
    v_and_b32 v26, s98, v26
    v_max_f32 v57, v57, v26
    v_accvgpr_write_b32 a231, v26
L_vloop:
    s_cmp_lt_u32 s56, 20
    s_cselect_b32 s7, s100, s9
    s_cmp_lt_u32 s56, 32
    s_cselect_b32 s7, s7, s11
    s_cselect_b32 s6, s8, 0xe6e00
    s_cmp_eq_u32 s56, 32
    s_cselect_b32 s61, s21, s61
    v_accvgpr_read_b32 v29, a192
    v_sub_f32 v29, v29, v16
    v_mul_f32 v29, s97, v29
    v_exp_f32 v29, v29
    s_nop 0
    v_add_f32 v17, v17, v29
    v_cvt_pk_bf16_f32 v29, v29, v29
    s_nop 1
    v_and_b32_dpp v32, v29, v8 row_newbcast:0 row_mask:0xf bank_mask:0xf
    v_and_b32_dpp v33, v29, v9 row_newbcast:0 row_mask:0xf bank_mask:0xf
    v_and_b32_dpp v34, v29, v10 row_newbcast:0 row_mask:0xf bank_mask:0xf
    v_and_b32_dpp v35, v29, v11 row_newbcast:0 row_mask:0xf bank_mask:0xf
    v_and_b32_dpp v36, v29, v8 row_newbcast:8 row_mask:0xf bank_mask:0xf
    v_and_b32_dpp v37, v29, v9 row_newbcast:8 row_mask:0xf bank_mask:0xf
    v_and_b32_dpp v38, v29, v10 row_newbcast:8 row_mask:0xf bank_mask:0xf
    v_and_b32_dpp v39, v29, v11 row_newbcast:8 row_mask:0xf bank_mask:0xf
    v_and_b32_dpp v40, v29, v8 row_newbcast:4 row_mask:0xf bank_mask:0xf
    v_and_b32_dpp v41, v29, v9 row_newbcast:4 row_mask:0xf bank_mask:0xf
    v_and_b32_dpp v42, v29, v10 row_newbcast:4 row_mask:0xf bank_mask:0xf
    v_and_b32_dpp v43, v29, v11 row_newbcast:4 row_mask:0xf bank_mask:0xf
    v_and_b32_dpp v44, v29, v8 row_newbcast:12 row_mask:0xf bank_mask:0xf
    v_and_b32_dpp v45, v29, v9 row_newbcast:12 row_mask:0xf bank_mask:0xf
    v_and_b32_dpp v46, v29, v10 row_newbcast:12 row_mask:0xf bank_mask:0xf
    v_and_b32_dpp v47, v29, v11 row_newbcast:12 row_mask:0xf bank_mask:0xf
    s_waitcnt vmcnt(12)
    v_mfma_f32_16x16x32_bf16 v[12:15], v[32:35], a[0:3], v[12:15]
    v_mfma_f32_16x16x32_bf16 v[12:15], v[36:39], a[4:7], v[12:15]
    v_mfma_f32_16x16x32_bf16 v[12:15], v[40:43], a[8:11], v[12:15]
    v_mfma_f32_16x16x32_bf16 v[12:15], v[44:47], a[12:15], v[12:15]
    s_or_b32 s60, s61, s7
    s_orn2_b32 s61, s61, s6
    s_add_u32 s61, s61, 1
    s_and_b32 s61, s61, s6
    buffer_load_dwordx4 a[0:3], v0, s[36:39], s60 offen nt
    buffer_load_dwordx4 a[4:7], v18, s[36:39], s60 offen nt
    buffer_load_dwordx4 a[8:11], v48, s[36:39], s60 offen nt
    buffer_load_dwordx4 a[12:15], v49, s[36:39], s60 offen nt
    v_accvgpr_mov_b32 a192, a196
    v_accvgpr_mov_b32 a196, a200
    v_accvgpr_mov_b32 a200, a204
    v_accvgpr_mov_b32 a204, a208
    v_accvgpr_mov_b32 a208, a212
    v_accvgpr_mov_b32 a212, a216
    v_accvgpr_mov_b32 a216, a220
    v_accvgpr_mov_b32 a220, a224
    v_accvgpr_mov_b32 a224, a228
    v_accvgpr_read_b32 v29, a193
    v_sub_f32 v29, v29, v16
    v_mul_f32 v29, s97, v29
    v_exp_f32 v29, v29
    s_nop 0
    v_add_f32 v17, v17, v29
    v_cvt_pk_bf16_f32 v29, v29, v29
    s_nop 1
    v_and_b32_dpp v32, v29, v8 row_newbcast:0 row_mask:0xf bank_mask:0xf
    v_and_b32_dpp v33, v29, v9 row_newbcast:0 row_mask:0xf bank_mask:0xf
    v_and_b32_dpp v34, v29, v10 row_newbcast:0 row_mask:0xf bank_mask:0xf
    v_and_b32_dpp v35, v29, v11 row_newbcast:0 row_mask:0xf bank_mask:0xf
    v_and_b32_dpp v36, v29, v8 row_newbcast:8 row_mask:0xf bank_mask:0xf
    v_and_b32_dpp v37, v29, v9 row_newbcast:8 row_mask:0xf bank_mask:0xf
    v_and_b32_dpp v38, v29, v10 row_newbcast:8 row_mask:0xf bank_mask:0xf
    v_and_b32_dpp v39, v29, v11 row_newbcast:8 row_mask:0xf bank_mask:0xf
    v_and_b32_dpp v40, v29, v8 row_newbcast:4 row_mask:0xf bank_mask:0xf
    v_and_b32_dpp v41, v29, v9 row_newbcast:4 row_mask:0xf bank_mask:0xf
    v_and_b32_dpp v42, v29, v10 row_newbcast:4 row_mask:0xf bank_mask:0xf
    v_and_b32_dpp v43, v29, v11 row_newbcast:4 row_mask:0xf bank_mask:0xf
    v_and_b32_dpp v44, v29, v8 row_newbcast:12 row_mask:0xf bank_mask:0xf
    v_and_b32_dpp v45, v29, v9 row_newbcast:12 row_mask:0xf bank_mask:0xf
    v_and_b32_dpp v46, v29, v10 row_newbcast:12 row_mask:0xf bank_mask:0xf
    v_and_b32_dpp v47, v29, v11 row_newbcast:12 row_mask:0xf bank_mask:0xf
    s_waitcnt vmcnt(12)
    v_mfma_f32_16x16x32_bf16 v[12:15], v[32:35], a[16:19], v[12:15]
    v_mfma_f32_16x16x32_bf16 v[12:15], v[36:39], a[20:23], v[12:15]
    v_mfma_f32_16x16x32_bf16 v[12:15], v[40:43], a[24:27], v[12:15]
    v_mfma_f32_16x16x32_bf16 v[12:15], v[44:47], a[28:31], v[12:15]
    s_or_b32 s60, s61, s7
    s_orn2_b32 s61, s61, s6
    s_add_u32 s61, s61, 1
    s_and_b32 s61, s61, s6
    buffer_load_dwordx4 a[16:19], v0, s[36:39], s60 offen nt
    buffer_load_dwordx4 a[20:23], v18, s[36:39], s60 offen nt
    buffer_load_dwordx4 a[24:27], v48, s[36:39], s60 offen nt
    buffer_load_dwordx4 a[28:31], v49, s[36:39], s60 offen nt
    v_accvgpr_mov_b32 a193, a197
    v_accvgpr_mov_b32 a197, a201
    v_accvgpr_mov_b32 a201, a205
    v_accvgpr_mov_b32 a205, a209
    v_accvgpr_mov_b32 a209, a213
    v_accvgpr_mov_b32 a213, a217
    v_accvgpr_mov_b32 a217, a221
    v_accvgpr_mov_b32 a221, a225
    v_accvgpr_mov_b32 a225, a229
    v_accvgpr_read_b32 v29, a194
    v_sub_f32 v29, v29, v16
    v_mul_f32 v29, s97, v29
    v_exp_f32 v29, v29
    s_nop 0
    v_add_f32 v17, v17, v29
    v_cvt_pk_bf16_f32 v29, v29, v29
    s_nop 1
    v_and_b32_dpp v32, v29, v8 row_newbcast:0 row_mask:0xf bank_mask:0xf
    v_and_b32_dpp v33, v29, v9 row_newbcast:0 row_mask:0xf bank_mask:0xf
    v_and_b32_dpp v34, v29, v10 row_newbcast:0 row_mask:0xf bank_mask:0xf
    v_and_b32_dpp v35, v29, v11 row_newbcast:0 row_mask:0xf bank_mask:0xf
    v_and_b32_dpp v36, v29, v8 row_newbcast:8 row_mask:0xf bank_mask:0xf
    v_and_b32_dpp v37, v29, v9 row_newbcast:8 row_mask:0xf bank_mask:0xf
    v_and_b32_dpp v38, v29, v10 row_newbcast:8 row_mask:0xf bank_mask:0xf
    v_and_b32_dpp v39, v29, v11 row_newbcast:8 row_mask:0xf bank_mask:0xf
    v_and_b32_dpp v40, v29, v8 row_newbcast:4 row_mask:0xf bank_mask:0xf
    v_and_b32_dpp v41, v29, v9 row_newbcast:4 row_mask:0xf bank_mask:0xf
    v_and_b32_dpp v42, v29, v10 row_newbcast:4 row_mask:0xf bank_mask:0xf
    v_and_b32_dpp v43, v29, v11 row_newbcast:4 row_mask:0xf bank_mask:0xf
    v_and_b32_dpp v44, v29, v8 row_newbcast:12 row_mask:0xf bank_mask:0xf
    v_and_b32_dpp v45, v29, v9 row_newbcast:12 row_mask:0xf bank_mask:0xf
    v_and_b32_dpp v46, v29, v10 row_newbcast:12 row_mask:0xf bank_mask:0xf
    v_and_b32_dpp v47, v29, v11 row_newbcast:12 row_mask:0xf bank_mask:0xf
    s_waitcnt vmcnt(12)
    v_mfma_f32_16x16x32_bf16 v[12:15], v[32:35], a[32:35], v[12:15]
    v_mfma_f32_16x16x32_bf16 v[12:15], v[36:39], a[36:39], v[12:15]
    v_mfma_f32_16x16x32_bf16 v[12:15], v[40:43], a[40:43], v[12:15]
    v_mfma_f32_16x16x32_bf16 v[12:15], v[44:47], a[44:47], v[12:15]
    s_or_b32 s60, s61, s7
    s_orn2_b32 s61, s61, s6
    s_add_u32 s61, s61, 1
    s_and_b32 s61, s61, s6
    buffer_load_dwordx4 a[32:35], v0, s[36:39], s60 offen nt
    buffer_load_dwordx4 a[36:39], v18, s[36:39], s60 offen nt
    buffer_load_dwordx4 a[40:43], v48, s[36:39], s60 offen nt
    buffer_load_dwordx4 a[44:47], v49, s[36:39], s60 offen nt
    v_accvgpr_mov_b32 a194, a198
    v_accvgpr_mov_b32 a198, a202
    v_accvgpr_mov_b32 a202, a206
    v_accvgpr_mov_b32 a206, a210
    v_accvgpr_mov_b32 a210, a214
    v_accvgpr_mov_b32 a214, a218
    v_accvgpr_mov_b32 a218, a222
    v_accvgpr_mov_b32 a222, a226
    v_accvgpr_mov_b32 a226, a230
    v_accvgpr_read_b32 v29, a195
    v_sub_f32 v29, v29, v16
    v_mul_f32 v29, s97, v29
    v_exp_f32 v29, v29
    s_nop 0
    v_add_f32 v17, v17, v29
    v_cvt_pk_bf16_f32 v29, v29, v29
    s_nop 1
    v_and_b32_dpp v32, v29, v8 row_newbcast:0 row_mask:0xf bank_mask:0xf
    v_and_b32_dpp v33, v29, v9 row_newbcast:0 row_mask:0xf bank_mask:0xf
    v_and_b32_dpp v34, v29, v10 row_newbcast:0 row_mask:0xf bank_mask:0xf
    v_and_b32_dpp v35, v29, v11 row_newbcast:0 row_mask:0xf bank_mask:0xf
    v_and_b32_dpp v36, v29, v8 row_newbcast:8 row_mask:0xf bank_mask:0xf
    v_and_b32_dpp v37, v29, v9 row_newbcast:8 row_mask:0xf bank_mask:0xf
    v_and_b32_dpp v38, v29, v10 row_newbcast:8 row_mask:0xf bank_mask:0xf
    v_and_b32_dpp v39, v29, v11 row_newbcast:8 row_mask:0xf bank_mask:0xf
    v_and_b32_dpp v40, v29, v8 row_newbcast:4 row_mask:0xf bank_mask:0xf
    v_and_b32_dpp v41, v29, v9 row_newbcast:4 row_mask:0xf bank_mask:0xf
    v_and_b32_dpp v42, v29, v10 row_newbcast:4 row_mask:0xf bank_mask:0xf
    v_and_b32_dpp v43, v29, v11 row_newbcast:4 row_mask:0xf bank_mask:0xf
    v_and_b32_dpp v44, v29, v8 row_newbcast:12 row_mask:0xf bank_mask:0xf
    v_and_b32_dpp v45, v29, v9 row_newbcast:12 row_mask:0xf bank_mask:0xf
    v_and_b32_dpp v46, v29, v10 row_newbcast:12 row_mask:0xf bank_mask:0xf
    v_and_b32_dpp v47, v29, v11 row_newbcast:12 row_mask:0xf bank_mask:0xf
    s_waitcnt vmcnt(12)
    v_mfma_f32_16x16x32_bf16 v[12:15], v[32:35], a[48:51], v[12:15]
    v_mfma_f32_16x16x32_bf16 v[12:15], v[36:39], a[52:55], v[12:15]
    v_mfma_f32_16x16x32_bf16 v[12:15], v[40:43], a[56:59], v[12:15]
    v_mfma_f32_16x16x32_bf16 v[12:15], v[44:47], a[60:63], v[12:15]
    s_or_b32 s60, s61, s7
    s_orn2_b32 s61, s61, s6
    s_add_u32 s61, s61, 1
    s_and_b32 s61, s61, s6
    buffer_load_dwordx4 a[48:51], v0, s[36:39], s60 offen nt
    buffer_load_dwordx4 a[52:55], v18, s[36:39], s60 offen nt
    buffer_load_dwordx4 a[56:59], v48, s[36:39], s60 offen nt
    buffer_load_dwordx4 a[60:63], v49, s[36:39], s60 offen nt
    v_accvgpr_mov_b32 a195, a199
    v_accvgpr_mov_b32 a199, a203
    v_accvgpr_mov_b32 a203, a207
    v_accvgpr_mov_b32 a207, a211
    v_accvgpr_mov_b32 a211, a215
    v_accvgpr_mov_b32 a215, a219
    v_accvgpr_mov_b32 a219, a223
    v_accvgpr_mov_b32 a223, a227
    v_accvgpr_mov_b32 a227, a231
    s_add_u32 s56, s56, 4
    s_cmp_lg_u32 s56, 36
    s_cbranch_scc1 L_vnext
    v_add_f32_dpp v17, v17, v17 row_ror:4 row_mask:0xf bank_mask:0xf
    s_nop 1
    v_add_f32_dpp v17, v17, v17 row_ror:8 row_mask:0xf bank_mask:0xf
    v_mov_b32 v28, v17
    s_nop 1
    v_permlane16_swap_b32 v17, v28
    v_add_f32 v17, v17, v28
    v_mov_b32 v28, v17
    s_nop 1
    v_permlane32_swap_b32 v17, v28
    v_add_f32 v51, v17, v28
    v_mov_b32 v50, v16
    v_cvt_pk_bf16_f32 v52, v12, v13
    v_cvt_pk_bf16_f32 v53, v14, v15
    v_mov_b32 v12, 0
    v_mov_b32 v13, 0
    v_mov_b32 v14, 0
    v_mov_b32 v15, 0
    v_mov_b32 v16, 0xff800000
    v_mov_b32 v17, 0
    v_max_f32_dpp v27, v57, v57 row_ror:4 row_mask:0xf bank_mask:0xf
    s_nop 1
    v_max_f32_dpp v27, v27, v27 row_ror:8 row_mask:0xf bank_mask:0xf
    v_mov_b32 v28, v27
    s_nop 1
    v_permlane16_swap_b32 v27, v28
    v_max_f32 v27, v27, v28
    v_mov_b32 v28, v27
    s_nop 1
    v_permlane32_swap_b32 v27, v28
    v_max_f32 v16, v27, v28
L_vnext:
    s_cmp_lt_u32 s56, s20
    s_cbranch_scc1 L_vloop
    s_mov_b32 s18, 0
    s_mov_b32 s14, 0
    s_mov_b32 s58, s59
    s_mov_b32 s13, 1
    s_cmp_eq_u32 s18, 0
    s_cbranch_scc0 L_notk_2
    s_mov_b32 s16, 1
    s_atomic_add s16, s[30:31], s57 glc
L_notk_2:
    v_accvgpr_read_b32 v29, a192
    v_sub_f32 v29, v29, v16
    v_mul_f32 v29, s97, v29
    v_exp_f32 v29, v29
    s_nop 0
    v_add_f32 v17, v17, v29
    v_cvt_pk_bf16_f32 v29, v29, v29
    s_nop 1
    v_and_b32_dpp v32, v29, v8 row_newbcast:0 row_mask:0xf bank_mask:0xf
    v_and_b32_dpp v33, v29, v9 row_newbcast:0 row_mask:0xf bank_mask:0xf
    v_and_b32_dpp v34, v29, v10 row_newbcast:0 row_mask:0xf bank_mask:0xf
    v_and_b32_dpp v35, v29, v11 row_newbcast:0 row_mask:0xf bank_mask:0xf
    v_and_b32_dpp v36, v29, v8 row_newbcast:8 row_mask:0xf bank_mask:0xf
    v_and_b32_dpp v37, v29, v9 row_newbcast:8 row_mask:0xf bank_mask:0xf
    v_and_b32_dpp v38, v29, v10 row_newbcast:8 row_mask:0xf bank_mask:0xf
    v_and_b32_dpp v39, v29, v11 row_newbcast:8 row_mask:0xf bank_mask:0xf
    v_and_b32_dpp v40, v29, v8 row_newbcast:4 row_mask:0xf bank_mask:0xf
    v_and_b32_dpp v41, v29, v9 row_newbcast:4 row_mask:0xf bank_mask:0xf
    v_and_b32_dpp v42, v29, v10 row_newbcast:4 row_mask:0xf bank_mask:0xf
    v_and_b32_dpp v43, v29, v11 row_newbcast:4 row_mask:0xf bank_mask:0xf
    v_and_b32_dpp v44, v29, v8 row_newbcast:12 row_mask:0xf bank_mask:0xf
    v_and_b32_dpp v45, v29, v9 row_newbcast:12 row_mask:0xf bank_mask:0xf
    v_and_b32_dpp v46, v29, v10 row_newbcast:12 row_mask:0xf bank_mask:0xf
    v_and_b32_dpp v47, v29, v11 row_newbcast:12 row_mask:0xf bank_mask:0xf
    s_waitcnt vmcnt(12)
    v_mfma_f32_16x16x32_bf16 v[12:15], v[32:35], a[0:3], v[12:15]
    v_mfma_f32_16x16x32_bf16 v[12:15], v[36:39], a[4:7], v[12:15]
    v_mfma_f32_16x16x32_bf16 v[12:15], v[40:43], a[8:11], v[12:15]
    v_mfma_f32_16x16x32_bf16 v[12:15], v[44:47], a[12:15], v[12:15]
    s_cmp_lg_u32 s18, 0
    s_cbranch_scc1 L_have_3
    s_waitcnt lgkmcnt(0)
    s_add_u32 s17, s16, 144
    s_mov_b32 s18, 1
    s_min_u32 s54, s16, 28
    s_cselect_b32 s18, 2, s18
    s_mul_i32 s54, s54, 1
    s_add_u32 s17, s17, s54
    s_cmp_ge_u32 s17, s19
    s_cbranch_scc1 L_vdry0
    s_add_u32 s54, s17, s99
    s_lshl_b32 s61, s54, 9
    s_and_b32 s61, s61, 0xe00
    s_lshl_b32 s55, s54, 10
    s_and_b32 s55, s55, 0x6000
    s_or_b32 s61, s61, s55
    s_lshl_b32 s55, s54, 12
    s_and_b32 s55, s55, 0xe0000
    s_or_b32 s61, s61, s55
    s_cmp_lt_u32 s17, 256
    s_cselect_b32 s7, s11, 0x8000000
    s_cselect_b32 s18, s18, 9
    s_cselect_b32 s63, 0, 1
    s_mov_b32 s6, 0xe6e00
L_have_3:
    s_or_b32 s60, s61, s7
    buffer_load_dwordx4 v[64:67], v0, s[32:35], s60 offen nt
    buffer_load_dwordx4 v[68:71], v18, s[32:35], s60 offen nt
    buffer_load_dwordx4 v[72:75], v48, s[32:35], s60 offen nt
    buffer_load_dwordx4 v[76:79], v49, s[32:35], s60 offen nt
    s_orn2_b32 s61, s61, s6
    s_add_u32 s61, s61, 1
    s_and_b32 s61, s61, s6
    s_add_u32 s58, s58, 32768
    s_sub_u32 s18, s18, 1
    s_sub_u32 s62, s62, s63
    v_accvgpr_read_b32 v29, a193
    v_sub_f32 v29, v29, v16
    v_mul_f32 v29, s97, v29
    v_exp_f32 v29, v29
    s_nop 0
    v_add_f32 v17, v17, v29
    v_cvt_pk_bf16_f32 v29, v29, v29
    s_nop 1
    v_and_b32_dpp v32, v29, v8 row_newbcast:0 row_mask:0xf bank_mask:0xf
    v_and_b32_dpp v33, v29, v9 row_newbcast:0 row_mask:0xf bank_mask:0xf
    v_and_b32_dpp v34, v29, v10 row_newbcast:0 row_mask:0xf bank_mask:0xf
    v_and_b32_dpp v35, v29, v11 row_newbcast:0 row_mask:0xf bank_mask:0xf
    v_and_b32_dpp v36, v29, v8 row_newbcast:8 row_mask:0xf bank_mask:0xf
    v_and_b32_dpp v37, v29, v9 row_newbcast:8 row_mask:0xf bank_mask:0xf
    v_and_b32_dpp v38, v29, v10 row_newbcast:8 row_mask:0xf bank_mask:0xf
    v_and_b32_dpp v39, v29, v11 row_newbcast:8 row_mask:0xf bank_mask:0xf
    v_and_b32_dpp v40, v29, v8 row_newbcast:4 row_mask:0xf bank_mask:0xf
    v_and_b32_dpp v41, v29, v9 row_newbcast:4 row_mask:0xf bank_mask:0xf
    v_and_b32_dpp v42, v29, v10 row_newbcast:4 row_mask:0xf bank_mask:0xf
    v_and_b32_dpp v43, v29, v11 row_newbcast:4 row_mask:0xf bank_mask:0xf
    v_and_b32_dpp v44, v29, v8 row_newbcast:12 row_mask:0xf bank_mask:0xf
    v_and_b32_dpp v45, v29, v9 row_newbcast:12 row_mask:0xf bank_mask:0xf
    v_and_b32_dpp v46, v29, v10 row_newbcast:12 row_mask:0xf bank_mask:0xf
    v_and_b32_dpp v47, v29, v11 row_newbcast:12 row_mask:0xf bank_mask:0xf
    s_waitcnt vmcnt(12)
    v_mfma_f32_16x16x32_bf16 v[12:15], v[32:35], a[16:19], v[12:15]
    v_mfma_f32_16x16x32_bf16 v[12:15], v[36:39], a[20:23], v[12:15]
    v_mfma_f32_16x16x32_bf16 v[12:15], v[40:43], a[24:27], v[12:15]
    v_mfma_f32_16x16x32_bf16 v[12:15], v[44:47], a[28:31], v[12:15]
    buffer_load_dwordx4 a[0:3], v0, s[36:39], s60 offen nt
    buffer_load_dwordx4 a[4:7], v18, s[36:39], s60 offen nt
    buffer_load_dwordx4 a[8:11], v48, s[36:39], s60 offen nt
    buffer_load_dwordx4 a[12:15], v49, s[36:39], s60 offen nt
    s_cmp_eq_u32 s18, 0
    s_cbranch_scc0 L_notk_4
    s_mov_b32 s16, 1
    s_atomic_add s16, s[30:31], s57 glc
L_notk_4:
    v_accvgpr_read_b32 v29, a194
    v_sub_f32 v29, v29, v16
    v_mul_f32 v29, s97, v29
    v_exp_f32 v29, v29
    s_nop 0
    v_add_f32 v17, v17, v29
    v_cvt_pk_bf16_f32 v29, v29, v29
    s_nop 1
    v_and_b32_dpp v32, v29, v8 row_newbcast:0 row_mask:0xf bank_mask:0xf
    v_and_b32_dpp v33, v29, v9 row_newbcast:0 row_mask:0xf bank_mask:0xf
    v_and_b32_dpp v34, v29, v10 row_newbcast:0 row_mask:0xf bank_mask:0xf
    v_and_b32_dpp v35, v29, v11 row_newbcast:0 row_mask:0xf bank_mask:0xf
    v_and_b32_dpp v36, v29, v8 row_newbcast:8 row_mask:0xf bank_mask:0xf
    v_and_b32_dpp v37, v29, v9 row_newbcast:8 row_mask:0xf bank_mask:0xf
    v_and_b32_dpp v38, v29, v10 row_newbcast:8 row_mask:0xf bank_mask:0xf
    v_and_b32_dpp v39, v29, v11 row_newbcast:8 row_mask:0xf bank_mask:0xf
    v_and_b32_dpp v40, v29, v8 row_newbcast:4 row_mask:0xf bank_mask:0xf
    v_and_b32_dpp v41, v29, v9 row_newbcast:4 row_mask:0xf bank_mask:0xf
    v_and_b32_dpp v42, v29, v10 row_newbcast:4 row_mask:0xf bank_mask:0xf
    v_and_b32_dpp v43, v29, v11 row_newbcast:4 row_mask:0xf bank_mask:0xf
    v_and_b32_dpp v44, v29, v8 row_newbcast:12 row_mask:0xf bank_mask:0xf
    v_and_b32_dpp v45, v29, v9 row_newbcast:12 row_mask:0xf bank_mask:0xf
    v_and_b32_dpp v46, v29, v10 row_newbcast:12 row_mask:0xf bank_mask:0xf
    v_and_b32_dpp v47, v29, v11 row_newbcast:12 row_mask:0xf bank_mask:0xf
    s_waitcnt vmcnt(12)
    v_mfma_f32_16x16x32_bf16 v[12:15], v[32:35], a[32:35], v[12:15]
    v_mfma_f32_16x16x32_bf16 v[12:15], v[36:39], a[36:39], v[12:15]
    v_mfma_f32_16x16x32_bf16 v[12:15], v[40:43], a[40:43], v[12:15]
    v_mfma_f32_16x16x32_bf16 v[12:15], v[44:47], a[44:47], v[12:15]
    s_cmp_lg_u32 s18, 0
    s_cbranch_scc1 L_have_5
    s_waitcnt lgkmcnt(0)
    s_add_u32 s17, s16, 144
    s_mov_b32 s18, 1
    s_min_u32 s54, s16, 28
    s_cselect_b32 s18, 2, s18
    s_mul_i32 s54, s54, 1
    s_add_u32 s17, s17, s54
    s_cmp_ge_u32 s17, s19
    s_cbranch_scc1 L_vdry1
    s_add_u32 s54, s17, s99
    s_lshl_b32 s61, s54, 9
    s_and_b32 s61, s61, 0xe00
    s_lshl_b32 s55, s54, 10
    s_and_b32 s55, s55, 0x6000
    s_or_b32 s61, s61, s55
    s_lshl_b32 s55, s54, 12
    s_and_b32 s55, s55, 0xe0000
    s_or_b32 s61, s61, s55
    s_cmp_lt_u32 s17, 256
    s_cselect_b32 s7, s11, 0x8000000
    s_cselect_b32 s18, s18, 9
    s_cselect_b32 s63, 0, 1
    s_mov_b32 s6, 0xe6e00
L_have_5:
    s_or_b32 s60, s61, s7
    buffer_load_dwordx4 v[80:83], v0, s[32:35], s60 offen nt
    buffer_load_dwordx4 v[84:87], v18, s[32:35], s60 offen nt
    buffer_load_dwordx4 v[88:91], v48, s[32:35], s60 offen nt
    buffer_load_dwordx4 v[92:95], v49, s[32:35], s60 offen nt
    s_orn2_b32 s61, s61, s6
    s_add_u32 s61, s61, 1
    s_and_b32 s61, s61, s6
    s_add_u32 s58, s58, 32768
    s_sub_u32 s18, s18, 1
    s_sub_u32 s62, s62, s63
    v_accvgpr_read_b32 v29, a195
    v_sub_f32 v29, v29, v16
    v_mul_f32 v29, s97, v29
    v_exp_f32 v29, v29
    s_nop 0
    v_add_f32 v17, v17, v29
    v_cvt_pk_bf16_f32 v29, v29, v29
    s_nop 1
    v_and_b32_dpp v32, v29, v8 row_newbcast:0 row_mask:0xf bank_mask:0xf
    v_and_b32_dpp v33, v29, v9 row_newbcast:0 row_mask:0xf bank_mask:0xf
    v_and_b32_dpp v34, v29, v10 row_newbcast:0 row_mask:0xf bank_mask:0xf
    v_and_b32_dpp v35, v29, v11 row_newbcast:0 row_mask:0xf bank_mask:0xf
    v_and_b32_dpp v36, v29, v8 row_newbcast:8 row_mask:0xf bank_mask:0xf
    v_and_b32_dpp v37, v29, v9 row_newbcast:8 row_mask:0xf bank_mask:0xf
    v_and_b32_dpp v38, v29, v10 row_newbcast:8 row_mask:0xf bank_mask:0xf
    v_and_b32_dpp v39, v29, v11 row_newbcast:8 row_mask:0xf bank_mask:0xf
    v_and_b32_dpp v40, v29, v8 row_newbcast:4 row_mask:0xf bank_mask:0xf
    v_and_b32_dpp v41, v29, v9 row_newbcast:4 row_mask:0xf bank_mask:0xf
    v_and_b32_dpp v42, v29, v10 row_newbcast:4 row_mask:0xf bank_mask:0xf
    v_and_b32_dpp v43, v29, v11 row_newbcast:4 row_mask:0xf bank_mask:0xf
    v_and_b32_dpp v44, v29, v8 row_newbcast:12 row_mask:0xf bank_mask:0xf
    v_and_b32_dpp v45, v29, v9 row_newbcast:12 row_mask:0xf bank_mask:0xf
    v_and_b32_dpp v46, v29, v10 row_newbcast:12 row_mask:0xf bank_mask:0xf
    v_and_b32_dpp v47, v29, v11 row_newbcast:12 row_mask:0xf bank_mask:0xf
    s_waitcnt vmcnt(12)
    v_mfma_f32_16x16x32_bf16 v[12:15], v[32:35], a[48:51], v[12:15]
    v_mfma_f32_16x16x32_bf16 v[12:15], v[36:39], a[52:55], v[12:15]
    v_mfma_f32_16x16x32_bf16 v[12:15], v[40:43], a[56:59], v[12:15]
    v_mfma_f32_16x16x32_bf16 v[12:15], v[44:47], a[60:63], v[12:15]
    buffer_load_dwordx4 a[16:19], v0, s[36:39], s60 offen nt
    buffer_load_dwordx4 a[20:23], v18, s[36:39], s60 offen nt
    buffer_load_dwordx4 a[24:27], v48, s[36:39], s60 offen nt
    buffer_load_dwordx4 a[28:31], v49, s[36:39], s60 offen nt
    s_cmp_eq_u32 s18, 0
    s_cbranch_scc0 L_notk_6
    s_mov_b32 s16, 1
    s_atomic_add s16, s[30:31], s57 glc
L_notk_6:
    s_nop 3
    s_cmp_eq_u32 s62, 0
    s_cbranch_scc1 L_adone2
L_aloop:
    s_waitcnt vmcnt(12)
    v_dot2_f32_bf16 v20, v64, v4, 0
    v_dot2_f32_bf16 v21, v68, v4, 0
    v_dot2_f32_bf16 v22, v72, v4, 0
    v_dot2_f32_bf16 v23, v76, v4, 0
    v_dot2_f32_bf16 v20, v65, v5, v20
    v_dot2_f32_bf16 v21, v69, v5, v21
    v_dot2_f32_bf16 v22, v73, v5, v22
    v_dot2_f32_bf16 v23, v77, v5, v23
    v_dot2_f32_bf16 v20, v66, v6, v20
    v_dot2_f32_bf16 v21, v70, v6, v21
    v_dot2_f32_bf16 v22, v74, v6, v22
    v_dot2_f32_bf16 v23, v78, v6, v23
    v_dot2_f32_bf16 v20, v67, v7, v20
    v_dot2_f32_bf16 v21, v71, v7, v21
    v_dot2_f32_bf16 v22, v75, v7, v22
    v_dot2_f32_bf16 v23, v79, v7, v23
    s_cmp_lg_u32 s18, 0
    s_cbranch_scc1 L_have_7
    s_waitcnt lgkmcnt(0)
    s_add_u32 s17, s16, 144
    s_mov_b32 s18, 1
    s_min_u32 s54, s16, 28
    s_cselect_b32 s18, 2, s18
    s_mul_i32 s54, s54, 1
    s_add_u32 s17, s17, s54
    s_cmp_ge_u32 s17, s19
    s_cbranch_scc1 L_adrain0
    s_add_u32 s54, s17, s99
    s_lshl_b32 s61, s54, 9
    s_and_b32 s61, s61, 0xe00
    s_lshl_b32 s55, s54, 10
    s_and_b32 s55, s55, 0x6000
    s_or_b32 s61, s61, s55
    s_lshl_b32 s55, s54, 12
    s_and_b32 s55, s55, 0xe0000
    s_or_b32 s61, s61, s55
    s_cmp_lt_u32 s17, 256
    s_cselect_b32 s7, s11, 0x8000000
    s_cselect_b32 s18, s18, 9
    s_cselect_b32 s63, 0, 1
    s_mov_b32 s6, 0xe6e00
L_have_7:
    s_or_b32 s60, s61, s7
    buffer_load_dwordx4 v[64:67], v0, s[32:35], s60 offen nt
    buffer_load_dwordx4 v[68:71], v18, s[32:35], s60 offen nt
    buffer_load_dwordx4 v[72:75], v48, s[32:35], s60 offen nt
    buffer_load_dwordx4 v[76:79], v49, s[32:35], s60 offen nt
    s_orn2_b32 s61, s61, s6
    s_add_u32 s61, s61, 1
    s_and_b32 s61, s61, s6
    s_add_u32 s58, s58, 32768
    s_sub_u32 s18, s18, 1
    s_sub_u32 s62, s62, s63
    v_add_f32_dpp v24, v20, v20 row_ror:8 row_mask:0xf bank_mask:0x3
    v_add_f32_dpp v25, v22, v22 row_ror:8 row_mask:0xf bank_mask:0x3
    v_add_f32_dpp v24, v21, v21 row_ror:8 row_mask:0xf bank_mask:0xc
    v_add_f32_dpp v25, v23, v23 row_ror:8 row_mask:0xf bank_mask:0xc
    s_nop 0
    v_add_f32_dpp v26, v24, v24 row_shl:4 row_mask:0xf bank_mask:0x5
    v_add_f32_dpp v26, v25, v25 row_shr:4 row_mask:0xf bank_mask:0xa
    s_nop 1
    v_add_f32_dpp v26, v26, v26 quad_perm:[1,0,3,2] row_mask:0xf bank_mask:0xf
    s_nop 1
    v_add_f32_dpp v26, v26, v26 quad_perm:[2,3,0,1] row_mask:0xf bank_mask:0xf
    v_cvt_pk_bf16_f32 v26, v26, v26
    v_and_b32 v26, s98, v26
    v_mul_f32 v26, s96, v26
    v_cvt_pk_bf16_f32 v26, v26, v26
    v_and_b32 v26, s98, v26
    s_nop 1
    v_max_f32_dpp v27, v26, v26 row_ror:4 row_mask:0xf bank_mask:0xf
    s_nop 1
    v_max_f32_dpp v27, v27, v27 row_ror:8 row_mask:0xf bank_mask:0xf
    v_mov_b32 v28, v27
    s_nop 1
    v_permlane16_swap_b32 v27, v28
    v_max_f32 v27, v27, v28
    v_mov_b32 v28, v27
    s_nop 1
    v_permlane32_swap_b32 v27, v28
    v_max3_f32 v27, v27, v28, v16
    v_sub_f32 v28, v16, v27
    v_sub_f32 v29, v26, v27
    v_mul_f32 v28, s97, v28
    v_mul_f32 v29, s97, v29
    v_exp_f32 v28, v28
    v_exp_f32 v29, v29
    v_mov_b32 v16, v27
    v_fma_f32 v17, v17, v28, v29
    v_cvt_pk_bf16_f32 v29, v29, v29
    v_mul_f32 v12, v12, v28
    v_mul_f32 v13, v13, v28
    v_mul_f32 v14, v14, v28
    v_mul_f32 v15, v15, v28
    s_waitcnt vmcnt(12)
    v_and_b32_dpp v32, v29, v8 row_newbcast:0 row_mask:0xf bank_mask:0xf
    v_and_b32_dpp v33, v29, v9 row_newbcast:0 row_mask:0xf bank_mask:0xf
    v_and_b32_dpp v34, v29, v10 row_newbcast:0 row_mask:0xf bank_mask:0xf
    v_and_b32_dpp v35, v29, v11 row_newbcast:0 row_mask:0xf bank_mask:0xf
    v_and_b32_dpp v36, v29, v8 row_newbcast:8 row_mask:0xf bank_mask:0xf
    v_and_b32_dpp v37, v29, v9 row_newbcast:8 row_mask:0xf bank_mask:0xf
    v_and_b32_dpp v38, v29, v10 row_newbcast:8 row_mask:0xf bank_mask:0xf
    v_and_b32_dpp v39, v29, v11 row_newbcast:8 row_mask:0xf bank_mask:0xf
    v_and_b32_dpp v40, v29, v8 row_newbcast:4 row_mask:0xf bank_mask:0xf
    v_and_b32_dpp v41, v29, v9 row_newbcast:4 row_mask:0xf bank_mask:0xf
    v_and_b32_dpp v42, v29, v10 row_newbcast:4 row_mask:0xf bank_mask:0xf
    v_and_b32_dpp v43, v29, v11 row_newbcast:4 row_mask:0xf bank_mask:0xf
    v_and_b32_dpp v44, v29, v8 row_newbcast:12 row_mask:0xf bank_mask:0xf
    v_and_b32_dpp v45, v29, v9 row_newbcast:12 row_mask:0xf bank_mask:0xf
    v_and_b32_dpp v46, v29, v10 row_newbcast:12 row_mask:0xf bank_mask:0xf
    v_and_b32_dpp v47, v29, v11 row_newbcast:12 row_mask:0xf bank_mask:0xf
    v_mfma_f32_16x16x32_bf16 v[12:15], v[32:35], a[0:3], v[12:15]
    v_mfma_f32_16x16x32_bf16 v[12:15], v[36:39], a[4:7], v[12:15]
    v_mfma_f32_16x16x32_bf16 v[12:15], v[40:43], a[8:11], v[12:15]
    v_mfma_f32_16x16x32_bf16 v[12:15], v[44:47], a[12:15], v[12:15]
    buffer_load_dwordx4 a[0:3], v0, s[36:39], s60 offen nt
    buffer_load_dwordx4 a[4:7], v18, s[36:39], s60 offen nt
    buffer_load_dwordx4 a[8:11], v48, s[36:39], s60 offen nt
    buffer_load_dwordx4 a[12:15], v49, s[36:39], s60 offen nt
    s_cmp_eq_u32 s18, 0
    s_cbranch_scc0 L_notk_8
    s_mov_b32 s16, 1
    s_atomic_add s16, s[30:31], s57 glc
L_notk_8:
    s_cmp_eq_u32 s62, 0
    s_cbranch_scc1 L_adone
    s_waitcnt vmcnt(12)
    v_dot2_f32_bf16 v20, v80, v4, 0
    v_dot2_f32_bf16 v21, v84, v4, 0
    v_dot2_f32_bf16 v22, v88, v4, 0
    v_dot2_f32_bf16 v23, v92, v4, 0
    v_dot2_f32_bf16 v20, v81, v5, v20
    v_dot2_f32_bf16 v21, v85, v5, v21
    v_dot2_f32_bf16 v22, v89, v5, v22
    v_dot2_f32_bf16 v23, v93, v5, v23
    v_dot2_f32_bf16 v20, v82, v6, v20
    v_dot2_f32_bf16 v21, v86, v6, v21
    v_dot2_f32_bf16 v22, v90, v6, v22
    v_dot2_f32_bf16 v23, v94, v6, v23
    v_dot2_f32_bf16 v20, v83, v7, v20
    v_dot2_f32_bf16 v21, v87, v7, v21
    v_dot2_f32_bf16 v22, v91, v7, v22
    v_dot2_f32_bf16 v23, v95, v7, v23
    s_cmp_lg_u32 s18, 0
    s_cbranch_scc1 L_have_9
    s_waitcnt lgkmcnt(0)
    s_add_u32 s17, s16, 144
    s_mov_b32 s18, 1
    s_min_u32 s54, s16, 28
    s_cselect_b32 s18, 2, s18
    s_mul_i32 s54, s54, 1
    s_add_u32 s17, s17, s54
    s_cmp_ge_u32 s17, s19
    s_cbranch_scc1 L_adrain1
    s_add_u32 s54, s17, s99
    s_lshl_b32 s61, s54, 9
    s_and_b32 s61, s61, 0xe00
    s_lshl_b32 s55, s54, 10
    s_and_b32 s55, s55, 0x6000
    s_or_b32 s61, s61, s55
    s_lshl_b32 s55, s54, 12
    s_and_b32 s55, s55, 0xe0000
    s_or_b32 s61, s61, s55
    s_cmp_lt_u32 s17, 256
    s_cselect_b32 s7, s11, 0x8000000
    s_cselect_b32 s18, s18, 9
    s_cselect_b32 s63, 0, 1
    s_mov_b32 s6, 0xe6e00
L_have_9:
    s_or_b32 s60, s61, s7
    buffer_load_dwordx4 v[80:83], v0, s[32:35], s60 offen nt
    buffer_load_dwordx4 v[84:87], v18, s[32:35], s60 offen nt
    buffer_load_dwordx4 v[88:91], v48, s[32:35], s60 offen nt
    buffer_load_dwordx4 v[92:95], v49, s[32:35], s60 offen nt
    s_orn2_b32 s61, s61, s6
    s_add_u32 s61, s61, 1
    s_and_b32 s61, s61, s6
    s_add_u32 s58, s58, 32768
    s_sub_u32 s18, s18, 1
    s_sub_u32 s62, s62, s63
    v_add_f32_dpp v24, v20, v20 row_ror:8 row_mask:0xf bank_mask:0x3
    v_add_f32_dpp v25, v22, v22 row_ror:8 row_mask:0xf bank_mask:0x3
    v_add_f32_dpp v24, v21, v21 row_ror:8 row_mask:0xf bank_mask:0xc
    v_add_f32_dpp v25, v23, v23 row_ror:8 row_mask:0xf bank_mask:0xc
    s_nop 0
    v_add_f32_dpp v26, v24, v24 row_shl:4 row_mask:0xf bank_mask:0x5
    v_add_f32_dpp v26, v25, v25 row_shr:4 row_mask:0xf bank_mask:0xa
    s_nop 1
    v_add_f32_dpp v26, v26, v26 quad_perm:[1,0,3,2] row_mask:0xf bank_mask:0xf
    s_nop 1
    v_add_f32_dpp v26, v26, v26 quad_perm:[2,3,0,1] row_mask:0xf bank_mask:0xf
    v_cvt_pk_bf16_f32 v26, v26, v26
    v_and_b32 v26, s98, v26
    v_mul_f32 v26, s96, v26
    v_cvt_pk_bf16_f32 v26, v26, v26
    v_and_b32 v26, s98, v26
    s_nop 1
    v_max_f32_dpp v27, v26, v26 row_ror:4 row_mask:0xf bank_mask:0xf
    s_nop 1
    v_max_f32_dpp v27, v27, v27 row_ror:8 row_mask:0xf bank_mask:0xf
    v_mov_b32 v28, v27
    s_nop 1
    v_permlane16_swap_b32 v27, v28
    v_max_f32 v27, v27, v28
    v_mov_b32 v28, v27
    s_nop 1
    v_permlane32_swap_b32 v27, v28
    v_max3_f32 v27, v27, v28, v16
    v_sub_f32 v28, v16, v27
    v_sub_f32 v29, v26, v27
    v_mul_f32 v28, s97, v28
    v_mul_f32 v29, s97, v29
    v_exp_f32 v28, v28
    v_exp_f32 v29, v29
    v_mov_b32 v16, v27
    v_fma_f32 v17, v17, v28, v29
    v_cvt_pk_bf16_f32 v29, v29, v29
    v_mul_f32 v12, v12, v28
    v_mul_f32 v13, v13, v28
    v_mul_f32 v14, v14, v28
    v_mul_f32 v15, v15, v28
    s_waitcnt vmcnt(12)
    v_and_b32_dpp v32, v29, v8 row_newbcast:0 row_mask:0xf bank_mask:0xf
    v_and_b32_dpp v33, v29, v9 row_newbcast:0 row_mask:0xf bank_mask:0xf
    v_and_b32_dpp v34, v29, v10 row_newbcast:0 row_mask:0xf bank_mask:0xf
    v_and_b32_dpp v35, v29, v11 row_newbcast:0 row_mask:0xf bank_mask:0xf
    v_and_b32_dpp v36, v29, v8 row_newbcast:8 row_mask:0xf bank_mask:0xf
    v_and_b32_dpp v37, v29, v9 row_newbcast:8 row_mask:0xf bank_mask:0xf
    v_and_b32_dpp v38, v29, v10 row_newbcast:8 row_mask:0xf bank_mask:0xf
    v_and_b32_dpp v39, v29, v11 row_newbcast:8 row_mask:0xf bank_mask:0xf
    v_and_b32_dpp v40, v29, v8 row_newbcast:4 row_mask:0xf bank_mask:0xf
    v_and_b32_dpp v41, v29, v9 row_newbcast:4 row_mask:0xf bank_mask:0xf
    v_and_b32_dpp v42, v29, v10 row_newbcast:4 row_mask:0xf bank_mask:0xf
    v_and_b32_dpp v43, v29, v11 row_newbcast:4 row_mask:0xf bank_mask:0xf
    v_and_b32_dpp v44, v29, v8 row_newbcast:12 row_mask:0xf bank_mask:0xf
    v_and_b32_dpp v45, v29, v9 row_newbcast:12 row_mask:0xf bank_mask:0xf
    v_and_b32_dpp v46, v29, v10 row_newbcast:12 row_mask:0xf bank_mask:0xf
    v_and_b32_dpp v47, v29, v11 row_newbcast:12 row_mask:0xf bank_mask:0xf
    v_mfma_f32_16x16x32_bf16 v[12:15], v[32:35], a[16:19], v[12:15]
    v_mfma_f32_16x16x32_bf16 v[12:15], v[36:39], a[20:23], v[12:15]
    v_mfma_f32_16x16x32_bf16 v[12:15], v[40:43], a[24:27], v[12:15]
    v_mfma_f32_16x16x32_bf16 v[12:15], v[44:47], a[28:31], v[12:15]
    buffer_load_dwordx4 a[16:19], v0, s[36:39], s60 offen nt
    buffer_load_dwordx4 a[20:23], v18, s[36:39], s60 offen nt
    buffer_load_dwordx4 a[24:27], v48, s[36:39], s60 offen nt
    buffer_load_dwordx4 a[28:31], v49, s[36:39], s60 offen nt
    s_cmp_eq_u32 s18, 0
    s_cbranch_scc0 L_notk_10
    s_mov_b32 s16, 1
    s_atomic_add s16, s[30:31], s57 glc
L_notk_10:
    s_cmp_eq_u32 s62, 0
    s_cbranch_scc1 L_adone
    s_cmp_lg_u32 s58, s14
    s_cbranch_scc1 L_aloop
    s_cmp_eq_u32 s14, s15
    s_cbranch_scc1 L_aswitch
    buffer_load_dwordx4 v[60:63], v59, s[44:47], s12 offen sc1
    s_mov_b32 s14, s15
    s_branch L_aloop
L_aswitch:
    s_nop 11
    v_add_f32_dpp v17, v17, v17 row_ror:4 row_mask:0xf bank_mask:0xf
    s_nop 1
    v_add_f32_dpp v17, v17, v17 row_ror:8 row_mask:0xf bank_mask:0xf
    v_mov_b32 v28, v17
    s_nop 1
    v_permlane16_swap_b32 v17, v28
    v_add_f32 v17, v17, v28
    v_mov_b32 v28, v17
    s_nop 1
    v_permlane32_swap_b32 v17, v28
    v_add_f32 v51, v17, v28
    v_mov_b32 v50, v16
    v_cvt_pk_bf16_f32 v52, v12, v13
    v_cvt_pk_bf16_f32 v53, v14, v15
    v_mov_b32 v12, 0
    v_mov_b32 v13, 0
    v_mov_b32 v14, 0
    v_mov_b32 v15, 0
    v_mov_b32 v16, 0xff800000
    v_mov_b32 v17, 0
    s_mov_b32 s13, 1
    s_cmp_eq_u32 s62, 0
    s_cbranch_scc1 L_adone
    s_cmp_lg_u32 s62, 3
    s_cbranch_scc1 L_aloop
    s_branch L_alast0
L_adrain1:
    buffer_load_dwordx4 v[128:131], v19, s[40:43], s24 offen offset:0 nt
    buffer_load_dwordx4 v[132:135], v19, s[40:43], s24 offen offset:1152 nt
    buffer_load_dwordx4 v[136:139], v19, s[40:43], s24 offen offset:2304 nt
    buffer_load_dwordx4 v[140:143], v19, s[40:43], s24 offen offset:3456 nt
    s_add_u32 s24, s24, 4608
    buffer_load_dwordx4 v[144:147], v19, s[40:43], s24 offen offset:0 nt
    buffer_load_dwordx4 v[148:151], v19, s[40:43], s24 offen offset:1152 nt
    buffer_load_dwordx4 v[152:155], v19, s[40:43], s24 offen offset:2304 nt
    buffer_load_dwordx4 v[156:159], v19, s[40:43], s24 offen offset:3456 nt
    s_add_u32 s24, s24, 69120
    v_add_f32_dpp v24, v20, v20 row_ror:8 row_mask:0xf bank_mask:0x3
    v_add_f32_dpp v25, v22, v22 row_ror:8 row_mask:0xf bank_mask:0x3
    v_add_f32_dpp v24, v21, v21 row_ror:8 row_mask:0xf bank_mask:0xc
    v_add_f32_dpp v25, v23, v23 row_ror:8 row_mask:0xf bank_mask:0xc
    s_nop 0
    v_add_f32_dpp v26, v24, v24 row_shl:4 row_mask:0xf bank_mask:0x5
    v_add_f32_dpp v26, v25, v25 row_shr:4 row_mask:0xf bank_mask:0xa
    s_nop 1
    v_add_f32_dpp v26, v26, v26 quad_perm:[1,0,3,2] row_mask:0xf bank_mask:0xf
    s_nop 1
    v_add_f32_dpp v26, v26, v26 quad_perm:[2,3,0,1] row_mask:0xf bank_mask:0xf
    v_cvt_pk_bf16_f32 v26, v26, v26
    v_and_b32 v26, s98, v26
    v_mul_f32 v26, s96, v26
    v_cvt_pk_bf16_f32 v26, v26, v26
    v_and_b32 v26, s98, v26
    s_nop 1
    v_max_f32_dpp v27, v26, v26 row_ror:4 row_mask:0xf bank_mask:0xf
    s_nop 1
    v_max_f32_dpp v27, v27, v27 row_ror:8 row_mask:0xf bank_mask:0xf
    v_mov_b32 v28, v27
    s_nop 1
    v_permlane16_swap_b32 v27, v28
    v_max_f32 v27, v27, v28
    v_mov_b32 v28, v27
    s_nop 1
    v_permlane32_swap_b32 v27, v28
    v_max3_f32 v27, v27, v28, v16
    v_sub_f32 v28, v16, v27
    v_sub_f32 v29, v26, v27
    v_mul_f32 v28, s97, v28
    v_mul_f32 v29, s97, v29
    v_exp_f32 v28, v28
    v_exp_f32 v29, v29
    v_mov_b32 v16, v27
    v_fma_f32 v17, v17, v28, v29
    v_cvt_pk_bf16_f32 v29, v29, v29
    v_mul_f32 v12, v12, v28
    v_mul_f32 v13, v13, v28
    v_mul_f32 v14, v14, v28
    v_mul_f32 v15, v15, v28
    s_waitcnt vmcnt(16)
    v_and_b32_dpp v32, v29, v8 row_newbcast:0 row_mask:0xf bank_mask:0xf
    v_and_b32_dpp v33, v29, v9 row_newbcast:0 row_mask:0xf bank_mask:0xf
    v_and_b32_dpp v34, v29, v10 row_newbcast:0 row_mask:0xf bank_mask:0xf
    v_and_b32_dpp v35, v29, v11 row_newbcast:0 row_mask:0xf bank_mask:0xf
    v_and_b32_dpp v36, v29, v8 row_newbcast:8 row_mask:0xf bank_mask:0xf
    v_and_b32_dpp v37, v29, v9 row_newbcast:8 row_mask:0xf bank_mask:0xf
    v_and_b32_dpp v38, v29, v10 row_newbcast:8 row_mask:0xf bank_mask:0xf
    v_and_b32_dpp v39, v29, v11 row_newbcast:8 row_mask:0xf bank_mask:0xf
    v_and_b32_dpp v40, v29, v8 row_newbcast:4 row_mask:0xf bank_mask:0xf
    v_and_b32_dpp v41, v29, v9 row_newbcast:4 row_mask:0xf bank_mask:0xf
    v_and_b32_dpp v42, v29, v10 row_newbcast:4 row_mask:0xf bank_mask:0xf
    v_and_b32_dpp v43, v29, v11 row_newbcast:4 row_mask:0xf bank_mask:0xf
    v_and_b32_dpp v44, v29, v8 row_newbcast:12 row_mask:0xf bank_mask:0xf
    v_and_b32_dpp v45, v29, v9 row_newbcast:12 row_mask:0xf bank_mask:0xf
    v_and_b32_dpp v46, v29, v10 row_newbcast:12 row_mask:0xf bank_mask:0xf
    v_and_b32_dpp v47, v29, v11 row_newbcast:12 row_mask:0xf bank_mask:0xf
    v_mfma_f32_16x16x32_bf16 v[12:15], v[32:35], a[16:19], v[12:15]
    v_mfma_f32_16x16x32_bf16 v[12:15], v[36:39], a[20:23], v[12:15]
    v_mfma_f32_16x16x32_bf16 v[12:15], v[40:43], a[24:27], v[12:15]
    v_mfma_f32_16x16x32_bf16 v[12:15], v[44:47], a[28:31], v[12:15]
    s_mov_b32 s62, 3
    s_cmp_eq_u32 s13, 0
    s_cbranch_scc1 L_aswitch
L_alast0:
    s_waitcnt vmcnt(12)
    v_dot2_f32_bf16 v20, v64, v4, 0
    v_dot2_f32_bf16 v21, v68, v4, 0
    v_dot2_f32_bf16 v22, v72, v4, 0
    v_dot2_f32_bf16 v23, v76, v4, 0
    v_dot2_f32_bf16 v20, v65, v5, v20
    v_dot2_f32_bf16 v21, v69, v5, v21
    v_dot2_f32_bf16 v22, v73, v5, v22
    v_dot2_f32_bf16 v23, v77, v5, v23
    v_dot2_f32_bf16 v20, v66, v6, v20
    v_dot2_f32_bf16 v21, v70, v6, v21
    v_dot2_f32_bf16 v22, v74, v6, v22
    v_dot2_f32_bf16 v23, v78, v6, v23
    v_dot2_f32_bf16 v20, v67, v7, v20
    v_dot2_f32_bf16 v21, v71, v7, v21
    v_dot2_f32_bf16 v22, v75, v7, v22
    v_dot2_f32_bf16 v23, v79, v7, v23
    buffer_load_dwordx4 v[160:163], v19, s[40:43], s24 offen offset:0 nt
    buffer_load_dwordx4 v[164:167], v19, s[40:43], s24 offen offset:1152 nt
    buffer_load_dwordx4 v[168:171], v19, s[40:43], s24 offen offset:2304 nt
    buffer_load_dwordx4 v[172:175], v19, s[40:43], s24 offen offset:3456 nt
    s_add_u32 s24, s24, 4608
    buffer_load_dwordx4 v[176:179], v19, s[40:43], s24 offen offset:0 nt
    buffer_load_dwordx4 v[180:183], v19, s[40:43], s24 offen offset:1152 nt
    buffer_load_dwordx4 v[184:187], v19, s[40:43], s24 offen offset:2304 nt
    buffer_load_dwordx4 v[188:191], v19, s[40:43], s24 offen offset:3456 nt
    v_add_f32_dpp v24, v20, v20 row_ror:8 row_mask:0xf bank_mask:0x3
    v_add_f32_dpp v25, v22, v22 row_ror:8 row_mask:0xf bank_mask:0x3
    v_add_f32_dpp v24, v21, v21 row_ror:8 row_mask:0xf bank_mask:0xc
    v_add_f32_dpp v25, v23, v23 row_ror:8 row_mask:0xf bank_mask:0xc
    s_nop 0
    v_add_f32_dpp v26, v24, v24 row_shl:4 row_mask:0xf bank_mask:0x5
    v_add_f32_dpp v26, v25, v25 row_shr:4 row_mask:0xf bank_mask:0xa
    s_nop 1
    v_add_f32_dpp v26, v26, v26 quad_perm:[1,0,3,2] row_mask:0xf bank_mask:0xf
    s_nop 1
    v_add_f32_dpp v26, v26, v26 quad_perm:[2,3,0,1] row_mask:0xf bank_mask:0xf
    v_cvt_pk_bf16_f32 v26, v26, v26
    v_and_b32 v26, s98, v26
    v_mul_f32 v26, s96, v26
    v_cvt_pk_bf16_f32 v26, v26, v26
    v_and_b32 v26, s98, v26
    s_nop 1
    v_max_f32_dpp v27, v26, v26 row_ror:4 row_mask:0xf bank_mask:0xf
    s_nop 1
    v_max_f32_dpp v27, v27, v27 row_ror:8 row_mask:0xf bank_mask:0xf
    v_mov_b32 v28, v27
    s_nop 1
    v_permlane16_swap_b32 v27, v28
    v_max_f32 v27, v27, v28
    v_mov_b32 v28, v27
    s_nop 1
    v_permlane32_swap_b32 v27, v28
    v_max3_f32 v27, v27, v28, v16
    v_sub_f32 v28, v16, v27
    v_sub_f32 v29, v26, v27
    v_mul_f32 v28, s97, v28
    v_mul_f32 v29, s97, v29
    v_exp_f32 v28, v28
    v_exp_f32 v29, v29
    v_mov_b32 v16, v27
    v_fma_f32 v17, v17, v28, v29
    v_cvt_pk_bf16_f32 v29, v29, v29
    v_mul_f32 v12, v12, v28
    v_mul_f32 v13, v13, v28
    v_mul_f32 v14, v14, v28
    v_mul_f32 v15, v15, v28
    s_waitcnt vmcnt(16)
    v_and_b32_dpp v32, v29, v8 row_newbcast:0 row_mask:0xf bank_mask:0xf
    v_and_b32_dpp v33, v29, v9 row_newbcast:0 row_mask:0xf bank_mask:0xf
    v_and_b32_dpp v34, v29, v10 row_newbcast:0 row_mask:0xf bank_mask:0xf
    v_and_b32_dpp v35, v29, v11 row_newbcast:0 row_mask:0xf bank_mask:0xf
    v_and_b32_dpp v36, v29, v8 row_newbcast:8 row_mask:0xf bank_mask:0xf
    v_and_b32_dpp v37, v29, v9 row_newbcast:8 row_mask:0xf bank_mask:0xf
    v_and_b32_dpp v38, v29, v10 row_newbcast:8 row_mask:0xf bank_mask:0xf
    v_and_b32_dpp v39, v29, v11 row_newbcast:8 row_mask:0xf bank_mask:0xf
    v_and_b32_dpp v40, v29, v8 row_newbcast:4 row_mask:0xf bank_mask:0xf
    v_and_b32_dpp v41, v29, v9 row_newbcast:4 row_mask:0xf bank_mask:0xf
    v_and_b32_dpp v42, v29, v10 row_newbcast:4 row_mask:0xf bank_mask:0xf
    v_and_b32_dpp v43, v29, v11 row_newbcast:4 row_mask:0xf bank_mask:0xf
    v_and_b32_dpp v44, v29, v8 row_newbcast:12 row_mask:0xf bank_mask:0xf
    v_and_b32_dpp v45, v29, v9 row_newbcast:12 row_mask:0xf bank_mask:0xf
    v_and_b32_dpp v46, v29, v10 row_newbcast:12 row_mask:0xf bank_mask:0xf
    v_and_b32_dpp v47, v29, v11 row_newbcast:12 row_mask:0xf bank_mask:0xf
    v_mfma_f32_16x16x32_bf16 v[12:15], v[32:35], a[0:3], v[12:15]
    v_mfma_f32_16x16x32_bf16 v[12:15], v[36:39], a[4:7], v[12:15]
    v_mfma_f32_16x16x32_bf16 v[12:15], v[40:43], a[8:11], v[12:15]
    v_mfma_f32_16x16x32_bf16 v[12:15], v[44:47], a[12:15], v[12:15]
    s_nop 3
    s_branch L_adone2
L_adrain0:
    buffer_load_dwordx4 v[128:131], v19, s[40:43], s24 offen offset:0 nt
    buffer_load_dwordx4 v[132:135], v19, s[40:43], s24 offen offset:1152 nt
    buffer_load_dwordx4 v[136:139], v19, s[40:43], s24 offen offset:2304 nt
    buffer_load_dwordx4 v[140:143], v19, s[40:43], s24 offen offset:3456 nt
    s_add_u32 s24, s24, 4608
    buffer_load_dwordx4 v[144:147], v19, s[40:43], s24 offen offset:0 nt
    buffer_load_dwordx4 v[148:151], v19, s[40:43], s24 offen offset:1152 nt
    buffer_load_dwordx4 v[152:155], v19, s[40:43], s24 offen offset:2304 nt
    buffer_load_dwordx4 v[156:159], v19, s[40:43], s24 offen offset:3456 nt
    s_add_u32 s24, s24, 69120
    v_add_f32_dpp v24, v20, v20 row_ror:8 row_mask:0xf bank_mask:0x3
    v_add_f32_dpp v25, v22, v22 row_ror:8 row_mask:0xf bank_mask:0x3
    v_add_f32_dpp v24, v21, v21 row_ror:8 row_mask:0xf bank_mask:0xc
    v_add_f32_dpp v25, v23, v23 row_ror:8 row_mask:0xf bank_mask:0xc
    s_nop 0
    v_add_f32_dpp v26, v24, v24 row_shl:4 row_mask:0xf bank_mask:0x5
    v_add_f32_dpp v26, v25, v25 row_shr:4 row_mask:0xf bank_mask:0xa
    s_nop 1
    v_add_f32_dpp v26, v26, v26 quad_perm:[1,0,3,2] row_mask:0xf bank_mask:0xf
    s_nop 1
    v_add_f32_dpp v26, v26, v26 quad_perm:[2,3,0,1] row_mask:0xf bank_mask:0xf
    v_cvt_pk_bf16_f32 v26, v26, v26
    v_and_b32 v26, s98, v26
    v_mul_f32 v26, s96, v26
    v_cvt_pk_bf16_f32 v26, v26, v26
    v_and_b32 v26, s98, v26
    s_nop 1
    v_max_f32_dpp v27, v26, v26 row_ror:4 row_mask:0xf bank_mask:0xf
    s_nop 1
    v_max_f32_dpp v27, v27, v27 row_ror:8 row_mask:0xf bank_mask:0xf
    v_mov_b32 v28, v27
    s_nop 1
    v_permlane16_swap_b32 v27, v28
    v_max_f32 v27, v27, v28
    v_mov_b32 v28, v27
    s_nop 1
    v_permlane32_swap_b32 v27, v28
    v_max3_f32 v27, v27, v28, v16
    v_sub_f32 v28, v16, v27
    v_sub_f32 v29, v26, v27
    v_mul_f32 v28, s97, v28
    v_mul_f32 v29, s97, v29
    v_exp_f32 v28, v28
    v_exp_f32 v29, v29
    v_mov_b32 v16, v27
    v_fma_f32 v17, v17, v28, v29
    v_cvt_pk_bf16_f32 v29, v29, v29
    v_mul_f32 v12, v12, v28
    v_mul_f32 v13, v13, v28
    v_mul_f32 v14, v14, v28
    v_mul_f32 v15, v15, v28
    s_waitcnt vmcnt(16)
    v_and_b32_dpp v32, v29, v8 row_newbcast:0 row_mask:0xf bank_mask:0xf
    v_and_b32_dpp v33, v29, v9 row_newbcast:0 row_mask:0xf bank_mask:0xf
    v_and_b32_dpp v34, v29, v10 row_newbcast:0 row_mask:0xf bank_mask:0xf
    v_and_b32_dpp v35, v29, v11 row_newbcast:0 row_mask:0xf bank_mask:0xf
    v_and_b32_dpp v36, v29, v8 row_newbcast:8 row_mask:0xf bank_mask:0xf
    v_and_b32_dpp v37, v29, v9 row_newbcast:8 row_mask:0xf bank_mask:0xf
    v_and_b32_dpp v38, v29, v10 row_newbcast:8 row_mask:0xf bank_mask:0xf
    v_and_b32_dpp v39, v29, v11 row_newbcast:8 row_mask:0xf bank_mask:0xf
    v_and_b32_dpp v40, v29, v8 row_newbcast:4 row_mask:0xf bank_mask:0xf
    v_and_b32_dpp v41, v29, v9 row_newbcast:4 row_mask:0xf bank_mask:0xf
    v_and_b32_dpp v42, v29, v10 row_newbcast:4 row_mask:0xf bank_mask:0xf
    v_and_b32_dpp v43, v29, v11 row_newbcast:4 row_mask:0xf bank_mask:0xf
    v_and_b32_dpp v44, v29, v8 row_newbcast:12 row_mask:0xf bank_mask:0xf
    v_and_b32_dpp v45, v29, v9 row_newbcast:12 row_mask:0xf bank_mask:0xf
    v_and_b32_dpp v46, v29, v10 row_newbcast:12 row_mask:0xf bank_mask:0xf
    v_and_b32_dpp v47, v29, v11 row_newbcast:12 row_mask:0xf bank_mask:0xf
    v_mfma_f32_16x16x32_bf16 v[12:15], v[32:35], a[0:3], v[12:15]
    v_mfma_f32_16x16x32_bf16 v[12:15], v[36:39], a[4:7], v[12:15]
    v_mfma_f32_16x16x32_bf16 v[12:15], v[40:43], a[8:11], v[12:15]
    v_mfma_f32_16x16x32_bf16 v[12:15], v[44:47], a[12:15], v[12:15]
    s_waitcnt vmcnt(12)
    v_dot2_f32_bf16 v20, v80, v4, 0
    v_dot2_f32_bf16 v21, v84, v4, 0
    v_dot2_f32_bf16 v22, v88, v4, 0
    v_dot2_f32_bf16 v23, v92, v4, 0
    v_dot2_f32_bf16 v20, v81, v5, v20
    v_dot2_f32_bf16 v21, v85, v5, v21
    v_dot2_f32_bf16 v22, v89, v5, v22
    v_dot2_f32_bf16 v23, v93, v5, v23
    v_dot2_f32_bf16 v20, v82, v6, v20
    v_dot2_f32_bf16 v21, v86, v6, v21
    v_dot2_f32_bf16 v22, v90, v6, v22
    v_dot2_f32_bf16 v23, v94, v6, v23
    v_dot2_f32_bf16 v20, v83, v7, v20
    v_dot2_f32_bf16 v21, v87, v7, v21
    v_dot2_f32_bf16 v22, v91, v7, v22
    v_dot2_f32_bf16 v23, v95, v7, v23
    buffer_load_dwordx4 v[160:163], v19, s[40:43], s24 offen offset:0 nt
    buffer_load_dwordx4 v[164:167], v19, s[40:43], s24 offen offset:1152 nt
    buffer_load_dwordx4 v[168:171], v19, s[40:43], s24 offen offset:2304 nt
    buffer_load_dwordx4 v[172:175], v19, s[40:43], s24 offen offset:3456 nt
    s_add_u32 s24, s24, 4608
    buffer_load_dwordx4 v[176:179], v19, s[40:43], s24 offen offset:0 nt
    buffer_load_dwordx4 v[180:183], v19, s[40:43], s24 offen offset:1152 nt
    buffer_load_dwordx4 v[184:187], v19, s[40:43], s24 offen offset:2304 nt
    buffer_load_dwordx4 v[188:191], v19, s[40:43], s24 offen offset:3456 nt
    v_add_f32_dpp v24, v20, v20 row_ror:8 row_mask:0xf bank_mask:0x3
    v_add_f32_dpp v25, v22, v22 row_ror:8 row_mask:0xf bank_mask:0x3
    v_add_f32_dpp v24, v21, v21 row_ror:8 row_mask:0xf bank_mask:0xc
    v_add_f32_dpp v25, v23, v23 row_ror:8 row_mask:0xf bank_mask:0xc
    s_nop 0
    v_add_f32_dpp v26, v24, v24 row_shl:4 row_mask:0xf bank_mask:0x5
    v_add_f32_dpp v26, v25, v25 row_shr:4 row_mask:0xf bank_mask:0xa
    s_nop 1
    v_add_f32_dpp v26, v26, v26 quad_perm:[1,0,3,2] row_mask:0xf bank_mask:0xf
    s_nop 1
    v_add_f32_dpp v26, v26, v26 quad_perm:[2,3,0,1] row_mask:0xf bank_mask:0xf
    v_cvt_pk_bf16_f32 v26, v26, v26
    v_and_b32 v26, s98, v26
    v_mul_f32 v26, s96, v26
    v_cvt_pk_bf16_f32 v26, v26, v26
    v_and_b32 v26, s98, v26
    s_nop 1
    v_max_f32_dpp v27, v26, v26 row_ror:4 row_mask:0xf bank_mask:0xf
    s_nop 1
    v_max_f32_dpp v27, v27, v27 row_ror:8 row_mask:0xf bank_mask:0xf
    v_mov_b32 v28, v27
    s_nop 1
    v_permlane16_swap_b32 v27, v28
    v_max_f32 v27, v27, v28
    v_mov_b32 v28, v27
    s_nop 1
    v_permlane32_swap_b32 v27, v28
    v_max3_f32 v27, v27, v28, v16
    v_sub_f32 v28, v16, v27
    v_sub_f32 v29, v26, v27
    v_mul_f32 v28, s97, v28
    v_mul_f32 v29, s97, v29
    v_exp_f32 v28, v28
    v_exp_f32 v29, v29
    v_mov_b32 v16, v27
    v_fma_f32 v17, v17, v28, v29
    v_cvt_pk_bf16_f32 v29, v29, v29
    v_mul_f32 v12, v12, v28
    v_mul_f32 v13, v13, v28
    v_mul_f32 v14, v14, v28
    v_mul_f32 v15, v15, v28
    s_waitcnt vmcnt(16)
    v_and_b32_dpp v32, v29, v8 row_newbcast:0 row_mask:0xf bank_mask:0xf
    v_and_b32_dpp v33, v29, v9 row_newbcast:0 row_mask:0xf bank_mask:0xf
    v_and_b32_dpp v34, v29, v10 row_newbcast:0 row_mask:0xf bank_mask:0xf
    v_and_b32_dpp v35, v29, v11 row_newbcast:0 row_mask:0xf bank_mask:0xf
    v_and_b32_dpp v36, v29, v8 row_newbcast:8 row_mask:0xf bank_mask:0xf
    v_and_b32_dpp v37, v29, v9 row_newbcast:8 row_mask:0xf bank_mask:0xf
    v_and_b32_dpp v38, v29, v10 row_newbcast:8 row_mask:0xf bank_mask:0xf
    v_and_b32_dpp v39, v29, v11 row_newbcast:8 row_mask:0xf bank_mask:0xf
    v_and_b32_dpp v40, v29, v8 row_newbcast:4 row_mask:0xf bank_mask:0xf
    v_and_b32_dpp v41, v29, v9 row_newbcast:4 row_mask:0xf bank_mask:0xf
    v_and_b32_dpp v42, v29, v10 row_newbcast:4 row_mask:0xf bank_mask:0xf
    v_and_b32_dpp v43, v29, v11 row_newbcast:4 row_mask:0xf bank_mask:0xf
    v_and_b32_dpp v44, v29, v8 row_newbcast:12 row_mask:0xf bank_mask:0xf
    v_and_b32_dpp v45, v29, v9 row_newbcast:12 row_mask:0xf bank_mask:0xf
    v_and_b32_dpp v46, v29, v10 row_newbcast:12 row_mask:0xf bank_mask:0xf
    v_and_b32_dpp v47, v29, v11 row_newbcast:12 row_mask:0xf bank_mask:0xf
    v_mfma_f32_16x16x32_bf16 v[12:15], v[32:35], a[16:19], v[12:15]
    v_mfma_f32_16x16x32_bf16 v[12:15], v[36:39], a[20:23], v[12:15]
    v_mfma_f32_16x16x32_bf16 v[12:15], v[40:43], a[24:27], v[12:15]
    v_mfma_f32_16x16x32_bf16 v[12:15], v[44:47], a[28:31], v[12:15]
    s_mov_b32 s62, 0
L_adone:
    s_cmp_eq_u32 s13, 0
    s_cbranch_scc1 L_aswitch
L_adone2:
    v_add_f32_dpp v17, v17, v17 row_ror:4 row_mask:0xf bank_mask:0xf
    s_nop 1
    v_add_f32_dpp v17, v17, v17 row_ror:8 row_mask:0xf bank_mask:0xf
    v_mov_b32 v28, v17
    s_nop 1
    v_permlane16_swap_b32 v17, v28
    v_add_f32 v17, v17, v28
    v_mov_b32 v28, v17
    s_nop 1
    v_permlane32_swap_b32 v17, v28
    v_add_f32 v17, v17, v28
    v_cvt_pk_bf16_f32 v54, v12, v13
    v_cvt_pk_bf16_f32 v55, v14, v15
    v_cmp_gt_u32 vcc, 48, v1
    s_nop 1
    v_cndmask_b32 v16, v16, v50, vcc
    v_cndmask_b32 v17, v17, v51, vcc
    v_permlane16_swap_b32 v52, v54
    v_permlane16_swap_b32 v53, v55
    v_cmp_gt_u32 vcc, 32, v1
    s_nop 1
    v_cndmask_b32 v52, v16, v52, vcc
    v_cndmask_b32 v53, v17, v53, vcc
    v_cndmask_b32 v54, v16, v54, vcc
    v_cndmask_b32 v55, v17, v55, vcc
    v_min_u32 v52, -2, v52
    v_min_u32 v53, -2, v53
    v_min_u32 v54, -2, v54
    v_min_u32 v55, -2, v55
    s_mov_b32 s54, 8388608
    buffer_store_dwordx4 v[52:55], v3, s[44:47], s54 offen sc1
    s_barrier
    s_mov_b32 s58, s22
    s_add_u32 s59, s22, 4096
    s_cmp_eq_u32 s23, 2
    s_cbranch_scc1 L_eshared
    s_cmp_lg_u32 s23, 0
    s_cbranch_scc1 L_epiB
    buffer_load_dwordx4 v[40:43], v30, s[44:47], s58 offen sc1
    buffer_load_dwordx4 v[192:195], v2, s[44:47], s58 offen offset:0 sc1
    buffer_load_dwordx4 v[196:199], v2, s[44:47], s58 offen offset:1024 sc1
    v_and_b32 v3, 15, v1
    v_lshrrev_b32 v4, 4, v1
    s_mov_b32 s60, 0x05040100
    s_mov_b32 s61, 0x07060302
    v_mul_u32_u24 v0, 73728, v4
    v_bfe_u32 v5, v1, 2, 1
    v_lshl_add_u32 v0, v5, 12, v0
    v_and_b32 v5, 3, v1
    v_lshl_add_u32 v0, v5, 5, v0
    v_bfe_u32 v5, v1, 3, 1
    v_lshl_add_u32 v0, v5, 4, v0
    s_lshl_b32 s54, s3, 9
    v_lshl_add_u32 v5, v3, 4, s54
    v_and_b32 v6, 1, v4
    v_lshl_add_u32 v5, v6, 3, v5
    v_lshrrev_b32 v6, 1, v4
    v_lshl_add_u32 v5, v6, 8, v5
    v_lshrrev_b32 v7, 2, v3
    v_lshlrev_b32 v7, 9, v7
    v_lshl_add_u32 v7, v4, 4, v7
    v_and_b32 v6, 1, v1
    v_lshl_add_u32 v7, v6, 6, v7
    v_and_b32 v6, 1, v3
    v_cmp_gt_u32 s[20:21], 2, v6
    s_waitcnt vmcnt(17)
    v_perm_b32 v64, v132, v128, s60
    v_perm_b32 v68, v132, v128, s61
    v_perm_b32 v72, v133, v129, s60
    v_perm_b32 v76, v133, v129, s61
    v_perm_b32 v80, v134, v130, s60
    v_perm_b32 v84, v134, v130, s61
    v_perm_b32 v88, v135, v131, s60
    v_perm_b32 v92, v135, v131, s61
    s_waitcnt vmcnt(15)
    v_perm_b32 v65, v140, v136, s60
    v_perm_b32 v69, v140, v136, s61
    v_perm_b32 v73, v141, v137, s60
    v_perm_b32 v77, v141, v137, s61
    v_perm_b32 v81, v142, v138, s60
    v_perm_b32 v85, v142, v138, s61
    v_perm_b32 v89, v143, v139, s60
    v_perm_b32 v93, v143, v139, s61
    s_waitcnt vmcnt(13)
    v_perm_b32 v66, v148, v144, s60
    v_perm_b32 v70, v148, v144, s61
    v_perm_b32 v74, v149, v145, s60
    v_perm_b32 v78, v149, v145, s61
    v_perm_b32 v82, v150, v146, s60
    v_perm_b32 v86, v150, v146, s61
    v_perm_b32 v90, v151, v147, s60
    v_perm_b32 v94, v151, v147, s61
    s_waitcnt vmcnt(11)
    v_perm_b32 v67, v156, v152, s60
    v_perm_b32 v71, v156, v152, s61
    v_perm_b32 v75, v157, v153, s60
    v_perm_b32 v79, v157, v153, s61
    v_perm_b32 v83, v158, v154, s60
    v_perm_b32 v87, v158, v154, s61
    v_perm_b32 v91, v159, v155, s60
    v_perm_b32 v95, v159, v155, s61
    s_waitcnt vmcnt(9)
    v_perm_b32 v96, v164, v160, s60
    v_perm_b32 v100, v164, v160, s61
    v_perm_b32 v104, v165, v161, s60
    v_perm_b32 v108, v165, v161, s61
    v_perm_b32 v112, v166, v162, s60
    v_perm_b32 v116, v166, v162, s61
    v_perm_b32 v120, v167, v163, s60
    v_perm_b32 v124, v167, v163, s61
    s_waitcnt vmcnt(7)
    v_perm_b32 v97, v172, v168, s60
    v_perm_b32 v101, v172, v168, s61
    v_perm_b32 v105, v173, v169, s60
    v_perm_b32 v109, v173, v169, s61
    v_perm_b32 v113, v174, v170, s60
    v_perm_b32 v117, v174, v170, s61
    v_perm_b32 v121, v175, v171, s60
    v_perm_b32 v125, v175, v171, s61
    s_waitcnt vmcnt(5)
    v_perm_b32 v98, v180, v176, s60
    v_perm_b32 v102, v180, v176, s61
    v_perm_b32 v106, v181, v177, s60
    v_perm_b32 v110, v181, v177, s61
    v_perm_b32 v114, v182, v178, s60
    v_perm_b32 v118, v182, v178, s61
    v_perm_b32 v122, v183, v179, s60
    v_perm_b32 v126, v183, v179, s61
    s_waitcnt vmcnt(3)
    v_perm_b32 v99, v188, v184, s60
    v_perm_b32 v103, v188, v184, s61
    v_perm_b32 v107, v189, v185, s60
    v_perm_b32 v111, v189, v185, s61
    v_perm_b32 v115, v190, v186, s60
    v_perm_b32 v119, v190, v186, s61
    v_perm_b32 v123, v191, v187, s60
    v_perm_b32 v127, v191, v187, s61
    s_waitcnt vmcnt(0)
    s_branch L_mpoll_13_c
L_mpoll_13:
    s_mov_b64 exec, s[4:5]
    buffer_load_dwordx4 v[40:43], v30, s[44:47], s58 offen sc1
    s_mov_b64 exec, s[6:7]
    buffer_load_dwordx4 v[192:195], v2, s[44:47], s58 offen offset:0 sc1
    s_mov_b64 exec, s[8:9]
    buffer_load_dwordx4 v[196:199], v2, s[44:47], s58 offen offset:1024 sc1
    s_mov_b64 exec, -1
    s_waitcnt vmcnt(3)
L_mpoll_13_c:
    v_max3_u32 v236, v40, v41, v42
    v_max3_u32 v237, v192, v193, v194
    v_max3_u32 v238, v196, v197, v198
    v_max_u32 v236, v236, v43
    v_max_u32 v237, v237, v195
    v_max_u32 v238, v238, v199
    v_cmp_eq_u32 s[4:5], -1, v236
    v_cmp_eq_u32 s[6:7], -1, v237
    v_cmp_eq_u32 s[8:9], -1, v238
    s_or_b64 vcc, s[4:5], s[6:7]
    s_or_b64 vcc, vcc, s[8:9]
    s_cbranch_scc0 L_mpollok_14
    s_sub_u32 s101, s101, 1
    s_cbranch_scc0 L_mpoll_13
    s_mov_b32 s101, 0
L_mpollok_14:
    v_max_f32_dpp v44, v40, v40 row_ror:1 row_mask:0xf bank_mask:0xf
    v_cndmask_b32 v47, 0, v41, s[20:21]
    v_mov_b32 v45, v44
    s_nop 1
    v_permlane16_swap_b32 v44, v45
    v_max_f32 v44, v44, v45
    v_mov_b32 v45, v44
    s_nop 1
    v_permlane32_swap_b32 v44, v45
    v_max_f32 v44, v44, v45
    v_sub_f32 v45, v40, v44
    v_mul_f32 v45, s97, v45
    v_exp_f32 v45, v45
    s_nop 0
    v_cvt_pk_bf16_f32 v46, v45, v45
    v_and_b32 v45, s98, v46
    v_mul_f32 v47, v47, v45
    v_and_b32_dpp v232, v46, v8 row_newbcast:0 row_mask:0xf bank_mask:0xf
    v_and_b32_dpp v233, v46, v9 row_newbcast:0 row_mask:0xf bank_mask:0xf
    v_add_f32_dpp v47, v47, v47 row_ror:1 row_mask:0xf bank_mask:0xf
    v_and_b32_dpp v234, v46, v10 row_newbcast:0 row_mask:0xf bank_mask:0xf
    v_and_b32_dpp v235, v46, v11 row_newbcast:0 row_mask:0xf bank_mask:0xf
    v_and_b32_dpp v236, v46, v8 row_newbcast:1 row_mask:0xf bank_mask:0xf
    v_mov_b32 v45, v47
    v_and_b32_dpp v237, v46, v9 row_newbcast:1 row_mask:0xf bank_mask:0xf
    v_and_b32_dpp v238, v46, v10 row_newbcast:1 row_mask:0xf bank_mask:0xf
    v_and_b32_dpp v239, v46, v11 row_newbcast:1 row_mask:0xf bank_mask:0xf
    v_permlane16_swap_b32 v47, v45
    v_mfma_f32_16x16x32_bf16 v[228:231], v[232:235], v[192:195], 0
    v_add_f32 v47, v47, v45
    v_mfma_f32_16x16x32_bf16 v[228:231], v[236:239], v[196:199], v[228:231]
    v_mov_b32 v45, v47
    s_nop 1
    v_permlane32_swap_b32 v47, v45
    v_add_f32 v47, v47, v45
    v_rcp_f32 v47, v47
    s_nop 1
    v_mul_f32 v228, v228, v47
    v_mul_f32 v229, v229, v47
    v_mul_f32 v230, v230, v47
    v_mul_f32 v231, v231, v47
    v_cvt_pk_bf16_f32 v224, v228, v229
    v_cvt_pk_bf16_f32 v225, v230, v231
    s_branch L_emerged
L_eshared:
    buffer_load_dwordx4 v[40:43], v30, s[44:47], s58 offen sc1
    buffer_load_dwordx4 v[192:195], v2, s[44:47], s58 offen offset:0 sc1
    buffer_load_dwordx4 v[196:199], v2, s[44:47], s58 offen offset:1024 sc1
    buffer_load_dwordx4 v[200:203], v2, s[44:47], s58 offen offset:2048 sc1
    buffer_load_dwordx4 v[204:207], v2, s[44:47], s58 offen offset:3072 sc1
    buffer_load_dwordx4 v[208:211], v2, s[44:47], s59 offen offset:0 sc1
    buffer_load_dwordx4 v[212:215], v2, s[44:47], s59 offen offset:1024 sc1
    v_and_b32 v3, 15, v1
    v_lshrrev_b32 v4, 4, v1
    s_mov_b32 s60, 0x05040100
    s_mov_b32 s61, 0x07060302
    v_mul_u32_u24 v0, 73728, v4
    v_bfe_u32 v5, v1, 2, 1
    v_lshl_add_u32 v0, v5, 12, v0
    v_and_b32 v5, 3, v1
    v_lshl_add_u32 v0, v5, 5, v0
    v_bfe_u32 v5, v1, 3, 1
    v_lshl_add_u32 v0, v5, 4, v0
    s_lshl_b32 s54, s3, 9
    v_lshl_add_u32 v5, v3, 4, s54
    v_and_b32 v6, 1, v4
    v_lshl_add_u32 v5, v6, 3, v5
    v_lshrrev_b32 v6, 1, v4
    v_lshl_add_u32 v5, v6, 8, v5
    v_lshrrev_b32 v7, 2, v3
    v_lshlrev_b32 v7, 9, v7
    v_lshl_add_u32 v7, v4, 4, v7
    v_and_b32 v6, 1, v1
    v_lshl_add_u32 v7, v6, 6, v7
    v_and_b32 v6, 7, v3
    v_cmp_gt_u32 s[20:21], 6, v6
    s_waitcnt vmcnt(21)
    v_perm_b32 v64, v132, v128, s60
    v_perm_b32 v68, v132, v128, s61
    v_perm_b32 v72, v133, v129, s60
    v_perm_b32 v76, v133, v129, s61
    v_perm_b32 v80, v134, v130, s60
    v_perm_b32 v84, v134, v130, s61
    v_perm_b32 v88, v135, v131, s60
    v_perm_b32 v92, v135, v131, s61
    s_waitcnt vmcnt(19)
    v_perm_b32 v65, v140, v136, s60
    v_perm_b32 v69, v140, v136, s61
    v_perm_b32 v73, v141, v137, s60
    v_perm_b32 v77, v141, v137, s61
    v_perm_b32 v81, v142, v138, s60
    v_perm_b32 v85, v142, v138, s61
    v_perm_b32 v89, v143, v139, s60
    v_perm_b32 v93, v143, v139, s61
    s_waitcnt vmcnt(17)
    v_perm_b32 v66, v148, v144, s60
    v_perm_b32 v70, v148, v144, s61
    v_perm_b32 v74, v149, v145, s60
    v_perm_b32 v78, v149, v145, s61
    v_perm_b32 v82, v150, v146, s60
    v_perm_b32 v86, v150, v146, s61
    v_perm_b32 v90, v151, v147, s60
    v_perm_b32 v94, v151, v147, s61
    s_waitcnt vmcnt(15)
    v_perm_b32 v67, v156, v152, s60
    v_perm_b32 v71, v156, v152, s61
    v_perm_b32 v75, v157, v153, s60
    v_perm_b32 v79, v157, v153, s61
    v_perm_b32 v83, v158, v154, s60
    v_perm_b32 v87, v158, v154, s61
    v_perm_b32 v91, v159, v155, s60
    v_perm_b32 v95, v159, v155, s61
    s_waitcnt vmcnt(13)
    v_perm_b32 v96, v164, v160, s60
    v_perm_b32 v100, v164, v160, s61
    v_perm_b32 v104, v165, v161, s60
    v_perm_b32 v108, v165, v161, s61
    v_perm_b32 v112, v166, v162, s60
    v_perm_b32 v116, v166, v162, s61
    v_perm_b32 v120, v167, v163, s60
    v_perm_b32 v124, v167, v163, s61
    s_waitcnt vmcnt(11)
    v_perm_b32 v97, v172, v168, s60
    v_perm_b32 v101, v172, v168, s61
    v_perm_b32 v105, v173, v169, s60
    v_perm_b32 v109, v173, v169, s61
    v_perm_b32 v113, v174, v170, s60
    v_perm_b32 v117, v174, v170, s61
    v_perm_b32 v121, v175, v171, s60
    v_perm_b32 v125, v175, v171, s61
    s_waitcnt vmcnt(9)
    v_perm_b32 v98, v180, v176, s60
    v_perm_b32 v102, v180, v176, s61
    v_perm_b32 v106, v181, v177, s60
    v_perm_b32 v110, v181, v177, s61
    v_perm_b32 v114, v182, v178, s60
    v_perm_b32 v118, v182, v178, s61
    v_perm_b32 v122, v183, v179, s60
    v_perm_b32 v126, v183, v179, s61
    s_waitcnt vmcnt(7)
    v_perm_b32 v99, v188, v184, s60
    v_perm_b32 v103, v188, v184, s61
    v_perm_b32 v107, v189, v185, s60
    v_perm_b32 v111, v189, v185, s61
    v_perm_b32 v115, v190, v186, s60
    v_perm_b32 v119, v190, v186, s61
    v_perm_b32 v123, v191, v187, s60
    v_perm_b32 v127, v191, v187, s61
    s_waitcnt vmcnt(0)
    s_branch L_mpoll_17_c
L_mpoll_17:
    s_mov_b64 exec, s[4:5]
    buffer_load_dwordx4 v[40:43], v30, s[44:47], s58 offen sc1
    s_mov_b64 exec, s[6:7]
    buffer_load_dwordx4 v[192:195], v2, s[44:47], s58 offen offset:0 sc1
    s_mov_b64 exec, s[8:9]
    buffer_load_dwordx4 v[196:199], v2, s[44:47], s58 offen offset:1024 sc1
    s_mov_b64 exec, s[10:11]
    buffer_load_dwordx4 v[200:203], v2, s[44:47], s58 offen offset:2048 sc1
    s_mov_b64 exec, s[12:13]
    buffer_load_dwordx4 v[204:207], v2, s[44:47], s58 offen offset:3072 sc1
    s_mov_b64 exec, s[14:15]
    buffer_load_dwordx4 v[208:211], v2, s[44:47], s59 offen offset:0 sc1
    s_mov_b64 exec, s[16:17]
    buffer_load_dwordx4 v[212:215], v2, s[44:47], s59 offen offset:1024 sc1
    s_mov_b64 exec, -1
    s_waitcnt vmcnt(7)
L_mpoll_17_c:
    v_max3_u32 v236, v40, v41, v42
    v_max3_u32 v237, v192, v193, v194
    v_max3_u32 v238, v196, v197, v198
    v_max3_u32 v239, v200, v201, v202
    v_max3_u32 v240, v204, v205, v206
    v_max3_u32 v241, v208, v209, v210
    v_max3_u32 v242, v212, v213, v214
    v_max_u32 v236, v236, v43
    v_max_u32 v237, v237, v195
    v_max_u32 v238, v238, v199
    v_max_u32 v239, v239, v203
    v_max_u32 v240, v240, v207
    v_max_u32 v241, v241, v211
    v_max_u32 v242, v242, v215
    v_cmp_eq_u32 s[4:5], -1, v236
    v_cmp_eq_u32 s[6:7], -1, v237
    v_cmp_eq_u32 s[8:9], -1, v238
    v_cmp_eq_u32 s[10:11], -1, v239
    v_cmp_eq_u32 s[12:13], -1, v240
    v_cmp_eq_u32 s[14:15], -1, v241
    v_cmp_eq_u32 s[16:17], -1, v242
    s_or_b64 vcc, s[4:5], s[6:7]
    s_or_b64 vcc, vcc, s[8:9]
    s_or_b64 vcc, vcc, s[10:11]
    s_or_b64 vcc, vcc, s[12:13]
    s_or_b64 vcc, vcc, s[14:15]
    s_or_b64 vcc, vcc, s[16:17]
    s_cbranch_scc0 L_mpollok_18
    s_sub_u32 s101, s101, 1
    s_cbranch_scc0 L_mpoll_17
    s_mov_b32 s101, 0
L_mpollok_18:
    v_max_f32_dpp v44, v40, v40 row_ror:1 row_mask:0xf bank_mask:0xf
    v_cndmask_b32 v47, 0, v41, s[20:21]
    s_nop 0
    v_max_f32_dpp v44, v44, v44 row_ror:2 row_mask:0xf bank_mask:0xf
    s_nop 1
    v_max_f32_dpp v44, v44, v44 row_ror:4 row_mask:0xf bank_mask:0xf
    v_mov_b32 v45, v44
    s_nop 1
    v_permlane16_swap_b32 v44, v45
    v_max_f32 v44, v44, v45
    v_mov_b32 v45, v44
    s_nop 1
    v_permlane32_swap_b32 v44, v45
    v_max_f32 v44, v44, v45
    v_sub_f32 v45, v40, v44
    v_mul_f32 v45, s97, v45
    v_exp_f32 v45, v45
    s_nop 0
    v_cvt_pk_bf16_f32 v46, v45, v45
    v_and_b32 v45, s98, v46
    v_mul_f32 v47, v47, v45
    v_and_b32_dpp v232, v46, v8 row_newbcast:0 row_mask:0xf bank_mask:0xf
    v_and_b32_dpp v233, v46, v9 row_newbcast:0 row_mask:0xf bank_mask:0xf
    v_add_f32_dpp v47, v47, v47 row_ror:1 row_mask:0xf bank_mask:0xf
    v_and_b32_dpp v234, v46, v10 row_newbcast:0 row_mask:0xf bank_mask:0xf
    v_and_b32_dpp v235, v46, v11 row_newbcast:0 row_mask:0xf bank_mask:0xf
    v_and_b32_dpp v236, v46, v8 row_newbcast:1 row_mask:0xf bank_mask:0xf
    v_and_b32_dpp v237, v46, v9 row_newbcast:1 row_mask:0xf bank_mask:0xf
    v_add_f32_dpp v47, v47, v47 row_ror:2 row_mask:0xf bank_mask:0xf
    v_and_b32_dpp v238, v46, v10 row_newbcast:1 row_mask:0xf bank_mask:0xf
    v_and_b32_dpp v239, v46, v11 row_newbcast:1 row_mask:0xf bank_mask:0xf
    v_mfma_f32_16x16x32_bf16 v[228:231], v[232:235], v[192:195], 0
    v_and_b32_dpp v240, v46, v8 row_newbcast:2 row_mask:0xf bank_mask:0xf
    v_add_f32_dpp v47, v47, v47 row_ror:4 row_mask:0xf bank_mask:0xf
    v_and_b32_dpp v241, v46, v9 row_newbcast:2 row_mask:0xf bank_mask:0xf
    v_and_b32_dpp v242, v46, v10 row_newbcast:2 row_mask:0xf bank_mask:0xf
    v_and_b32_dpp v243, v46, v11 row_newbcast:2 row_mask:0xf bank_mask:0xf
    v_mfma_f32_16x16x32_bf16 v[228:231], v[236:239], v[196:199], v[228:231]
    v_mov_b32 v45, v47
    v_and_b32_dpp v244, v46, v8 row_newbcast:3 row_mask:0xf bank_mask:0xf
    v_and_b32_dpp v245, v46, v9 row_newbcast:3 row_mask:0xf bank_mask:0xf
    v_and_b32_dpp v246, v46, v10 row_newbcast:3 row_mask:0xf bank_mask:0xf
    v_and_b32_dpp v247, v46, v11 row_newbcast:3 row_mask:0xf bank_mask:0xf
    v_permlane16_swap_b32 v47, v45
    v_mfma_f32_16x16x32_bf16 v[228:231], v[240:243], v[200:203], v[228:231]
    v_and_b32_dpp v248, v46, v8 row_newbcast:4 row_mask:0xf bank_mask:0xf
    v_and_b32_dpp v249, v46, v9 row_newbcast:4 row_mask:0xf bank_mask:0xf
    v_and_b32_dpp v250, v46, v10 row_newbcast:4 row_mask:0xf bank_mask:0xf
    v_add_f32 v47, v47, v45
    v_and_b32_dpp v251, v46, v11 row_newbcast:4 row_mask:0xf bank_mask:0xf
    v_mfma_f32_16x16x32_bf16 v[228:231], v[244:247], v[204:207], v[228:231]
    v_and_b32_dpp v252, v46, v8 row_newbcast:5 row_mask:0xf bank_mask:0xf
    v_and_b32_dpp v253, v46, v9 row_newbcast:5 row_mask:0xf bank_mask:0xf
    v_mov_b32 v45, v47
    v_and_b32_dpp v254, v46, v10 row_newbcast:5 row_mask:0xf bank_mask:0xf
    v_and_b32_dpp v255, v46, v11 row_newbcast:5 row_mask:0xf bank_mask:0xf
    v_mfma_f32_16x16x32_bf16 v[228:231], v[248:251], v[208:211], v[228:231]
    v_permlane32_swap_b32 v47, v45
    v_add_f32 v47, v47, v45
    v_mfma_f32_16x16x32_bf16 v[228:231], v[252:255], v[212:215], v[228:231]
    v_rcp_f32 v47, v47
    s_nop 6
    v_mul_f32 v228, v228, v47
    v_mul_f32 v229, v229, v47
    v_mul_f32 v230, v230, v47
    v_mul_f32 v231, v231, v47
    v_cvt_pk_bf16_f32 v224, v228, v229
    v_cvt_pk_bf16_f32 v225, v230, v231
L_emerged:
    ds_write_b64 v5, v[224:225]
    s_cmp_eq_u32 s3, 3
    s_waitcnt lgkmcnt(0)
    s_barrier
    s_cbranch_scc1 L_eendA
    ds_read_b128 v[48:51], v7 offset:0
    ds_read_b128 v[52:55], v7 offset:128
    s_waitcnt lgkmcnt(1)
    v_mfma_f32_16x16x32_bf16 v[224:227], v[48:51], v[64:67], 0
    v_mfma_f32_16x16x32_bf16 v[228:231], v[48:51], v[68:71], 0
    v_mfma_f32_16x16x32_bf16 v[232:235], v[48:51], v[72:75], 0
    v_mfma_f32_16x16x32_bf16 v[236:239], v[48:51], v[76:79], 0
    v_mfma_f32_16x16x32_bf16 v[240:243], v[48:51], v[80:83], 0
    v_mfma_f32_16x16x32_bf16 v[244:247], v[48:51], v[84:87], 0
    v_mfma_f32_16x16x32_bf16 v[248:251], v[48:51], v[88:91], 0
    v_mfma_f32_16x16x32_bf16 v[252:255], v[48:51], v[92:95], 0
    s_waitcnt lgkmcnt(0)
    v_mfma_f32_16x16x32_bf16 v[224:227], v[52:55], v[96:99], v[224:227]
    s_nop 1
    v_mfma_f32_16x16x32_bf16 v[228:231], v[52:55], v[100:103], v[228:231]
    s_nop 1
    v_mfma_f32_16x16x32_bf16 v[232:235], v[52:55], v[104:107], v[232:235]
    s_nop 1
    v_mfma_f32_16x16x32_bf16 v[236:239], v[52:55], v[108:111], v[236:239]
    s_nop 0
    v_add_f32_dpp v56, v225, v224 row_ror:8 row_mask:0xf bank_mask:0x3
    v_mfma_f32_16x16x32_bf16 v[240:243], v[52:55], v[112:115], v[240:243]
    s_nop 0
    v_add_f32_dpp v57, v229, v228 row_ror:8 row_mask:0xf bank_mask:0x3
    v_mfma_f32_16x16x32_bf16 v[244:247], v[52:55], v[116:119], v[244:247]
    s_nop 0
    v_add_f32_dpp v58, v233, v232 row_ror:8 row_mask:0xf bank_mask:0x3
    v_mfma_f32_16x16x32_bf16 v[248:251], v[52:55], v[120:123], v[248:251]
    s_nop 0
    v_add_f32_dpp v59, v237, v236 row_ror:8 row_mask:0xf bank_mask:0x3
    v_mfma_f32_16x16x32_bf16 v[252:255], v[52:55], v[124:127], v[252:255]
    s_nop 0
    v_add_f32_dpp v56, v240, v241 row_ror:8 row_mask:0xf bank_mask:0xc
    v_add_f32_dpp v57, v244, v245 row_ror:8 row_mask:0xf bank_mask:0xc
    v_min_u32 v56, -2, v56
    s_nop 0
    v_add_f32_dpp v58, v248, v249 row_ror:8 row_mask:0xf bank_mask:0xc
    v_min_u32 v57, -2, v57
    s_nop 0
    v_add_f32_dpp v59, v252, v253 row_ror:8 row_mask:0xf bank_mask:0xc
    v_min_u32 v58, -2, v58
    v_min_u32 v59, -2, v59
    buffer_store_dwordx4 v[56:59], v0, s[44:47], s25 offen sc1
L_eendA:
    s_endpgm
L_epiB:
    s_cmp_eq_u32 s3, 3
    s_cbranch_scc1 L_eendB
    v_bfe_u32 v6, v1, 2, 2
    v_lshlrev_b32 v6, 6, v6
    v_and_b32 v5, 48, v1
    v_add_u32 v6, v6, v5
    v_and_b32 v5, 1, v1
    v_lshl_add_u32 v6, v5, 8, v6
    buffer_load_dwordx4 v[48:51], v6, s[44:47], s27 offen offset:0 sc1
    buffer_load_dwordx4 v[52:55], v6, s[44:47], s27 offen offset:512 sc1
    v_and_b32 v3, 15, v1
    v_lshrrev_b32 v4, 4, v1
    s_mov_b32 s60, 0x05040100
    s_mov_b32 s61, 0x07060302
    v_mul_u32_u24 v0, 73728, v4
    v_bfe_u32 v5, v1, 2, 1
    v_lshl_add_u32 v0, v5, 12, v0
    v_and_b32 v5, 3, v1
    v_lshl_add_u32 v0, v5, 5, v0
    v_bfe_u32 v5, v1, 3, 1
    v_lshl_add_u32 v0, v5, 4, v0
    s_waitcnt vmcnt(16)
    v_perm_b32 v64, v132, v128, s60
    v_perm_b32 v68, v132, v128, s61
    v_perm_b32 v72, v133, v129, s60
    v_perm_b32 v76, v133, v129, s61
    v_perm_b32 v80, v134, v130, s60
    v_perm_b32 v84, v134, v130, s61
    v_perm_b32 v88, v135, v131, s60
    v_perm_b32 v92, v135, v131, s61
    s_waitcnt vmcnt(14)
    v_perm_b32 v65, v140, v136, s60
    v_perm_b32 v69, v140, v136, s61
    v_perm_b32 v73, v141, v137, s60
    v_perm_b32 v77, v141, v137, s61
    v_perm_b32 v81, v142, v138, s60
    v_perm_b32 v85, v142, v138, s61
    v_perm_b32 v89, v143, v139, s60
    v_perm_b32 v93, v143, v139, s61
    s_waitcnt vmcnt(12)
    v_perm_b32 v66, v148, v144, s60
    v_perm_b32 v70, v148, v144, s61
    v_perm_b32 v74, v149, v145, s60
    v_perm_b32 v78, v149, v145, s61
    v_perm_b32 v82, v150, v146, s60
    v_perm_b32 v86, v150, v146, s61
    v_perm_b32 v90, v151, v147, s60
    v_perm_b32 v94, v151, v147, s61
    s_waitcnt vmcnt(10)
    v_perm_b32 v67, v156, v152, s60
    v_perm_b32 v71, v156, v152, s61
    v_perm_b32 v75, v157, v153, s60
    v_perm_b32 v79, v157, v153, s61
    v_perm_b32 v83, v158, v154, s60
    v_perm_b32 v87, v158, v154, s61
    v_perm_b32 v91, v159, v155, s60
    v_perm_b32 v95, v159, v155, s61
    s_waitcnt vmcnt(8)
    v_perm_b32 v96, v164, v160, s60
    v_perm_b32 v100, v164, v160, s61
    v_perm_b32 v104, v165, v161, s60
    v_perm_b32 v108, v165, v161, s61
    v_perm_b32 v112, v166, v162, s60
    v_perm_b32 v116, v166, v162, s61
    v_perm_b32 v120, v167, v163, s60
    v_perm_b32 v124, v167, v163, s61
    s_waitcnt vmcnt(6)
    v_perm_b32 v97, v172, v168, s60
    v_perm_b32 v101, v172, v168, s61
    v_perm_b32 v105, v173, v169, s60
    v_perm_b32 v109, v173, v169, s61
    v_perm_b32 v113, v174, v170, s60
    v_perm_b32 v117, v174, v170, s61
    v_perm_b32 v121, v175, v171, s60
    v_perm_b32 v125, v175, v171, s61
    s_waitcnt vmcnt(4)
    v_perm_b32 v98, v180, v176, s60
    v_perm_b32 v102, v180, v176, s61
    v_perm_b32 v106, v181, v177, s60
    v_perm_b32 v110, v181, v177, s61
    v_perm_b32 v114, v182, v178, s60
    v_perm_b32 v118, v182, v178, s61
    v_perm_b32 v122, v183, v179, s60
    v_perm_b32 v126, v183, v179, s61
    s_waitcnt vmcnt(2)
    v_perm_b32 v99, v188, v184, s60
    v_perm_b32 v103, v188, v184, s61
    v_perm_b32 v107, v189, v185, s60
    v_perm_b32 v111, v189, v185, s61
    v_perm_b32 v115, v190, v186, s60
    v_perm_b32 v119, v190, v186, s61
    v_perm_b32 v123, v191, v187, s60
    v_perm_b32 v127, v191, v187, s61
    s_waitcnt vmcnt(0)
    s_branch L_mpoll_19_c
L_mpoll_19:
    s_mov_b64 exec, s[4:5]
    buffer_load_dwordx4 v[48:51], v6, s[44:47], s27 offen offset:0 sc1
    s_mov_b64 exec, s[6:7]
    buffer_load_dwordx4 v[52:55], v6, s[44:47], s27 offen offset:512 sc1
    s_mov_b64 exec, -1
    s_waitcnt vmcnt(0)
L_mpoll_19_c:
    v_max3_u32 v236, v48, v49, v50
    v_max3_u32 v237, v52, v53, v54
    v_max_u32 v236, v236, v51
    v_max_u32 v237, v237, v55
    v_cmp_eq_u32 s[4:5], -1, v236
    v_cmp_eq_u32 s[6:7], -1, v237
    s_nop 0
    s_or_b64 vcc, s[4:5], s[6:7]
    s_cbranch_scc0 L_mpollok_20
    s_sub_u32 s101, s101, 1
    s_cbranch_scc0 L_mpoll_19
    s_mov_b32 s101, 0
L_mpollok_20:
    v_mfma_f32_16x16x32_bf16 v[224:227], v[48:51], v[64:67], 0
    v_mfma_f32_16x16x32_bf16 v[228:231], v[48:51], v[68:71], 0
    v_mfma_f32_16x16x32_bf16 v[232:235], v[48:51], v[72:75], 0
    v_mfma_f32_16x16x32_bf16 v[236:239], v[48:51], v[76:79], 0
    v_mfma_f32_16x16x32_bf16 v[240:243], v[48:51], v[80:83], 0
    v_mfma_f32_16x16x32_bf16 v[244:247], v[48:51], v[84:87], 0
    v_mfma_f32_16x16x32_bf16 v[248:251], v[48:51], v[88:91], 0
    v_mfma_f32_16x16x32_bf16 v[252:255], v[48:51], v[92:95], 0
    v_mfma_f32_16x16x32_bf16 v[224:227], v[52:55], v[96:99], v[224:227]
    s_nop 1
    v_mfma_f32_16x16x32_bf16 v[228:231], v[52:55], v[100:103], v[228:231]
    s_nop 1
    v_mfma_f32_16x16x32_bf16 v[232:235], v[52:55], v[104:107], v[232:235]
    s_nop 1
    v_mfma_f32_16x16x32_bf16 v[236:239], v[52:55], v[108:111], v[236:239]
    s_nop 0
    v_add_f32_dpp v56, v225, v224 row_ror:8 row_mask:0xf bank_mask:0x3
    v_mfma_f32_16x16x32_bf16 v[240:243], v[52:55], v[112:115], v[240:243]
    s_nop 0
    v_add_f32_dpp v57, v229, v228 row_ror:8 row_mask:0xf bank_mask:0x3
    v_mfma_f32_16x16x32_bf16 v[244:247], v[52:55], v[116:119], v[244:247]
    s_nop 0
    v_add_f32_dpp v58, v233, v232 row_ror:8 row_mask:0xf bank_mask:0x3
    v_mfma_f32_16x16x32_bf16 v[248:251], v[52:55], v[120:123], v[248:251]
    s_nop 0
    v_add_f32_dpp v59, v237, v236 row_ror:8 row_mask:0xf bank_mask:0x3
    v_mfma_f32_16x16x32_bf16 v[252:255], v[52:55], v[124:127], v[252:255]
    s_nop 0
    v_add_f32_dpp v56, v240, v241 row_ror:8 row_mask:0xf bank_mask:0xc
    v_add_f32_dpp v57, v244, v245 row_ror:8 row_mask:0xf bank_mask:0xc
    v_min_u32 v56, -2, v56
    s_nop 0
    v_add_f32_dpp v58, v248, v249 row_ror:8 row_mask:0xf bank_mask:0xc
    v_min_u32 v57, -2, v57
    s_nop 0
    v_add_f32_dpp v59, v252, v253 row_ror:8 row_mask:0xf bank_mask:0xc
    v_min_u32 v58, -2, v58
    v_min_u32 v59, -2, v59
    buffer_store_dwordx4 v[56:59], v0, s[44:47], s25 offen sc1
L_eendB:
    s_endpgm
L_vdry0:
    v_accvgpr_read_b32 v29, a193
    v_sub_f32 v29, v29, v16
    v_mul_f32 v29, s97, v29
    v_exp_f32 v29, v29
    s_nop 0
    v_add_f32 v17, v17, v29
    v_cvt_pk_bf16_f32 v29, v29, v29
    s_nop 1
    v_and_b32_dpp v32, v29, v8 row_newbcast:0 row_mask:0xf bank_mask:0xf
    v_and_b32_dpp v33, v29, v9 row_newbcast:0 row_mask:0xf bank_mask:0xf
    v_and_b32_dpp v34, v29, v10 row_newbcast:0 row_mask:0xf bank_mask:0xf
    v_and_b32_dpp v35, v29, v11 row_newbcast:0 row_mask:0xf bank_mask:0xf
    v_and_b32_dpp v36, v29, v8 row_newbcast:8 row_mask:0xf bank_mask:0xf
    v_and_b32_dpp v37, v29, v9 row_newbcast:8 row_mask:0xf bank_mask:0xf
    v_and_b32_dpp v38, v29, v10 row_newbcast:8 row_mask:0xf bank_mask:0xf
    v_and_b32_dpp v39, v29, v11 row_newbcast:8 row_mask:0xf bank_mask:0xf
    v_and_b32_dpp v40, v29, v8 row_newbcast:4 row_mask:0xf bank_mask:0xf
    v_and_b32_dpp v41, v29, v9 row_newbcast:4 row_mask:0xf bank_mask:0xf
    v_and_b32_dpp v42, v29, v10 row_newbcast:4 row_mask:0xf bank_mask:0xf
    v_and_b32_dpp v43, v29, v11 row_newbcast:4 row_mask:0xf bank_mask:0xf
    v_and_b32_dpp v44, v29, v8 row_newbcast:12 row_mask:0xf bank_mask:0xf
    v_and_b32_dpp v45, v29, v9 row_newbcast:12 row_mask:0xf bank_mask:0xf
    v_and_b32_dpp v46, v29, v10 row_newbcast:12 row_mask:0xf bank_mask:0xf
    v_and_b32_dpp v47, v29, v11 row_newbcast:12 row_mask:0xf bank_mask:0xf
    s_waitcnt vmcnt(0)
    v_mfma_f32_16x16x32_bf16 v[12:15], v[32:35], a[16:19], v[12:15]
    v_mfma_f32_16x16x32_bf16 v[12:15], v[36:39], a[20:23], v[12:15]
    v_mfma_f32_16x16x32_bf16 v[12:15], v[40:43], a[24:27], v[12:15]
    v_mfma_f32_16x16x32_bf16 v[12:15], v[44:47], a[28:31], v[12:15]
    v_accvgpr_read_b32 v29, a194
    v_sub_f32 v29, v29, v16
    v_mul_f32 v29, s97, v29
    v_exp_f32 v29, v29
    s_nop 0
    v_add_f32 v17, v17, v29
    v_cvt_pk_bf16_f32 v29, v29, v29
    s_nop 1
    v_and_b32_dpp v32, v29, v8 row_newbcast:0 row_mask:0xf bank_mask:0xf
    v_and_b32_dpp v33, v29, v9 row_newbcast:0 row_mask:0xf bank_mask:0xf
    v_and_b32_dpp v34, v29, v10 row_newbcast:0 row_mask:0xf bank_mask:0xf
    v_and_b32_dpp v35, v29, v11 row_newbcast:0 row_mask:0xf bank_mask:0xf
    v_and_b32_dpp v36, v29, v8 row_newbcast:8 row_mask:0xf bank_mask:0xf
    v_and_b32_dpp v37, v29, v9 row_newbcast:8 row_mask:0xf bank_mask:0xf
    v_and_b32_dpp v38, v29, v10 row_newbcast:8 row_mask:0xf bank_mask:0xf
    v_and_b32_dpp v39, v29, v11 row_newbcast:8 row_mask:0xf bank_mask:0xf
    v_and_b32_dpp v40, v29, v8 row_newbcast:4 row_mask:0xf bank_mask:0xf
    v_and_b32_dpp v41, v29, v9 row_newbcast:4 row_mask:0xf bank_mask:0xf
    v_and_b32_dpp v42, v29, v10 row_newbcast:4 row_mask:0xf bank_mask:0xf
    v_and_b32_dpp v43, v29, v11 row_newbcast:4 row_mask:0xf bank_mask:0xf
    v_and_b32_dpp v44, v29, v8 row_newbcast:12 row_mask:0xf bank_mask:0xf
    v_and_b32_dpp v45, v29, v9 row_newbcast:12 row_mask:0xf bank_mask:0xf
    v_and_b32_dpp v46, v29, v10 row_newbcast:12 row_mask:0xf bank_mask:0xf
    v_and_b32_dpp v47, v29, v11 row_newbcast:12 row_mask:0xf bank_mask:0xf
    v_mfma_f32_16x16x32_bf16 v[12:15], v[32:35], a[32:35], v[12:15]
    v_mfma_f32_16x16x32_bf16 v[12:15], v[36:39], a[36:39], v[12:15]
    v_mfma_f32_16x16x32_bf16 v[12:15], v[40:43], a[40:43], v[12:15]
    v_mfma_f32_16x16x32_bf16 v[12:15], v[44:47], a[44:47], v[12:15]
    v_accvgpr_read_b32 v29, a195
    v_sub_f32 v29, v29, v16
    v_mul_f32 v29, s97, v29
    v_exp_f32 v29, v29
    s_nop 0
    v_add_f32 v17, v17, v29
    v_cvt_pk_bf16_f32 v29, v29, v29
    s_nop 1
    v_and_b32_dpp v32, v29, v8 row_newbcast:0 row_mask:0xf bank_mask:0xf
    v_and_b32_dpp v33, v29, v9 row_newbcast:0 row_mask:0xf bank_mask:0xf
    v_and_b32_dpp v34, v29, v10 row_newbcast:0 row_mask:0xf bank_mask:0xf
    v_and_b32_dpp v35, v29, v11 row_newbcast:0 row_mask:0xf bank_mask:0xf
    v_and_b32_dpp v36, v29, v8 row_newbcast:8 row_mask:0xf bank_mask:0xf
    v_and_b32_dpp v37, v29, v9 row_newbcast:8 row_mask:0xf bank_mask:0xf
    v_and_b32_dpp v38, v29, v10 row_newbcast:8 row_mask:0xf bank_mask:0xf
    v_and_b32_dpp v39, v29, v11 row_newbcast:8 row_mask:0xf bank_mask:0xf
    v_and_b32_dpp v40, v29, v8 row_newbcast:4 row_mask:0xf bank_mask:0xf
    v_and_b32_dpp v41, v29, v9 row_newbcast:4 row_mask:0xf bank_mask:0xf
    v_and_b32_dpp v42, v29, v10 row_newbcast:4 row_mask:0xf bank_mask:0xf
    v_and_b32_dpp v43, v29, v11 row_newbcast:4 row_mask:0xf bank_mask:0xf
    v_and_b32_dpp v44, v29, v8 row_newbcast:12 row_mask:0xf bank_mask:0xf
    v_and_b32_dpp v45, v29, v9 row_newbcast:12 row_mask:0xf bank_mask:0xf
    v_and_b32_dpp v46, v29, v10 row_newbcast:12 row_mask:0xf bank_mask:0xf
    v_and_b32_dpp v47, v29, v11 row_newbcast:12 row_mask:0xf bank_mask:0xf
    v_mfma_f32_16x16x32_bf16 v[12:15], v[32:35], a[48:51], v[12:15]
    v_mfma_f32_16x16x32_bf16 v[12:15], v[36:39], a[52:55], v[12:15]
    v_mfma_f32_16x16x32_bf16 v[12:15], v[40:43], a[56:59], v[12:15]
    v_mfma_f32_16x16x32_bf16 v[12:15], v[44:47], a[60:63], v[12:15]
    buffer_load_dwordx4 v[128:131], v19, s[40:43], s24 offen offset:0 nt
    buffer_load_dwordx4 v[132:135], v19, s[40:43], s24 offen offset:1152 nt
    buffer_load_dwordx4 v[136:139], v19, s[40:43], s24 offen offset:2304 nt
    buffer_load_dwordx4 v[140:143], v19, s[40:43], s24 offen offset:3456 nt
    s_add_u32 s24, s24, 4608
    buffer_load_dwordx4 v[144:147], v19, s[40:43], s24 offen offset:0 nt
    buffer_load_dwordx4 v[148:151], v19, s[40:43], s24 offen offset:1152 nt
    buffer_load_dwordx4 v[152:155], v19, s[40:43], s24 offen offset:2304 nt
    buffer_load_dwordx4 v[156:159], v19, s[40:43], s24 offen offset:3456 nt
    s_add_u32 s24, s24, 69120
    buffer_load_dwordx4 v[160:163], v19, s[40:43], s24 offen offset:0 nt
    buffer_load_dwordx4 v[164:167], v19, s[40:43], s24 offen offset:1152 nt
    buffer_load_dwordx4 v[168:171], v19, s[40:43], s24 offen offset:2304 nt
    buffer_load_dwordx4 v[172:175], v19, s[40:43], s24 offen offset:3456 nt
    s_add_u32 s24, s24, 4608
    buffer_load_dwordx4 v[176:179], v19, s[40:43], s24 offen offset:0 nt
    buffer_load_dwordx4 v[180:183], v19, s[40:43], s24 offen offset:1152 nt
    buffer_load_dwordx4 v[184:187], v19, s[40:43], s24 offen offset:2304 nt
    buffer_load_dwordx4 v[188:191], v19, s[40:43], s24 offen offset:3456 nt
    s_branch L_adone2
L_vdry1:
    v_accvgpr_read_b32 v29, a195
    v_sub_f32 v29, v29, v16
    v_mul_f32 v29, s97, v29
    v_exp_f32 v29, v29
    s_nop 0
    v_add_f32 v17, v17, v29
    v_cvt_pk_bf16_f32 v29, v29, v29
    s_nop 1
    v_and_b32_dpp v32, v29, v8 row_newbcast:0 row_mask:0xf bank_mask:0xf
    v_and_b32_dpp v33, v29, v9 row_newbcast:0 row_mask:0xf bank_mask:0xf
    v_and_b32_dpp v34, v29, v10 row_newbcast:0 row_mask:0xf bank_mask:0xf
    v_and_b32_dpp v35, v29, v11 row_newbcast:0 row_mask:0xf bank_mask:0xf
    v_and_b32_dpp v36, v29, v8 row_newbcast:8 row_mask:0xf bank_mask:0xf
    v_and_b32_dpp v37, v29, v9 row_newbcast:8 row_mask:0xf bank_mask:0xf
    v_and_b32_dpp v38, v29, v10 row_newbcast:8 row_mask:0xf bank_mask:0xf
    v_and_b32_dpp v39, v29, v11 row_newbcast:8 row_mask:0xf bank_mask:0xf
    v_and_b32_dpp v40, v29, v8 row_newbcast:4 row_mask:0xf bank_mask:0xf
    v_and_b32_dpp v41, v29, v9 row_newbcast:4 row_mask:0xf bank_mask:0xf
    v_and_b32_dpp v42, v29, v10 row_newbcast:4 row_mask:0xf bank_mask:0xf
    v_and_b32_dpp v43, v29, v11 row_newbcast:4 row_mask:0xf bank_mask:0xf
    v_and_b32_dpp v44, v29, v8 row_newbcast:12 row_mask:0xf bank_mask:0xf
    v_and_b32_dpp v45, v29, v9 row_newbcast:12 row_mask:0xf bank_mask:0xf
    v_and_b32_dpp v46, v29, v10 row_newbcast:12 row_mask:0xf bank_mask:0xf
    v_and_b32_dpp v47, v29, v11 row_newbcast:12 row_mask:0xf bank_mask:0xf
    s_waitcnt vmcnt(8)
    v_mfma_f32_16x16x32_bf16 v[12:15], v[32:35], a[48:51], v[12:15]
    v_mfma_f32_16x16x32_bf16 v[12:15], v[36:39], a[52:55], v[12:15]
    v_mfma_f32_16x16x32_bf16 v[12:15], v[40:43], a[56:59], v[12:15]
    v_mfma_f32_16x16x32_bf16 v[12:15], v[44:47], a[60:63], v[12:15]
    buffer_load_dwordx4 v[128:131], v19, s[40:43], s24 offen offset:0 nt
    buffer_load_dwordx4 v[132:135], v19, s[40:43], s24 offen offset:1152 nt
    buffer_load_dwordx4 v[136:139], v19, s[40:43], s24 offen offset:2304 nt
    buffer_load_dwordx4 v[140:143], v19, s[40:43], s24 offen offset:3456 nt
    s_add_u32 s24, s24, 4608
    buffer_load_dwordx4 v[144:147], v19, s[40:43], s24 offen offset:0 nt
    buffer_load_dwordx4 v[148:151], v19, s[40:43], s24 offen offset:1152 nt
    buffer_load_dwordx4 v[152:155], v19, s[40:43], s24 offen offset:2304 nt
    buffer_load_dwordx4 v[156:159], v19, s[40:43], s24 offen offset:3456 nt
    s_add_u32 s24, s24, 69120
    s_branch L_alast0
L_aflag:
    s_sleep 2
    global_load_dword v57, v58, s[28:29] sc1
    s_waitcnt vmcnt(0)
    v_readfirstlane_b32 s18, v57
    v_cmp_gt_u32 vcc, 1073741824, v57
    s_cbranch_vccz L_aflag_ok
    s_sub_u32 s101, s101, 1
    s_cbranch_scc0 L_aflag
    s_mov_b32 s101, 0
    s_branch L_aflag_ok
L_roleA_end:
L_roleH:
    s_mov_b32 s101, 100000
    s_getpc_b64 s[56:57]
L_pc_21:
    s_sub_u32 s56, s56, L_pc_21-L_roleH
    s_subb_u32 s57, s57, 0
    v_lshlrev_b32 v5, 7, v0
    v_min_u32 v6, L_roleH_end-L_roleH-4, v5
    global_load_dword v122, v6, s[56:57]
    v_mov_b32 v20, -1
    v_mov_b32 v21, -1
    v_mov_b32 v22, -1
    v_mov_b32 v23, -1
    v_mul_u32_u24 v7, 73728, v4
    v_lshrrev_b32 v5, 3, v3
    v_lshl_add_u32 v6, v5, 13, v7
    v_and_b32 v5, 7, v3
    v_lshl_add_u32 v6, v5, 4, v6
    v_lshl_add_u32 v7, v3, 3, v7
    v_add_u32 v7, 65536, v7
    s_lshl_b32 s56, s52, 7
    s_add_u32 s56, s56, 4718592
    s_lshl_b32 s54, s3, 14
    s_add_u32 s54, s54, s56
    s_add_u32 s55, s54, 4096
    s_and_b32 s57, s3, 1
    s_lshl_b32 s57, s57, 12
    s_add_u32 s56, s56, s57
    s_waitcnt lgkmcnt(0)
    s_mov_b32 s44, s30
    s_mov_b32 s45, s31
    s_mov_b32 s46, 536870912
    s_mov_b32 s47, 0x20000
    buffer_store_dwordx4 v[20:23], v6, s[44:47], s54 offen sc1
    buffer_store_dwordx4 v[20:23], v6, s[44:47], s55 offen sc1
    buffer_store_dwordx2 v[20:21], v7, s[44:47], s56 offen sc1
    v_lshrrev_b32 v5, 2, v3
    v_lshlrev_b32 v5, 15, v5
    v_lshl_add_u32 v5, v4, 4, v5
    v_and_b32 v6, 3, v3
    v_lshl_add_u32 v5, v6, 6, v5
    s_lshl_b32 s54, s52, 10
    s_lshl_b32 s55, s3, 8
    s_add_u32 s54, s54, s55
    s_add_u32 s54, s54, 1048576
    buffer_store_dwordx4 v[20:23], v5, s[44:47], s54 offen sc1
    v_bfe_u32 v6, v1, 2, 2
    v_lshlrev_b32 v6, 6, v6
    v_and_b32 v5, 48, v1
    v_add_u32 v6, v6, v5
    v_and_b32 v5, 3, v1
    v_lshl_add_u32 v6, v5, 29, v6
    s_lshl_b32 s54, s52, 10
    s_lshl_b32 s55, s3, 8
    s_add_u32 s54, s54, s55
    s_add_u32 s54, s54, 5439488
    buffer_store_dwordx4 v[20:23], v6, s[44:47], s54 offen sc1
    s_mov_b32 s32, s18
    s_mov_b32 s33, s19
    s_mov_b32 s34, 4718592
    s_mov_b32 s35, 0x20000
    s_mov_b32 s36, s14
    s_mov_b32 s37, s15
    s_mov_b32 s38, 4608
    s_mov_b32 s39, 0x20000
    v_lshrrev_b32 v5, 3, v3
    v_mul_u32_u24 v5, 1152, v5
    v_mul_u32_u24 v6, 72, v4
    v_add_u32 v5, v5, v6
    s_mul_i32 s54, s3, 288
    buffer_load_dwordx4 v[48:51], v5, s[36:39], s54 offen offset:0
    buffer_load_dwordx4 v[52:55], v5, s[36:39], s54 offen offset:16
    buffer_load_dwordx4 v[56:59], v5, s[36:39], s54 offen offset:32
    buffer_load_dwordx4 v[60:63], v5, s[36:39], s54 offen offset:48
    buffer_load_dwordx2 v[64:65], v5, s[36:39], s54 offen offset:64
    buffer_load_dwordx4 v[68:71], v5, s[36:39], s54 offen offset:2304
    buffer_load_dwordx4 v[72:75], v5, s[36:39], s54 offen offset:2320
    buffer_load_dwordx4 v[76:79], v5, s[36:39], s54 offen offset:2336
    buffer_load_dwordx4 v[80:83], v5, s[36:39], s54 offen offset:2352
    buffer_load_dwordx2 v[84:85], v5, s[36:39], s54 offen offset:2368
    v_mul_u32_u24 v120, 294912, v4
    v_lshl_add_u32 v120, v3, 4, v120
    s_mul_i32 s61, s3, 1179648
    s_lshl_b32 s54, s52, 8
    s_add_u32 s61, s61, s54
    buffer_load_dwordx4 a[112:115], v120, s[32:35], s61 offen nt
    s_add_u32 s61, s61, 8192
    buffer_load_dwordx4 a[116:119], v120, s[32:35], s61 offen nt
    s_add_u32 s61, s61, 8192
    buffer_load_dwordx4 a[120:123], v120, s[32:35], s61 offen nt
    s_add_u32 s61, s61, 8192
    buffer_load_dwordx4 a[124:127], v120, s[32:35], s61 offen nt
    s_add_u32 s61, s61, 8192
    buffer_load_dwordx4 a[128:131], v120, s[32:35], s61 offen nt
    s_add_u32 s61, s61, 8192
    buffer_load_dwordx4 a[132:135], v120, s[32:35], s61 offen nt
    s_add_u32 s61, s61, 8192
    buffer_load_dwordx4 a[136:139], v120, s[32:35], s61 offen nt
    s_add_u32 s61, s61, 8192
    buffer_load_dwordx4 a[140:143], v120, s[32:35], s61 offen nt
    s_add_u32 s61, s61, 8192
    buffer_load_dwordx4 a[144:147], v120, s[32:35], s61 offen nt
    s_add_u32 s61, s61, 8192
    s_cmp_lg_u32 s3, 0
    s_cbranch_scc1 L_norace_22
    s_sub_u32 s84, s52, 1
    s_lshl_b32 s84, s84, 11
    s_lshl_b32 s85, s52, 12
    s_xor_b32 s84, s84, s85
    s_lshl_b32 s85, s52, 10
    s_xor_b32 s84, s84, s85
    s_and_b32 s84, s84, 0x2000
    s_lshr_b32 s85, s52, 2
    s_xor_b32 s85, s85, s52
    s_and_b32 s85, s85, 3
    s_lshl_b32 s85, s85, 25
    s_or_b32 s84, s84, s85
    s_lshl_b32 s85, s52, 20
    s_or_b32 s84, s84, s85
    s_xor_b32 s85, s84, 0x2000
    s_mov_b32 s86, -1
    s_mov_b32 s87, -1
    s_load_dword s87, s[6:7], s85 offset:0x80500
    s_load_dword s86, s[6:7], s84 offset:0x80000
    s_mov_b32 s97, 1
    s_waitcnt lgkmcnt(1)
    s_cmp_lg_u32 s87, -1
    s_subb_u32 s97, s97, 0
    s_cmp_lg_u32 s86, -1
    s_addc_u32 s97, s97, 0
    s_sub_u32 s96, 2, s97
    s_bitcmp1_b32 s52, 3
    s_cselect_b32 s97, s96, s97
    s_lshl_b32 s97, s97, 0
    s_or_b32 s97, s97, 0x1000000
L_norace_22:
    s_waitcnt vmcnt(19)
    s_barrier
    s_cmp_lg_u32 s3, 0
    s_cbranch_scc1 L_nosig_23
    s_atomic_add s97, s[28:29], 0 glc
L_nosig_23:
    buffer_load_dwordx4 a[148:151], v120, s[32:35], s61 offen nt
    s_add_u32 s61, s61, 8192
    buffer_load_dwordx4 a[152:155], v120, s[32:35], s61 offen nt
    s_add_u32 s61, s61, 8192
    buffer_load_dwordx4 a[156:159], v120, s[32:35], s61 offen nt
    s_add_u32 s61, s61, 8192
    buffer_load_dwordx4 a[160:163], v120, s[32:35], s61 offen nt
    s_add_u32 s61, s61, 8192
    buffer_load_dwordx4 a[164:167], v120, s[32:35], s61 offen nt
    s_add_u32 s61, s61, 8192
    buffer_load_dwordx4 a[168:171], v120, s[32:35], s61 offen nt
    s_add_u32 s61, s61, 8192
    buffer_load_dwordx4 a[172:175], v120, s[32:35], s61 offen nt
    s_add_u32 s61, s61, 8192
    buffer_load_dwordx4 a[176:179], v120, s[32:35], s61 offen nt
    s_add_u32 s61, s61, 8192
    buffer_load_dwordx4 a[180:183], v120, s[32:35], s61 offen nt
    s_add_u32 s61, s61, 8192
    s_mov_b32 s36, s20
    s_mov_b32 s37, s21
    s_mov_b32 s38, 4194304
    s_mov_b32 s39, 0x20000
    s_mov_b32 s40, s22
    s_mov_b32 s41, s23
    s_mov_b32 s42, 4194304
    s_mov_b32 s43, 0x20000
    v_lshlrev_b32 v5, 2, v4
    v_xor_b32 v5, v5, v3
    v_lshlrev_b32 v6, 13, v4
    v_xor_b32 v7, 0, v5
    v_lshl_add_u32 v88, v7, 4, v6
    v_xor_b32 v7, 1, v5
    v_lshl_add_u32 v89, v7, 4, v6
    v_xor_b32 v7, 2, v5
    v_lshl_add_u32 v90, v7, 4, v6
    v_xor_b32 v7, 3, v5
    v_lshl_add_u32 v91, v7, 4, v6
    s_lshl_b32 s62, s3, 20
    s_lshl_b32 s54, s52, 8
    s_add_u32 s62, s62, s54
    s_mov_b32 s60, s62
    s_lshl_b32 s63, s3, 15
    v_lshlrev_b32 v121, 18, v4
    v_lshl_add_u32 v121, v3, 4, v121
    v_lshrrev_b32 v5, 2, v3
    v_and_b32 v6, 3, v3
    v_lshl_add_u32 v7, v5, 3, v6
    v_lshlrev_b32 v92, 8, v7
    v_lshl_or_b32 v5, v6, 2, v5
    v_xor_b32 v5, v5, v4
    v_lshl_add_u32 v92, v5, 4, v92
    v_add_u32 v92, s63, v92
    v_xor_b32 v93, 64, v92
    v_xor_b32 v94, 128, v92
    v_xor_b32 v95, 192, v92
    v_and_b32 v5, 1, v3
    v_cmp_eq_u32 vcc, 1, v5
    v_mov_b32 v5, 0x0c0c0100
    v_mov_b32 v6, 0x01000c0c
    v_cndmask_b32 v5, v5, v6, vcc
    v_mov_b32 v6, 0x0c0c0302
    v_mov_b32 v7, 0x03020c0c
    v_cndmask_b32 v6, v6, v7, vcc
    v_bfe_u32 v7, v3, 1, 2
    v_mov_b32 v16, 0x0c0c0c0c
    v_cmp_eq_u32 vcc, 0, v7
    s_nop 1
    v_cndmask_b32 v8, v16, v5, vcc
    v_cndmask_b32 v9, v16, v6, vcc
    v_cmp_eq_u32 vcc, 1, v7
    s_nop 1
    v_cndmask_b32 v10, v16, v5, vcc
    v_cndmask_b32 v11, v16, v6, vcc
    v_cmp_eq_u32 vcc, 2, v7
    s_nop 1
    v_cndmask_b32 v12, v16, v5, vcc
    v_cndmask_b32 v13, v16, v6, vcc
    v_cmp_eq_u32 vcc, 3, v7
    s_nop 1
    v_cndmask_b32 v14, v16, v5, vcc
    v_cndmask_b32 v15, v16, v6, vcc
    s_waitcnt vmcnt(9)
    buffer_load_dwordx4 a[184:187], v120, s[32:35], s61 offen nt
    s_add_u32 s61, s61, 8192
    buffer_load_dwordx4 a[188:191], v120, s[32:35], s61 offen nt
    s_add_u32 s61, s61, 8192
    buffer_load_dwordx4 a[192:195], v120, s[32:35], s61 offen nt
    s_add_u32 s61, s61, 8192
    buffer_load_dwordx4 a[196:199], v120, s[32:35], s61 offen nt
    s_add_u32 s61, s61, 8192
    buffer_load_dwordx4 a[200:203], v120, s[32:35], s61 offen nt
    s_add_u32 s61, s61, 8192
    buffer_load_dwordx4 a[204:207], v120, s[32:35], s61 offen nt
    s_add_u32 s61, s61, 8192
    buffer_load_dwordx4 a[208:211], v120, s[32:35], s61 offen nt
    s_add_u32 s61, s61, 8192
    buffer_load_dwordx4 a[212:215], v120, s[32:35], s61 offen nt
    s_add_u32 s61, s61, 8192
    buffer_load_dwordx4 a[216:219], v120, s[32:35], s61 offen nt
    s_add_u32 s61, s61, 8192
    buffer_load_dwordx4 a[220:223], v120, s[32:35], s61 offen nt
    s_add_u32 s61, s61, 8192
    buffer_load_dwordx4 a[224:227], v120, s[32:35], s61 offen nt
    s_add_u32 s61, s61, 8192
    buffer_load_dwordx4 a[228:231], v120, s[32:35], s61 offen nt
    s_add_u32 s61, s61, 8192
    buffer_load_dwordx4 a[232:235], v120, s[32:35], s61 offen nt
    s_add_u32 s61, s61, 8192
    buffer_load_dwordx4 a[236:239], v120, s[32:35], s61 offen nt
    s_add_u32 s61, s61, 8192
    buffer_load_dwordx4 a[240:243], v120, s[32:35], s61 offen nt
    s_add_u32 s61, s61, 8192
    buffer_load_dwordx4 a[244:247], v120, s[32:35], s61 offen nt
    s_add_u32 s61, s61, 8192
    buffer_load_dwordx4 a[248:251], v120, s[32:35], s61 offen nt
    s_add_u32 s61, s61, 8192
    buffer_load_dwordx4 a[252:255], v120, s[32:35], s61 offen nt
    s_add_u32 s61, s61, 8192
    s_add_u32 m0, s63, 0
    s_nop 0
    buffer_load_dwordx4 v88, s[36:39], s60 offen nt lds
    s_add_u32 s60, s60, 32768
    v_perm_b32 v96, v48, v48, v8
    v_perm_b32 v97, v48, v48, v10
    v_perm_b32 v98, v48, v48, v12
    v_perm_b32 v99, v48, v48, v14
    s_nop 1
    v_mfma_f32_16x16x32_bf16 v[112:115], v[96:99], a[112:115], 0
    v_perm_b32 v100, v68, v68, v8
    v_perm_b32 v101, v68, v68, v10
    v_perm_b32 v102, v68, v68, v12
    v_perm_b32 v103, v68, v68, v14
    s_nop 1
    v_mfma_f32_16x16x32_bf16 v[116:119], v[100:103], a[112:115], 0
    v_perm_b32 v104, v48, v48, v9
    v_perm_b32 v105, v48, v48, v11
    v_perm_b32 v106, v48, v48, v13
    v_perm_b32 v107, v48, v48, v15
    s_nop 1
    v_mfma_f32_16x16x32_bf16 v[112:115], v[104:107], a[116:119], v[112:115]
    v_perm_b32 v108, v68, v68, v9
    v_perm_b32 v109, v68, v68, v11
    v_perm_b32 v110, v68, v68, v13
    v_perm_b32 v111, v68, v68, v15
    s_nop 1
    v_mfma_f32_16x16x32_bf16 v[116:119], v[108:111], a[116:119], v[116:119]
    v_perm_b32 v96, v49, v49, v8
    v_perm_b32 v97, v49, v49, v10
    v_perm_b32 v98, v49, v49, v12
    v_perm_b32 v99, v49, v49, v14
    s_nop 1
    v_mfma_f32_16x16x32_bf16 v[112:115], v[96:99], a[120:123], v[112:115]
    v_perm_b32 v100, v69, v69, v8
    v_perm_b32 v101, v69, v69, v10
    v_perm_b32 v102, v69, v69, v12
    v_perm_b32 v103, v69, v69, v14
    s_nop 1
    v_mfma_f32_16x16x32_bf16 v[116:119], v[100:103], a[120:123], v[116:119]
    v_perm_b32 v104, v49, v49, v9
    v_perm_b32 v105, v49, v49, v11
    v_perm_b32 v106, v49, v49, v13
    v_perm_b32 v107, v49, v49, v15
    s_nop 1
    v_mfma_f32_16x16x32_bf16 v[112:115], v[104:107], a[124:127], v[112:115]
    v_perm_b32 v108, v69, v69, v9
    v_perm_b32 v109, v69, v69, v11
    v_perm_b32 v110, v69, v69, v13
    v_perm_b32 v111, v69, v69, v15
    s_nop 1
    v_mfma_f32_16x16x32_bf16 v[116:119], v[108:111], a[124:127], v[116:119]
    v_perm_b32 v96, v50, v50, v8
    v_perm_b32 v97, v50, v50, v10
    v_perm_b32 v98, v50, v50, v12
    v_perm_b32 v99, v50, v50, v14
    s_nop 1
    v_mfma_f32_16x16x32_bf16 v[112:115], v[96:99], a[128:131], v[112:115]
    v_perm_b32 v100, v70, v70, v8
    v_perm_b32 v101, v70, v70, v10
    v_perm_b32 v102, v70, v70, v12
    v_perm_b32 v103, v70, v70, v14
    s_nop 1
    v_mfma_f32_16x16x32_bf16 v[116:119], v[100:103], a[128:131], v[116:119]
    v_perm_b32 v104, v50, v50, v9
    v_perm_b32 v105, v50, v50, v11
    v_perm_b32 v106, v50, v50, v13
    v_perm_b32 v107, v50, v50, v15
    s_nop 1
    v_mfma_f32_16x16x32_bf16 v[112:115], v[104:107], a[132:135], v[112:115]
    v_perm_b32 v108, v70, v70, v9
    v_perm_b32 v109, v70, v70, v11
    v_perm_b32 v110, v70, v70, v13
    v_perm_b32 v111, v70, v70, v15
    s_nop 1
    v_mfma_f32_16x16x32_bf16 v[116:119], v[108:111], a[132:135], v[116:119]
    v_perm_b32 v96, v51, v51, v8
    v_perm_b32 v97, v51, v51, v10
    v_perm_b32 v98, v51, v51, v12
    v_perm_b32 v99, v51, v51, v14
    s_nop 1
    v_mfma_f32_16x16x32_bf16 v[112:115], v[96:99], a[136:139], v[112:115]
    v_perm_b32 v100, v71, v71, v8
    v_perm_b32 v101, v71, v71, v10
    v_perm_b32 v102, v71, v71, v12
    v_perm_b32 v103, v71, v71, v14
    s_nop 1
    v_mfma_f32_16x16x32_bf16 v[116:119], v[100:103], a[136:139], v[116:119]
    v_perm_b32 v104, v51, v51, v9
    v_perm_b32 v105, v51, v51, v11
    v_perm_b32 v106, v51, v51, v13
    v_perm_b32 v107, v51, v51, v15
    s_nop 1
    v_mfma_f32_16x16x32_bf16 v[112:115], v[104:107], a[140:143], v[112:115]
    v_perm_b32 v108, v71, v71, v9
    v_perm_b32 v109, v71, v71, v11
    v_perm_b32 v110, v71, v71, v13
    v_perm_b32 v111, v71, v71, v15
    s_nop 1
    v_mfma_f32_16x16x32_bf16 v[116:119], v[108:111], a[140:143], v[116:119]
    v_perm_b32 v96, v52, v52, v8
    v_perm_b32 v97, v52, v52, v10
    v_perm_b32 v98, v52, v52, v12
    v_perm_b32 v99, v52, v52, v14
    s_nop 1
    v_mfma_f32_16x16x32_bf16 v[112:115], v[96:99], a[144:147], v[112:115]
    v_perm_b32 v100, v72, v72, v8
    v_perm_b32 v101, v72, v72, v10
    v_perm_b32 v102, v72, v72, v12
    v_perm_b32 v103, v72, v72, v14
    s_nop 1
    v_mfma_f32_16x16x32_bf16 v[116:119], v[100:103], a[144:147], v[116:119]
    s_waitcnt vmcnt(19)
    s_add_u32 m0, s63, 1024
    s_nop 0
    buffer_load_dwordx4 v88, s[36:39], s60 offen nt lds
    s_add_u32 s60, s60, 32768
    s_add_u32 m0, s63, 2048
    s_nop 0
    buffer_load_dwordx4 v89, s[36:39], s60 offen nt lds
    s_add_u32 s60, s60, 32768
    s_add_u32 m0, s63, 3072
    s_nop 0
    buffer_load_dwordx4 v89, s[36:39], s60 offen nt lds
    s_add_u32 s60, s60, 32768
    s_add_u32 m0, s63, 4096
    s_nop 0
    buffer_load_dwordx4 v90, s[36:39], s60 offen nt lds
    s_add_u32 s60, s60, 32768
    s_add_u32 m0, s63, 5120
    s_nop 0
    buffer_load_dwordx4 v90, s[36:39], s60 offen nt lds
    s_add_u32 s60, s60, 32768
    s_add_u32 m0, s63, 6144
    s_nop 0
    buffer_load_dwordx4 v91, s[36:39], s60 offen nt lds
    s_add_u32 s60, s60, 32768
    s_add_u32 m0, s63, 7168
    s_nop 0
    buffer_load_dwordx4 v91, s[36:39], s60 offen nt lds
    s_add_u32 s60, s60, 32768
    s_add_u32 m0, s63, 8192
    s_nop 0
    buffer_load_dwordx4 v88, s[36:39], s60 offen nt lds
    s_add_u32 s60, s60, 32768
    s_add_u32 m0, s63, 9216
    s_nop 0
    buffer_load_dwordx4 v88, s[36:39], s60 offen nt lds
    s_add_u32 s60, s60, 32768
    v_perm_b32 v104, v52, v52, v9
    v_perm_b32 v105, v52, v52, v11
    v_perm_b32 v106, v52, v52, v13
    v_perm_b32 v107, v52, v52, v15
    s_nop 1
    v_mfma_f32_16x16x32_bf16 v[112:115], v[104:107], a[148:151], v[112:115]
    v_perm_b32 v108, v72, v72, v9
    v_perm_b32 v109, v72, v72, v11
    v_perm_b32 v110, v72, v72, v13
    v_perm_b32 v111, v72, v72, v15
    s_nop 1
    v_mfma_f32_16x16x32_bf16 v[116:119], v[108:111], a[148:151], v[116:119]
    v_perm_b32 v96, v53, v53, v8
    v_perm_b32 v97, v53, v53, v10
    v_perm_b32 v98, v53, v53, v12
    v_perm_b32 v99, v53, v53, v14
    s_nop 1
    v_mfma_f32_16x16x32_bf16 v[112:115], v[96:99], a[152:155], v[112:115]
    v_perm_b32 v100, v73, v73, v8
    v_perm_b32 v101, v73, v73, v10
    v_perm_b32 v102, v73, v73, v12
    v_perm_b32 v103, v73, v73, v14
    s_nop 1
    v_mfma_f32_16x16x32_bf16 v[116:119], v[100:103], a[152:155], v[116:119]
    v_perm_b32 v104, v53, v53, v9
    v_perm_b32 v105, v53, v53, v11
    v_perm_b32 v106, v53, v53, v13
    v_perm_b32 v107, v53, v53, v15
    s_nop 1
    v_mfma_f32_16x16x32_bf16 v[112:115], v[104:107], a[156:159], v[112:115]
    v_perm_b32 v108, v73, v73, v9
    v_perm_b32 v109, v73, v73, v11
    v_perm_b32 v110, v73, v73, v13
    v_perm_b32 v111, v73, v73, v15
    s_nop 1
    v_mfma_f32_16x16x32_bf16 v[116:119], v[108:111], a[156:159], v[116:119]
    v_perm_b32 v96, v54, v54, v8
    v_perm_b32 v97, v54, v54, v10
    v_perm_b32 v98, v54, v54, v12
    v_perm_b32 v99, v54, v54, v14
    s_nop 1
    v_mfma_f32_16x16x32_bf16 v[112:115], v[96:99], a[160:163], v[112:115]
    v_perm_b32 v100, v74, v74, v8
    v_perm_b32 v101, v74, v74, v10
    v_perm_b32 v102, v74, v74, v12
    v_perm_b32 v103, v74, v74, v14
    s_nop 1
    v_mfma_f32_16x16x32_bf16 v[116:119], v[100:103], a[160:163], v[116:119]
    v_perm_b32 v104, v54, v54, v9
    v_perm_b32 v105, v54, v54, v11
    v_perm_b32 v106, v54, v54, v13
    v_perm_b32 v107, v54, v54, v15
    s_nop 1
    v_mfma_f32_16x16x32_bf16 v[112:115], v[104:107], a[164:167], v[112:115]
    v_perm_b32 v108, v74, v74, v9
    v_perm_b32 v109, v74, v74, v11
    v_perm_b32 v110, v74, v74, v13
    v_perm_b32 v111, v74, v74, v15
    s_nop 1
    v_mfma_f32_16x16x32_bf16 v[116:119], v[108:111], a[164:167], v[116:119]
    v_perm_b32 v96, v55, v55, v8
    v_perm_b32 v97, v55, v55, v10
    v_perm_b32 v98, v55, v55, v12
    v_perm_b32 v99, v55, v55, v14
    s_nop 1
    v_mfma_f32_16x16x32_bf16 v[112:115], v[96:99], a[168:171], v[112:115]
    v_perm_b32 v100, v75, v75, v8
    v_perm_b32 v101, v75, v75, v10
    v_perm_b32 v102, v75, v75, v12
    v_perm_b32 v103, v75, v75, v14
    s_nop 1
    v_mfma_f32_16x16x32_bf16 v[116:119], v[100:103], a[168:171], v[116:119]
    v_perm_b32 v104, v55, v55, v9
    v_perm_b32 v105, v55, v55, v11
    v_perm_b32 v106, v55, v55, v13
    v_perm_b32 v107, v55, v55, v15
    s_nop 1
    v_mfma_f32_16x16x32_bf16 v[112:115], v[104:107], a[172:175], v[112:115]
    v_perm_b32 v108, v75, v75, v9
    v_perm_b32 v109, v75, v75, v11
    v_perm_b32 v110, v75, v75, v13
    v_perm_b32 v111, v75, v75, v15
    s_nop 1
    v_mfma_f32_16x16x32_bf16 v[116:119], v[108:111], a[172:175], v[116:119]
    v_perm_b32 v96, v56, v56, v8
    v_perm_b32 v97, v56, v56, v10
    v_perm_b32 v98, v56, v56, v12
    v_perm_b32 v99, v56, v56, v14
    s_nop 1
    v_mfma_f32_16x16x32_bf16 v[112:115], v[96:99], a[176:179], v[112:115]
    v_perm_b32 v100, v76, v76, v8
    v_perm_b32 v101, v76, v76, v10
    v_perm_b32 v102, v76, v76, v12
    v_perm_b32 v103, v76, v76, v14
    s_nop 1
    v_mfma_f32_16x16x32_bf16 v[116:119], v[100:103], a[176:179], v[116:119]
    v_perm_b32 v104, v56, v56, v9
    v_perm_b32 v105, v56, v56, v11
    v_perm_b32 v106, v56, v56, v13
    v_perm_b32 v107, v56, v56, v15
    s_nop 1
    v_mfma_f32_16x16x32_bf16 v[112:115], v[104:107], a[180:183], v[112:115]
    v_perm_b32 v108, v76, v76, v9
    v_perm_b32 v109, v76, v76, v11
    v_perm_b32 v110, v76, v76, v13
    v_perm_b32 v111, v76, v76, v15
    s_nop 1
    v_mfma_f32_16x16x32_bf16 v[116:119], v[108:111], a[180:183], v[116:119]
    s_waitcnt vmcnt(19)
    s_add_u32 m0, s63, 10240
    s_nop 0
    buffer_load_dwordx4 v89, s[36:39], s60 offen nt lds
    s_add_u32 s60, s60, 32768
    s_add_u32 m0, s63, 11264
    s_nop 0
    buffer_load_dwordx4 v89, s[36:39], s60 offen nt lds
    s_add_u32 s60, s60, 32768
    s_add_u32 m0, s63, 12288
    s_nop 0
    buffer_load_dwordx4 v90, s[36:39], s60 offen nt lds
    s_add_u32 s60, s60, 32768
    s_add_u32 m0, s63, 13312
    s_nop 0
    buffer_load_dwordx4 v90, s[36:39], s60 offen nt lds
    s_add_u32 s60, s60, 32768
    s_add_u32 m0, s63, 14336
    s_nop 0
    buffer_load_dwordx4 v91, s[36:39], s60 offen nt lds
    s_add_u32 s60, s60, 32768
    s_add_u32 m0, s63, 15360
    s_nop 0
    buffer_load_dwordx4 v91, s[36:39], s60 offen nt lds
    s_add_u32 s60, s60, 32768
    s_add_u32 m0, s63, 16384
    s_nop 0
    buffer_load_dwordx4 v88, s[36:39], s60 offen nt lds
    s_add_u32 s60, s60, 32768
    s_add_u32 m0, s63, 17408
    s_nop 0
    buffer_load_dwordx4 v88, s[36:39], s60 offen nt lds
    s_add_u32 s60, s60, 32768
    s_add_u32 m0, s63, 18432
    s_nop 0
    buffer_load_dwordx4 v89, s[36:39], s60 offen nt lds
    s_add_u32 s60, s60, 32768
    v_perm_b32 v96, v57, v57, v8
    v_perm_b32 v97, v57, v57, v10
    v_perm_b32 v98, v57, v57, v12
    v_perm_b32 v99, v57, v57, v14
    s_nop 1
    v_mfma_f32_16x16x32_bf16 v[112:115], v[96:99], a[184:187], v[112:115]
    v_perm_b32 v100, v77, v77, v8
    v_perm_b32 v101, v77, v77, v10
    v_perm_b32 v102, v77, v77, v12
    v_perm_b32 v103, v77, v77, v14
    s_nop 1
    v_mfma_f32_16x16x32_bf16 v[116:119], v[100:103], a[184:187], v[116:119]
    v_perm_b32 v104, v57, v57, v9
    v_perm_b32 v105, v57, v57, v11
    v_perm_b32 v106, v57, v57, v13
    v_perm_b32 v107, v57, v57, v15
    s_nop 1
    v_mfma_f32_16x16x32_bf16 v[112:115], v[104:107], a[188:191], v[112:115]
    v_perm_b32 v108, v77, v77, v9
    v_perm_b32 v109, v77, v77, v11
    v_perm_b32 v110, v77, v77, v13
    v_perm_b32 v111, v77, v77, v15
    s_nop 1
    v_mfma_f32_16x16x32_bf16 v[116:119], v[108:111], a[188:191], v[116:119]
    v_perm_b32 v96, v58, v58, v8
    v_perm_b32 v97, v58, v58, v10
    v_perm_b32 v98, v58, v58, v12
    v_perm_b32 v99, v58, v58, v14
    s_nop 1
    v_mfma_f32_16x16x32_bf16 v[112:115], v[96:99], a[192:195], v[112:115]
    v_perm_b32 v100, v78, v78, v8
    v_perm_b32 v101, v78, v78, v10
    v_perm_b32 v102, v78, v78, v12
    v_perm_b32 v103, v78, v78, v14
    s_nop 1
    v_mfma_f32_16x16x32_bf16 v[116:119], v[100:103], a[192:195], v[116:119]
    v_perm_b32 v104, v58, v58, v9
    v_perm_b32 v105, v58, v58, v11
    v_perm_b32 v106, v58, v58, v13
    v_perm_b32 v107, v58, v58, v15
    s_nop 1
    v_mfma_f32_16x16x32_bf16 v[112:115], v[104:107], a[196:199], v[112:115]
    v_perm_b32 v108, v78, v78, v9
    v_perm_b32 v109, v78, v78, v11
    v_perm_b32 v110, v78, v78, v13
    v_perm_b32 v111, v78, v78, v15
    s_nop 1
    v_mfma_f32_16x16x32_bf16 v[116:119], v[108:111], a[196:199], v[116:119]
    v_perm_b32 v96, v59, v59, v8
    v_perm_b32 v97, v59, v59, v10
    v_perm_b32 v98, v59, v59, v12
    v_perm_b32 v99, v59, v59, v14
    s_nop 1
    v_mfma_f32_16x16x32_bf16 v[112:115], v[96:99], a[200:203], v[112:115]
    v_perm_b32 v100, v79, v79, v8
    v_perm_b32 v101, v79, v79, v10
    v_perm_b32 v102, v79, v79, v12
    v_perm_b32 v103, v79, v79, v14
    s_nop 1
    v_mfma_f32_16x16x32_bf16 v[116:119], v[100:103], a[200:203], v[116:119]
    v_perm_b32 v104, v59, v59, v9
    v_perm_b32 v105, v59, v59, v11
    v_perm_b32 v106, v59, v59, v13
    v_perm_b32 v107, v59, v59, v15
    s_nop 1
    v_mfma_f32_16x16x32_bf16 v[112:115], v[104:107], a[204:207], v[112:115]
    v_perm_b32 v108, v79, v79, v9
    v_perm_b32 v109, v79, v79, v11
    v_perm_b32 v110, v79, v79, v13
    v_perm_b32 v111, v79, v79, v15
    s_nop 1
    v_mfma_f32_16x16x32_bf16 v[116:119], v[108:111], a[204:207], v[116:119]
    v_perm_b32 v96, v60, v60, v8
    v_perm_b32 v97, v60, v60, v10
    v_perm_b32 v98, v60, v60, v12
    v_perm_b32 v99, v60, v60, v14
    s_nop 1
    v_mfma_f32_16x16x32_bf16 v[112:115], v[96:99], a[208:211], v[112:115]
    v_perm_b32 v100, v80, v80, v8
    v_perm_b32 v101, v80, v80, v10
    v_perm_b32 v102, v80, v80, v12
    v_perm_b32 v103, v80, v80, v14
    s_nop 1
    v_mfma_f32_16x16x32_bf16 v[116:119], v[100:103], a[208:211], v[116:119]
    v_perm_b32 v104, v60, v60, v9
    v_perm_b32 v105, v60, v60, v11
    v_perm_b32 v106, v60, v60, v13
    v_perm_b32 v107, v60, v60, v15
    s_nop 1
    v_mfma_f32_16x16x32_bf16 v[112:115], v[104:107], a[212:215], v[112:115]
    v_perm_b32 v108, v80, v80, v9
    v_perm_b32 v109, v80, v80, v11
    v_perm_b32 v110, v80, v80, v13
    v_perm_b32 v111, v80, v80, v15
    s_nop 1
    v_mfma_f32_16x16x32_bf16 v[116:119], v[108:111], a[212:215], v[116:119]
    v_perm_b32 v96, v61, v61, v8
    v_perm_b32 v97, v61, v61, v10
    v_perm_b32 v98, v61, v61, v12
    v_perm_b32 v99, v61, v61, v14
    s_nop 1
    v_mfma_f32_16x16x32_bf16 v[112:115], v[96:99], a[216:219], v[112:115]
    v_perm_b32 v100, v81, v81, v8
    v_perm_b32 v101, v81, v81, v10
    v_perm_b32 v102, v81, v81, v12
    v_perm_b32 v103, v81, v81, v14
    s_nop 1
    v_mfma_f32_16x16x32_bf16 v[116:119], v[100:103], a[216:219], v[116:119]
    s_waitcnt vmcnt(19)
    s_add_u32 m0, s63, 19456
    s_nop 0
    buffer_load_dwordx4 v89, s[36:39], s60 offen nt lds
    s_add_u32 s60, s60, 32768
    s_add_u32 m0, s63, 20480
    s_nop 0
    buffer_load_dwordx4 v90, s[36:39], s60 offen nt lds
    s_add_u32 s60, s60, 32768
    s_add_u32 m0, s63, 21504
    s_nop 0
    buffer_load_dwordx4 v90, s[36:39], s60 offen nt lds
    s_add_u32 s60, s60, 32768
    s_add_u32 m0, s63, 22528
    s_nop 0
    buffer_load_dwordx4 v91, s[36:39], s60 offen nt lds
    s_add_u32 s60, s60, 32768
    s_add_u32 m0, s63, 23552
    s_nop 0
    buffer_load_dwordx4 v91, s[36:39], s60 offen nt lds
    s_add_u32 s60, s60, 32768
    s_add_u32 m0, s63, 24576
    s_nop 0
    buffer_load_dwordx4 v88, s[36:39], s60 offen nt lds
    s_add_u32 s60, s60, 32768
    s_add_u32 m0, s63, 25600
    s_nop 0
    buffer_load_dwordx4 v88, s[36:39], s60 offen nt lds
    s_add_u32 s60, s60, 32768
    s_add_u32 m0, s63, 26624
    s_nop 0
    buffer_load_dwordx4 v89, s[36:39], s60 offen nt lds
    s_add_u32 s60, s60, 32768
    s_add_u32 m0, s63, 27648
    s_nop 0
    buffer_load_dwordx4 v89, s[36:39], s60 offen nt lds
    s_add_u32 s60, s60, 32768
    v_perm_b32 v104, v61, v61, v9
    v_perm_b32 v105, v61, v61, v11
    v_perm_b32 v106, v61, v61, v13
    v_perm_b32 v107, v61, v61, v15
    s_nop 1
    v_mfma_f32_16x16x32_bf16 v[112:115], v[104:107], a[220:223], v[112:115]
    v_perm_b32 v108, v81, v81, v9
    v_perm_b32 v109, v81, v81, v11
    v_perm_b32 v110, v81, v81, v13
    v_perm_b32 v111, v81, v81, v15
    s_nop 1
    v_mfma_f32_16x16x32_bf16 v[116:119], v[108:111], a[220:223], v[116:119]
    v_perm_b32 v96, v62, v62, v8
    v_perm_b32 v97, v62, v62, v10
    v_perm_b32 v98, v62, v62, v12
    v_perm_b32 v99, v62, v62, v14
    s_nop 1
    v_mfma_f32_16x16x32_bf16 v[112:115], v[96:99], a[224:227], v[112:115]
    v_perm_b32 v100, v82, v82, v8
    v_perm_b32 v101, v82, v82, v10
    v_perm_b32 v102, v82, v82, v12
    v_perm_b32 v103, v82, v82, v14
    s_nop 1
    v_mfma_f32_16x16x32_bf16 v[116:119], v[100:103], a[224:227], v[116:119]
    v_perm_b32 v104, v62, v62, v9
    v_perm_b32 v105, v62, v62, v11
    v_perm_b32 v106, v62, v62, v13
    v_perm_b32 v107, v62, v62, v15
    s_nop 1
    v_mfma_f32_16x16x32_bf16 v[112:115], v[104:107], a[228:231], v[112:115]
    v_perm_b32 v108, v82, v82, v9
    v_perm_b32 v109, v82, v82, v11
    v_perm_b32 v110, v82, v82, v13
    v_perm_b32 v111, v82, v82, v15
    s_nop 1
    v_mfma_f32_16x16x32_bf16 v[116:119], v[108:111], a[228:231], v[116:119]
    v_perm_b32 v96, v63, v63, v8
    v_perm_b32 v97, v63, v63, v10
    v_perm_b32 v98, v63, v63, v12
    v_perm_b32 v99, v63, v63, v14
    s_nop 1
    v_mfma_f32_16x16x32_bf16 v[112:115], v[96:99], a[232:235], v[112:115]
    v_perm_b32 v100, v83, v83, v8
    v_perm_b32 v101, v83, v83, v10
    v_perm_b32 v102, v83, v83, v12
    v_perm_b32 v103, v83, v83, v14
    s_nop 1
    v_mfma_f32_16x16x32_bf16 v[116:119], v[100:103], a[232:235], v[116:119]
    v_perm_b32 v104, v63, v63, v9
    v_perm_b32 v105, v63, v63, v11
    v_perm_b32 v106, v63, v63, v13
    v_perm_b32 v107, v63, v63, v15
    s_nop 1
    v_mfma_f32_16x16x32_bf16 v[112:115], v[104:107], a[236:239], v[112:115]
    v_perm_b32 v108, v83, v83, v9
    v_perm_b32 v109, v83, v83, v11
    v_perm_b32 v110, v83, v83, v13
    v_perm_b32 v111, v83, v83, v15
    s_nop 1
    v_mfma_f32_16x16x32_bf16 v[116:119], v[108:111], a[236:239], v[116:119]
    v_perm_b32 v96, v64, v64, v8
    v_perm_b32 v97, v64, v64, v10
    v_perm_b32 v98, v64, v64, v12
    v_perm_b32 v99, v64, v64, v14
    s_nop 1
    v_mfma_f32_16x16x32_bf16 v[112:115], v[96:99], a[240:243], v[112:115]
    v_perm_b32 v100, v84, v84, v8
    v_perm_b32 v101, v84, v84, v10
    v_perm_b32 v102, v84, v84, v12
    v_perm_b32 v103, v84, v84, v14
    s_nop 1
    v_mfma_f32_16x16x32_bf16 v[116:119], v[100:103], a[240:243], v[116:119]
    v_perm_b32 v104, v64, v64, v9
    v_perm_b32 v105, v64, v64, v11
    v_perm_b32 v106, v64, v64, v13
    v_perm_b32 v107, v64, v64, v15
    s_nop 1
    v_mfma_f32_16x16x32_bf16 v[112:115], v[104:107], a[244:247], v[112:115]
    v_perm_b32 v108, v84, v84, v9
    v_perm_b32 v109, v84, v84, v11
    v_perm_b32 v110, v84, v84, v13
    v_perm_b32 v111, v84, v84, v15
    s_nop 1
    v_mfma_f32_16x16x32_bf16 v[116:119], v[108:111], a[244:247], v[116:119]
    v_perm_b32 v96, v65, v65, v8
    v_perm_b32 v97, v65, v65, v10
    v_perm_b32 v98, v65, v65, v12
    v_perm_b32 v99, v65, v65, v14
    s_nop 1
    v_mfma_f32_16x16x32_bf16 v[112:115], v[96:99], a[248:251], v[112:115]
    v_perm_b32 v100, v85, v85, v8
    v_perm_b32 v101, v85, v85, v10
    v_perm_b32 v102, v85, v85, v12
    v_perm_b32 v103, v85, v85, v14
    s_nop 1
    v_mfma_f32_16x16x32_bf16 v[116:119], v[100:103], a[248:251], v[116:119]
    v_perm_b32 v104, v65, v65, v9
    v_perm_b32 v105, v65, v65, v11
    v_perm_b32 v106, v65, v65, v13
    v_perm_b32 v107, v65, v65, v15
    s_nop 1
    v_mfma_f32_16x16x32_bf16 v[112:115], v[104:107], a[252:255], v[112:115]
    v_perm_b32 v108, v85, v85, v9
    v_perm_b32 v109, v85, v85, v11
    v_perm_b32 v110, v85, v85, v13
    v_perm_b32 v111, v85, v85, v15
    s_nop 1
    v_mfma_f32_16x16x32_bf16 v[116:119], v[108:111], a[252:255], v[116:119]
    v_lshrrev_b32 v5, 1, v4
    v_lshlrev_b32 v5, 9, v5
    v_lshl_add_u32 v5, v3, 5, v5
    v_and_b32 v6, 1, v4
    v_lshl_add_u32 v5, v6, 4, v5
    s_lshl_b32 s54, s3, 11
    s_add_u32 s54, s54, 131072
    v_add_u32 v5, s54, v5
    ds_write_b128 v5, v[112:115]
    ds_write_b128 v5, v[116:119] offset:1024
    s_waitcnt lgkmcnt(0)
    s_barrier
    s_add_u32 m0, s63, 28672
    s_nop 0
    buffer_load_dwordx4 v90, s[36:39], s60 offen nt lds
    s_add_u32 s60, s60, 32768
    s_add_u32 m0, s63, 29696
    s_nop 0
    buffer_load_dwordx4 v90, s[36:39], s60 offen nt lds
    s_add_u32 s60, s60, 32768
    s_add_u32 m0, s63, 30720
    s_nop 0
    buffer_load_dwordx4 v91, s[36:39], s60 offen nt lds
    s_add_u32 s60, s60, 32768
    s_add_u32 m0, s63, 31744
    s_nop 0
    buffer_load_dwordx4 v91, s[36:39], s60 offen nt lds
    s_add_u32 s60, s60, 32768
    v_lshrrev_b32 v5, 2, v3
    v_lshlrev_b32 v5, 9, v5
    v_lshl_add_u32 v5, v4, 5, v5
    v_add_u32 v5, 131072, v5
    ds_read_b128 v[48:51], v5 offset:0
    ds_read_b128 v[52:55], v5 offset:16
    ds_read_b128 v[56:59], v5 offset:2048
    ds_read_b128 v[60:63], v5 offset:2064
    ds_read_b128 v[64:67], v5 offset:4096
    ds_read_b128 v[68:71], v5 offset:4112
    ds_read_b128 v[72:75], v5 offset:6144
    ds_read_b128 v[76:79], v5 offset:6160
    s_waitcnt lgkmcnt(0)
    v_add_f32 v48, v48, v56
    v_add_f32 v64, v64, v72
    v_add_f32 v49, v49, v57
    v_add_f32 v65, v65, v73
    v_add_f32 v50, v50, v58
    v_add_f32 v66, v66, v74
    v_add_f32 v51, v51, v59
    v_add_f32 v67, v67, v75
    v_add_f32 v52, v52, v60
    v_add_f32 v68, v68, v76
    v_add_f32 v53, v53, v61
    v_add_f32 v69, v69, v77
    v_add_f32 v54, v54, v62
    v_add_f32 v70, v70, v78
    v_add_f32 v55, v55, v63
    v_add_f32 v71, v71, v79
    v_add_f32 v48, v48, v64
    v_add_f32 v49, v49, v65
    v_add_f32 v50, v50, v66
    v_add_f32 v51, v51, v67
    v_add_f32 v52, v52, v68
    v_add_f32 v53, v53, v69
    v_add_f32 v54, v54, v70
    v_add_f32 v55, v55, v71
    v_cvt_pk_bf16_f32 v96, v48, v49
    v_cvt_pk_bf16_f32 v97, v50, v51
    v_cvt_pk_bf16_f32 v98, v52, v53
    v_cvt_pk_bf16_f32 v99, v54, v55
    ds_read_b128 v[48:51], v5 offset:128
    ds_read_b128 v[52:55], v5 offset:144
    ds_read_b128 v[56:59], v5 offset:2176
    ds_read_b128 v[60:63], v5 offset:2192
    ds_read_b128 v[64:67], v5 offset:4224
    ds_read_b128 v[68:71], v5 offset:4240
    ds_read_b128 v[72:75], v5 offset:6272
    ds_read_b128 v[76:79], v5 offset:6288
    s_waitcnt lgkmcnt(0)
    v_add_f32 v48, v48, v56
    v_add_f32 v64, v64, v72
    v_add_f32 v49, v49, v57
    v_add_f32 v65, v65, v73
    v_add_f32 v50, v50, v58
    v_add_f32 v66, v66, v74
    v_add_f32 v51, v51, v59
    v_add_f32 v67, v67, v75
    v_add_f32 v52, v52, v60
    v_add_f32 v68, v68, v76
    v_add_f32 v53, v53, v61
    v_add_f32 v69, v69, v77
    v_add_f32 v54, v54, v62
    v_add_f32 v70, v70, v78
    v_add_f32 v55, v55, v63
    v_add_f32 v71, v71, v79
    v_add_f32 v48, v48, v64
    v_add_f32 v49, v49, v65
    v_add_f32 v50, v50, v66
    v_add_f32 v51, v51, v67
    v_add_f32 v52, v52, v68
    v_add_f32 v53, v53, v69
    v_add_f32 v54, v54, v70
    v_add_f32 v55, v55, v71
    v_cvt_pk_bf16_f32 v100, v48, v49
    v_cvt_pk_bf16_f32 v101, v50, v51
    v_cvt_pk_bf16_f32 v102, v52, v53
    v_cvt_pk_bf16_f32 v103, v54, v55
    ds_read_b128 v[48:51], v5 offset:256
    ds_read_b128 v[52:55], v5 offset:272
    ds_read_b128 v[56:59], v5 offset:2304
    ds_read_b128 v[60:63], v5 offset:2320
    ds_read_b128 v[64:67], v5 offset:4352
    ds_read_b128 v[68:71], v5 offset:4368
    ds_read_b128 v[72:75], v5 offset:6400
    ds_read_b128 v[76:79], v5 offset:6416
    s_waitcnt lgkmcnt(0)
    v_add_f32 v48, v48, v56
    v_add_f32 v64, v64, v72
    v_add_f32 v49, v49, v57
    v_add_f32 v65, v65, v73
    v_add_f32 v50, v50, v58
    v_add_f32 v66, v66, v74
    v_add_f32 v51, v51, v59
    v_add_f32 v67, v67, v75
    v_add_f32 v52, v52, v60
    v_add_f32 v68, v68, v76
    v_add_f32 v53, v53, v61
    v_add_f32 v69, v69, v77
    v_add_f32 v54, v54, v62
    v_add_f32 v70, v70, v78
    v_add_f32 v55, v55, v63
    v_add_f32 v71, v71, v79
    v_add_f32 v48, v48, v64
    v_add_f32 v49, v49, v65
    v_add_f32 v50, v50, v66
    v_add_f32 v51, v51, v67
    v_add_f32 v52, v52, v68
    v_add_f32 v53, v53, v69
    v_add_f32 v54, v54, v70
    v_add_f32 v55, v55, v71
    v_cvt_pk_bf16_f32 v104, v48, v49
    v_cvt_pk_bf16_f32 v105, v50, v51
    v_cvt_pk_bf16_f32 v106, v52, v53
    v_cvt_pk_bf16_f32 v107, v54, v55
    ds_read_b128 v[48:51], v5 offset:384
    ds_read_b128 v[52:55], v5 offset:400
    ds_read_b128 v[56:59], v5 offset:2432
    ds_read_b128 v[60:63], v5 offset:2448
    ds_read_b128 v[64:67], v5 offset:4480
    ds_read_b128 v[68:71], v5 offset:4496
    ds_read_b128 v[72:75], v5 offset:6528
    ds_read_b128 v[76:79], v5 offset:6544
    s_waitcnt lgkmcnt(0)
    v_add_f32 v48, v48, v56
    v_add_f32 v64, v64, v72
    v_add_f32 v49, v49, v57
    v_add_f32 v65, v65, v73
    v_add_f32 v50, v50, v58
    v_add_f32 v66, v66, v74
    v_add_f32 v51, v51, v59
    v_add_f32 v67, v67, v75
    v_add_f32 v52, v52, v60
    v_add_f32 v68, v68, v76
    v_add_f32 v53, v53, v61
    v_add_f32 v69, v69, v77
    v_add_f32 v54, v54, v62
    v_add_f32 v70, v70, v78
    v_add_f32 v55, v55, v63
    v_add_f32 v71, v71, v79
    v_add_f32 v48, v48, v64
    v_add_f32 v49, v49, v65
    v_add_f32 v50, v50, v66
    v_add_f32 v51, v51, v67
    v_add_f32 v52, v52, v68
    v_add_f32 v53, v53, v69
    v_add_f32 v54, v54, v70
    v_add_f32 v55, v55, v71
    v_cvt_pk_bf16_f32 v108, v48, v49
    v_cvt_pk_bf16_f32 v109, v50, v51
    v_cvt_pk_bf16_f32 v110, v52, v53
    v_cvt_pk_bf16_f32 v111, v54, v55
    s_waitcnt vmcnt(24)
    ds_read_b128 v[128:131], v92 offset:0
    ds_read_b128 v[132:135], v93 offset:0
    ds_read_b128 v[136:139], v94 offset:0
    ds_read_b128 v[140:143], v95 offset:0
    ds_read_b128 v[144:147], v92 offset:1024
    ds_read_b128 v[148:151], v93 offset:1024
    ds_read_b128 v[152:155], v94 offset:1024
    ds_read_b128 v[156:159], v95 offset:1024
    s_waitcnt lgkmcnt(7)
    v_mfma_f32_16x16x32_bf16 v[48:51], v[128:131], v[96:99], 0
    s_waitcnt lgkmcnt(6)
    v_mfma_f32_16x16x32_bf16 v[48:51], v[132:135], v[100:103], v[48:51]
    s_waitcnt lgkmcnt(5)
    v_mfma_f32_16x16x32_bf16 v[48:51], v[136:139], v[104:107], v[48:51]
    s_waitcnt lgkmcnt(4)
    v_mfma_f32_16x16x32_bf16 v[48:51], v[140:143], v[108:111], v[48:51]
    s_waitcnt lgkmcnt(3)
    v_mfma_f32_16x16x32_bf16 v[52:55], v[144:147], v[96:99], 0
    s_waitcnt lgkmcnt(2)
    v_mfma_f32_16x16x32_bf16 v[52:55], v[148:151], v[100:103], v[52:55]
    s_waitcnt lgkmcnt(1)
    v_mfma_f32_16x16x32_bf16 v[52:55], v[152:155], v[104:107], v[52:55]
    s_waitcnt lgkmcnt(0)
    v_mfma_f32_16x16x32_bf16 v[52:55], v[156:159], v[108:111], v[52:55]
    s_waitcnt vmcnt(16)
    ds_read_b128 v[160:163], v92 offset:8192
    ds_read_b128 v[164:167], v93 offset:8192
    ds_read_b128 v[168:171], v94 offset:8192
    ds_read_b128 v[172:175], v95 offset:8192
    ds_read_b128 v[176:179], v92 offset:9216
    ds_read_b128 v[180:183], v93 offset:9216
    ds_read_b128 v[184:187], v94 offset:9216
    ds_read_b128 v[188:191], v95 offset:9216
    s_waitcnt lgkmcnt(7)
    v_mfma_f32_16x16x32_bf16 v[56:59], v[160:163], v[96:99], 0
    s_waitcnt lgkmcnt(6)
    v_mfma_f32_16x16x32_bf16 v[56:59], v[164:167], v[100:103], v[56:59]
    s_waitcnt lgkmcnt(5)
    v_mfma_f32_16x16x32_bf16 v[56:59], v[168:171], v[104:107], v[56:59]
    s_waitcnt lgkmcnt(4)
    v_mfma_f32_16x16x32_bf16 v[56:59], v[172:175], v[108:111], v[56:59]
    s_waitcnt lgkmcnt(3)
    v_mfma_f32_16x16x32_bf16 v[60:63], v[176:179], v[96:99], 0
    s_waitcnt lgkmcnt(2)
    v_mfma_f32_16x16x32_bf16 v[60:63], v[180:183], v[100:103], v[60:63]
    s_waitcnt lgkmcnt(1)
    v_mfma_f32_16x16x32_bf16 v[60:63], v[184:187], v[104:107], v[60:63]
    s_waitcnt lgkmcnt(0)
    v_mfma_f32_16x16x32_bf16 v[60:63], v[188:191], v[108:111], v[60:63]
    s_waitcnt vmcnt(8)
    ds_read_b128 v[128:131], v92 offset:16384
    ds_read_b128 v[132:135], v93 offset:16384
    ds_read_b128 v[136:139], v94 offset:16384
    ds_read_b128 v[140:143], v95 offset:16384
    ds_read_b128 v[144:147], v92 offset:17408
    ds_read_b128 v[148:151], v93 offset:17408
    ds_read_b128 v[152:155], v94 offset:17408
    ds_read_b128 v[156:159], v95 offset:17408
    s_waitcnt lgkmcnt(7)
    v_mfma_f32_16x16x32_bf16 v[64:67], v[128:131], v[96:99], 0
    s_waitcnt lgkmcnt(6)
    v_mfma_f32_16x16x32_bf16 v[64:67], v[132:135], v[100:103], v[64:67]
    s_waitcnt lgkmcnt(5)
    v_mfma_f32_16x16x32_bf16 v[64:67], v[136:139], v[104:107], v[64:67]
    s_waitcnt lgkmcnt(4)
    v_mfma_f32_16x16x32_bf16 v[64:67], v[140:143], v[108:111], v[64:67]
    s_waitcnt lgkmcnt(3)
    v_mfma_f32_16x16x32_bf16 v[68:71], v[144:147], v[96:99], 0
    s_waitcnt lgkmcnt(2)
    v_mfma_f32_16x16x32_bf16 v[68:71], v[148:151], v[100:103], v[68:71]
    s_waitcnt lgkmcnt(1)
    v_mfma_f32_16x16x32_bf16 v[68:71], v[152:155], v[104:107], v[68:71]
    s_waitcnt lgkmcnt(0)
    v_mfma_f32_16x16x32_bf16 v[68:71], v[156:159], v[108:111], v[68:71]
    s_waitcnt vmcnt(0)
    ds_read_b128 v[160:163], v92 offset:24576
    ds_read_b128 v[164:167], v93 offset:24576
    ds_read_b128 v[168:171], v94 offset:24576
    ds_read_b128 v[172:175], v95 offset:24576
    ds_read_b128 v[176:179], v92 offset:25600
    ds_read_b128 v[180:183], v93 offset:25600
    ds_read_b128 v[184:187], v94 offset:25600
    ds_read_b128 v[188:191], v95 offset:25600
    s_waitcnt lgkmcnt(7)
    v_mfma_f32_16x16x32_bf16 v[72:75], v[160:163], v[96:99], 0
    s_waitcnt lgkmcnt(6)
    v_mfma_f32_16x16x32_bf16 v[72:75], v[164:167], v[100:103], v[72:75]
    s_waitcnt lgkmcnt(5)
    v_mfma_f32_16x16x32_bf16 v[72:75], v[168:171], v[104:107], v[72:75]
    s_waitcnt lgkmcnt(4)
    v_mfma_f32_16x16x32_bf16 v[72:75], v[172:175], v[108:111], v[72:75]
    s_waitcnt lgkmcnt(3)
    v_mfma_f32_16x16x32_bf16 v[76:79], v[176:179], v[96:99], 0
    s_waitcnt lgkmcnt(2)
    v_mfma_f32_16x16x32_bf16 v[76:79], v[180:183], v[100:103], v[76:79]
    s_waitcnt lgkmcnt(1)
    v_mfma_f32_16x16x32_bf16 v[76:79], v[184:187], v[104:107], v[76:79]
    s_waitcnt lgkmcnt(0)
    v_mfma_f32_16x16x32_bf16 v[76:79], v[188:191], v[108:111], v[76:79]
    s_mov_b32 s96, 1040356334
    v_and_b32 v6, 3, v3
    v_cmp_eq_u32 vcc, 1, v6
    s_nop 1
    v_cndmask_b32 v48, v48, v56, vcc
    v_cndmask_b32 v49, v49, v57, vcc
    v_cndmask_b32 v50, v50, v58, vcc
    v_cndmask_b32 v51, v51, v59, vcc
    v_cndmask_b32 v52, v52, v60, vcc
    v_cndmask_b32 v53, v53, v61, vcc
    v_cndmask_b32 v54, v54, v62, vcc
    v_cndmask_b32 v55, v55, v63, vcc
    v_cmp_eq_u32 vcc, 2, v6
    s_nop 1
    v_cndmask_b32 v48, v48, v64, vcc
    v_cndmask_b32 v49, v49, v65, vcc
    v_cndmask_b32 v50, v50, v66, vcc
    v_cndmask_b32 v51, v51, v67, vcc
    v_cndmask_b32 v52, v52, v68, vcc
    v_cndmask_b32 v53, v53, v69, vcc
    v_cndmask_b32 v54, v54, v70, vcc
    v_cndmask_b32 v55, v55, v71, vcc
    v_cmp_eq_u32 vcc, 3, v6
    s_nop 1
    v_cndmask_b32 v48, v48, v72, vcc
    v_cndmask_b32 v49, v49, v73, vcc
    v_cndmask_b32 v50, v50, v74, vcc
    v_cndmask_b32 v51, v51, v75, vcc
    v_cndmask_b32 v52, v52, v76, vcc
    v_cndmask_b32 v53, v53, v77, vcc
    v_cndmask_b32 v54, v54, v78, vcc
    v_cndmask_b32 v55, v55, v79, vcc
    v_mul_f32 v48, s96, v48
    v_mul_f32 v49, s96, v49
    v_mul_f32 v50, s96, v50
    v_mul_f32 v51, s96, v51
    v_mul_f32 v52, s96, v52
    v_mul_f32 v53, s96, v53
    v_mul_f32 v54, s96, v54
    v_mul_f32 v55, s96, v55
    v_cvt_pk_bf16_f32 v24, v48, v49
    v_cvt_pk_bf16_f32 v25, v50, v51
    v_cvt_pk_bf16_f32 v26, v52, v53
    v_cvt_pk_bf16_f32 v27, v54, v55
    v_min_u32 v24, -2, v24
    v_min_u32 v25, -2, v25
    v_min_u32 v26, -2, v26
    v_min_u32 v27, -2, v27
    v_lshrrev_b32 v5, 2, v3
    v_lshlrev_b32 v5, 15, v5
    v_lshl_add_u32 v5, v4, 4, v5
    v_and_b32 v6, 3, v3
    v_lshl_add_u32 v5, v6, 6, v5
    s_lshl_b32 s54, s52, 10
    s_lshl_b32 s55, s3, 8
    s_add_u32 s54, s54, s55
    s_add_u32 s54, s54, 1048576
    buffer_store_dwordx4 v[24:27], v5, s[44:47], s54 offen sc1
    buffer_load_dwordx4 a[0:3], v121, s[40:43], s62 offen nt
    s_add_u32 s62, s62, 8192
    buffer_load_dwordx4 a[4:7], v121, s[40:43], s62 offen nt
    s_add_u32 s62, s62, 8192
    buffer_load_dwordx4 a[8:11], v121, s[40:43], s62 offen nt
    s_add_u32 s62, s62, 8192
    buffer_load_dwordx4 a[12:15], v121, s[40:43], s62 offen nt
    s_add_u32 s62, s62, 8192
    buffer_load_dwordx4 a[16:19], v121, s[40:43], s62 offen nt
    s_add_u32 s62, s62, 8192
    buffer_load_dwordx4 a[20:23], v121, s[40:43], s62 offen nt
    s_add_u32 s62, s62, 8192
    buffer_load_dwordx4 a[24:27], v121, s[40:43], s62 offen nt
    s_add_u32 s62, s62, 8192
    buffer_load_dwordx4 a[28:31], v121, s[40:43], s62 offen nt
    s_add_u32 s62, s62, 8192
    buffer_load_dwordx4 a[32:35], v121, s[40:43], s62 offen nt
    s_add_u32 s62, s62, 8192
    buffer_load_dwordx4 a[36:39], v121, s[40:43], s62 offen nt
    s_add_u32 s62, s62, 8192
    buffer_load_dwordx4 a[40:43], v121, s[40:43], s62 offen nt
    s_add_u32 s62, s62, 8192
    buffer_load_dwordx4 a[44:47], v121, s[40:43], s62 offen nt
    s_add_u32 s62, s62, 8192
    buffer_load_dwordx4 a[48:51], v121, s[40:43], s62 offen nt
    s_add_u32 s62, s62, 8192
    buffer_load_dwordx4 a[52:55], v121, s[40:43], s62 offen nt
    s_add_u32 s62, s62, 8192
    buffer_load_dwordx4 a[56:59], v121, s[40:43], s62 offen nt
    s_add_u32 s62, s62, 8192
    buffer_load_dwordx4 a[60:63], v121, s[40:43], s62 offen nt
    s_add_u32 s62, s62, 8192
    buffer_load_dwordx4 a[64:67], v121, s[40:43], s62 offen nt
    s_add_u32 s62, s62, 8192
    buffer_load_dwordx4 a[68:71], v121, s[40:43], s62 offen nt
    s_add_u32 s62, s62, 8192
    buffer_load_dwordx4 a[72:75], v121, s[40:43], s62 offen nt
    s_add_u32 s62, s62, 8192
    buffer_load_dwordx4 a[76:79], v121, s[40:43], s62 offen nt
    s_add_u32 s62, s62, 8192
    buffer_load_dwordx4 a[80:83], v121, s[40:43], s62 offen nt
    s_add_u32 s62, s62, 8192
    buffer_load_dwordx4 a[84:87], v121, s[40:43], s62 offen nt
    s_add_u32 s62, s62, 8192
    buffer_load_dwordx4 a[88:91], v121, s[40:43], s62 offen nt
    s_add_u32 s62, s62, 8192
    buffer_load_dwordx4 a[92:95], v121, s[40:43], s62 offen nt
    s_add_u32 s62, s62, 8192
    buffer_load_dwordx4 a[96:99], v121, s[40:43], s62 offen nt
    s_add_u32 s62, s62, 8192
    buffer_load_dwordx4 a[100:103], v121, s[40:43], s62 offen nt
    s_add_u32 s62, s62, 8192
    buffer_load_dwordx4 a[104:107], v121, s[40:43], s62 offen nt
    s_add_u32 s62, s62, 8192
    buffer_load_dwordx4 a[108:111], v121, s[40:43], s62 offen nt
    s_add_u32 s62, s62, 8192
    buffer_load_dwordx4 a[112:115], v121, s[40:43], s62 offen nt
    s_add_u32 s62, s62, 8192
    buffer_load_dwordx4 a[116:119], v121, s[40:43], s62 offen nt
    s_add_u32 s62, s62, 8192
    buffer_load_dwordx4 a[120:123], v121, s[40:43], s62 offen nt
    s_add_u32 s62, s62, 8192
    buffer_load_dwordx4 a[124:127], v121, s[40:43], s62 offen nt
    s_add_u32 s62, s62, 8192
    v_mov_b32 v16, 0
    global_load_dword v17, v16, s[28:29] sc1
    s_waitcnt vmcnt(0)
    s_barrier
L_flags_24:
    v_cmp_gt_u32 vcc, 1073741824, v17
    s_cbranch_vccz L_flagsok_25
    s_sleep 2
    global_load_dword v17, v16, s[28:29] sc1
    s_waitcnt vmcnt(0)
    s_sub_u32 s101, s101, 1
    s_cbranch_scc0 L_flags_24
    s_mov_b32 s101, 0
L_flagsok_25:
    s_lshl_b32 s58, s3, 18
    s_lshl_b32 s54, s52, 10
    s_add_u32 s58, s58, s54
    s_add_u32 s58, s58, 2097152
    s_lshl_b32 s59, s3, 11
    s_lshl_b32 s54, s52, 3
    s_add_u32 s59, s59, s54
    s_add_u32 s59, s59, 3145728
    s_mov_b32 s98, 0xffff0000
    v_and_b32 v5, 7, v1
    v_lshlrev_b32 v5, 8, v5
L_blight_26:
    buffer_load_dwordx2 v[232:233], v5, s[44:47], s59 offen sc1
    s_waitcnt vmcnt(0)
    v_max_u32 v6, v232, v233
    v_cmp_eq_u32 vcc, -1, v6
    s_cbranch_vccz L_bheavy_27
    s_sleep 2
    s_sub_u32 s101, s101, 1
    s_cbranch_scc0 L_blight_26
    s_mov_b32 s101, 0
L_bheavy_27:
    buffer_load_dwordx4 v[16:19], v2, s[44:47], s58 offen sc1 nt
    s_add_u32 s58, s58, 32768
    buffer_load_dwordx4 v[20:23], v2, s[44:47], s58 offen sc1 nt
    s_add_u32 s58, s58, 32768
    buffer_load_dwordx4 v[24:27], v2, s[44:47], s58 offen sc1 nt
    s_add_u32 s58, s58, 32768
    buffer_load_dwordx4 v[28:31], v2, s[44:47], s58 offen sc1 nt
    s_add_u32 s58, s58, 32768
    buffer_load_dwordx4 v[32:35], v2, s[44:47], s58 offen sc1 nt
    s_add_u32 s58, s58, 32768
    buffer_load_dwordx4 v[36:39], v2, s[44:47], s58 offen sc1 nt
    s_add_u32 s58, s58, 32768
    buffer_load_dwordx4 v[40:43], v2, s[44:47], s58 offen sc1 nt
    s_add_u32 s58, s58, 32768
    buffer_load_dwordx4 v[44:47], v2, s[44:47], s58 offen sc1 nt
    s_add_u32 s58, s58, 32768
    v_max_f32_dpp v234, v232, v232 row_ror:1 row_mask:0xf bank_mask:0xf
    s_nop 1
    v_max_f32_dpp v234, v234, v234 row_ror:2 row_mask:0xf bank_mask:0xf
    s_nop 1
    v_max_f32_dpp v234, v234, v234 row_ror:4 row_mask:0xf bank_mask:0xf
    v_sub_f32 v232, v232, v234
    v_exp_f32 v232, v232
    s_nop 0
    v_mul_f32 v232, v232, v233
    s_nop 1
    v_add_f32_dpp v234, v232, v232 row_ror:1 row_mask:0xf bank_mask:0xf
    s_nop 1
    v_add_f32_dpp v234, v234, v234 row_ror:2 row_mask:0xf bank_mask:0xf
    s_nop 1
    v_add_f32_dpp v234, v234, v234 row_ror:4 row_mask:0xf bank_mask:0xf
    v_rcp_f32 v234, v234
    s_nop 0
    v_mul_f32 v232, v232, v234
    s_waitcnt vmcnt(7)
    v_lshlrev_b32 v240, 16, v16
    v_and_b32 v16, s98, v16
    v_lshlrev_b32 v241, 16, v17
    v_and_b32 v17, s98, v17
    v_lshlrev_b32 v242, 16, v18
    v_and_b32 v18, s98, v18
    v_lshlrev_b32 v243, 16, v19
    v_and_b32 v19, s98, v19
    v_mul_f32_dpp v224, v232, v240 row_newbcast:0 row_mask:0xf bank_mask:0xf
    v_mul_f32_dpp v225, v232, v16 row_newbcast:0 row_mask:0xf bank_mask:0xf
    v_mul_f32_dpp v226, v232, v241 row_newbcast:0 row_mask:0xf bank_mask:0xf
    v_mul_f32_dpp v227, v232, v17 row_newbcast:0 row_mask:0xf bank_mask:0xf
    v_mul_f32_dpp v228, v232, v242 row_newbcast:0 row_mask:0xf bank_mask:0xf
    v_mul_f32_dpp v229, v232, v18 row_newbcast:0 row_mask:0xf bank_mask:0xf
    v_mul_f32_dpp v230, v232, v243 row_newbcast:0 row_mask:0xf bank_mask:0xf
    v_mul_f32_dpp v231, v232, v19 row_newbcast:0 row_mask:0xf bank_mask:0xf
    s_waitcnt vmcnt(6)
    v_lshlrev_b32 v240, 16, v20
    v_and_b32 v20, s98, v20
    v_lshlrev_b32 v241, 16, v21
    v_and_b32 v21, s98, v21
    v_lshlrev_b32 v242, 16, v22
    v_and_b32 v22, s98, v22
    v_lshlrev_b32 v243, 16, v23
    v_and_b32 v23, s98, v23
    v_fmac_f32_dpp v224, v232, v240 row_newbcast:1 row_mask:0xf bank_mask:0xf
    v_fmac_f32_dpp v225, v232, v20 row_newbcast:1 row_mask:0xf bank_mask:0xf
    v_fmac_f32_dpp v226, v232, v241 row_newbcast:1 row_mask:0xf bank_mask:0xf
    v_fmac_f32_dpp v227, v232, v21 row_newbcast:1 row_mask:0xf bank_mask:0xf
    v_fmac_f32_dpp v228, v232, v242 row_newbcast:1 row_mask:0xf bank_mask:0xf
    v_fmac_f32_dpp v229, v232, v22 row_newbcast:1 row_mask:0xf bank_mask:0xf
    v_fmac_f32_dpp v230, v232, v243 row_newbcast:1 row_mask:0xf bank_mask:0xf
    v_fmac_f32_dpp v231, v232, v23 row_newbcast:1 row_mask:0xf bank_mask:0xf
    s_waitcnt vmcnt(5)
    v_lshlrev_b32 v240, 16, v24
    v_and_b32 v24, s98, v24
    v_lshlrev_b32 v241, 16, v25
    v_and_b32 v25, s98, v25
    v_lshlrev_b32 v242, 16, v26
    v_and_b32 v26, s98, v26
    v_lshlrev_b32 v243, 16, v27
    v_and_b32 v27, s98, v27
    v_fmac_f32_dpp v224, v232, v240 row_newbcast:2 row_mask:0xf bank_mask:0xf
    v_fmac_f32_dpp v225, v232, v24 row_newbcast:2 row_mask:0xf bank_mask:0xf
    v_fmac_f32_dpp v226, v232, v241 row_newbcast:2 row_mask:0xf bank_mask:0xf
    v_fmac_f32_dpp v227, v232, v25 row_newbcast:2 row_mask:0xf bank_mask:0xf
    v_fmac_f32_dpp v228, v232, v242 row_newbcast:2 row_mask:0xf bank_mask:0xf
    v_fmac_f32_dpp v229, v232, v26 row_newbcast:2 row_mask:0xf bank_mask:0xf
    v_fmac_f32_dpp v230, v232, v243 row_newbcast:2 row_mask:0xf bank_mask:0xf
    v_fmac_f32_dpp v231, v232, v27 row_newbcast:2 row_mask:0xf bank_mask:0xf
    s_waitcnt vmcnt(4)
    v_lshlrev_b32 v240, 16, v28
    v_and_b32 v28, s98, v28
    v_lshlrev_b32 v241, 16, v29
    v_and_b32 v29, s98, v29
    v_lshlrev_b32 v242, 16, v30
    v_and_b32 v30, s98, v30
    v_lshlrev_b32 v243, 16, v31
    v_and_b32 v31, s98, v31
    v_fmac_f32_dpp v224, v232, v240 row_newbcast:3 row_mask:0xf bank_mask:0xf
    v_fmac_f32_dpp v225, v232, v28 row_newbcast:3 row_mask:0xf bank_mask:0xf
    v_fmac_f32_dpp v226, v232, v241 row_newbcast:3 row_mask:0xf bank_mask:0xf
    v_fmac_f32_dpp v227, v232, v29 row_newbcast:3 row_mask:0xf bank_mask:0xf
    v_fmac_f32_dpp v228, v232, v242 row_newbcast:3 row_mask:0xf bank_mask:0xf
    v_fmac_f32_dpp v229, v232, v30 row_newbcast:3 row_mask:0xf bank_mask:0xf
    v_fmac_f32_dpp v230, v232, v243 row_newbcast:3 row_mask:0xf bank_mask:0xf
    v_fmac_f32_dpp v231, v232, v31 row_newbcast:3 row_mask:0xf bank_mask:0xf
    s_waitcnt vmcnt(3)
    v_lshlrev_b32 v240, 16, v32
    v_and_b32 v32, s98, v32
    v_lshlrev_b32 v241, 16, v33
    v_and_b32 v33, s98, v33
    v_lshlrev_b32 v242, 16, v34
    v_and_b32 v34, s98, v34
    v_lshlrev_b32 v243, 16, v35
    v_and_b32 v35, s98, v35
    v_fmac_f32_dpp v224, v232, v240 row_newbcast:4 row_mask:0xf bank_mask:0xf
    v_fmac_f32_dpp v225, v232, v32 row_newbcast:4 row_mask:0xf bank_mask:0xf
    v_fmac_f32_dpp v226, v232, v241 row_newbcast:4 row_mask:0xf bank_mask:0xf
    v_fmac_f32_dpp v227, v232, v33 row_newbcast:4 row_mask:0xf bank_mask:0xf
    v_fmac_f32_dpp v228, v232, v242 row_newbcast:4 row_mask:0xf bank_mask:0xf
    v_fmac_f32_dpp v229, v232, v34 row_newbcast:4 row_mask:0xf bank_mask:0xf
    v_fmac_f32_dpp v230, v232, v243 row_newbcast:4 row_mask:0xf bank_mask:0xf
    v_fmac_f32_dpp v231, v232, v35 row_newbcast:4 row_mask:0xf bank_mask:0xf
    s_waitcnt vmcnt(2)
    v_lshlrev_b32 v240, 16, v36
    v_and_b32 v36, s98, v36
    v_lshlrev_b32 v241, 16, v37
    v_and_b32 v37, s98, v37
    v_lshlrev_b32 v242, 16, v38
    v_and_b32 v38, s98, v38
    v_lshlrev_b32 v243, 16, v39
    v_and_b32 v39, s98, v39
    v_fmac_f32_dpp v224, v232, v240 row_newbcast:5 row_mask:0xf bank_mask:0xf
    v_fmac_f32_dpp v225, v232, v36 row_newbcast:5 row_mask:0xf bank_mask:0xf
    v_fmac_f32_dpp v226, v232, v241 row_newbcast:5 row_mask:0xf bank_mask:0xf
    v_fmac_f32_dpp v227, v232, v37 row_newbcast:5 row_mask:0xf bank_mask:0xf
    v_fmac_f32_dpp v228, v232, v242 row_newbcast:5 row_mask:0xf bank_mask:0xf
    v_fmac_f32_dpp v229, v232, v38 row_newbcast:5 row_mask:0xf bank_mask:0xf
    v_fmac_f32_dpp v230, v232, v243 row_newbcast:5 row_mask:0xf bank_mask:0xf
    v_fmac_f32_dpp v231, v232, v39 row_newbcast:5 row_mask:0xf bank_mask:0xf
    s_waitcnt vmcnt(1)
    v_lshlrev_b32 v240, 16, v40
    v_and_b32 v40, s98, v40
    v_lshlrev_b32 v241, 16, v41
    v_and_b32 v41, s98, v41
    v_lshlrev_b32 v242, 16, v42
    v_and_b32 v42, s98, v42
    v_lshlrev_b32 v243, 16, v43
    v_and_b32 v43, s98, v43
    v_fmac_f32_dpp v224, v232, v240 row_newbcast:6 row_mask:0xf bank_mask:0xf
    v_fmac_f32_dpp v225, v232, v40 row_newbcast:6 row_mask:0xf bank_mask:0xf
    v_fmac_f32_dpp v226, v232, v241 row_newbcast:6 row_mask:0xf bank_mask:0xf
    v_fmac_f32_dpp v227, v232, v41 row_newbcast:6 row_mask:0xf bank_mask:0xf
    v_fmac_f32_dpp v228, v232, v242 row_newbcast:6 row_mask:0xf bank_mask:0xf
    v_fmac_f32_dpp v229, v232, v42 row_newbcast:6 row_mask:0xf bank_mask:0xf
    v_fmac_f32_dpp v230, v232, v243 row_newbcast:6 row_mask:0xf bank_mask:0xf
    v_fmac_f32_dpp v231, v232, v43 row_newbcast:6 row_mask:0xf bank_mask:0xf
    s_waitcnt vmcnt(0)
    v_lshlrev_b32 v240, 16, v44
    v_and_b32 v44, s98, v44
    v_lshlrev_b32 v241, 16, v45
    v_and_b32 v45, s98, v45
    v_lshlrev_b32 v242, 16, v46
    v_and_b32 v46, s98, v46
    v_lshlrev_b32 v243, 16, v47
    v_and_b32 v47, s98, v47
    v_fmac_f32_dpp v224, v232, v240 row_newbcast:7 row_mask:0xf bank_mask:0xf
    v_fmac_f32_dpp v225, v232, v44 row_newbcast:7 row_mask:0xf bank_mask:0xf
    v_fmac_f32_dpp v226, v232, v241 row_newbcast:7 row_mask:0xf bank_mask:0xf
    v_fmac_f32_dpp v227, v232, v45 row_newbcast:7 row_mask:0xf bank_mask:0xf
    v_fmac_f32_dpp v228, v232, v242 row_newbcast:7 row_mask:0xf bank_mask:0xf
    v_fmac_f32_dpp v229, v232, v46 row_newbcast:7 row_mask:0xf bank_mask:0xf
    v_fmac_f32_dpp v230, v232, v243 row_newbcast:7 row_mask:0xf bank_mask:0xf
    v_fmac_f32_dpp v231, v232, v47 row_newbcast:7 row_mask:0xf bank_mask:0xf
    v_cvt_pk_bf16_f32 v244, v224, v225
    v_cvt_pk_bf16_f32 v245, v226, v227
    v_cvt_pk_bf16_f32 v246, v228, v229
    v_cvt_pk_bf16_f32 v247, v230, v231
    s_lshl_b32 s54, s3, 10
    v_add_u32 v5, s54, v2
    ds_write_b128 v5, v[244:247]
    v_lshrrev_b32 v5, 3, v3
    v_lshlrev_b32 v5, 10, v5
    v_lshl_add_u32 v5, v4, 6, v5
    s_lshl_b32 s54, s3, 8
    v_add_u32 v5, s54, v5
    s_waitcnt lgkmcnt(0)
    s_barrier
    ds_read_b128 v[16:19], v5 offset:0
    ds_read_b128 v[20:23], v5 offset:16
    ds_read_b128 v[24:27], v5 offset:32
    ds_read_b128 v[28:31], v5 offset:48
    ds_read_b128 v[32:35], v5 offset:2048
    ds_read_b128 v[36:39], v5 offset:2064
    ds_read_b128 v[40:43], v5 offset:2080
    ds_read_b128 v[44:47], v5 offset:2096
    s_waitcnt lgkmcnt(0)
    v_perm_b32 v48, v16, v16, v8
    v_perm_b32 v49, v16, v16, v10
    v_perm_b32 v50, v16, v16, v12
    v_perm_b32 v51, v16, v16, v14
    s_nop 1
    v_mfma_f32_16x16x32_bf16 v[224:227], v[48:51], a[0:3], 0
    v_perm_b32 v52, v32, v32, v8
    v_perm_b32 v53, v32, v32, v10
    v_perm_b32 v54, v32, v32, v12
    v_perm_b32 v55, v32, v32, v14
    s_nop 1
    v_mfma_f32_16x16x32_bf16 v[228:231], v[52:55], a[0:3], 0
    v_perm_b32 v56, v16, v16, v9
    v_perm_b32 v57, v16, v16, v11
    v_perm_b32 v58, v16, v16, v13
    v_perm_b32 v59, v16, v16, v15
    s_nop 1
    v_mfma_f32_16x16x32_bf16 v[224:227], v[56:59], a[4:7], v[224:227]
    v_perm_b32 v60, v32, v32, v9
    v_perm_b32 v61, v32, v32, v11
    v_perm_b32 v62, v32, v32, v13
    v_perm_b32 v63, v32, v32, v15
    s_nop 1
    v_mfma_f32_16x16x32_bf16 v[228:231], v[60:63], a[4:7], v[228:231]
    v_perm_b32 v48, v17, v17, v8
    v_perm_b32 v49, v17, v17, v10
    v_perm_b32 v50, v17, v17, v12
    v_perm_b32 v51, v17, v17, v14
    s_nop 1
    v_mfma_f32_16x16x32_bf16 v[224:227], v[48:51], a[8:11], v[224:227]
    v_perm_b32 v52, v33, v33, v8
    v_perm_b32 v53, v33, v33, v10
    v_perm_b32 v54, v33, v33, v12
    v_perm_b32 v55, v33, v33, v14
    s_nop 1
    v_mfma_f32_16x16x32_bf16 v[228:231], v[52:55], a[8:11], v[228:231]
    v_perm_b32 v56, v17, v17, v9
    v_perm_b32 v57, v17, v17, v11
    v_perm_b32 v58, v17, v17, v13
    v_perm_b32 v59, v17, v17, v15
    s_nop 1
    v_mfma_f32_16x16x32_bf16 v[224:227], v[56:59], a[12:15], v[224:227]
    v_perm_b32 v60, v33, v33, v9
    v_perm_b32 v61, v33, v33, v11
    v_perm_b32 v62, v33, v33, v13
    v_perm_b32 v63, v33, v33, v15
    s_nop 1
    v_mfma_f32_16x16x32_bf16 v[228:231], v[60:63], a[12:15], v[228:231]
    v_perm_b32 v48, v18, v18, v8
    v_perm_b32 v49, v18, v18, v10
    v_perm_b32 v50, v18, v18, v12
    v_perm_b32 v51, v18, v18, v14
    s_nop 1
    v_mfma_f32_16x16x32_bf16 v[224:227], v[48:51], a[16:19], v[224:227]
    v_perm_b32 v52, v34, v34, v8
    v_perm_b32 v53, v34, v34, v10
    v_perm_b32 v54, v34, v34, v12
    v_perm_b32 v55, v34, v34, v14
    s_nop 1
    v_mfma_f32_16x16x32_bf16 v[228:231], v[52:55], a[16:19], v[228:231]
    v_perm_b32 v56, v18, v18, v9
    v_perm_b32 v57, v18, v18, v11
    v_perm_b32 v58, v18, v18, v13
    v_perm_b32 v59, v18, v18, v15
    s_nop 1
    v_mfma_f32_16x16x32_bf16 v[224:227], v[56:59], a[20:23], v[224:227]
    v_perm_b32 v60, v34, v34, v9
    v_perm_b32 v61, v34, v34, v11
    v_perm_b32 v62, v34, v34, v13
    v_perm_b32 v63, v34, v34, v15
    s_nop 1
    v_mfma_f32_16x16x32_bf16 v[228:231], v[60:63], a[20:23], v[228:231]
    v_perm_b32 v48, v19, v19, v8
    v_perm_b32 v49, v19, v19, v10
    v_perm_b32 v50, v19, v19, v12
    v_perm_b32 v51, v19, v19, v14
    s_nop 1
    v_mfma_f32_16x16x32_bf16 v[224:227], v[48:51], a[24:27], v[224:227]
    v_perm_b32 v52, v35, v35, v8
    v_perm_b32 v53, v35, v35, v10
    v_perm_b32 v54, v35, v35, v12
    v_perm_b32 v55, v35, v35, v14
    s_nop 1
    v_mfma_f32_16x16x32_bf16 v[228:231], v[52:55], a[24:27], v[228:231]
    v_perm_b32 v56, v19, v19, v9
    v_perm_b32 v57, v19, v19, v11
    v_perm_b32 v58, v19, v19, v13
    v_perm_b32 v59, v19, v19, v15
    s_nop 1
    v_mfma_f32_16x16x32_bf16 v[224:227], v[56:59], a[28:31], v[224:227]
    v_perm_b32 v60, v35, v35, v9
    v_perm_b32 v61, v35, v35, v11
    v_perm_b32 v62, v35, v35, v13
    v_perm_b32 v63, v35, v35, v15
    s_nop 1
    v_mfma_f32_16x16x32_bf16 v[228:231], v[60:63], a[28:31], v[228:231]
    v_perm_b32 v48, v20, v20, v8
    v_perm_b32 v49, v20, v20, v10
    v_perm_b32 v50, v20, v20, v12
    v_perm_b32 v51, v20, v20, v14
    s_nop 1
    v_mfma_f32_16x16x32_bf16 v[224:227], v[48:51], a[32:35], v[224:227]
    v_perm_b32 v52, v36, v36, v8
    v_perm_b32 v53, v36, v36, v10
    v_perm_b32 v54, v36, v36, v12
    v_perm_b32 v55, v36, v36, v14
    s_nop 1
    v_mfma_f32_16x16x32_bf16 v[228:231], v[52:55], a[32:35], v[228:231]
    v_perm_b32 v56, v20, v20, v9
    v_perm_b32 v57, v20, v20, v11
    v_perm_b32 v58, v20, v20, v13
    v_perm_b32 v59, v20, v20, v15
    s_nop 1
    v_mfma_f32_16x16x32_bf16 v[224:227], v[56:59], a[36:39], v[224:227]
    v_perm_b32 v60, v36, v36, v9
    v_perm_b32 v61, v36, v36, v11
    v_perm_b32 v62, v36, v36, v13
    v_perm_b32 v63, v36, v36, v15
    s_nop 1
    v_mfma_f32_16x16x32_bf16 v[228:231], v[60:63], a[36:39], v[228:231]
    v_perm_b32 v48, v21, v21, v8
    v_perm_b32 v49, v21, v21, v10
    v_perm_b32 v50, v21, v21, v12
    v_perm_b32 v51, v21, v21, v14
    s_nop 1
    v_mfma_f32_16x16x32_bf16 v[224:227], v[48:51], a[40:43], v[224:227]
    v_perm_b32 v52, v37, v37, v8
    v_perm_b32 v53, v37, v37, v10
    v_perm_b32 v54, v37, v37, v12
    v_perm_b32 v55, v37, v37, v14
    s_nop 1
    v_mfma_f32_16x16x32_bf16 v[228:231], v[52:55], a[40:43], v[228:231]
    v_perm_b32 v56, v21, v21, v9
    v_perm_b32 v57, v21, v21, v11
    v_perm_b32 v58, v21, v21, v13
    v_perm_b32 v59, v21, v21, v15
    s_nop 1
    v_mfma_f32_16x16x32_bf16 v[224:227], v[56:59], a[44:47], v[224:227]
    v_perm_b32 v60, v37, v37, v9
    v_perm_b32 v61, v37, v37, v11
    v_perm_b32 v62, v37, v37, v13
    v_perm_b32 v63, v37, v37, v15
    s_nop 1
    v_mfma_f32_16x16x32_bf16 v[228:231], v[60:63], a[44:47], v[228:231]
    v_perm_b32 v48, v22, v22, v8
    v_perm_b32 v49, v22, v22, v10
    v_perm_b32 v50, v22, v22, v12
    v_perm_b32 v51, v22, v22, v14
    s_nop 1
    v_mfma_f32_16x16x32_bf16 v[224:227], v[48:51], a[48:51], v[224:227]
    v_perm_b32 v52, v38, v38, v8
    v_perm_b32 v53, v38, v38, v10
    v_perm_b32 v54, v38, v38, v12
    v_perm_b32 v55, v38, v38, v14
    s_nop 1
    v_mfma_f32_16x16x32_bf16 v[228:231], v[52:55], a[48:51], v[228:231]
    v_perm_b32 v56, v22, v22, v9
    v_perm_b32 v57, v22, v22, v11
    v_perm_b32 v58, v22, v22, v13
    v_perm_b32 v59, v22, v22, v15
    s_nop 1
    v_mfma_f32_16x16x32_bf16 v[224:227], v[56:59], a[52:55], v[224:227]
    v_perm_b32 v60, v38, v38, v9
    v_perm_b32 v61, v38, v38, v11
    v_perm_b32 v62, v38, v38, v13
    v_perm_b32 v63, v38, v38, v15
    s_nop 1
    v_mfma_f32_16x16x32_bf16 v[228:231], v[60:63], a[52:55], v[228:231]
    v_perm_b32 v48, v23, v23, v8
    v_perm_b32 v49, v23, v23, v10
    v_perm_b32 v50, v23, v23, v12
    v_perm_b32 v51, v23, v23, v14
    s_nop 1
    v_mfma_f32_16x16x32_bf16 v[224:227], v[48:51], a[56:59], v[224:227]
    v_perm_b32 v52, v39, v39, v8
    v_perm_b32 v53, v39, v39, v10
    v_perm_b32 v54, v39, v39, v12
    v_perm_b32 v55, v39, v39, v14
    s_nop 1
    v_mfma_f32_16x16x32_bf16 v[228:231], v[52:55], a[56:59], v[228:231]
    v_perm_b32 v56, v23, v23, v9
    v_perm_b32 v57, v23, v23, v11
    v_perm_b32 v58, v23, v23, v13
    v_perm_b32 v59, v23, v23, v15
    s_nop 1
    v_mfma_f32_16x16x32_bf16 v[224:227], v[56:59], a[60:63], v[224:227]
    v_perm_b32 v60, v39, v39, v9
    v_perm_b32 v61, v39, v39, v11
    v_perm_b32 v62, v39, v39, v13
    v_perm_b32 v63, v39, v39, v15
    s_nop 1
    v_mfma_f32_16x16x32_bf16 v[228:231], v[60:63], a[60:63], v[228:231]
    v_perm_b32 v48, v24, v24, v8
    v_perm_b32 v49, v24, v24, v10
    v_perm_b32 v50, v24, v24, v12
    v_perm_b32 v51, v24, v24, v14
    s_nop 1
    v_mfma_f32_16x16x32_bf16 v[224:227], v[48:51], a[64:67], v[224:227]
    v_perm_b32 v52, v40, v40, v8
    v_perm_b32 v53, v40, v40, v10
    v_perm_b32 v54, v40, v40, v12
    v_perm_b32 v55, v40, v40, v14
    s_nop 1
    v_mfma_f32_16x16x32_bf16 v[228:231], v[52:55], a[64:67], v[228:231]
    v_perm_b32 v56, v24, v24, v9
    v_perm_b32 v57, v24, v24, v11
    v_perm_b32 v58, v24, v24, v13
    v_perm_b32 v59, v24, v24, v15
    s_nop 1
    v_mfma_f32_16x16x32_bf16 v[224:227], v[56:59], a[68:71], v[224:227]
    v_perm_b32 v60, v40, v40, v9
    v_perm_b32 v61, v40, v40, v11
    v_perm_b32 v62, v40, v40, v13
    v_perm_b32 v63, v40, v40, v15
    s_nop 1
    v_mfma_f32_16x16x32_bf16 v[228:231], v[60:63], a[68:71], v[228:231]
    v_perm_b32 v48, v25, v25, v8
    v_perm_b32 v49, v25, v25, v10
    v_perm_b32 v50, v25, v25, v12
    v_perm_b32 v51, v25, v25, v14
    s_nop 1
    v_mfma_f32_16x16x32_bf16 v[224:227], v[48:51], a[72:75], v[224:227]
    v_perm_b32 v52, v41, v41, v8
    v_perm_b32 v53, v41, v41, v10
    v_perm_b32 v54, v41, v41, v12
    v_perm_b32 v55, v41, v41, v14
    s_nop 1
    v_mfma_f32_16x16x32_bf16 v[228:231], v[52:55], a[72:75], v[228:231]
    v_perm_b32 v56, v25, v25, v9
    v_perm_b32 v57, v25, v25, v11
    v_perm_b32 v58, v25, v25, v13
    v_perm_b32 v59, v25, v25, v15
    s_nop 1
    v_mfma_f32_16x16x32_bf16 v[224:227], v[56:59], a[76:79], v[224:227]
    v_perm_b32 v60, v41, v41, v9
    v_perm_b32 v61, v41, v41, v11
    v_perm_b32 v62, v41, v41, v13
    v_perm_b32 v63, v41, v41, v15
    s_nop 1
    v_mfma_f32_16x16x32_bf16 v[228:231], v[60:63], a[76:79], v[228:231]
    v_perm_b32 v48, v26, v26, v8
    v_perm_b32 v49, v26, v26, v10
    v_perm_b32 v50, v26, v26, v12
    v_perm_b32 v51, v26, v26, v14
    s_nop 1
    v_mfma_f32_16x16x32_bf16 v[224:227], v[48:51], a[80:83], v[224:227]
    v_perm_b32 v52, v42, v42, v8
    v_perm_b32 v53, v42, v42, v10
    v_perm_b32 v54, v42, v42, v12
    v_perm_b32 v55, v42, v42, v14
    s_nop 1
    v_mfma_f32_16x16x32_bf16 v[228:231], v[52:55], a[80:83], v[228:231]
    v_perm_b32 v56, v26, v26, v9
    v_perm_b32 v57, v26, v26, v11
    v_perm_b32 v58, v26, v26, v13
    v_perm_b32 v59, v26, v26, v15
    s_nop 1
    v_mfma_f32_16x16x32_bf16 v[224:227], v[56:59], a[84:87], v[224:227]
    v_perm_b32 v60, v42, v42, v9
    v_perm_b32 v61, v42, v42, v11
    v_perm_b32 v62, v42, v42, v13
    v_perm_b32 v63, v42, v42, v15
    s_nop 1
    v_mfma_f32_16x16x32_bf16 v[228:231], v[60:63], a[84:87], v[228:231]
    v_perm_b32 v48, v27, v27, v8
    v_perm_b32 v49, v27, v27, v10
    v_perm_b32 v50, v27, v27, v12
    v_perm_b32 v51, v27, v27, v14
    s_nop 1
    v_mfma_f32_16x16x32_bf16 v[224:227], v[48:51], a[88:91], v[224:227]
    v_perm_b32 v52, v43, v43, v8
    v_perm_b32 v53, v43, v43, v10
    v_perm_b32 v54, v43, v43, v12
    v_perm_b32 v55, v43, v43, v14
    s_nop 1
    v_mfma_f32_16x16x32_bf16 v[228:231], v[52:55], a[88:91], v[228:231]
    v_perm_b32 v56, v27, v27, v9
    v_perm_b32 v57, v27, v27, v11
    v_perm_b32 v58, v27, v27, v13
    v_perm_b32 v59, v27, v27, v15
    s_nop 1
    v_mfma_f32_16x16x32_bf16 v[224:227], v[56:59], a[92:95], v[224:227]
    v_perm_b32 v60, v43, v43, v9
    v_perm_b32 v61, v43, v43, v11
    v_perm_b32 v62, v43, v43, v13
    v_perm_b32 v63, v43, v43, v15
    s_nop 1
    v_mfma_f32_16x16x32_bf16 v[228:231], v[60:63], a[92:95], v[228:231]
    v_perm_b32 v48, v28, v28, v8
    v_perm_b32 v49, v28, v28, v10
    v_perm_b32 v50, v28, v28, v12
    v_perm_b32 v51, v28, v28, v14
    s_nop 1
    v_mfma_f32_16x16x32_bf16 v[224:227], v[48:51], a[96:99], v[224:227]
    v_perm_b32 v52, v44, v44, v8
    v_perm_b32 v53, v44, v44, v10
    v_perm_b32 v54, v44, v44, v12
    v_perm_b32 v55, v44, v44, v14
    s_nop 1
    v_mfma_f32_16x16x32_bf16 v[228:231], v[52:55], a[96:99], v[228:231]
    v_perm_b32 v56, v28, v28, v9
    v_perm_b32 v57, v28, v28, v11
    v_perm_b32 v58, v28, v28, v13
    v_perm_b32 v59, v28, v28, v15
    s_nop 1
    v_mfma_f32_16x16x32_bf16 v[224:227], v[56:59], a[100:103], v[224:227]
    v_perm_b32 v60, v44, v44, v9
    v_perm_b32 v61, v44, v44, v11
    v_perm_b32 v62, v44, v44, v13
    v_perm_b32 v63, v44, v44, v15
    s_nop 1
    v_mfma_f32_16x16x32_bf16 v[228:231], v[60:63], a[100:103], v[228:231]
    v_perm_b32 v48, v29, v29, v8
    v_perm_b32 v49, v29, v29, v10
    v_perm_b32 v50, v29, v29, v12
    v_perm_b32 v51, v29, v29, v14
    s_nop 1
    v_mfma_f32_16x16x32_bf16 v[224:227], v[48:51], a[104:107], v[224:227]
    v_perm_b32 v52, v45, v45, v8
    v_perm_b32 v53, v45, v45, v10
    v_perm_b32 v54, v45, v45, v12
    v_perm_b32 v55, v45, v45, v14
    s_nop 1
    v_mfma_f32_16x16x32_bf16 v[228:231], v[52:55], a[104:107], v[228:231]
    v_perm_b32 v56, v29, v29, v9
    v_perm_b32 v57, v29, v29, v11
    v_perm_b32 v58, v29, v29, v13
    v_perm_b32 v59, v29, v29, v15
    s_nop 1
    v_mfma_f32_16x16x32_bf16 v[224:227], v[56:59], a[108:111], v[224:227]
    v_perm_b32 v60, v45, v45, v9
    v_perm_b32 v61, v45, v45, v11
    v_perm_b32 v62, v45, v45, v13
    v_perm_b32 v63, v45, v45, v15
    s_nop 1
    v_mfma_f32_16x16x32_bf16 v[228:231], v[60:63], a[108:111], v[228:231]
    v_perm_b32 v48, v30, v30, v8
    v_perm_b32 v49, v30, v30, v10
    v_perm_b32 v50, v30, v30, v12
    v_perm_b32 v51, v30, v30, v14
    s_nop 1
    v_mfma_f32_16x16x32_bf16 v[224:227], v[48:51], a[112:115], v[224:227]
    v_perm_b32 v52, v46, v46, v8
    v_perm_b32 v53, v46, v46, v10
    v_perm_b32 v54, v46, v46, v12
    v_perm_b32 v55, v46, v46, v14
    s_nop 1
    v_mfma_f32_16x16x32_bf16 v[228:231], v[52:55], a[112:115], v[228:231]
    v_perm_b32 v56, v30, v30, v9
    v_perm_b32 v57, v30, v30, v11
    v_perm_b32 v58, v30, v30, v13
    v_perm_b32 v59, v30, v30, v15
    s_nop 1
    v_mfma_f32_16x16x32_bf16 v[224:227], v[56:59], a[116:119], v[224:227]
    v_perm_b32 v60, v46, v46, v9
    v_perm_b32 v61, v46, v46, v11
    v_perm_b32 v62, v46, v46, v13
    v_perm_b32 v63, v46, v46, v15
    s_nop 1
    v_mfma_f32_16x16x32_bf16 v[228:231], v[60:63], a[116:119], v[228:231]
    v_perm_b32 v48, v31, v31, v8
    v_perm_b32 v49, v31, v31, v10
    v_perm_b32 v50, v31, v31, v12
    v_perm_b32 v51, v31, v31, v14
    s_nop 1
    v_mfma_f32_16x16x32_bf16 v[224:227], v[48:51], a[120:123], v[224:227]
    v_perm_b32 v52, v47, v47, v8
    v_perm_b32 v53, v47, v47, v10
    v_perm_b32 v54, v47, v47, v12
    v_perm_b32 v55, v47, v47, v14
    s_nop 1
    v_mfma_f32_16x16x32_bf16 v[228:231], v[52:55], a[120:123], v[228:231]
    v_perm_b32 v56, v31, v31, v9
    v_perm_b32 v57, v31, v31, v11
    v_perm_b32 v58, v31, v31, v13
    v_perm_b32 v59, v31, v31, v15
    s_nop 1
    v_mfma_f32_16x16x32_bf16 v[224:227], v[56:59], a[124:127], v[224:227]
    v_perm_b32 v60, v47, v47, v9
    v_perm_b32 v61, v47, v47, v11
    v_perm_b32 v62, v47, v47, v13
    v_perm_b32 v63, v47, v47, v15
    s_nop 1
    v_mfma_f32_16x16x32_bf16 v[228:231], v[60:63], a[124:127], v[228:231]
    v_lshrrev_b32 v5, 1, v4
    v_lshlrev_b32 v5, 9, v5
    v_lshl_add_u32 v5, v3, 5, v5
    v_and_b32 v6, 1, v4
    v_lshl_add_u32 v5, v6, 4, v5
    s_lshl_b32 s54, s3, 11
    s_add_u32 s54, s54, 131072
    v_add_u32 v5, s54, v5
    ds_write_b128 v5, v[224:227]
    ds_write_b128 v5, v[228:231] offset:1024
    s_waitcnt lgkmcnt(0)
    s_barrier
    v_lshrrev_b32 v5, 2, v3
    v_lshlrev_b32 v5, 9, v5
    v_lshl_add_u32 v5, v4, 5, v5
    s_lshl_b32 s54, s3, 7
    s_add_u32 s54, s54, 131072
    v_add_u32 v5, s54, v5
    ds_read_b128 v[16:19], v5 offset:0
    ds_read_b128 v[20:23], v5 offset:16
    ds_read_b128 v[24:27], v5 offset:2048
    ds_read_b128 v[28:31], v5 offset:2064
    ds_read_b128 v[32:35], v5 offset:4096
    ds_read_b128 v[36:39], v5 offset:4112
    ds_read_b128 v[40:43], v5 offset:6144
    ds_read_b128 v[44:47], v5 offset:6160
    s_waitcnt lgkmcnt(0)
    v_add_f32 v16, v16, v24
    v_add_f32 v32, v32, v40
    v_add_f32 v17, v17, v25
    v_add_f32 v33, v33, v41
    v_add_f32 v18, v18, v26
    v_add_f32 v34, v34, v42
    v_add_f32 v19, v19, v27
    v_add_f32 v35, v35, v43
    v_add_f32 v20, v20, v28
    v_add_f32 v36, v36, v44
    v_add_f32 v21, v21, v29
    v_add_f32 v37, v37, v45
    v_add_f32 v22, v22, v30
    v_add_f32 v38, v38, v46
    v_add_f32 v23, v23, v31
    v_add_f32 v39, v39, v47
    v_add_f32 v16, v16, v32
    v_add_f32 v17, v17, v33
    v_add_f32 v18, v18, v34
    v_add_f32 v19, v19, v35
    v_add_f32 v20, v20, v36
    v_add_f32 v21, v21, v37
    v_add_f32 v22, v22, v38
    v_add_f32 v23, v23, v39
    v_cvt_pk_bf16_f32 v64, v16, v17
    v_cvt_pk_bf16_f32 v65, v18, v19
    v_cvt_pk_bf16_f32 v66, v20, v21
    v_cvt_pk_bf16_f32 v67, v22, v23
    v_min_u32 v64, -2, v64
    v_min_u32 v65, -2, v65
    v_min_u32 v66, -2, v66
    v_min_u32 v67, -2, v67
    v_bfe_u32 v6, v1, 2, 2
    v_lshlrev_b32 v6, 6, v6
    v_and_b32 v5, 48, v1
    v_add_u32 v6, v6, v5
    v_and_b32 v5, 3, v1
    v_lshl_add_u32 v6, v5, 29, v6
    s_lshl_b32 s54, s52, 10
    s_lshl_b32 s55, s3, 8
    s_add_u32 s54, s54, s55
    s_add_u32 s54, s54, 5439488
    buffer_store_dwordx4 v[64:67], v6, s[44:47], s54 offen sc1
    s_mov_b32 s48, s26
    s_mov_b32 s49, s27
    s_mov_b32 s50, 9216
    s_mov_b32 s51, 0x20000
    s_lshl_b32 s54, s3, 5
    s_add_u32 s54, s54, s53
    s_cmp_ge_u32 s54, 72
    s_cbranch_scc1 L_nored_28
    v_mov_b32 v48, -1
    v_mov_b32 v49, -1
    v_mov_b32 v50, -1
    v_mov_b32 v51, -1
    v_mov_b32 v52, -1
    v_mov_b32 v53, -1
    v_mov_b32 v54, -1
    v_mov_b32 v55, -1
    v_mov_b32 v56, -1
    v_mov_b32 v57, -1
    v_mov_b32 v58, -1
    v_mov_b32 v59, -1
    v_mov_b32 v60, -1
    v_mov_b32 v61, -1
    v_mov_b32 v62, -1
    v_mov_b32 v63, -1
    s_lshl_b32 s55, s54, 12
    s_add_u32 s55, s55, 4718592
    s_mul_hi_u32 s56, s54, 238609295
    s_add_u32 s56, s56, 1
    s_mul_i32 s56, s56, 1152
    s_lshl_b32 s57, s54, 6
    s_add_u32 s56, s56, s57
    v_lshlrev_b32 v5, 3, v3
    v_lshl_add_u32 v5, v4, 1, v5
    v_mov_b32 v6, 0x4000
    v_cmp_gt_u32 vcc, 8, v3
    s_nop 1
    v_cndmask_b32 v5, v6, v5, vcc
    s_mov_b64 s[4:5], -1
    s_mov_b64 s[6:7], -1
    s_mov_b64 s[8:9], -1
    s_mov_b64 s[10:11], -1
L_mpoll_29:
    s_mov_b64 exec, s[4:5]
    buffer_load_dwordx4 v[48:51], v2, s[44:47], s55 offen offset:0 sc1
    s_mov_b64 exec, s[6:7]
    buffer_load_dwordx4 v[52:55], v2, s[44:47], s55 offen offset:1024 sc1
    s_mov_b64 exec, s[8:9]
    buffer_load_dwordx4 v[56:59], v2, s[44:47], s55 offen offset:2048 sc1
    s_mov_b64 exec, s[10:11]
    buffer_load_dwordx4 v[60:63], v2, s[44:47], s55 offen offset:3072 sc1
    s_mov_b64 exec, -1
    s_waitcnt vmcnt(4)
    v_max3_u32 v32, v48, v49, v50
    v_max3_u32 v33, v52, v53, v54
    v_max3_u32 v34, v56, v57, v58
    v_max3_u32 v35, v60, v61, v62
    v_max_u32 v32, v32, v51
    v_max_u32 v33, v33, v55
    v_max_u32 v34, v34, v59
    v_max_u32 v35, v35, v63
    v_cmp_eq_u32 s[4:5], -1, v32
    v_cmp_eq_u32 s[6:7], -1, v33
    v_cmp_eq_u32 s[8:9], -1, v34
    v_cmp_eq_u32 s[10:11], -1, v35
    s_or_b64 vcc, s[4:5], s[6:7]
    s_or_b64 vcc, vcc, s[8:9]
    s_or_b64 vcc, vcc, s[10:11]
    s_cbranch_scc0 L_mpollok_30
    s_and_b64 vcc, s[4:5], s[6:7]
    s_and_b64 vcc, vcc, s[8:9]
    s_and_b64 vcc, vcc, s[10:11]
    s_cmp_eq_u64 vcc, -1
    s_cbranch_scc0 L_mpoll_29_b
    s_sleep 4
L_mpoll_29_b:
    s_sub_u32 s101, s101, 1
    s_cbranch_scc0 L_mpoll_29
    s_mov_b32 s101, 0
L_mpollok_30:
    v_add_f32 v16, v48, v52
    v_add_f32 v24, v56, v60
    v_add_f32 v18, v50, v54
    v_add_f32 v26, v58, v62
    v_add_f32 v17, v49, v53
    v_add_f32 v25, v57, v61
    v_add_f32 v19, v51, v55
    v_add_f32 v27, v59, v63
    v_add_f32 v16, v16, v24
    v_add_f32 v18, v18, v26
    v_add_f32 v17, v17, v25
    v_add_f32 v19, v19, v27
    v_permlane32_swap_b32 v16, v18
    s_nop 0
    v_permlane32_swap_b32 v17, v19
    v_add_f32 v16, v16, v18
    v_add_f32 v17, v17, v19
    s_nop 1
    v_permlane16_swap_b32 v16, v17
    v_add_f32 v16, v16, v17
    s_nop 1
    v_add_f32_dpp v16, v16, v16 row_ror:8 row_mask:0xf bank_mask:0xf
    v_cvt_pk_bf16_f32 v16, v16, v16
    buffer_store_short v16, v5, s[48:51], s56 offen
L_nored_28:
    s_endpgm
L_roleH_end:
L_roleC:
    s_mov_b32 s101, 100000
    s_getpc_b64 s[56:57]
L_pc_31:
    s_sub_u32 s56, s56, L_pc_31-L_roleC
    s_subb_u32 s57, s57, 0
    v_lshlrev_b32 v5, 7, v0
    v_min_u32 v6, L_roleC_end-L_roleC-4, v5
    global_load_dword v122, v6, s[56:57]
    v_add_u32 v5, 32768, v5
    v_min_u32 v6, L_roleC_end-L_roleC-4, v5
    global_load_dword v122, v6, s[56:57]
    v_mov_b32 v20, -1
    v_mov_b32 v21, -1
    v_mov_b32 v22, -1
    v_mov_b32 v23, -1
    v_mul_u32_u24 v7, 73728, v4
    v_lshrrev_b32 v5, 3, v3
    v_lshl_add_u32 v6, v5, 13, v7
    v_and_b32 v5, 7, v3
    v_lshl_add_u32 v6, v5, 4, v6
    v_lshl_add_u32 v7, v3, 3, v7
    v_add_u32 v7, 65536, v7
    s_lshl_b32 s56, s52, 7
    s_add_u32 s56, s56, 4194304
    s_lshl_b32 s54, s3, 14
    s_add_u32 s54, s54, s56
    s_add_u32 s55, s54, 4096
    s_and_b32 s57, s3, 1
    s_lshl_b32 s57, s57, 12
    s_add_u32 s56, s56, s57
    s_waitcnt lgkmcnt(0)
    s_mov_b32 s44, s30
    s_mov_b32 s45, s31
    s_mov_b32 s46, 536870912
    s_mov_b32 s47, 0x20000
    buffer_store_dwordx4 v[20:23], v6, s[44:47], s54 offen sc1
    buffer_store_dwordx4 v[20:23], v6, s[44:47], s55 offen sc1
    buffer_store_dwordx2 v[20:21], v7, s[44:47], s56 offen sc1
    v_mov_b32 v7, 536870912
    v_cmp_gt_u32 vcc, 16, v1
    s_nop 1
    v_cndmask_b32 v123, v7, v2, vcc
    s_lshl_b32 s98, s52, 10
    s_lshl_b32 s54, s3, 8
    s_add_u32 s98, s98, s54
    s_add_u32 s98, s98, 5242880
    buffer_store_dwordx4 v[20:23], v123, s[44:47], s98 offen sc1
    s_lshl_b32 s58, s52, 2
    s_add_u32 s58, s58, s3
    s_lshl_b32 s58, s58, 13
    s_add_u32 s58, s58, 8388608
    s_add_u32 s59, s58, 4096
    v_min_u32 v6, 1, v3
    v_lshl_add_u32 v6, v6, 2, v4
    v_lshlrev_b32 v6, 4, v6
    s_lshr_b32 s55, s52, 2
    s_add_u32 s55, s55, s3
    s_and_b32 s55, s55, 3
    s_and_b32 s54, s52, 3
    s_cmp_eq_u32 s54, s55
    s_mov_b32 s56, 255
    s_cselect_b32 s56, 16777215, s56
    s_mov_b32 s57, 0
    s_cbranch_scc0 L_cclr
    buffer_store_dwordx4 v[20:23], v2, s[44:47], s58 offen offset:2048 sc1
    buffer_store_dwordx4 v[20:23], v2, s[44:47], s58 offen offset:3072 sc1
    buffer_store_dwordx4 v[20:23], v2, s[44:47], s59 offen offset:0 sc1
    buffer_store_dwordx4 v[20:23], v2, s[44:47], s59 offen offset:1024 sc1
    s_and_b32 s55, s52, 28
    s_add_u32 s55, s55, s3
    s_mul_i32 s55, s55, 256
    s_add_u32 s55, s55, 16777216
    v_mov_b32 v5, 0
    s_mov_b64 exec, 1
    buffer_store_dword v5, v5, s[44:47], s55 offen sc1
    s_lshl_b32 s55, s53, 8
    s_add_u32 s55, s55, 3145728
    s_mov_b64 exec, 0xffff
    buffer_store_dwordx4 v[20:23], v2, s[44:47], s55 offen sc1
    s_mov_b64 exec, -1
L_cclr:
    buffer_store_dwordx4 v[20:23], v2, s[44:47], s58 offen offset:0 sc1
    buffer_store_dwordx4 v[20:23], v2, s[44:47], s58 offen offset:1024 sc1
    s_mov_b64 exec, s[56:57]
    buffer_store_dwordx4 v[20:23], v2, s[44:47], s59 offen offset:2048 sc1
    s_mov_b64 exec, -1
    s_mov_b32 s40, s10
    s_mov_b32 s41, s11
    s_mov_b32 s42, 4718592
    s_mov_b32 s43, 0x20000
    s_mov_b32 s48, s4
    s_mov_b32 s49, s5
    s_mov_b32 s50, 4608
    s_mov_b32 s51, 0x20000
    s_mov_b32 s32, s16
    s_mov_b32 s33, s17
    s_mov_b32 s34, 16777216
    s_mov_b32 s35, 0x20000
    v_lshrrev_b32 v5, 3, v3
    v_mul_u32_u24 v5, 1152, v5
    v_mul_u32_u24 v6, 72, v4
    v_add_u32 v5, v5, v6
    s_mul_i32 s54, s3, 288
    buffer_load_dwordx4 v[48:51], v5, s[48:51], s54 offen offset:0
    buffer_load_dwordx4 v[52:55], v5, s[48:51], s54 offen offset:16
    buffer_load_dwordx4 v[56:59], v5, s[48:51], s54 offen offset:32
    buffer_load_dwordx4 v[60:63], v5, s[48:51], s54 offen offset:48
    buffer_load_dwordx2 v[64:65], v5, s[48:51], s54 offen offset:64
    buffer_load_dwordx4 v[68:71], v5, s[48:51], s54 offen offset:2304
    buffer_load_dwordx4 v[72:75], v5, s[48:51], s54 offen offset:2320
    buffer_load_dwordx4 v[76:79], v5, s[48:51], s54 offen offset:2336
    buffer_load_dwordx4 v[80:83], v5, s[48:51], s54 offen offset:2352
    buffer_load_dwordx2 v[84:85], v5, s[48:51], s54 offen offset:2368
    v_mul_u32_u24 v120, 294912, v4
    v_lshl_add_u32 v120, v3, 4, v120
    s_mul_i32 s61, s3, 1179648
    s_lshl_b32 s54, s52, 8
    s_add_u32 s61, s61, s54
    buffer_load_dwordx4 a[0:3], v120, s[40:43], s61 offen nt
    s_add_u32 s61, s61, 8192
    buffer_load_dwordx4 a[4:7], v120, s[40:43], s61 offen nt
    s_add_u32 s61, s61, 8192
    buffer_load_dwordx4 a[8:11], v120, s[40:43], s61 offen nt
    s_add_u32 s61, s61, 8192
    buffer_load_dwordx4 a[12:15], v120, s[40:43], s61 offen nt
    s_add_u32 s61, s61, 8192
    buffer_load_dwordx4 a[16:19], v120, s[40:43], s61 offen nt
    s_add_u32 s61, s61, 8192
    buffer_load_dwordx4 a[20:23], v120, s[40:43], s61 offen nt
    s_add_u32 s61, s61, 8192
    buffer_load_dwordx4 a[24:27], v120, s[40:43], s61 offen nt
    s_add_u32 s61, s61, 8192
    buffer_load_dwordx4 a[28:31], v120, s[40:43], s61 offen nt
    s_add_u32 s61, s61, 8192
    buffer_load_dwordx4 a[32:35], v120, s[40:43], s61 offen nt
    s_add_u32 s61, s61, 8192
    s_cmp_lg_u32 s3, 0
    s_cbranch_scc1 L_norace_32
    s_sub_u32 s84, s52, 1
    s_lshl_b32 s84, s84, 11
    s_lshl_b32 s85, s52, 12
    s_xor_b32 s84, s84, s85
    s_lshl_b32 s85, s52, 10
    s_xor_b32 s84, s84, s85
    s_and_b32 s84, s84, 0x2000
    s_lshr_b32 s85, s52, 2
    s_xor_b32 s85, s85, s52
    s_and_b32 s85, s85, 3
    s_lshl_b32 s85, s85, 25
    s_or_b32 s84, s84, s85
    s_lshl_b32 s85, s52, 20
    s_or_b32 s84, s84, s85
    s_xor_b32 s85, s84, 0x2000
    s_mov_b32 s86, -1
    s_mov_b32 s87, -1
    s_load_dword s87, s[8:9], s85 offset:0x80500
    s_load_dword s86, s[8:9], s84 offset:0x80000
    s_mov_b32 s97, 1
    s_waitcnt lgkmcnt(1)
    s_cmp_lg_u32 s87, -1
    s_subb_u32 s97, s97, 0
    s_cmp_lg_u32 s86, -1
    s_addc_u32 s97, s97, 0
    s_sub_u32 s96, 2, s97
    s_bitcmp1_b32 s52, 3
    s_cselect_b32 s97, s96, s97
    s_lshl_b32 s97, s97, 12
    s_or_b32 s97, s97, 0x1000000
L_norace_32:
    s_waitcnt vmcnt(19)
    s_barrier
    s_cmp_lg_u32 s3, 0
    s_cbranch_scc1 L_nosig_33
    s_atomic_add s97, s[28:29], 0 glc
L_nosig_33:
    buffer_load_dwordx4 a[36:39], v120, s[40:43], s61 offen nt
    s_add_u32 s61, s61, 8192
    buffer_load_dwordx4 a[40:43], v120, s[40:43], s61 offen nt
    s_add_u32 s61, s61, 8192
    buffer_load_dwordx4 a[44:47], v120, s[40:43], s61 offen nt
    s_add_u32 s61, s61, 8192
    buffer_load_dwordx4 a[48:51], v120, s[40:43], s61 offen nt
    s_add_u32 s61, s61, 8192
    buffer_load_dwordx4 a[52:55], v120, s[40:43], s61 offen nt
    s_add_u32 s61, s61, 8192
    buffer_load_dwordx4 a[56:59], v120, s[40:43], s61 offen nt
    s_add_u32 s61, s61, 8192
    buffer_load_dwordx4 a[60:63], v120, s[40:43], s61 offen nt
    s_add_u32 s61, s61, 8192
    buffer_load_dwordx4 a[64:67], v120, s[40:43], s61 offen nt
    s_add_u32 s61, s61, 8192
    buffer_load_dwordx4 a[68:71], v120, s[40:43], s61 offen nt
    s_add_u32 s61, s61, 8192
    buffer_load_dwordx4 a[72:75], v120, s[40:43], s61 offen nt
    s_add_u32 s61, s61, 8192
    buffer_load_dwordx4 a[76:79], v120, s[40:43], s61 offen nt
    s_add_u32 s61, s61, 8192
    buffer_load_dwordx4 a[80:83], v120, s[40:43], s61 offen nt
    s_add_u32 s61, s61, 8192
    buffer_load_dwordx4 a[84:87], v120, s[40:43], s61 offen nt
    s_add_u32 s61, s61, 8192
    buffer_load_dwordx4 a[88:91], v120, s[40:43], s61 offen nt
    s_add_u32 s61, s61, 8192
    buffer_load_dwordx4 a[92:95], v120, s[40:43], s61 offen nt
    s_add_u32 s61, s61, 8192
    buffer_load_dwordx4 a[96:99], v120, s[40:43], s61 offen nt
    s_add_u32 s61, s61, 8192
    buffer_load_dwordx4 a[100:103], v120, s[40:43], s61 offen nt
    s_add_u32 s61, s61, 8192
    buffer_load_dwordx4 a[104:107], v120, s[40:43], s61 offen nt
    s_add_u32 s61, s61, 8192
    buffer_load_dwordx4 a[108:111], v120, s[40:43], s61 offen nt
    s_add_u32 s61, s61, 8192
    buffer_load_dwordx4 a[112:115], v120, s[40:43], s61 offen nt
    s_add_u32 s61, s61, 8192
    buffer_load_dwordx4 a[116:119], v120, s[40:43], s61 offen nt
    s_add_u32 s61, s61, 8192
    buffer_load_dwordx4 a[120:123], v120, s[40:43], s61 offen nt
    s_add_u32 s61, s61, 8192
    buffer_load_dwordx4 a[124:127], v120, s[40:43], s61 offen nt
    s_add_u32 s61, s61, 8192
    buffer_load_dwordx4 a[128:131], v120, s[40:43], s61 offen nt
    s_add_u32 s61, s61, 8192
    buffer_load_dwordx4 a[132:135], v120, s[40:43], s61 offen nt
    s_add_u32 s61, s61, 8192
    buffer_load_dwordx4 a[136:139], v120, s[40:43], s61 offen nt
    s_add_u32 s61, s61, 8192
    buffer_load_dwordx4 a[140:143], v120, s[40:43], s61 offen nt
    s_add_u32 s61, s61, 8192
    v_and_b32 v5, 1, v3
    v_cmp_eq_u32 vcc, 1, v5
    v_mov_b32 v5, 0x0c0c0100
    v_mov_b32 v6, 0x01000c0c
    v_cndmask_b32 v5, v5, v6, vcc
    v_mov_b32 v6, 0x0c0c0302
    v_mov_b32 v7, 0x03020c0c
    v_cndmask_b32 v6, v6, v7, vcc
    v_bfe_u32 v7, v3, 1, 2
    v_mov_b32 v16, 0x0c0c0c0c
    v_cmp_eq_u32 vcc, 0, v7
    s_nop 1
    v_cndmask_b32 v8, v16, v5, vcc
    v_cndmask_b32 v9, v16, v6, vcc
    v_cmp_eq_u32 vcc, 1, v7
    s_nop 1
    v_cndmask_b32 v10, v16, v5, vcc
    v_cndmask_b32 v11, v16, v6, vcc
    v_cmp_eq_u32 vcc, 2, v7
    s_nop 1
    v_cndmask_b32 v12, v16, v5, vcc
    v_cndmask_b32 v13, v16, v6, vcc
    v_cmp_eq_u32 vcc, 3, v7
    s_nop 1
    v_cndmask_b32 v14, v16, v5, vcc
    v_cndmask_b32 v15, v16, v6, vcc
    v_lshlrev_b32 v5, 2, v4
    v_xor_b32 v5, v5, v3
    v_lshlrev_b32 v6, 10, v4
    v_xor_b32 v7, 0, v5
    v_lshl_add_u32 v20, v7, 4, v6
    v_xor_b32 v7, 1, v5
    v_lshl_add_u32 v21, v7, 4, v6
    v_add_u32 v21, 4096, v21
    v_xor_b32 v7, 2, v5
    v_lshl_add_u32 v22, v7, 4, v6
    v_add_u32 v22, 8192, v22
    v_xor_b32 v7, 3, v5
    v_lshl_add_u32 v23, v7, 4, v6
    v_add_u32 v23, 12288, v23
    s_lshl_b32 s58, s53, 19
    s_lshl_b32 s54, s3, 8
    s_add_u32 s58, s58, s54
    s_lshl_b32 s63, s3, 15
    s_mov_b32 s59, s63
    s_add_u32 m0, s59, 0
    s_add_u32 s54, s58, 0
    buffer_load_dwordx4 v20, s[32:35], s54 offen nt lds
    s_add_u32 m0, s59, 1024
    s_add_u32 s54, s58, 0
    buffer_load_dwordx4 v21, s[32:35], s54 offen nt lds
    s_add_u32 m0, s59, 2048
    s_add_u32 s54, s58, 0
    buffer_load_dwordx4 v22, s[32:35], s54 offen nt lds
    s_add_u32 m0, s59, 3072
    s_add_u32 s54, s58, 0
    buffer_load_dwordx4 v23, s[32:35], s54 offen nt lds
    s_add_u32 m0, s59, 4096
    s_add_u32 s54, s58, 16384
    buffer_load_dwordx4 v20, s[32:35], s54 offen nt lds
    s_add_u32 m0, s59, 5120
    s_add_u32 s54, s58, 16384
    buffer_load_dwordx4 v21, s[32:35], s54 offen nt lds
    s_add_u32 m0, s59, 6144
    s_add_u32 s54, s58, 16384
    buffer_load_dwordx4 v22, s[32:35], s54 offen nt lds
    s_add_u32 m0, s59, 7168
    s_add_u32 s54, s58, 16384
    buffer_load_dwordx4 v23, s[32:35], s54 offen nt lds
    s_add_u32 s58, s58, 32768
    s_add_u32 s59, s59, 8192
    s_waitcnt vmcnt(35)
    v_perm_b32 v96, v48, v48, v8
    v_perm_b32 v97, v48, v48, v10
    v_perm_b32 v98, v48, v48, v12
    v_perm_b32 v99, v48, v48, v14
    s_nop 1
    v_mfma_f32_16x16x32_bf16 v[112:115], v[96:99], a[0:3], 0
    v_perm_b32 v100, v68, v68, v8
    v_perm_b32 v101, v68, v68, v10
    v_perm_b32 v102, v68, v68, v12
    v_perm_b32 v103, v68, v68, v14
    s_nop 1
    v_mfma_f32_16x16x32_bf16 v[116:119], v[100:103], a[0:3], 0
    v_perm_b32 v104, v48, v48, v9
    v_perm_b32 v105, v48, v48, v11
    v_perm_b32 v106, v48, v48, v13
    v_perm_b32 v107, v48, v48, v15
    s_nop 1
    v_mfma_f32_16x16x32_bf16 v[112:115], v[104:107], a[4:7], v[112:115]
    v_perm_b32 v108, v68, v68, v9
    v_perm_b32 v109, v68, v68, v11
    v_perm_b32 v110, v68, v68, v13
    v_perm_b32 v111, v68, v68, v15
    s_nop 1
    v_mfma_f32_16x16x32_bf16 v[116:119], v[108:111], a[4:7], v[116:119]
    v_perm_b32 v96, v49, v49, v8
    v_perm_b32 v97, v49, v49, v10
    v_perm_b32 v98, v49, v49, v12
    v_perm_b32 v99, v49, v49, v14
    s_nop 1
    v_mfma_f32_16x16x32_bf16 v[112:115], v[96:99], a[8:11], v[112:115]
    v_perm_b32 v100, v69, v69, v8
    v_perm_b32 v101, v69, v69, v10
    v_perm_b32 v102, v69, v69, v12
    v_perm_b32 v103, v69, v69, v14
    s_nop 1
    v_mfma_f32_16x16x32_bf16 v[116:119], v[100:103], a[8:11], v[116:119]
    v_perm_b32 v104, v49, v49, v9
    v_perm_b32 v105, v49, v49, v11
    v_perm_b32 v106, v49, v49, v13
    v_perm_b32 v107, v49, v49, v15
    s_nop 1
    v_mfma_f32_16x16x32_bf16 v[112:115], v[104:107], a[12:15], v[112:115]
    v_perm_b32 v108, v69, v69, v9
    v_perm_b32 v109, v69, v69, v11
    v_perm_b32 v110, v69, v69, v13
    v_perm_b32 v111, v69, v69, v15
    s_nop 1
    v_mfma_f32_16x16x32_bf16 v[116:119], v[108:111], a[12:15], v[116:119]
    v_perm_b32 v96, v50, v50, v8
    v_perm_b32 v97, v50, v50, v10
    v_perm_b32 v98, v50, v50, v12
    v_perm_b32 v99, v50, v50, v14
    s_nop 1
    v_mfma_f32_16x16x32_bf16 v[112:115], v[96:99], a[16:19], v[112:115]
    v_perm_b32 v100, v70, v70, v8
    v_perm_b32 v101, v70, v70, v10
    v_perm_b32 v102, v70, v70, v12
    v_perm_b32 v103, v70, v70, v14
    s_nop 1
    v_mfma_f32_16x16x32_bf16 v[116:119], v[100:103], a[16:19], v[116:119]
    v_perm_b32 v104, v50, v50, v9
    v_perm_b32 v105, v50, v50, v11
    v_perm_b32 v106, v50, v50, v13
    v_perm_b32 v107, v50, v50, v15
    s_nop 1
    v_mfma_f32_16x16x32_bf16 v[112:115], v[104:107], a[20:23], v[112:115]
    v_perm_b32 v108, v70, v70, v9
    v_perm_b32 v109, v70, v70, v11
    v_perm_b32 v110, v70, v70, v13
    v_perm_b32 v111, v70, v70, v15
    s_nop 1
    v_mfma_f32_16x16x32_bf16 v[116:119], v[108:111], a[20:23], v[116:119]
    v_perm_b32 v96, v51, v51, v8
    v_perm_b32 v97, v51, v51, v10
    v_perm_b32 v98, v51, v51, v12
    v_perm_b32 v99, v51, v51, v14
    s_nop 1
    v_mfma_f32_16x16x32_bf16 v[112:115], v[96:99], a[24:27], v[112:115]
    v_perm_b32 v100, v71, v71, v8
    v_perm_b32 v101, v71, v71, v10
    v_perm_b32 v102, v71, v71, v12
    v_perm_b32 v103, v71, v71, v14
    s_nop 1
    v_mfma_f32_16x16x32_bf16 v[116:119], v[100:103], a[24:27], v[116:119]
    v_perm_b32 v104, v51, v51, v9
    v_perm_b32 v105, v51, v51, v11
    v_perm_b32 v106, v51, v51, v13
    v_perm_b32 v107, v51, v51, v15
    s_nop 1
    v_mfma_f32_16x16x32_bf16 v[112:115], v[104:107], a[28:31], v[112:115]
    v_perm_b32 v108, v71, v71, v9
    v_perm_b32 v109, v71, v71, v11
    v_perm_b32 v110, v71, v71, v13
    v_perm_b32 v111, v71, v71, v15
    s_nop 1
    v_mfma_f32_16x16x32_bf16 v[116:119], v[108:111], a[28:31], v[116:119]
    v_perm_b32 v96, v52, v52, v8
    v_perm_b32 v97, v52, v52, v10
    v_perm_b32 v98, v52, v52, v12
    v_perm_b32 v99, v52, v52, v14
    s_nop 1
    v_mfma_f32_16x16x32_bf16 v[112:115], v[96:99], a[32:35], v[112:115]
    v_perm_b32 v100, v72, v72, v8
    v_perm_b32 v101, v72, v72, v10
    v_perm_b32 v102, v72, v72, v12
    v_perm_b32 v103, v72, v72, v14
    s_nop 1
    v_mfma_f32_16x16x32_bf16 v[116:119], v[100:103], a[32:35], v[116:119]
    s_waitcnt vmcnt(26)
    v_perm_b32 v104, v52, v52, v9
    v_perm_b32 v105, v52, v52, v11
    v_perm_b32 v106, v52, v52, v13
    v_perm_b32 v107, v52, v52, v15
    s_nop 1
    v_mfma_f32_16x16x32_bf16 v[112:115], v[104:107], a[36:39], v[112:115]
    v_perm_b32 v108, v72, v72, v9
    v_perm_b32 v109, v72, v72, v11
    v_perm_b32 v110, v72, v72, v13
    v_perm_b32 v111, v72, v72, v15
    s_nop 1
    v_mfma_f32_16x16x32_bf16 v[116:119], v[108:111], a[36:39], v[116:119]
    v_perm_b32 v96, v53, v53, v8
    v_perm_b32 v97, v53, v53, v10
    v_perm_b32 v98, v53, v53, v12
    v_perm_b32 v99, v53, v53, v14
    s_nop 1
    v_mfma_f32_16x16x32_bf16 v[112:115], v[96:99], a[40:43], v[112:115]
    v_perm_b32 v100, v73, v73, v8
    v_perm_b32 v101, v73, v73, v10
    v_perm_b32 v102, v73, v73, v12
    v_perm_b32 v103, v73, v73, v14
    s_nop 1
    v_mfma_f32_16x16x32_bf16 v[116:119], v[100:103], a[40:43], v[116:119]
    v_perm_b32 v104, v53, v53, v9
    v_perm_b32 v105, v53, v53, v11
    v_perm_b32 v106, v53, v53, v13
    v_perm_b32 v107, v53, v53, v15
    s_nop 1
    v_mfma_f32_16x16x32_bf16 v[112:115], v[104:107], a[44:47], v[112:115]
    v_perm_b32 v108, v73, v73, v9
    v_perm_b32 v109, v73, v73, v11
    v_perm_b32 v110, v73, v73, v13
    v_perm_b32 v111, v73, v73, v15
    s_nop 1
    v_mfma_f32_16x16x32_bf16 v[116:119], v[108:111], a[44:47], v[116:119]
    v_perm_b32 v96, v54, v54, v8
    v_perm_b32 v97, v54, v54, v10
    v_perm_b32 v98, v54, v54, v12
    v_perm_b32 v99, v54, v54, v14
    s_nop 1
    v_mfma_f32_16x16x32_bf16 v[112:115], v[96:99], a[48:51], v[112:115]
    v_perm_b32 v100, v74, v74, v8
    v_perm_b32 v101, v74, v74, v10
    v_perm_b32 v102, v74, v74, v12
    v_perm_b32 v103, v74, v74, v14
    s_nop 1
    v_mfma_f32_16x16x32_bf16 v[116:119], v[100:103], a[48:51], v[116:119]
    v_perm_b32 v104, v54, v54, v9
    v_perm_b32 v105, v54, v54, v11
    v_perm_b32 v106, v54, v54, v13
    v_perm_b32 v107, v54, v54, v15
    s_nop 1
    v_mfma_f32_16x16x32_bf16 v[112:115], v[104:107], a[52:55], v[112:115]
    v_perm_b32 v108, v74, v74, v9
    v_perm_b32 v109, v74, v74, v11
    v_perm_b32 v110, v74, v74, v13
    v_perm_b32 v111, v74, v74, v15
    s_nop 1
    v_mfma_f32_16x16x32_bf16 v[116:119], v[108:111], a[52:55], v[116:119]
    v_perm_b32 v96, v55, v55, v8
    v_perm_b32 v97, v55, v55, v10
    v_perm_b32 v98, v55, v55, v12
    v_perm_b32 v99, v55, v55, v14
    s_nop 1
    v_mfma_f32_16x16x32_bf16 v[112:115], v[96:99], a[56:59], v[112:115]
    v_perm_b32 v100, v75, v75, v8
    v_perm_b32 v101, v75, v75, v10
    v_perm_b32 v102, v75, v75, v12
    v_perm_b32 v103, v75, v75, v14
    s_nop 1
    v_mfma_f32_16x16x32_bf16 v[116:119], v[100:103], a[56:59], v[116:119]
    v_perm_b32 v104, v55, v55, v9
    v_perm_b32 v105, v55, v55, v11
    v_perm_b32 v106, v55, v55, v13
    v_perm_b32 v107, v55, v55, v15
    s_nop 1
    v_mfma_f32_16x16x32_bf16 v[112:115], v[104:107], a[60:63], v[112:115]
    v_perm_b32 v108, v75, v75, v9
    v_perm_b32 v109, v75, v75, v11
    v_perm_b32 v110, v75, v75, v13
    v_perm_b32 v111, v75, v75, v15
    s_nop 1
    v_mfma_f32_16x16x32_bf16 v[116:119], v[108:111], a[60:63], v[116:119]
    v_perm_b32 v96, v56, v56, v8
    v_perm_b32 v97, v56, v56, v10
    v_perm_b32 v98, v56, v56, v12
    v_perm_b32 v99, v56, v56, v14
    s_nop 1
    v_mfma_f32_16x16x32_bf16 v[112:115], v[96:99], a[64:67], v[112:115]
    v_perm_b32 v100, v76, v76, v8
    v_perm_b32 v101, v76, v76, v10
    v_perm_b32 v102, v76, v76, v12
    v_perm_b32 v103, v76, v76, v14
    s_nop 1
    v_mfma_f32_16x16x32_bf16 v[116:119], v[100:103], a[64:67], v[116:119]
    v_perm_b32 v104, v56, v56, v9
    v_perm_b32 v105, v56, v56, v11
    v_perm_b32 v106, v56, v56, v13
    v_perm_b32 v107, v56, v56, v15
    s_nop 1
    v_mfma_f32_16x16x32_bf16 v[112:115], v[104:107], a[68:71], v[112:115]
    v_perm_b32 v108, v76, v76, v9
    v_perm_b32 v109, v76, v76, v11
    v_perm_b32 v110, v76, v76, v13
    v_perm_b32 v111, v76, v76, v15
    s_nop 1
    v_mfma_f32_16x16x32_bf16 v[116:119], v[108:111], a[68:71], v[116:119]
    s_waitcnt vmcnt(17)
    v_perm_b32 v96, v57, v57, v8
    v_perm_b32 v97, v57, v57, v10
    v_perm_b32 v98, v57, v57, v12
    v_perm_b32 v99, v57, v57, v14
    s_nop 1
    v_mfma_f32_16x16x32_bf16 v[112:115], v[96:99], a[72:75], v[112:115]
    v_perm_b32 v100, v77, v77, v8
    v_perm_b32 v101, v77, v77, v10
    v_perm_b32 v102, v77, v77, v12
    v_perm_b32 v103, v77, v77, v14
    s_nop 1
    v_mfma_f32_16x16x32_bf16 v[116:119], v[100:103], a[72:75], v[116:119]
    v_perm_b32 v104, v57, v57, v9
    v_perm_b32 v105, v57, v57, v11
    v_perm_b32 v106, v57, v57, v13
    v_perm_b32 v107, v57, v57, v15
    s_nop 1
    v_mfma_f32_16x16x32_bf16 v[112:115], v[104:107], a[76:79], v[112:115]
    v_perm_b32 v108, v77, v77, v9
    v_perm_b32 v109, v77, v77, v11
    v_perm_b32 v110, v77, v77, v13
    v_perm_b32 v111, v77, v77, v15
    s_nop 1
    v_mfma_f32_16x16x32_bf16 v[116:119], v[108:111], a[76:79], v[116:119]
    v_perm_b32 v96, v58, v58, v8
    v_perm_b32 v97, v58, v58, v10
    v_perm_b32 v98, v58, v58, v12
    v_perm_b32 v99, v58, v58, v14
    s_nop 1
    v_mfma_f32_16x16x32_bf16 v[112:115], v[96:99], a[80:83], v[112:115]
    v_perm_b32 v100, v78, v78, v8
    v_perm_b32 v101, v78, v78, v10
    v_perm_b32 v102, v78, v78, v12
    v_perm_b32 v103, v78, v78, v14
    s_nop 1
    v_mfma_f32_16x16x32_bf16 v[116:119], v[100:103], a[80:83], v[116:119]
    v_perm_b32 v104, v58, v58, v9
    v_perm_b32 v105, v58, v58, v11
    v_perm_b32 v106, v58, v58, v13
    v_perm_b32 v107, v58, v58, v15
    s_nop 1
    v_mfma_f32_16x16x32_bf16 v[112:115], v[104:107], a[84:87], v[112:115]
    v_perm_b32 v108, v78, v78, v9
    v_perm_b32 v109, v78, v78, v11
    v_perm_b32 v110, v78, v78, v13
    v_perm_b32 v111, v78, v78, v15
    s_nop 1
    v_mfma_f32_16x16x32_bf16 v[116:119], v[108:111], a[84:87], v[116:119]
    v_perm_b32 v96, v59, v59, v8
    v_perm_b32 v97, v59, v59, v10
    v_perm_b32 v98, v59, v59, v12
    v_perm_b32 v99, v59, v59, v14
    s_nop 1
    v_mfma_f32_16x16x32_bf16 v[112:115], v[96:99], a[88:91], v[112:115]
    v_perm_b32 v100, v79, v79, v8
    v_perm_b32 v101, v79, v79, v10
    v_perm_b32 v102, v79, v79, v12
    v_perm_b32 v103, v79, v79, v14
    s_nop 1
    v_mfma_f32_16x16x32_bf16 v[116:119], v[100:103], a[88:91], v[116:119]
    v_perm_b32 v104, v59, v59, v9
    v_perm_b32 v105, v59, v59, v11
    v_perm_b32 v106, v59, v59, v13
    v_perm_b32 v107, v59, v59, v15
    s_nop 1
    v_mfma_f32_16x16x32_bf16 v[112:115], v[104:107], a[92:95], v[112:115]
    v_perm_b32 v108, v79, v79, v9
    v_perm_b32 v109, v79, v79, v11
    v_perm_b32 v110, v79, v79, v13
    v_perm_b32 v111, v79, v79, v15
    s_nop 1
    v_mfma_f32_16x16x32_bf16 v[116:119], v[108:111], a[92:95], v[116:119]
    v_perm_b32 v96, v60, v60, v8
    v_perm_b32 v97, v60, v60, v10
    v_perm_b32 v98, v60, v60, v12
    v_perm_b32 v99, v60, v60, v14
    s_nop 1
    v_mfma_f32_16x16x32_bf16 v[112:115], v[96:99], a[96:99], v[112:115]
    v_perm_b32 v100, v80, v80, v8
    v_perm_b32 v101, v80, v80, v10
    v_perm_b32 v102, v80, v80, v12
    v_perm_b32 v103, v80, v80, v14
    s_nop 1
    v_mfma_f32_16x16x32_bf16 v[116:119], v[100:103], a[96:99], v[116:119]
    v_perm_b32 v104, v60, v60, v9
    v_perm_b32 v105, v60, v60, v11
    v_perm_b32 v106, v60, v60, v13
    v_perm_b32 v107, v60, v60, v15
    s_nop 1
    v_mfma_f32_16x16x32_bf16 v[112:115], v[104:107], a[100:103], v[112:115]
    v_perm_b32 v108, v80, v80, v9
    v_perm_b32 v109, v80, v80, v11
    v_perm_b32 v110, v80, v80, v13
    v_perm_b32 v111, v80, v80, v15
    s_nop 1
    v_mfma_f32_16x16x32_bf16 v[116:119], v[108:111], a[100:103], v[116:119]
    v_perm_b32 v96, v61, v61, v8
    v_perm_b32 v97, v61, v61, v10
    v_perm_b32 v98, v61, v61, v12
    v_perm_b32 v99, v61, v61, v14
    s_nop 1
    v_mfma_f32_16x16x32_bf16 v[112:115], v[96:99], a[104:107], v[112:115]
    v_perm_b32 v100, v81, v81, v8
    v_perm_b32 v101, v81, v81, v10
    v_perm_b32 v102, v81, v81, v12
    v_perm_b32 v103, v81, v81, v14
    s_nop 1
    v_mfma_f32_16x16x32_bf16 v[116:119], v[100:103], a[104:107], v[116:119]
    s_waitcnt vmcnt(8)
    v_perm_b32 v104, v61, v61, v9
    v_perm_b32 v105, v61, v61, v11
    v_perm_b32 v106, v61, v61, v13
    v_perm_b32 v107, v61, v61, v15
    s_nop 1
    v_mfma_f32_16x16x32_bf16 v[112:115], v[104:107], a[108:111], v[112:115]
    v_perm_b32 v108, v81, v81, v9
    v_perm_b32 v109, v81, v81, v11
    v_perm_b32 v110, v81, v81, v13
    v_perm_b32 v111, v81, v81, v15
    s_nop 1
    v_mfma_f32_16x16x32_bf16 v[116:119], v[108:111], a[108:111], v[116:119]
    v_perm_b32 v96, v62, v62, v8
    v_perm_b32 v97, v62, v62, v10
    v_perm_b32 v98, v62, v62, v12
    v_perm_b32 v99, v62, v62, v14
    s_nop 1
    v_mfma_f32_16x16x32_bf16 v[112:115], v[96:99], a[112:115], v[112:115]
    v_perm_b32 v100, v82, v82, v8
    v_perm_b32 v101, v82, v82, v10
    v_perm_b32 v102, v82, v82, v12
    v_perm_b32 v103, v82, v82, v14
    s_nop 1
    v_mfma_f32_16x16x32_bf16 v[116:119], v[100:103], a[112:115], v[116:119]
    v_perm_b32 v104, v62, v62, v9
    v_perm_b32 v105, v62, v62, v11
    v_perm_b32 v106, v62, v62, v13
    v_perm_b32 v107, v62, v62, v15
    s_nop 1
    v_mfma_f32_16x16x32_bf16 v[112:115], v[104:107], a[116:119], v[112:115]
    v_perm_b32 v108, v82, v82, v9
    v_perm_b32 v109, v82, v82, v11
    v_perm_b32 v110, v82, v82, v13
    v_perm_b32 v111, v82, v82, v15
    s_nop 1
    v_mfma_f32_16x16x32_bf16 v[116:119], v[108:111], a[116:119], v[116:119]
    v_perm_b32 v96, v63, v63, v8
    v_perm_b32 v97, v63, v63, v10
    v_perm_b32 v98, v63, v63, v12
    v_perm_b32 v99, v63, v63, v14
    s_nop 1
    v_mfma_f32_16x16x32_bf16 v[112:115], v[96:99], a[120:123], v[112:115]
    v_perm_b32 v100, v83, v83, v8
    v_perm_b32 v101, v83, v83, v10
    v_perm_b32 v102, v83, v83, v12
    v_perm_b32 v103, v83, v83, v14
    s_nop 1
    v_mfma_f32_16x16x32_bf16 v[116:119], v[100:103], a[120:123], v[116:119]
    v_perm_b32 v104, v63, v63, v9
    v_perm_b32 v105, v63, v63, v11
    v_perm_b32 v106, v63, v63, v13
    v_perm_b32 v107, v63, v63, v15
    s_nop 1
    v_mfma_f32_16x16x32_bf16 v[112:115], v[104:107], a[124:127], v[112:115]
    v_perm_b32 v108, v83, v83, v9
    v_perm_b32 v109, v83, v83, v11
    v_perm_b32 v110, v83, v83, v13
    v_perm_b32 v111, v83, v83, v15
    s_nop 1
    v_mfma_f32_16x16x32_bf16 v[116:119], v[108:111], a[124:127], v[116:119]
    v_perm_b32 v96, v64, v64, v8
    v_perm_b32 v97, v64, v64, v10
    v_perm_b32 v98, v64, v64, v12
    v_perm_b32 v99, v64, v64, v14
    s_nop 1
    v_mfma_f32_16x16x32_bf16 v[112:115], v[96:99], a[128:131], v[112:115]
    v_perm_b32 v100, v84, v84, v8
    v_perm_b32 v101, v84, v84, v10
    v_perm_b32 v102, v84, v84, v12
    v_perm_b32 v103, v84, v84, v14
    s_nop 1
    v_mfma_f32_16x16x32_bf16 v[116:119], v[100:103], a[128:131], v[116:119]
    v_perm_b32 v104, v64, v64, v9
    v_perm_b32 v105, v64, v64, v11
    v_perm_b32 v106, v64, v64, v13
    v_perm_b32 v107, v64, v64, v15
    s_nop 1
    v_mfma_f32_16x16x32_bf16 v[112:115], v[104:107], a[132:135], v[112:115]
    v_perm_b32 v108, v84, v84, v9
    v_perm_b32 v109, v84, v84, v11
    v_perm_b32 v110, v84, v84, v13
    v_perm_b32 v111, v84, v84, v15
    s_nop 1
    v_mfma_f32_16x16x32_bf16 v[116:119], v[108:111], a[132:135], v[116:119]
    v_perm_b32 v96, v65, v65, v8
    v_perm_b32 v97, v65, v65, v10
    v_perm_b32 v98, v65, v65, v12
    v_perm_b32 v99, v65, v65, v14
    s_nop 1
    v_mfma_f32_16x16x32_bf16 v[112:115], v[96:99], a[136:139], v[112:115]
    v_perm_b32 v100, v85, v85, v8
    v_perm_b32 v101, v85, v85, v10
    v_perm_b32 v102, v85, v85, v12
    v_perm_b32 v103, v85, v85, v14
    s_nop 1
    v_mfma_f32_16x16x32_bf16 v[116:119], v[100:103], a[136:139], v[116:119]
    v_perm_b32 v104, v65, v65, v9
    v_perm_b32 v105, v65, v65, v11
    v_perm_b32 v106, v65, v65, v13
    v_perm_b32 v107, v65, v65, v15
    s_nop 1
    v_mfma_f32_16x16x32_bf16 v[112:115], v[104:107], a[140:143], v[112:115]
    v_perm_b32 v108, v85, v85, v9
    v_perm_b32 v109, v85, v85, v11
    v_perm_b32 v110, v85, v85, v13
    v_perm_b32 v111, v85, v85, v15
    s_nop 1
    v_mfma_f32_16x16x32_bf16 v[116:119], v[108:111], a[140:143], v[116:119]
    v_lshrrev_b32 v5, 1, v4
    v_lshlrev_b32 v5, 9, v5
    v_lshl_add_u32 v5, v3, 5, v5
    v_and_b32 v6, 1, v4
    v_lshl_add_u32 v5, v6, 4, v5
    s_lshl_b32 s54, s3, 11
    s_add_u32 s54, s54, 139264
    v_add_u32 v5, s54, v5
    ds_write_b128 v5, v[112:115]
    ds_write_b128 v5, v[116:119] offset:1024
    s_waitcnt lgkmcnt(0)
    s_barrier
    s_lshl_b32 s54, s3, 9
    s_add_u32 s54, s54, 139264
    v_lshl_add_u32 v5, v3, 5, s54
    ds_read_b128 v[48:51], v5 offset:0
    ds_read_b128 v[52:55], v5 offset:16
    ds_read_b128 v[56:59], v5 offset:2048
    ds_read_b128 v[60:63], v5 offset:2064
    ds_read_b128 v[64:67], v5 offset:4096
    ds_read_b128 v[68:71], v5 offset:4112
    ds_read_b128 v[72:75], v5 offset:6144
    ds_read_b128 v[76:79], v5 offset:6160
    s_waitcnt lgkmcnt(0)
    v_add_f32 v48, v48, v56
    v_add_f32 v64, v64, v72
    v_add_f32 v49, v49, v57
    v_add_f32 v65, v65, v73
    v_add_f32 v50, v50, v58
    v_add_f32 v66, v66, v74
    v_add_f32 v51, v51, v59
    v_add_f32 v67, v67, v75
    v_add_f32 v52, v52, v60
    v_add_f32 v68, v68, v76
    v_add_f32 v53, v53, v61
    v_add_f32 v69, v69, v77
    v_add_f32 v54, v54, v62
    v_add_f32 v70, v70, v78
    v_add_f32 v55, v55, v63
    v_add_f32 v71, v71, v79
    v_add_f32 v48, v48, v64
    v_add_f32 v49, v49, v65
    v_add_f32 v50, v50, v66
    v_add_f32 v51, v51, v67
    v_add_f32 v52, v52, v68
    v_add_f32 v53, v53, v69
    v_add_f32 v54, v54, v70
    v_add_f32 v55, v55, v71
    v_cvt_pk_bf16_f32 v124, v48, v49
    v_cvt_pk_bf16_f32 v125, v50, v51
    v_cvt_pk_bf16_f32 v126, v52, v53
    v_cvt_pk_bf16_f32 v127, v54, v55
    v_min_u32 v124, -2, v124
    v_min_u32 v125, -2, v125
    v_min_u32 v126, -2, v126
    v_min_u32 v127, -2, v127
    buffer_store_dwordx4 v[124:127], v123, s[44:47], s98 offen sc1
    s_add_u32 m0, s59, 0
    s_add_u32 s54, s58, 0
    buffer_load_dwordx4 v20, s[32:35], s54 offen nt lds
    s_add_u32 m0, s59, 1024
    s_add_u32 s54, s58, 0
    buffer_load_dwordx4 v21, s[32:35], s54 offen nt lds
    s_add_u32 m0, s59, 2048
    s_add_u32 s54, s58, 0
    buffer_load_dwordx4 v22, s[32:35], s54 offen nt lds
    s_add_u32 m0, s59, 3072
    s_add_u32 s54, s58, 0
    buffer_load_dwordx4 v23, s[32:35], s54 offen nt lds
    s_add_u32 m0, s59, 4096
    s_add_u32 s54, s58, 16384
    buffer_load_dwordx4 v20, s[32:35], s54 offen nt lds
    s_add_u32 m0, s59, 5120
    s_add_u32 s54, s58, 16384
    buffer_load_dwordx4 v21, s[32:35], s54 offen nt lds
    s_add_u32 m0, s59, 6144
    s_add_u32 s54, s58, 16384
    buffer_load_dwordx4 v22, s[32:35], s54 offen nt lds
    s_add_u32 m0, s59, 7168
    s_add_u32 s54, s58, 16384
    buffer_load_dwordx4 v23, s[32:35], s54 offen nt lds
    s_add_u32 s58, s58, 32768
    s_add_u32 s59, s59, 8192
    s_add_u32 m0, s59, 0
    s_add_u32 s54, s58, 0
    buffer_load_dwordx4 v20, s[32:35], s54 offen nt lds
    s_add_u32 m0, s59, 1024
    s_add_u32 s54, s58, 0
    buffer_load_dwordx4 v21, s[32:35], s54 offen nt lds
    s_add_u32 m0, s59, 2048
    s_add_u32 s54, s58, 0
    buffer_load_dwordx4 v22, s[32:35], s54 offen nt lds
    s_add_u32 m0, s59, 3072
    s_add_u32 s54, s58, 0
    buffer_load_dwordx4 v23, s[32:35], s54 offen nt lds
    s_add_u32 m0, s59, 4096
    s_add_u32 s54, s58, 16384
    buffer_load_dwordx4 v20, s[32:35], s54 offen nt lds
    s_add_u32 m0, s59, 5120
    s_add_u32 s54, s58, 16384
    buffer_load_dwordx4 v21, s[32:35], s54 offen nt lds
    s_add_u32 m0, s59, 6144
    s_add_u32 s54, s58, 16384
    buffer_load_dwordx4 v22, s[32:35], s54 offen nt lds
    s_add_u32 m0, s59, 7168
    s_add_u32 s54, s58, 16384
    buffer_load_dwordx4 v23, s[32:35], s54 offen nt lds
    s_add_u32 s58, s58, 32768
    s_add_u32 s59, s59, 8192
    s_add_u32 m0, s59, 0
    s_add_u32 s54, s58, 0
    buffer_load_dwordx4 v20, s[32:35], s54 offen nt lds
    s_add_u32 m0, s59, 1024
    s_add_u32 s54, s58, 0
    buffer_load_dwordx4 v21, s[32:35], s54 offen nt lds
    s_add_u32 m0, s59, 2048
    s_add_u32 s54, s58, 0
    buffer_load_dwordx4 v22, s[32:35], s54 offen nt lds
    s_add_u32 m0, s59, 3072
    s_add_u32 s54, s58, 0
    buffer_load_dwordx4 v23, s[32:35], s54 offen nt lds
    s_add_u32 m0, s59, 4096
    s_add_u32 s54, s58, 16384
    buffer_load_dwordx4 v20, s[32:35], s54 offen nt lds
    s_add_u32 m0, s59, 5120
    s_add_u32 s54, s58, 16384
    buffer_load_dwordx4 v21, s[32:35], s54 offen nt lds
    s_add_u32 m0, s59, 6144
    s_add_u32 s54, s58, 16384
    buffer_load_dwordx4 v22, s[32:35], s54 offen nt lds
    s_add_u32 m0, s59, 7168
    s_add_u32 s54, s58, 16384
    buffer_load_dwordx4 v23, s[32:35], s54 offen nt lds
    s_add_u32 s58, s58, 32768
    s_add_u32 s59, s59, 8192
    s_waitcnt vmcnt(40)
    v_mov_b32 v27, 0
    global_load_dword v18, v27, s[28:29] sc1
    buffer_load_dwordx4 a[96:99], v20, s[32:35], s58 offen nt
    buffer_load_dwordx4 a[100:103], v21, s[32:35], s58 offen nt
    buffer_load_dwordx4 a[104:107], v22, s[32:35], s58 offen nt
    buffer_load_dwordx4 a[108:111], v23, s[32:35], s58 offen nt
    s_add_u32 s58, s58, 16384
    buffer_load_dwordx4 a[112:115], v20, s[32:35], s58 offen nt
    buffer_load_dwordx4 a[116:119], v21, s[32:35], s58 offen nt
    buffer_load_dwordx4 a[120:123], v22, s[32:35], s58 offen nt
    buffer_load_dwordx4 a[124:127], v23, s[32:35], s58 offen nt
    s_add_u32 s58, s58, 16384
    s_waitcnt vmcnt(40)
    buffer_load_dwordx4 a[128:131], v20, s[32:35], s58 offen nt
    buffer_load_dwordx4 a[132:135], v21, s[32:35], s58 offen nt
    buffer_load_dwordx4 a[136:139], v22, s[32:35], s58 offen nt
    buffer_load_dwordx4 a[140:143], v23, s[32:35], s58 offen nt
    s_add_u32 s58, s58, 16384
    buffer_load_dwordx4 a[144:147], v20, s[32:35], s58 offen nt
    buffer_load_dwordx4 a[148:151], v21, s[32:35], s58 offen nt
    buffer_load_dwordx4 a[152:155], v22, s[32:35], s58 offen nt
    buffer_load_dwordx4 a[156:159], v23, s[32:35], s58 offen nt
    s_add_u32 s58, s58, 16384
    s_mov_b32 s36, s12
    s_mov_b32 s37, s13
    s_mov_b32 s38, 4718592
    s_mov_b32 s39, 0x20000
    v_mul_u32_u24 v49, 9216, v4
    v_lshl_add_u32 v48, v3, 4, v49
    v_lshl_add_u32 v49, v3, 2, v49
    s_mul_i32 s100, s52, 147456
    s_lshl_b32 s54, s3, 8
    s_add_u32 s99, s100, s54
    s_and_b32 s54, s3, 1
    s_lshl_b32 s54, s54, 6
    s_add_u32 s100, s100, s54
    s_add_u32 s100, s100, 1024
    v_add_u32 v26, s63, v2
    v_and_b32 v24, 31, v1
    v_lshrrev_b32 v25, 5, v1
    v_lshlrev_b32 v19, 10, v24
    v_lshl_add_u32 v19, v25, 4, v19
    s_lshr_b32 s96, s53, 3
    s_lshl_b32 s96, s96, 15
    s_lshl_b32 s55, s3, 8
    s_add_u32 s96, s96, s55
    s_add_u32 s96, s96, 1048576
    v_and_b32 v5, 3, v24
    v_lshlrev_b32 v5, 2, v5
    v_bfe_u32 v6, v24, 2, 2
    v_or_b32 v5, v5, v6
    v_xor_b32 v5, v5, v25
    v_lshlrev_b32 v32, 8, v24
    v_lshl_add_u32 v32, v5, 4, v32
    v_add_u32 v32, s63, v32
    v_bfe_u32 v5, v1, 2, 2
    v_lshl_add_u32 v6, v25, 2, v5
    v_lshlrev_b32 v40, 8, v6
    v_and_b32 v6, 1, v1
    v_lshl_add_u32 v40, v6, 3, v40
    v_bfe_u32 v6, v1, 4, 1
    v_lshlrev_b32 v6, 1, v6
    v_bfe_u32 v7, v1, 1, 1
    v_or_b32 v6, v6, v7
    v_xor_b32 v6, v6, v25
    v_lshl_or_b32 v6, v5, 2, v6
    v_lshl_add_u32 v40, v6, 4, v40
    v_add_u32 v40, s63, v40
    v_xor_b32 v33, 32, v32
    v_xor_b32 v41, 32, v40
    v_xor_b32 v34, 64, v32
    v_xor_b32 v42, 64, v40
    v_xor_b32 v35, 96, v32
    v_xor_b32 v43, 96, v40
    v_xor_b32 v36, 128, v32
    v_xor_b32 v44, 128, v40
    v_xor_b32 v37, 160, v32
    v_xor_b32 v45, 160, v40
    v_xor_b32 v38, 192, v32
    v_xor_b32 v46, 192, v40
    v_xor_b32 v39, 224, v32
    v_xor_b32 v47, 224, v40
    s_lshl_b32 s54, s3, 12
    s_add_u32 s54, s54, 131072
    v_add_u32 v28, s54, v2
    v_xor_b32 v29, 4096, v28
    v_xor_b32 v30, 8192, v28
    v_xor_b32 v31, 12288, v28
    v_lshlrev_b32 v192, 10, v4
    v_lshl_add_u32 v192, v3, 4, v192
    v_add_u32 v193, 4096, v192
    v_add_u32 v194, 8192, v192
    v_add_u32 v195, 12288, v192
    v_add_u32 v196, 16384, v192
    v_add_u32 v197, 20480, v192
    v_add_u32 v198, 24576, v192
    v_add_u32 v199, 28672, v192
    v_xor_b32 v5, v3, v4
    v_lshlrev_b32 v200, 8, v4
    v_lshl_add_u32 v200, v5, 4, v200
    v_add_u32 v200, s54, v200
    v_xor_b32 v201, 64, v200
    v_xor_b32 v202, 128, v200
    v_xor_b32 v203, 192, v200
    v_xor_b32 v5, v3, v25
    v_lshlrev_b32 v204, 8, v3
    v_lshl_add_u32 v204, v5, 4, v204
    v_and_b32 v5, 1, v4
    v_lshl_add_u32 v204, v5, 14, v204
    v_add_u32 v204, s54, v204
    v_mov_b32 v64, 0
    v_mov_b32 v65, 0
    v_mov_b32 v66, 0
    v_mov_b32 v67, 0
    v_mov_b32 v68, 0
    v_mov_b32 v69, 0
    v_mov_b32 v70, 0
    v_mov_b32 v71, 0
    v_mov_b32 v72, 0
    v_mov_b32 v73, 0
    v_mov_b32 v74, 0
    v_mov_b32 v75, 0
    v_mov_b32 v76, 0
    v_mov_b32 v77, 0
    v_mov_b32 v78, 0
    v_mov_b32 v79, 0
    v_mov_b32 v80, 0
    v_mov_b32 v81, 0
    v_mov_b32 v82, 0
    v_mov_b32 v83, 0
    v_mov_b32 v84, 0
    v_mov_b32 v85, 0
    v_mov_b32 v86, 0
    v_mov_b32 v87, 0
    v_mov_b32 v88, 0
    v_mov_b32 v89, 0
    v_mov_b32 v90, 0
    v_mov_b32 v91, 0
    v_mov_b32 v92, 0
    v_mov_b32 v93, 0
    v_mov_b32 v94, 0
    v_mov_b32 v95, 0
    v_mov_b32 v96, 0
    v_mov_b32 v97, 0
    v_mov_b32 v98, 0
    v_mov_b32 v99, 0
    v_mov_b32 v100, 0
    v_mov_b32 v101, 0
    v_mov_b32 v102, 0
    v_mov_b32 v103, 0
    v_mov_b32 v104, 0
    v_mov_b32 v105, 0
    v_mov_b32 v106, 0
    v_mov_b32 v107, 0
    v_mov_b32 v108, 0
    v_mov_b32 v109, 0
    v_mov_b32 v110, 0
    v_mov_b32 v111, 0
    v_mov_b32 v112, 0
    v_mov_b32 v113, 0
    v_mov_b32 v114, 0
    v_mov_b32 v115, 0
    v_mov_b32 v116, 0
    v_mov_b32 v117, 0
    v_mov_b32 v118, 0
    v_mov_b32 v119, 0
    v_mov_b32 v120, 0
    v_mov_b32 v121, 0
    v_mov_b32 v122, 0
    v_mov_b32 v123, 0
    v_mov_b32 v124, 0
    v_mov_b32 v125, 0
    v_mov_b32 v126, 0
    v_mov_b32 v127, 0
    v_mov_b32 v216, 0xff800000
    v_mov_b32 v217, 0
    s_waitcnt vmcnt(16)
L_flags_34:
    v_cmp_gt_u32 vcc, 1073741824, v18
    s_cbranch_vccz L_flagsok_35
    s_sleep 2
    global_load_dword v18, v27, s[28:29] sc1
    s_waitcnt vmcnt(0)
    s_sub_u32 s101, s101, 1
    s_cbranch_scc0 L_flags_34
    s_mov_b32 s101, 0
L_flagsok_35:
    s_barrier
    ds_read_b128 a[32:35], v32 offset:0
    ds_read_b128 a[36:39], v33 offset:0
    ds_read_b128 a[40:43], v34 offset:0
    ds_read_b128 a[44:47], v35 offset:0
    ds_read_b128 a[48:51], v36 offset:0
    ds_read_b128 a[52:55], v37 offset:0
    ds_read_b128 a[56:59], v38 offset:0
    ds_read_b128 a[60:63], v39 offset:0
    buffer_load_dwordx4 v[128:131], v192, s[44:47], s96 offen sc1
    buffer_load_dwordx4 v[132:135], v193, s[44:47], s96 offen sc1
    buffer_load_dwordx4 v[136:139], v194, s[44:47], s96 offen sc1
    buffer_load_dwordx4 v[140:143], v195, s[44:47], s96 offen sc1
    buffer_load_dwordx4 v[144:147], v196, s[44:47], s96 offen sc1
    buffer_load_dwordx4 v[148:151], v197, s[44:47], s96 offen sc1
    buffer_load_dwordx4 v[152:155], v198, s[44:47], s96 offen sc1
    buffer_load_dwordx4 v[156:159], v199, s[44:47], s96 offen sc1
    buffer_load_dwordx4 a[160:163], v20, s[32:35], s58 offen nt
    buffer_load_dwordx4 a[164:167], v21, s[32:35], s58 offen nt
    buffer_load_dwordx4 a[168:171], v22, s[32:35], s58 offen nt
    buffer_load_dwordx4 a[172:175], v23, s[32:35], s58 offen nt
    s_add_u32 s58, s58, 16384
    buffer_load_dwordx4 a[176:179], v20, s[32:35], s58 offen nt
    buffer_load_dwordx4 a[180:183], v21, s[32:35], s58 offen nt
    buffer_load_dwordx4 a[184:187], v22, s[32:35], s58 offen nt
    buffer_load_dwordx4 a[188:191], v23, s[32:35], s58 offen nt
    s_add_u32 s58, s58, 16384
    s_waitcnt vmcnt(8)
    s_branch L_qpoll_36_c
L_qpoll_36:
    s_sleep 4
    buffer_load_dwordx4 v[128:131], v192, s[44:47], s96 offen sc1
    buffer_load_dwordx4 v[132:135], v193, s[44:47], s96 offen sc1
    buffer_load_dwordx4 v[136:139], v194, s[44:47], s96 offen sc1
    buffer_load_dwordx4 v[140:143], v195, s[44:47], s96 offen sc1
    buffer_load_dwordx4 v[144:147], v196, s[44:47], s96 offen sc1
    buffer_load_dwordx4 v[148:151], v197, s[44:47], s96 offen sc1
    buffer_load_dwordx4 v[152:155], v198, s[44:47], s96 offen sc1
    buffer_load_dwordx4 v[156:159], v199, s[44:47], s96 offen sc1
    s_waitcnt vmcnt(0)
L_qpoll_36_c:
    v_max3_u32 v5, v128, v129, v130
    v_max3_u32 v6, v144, v145, v146
    v_max3_u32 v5, v5, v131, v132
    v_max3_u32 v6, v6, v147, v148
    v_max3_u32 v5, v5, v133, v134
    v_max3_u32 v6, v6, v149, v150
    v_max3_u32 v5, v5, v135, v136
    v_max3_u32 v6, v6, v151, v152
    v_max3_u32 v5, v5, v137, v138
    v_max3_u32 v6, v6, v153, v154
    v_max3_u32 v5, v5, v139, v140
    v_max3_u32 v6, v6, v155, v156
    v_max3_u32 v5, v5, v141, v142
    v_max3_u32 v6, v6, v157, v158
    v_max3_u32 v5, v5, v143, v159
    v_max_u32 v5, v5, v6
    v_cmp_eq_u32 vcc, -1, v5
    s_nop 0
    s_mov_b64 exec, vcc
    s_cbranch_execz L_qok_37
    s_sub_u32 s101, s101, 1
    s_cbranch_scc0 L_qpoll_36
    s_mov_b32 s101, 0
L_qok_37:
    s_mov_b64 exec, -1
    ds_write_b128 v200, v[128:131] offset:0
    ds_write_b128 v201, v[132:135] offset:1024
    ds_write_b128 v202, v[136:139] offset:2048
    ds_write_b128 v203, v[140:143] offset:3072
    ds_write_b128 v200, v[144:147] offset:16384
    ds_write_b128 v201, v[148:151] offset:17408
    ds_write_b128 v202, v[152:155] offset:18432
    ds_write_b128 v203, v[156:159] offset:19456
    v_xor_b32 v192, 0, v204
    v_xor_b32 v193, 32, v204
    v_xor_b32 v194, 64, v204
    v_xor_b32 v195, 96, v204
    v_xor_b32 v196, 128, v204
    v_xor_b32 v197, 160, v204
    v_xor_b32 v198, 192, v204
    v_xor_b32 v199, 224, v204
    s_waitcnt lgkmcnt(0)
    ds_read_b128 a[0:3], v192
    ds_read_b128 a[4:7], v193
    ds_read_b128 a[8:11], v194
    ds_read_b128 a[12:15], v195
    ds_read_b128 a[16:19], v196
    ds_read_b128 a[20:23], v197
    ds_read_b128 a[24:27], v198
    ds_read_b128 a[28:31], v199
    s_waitcnt lgkmcnt(0)
    v_mfma_f32_32x32x16_bf16 v[128:143], a[32:35], a[0:3], 0
    v_mfma_f32_32x32x16_bf16 v[128:143], a[36:39], a[4:7], v[128:143]
    v_mfma_f32_32x32x16_bf16 v[128:143], a[40:43], a[8:11], v[128:143]
    v_mfma_f32_32x32x16_bf16 v[128:143], a[44:47], a[12:15], v[128:143]
    v_mfma_f32_32x32x16_bf16 v[128:143], a[48:51], a[16:19], v[128:143]
    v_mfma_f32_32x32x16_bf16 v[128:143], a[52:55], a[20:23], v[128:143]
    v_mfma_f32_32x32x16_bf16 v[128:143], a[56:59], a[24:27], v[128:143]
    v_mfma_f32_32x32x16_bf16 v[128:143], a[60:63], a[28:31], v[128:143]
    s_nop 11
    ds_write_b128 v28, v[128:131] offset:0
    ds_write_b128 v28, v[132:135] offset:1024
    ds_write_b128 v28, v[136:139] offset:2048
    ds_write_b128 v28, v[140:143] offset:3072
    s_waitcnt lgkmcnt(0)
    s_barrier
    ds_read_b128 v[144:147], v29 offset:0
    ds_read_b128 v[148:151], v29 offset:1024
    ds_read_b128 v[152:155], v29 offset:2048
    ds_read_b128 v[156:159], v29 offset:3072
    ds_read_b128 v[160:163], v30 offset:0
    ds_read_b128 v[164:167], v30 offset:1024
    ds_read_b128 v[168:171], v30 offset:2048
    ds_read_b128 v[172:175], v30 offset:3072
    ds_read_b128 v[176:179], v31 offset:0
    ds_read_b128 v[180:183], v31 offset:1024
    ds_read_b128 v[184:187], v31 offset:2048
    ds_read_b128 v[188:191], v31 offset:3072
    ds_read_b128 a[32:35], v32 offset:8192
    ds_read_b128 a[36:39], v33 offset:8192
    ds_read_b128 a[40:43], v34 offset:8192
    ds_read_b128 a[44:47], v35 offset:8192
    ds_read_b128 a[48:51], v36 offset:8192
    ds_read_b128 a[52:55], v37 offset:8192
    ds_read_b128 a[56:59], v38 offset:8192
    ds_read_b128 a[60:63], v39 offset:8192
    s_waitcnt lgkmcnt(8)
    v_add_f32 v144, v144, v128
    v_add_f32 v145, v145, v129
    v_add_f32 v146, v146, v130
    v_add_f32 v147, v147, v131
    buffer_load_dwordx4 a[192:195], v20, s[32:35], s58 offen nt
    v_add_f32 v148, v148, v132
    v_add_f32 v149, v149, v133
    v_add_f32 v150, v150, v134
    v_add_f32 v151, v151, v135
    v_add_f32 v152, v152, v136
    v_add_f32 v153, v153, v137
    v_add_f32 v154, v154, v138
    v_add_f32 v155, v155, v139
    v_add_f32 v156, v156, v140
    v_add_f32 v157, v157, v141
    v_add_f32 v158, v158, v142
    v_add_f32 v159, v159, v143
    s_waitcnt lgkmcnt(0)
    v_mfma_f32_32x32x16_bf16 v[128:143], a[32:35], a[0:3], 0
    ds_read_b64_tr_b16 a[64:65], v40 offset:0
    ds_read_b64_tr_b16 a[66:67], v41 offset:2048
    v_add_f32 v160, v160, v176
    v_add_f32 v161, v161, v177
    v_add_f32 v162, v162, v178
    v_add_f32 v163, v163, v179
    v_add_f32 v164, v164, v180
    v_mfma_f32_32x32x16_bf16 v[128:143], a[36:39], a[4:7], v[128:143]
    ds_read_b64_tr_b16 a[72:73], v42 offset:0
    ds_read_b64_tr_b16 a[74:75], v43 offset:2048
    v_add_f32 v165, v165, v181
    v_add_f32 v166, v166, v182
    v_add_f32 v167, v167, v183
    v_add_f32 v168, v168, v184
    v_add_f32 v169, v169, v185
    v_mfma_f32_32x32x16_bf16 v[128:143], a[40:43], a[8:11], v[128:143]
    ds_read_b64_tr_b16 a[80:81], v44 offset:0
    ds_read_b64_tr_b16 a[82:83], v45 offset:2048
    v_add_f32 v170, v170, v186
    v_add_f32 v171, v171, v187
    v_add_f32 v172, v172, v188
    v_add_f32 v173, v173, v189
    v_add_f32 v174, v174, v190
    v_mfma_f32_32x32x16_bf16 v[128:143], a[44:47], a[12:15], v[128:143]
    ds_read_b64_tr_b16 a[88:89], v46 offset:0
    ds_read_b64_tr_b16 a[90:91], v47 offset:2048
    v_add_f32 v175, v175, v191
    v_add_f32 v144, v144, v160
    v_add_f32 v145, v145, v161
    v_add_f32 v146, v146, v162
    v_add_f32 v147, v147, v163
    v_mfma_f32_32x32x16_bf16 v[128:143], a[48:51], a[16:19], v[128:143]
    ds_read_b64_tr_b16 a[68:69], v40 offset:4096
    ds_read_b64_tr_b16 a[70:71], v41 offset:6144
    v_add_f32 v148, v148, v164
    v_add_f32 v149, v149, v165
    v_add_f32 v150, v150, v166
    v_add_f32 v151, v151, v167
    v_add_f32 v152, v152, v168
    v_mfma_f32_32x32x16_bf16 v[128:143], a[52:55], a[20:23], v[128:143]
    ds_read_b64_tr_b16 a[76:77], v42 offset:4096
    ds_read_b64_tr_b16 a[78:79], v43 offset:6144
    v_add_f32 v153, v153, v169
    v_add_f32 v154, v154, v170
    v_add_f32 v155, v155, v171
    v_add_f32 v156, v156, v172
    v_add_f32 v157, v157, v173
    v_mfma_f32_32x32x16_bf16 v[128:143], a[56:59], a[24:27], v[128:143]
    ds_read_b64_tr_b16 a[84:85], v44 offset:4096
    ds_read_b64_tr_b16 a[86:87], v45 offset:6144
    v_add_f32 v158, v158, v174
    v_add_f32 v159, v159, v175
    v_max3_f32 v218, v144, v145, v146
    v_max3_f32 v219, v147, v148, v149
    v_max3_f32 v220, v150, v151, v152
    v_mfma_f32_32x32x16_bf16 v[128:143], a[60:63], a[28:31], v[128:143]
    ds_read_b64_tr_b16 a[92:93], v46 offset:4096
    ds_read_b64_tr_b16 a[94:95], v47 offset:6144
    v_max3_f32 v221, v153, v154, v155
    v_max3_f32 v218, v218, v156, v157
    v_max3_f32 v219, v219, v158, v159
    v_max3_f32 v218, v218, v219, v220
    v_max_f32 v218, v218, v221
    v_mov_b32 v219, v218
    s_nop 1
    v_permlane32_swap_b32 v218, v219
    v_max3_f32 v218, v218, v219, v216
    v_sub_f32 v220, v216, v218
    v_mov_b32 v216, v218
    v_exp_f32 v220, v220
    v_sub_f32 v192, v144, v218
    v_sub_f32 v193, v145, v218
    buffer_load_dwordx4 a[196:199], v21, s[32:35], s58 offen nt
    v_sub_f32 v194, v146, v218
    v_sub_f32 v195, v147, v218
    v_sub_f32 v196, v148, v218
    v_sub_f32 v197, v149, v218
    v_sub_f32 v198, v150, v218
    buffer_load_dwordx4 a[200:203], v22, s[32:35], s58 offen nt
    v_sub_f32 v199, v151, v218
    v_sub_f32 v200, v152, v218
    v_sub_f32 v201, v153, v218
    v_sub_f32 v202, v154, v218
    v_sub_f32 v203, v155, v218
    v_sub_f32 v204, v156, v218
    v_sub_f32 v205, v157, v218
    v_sub_f32 v206, v158, v218
    v_sub_f32 v207, v159, v218
    ds_write_b128 v28, v[128:131] offset:16384
    v_exp_f32 v192, v192
    v_exp_f32 v193, v193
    v_exp_f32 v194, v194
    v_exp_f32 v195, v195
    ds_write_b128 v28, v[132:135] offset:17408
    v_exp_f32 v196, v196
    v_exp_f32 v197, v197
    v_exp_f32 v198, v198
    v_exp_f32 v199, v199
    ds_write_b128 v28, v[136:139] offset:18432
    v_exp_f32 v200, v200
    v_exp_f32 v201, v201
    v_exp_f32 v202, v202
    v_exp_f32 v203, v203
    ds_write_b128 v28, v[140:143] offset:19456
    v_exp_f32 v204, v204
    v_exp_f32 v205, v205
    v_exp_f32 v206, v206
    v_exp_f32 v207, v207
    v_mul_f32 v217, v217, v220
    v_cvt_pk_bf16_f32 v208, v192, v193
    v_cvt_pk_bf16_f32 v209, v194, v195
    v_cvt_pk_bf16_f32 v210, v196, v197
    v_cvt_pk_bf16_f32 v211, v198, v199
    v_cvt_pk_bf16_f32 v212, v200, v201
    v_cvt_pk_bf16_f32 v213, v202, v203
    v_cvt_pk_bf16_f32 v214, v204, v205
    v_cvt_pk_bf16_f32 v215, v206, v207
    v_mul_f32 v64, v64, v220
    v_mul_f32 v65, v65, v220
    v_mul_f32 v66, v66, v220
    v_mul_f32 v67, v67, v220
    v_mul_f32 v68, v68, v220
    v_mul_f32 v69, v69, v220
    v_mul_f32 v70, v70, v220
    v_mul_f32 v71, v71, v220
    v_mul_f32 v72, v72, v220
    v_mul_f32 v73, v73, v220
    v_mul_f32 v74, v74, v220
    v_mul_f32 v75, v75, v220
    v_mul_f32 v76, v76, v220
    v_mul_f32 v77, v77, v220
    v_mul_f32 v78, v78, v220
    v_mul_f32 v79, v79, v220
    s_waitcnt lgkmcnt(0)
    s_barrier
    v_mfma_f32_32x32x16_bf16 v[64:79], a[64:67], v[208:211], v[64:79]
    ds_read_b128 v[144:147], v29 offset:16384
    v_mul_f32 v80, v80, v220
    v_mul_f32 v81, v81, v220
    ds_read_b128 v[148:151], v29 offset:17408
    ds_write_b128 v26, a[96:99] offset:0
    buffer_load_dwordx4 a[204:207], v23, s[32:35], s58 offen nt
    s_add_u32 s58, s58, 16384
    v_mul_f32 v82, v82, v220
    v_mul_f32 v83, v83, v220
    ds_read_b128 v[152:155], v29 offset:18432
    v_mul_f32 v84, v84, v220
    v_mfma_f32_32x32x16_bf16 v[64:79], a[68:71], v[212:215], v[64:79]
    v_mul_f32 v85, v85, v220
    ds_read_b128 v[156:159], v29 offset:19456
    v_mul_f32 v86, v86, v220
    ds_write_b128 v26, a[100:103] offset:1024
    v_mul_f32 v87, v87, v220
    v_mul_f32 v88, v88, v220
    v_mul_f32 v89, v89, v220
    v_mul_f32 v90, v90, v220
    v_mul_f32 v91, v91, v220
    v_mul_f32 v92, v92, v220
    v_mul_f32 v93, v93, v220
    v_mul_f32 v94, v94, v220
    v_mul_f32 v95, v95, v220
    s_nop 1
    v_mfma_f32_32x32x16_bf16 v[80:95], a[72:75], v[208:211], v[80:95]
    ds_read_b128 v[160:163], v30 offset:16384
    v_mul_f32 v96, v96, v220
    v_mul_f32 v97, v97, v220
    ds_read_b128 v[164:167], v30 offset:17408
    ds_write_b128 v26, a[104:107] offset:2048
    buffer_load_dwordx4 a[208:211], v20, s[32:35], s58 offen nt
    v_mul_f32 v98, v98, v220
    v_mul_f32 v99, v99, v220
    ds_read_b128 v[168:171], v30 offset:18432
    v_mul_f32 v100, v100, v220
    v_mfma_f32_32x32x16_bf16 v[80:95], a[76:79], v[212:215], v[80:95]
    v_mul_f32 v101, v101, v220
    ds_read_b128 v[172:175], v30 offset:19456
    v_mul_f32 v102, v102, v220
    ds_write_b128 v26, a[108:111] offset:3072
    v_mul_f32 v103, v103, v220
    v_mul_f32 v104, v104, v220
    v_mul_f32 v105, v105, v220
    v_mul_f32 v106, v106, v220
    v_mul_f32 v107, v107, v220
    v_mul_f32 v108, v108, v220
    v_mul_f32 v109, v109, v220
    v_mul_f32 v110, v110, v220
    v_mul_f32 v111, v111, v220
    s_nop 1
    v_mfma_f32_32x32x16_bf16 v[96:111], a[80:83], v[208:211], v[96:111]
    ds_read_b128 v[176:179], v31 offset:16384
    v_mul_f32 v112, v112, v220
    v_mul_f32 v113, v113, v220
    ds_read_b128 v[180:183], v31 offset:17408
    ds_write_b128 v26, a[112:115] offset:4096
    v_mul_f32 v114, v114, v220
    v_mul_f32 v115, v115, v220
    ds_read_b128 v[184:187], v31 offset:18432
    v_mul_f32 v116, v116, v220
    v_mfma_f32_32x32x16_bf16 v[96:111], a[84:87], v[212:215], v[96:111]
    v_mul_f32 v117, v117, v220
    ds_read_b128 v[188:191], v31 offset:19456
    v_mul_f32 v118, v118, v220
    ds_write_b128 v26, a[116:119] offset:5120
    buffer_load_dwordx4 a[212:215], v21, s[32:35], s58 offen nt
    v_mul_f32 v119, v119, v220
    v_mul_f32 v120, v120, v220
    v_mul_f32 v121, v121, v220
    v_mul_f32 v122, v122, v220
    v_mul_f32 v123, v123, v220
    v_mul_f32 v124, v124, v220
    v_mul_f32 v125, v125, v220
    v_mul_f32 v126, v126, v220
    v_mul_f32 v127, v127, v220
    s_nop 1
    v_mfma_f32_32x32x16_bf16 v[112:127], a[88:91], v[208:211], v[112:127]
    v_add_f32 v192, v192, v200
    v_add_f32 v193, v193, v201
    v_add_f32 v194, v194, v202
    v_add_f32 v195, v195, v203
    ds_write_b128 v26, a[120:123] offset:6144
    v_add_f32 v196, v196, v204
    v_add_f32 v197, v197, v205
    v_add_f32 v198, v198, v206
    v_add_f32 v199, v199, v207
    v_mfma_f32_32x32x16_bf16 v[112:127], a[92:95], v[212:215], v[112:127]
    v_add_f32 v192, v192, v196
    v_add_f32 v193, v193, v197
    v_add_f32 v194, v194, v198
    ds_write_b128 v26, a[124:127] offset:7168
    v_add_f32 v195, v195, v199
    v_add_f32 v192, v192, v193
    v_add_f32 v194, v194, v195
    v_add_f32 v192, v192, v194
    v_add_f32 v217, v217, v192
    ds_read_b128 a[32:35], v32 offset:16384
    ds_read_b128 a[36:39], v33 offset:16384
    ds_read_b128 a[40:43], v34 offset:16384
    ds_read_b128 a[44:47], v35 offset:16384
    ds_read_b128 a[48:51], v36 offset:16384
    ds_read_b128 a[52:55], v37 offset:16384
    ds_read_b128 a[56:59], v38 offset:16384
    ds_read_b128 a[60:63], v39 offset:16384
    s_waitcnt lgkmcnt(8)
    v_add_f32 v144, v144, v128
    v_add_f32 v145, v145, v129
    v_add_f32 v146, v146, v130
    v_add_f32 v147, v147, v131
    buffer_load_dwordx4 a[216:219], v22, s[32:35], s58 offen nt
    v_add_f32 v148, v148, v132
    v_add_f32 v149, v149, v133
    v_add_f32 v150, v150, v134
    v_add_f32 v151, v151, v135
    v_add_f32 v152, v152, v136
    v_add_f32 v153, v153, v137
    v_add_f32 v154, v154, v138
    v_add_f32 v155, v155, v139
    v_add_f32 v156, v156, v140
    v_add_f32 v157, v157, v141
    v_add_f32 v158, v158, v142
    v_add_f32 v159, v159, v143
    s_waitcnt lgkmcnt(0)
    v_mfma_f32_32x32x16_bf16 v[128:143], a[32:35], a[0:3], 0
    ds_read_b64_tr_b16 a[64:65], v40 offset:8192
    ds_read_b64_tr_b16 a[66:67], v41 offset:10240
    v_add_f32 v160, v160, v176
    v_add_f32 v161, v161, v177
    v_add_f32 v162, v162, v178
    v_add_f32 v163, v163, v179
    v_add_f32 v164, v164, v180
    v_mfma_f32_32x32x16_bf16 v[128:143], a[36:39], a[4:7], v[128:143]
    ds_read_b64_tr_b16 a[72:73], v42 offset:8192
    ds_read_b64_tr_b16 a[74:75], v43 offset:10240
    v_add_f32 v165, v165, v181
    v_add_f32 v166, v166, v182
    v_add_f32 v167, v167, v183
    v_add_f32 v168, v168, v184
    v_add_f32 v169, v169, v185
    v_mfma_f32_32x32x16_bf16 v[128:143], a[40:43], a[8:11], v[128:143]
    ds_read_b64_tr_b16 a[80:81], v44 offset:8192
    ds_read_b64_tr_b16 a[82:83], v45 offset:10240
    v_add_f32 v170, v170, v186
    v_add_f32 v171, v171, v187
    v_add_f32 v172, v172, v188
    v_add_f32 v173, v173, v189
    v_add_f32 v174, v174, v190
    v_mfma_f32_32x32x16_bf16 v[128:143], a[44:47], a[12:15], v[128:143]
    ds_read_b64_tr_b16 a[88:89], v46 offset:8192
    ds_read_b64_tr_b16 a[90:91], v47 offset:10240
    v_add_f32 v175, v175, v191
    v_add_f32 v144, v144, v160
    v_add_f32 v145, v145, v161
    v_add_f32 v146, v146, v162
    v_add_f32 v147, v147, v163
    v_mfma_f32_32x32x16_bf16 v[128:143], a[48:51], a[16:19], v[128:143]
    ds_read_b64_tr_b16 a[68:69], v40 offset:12288
    ds_read_b64_tr_b16 a[70:71], v41 offset:14336
    v_add_f32 v148, v148, v164
    v_add_f32 v149, v149, v165
    v_add_f32 v150, v150, v166
    v_add_f32 v151, v151, v167
    v_add_f32 v152, v152, v168
    v_mfma_f32_32x32x16_bf16 v[128:143], a[52:55], a[20:23], v[128:143]
    ds_read_b64_tr_b16 a[76:77], v42 offset:12288
    ds_read_b64_tr_b16 a[78:79], v43 offset:14336
    v_add_f32 v153, v153, v169
    v_add_f32 v154, v154, v170
    v_add_f32 v155, v155, v171
    v_add_f32 v156, v156, v172
    v_add_f32 v157, v157, v173
    v_mfma_f32_32x32x16_bf16 v[128:143], a[56:59], a[24:27], v[128:143]
    ds_read_b64_tr_b16 a[84:85], v44 offset:12288
    ds_read_b64_tr_b16 a[86:87], v45 offset:14336
    v_add_f32 v158, v158, v174
    v_add_f32 v159, v159, v175
    v_max3_f32 v218, v144, v145, v146
    v_max3_f32 v219, v147, v148, v149
    v_max3_f32 v220, v150, v151, v152
    v_mfma_f32_32x32x16_bf16 v[128:143], a[60:63], a[28:31], v[128:143]
    ds_read_b64_tr_b16 a[92:93], v46 offset:12288
    ds_read_b64_tr_b16 a[94:95], v47 offset:14336
    v_max3_f32 v221, v153, v154, v155
    v_max3_f32 v218, v218, v156, v157
    v_max3_f32 v219, v219, v158, v159
    v_max3_f32 v218, v218, v219, v220
    v_max_f32 v218, v218, v221
    v_mov_b32 v219, v218
    s_nop 1
    v_permlane32_swap_b32 v218, v219
    v_max3_f32 v218, v218, v219, v216
    v_sub_f32 v220, v216, v218
    v_mov_b32 v216, v218
    v_exp_f32 v220, v220
    v_sub_f32 v192, v144, v218
    v_sub_f32 v193, v145, v218
    buffer_load_dwordx4 a[220:223], v23, s[32:35], s58 offen nt
    s_add_u32 s58, s58, 16384
    v_sub_f32 v194, v146, v218
    v_sub_f32 v195, v147, v218
    v_sub_f32 v196, v148, v218
    v_sub_f32 v197, v149, v218
    v_sub_f32 v198, v150, v218
    buffer_load_dwordx4 a[224:227], v20, s[32:35], s58 offen nt
    v_sub_f32 v199, v151, v218
    v_sub_f32 v200, v152, v218
    v_sub_f32 v201, v153, v218
    v_sub_f32 v202, v154, v218
    v_sub_f32 v203, v155, v218
    v_sub_f32 v204, v156, v218
    v_sub_f32 v205, v157, v218
    v_sub_f32 v206, v158, v218
    v_sub_f32 v207, v159, v218
    ds_write_b128 v28, v[128:131] offset:0
    v_exp_f32 v192, v192
    v_exp_f32 v193, v193
    v_exp_f32 v194, v194
    v_exp_f32 v195, v195
    ds_write_b128 v28, v[132:135] offset:1024
    v_exp_f32 v196, v196
    v_exp_f32 v197, v197
    v_exp_f32 v198, v198
    v_exp_f32 v199, v199
    ds_write_b128 v28, v[136:139] offset:2048
    v_exp_f32 v200, v200
    v_exp_f32 v201, v201
    v_exp_f32 v202, v202
    v_exp_f32 v203, v203
    ds_write_b128 v28, v[140:143] offset:3072
    v_exp_f32 v204, v204
    v_exp_f32 v205, v205
    v_exp_f32 v206, v206
    v_exp_f32 v207, v207
    v_mul_f32 v217, v217, v220
    v_cvt_pk_bf16_f32 v208, v192, v193
    v_cvt_pk_bf16_f32 v209, v194, v195
    v_cvt_pk_bf16_f32 v210, v196, v197
    v_cvt_pk_bf16_f32 v211, v198, v199
    v_cvt_pk_bf16_f32 v212, v200, v201
    v_cvt_pk_bf16_f32 v213, v202, v203
    v_cvt_pk_bf16_f32 v214, v204, v205
    v_cvt_pk_bf16_f32 v215, v206, v207
    v_mul_f32 v64, v64, v220
    v_mul_f32 v65, v65, v220
    v_mul_f32 v66, v66, v220
    v_mul_f32 v67, v67, v220
    v_mul_f32 v68, v68, v220
    v_mul_f32 v69, v69, v220
    v_mul_f32 v70, v70, v220
    v_mul_f32 v71, v71, v220
    v_mul_f32 v72, v72, v220
    v_mul_f32 v73, v73, v220
    v_mul_f32 v74, v74, v220
    v_mul_f32 v75, v75, v220
    v_mul_f32 v76, v76, v220
    v_mul_f32 v77, v77, v220
    v_mul_f32 v78, v78, v220
    v_mul_f32 v79, v79, v220
    s_waitcnt lgkmcnt(0)
    s_barrier
    v_mfma_f32_32x32x16_bf16 v[64:79], a[64:67], v[208:211], v[64:79]
    ds_read_b128 v[144:147], v29 offset:0
    v_mul_f32 v80, v80, v220
    v_mul_f32 v81, v81, v220
    ds_read_b128 v[148:151], v29 offset:1024
    ds_write_b128 v26, a[128:131] offset:8192
    buffer_load_dwordx4 a[228:231], v21, s[32:35], s58 offen nt
    v_mul_f32 v82, v82, v220
    v_mul_f32 v83, v83, v220
    ds_read_b128 v[152:155], v29 offset:2048
    v_mul_f32 v84, v84, v220
    v_mfma_f32_32x32x16_bf16 v[64:79], a[68:71], v[212:215], v[64:79]
    v_mul_f32 v85, v85, v220
    ds_read_b128 v[156:159], v29 offset:3072
    v_mul_f32 v86, v86, v220
    ds_write_b128 v26, a[132:135] offset:9216
    v_mul_f32 v87, v87, v220
    v_mul_f32 v88, v88, v220
    v_mul_f32 v89, v89, v220
    v_mul_f32 v90, v90, v220
    v_mul_f32 v91, v91, v220
    v_mul_f32 v92, v92, v220
    v_mul_f32 v93, v93, v220
    v_mul_f32 v94, v94, v220
    v_mul_f32 v95, v95, v220
    s_nop 1
    v_mfma_f32_32x32x16_bf16 v[80:95], a[72:75], v[208:211], v[80:95]
    ds_read_b128 v[160:163], v30 offset:0
    v_mul_f32 v96, v96, v220
    v_mul_f32 v97, v97, v220
    ds_read_b128 v[164:167], v30 offset:1024
    ds_write_b128 v26, a[136:139] offset:10240
    buffer_load_dwordx4 a[232:235], v22, s[32:35], s58 offen nt
    v_mul_f32 v98, v98, v220
    v_mul_f32 v99, v99, v220
    ds_read_b128 v[168:171], v30 offset:2048
    v_mul_f32 v100, v100, v220
    v_mfma_f32_32x32x16_bf16 v[80:95], a[76:79], v[212:215], v[80:95]
    v_mul_f32 v101, v101, v220
    ds_read_b128 v[172:175], v30 offset:3072
    v_mul_f32 v102, v102, v220
    ds_write_b128 v26, a[140:143] offset:11264
    v_mul_f32 v103, v103, v220
    v_mul_f32 v104, v104, v220
    v_mul_f32 v105, v105, v220
    v_mul_f32 v106, v106, v220
    v_mul_f32 v107, v107, v220
    v_mul_f32 v108, v108, v220
    v_mul_f32 v109, v109, v220
    v_mul_f32 v110, v110, v220
    v_mul_f32 v111, v111, v220
    s_nop 1
    v_mfma_f32_32x32x16_bf16 v[96:111], a[80:83], v[208:211], v[96:111]
    ds_read_b128 v[176:179], v31 offset:0
    v_mul_f32 v112, v112, v220
    v_mul_f32 v113, v113, v220
    ds_read_b128 v[180:183], v31 offset:1024
    ds_write_b128 v26, a[144:147] offset:12288
    v_mul_f32 v114, v114, v220
    v_mul_f32 v115, v115, v220
    ds_read_b128 v[184:187], v31 offset:2048
    v_mul_f32 v116, v116, v220
    v_mfma_f32_32x32x16_bf16 v[96:111], a[84:87], v[212:215], v[96:111]
    v_mul_f32 v117, v117, v220
    ds_read_b128 v[188:191], v31 offset:3072
    v_mul_f32 v118, v118, v220
    ds_write_b128 v26, a[148:151] offset:13312
    buffer_load_dwordx4 a[236:239], v23, s[32:35], s58 offen nt
    s_add_u32 s58, s58, 16384
    v_mul_f32 v119, v119, v220
    v_mul_f32 v120, v120, v220
    v_mul_f32 v121, v121, v220
    v_mul_f32 v122, v122, v220
    v_mul_f32 v123, v123, v220
    v_mul_f32 v124, v124, v220
    v_mul_f32 v125, v125, v220
    v_mul_f32 v126, v126, v220
    v_mul_f32 v127, v127, v220
    s_nop 1
    v_mfma_f32_32x32x16_bf16 v[112:127], a[88:91], v[208:211], v[112:127]
    v_add_f32 v192, v192, v200
    v_add_f32 v193, v193, v201
    v_add_f32 v194, v194, v202
    v_add_f32 v195, v195, v203
    ds_write_b128 v26, a[152:155] offset:14336
    v_add_f32 v196, v196, v204
    v_add_f32 v197, v197, v205
    v_add_f32 v198, v198, v206
    v_add_f32 v199, v199, v207
    v_mfma_f32_32x32x16_bf16 v[112:127], a[92:95], v[212:215], v[112:127]
    v_add_f32 v192, v192, v196
    v_add_f32 v193, v193, v197
    v_add_f32 v194, v194, v198
    ds_write_b128 v26, a[156:159] offset:15360
    v_add_f32 v195, v195, v199
    v_add_f32 v192, v192, v193
    v_add_f32 v194, v194, v195
    v_add_f32 v192, v192, v194
    v_add_f32 v217, v217, v192
    ds_read_b128 a[32:35], v32 offset:24576
    ds_read_b128 a[36:39], v33 offset:24576
    ds_read_b128 a[40:43], v34 offset:24576
    ds_read_b128 a[44:47], v35 offset:24576
    ds_read_b128 a[48:51], v36 offset:24576
    ds_read_b128 a[52:55], v37 offset:24576
    ds_read_b128 a[56:59], v38 offset:24576
    ds_read_b128 a[60:63], v39 offset:24576
    s_waitcnt lgkmcnt(8)
    v_add_f32 v144, v144, v128
    v_add_f32 v145, v145, v129
    v_add_f32 v146, v146, v130
    v_add_f32 v147, v147, v131
    buffer_load_dwordx4 a[240:243], v20, s[32:35], s58 offen nt
    v_add_f32 v148, v148, v132
    v_add_f32 v149, v149, v133
    v_add_f32 v150, v150, v134
    v_add_f32 v151, v151, v135
    v_add_f32 v152, v152, v136
    v_add_f32 v153, v153, v137
    v_add_f32 v154, v154, v138
    v_add_f32 v155, v155, v139
    v_add_f32 v156, v156, v140
    v_add_f32 v157, v157, v141
    v_add_f32 v158, v158, v142
    v_add_f32 v159, v159, v143
    s_waitcnt lgkmcnt(0)
    v_mfma_f32_32x32x16_bf16 v[128:143], a[32:35], a[0:3], 0
    ds_read_b64_tr_b16 a[64:65], v40 offset:16384
    ds_read_b64_tr_b16 a[66:67], v41 offset:18432
    v_add_f32 v160, v160, v176
    v_add_f32 v161, v161, v177
    v_add_f32 v162, v162, v178
    v_add_f32 v163, v163, v179
    v_add_f32 v164, v164, v180
    v_mfma_f32_32x32x16_bf16 v[128:143], a[36:39], a[4:7], v[128:143]
    ds_read_b64_tr_b16 a[72:73], v42 offset:16384
    ds_read_b64_tr_b16 a[74:75], v43 offset:18432
    v_add_f32 v165, v165, v181
    v_add_f32 v166, v166, v182
    v_add_f32 v167, v167, v183
    v_add_f32 v168, v168, v184
    v_add_f32 v169, v169, v185
    v_mfma_f32_32x32x16_bf16 v[128:143], a[40:43], a[8:11], v[128:143]
    ds_read_b64_tr_b16 a[80:81], v44 offset:16384
    ds_read_b64_tr_b16 a[82:83], v45 offset:18432
    v_add_f32 v170, v170, v186
    v_add_f32 v171, v171, v187
    v_add_f32 v172, v172, v188
    v_add_f32 v173, v173, v189
    v_add_f32 v174, v174, v190
    v_mfma_f32_32x32x16_bf16 v[128:143], a[44:47], a[12:15], v[128:143]
    ds_read_b64_tr_b16 a[88:89], v46 offset:16384
    ds_read_b64_tr_b16 a[90:91], v47 offset:18432
    v_add_f32 v175, v175, v191
    v_add_f32 v144, v144, v160
    v_add_f32 v145, v145, v161
    v_add_f32 v146, v146, v162
    v_add_f32 v147, v147, v163
    v_mfma_f32_32x32x16_bf16 v[128:143], a[48:51], a[16:19], v[128:143]
    ds_read_b64_tr_b16 a[68:69], v40 offset:20480
    ds_read_b64_tr_b16 a[70:71], v41 offset:22528
    v_add_f32 v148, v148, v164
    v_add_f32 v149, v149, v165
    v_add_f32 v150, v150, v166
    v_add_f32 v151, v151, v167
    v_add_f32 v152, v152, v168
    v_mfma_f32_32x32x16_bf16 v[128:143], a[52:55], a[20:23], v[128:143]
    ds_read_b64_tr_b16 a[76:77], v42 offset:20480
    ds_read_b64_tr_b16 a[78:79], v43 offset:22528
    v_add_f32 v153, v153, v169
    v_add_f32 v154, v154, v170
    v_add_f32 v155, v155, v171
    v_add_f32 v156, v156, v172
    v_add_f32 v157, v157, v173
    v_mfma_f32_32x32x16_bf16 v[128:143], a[56:59], a[24:27], v[128:143]
    ds_read_b64_tr_b16 a[84:85], v44 offset:20480
    ds_read_b64_tr_b16 a[86:87], v45 offset:22528
    v_add_f32 v158, v158, v174
    v_add_f32 v159, v159, v175
    v_max3_f32 v218, v144, v145, v146
    v_max3_f32 v219, v147, v148, v149
    v_max3_f32 v220, v150, v151, v152
    v_mfma_f32_32x32x16_bf16 v[128:143], a[60:63], a[28:31], v[128:143]
    ds_read_b64_tr_b16 a[92:93], v46 offset:20480
    ds_read_b64_tr_b16 a[94:95], v47 offset:22528
    v_max3_f32 v221, v153, v154, v155
    v_max3_f32 v218, v218, v156, v157
    v_max3_f32 v219, v219, v158, v159
    v_max3_f32 v218, v218, v219, v220
    v_max_f32 v218, v218, v221
    v_mov_b32 v219, v218
    s_nop 1
    v_permlane32_swap_b32 v218, v219
    v_max3_f32 v218, v218, v219, v216
    v_sub_f32 v220, v216, v218
    v_mov_b32 v216, v218
    v_exp_f32 v220, v220
    v_sub_f32 v192, v144, v218
    v_sub_f32 v193, v145, v218
    buffer_load_dwordx4 a[244:247], v21, s[32:35], s58 offen nt
    v_sub_f32 v194, v146, v218
    v_sub_f32 v195, v147, v218
    v_sub_f32 v196, v148, v218
    v_sub_f32 v197, v149, v218
    v_sub_f32 v198, v150, v218
    buffer_load_dwordx4 a[248:251], v22, s[32:35], s58 offen nt
    v_sub_f32 v199, v151, v218
    v_sub_f32 v200, v152, v218
    v_sub_f32 v201, v153, v218
    v_sub_f32 v202, v154, v218
    v_sub_f32 v203, v155, v218
    v_sub_f32 v204, v156, v218
    v_sub_f32 v205, v157, v218
    v_sub_f32 v206, v158, v218
    v_sub_f32 v207, v159, v218
    ds_write_b128 v28, v[128:131] offset:16384
    v_exp_f32 v192, v192
    v_exp_f32 v193, v193
    v_exp_f32 v194, v194
    v_exp_f32 v195, v195
    ds_write_b128 v28, v[132:135] offset:17408
    v_exp_f32 v196, v196
    v_exp_f32 v197, v197
    v_exp_f32 v198, v198
    v_exp_f32 v199, v199
    ds_write_b128 v28, v[136:139] offset:18432
    v_exp_f32 v200, v200
    v_exp_f32 v201, v201
    v_exp_f32 v202, v202
    v_exp_f32 v203, v203
    ds_write_b128 v28, v[140:143] offset:19456
    v_exp_f32 v204, v204
    v_exp_f32 v205, v205
    v_exp_f32 v206, v206
    v_exp_f32 v207, v207
    v_mul_f32 v217, v217, v220
    v_cvt_pk_bf16_f32 v208, v192, v193
    v_cvt_pk_bf16_f32 v209, v194, v195
    v_cvt_pk_bf16_f32 v210, v196, v197
    v_cvt_pk_bf16_f32 v211, v198, v199
    v_cvt_pk_bf16_f32 v212, v200, v201
    v_cvt_pk_bf16_f32 v213, v202, v203
    v_cvt_pk_bf16_f32 v214, v204, v205
    v_cvt_pk_bf16_f32 v215, v206, v207
    v_mul_f32 v64, v64, v220
    v_mul_f32 v65, v65, v220
    v_mul_f32 v66, v66, v220
    v_mul_f32 v67, v67, v220
    v_mul_f32 v68, v68, v220
    v_mul_f32 v69, v69, v220
    v_mul_f32 v70, v70, v220
    v_mul_f32 v71, v71, v220
    v_mul_f32 v72, v72, v220
    v_mul_f32 v73, v73, v220
    v_mul_f32 v74, v74, v220
    v_mul_f32 v75, v75, v220
    v_mul_f32 v76, v76, v220
    v_mul_f32 v77, v77, v220
    v_mul_f32 v78, v78, v220
    v_mul_f32 v79, v79, v220
    s_waitcnt lgkmcnt(0)
    s_barrier
    v_mfma_f32_32x32x16_bf16 v[64:79], a[64:67], v[208:211], v[64:79]
    ds_read_b128 v[144:147], v29 offset:16384
    v_mul_f32 v80, v80, v220
    v_mul_f32 v81, v81, v220
    ds_read_b128 v[148:151], v29 offset:17408
    s_waitcnt vmcnt(22)
    ds_write_b128 v26, a[160:163] offset:16384
    buffer_load_dwordx4 a[252:255], v23, s[32:35], s58 offen nt
    s_add_u32 s58, s58, 16384
    v_mul_f32 v82, v82, v220
    v_mul_f32 v83, v83, v220
    ds_read_b128 v[152:155], v29 offset:18432
    v_mul_f32 v84, v84, v220
    v_mfma_f32_32x32x16_bf16 v[64:79], a[68:71], v[212:215], v[64:79]
    v_mul_f32 v85, v85, v220
    ds_read_b128 v[156:159], v29 offset:19456
    v_mul_f32 v86, v86, v220
    s_waitcnt vmcnt(22)
    ds_write_b128 v26, a[164:167] offset:17408
    v_mul_f32 v87, v87, v220
    v_mul_f32 v88, v88, v220
    v_mul_f32 v89, v89, v220
    v_mul_f32 v90, v90, v220
    v_mul_f32 v91, v91, v220
    v_mul_f32 v92, v92, v220
    v_mul_f32 v93, v93, v220
    v_mul_f32 v94, v94, v220
    v_mul_f32 v95, v95, v220
    s_nop 1
    v_mfma_f32_32x32x16_bf16 v[80:95], a[72:75], v[208:211], v[80:95]
    ds_read_b128 v[160:163], v30 offset:16384
    v_mul_f32 v96, v96, v220
    v_mul_f32 v97, v97, v220
    ds_read_b128 v[164:167], v30 offset:17408
    s_waitcnt vmcnt(21)
    ds_write_b128 v26, a[168:171] offset:18432
    buffer_load_dwordx4 v[224:227], v20, s[32:35], s58 offen nt
    v_mul_f32 v98, v98, v220
    v_mul_f32 v99, v99, v220
    ds_read_b128 v[168:171], v30 offset:18432
    v_mul_f32 v100, v100, v220
    v_mfma_f32_32x32x16_bf16 v[80:95], a[76:79], v[212:215], v[80:95]
    v_mul_f32 v101, v101, v220
    ds_read_b128 v[172:175], v30 offset:19456
    v_mul_f32 v102, v102, v220
    s_waitcnt vmcnt(21)
    ds_write_b128 v26, a[172:175] offset:19456
    v_mul_f32 v103, v103, v220
    v_mul_f32 v104, v104, v220
    v_mul_f32 v105, v105, v220
    v_mul_f32 v106, v106, v220
    v_mul_f32 v107, v107, v220
    v_mul_f32 v108, v108, v220
    v_mul_f32 v109, v109, v220
    v_mul_f32 v110, v110, v220
    v_mul_f32 v111, v111, v220
    s_nop 1
    v_mfma_f32_32x32x16_bf16 v[96:111], a[80:83], v[208:211], v[96:111]
    ds_read_b128 v[176:179], v31 offset:16384
    v_mul_f32 v112, v112, v220
    v_mul_f32 v113, v113, v220
    ds_read_b128 v[180:183], v31 offset:17408
    s_waitcnt vmcnt(20)
    ds_write_b128 v26, a[176:179] offset:20480
    v_mul_f32 v114, v114, v220
    v_mul_f32 v115, v115, v220
    ds_read_b128 v[184:187], v31 offset:18432
    v_mul_f32 v116, v116, v220
    v_mfma_f32_32x32x16_bf16 v[96:111], a[84:87], v[212:215], v[96:111]
    v_mul_f32 v117, v117, v220
    ds_read_b128 v[188:191], v31 offset:19456
    v_mul_f32 v118, v118, v220
    s_waitcnt vmcnt(19)
    ds_write_b128 v26, a[180:183] offset:21504
    buffer_load_dwordx4 v[228:231], v21, s[32:35], s58 offen nt
    v_mul_f32 v119, v119, v220
    v_mul_f32 v120, v120, v220
    v_mul_f32 v121, v121, v220
    v_mul_f32 v122, v122, v220
    v_mul_f32 v123, v123, v220
    v_mul_f32 v124, v124, v220
    v_mul_f32 v125, v125, v220
    v_mul_f32 v126, v126, v220
    v_mul_f32 v127, v127, v220
    s_nop 1
    v_mfma_f32_32x32x16_bf16 v[112:127], a[88:91], v[208:211], v[112:127]
    v_add_f32 v192, v192, v200
    v_add_f32 v193, v193, v201
    v_add_f32 v194, v194, v202
    v_add_f32 v195, v195, v203
    s_waitcnt vmcnt(19)
    ds_write_b128 v26, a[184:187] offset:22528
    v_add_f32 v196, v196, v204
    v_add_f32 v197, v197, v205
    v_add_f32 v198, v198, v206
    v_add_f32 v199, v199, v207
    v_mfma_f32_32x32x16_bf16 v[112:127], a[92:95], v[212:215], v[112:127]
    v_add_f32 v192, v192, v196
    v_add_f32 v193, v193, v197
    v_add_f32 v194, v194, v198
    s_waitcnt vmcnt(18)
    ds_write_b128 v26, a[188:191] offset:23552
    v_add_f32 v195, v195, v199
    v_add_f32 v192, v192, v193
    v_add_f32 v194, v194, v195
    v_add_f32 v192, v192, v194
    v_add_f32 v217, v217, v192
    ds_read_b128 a[32:35], v32 offset:0
    ds_read_b128 a[36:39], v33 offset:0
    ds_read_b128 a[40:43], v34 offset:0
    ds_read_b128 a[44:47], v35 offset:0
    ds_read_b128 a[48:51], v36 offset:0
    ds_read_b128 a[52:55], v37 offset:0
    ds_read_b128 a[56:59], v38 offset:0
    ds_read_b128 a[60:63], v39 offset:0
    s_waitcnt lgkmcnt(8)
    v_add_f32 v144, v144, v128
    v_add_f32 v145, v145, v129
    v_add_f32 v146, v146, v130
    v_add_f32 v147, v147, v131
    buffer_load_dwordx4 v[232:235], v22, s[32:35], s58 offen nt
    v_add_f32 v148, v148, v132
    v_add_f32 v149, v149, v133
    v_add_f32 v150, v150, v134
    v_add_f32 v151, v151, v135
    v_add_f32 v152, v152, v136
    v_add_f32 v153, v153, v137
    v_add_f32 v154, v154, v138
    v_add_f32 v155, v155, v139
    v_add_f32 v156, v156, v140
    v_add_f32 v157, v157, v141
    v_add_f32 v158, v158, v142
    v_add_f32 v159, v159, v143
    s_waitcnt lgkmcnt(0)
    v_mfma_f32_32x32x16_bf16 v[128:143], a[32:35], a[0:3], 0
    ds_read_b64_tr_b16 a[64:65], v40 offset:24576
    ds_read_b64_tr_b16 a[66:67], v41 offset:26624
    v_add_f32 v160, v160, v176
    v_add_f32 v161, v161, v177
    v_add_f32 v162, v162, v178
    v_add_f32 v163, v163, v179
    v_add_f32 v164, v164, v180
    v_mfma_f32_32x32x16_bf16 v[128:143], a[36:39], a[4:7], v[128:143]
    ds_read_b64_tr_b16 a[72:73], v42 offset:24576
    ds_read_b64_tr_b16 a[74:75], v43 offset:26624
    v_add_f32 v165, v165, v181
    v_add_f32 v166, v166, v182
    v_add_f32 v167, v167, v183
    v_add_f32 v168, v168, v184
    v_add_f32 v169, v169, v185
    v_mfma_f32_32x32x16_bf16 v[128:143], a[40:43], a[8:11], v[128:143]
    ds_read_b64_tr_b16 a[80:81], v44 offset:24576
    ds_read_b64_tr_b16 a[82:83], v45 offset:26624
    v_add_f32 v170, v170, v186
    v_add_f32 v171, v171, v187
    v_add_f32 v172, v172, v188
    v_add_f32 v173, v173, v189
    v_add_f32 v174, v174, v190
    v_mfma_f32_32x32x16_bf16 v[128:143], a[44:47], a[12:15], v[128:143]
    ds_read_b64_tr_b16 a[88:89], v46 offset:24576
    ds_read_b64_tr_b16 a[90:91], v47 offset:26624
    v_add_f32 v175, v175, v191
    v_add_f32 v144, v144, v160
    v_add_f32 v145, v145, v161
    v_add_f32 v146, v146, v162
    v_add_f32 v147, v147, v163
    v_mfma_f32_32x32x16_bf16 v[128:143], a[48:51], a[16:19], v[128:143]
    ds_read_b64_tr_b16 a[68:69], v40 offset:28672
    ds_read_b64_tr_b16 a[70:71], v41 offset:30720
    v_add_f32 v148, v148, v164
    v_add_f32 v149, v149, v165
    v_add_f32 v150, v150, v166
    v_add_f32 v151, v151, v167
    v_add_f32 v152, v152, v168
    v_mfma_f32_32x32x16_bf16 v[128:143], a[52:55], a[20:23], v[128:143]
    ds_read_b64_tr_b16 a[76:77], v42 offset:28672
    ds_read_b64_tr_b16 a[78:79], v43 offset:30720
    v_add_f32 v153, v153, v169
    v_add_f32 v154, v154, v170
    v_add_f32 v155, v155, v171
    v_add_f32 v156, v156, v172
    v_add_f32 v157, v157, v173
    v_mfma_f32_32x32x16_bf16 v[128:143], a[56:59], a[24:27], v[128:143]
    ds_read_b64_tr_b16 a[84:85], v44 offset:28672
    ds_read_b64_tr_b16 a[86:87], v45 offset:30720
    v_add_f32 v158, v158, v174
    v_add_f32 v159, v159, v175
    v_max3_f32 v218, v144, v145, v146
    v_max3_f32 v219, v147, v148, v149
    v_max3_f32 v220, v150, v151, v152
    v_mfma_f32_32x32x16_bf16 v[128:143], a[60:63], a[28:31], v[128:143]
    ds_read_b64_tr_b16 a[92:93], v46 offset:28672
    ds_read_b64_tr_b16 a[94:95], v47 offset:30720
    v_max3_f32 v221, v153, v154, v155
    v_max3_f32 v218, v218, v156, v157
    v_max3_f32 v219, v219, v158, v159
    v_max3_f32 v218, v218, v219, v220
    v_max_f32 v218, v218, v221
    v_mov_b32 v219, v218
    s_nop 1
    v_permlane32_swap_b32 v218, v219
    v_max3_f32 v218, v218, v219, v216
    v_sub_f32 v220, v216, v218
    v_mov_b32 v216, v218
    v_exp_f32 v220, v220
    v_sub_f32 v192, v144, v218
    v_sub_f32 v193, v145, v218
    buffer_load_dwordx4 v[236:239], v23, s[32:35], s58 offen nt
    s_add_u32 s58, s58, 16384
    v_sub_f32 v194, v146, v218
    v_sub_f32 v195, v147, v218
    v_sub_f32 v196, v148, v218
    v_sub_f32 v197, v149, v218
    v_sub_f32 v198, v150, v218
    buffer_load_dwordx4 v[240:243], v20, s[32:35], s58 offen nt
    v_sub_f32 v199, v151, v218
    v_sub_f32 v200, v152, v218
    v_sub_f32 v201, v153, v218
    v_sub_f32 v202, v154, v218
    v_sub_f32 v203, v155, v218
    v_sub_f32 v204, v156, v218
    v_sub_f32 v205, v157, v218
    v_sub_f32 v206, v158, v218
    v_sub_f32 v207, v159, v218
    ds_write_b128 v28, v[128:131] offset:0
    v_exp_f32 v192, v192
    v_exp_f32 v193, v193
    v_exp_f32 v194, v194
    v_exp_f32 v195, v195
    ds_write_b128 v28, v[132:135] offset:1024
    v_exp_f32 v196, v196
    v_exp_f32 v197, v197
    v_exp_f32 v198, v198
    v_exp_f32 v199, v199
    ds_write_b128 v28, v[136:139] offset:2048
    v_exp_f32 v200, v200
    v_exp_f32 v201, v201
    v_exp_f32 v202, v202
    v_exp_f32 v203, v203
    ds_write_b128 v28, v[140:143] offset:3072
    v_exp_f32 v204, v204
    v_exp_f32 v205, v205
    v_exp_f32 v206, v206
    v_exp_f32 v207, v207
    v_mul_f32 v217, v217, v220
    v_cvt_pk_bf16_f32 v208, v192, v193
    v_cvt_pk_bf16_f32 v209, v194, v195
    v_cvt_pk_bf16_f32 v210, v196, v197
    v_cvt_pk_bf16_f32 v211, v198, v199
    v_cvt_pk_bf16_f32 v212, v200, v201
    v_cvt_pk_bf16_f32 v213, v202, v203
    v_cvt_pk_bf16_f32 v214, v204, v205
    v_cvt_pk_bf16_f32 v215, v206, v207
    v_mul_f32 v64, v64, v220
    v_mul_f32 v65, v65, v220
    v_mul_f32 v66, v66, v220
    v_mul_f32 v67, v67, v220
    v_mul_f32 v68, v68, v220
    v_mul_f32 v69, v69, v220
    v_mul_f32 v70, v70, v220
    v_mul_f32 v71, v71, v220
    v_mul_f32 v72, v72, v220
    v_mul_f32 v73, v73, v220
    v_mul_f32 v74, v74, v220
    v_mul_f32 v75, v75, v220
    v_mul_f32 v76, v76, v220
    v_mul_f32 v77, v77, v220
    v_mul_f32 v78, v78, v220
    v_mul_f32 v79, v79, v220
    s_waitcnt lgkmcnt(0)
    s_barrier
    v_mfma_f32_32x32x16_bf16 v[64:79], a[64:67], v[208:211], v[64:79]
    ds_read_b128 v[144:147], v29 offset:0
    v_mul_f32 v80, v80, v220
    v_mul_f32 v81, v81, v220
    ds_read_b128 v[148:151], v29 offset:1024
    buffer_load_dwordx4 v[244:247], v21, s[32:35], s58 offen nt
    v_mul_f32 v82, v82, v220
    v_mul_f32 v83, v83, v220
    ds_read_b128 v[152:155], v29 offset:2048
    v_mul_f32 v84, v84, v220
    v_mfma_f32_32x32x16_bf16 v[64:79], a[68:71], v[212:215], v[64:79]
    v_mul_f32 v85, v85, v220
    ds_read_b128 v[156:159], v29 offset:3072
    v_mul_f32 v86, v86, v220
    v_mul_f32 v87, v87, v220
    v_mul_f32 v88, v88, v220
    v_mul_f32 v89, v89, v220
    v_mul_f32 v90, v90, v220
    v_mul_f32 v91, v91, v220
    v_mul_f32 v92, v92, v220
    v_mul_f32 v93, v93, v220
    v_mul_f32 v94, v94, v220
    v_mul_f32 v95, v95, v220
    s_nop 1
    v_mfma_f32_32x32x16_bf16 v[80:95], a[72:75], v[208:211], v[80:95]
    ds_read_b128 v[160:163], v30 offset:0
    v_mul_f32 v96, v96, v220
    v_mul_f32 v97, v97, v220
    ds_read_b128 v[164:167], v30 offset:1024
    buffer_load_dwordx4 v[248:251], v22, s[32:35], s58 offen nt
    v_mul_f32 v98, v98, v220
    v_mul_f32 v99, v99, v220
    ds_read_b128 v[168:171], v30 offset:2048
    v_mul_f32 v100, v100, v220
    v_mfma_f32_32x32x16_bf16 v[80:95], a[76:79], v[212:215], v[80:95]
    v_mul_f32 v101, v101, v220
    ds_read_b128 v[172:175], v30 offset:3072
    v_mul_f32 v102, v102, v220
    v_mul_f32 v103, v103, v220
    v_mul_f32 v104, v104, v220
    v_mul_f32 v105, v105, v220
    v_mul_f32 v106, v106, v220
    v_mul_f32 v107, v107, v220
    v_mul_f32 v108, v108, v220
    v_mul_f32 v109, v109, v220
    v_mul_f32 v110, v110, v220
    v_mul_f32 v111, v111, v220
    s_nop 1
    v_mfma_f32_32x32x16_bf16 v[96:111], a[80:83], v[208:211], v[96:111]
    ds_read_b128 v[176:179], v31 offset:0
    v_mul_f32 v112, v112, v220
    v_mul_f32 v113, v113, v220
    ds_read_b128 v[180:183], v31 offset:1024
    v_mul_f32 v114, v114, v220
    v_mul_f32 v115, v115, v220
    ds_read_b128 v[184:187], v31 offset:2048
    v_mul_f32 v116, v116, v220
    v_mfma_f32_32x32x16_bf16 v[96:111], a[84:87], v[212:215], v[96:111]
    v_mul_f32 v117, v117, v220
    ds_read_b128 v[188:191], v31 offset:3072
    v_mul_f32 v118, v118, v220
    buffer_load_dwordx4 v[252:255], v23, s[32:35], s58 offen nt
    s_add_u32 s58, s58, 16384
    v_mul_f32 v119, v119, v220
    v_mul_f32 v120, v120, v220
    v_mul_f32 v121, v121, v220
    v_mul_f32 v122, v122, v220
    v_mul_f32 v123, v123, v220
    v_mul_f32 v124, v124, v220
    v_mul_f32 v125, v125, v220
    v_mul_f32 v126, v126, v220
    v_mul_f32 v127, v127, v220
    s_nop 1
    v_mfma_f32_32x32x16_bf16 v[112:127], a[88:91], v[208:211], v[112:127]
    v_add_f32 v192, v192, v200
    v_add_f32 v193, v193, v201
    v_add_f32 v194, v194, v202
    v_add_f32 v195, v195, v203
    v_add_f32 v196, v196, v204
    v_add_f32 v197, v197, v205
    v_add_f32 v198, v198, v206
    v_add_f32 v199, v199, v207
    v_mfma_f32_32x32x16_bf16 v[112:127], a[92:95], v[212:215], v[112:127]
    v_add_f32 v192, v192, v196
    v_add_f32 v193, v193, v197
    v_add_f32 v194, v194, v198
    v_add_f32 v195, v195, v199
    v_add_f32 v192, v192, v193
    v_add_f32 v194, v194, v195
    v_add_f32 v192, v192, v194
    v_add_f32 v217, v217, v192
    ds_read_b128 a[32:35], v32 offset:8192
    ds_read_b128 a[36:39], v33 offset:8192
    ds_read_b128 a[40:43], v34 offset:8192
    ds_read_b128 a[44:47], v35 offset:8192
    ds_read_b128 a[48:51], v36 offset:8192
    ds_read_b128 a[52:55], v37 offset:8192
    ds_read_b128 a[56:59], v38 offset:8192
    ds_read_b128 a[60:63], v39 offset:8192
    s_waitcnt lgkmcnt(8)
    v_add_f32 v144, v144, v128
    v_add_f32 v145, v145, v129
    v_add_f32 v146, v146, v130
    v_add_f32 v147, v147, v131
    buffer_load_dwordx4 a[96:99], v20, s[32:35], s58 offen nt
    v_add_f32 v148, v148, v132
    v_add_f32 v149, v149, v133
    v_add_f32 v150, v150, v134
    v_add_f32 v151, v151, v135
    v_add_f32 v152, v152, v136
    v_add_f32 v153, v153, v137
    v_add_f32 v154, v154, v138
    v_add_f32 v155, v155, v139
    v_add_f32 v156, v156, v140
    v_add_f32 v157, v157, v141
    v_add_f32 v158, v158, v142
    v_add_f32 v159, v159, v143
    s_waitcnt lgkmcnt(0)
    v_mfma_f32_32x32x16_bf16 v[128:143], a[32:35], a[0:3], 0
    ds_read_b64_tr_b16 a[64:65], v40 offset:0
    ds_read_b64_tr_b16 a[66:67], v41 offset:2048
    v_add_f32 v160, v160, v176
    v_add_f32 v161, v161, v177
    v_add_f32 v162, v162, v178
    v_add_f32 v163, v163, v179
    v_add_f32 v164, v164, v180
    v_mfma_f32_32x32x16_bf16 v[128:143], a[36:39], a[4:7], v[128:143]
    ds_read_b64_tr_b16 a[72:73], v42 offset:0
    ds_read_b64_tr_b16 a[74:75], v43 offset:2048
    v_add_f32 v165, v165, v181
    v_add_f32 v166, v166, v182
    v_add_f32 v167, v167, v183
    v_add_f32 v168, v168, v184
    v_add_f32 v169, v169, v185
    v_mfma_f32_32x32x16_bf16 v[128:143], a[40:43], a[8:11], v[128:143]
    ds_read_b64_tr_b16 a[80:81], v44 offset:0
    ds_read_b64_tr_b16 a[82:83], v45 offset:2048
    v_add_f32 v170, v170, v186
    v_add_f32 v171, v171, v187
    v_add_f32 v172, v172, v188
    v_add_f32 v173, v173, v189
    v_add_f32 v174, v174, v190
    v_mfma_f32_32x32x16_bf16 v[128:143], a[44:47], a[12:15], v[128:143]
    ds_read_b64_tr_b16 a[88:89], v46 offset:0
    ds_read_b64_tr_b16 a[90:91], v47 offset:2048
    v_add_f32 v175, v175, v191
    v_add_f32 v144, v144, v160
    v_add_f32 v145, v145, v161
    v_add_f32 v146, v146, v162
    v_add_f32 v147, v147, v163
    v_mfma_f32_32x32x16_bf16 v[128:143], a[48:51], a[16:19], v[128:143]
    ds_read_b64_tr_b16 a[68:69], v40 offset:4096
    ds_read_b64_tr_b16 a[70:71], v41 offset:6144
    v_add_f32 v148, v148, v164
    v_add_f32 v149, v149, v165
    v_add_f32 v150, v150, v166
    v_add_f32 v151, v151, v167
    v_add_f32 v152, v152, v168
    v_mfma_f32_32x32x16_bf16 v[128:143], a[52:55], a[20:23], v[128:143]
    ds_read_b64_tr_b16 a[76:77], v42 offset:4096
    ds_read_b64_tr_b16 a[78:79], v43 offset:6144
    v_add_f32 v153, v153, v169
    v_add_f32 v154, v154, v170
    v_add_f32 v155, v155, v171
    v_add_f32 v156, v156, v172
    v_add_f32 v157, v157, v173
    v_mfma_f32_32x32x16_bf16 v[128:143], a[56:59], a[24:27], v[128:143]
    ds_read_b64_tr_b16 a[84:85], v44 offset:4096
    ds_read_b64_tr_b16 a[86:87], v45 offset:6144
    v_add_f32 v158, v158, v174
    v_add_f32 v159, v159, v175
    v_max3_f32 v218, v144, v145, v146
    v_max3_f32 v219, v147, v148, v149
    v_max3_f32 v220, v150, v151, v152
    v_mfma_f32_32x32x16_bf16 v[128:143], a[60:63], a[28:31], v[128:143]
    ds_read_b64_tr_b16 a[92:93], v46 offset:4096
    ds_read_b64_tr_b16 a[94:95], v47 offset:6144
    v_max3_f32 v221, v153, v154, v155
    v_max3_f32 v218, v218, v156, v157
    v_max3_f32 v219, v219, v158, v159
    v_max3_f32 v218, v218, v219, v220
    v_max_f32 v218, v218, v221
    v_mov_b32 v219, v218
    s_nop 1
    v_permlane32_swap_b32 v218, v219
    v_max3_f32 v218, v218, v219, v216
    v_sub_f32 v220, v216, v218
    v_mov_b32 v216, v218
    v_exp_f32 v220, v220
    v_sub_f32 v192, v144, v218
    v_sub_f32 v193, v145, v218
    buffer_load_dwordx4 a[100:103], v21, s[32:35], s58 offen nt
    v_sub_f32 v194, v146, v218
    v_sub_f32 v195, v147, v218
    v_sub_f32 v196, v148, v218
    v_sub_f32 v197, v149, v218
    v_sub_f32 v198, v150, v218
    buffer_load_dwordx4 a[104:107], v22, s[32:35], s58 offen nt
    v_sub_f32 v199, v151, v218
    v_sub_f32 v200, v152, v218
    v_sub_f32 v201, v153, v218
    v_sub_f32 v202, v154, v218
    v_sub_f32 v203, v155, v218
    v_sub_f32 v204, v156, v218
    v_sub_f32 v205, v157, v218
    v_sub_f32 v206, v158, v218
    v_sub_f32 v207, v159, v218
    ds_write_b128 v28, v[128:131] offset:16384
    v_exp_f32 v192, v192
    v_exp_f32 v193, v193
    v_exp_f32 v194, v194
    v_exp_f32 v195, v195
    ds_write_b128 v28, v[132:135] offset:17408
    v_exp_f32 v196, v196
    v_exp_f32 v197, v197
    v_exp_f32 v198, v198
    v_exp_f32 v199, v199
    ds_write_b128 v28, v[136:139] offset:18432
    v_exp_f32 v200, v200
    v_exp_f32 v201, v201
    v_exp_f32 v202, v202
    v_exp_f32 v203, v203
    ds_write_b128 v28, v[140:143] offset:19456
    v_exp_f32 v204, v204
    v_exp_f32 v205, v205
    v_exp_f32 v206, v206
    v_exp_f32 v207, v207
    v_mul_f32 v217, v217, v220
    v_cvt_pk_bf16_f32 v208, v192, v193
    v_cvt_pk_bf16_f32 v209, v194, v195
    v_cvt_pk_bf16_f32 v210, v196, v197
    v_cvt_pk_bf16_f32 v211, v198, v199
    v_cvt_pk_bf16_f32 v212, v200, v201
    v_cvt_pk_bf16_f32 v213, v202, v203
    v_cvt_pk_bf16_f32 v214, v204, v205
    v_cvt_pk_bf16_f32 v215, v206, v207
    v_mul_f32 v64, v64, v220
    v_mul_f32 v65, v65, v220
    v_mul_f32 v66, v66, v220
    v_mul_f32 v67, v67, v220
    v_mul_f32 v68, v68, v220
    v_mul_f32 v69, v69, v220
    v_mul_f32 v70, v70, v220
    v_mul_f32 v71, v71, v220
    v_mul_f32 v72, v72, v220
    v_mul_f32 v73, v73, v220
    v_mul_f32 v74, v74, v220
    v_mul_f32 v75, v75, v220
    v_mul_f32 v76, v76, v220
    v_mul_f32 v77, v77, v220
    v_mul_f32 v78, v78, v220
    v_mul_f32 v79, v79, v220
    s_waitcnt lgkmcnt(0)
    s_barrier
    v_mfma_f32_32x32x16_bf16 v[64:79], a[64:67], v[208:211], v[64:79]
    ds_read_b128 v[144:147], v29 offset:16384
    v_mul_f32 v80, v80, v220
    v_mul_f32 v81, v81, v220
    ds_read_b128 v[148:151], v29 offset:17408
    buffer_load_dwordx4 a[108:111], v23, s[32:35], s58 offen nt
    s_add_u32 s58, s58, 16384
    v_mul_f32 v82, v82, v220
    v_mul_f32 v83, v83, v220
    ds_read_b128 v[152:155], v29 offset:18432
    v_mul_f32 v84, v84, v220
    v_mfma_f32_32x32x16_bf16 v[64:79], a[68:71], v[212:215], v[64:79]
    v_mul_f32 v85, v85, v220
    ds_read_b128 v[156:159], v29 offset:19456
    v_mul_f32 v86, v86, v220
    v_mul_f32 v87, v87, v220
    v_mul_f32 v88, v88, v220
    v_mul_f32 v89, v89, v220
    v_mul_f32 v90, v90, v220
    v_mul_f32 v91, v91, v220
    v_mul_f32 v92, v92, v220
    v_mul_f32 v93, v93, v220
    v_mul_f32 v94, v94, v220
    v_mul_f32 v95, v95, v220
    s_nop 1
    v_mfma_f32_32x32x16_bf16 v[80:95], a[72:75], v[208:211], v[80:95]
    ds_read_b128 v[160:163], v30 offset:16384
    v_mul_f32 v96, v96, v220
    v_mul_f32 v97, v97, v220
    ds_read_b128 v[164:167], v30 offset:17408
    buffer_load_dwordx4 a[112:115], v20, s[32:35], s58 offen nt
    v_mul_f32 v98, v98, v220
    v_mul_f32 v99, v99, v220
    ds_read_b128 v[168:171], v30 offset:18432
    v_mul_f32 v100, v100, v220
    v_mfma_f32_32x32x16_bf16 v[80:95], a[76:79], v[212:215], v[80:95]
    v_mul_f32 v101, v101, v220
    ds_read_b128 v[172:175], v30 offset:19456
    v_mul_f32 v102, v102, v220
    v_mul_f32 v103, v103, v220
    v_mul_f32 v104, v104, v220
    v_mul_f32 v105, v105, v220
    v_mul_f32 v106, v106, v220
    v_mul_f32 v107, v107, v220
    v_mul_f32 v108, v108, v220
    v_mul_f32 v109, v109, v220
    v_mul_f32 v110, v110, v220
    v_mul_f32 v111, v111, v220
    s_nop 1
    v_mfma_f32_32x32x16_bf16 v[96:111], a[80:83], v[208:211], v[96:111]
    ds_read_b128 v[176:179], v31 offset:16384
    v_mul_f32 v112, v112, v220
    v_mul_f32 v113, v113, v220
    ds_read_b128 v[180:183], v31 offset:17408
    v_mul_f32 v114, v114, v220
    v_mul_f32 v115, v115, v220
    ds_read_b128 v[184:187], v31 offset:18432
    v_mul_f32 v116, v116, v220
    v_mfma_f32_32x32x16_bf16 v[96:111], a[84:87], v[212:215], v[96:111]
    v_mul_f32 v117, v117, v220
    ds_read_b128 v[188:191], v31 offset:19456
    v_mul_f32 v118, v118, v220
    buffer_load_dwordx4 a[116:119], v21, s[32:35], s58 offen nt
    v_mul_f32 v119, v119, v220
    v_mul_f32 v120, v120, v220
    v_mul_f32 v121, v121, v220
    v_mul_f32 v122, v122, v220
    v_mul_f32 v123, v123, v220
    v_mul_f32 v124, v124, v220
    v_mul_f32 v125, v125, v220
    v_mul_f32 v126, v126, v220
    v_mul_f32 v127, v127, v220
    s_nop 1
    v_mfma_f32_32x32x16_bf16 v[112:127], a[88:91], v[208:211], v[112:127]
    v_add_f32 v192, v192, v200
    v_add_f32 v193, v193, v201
    v_add_f32 v194, v194, v202
    v_add_f32 v195, v195, v203
    v_add_f32 v196, v196, v204
    v_add_f32 v197, v197, v205
    v_add_f32 v198, v198, v206
    v_add_f32 v199, v199, v207
    v_mfma_f32_32x32x16_bf16 v[112:127], a[92:95], v[212:215], v[112:127]
    v_add_f32 v192, v192, v196
    v_add_f32 v193, v193, v197
    v_add_f32 v194, v194, v198
    v_add_f32 v195, v195, v199
    v_add_f32 v192, v192, v193
    v_add_f32 v194, v194, v195
    v_add_f32 v192, v192, v194
    v_add_f32 v217, v217, v192
    ds_read_b128 a[32:35], v32 offset:16384
    ds_read_b128 a[36:39], v33 offset:16384
    ds_read_b128 a[40:43], v34 offset:16384
    ds_read_b128 a[44:47], v35 offset:16384
    ds_read_b128 a[48:51], v36 offset:16384
    ds_read_b128 a[52:55], v37 offset:16384
    ds_read_b128 a[56:59], v38 offset:16384
    ds_read_b128 a[60:63], v39 offset:16384
    s_waitcnt lgkmcnt(8)
    v_add_f32 v144, v144, v128
    v_add_f32 v145, v145, v129
    v_add_f32 v146, v146, v130
    v_add_f32 v147, v147, v131
    buffer_load_dwordx4 a[120:123], v22, s[32:35], s58 offen nt
    v_add_f32 v148, v148, v132
    v_add_f32 v149, v149, v133
    v_add_f32 v150, v150, v134
    v_add_f32 v151, v151, v135
    v_add_f32 v152, v152, v136
    v_add_f32 v153, v153, v137
    v_add_f32 v154, v154, v138
    v_add_f32 v155, v155, v139
    v_add_f32 v156, v156, v140
    v_add_f32 v157, v157, v141
    v_add_f32 v158, v158, v142
    v_add_f32 v159, v159, v143
    s_waitcnt lgkmcnt(0)
    v_mfma_f32_32x32x16_bf16 v[128:143], a[32:35], a[0:3], 0
    ds_read_b64_tr_b16 a[64:65], v40 offset:8192
    ds_read_b64_tr_b16 a[66:67], v41 offset:10240
    v_add_f32 v160, v160, v176
    v_add_f32 v161, v161, v177
    v_add_f32 v162, v162, v178
    v_add_f32 v163, v163, v179
    v_add_f32 v164, v164, v180
    v_mfma_f32_32x32x16_bf16 v[128:143], a[36:39], a[4:7], v[128:143]
    ds_read_b64_tr_b16 a[72:73], v42 offset:8192
    ds_read_b64_tr_b16 a[74:75], v43 offset:10240
    v_add_f32 v165, v165, v181
    v_add_f32 v166, v166, v182
    v_add_f32 v167, v167, v183
    v_add_f32 v168, v168, v184
    v_add_f32 v169, v169, v185
    v_mfma_f32_32x32x16_bf16 v[128:143], a[40:43], a[8:11], v[128:143]
    ds_read_b64_tr_b16 a[80:81], v44 offset:8192
    ds_read_b64_tr_b16 a[82:83], v45 offset:10240
    v_add_f32 v170, v170, v186
    v_add_f32 v171, v171, v187
    v_add_f32 v172, v172, v188
    v_add_f32 v173, v173, v189
    v_add_f32 v174, v174, v190
    v_mfma_f32_32x32x16_bf16 v[128:143], a[44:47], a[12:15], v[128:143]
    ds_read_b64_tr_b16 a[88:89], v46 offset:8192
    ds_read_b64_tr_b16 a[90:91], v47 offset:10240
    v_add_f32 v175, v175, v191
    v_add_f32 v144, v144, v160
    v_add_f32 v145, v145, v161
    v_add_f32 v146, v146, v162
    v_add_f32 v147, v147, v163
    v_mfma_f32_32x32x16_bf16 v[128:143], a[48:51], a[16:19], v[128:143]
    ds_read_b64_tr_b16 a[68:69], v40 offset:12288
    ds_read_b64_tr_b16 a[70:71], v41 offset:14336
    v_add_f32 v148, v148, v164
    v_add_f32 v149, v149, v165
    v_add_f32 v150, v150, v166
    v_add_f32 v151, v151, v167
    v_add_f32 v152, v152, v168
    v_mfma_f32_32x32x16_bf16 v[128:143], a[52:55], a[20:23], v[128:143]
    ds_read_b64_tr_b16 a[76:77], v42 offset:12288
    ds_read_b64_tr_b16 a[78:79], v43 offset:14336
    v_add_f32 v153, v153, v169
    v_add_f32 v154, v154, v170
    v_add_f32 v155, v155, v171
    v_add_f32 v156, v156, v172
    v_add_f32 v157, v157, v173
    v_mfma_f32_32x32x16_bf16 v[128:143], a[56:59], a[24:27], v[128:143]
    ds_read_b64_tr_b16 a[84:85], v44 offset:12288
    ds_read_b64_tr_b16 a[86:87], v45 offset:14336
    v_add_f32 v158, v158, v174
    v_add_f32 v159, v159, v175
    v_max3_f32 v218, v144, v145, v146
    v_max3_f32 v219, v147, v148, v149
    v_max3_f32 v220, v150, v151, v152
    v_mfma_f32_32x32x16_bf16 v[128:143], a[60:63], a[28:31], v[128:143]
    ds_read_b64_tr_b16 a[92:93], v46 offset:12288
    ds_read_b64_tr_b16 a[94:95], v47 offset:14336
    v_max3_f32 v221, v153, v154, v155
    v_max3_f32 v218, v218, v156, v157
    v_max3_f32 v219, v219, v158, v159
    v_max3_f32 v218, v218, v219, v220
    v_max_f32 v218, v218, v221
    v_mov_b32 v219, v218
    s_nop 1
    v_permlane32_swap_b32 v218, v219
    v_max3_f32 v218, v218, v219, v216
    v_sub_f32 v220, v216, v218
    v_mov_b32 v216, v218
    v_exp_f32 v220, v220
    v_sub_f32 v192, v144, v218
    v_sub_f32 v193, v145, v218
    buffer_load_dwordx4 a[124:127], v23, s[32:35], s58 offen nt
    s_add_u32 s58, s58, 16384
    v_sub_f32 v194, v146, v218
    v_sub_f32 v195, v147, v218
    v_sub_f32 v196, v148, v218
    v_sub_f32 v197, v149, v218
    v_sub_f32 v198, v150, v218
    buffer_load_dwordx4 a[128:131], v20, s[32:35], s58 offen nt
    v_sub_f32 v199, v151, v218
    v_sub_f32 v200, v152, v218
    v_sub_f32 v201, v153, v218
    v_sub_f32 v202, v154, v218
    v_sub_f32 v203, v155, v218
    v_sub_f32 v204, v156, v218
    v_sub_f32 v205, v157, v218
    v_sub_f32 v206, v158, v218
    v_sub_f32 v207, v159, v218
    ds_write_b128 v28, v[128:131] offset:0
    v_exp_f32 v192, v192
    v_exp_f32 v193, v193
    v_exp_f32 v194, v194
    v_exp_f32 v195, v195
    ds_write_b128 v28, v[132:135] offset:1024
    v_exp_f32 v196, v196
    v_exp_f32 v197, v197
    v_exp_f32 v198, v198
    v_exp_f32 v199, v199
    ds_write_b128 v28, v[136:139] offset:2048
    v_exp_f32 v200, v200
    v_exp_f32 v201, v201
    v_exp_f32 v202, v202
    v_exp_f32 v203, v203
    ds_write_b128 v28, v[140:143] offset:3072
    v_exp_f32 v204, v204
    v_exp_f32 v205, v205
    v_exp_f32 v206, v206
    v_exp_f32 v207, v207
    v_mul_f32 v217, v217, v220
    v_cvt_pk_bf16_f32 v208, v192, v193
    v_cvt_pk_bf16_f32 v209, v194, v195
    v_cvt_pk_bf16_f32 v210, v196, v197
    v_cvt_pk_bf16_f32 v211, v198, v199
    v_cvt_pk_bf16_f32 v212, v200, v201
    v_cvt_pk_bf16_f32 v213, v202, v203
    v_cvt_pk_bf16_f32 v214, v204, v205
    v_cvt_pk_bf16_f32 v215, v206, v207
    v_mul_f32 v64, v64, v220
    v_mul_f32 v65, v65, v220
    v_mul_f32 v66, v66, v220
    v_mul_f32 v67, v67, v220
    v_mul_f32 v68, v68, v220
    v_mul_f32 v69, v69, v220
    v_mul_f32 v70, v70, v220
    v_mul_f32 v71, v71, v220
    v_mul_f32 v72, v72, v220
    v_mul_f32 v73, v73, v220
    v_mul_f32 v74, v74, v220
    v_mul_f32 v75, v75, v220
    v_mul_f32 v76, v76, v220
    v_mul_f32 v77, v77, v220
    v_mul_f32 v78, v78, v220
    v_mul_f32 v79, v79, v220
    s_waitcnt lgkmcnt(0)
    s_barrier
    v_mfma_f32_32x32x16_bf16 v[64:79], a[64:67], v[208:211], v[64:79]
    ds_read_b128 v[144:147], v29 offset:0
    v_mul_f32 v80, v80, v220
    v_mul_f32 v81, v81, v220
    ds_read_b128 v[148:151], v29 offset:1024
    s_waitcnt vmcnt(32)
    ds_write_b128 v26, a[192:195] offset:24576
    buffer_load_dwordx4 a[132:135], v21, s[32:35], s58 offen nt
    v_mul_f32 v82, v82, v220
    v_mul_f32 v83, v83, v220
    ds_read_b128 v[152:155], v29 offset:2048
    v_mul_f32 v84, v84, v220
    v_mfma_f32_32x32x16_bf16 v[64:79], a[68:71], v[212:215], v[64:79]
    v_mul_f32 v85, v85, v220
    ds_read_b128 v[156:159], v29 offset:3072
    v_mul_f32 v86, v86, v220
    s_waitcnt vmcnt(32)
    ds_write_b128 v26, a[196:199] offset:25600
    v_mul_f32 v87, v87, v220
    v_mul_f32 v88, v88, v220
    v_mul_f32 v89, v89, v220
    v_mul_f32 v90, v90, v220
    v_mul_f32 v91, v91, v220
    v_mul_f32 v92, v92, v220
    v_mul_f32 v93, v93, v220
    v_mul_f32 v94, v94, v220
    v_mul_f32 v95, v95, v220
    s_nop 1
    v_mfma_f32_32x32x16_bf16 v[80:95], a[72:75], v[208:211], v[80:95]
    ds_read_b128 v[160:163], v30 offset:0
    v_mul_f32 v96, v96, v220
    v_mul_f32 v97, v97, v220
    ds_read_b128 v[164:167], v30 offset:1024
    s_waitcnt vmcnt(31)
    ds_write_b128 v26, a[200:203] offset:26624
    buffer_load_dwordx4 a[136:139], v22, s[32:35], s58 offen nt
    v_mul_f32 v98, v98, v220
    v_mul_f32 v99, v99, v220
    ds_read_b128 v[168:171], v30 offset:2048
    v_mul_f32 v100, v100, v220
    v_mfma_f32_32x32x16_bf16 v[80:95], a[76:79], v[212:215], v[80:95]
    v_mul_f32 v101, v101, v220
    ds_read_b128 v[172:175], v30 offset:3072
    v_mul_f32 v102, v102, v220
    s_waitcnt vmcnt(31)
    ds_write_b128 v26, a[204:207] offset:27648
    v_mul_f32 v103, v103, v220
    v_mul_f32 v104, v104, v220
    v_mul_f32 v105, v105, v220
    v_mul_f32 v106, v106, v220
    v_mul_f32 v107, v107, v220
    v_mul_f32 v108, v108, v220
    v_mul_f32 v109, v109, v220
    v_mul_f32 v110, v110, v220
    v_mul_f32 v111, v111, v220
    s_nop 1
    v_mfma_f32_32x32x16_bf16 v[96:111], a[80:83], v[208:211], v[96:111]
    ds_read_b128 v[176:179], v31 offset:0
    v_mul_f32 v112, v112, v220
    v_mul_f32 v113, v113, v220
    ds_read_b128 v[180:183], v31 offset:1024
    s_waitcnt vmcnt(30)
    ds_write_b128 v26, a[208:211] offset:28672
    v_mul_f32 v114, v114, v220
    v_mul_f32 v115, v115, v220
    ds_read_b128 v[184:187], v31 offset:2048
    v_mul_f32 v116, v116, v220
    v_mfma_f32_32x32x16_bf16 v[96:111], a[84:87], v[212:215], v[96:111]
    v_mul_f32 v117, v117, v220
    ds_read_b128 v[188:191], v31 offset:3072
    v_mul_f32 v118, v118, v220
    s_waitcnt vmcnt(29)
    ds_write_b128 v26, a[212:215] offset:29696
    buffer_load_dwordx4 a[140:143], v23, s[32:35], s58 offen nt
    s_add_u32 s58, s58, 16384
    v_mul_f32 v119, v119, v220
    v_mul_f32 v120, v120, v220
    v_mul_f32 v121, v121, v220
    v_mul_f32 v122, v122, v220
    v_mul_f32 v123, v123, v220
    v_mul_f32 v124, v124, v220
    v_mul_f32 v125, v125, v220
    v_mul_f32 v126, v126, v220
    v_mul_f32 v127, v127, v220
    s_nop 1
    v_mfma_f32_32x32x16_bf16 v[112:127], a[88:91], v[208:211], v[112:127]
    v_add_f32 v192, v192, v200
    v_add_f32 v193, v193, v201
    v_add_f32 v194, v194, v202
    v_add_f32 v195, v195, v203
    s_waitcnt vmcnt(29)
    ds_write_b128 v26, a[216:219] offset:30720
    v_add_f32 v196, v196, v204
    v_add_f32 v197, v197, v205
    v_add_f32 v198, v198, v206
    v_add_f32 v199, v199, v207
    v_mfma_f32_32x32x16_bf16 v[112:127], a[92:95], v[212:215], v[112:127]
    v_add_f32 v192, v192, v196
    v_add_f32 v193, v193, v197
    v_add_f32 v194, v194, v198
    s_waitcnt vmcnt(28)
    ds_write_b128 v26, a[220:223] offset:31744
    v_add_f32 v195, v195, v199
    v_add_f32 v192, v192, v193
    v_add_f32 v194, v194, v195
    v_add_f32 v192, v192, v194
    v_add_f32 v217, v217, v192
    ds_read_b128 a[32:35], v32 offset:24576
    ds_read_b128 a[36:39], v33 offset:24576
    ds_read_b128 a[40:43], v34 offset:24576
    ds_read_b128 a[44:47], v35 offset:24576
    ds_read_b128 a[48:51], v36 offset:24576
    ds_read_b128 a[52:55], v37 offset:24576
    ds_read_b128 a[56:59], v38 offset:24576
    ds_read_b128 a[60:63], v39 offset:24576
    s_waitcnt lgkmcnt(8)
    v_add_f32 v144, v144, v128
    v_add_f32 v145, v145, v129
    v_add_f32 v146, v146, v130
    v_add_f32 v147, v147, v131
    buffer_load_dwordx4 a[144:147], v20, s[32:35], s58 offen nt
    v_add_f32 v148, v148, v132
    v_add_f32 v149, v149, v133
    v_add_f32 v150, v150, v134
    v_add_f32 v151, v151, v135
    v_add_f32 v152, v152, v136
    v_add_f32 v153, v153, v137
    v_add_f32 v154, v154, v138
    v_add_f32 v155, v155, v139
    v_add_f32 v156, v156, v140
    v_add_f32 v157, v157, v141
    v_add_f32 v158, v158, v142
    v_add_f32 v159, v159, v143
    s_waitcnt lgkmcnt(0)
    v_mfma_f32_32x32x16_bf16 v[128:143], a[32:35], a[0:3], 0
    ds_read_b64_tr_b16 a[64:65], v40 offset:16384
    ds_read_b64_tr_b16 a[66:67], v41 offset:18432
    v_add_f32 v160, v160, v176
    v_add_f32 v161, v161, v177
    v_add_f32 v162, v162, v178
    v_add_f32 v163, v163, v179
    v_add_f32 v164, v164, v180
    v_mfma_f32_32x32x16_bf16 v[128:143], a[36:39], a[4:7], v[128:143]
    ds_read_b64_tr_b16 a[72:73], v42 offset:16384
    ds_read_b64_tr_b16 a[74:75], v43 offset:18432
    v_add_f32 v165, v165, v181
    v_add_f32 v166, v166, v182
    v_add_f32 v167, v167, v183
    v_add_f32 v168, v168, v184
    v_add_f32 v169, v169, v185
    v_mfma_f32_32x32x16_bf16 v[128:143], a[40:43], a[8:11], v[128:143]
    ds_read_b64_tr_b16 a[80:81], v44 offset:16384
    ds_read_b64_tr_b16 a[82:83], v45 offset:18432
    v_add_f32 v170, v170, v186
    v_add_f32 v171, v171, v187
    v_add_f32 v172, v172, v188
    v_add_f32 v173, v173, v189
    v_add_f32 v174, v174, v190
    v_mfma_f32_32x32x16_bf16 v[128:143], a[44:47], a[12:15], v[128:143]
    ds_read_b64_tr_b16 a[88:89], v46 offset:16384
    ds_read_b64_tr_b16 a[90:91], v47 offset:18432
    v_add_f32 v175, v175, v191
    v_add_f32 v144, v144, v160
    v_add_f32 v145, v145, v161
    v_add_f32 v146, v146, v162
    v_add_f32 v147, v147, v163
    v_mfma_f32_32x32x16_bf16 v[128:143], a[48:51], a[16:19], v[128:143]
    ds_read_b64_tr_b16 a[68:69], v40 offset:20480
    ds_read_b64_tr_b16 a[70:71], v41 offset:22528
    v_add_f32 v148, v148, v164
    v_add_f32 v149, v149, v165
    v_add_f32 v150, v150, v166
    v_add_f32 v151, v151, v167
    v_add_f32 v152, v152, v168
    v_mfma_f32_32x32x16_bf16 v[128:143], a[52:55], a[20:23], v[128:143]
    ds_read_b64_tr_b16 a[76:77], v42 offset:20480
    ds_read_b64_tr_b16 a[78:79], v43 offset:22528
    v_add_f32 v153, v153, v169
    v_add_f32 v154, v154, v170
    v_add_f32 v155, v155, v171
    v_add_f32 v156, v156, v172
    v_add_f32 v157, v157, v173
    v_mfma_f32_32x32x16_bf16 v[128:143], a[56:59], a[24:27], v[128:143]
    ds_read_b64_tr_b16 a[84:85], v44 offset:20480
    ds_read_b64_tr_b16 a[86:87], v45 offset:22528
    v_add_f32 v158, v158, v174
    v_add_f32 v159, v159, v175
    v_max3_f32 v218, v144, v145, v146
    v_max3_f32 v219, v147, v148, v149
    v_max3_f32 v220, v150, v151, v152
    v_mfma_f32_32x32x16_bf16 v[128:143], a[60:63], a[28:31], v[128:143]
    ds_read_b64_tr_b16 a[92:93], v46 offset:20480
    ds_read_b64_tr_b16 a[94:95], v47 offset:22528
    v_max3_f32 v221, v153, v154, v155
    v_max3_f32 v218, v218, v156, v157
    v_max3_f32 v219, v219, v158, v159
    v_max3_f32 v218, v218, v219, v220
    v_max_f32 v218, v218, v221
    v_mov_b32 v219, v218
    s_nop 1
    v_permlane32_swap_b32 v218, v219
    v_max3_f32 v218, v218, v219, v216
    v_sub_f32 v220, v216, v218
    v_mov_b32 v216, v218
    v_exp_f32 v220, v220
    v_sub_f32 v192, v144, v218
    v_sub_f32 v193, v145, v218
    buffer_load_dwordx4 a[148:151], v21, s[32:35], s58 offen nt
    v_sub_f32 v194, v146, v218
    v_sub_f32 v195, v147, v218
    v_sub_f32 v196, v148, v218
    v_sub_f32 v197, v149, v218
    v_sub_f32 v198, v150, v218
    buffer_load_dwordx4 a[152:155], v22, s[32:35], s58 offen nt
    v_sub_f32 v199, v151, v218
    v_sub_f32 v200, v152, v218
    v_sub_f32 v201, v153, v218
    v_sub_f32 v202, v154, v218
    v_sub_f32 v203, v155, v218
    v_sub_f32 v204, v156, v218
    v_sub_f32 v205, v157, v218
    v_sub_f32 v206, v158, v218
    v_sub_f32 v207, v159, v218
    ds_write_b128 v28, v[128:131] offset:16384
    v_exp_f32 v192, v192
    v_exp_f32 v193, v193
    v_exp_f32 v194, v194
    v_exp_f32 v195, v195
    ds_write_b128 v28, v[132:135] offset:17408
    v_exp_f32 v196, v196
    v_exp_f32 v197, v197
    v_exp_f32 v198, v198
    v_exp_f32 v199, v199
    ds_write_b128 v28, v[136:139] offset:18432
    v_exp_f32 v200, v200
    v_exp_f32 v201, v201
    v_exp_f32 v202, v202
    v_exp_f32 v203, v203
    ds_write_b128 v28, v[140:143] offset:19456
    v_exp_f32 v204, v204
    v_exp_f32 v205, v205
    v_exp_f32 v206, v206
    v_exp_f32 v207, v207
    v_mul_f32 v217, v217, v220
    v_cvt_pk_bf16_f32 v208, v192, v193
    v_cvt_pk_bf16_f32 v209, v194, v195
    v_cvt_pk_bf16_f32 v210, v196, v197
    v_cvt_pk_bf16_f32 v211, v198, v199
    v_cvt_pk_bf16_f32 v212, v200, v201
    v_cvt_pk_bf16_f32 v213, v202, v203
    v_cvt_pk_bf16_f32 v214, v204, v205
    v_cvt_pk_bf16_f32 v215, v206, v207
    v_mul_f32 v64, v64, v220
    v_mul_f32 v65, v65, v220
    v_mul_f32 v66, v66, v220
    v_mul_f32 v67, v67, v220
    v_mul_f32 v68, v68, v220
    v_mul_f32 v69, v69, v220
    v_mul_f32 v70, v70, v220
    v_mul_f32 v71, v71, v220
    v_mul_f32 v72, v72, v220
    v_mul_f32 v73, v73, v220
    v_mul_f32 v74, v74, v220
    v_mul_f32 v75, v75, v220
    v_mul_f32 v76, v76, v220
    v_mul_f32 v77, v77, v220
    v_mul_f32 v78, v78, v220
    v_mul_f32 v79, v79, v220
    s_waitcnt lgkmcnt(0)
    s_barrier
    v_mfma_f32_32x32x16_bf16 v[64:79], a[64:67], v[208:211], v[64:79]
    ds_read_b128 v[144:147], v29 offset:16384
    v_mul_f32 v80, v80, v220
    v_mul_f32 v81, v81, v220
    ds_read_b128 v[148:151], v29 offset:17408
    s_waitcnt vmcnt(30)
    ds_write_b128 v26, a[224:227] offset:0
    buffer_load_dwordx4 a[156:159], v23, s[32:35], s58 offen nt
    s_add_u32 s58, s58, 16384
    v_mul_f32 v82, v82, v220
    v_mul_f32 v83, v83, v220
    ds_read_b128 v[152:155], v29 offset:18432
    v_mul_f32 v84, v84, v220
    v_mfma_f32_32x32x16_bf16 v[64:79], a[68:71], v[212:215], v[64:79]
    v_mul_f32 v85, v85, v220
    ds_read_b128 v[156:159], v29 offset:19456
    v_mul_f32 v86, v86, v220
    s_waitcnt vmcnt(30)
    ds_write_b128 v26, a[228:231] offset:1024
    v_mul_f32 v87, v87, v220
    v_mul_f32 v88, v88, v220
    v_mul_f32 v89, v89, v220
    v_mul_f32 v90, v90, v220
    v_mul_f32 v91, v91, v220
    v_mul_f32 v92, v92, v220
    v_mul_f32 v93, v93, v220
    v_mul_f32 v94, v94, v220
    v_mul_f32 v95, v95, v220
    s_nop 1
    v_mfma_f32_32x32x16_bf16 v[80:95], a[72:75], v[208:211], v[80:95]
    ds_read_b128 v[160:163], v30 offset:16384
    v_mul_f32 v96, v96, v220
    v_mul_f32 v97, v97, v220
    ds_read_b128 v[164:167], v30 offset:17408
    s_waitcnt vmcnt(29)
    ds_write_b128 v26, a[232:235] offset:2048
    buffer_load_dwordx4 a[160:163], v20, s[32:35], s58 offen nt
    v_mul_f32 v98, v98, v220
    v_mul_f32 v99, v99, v220
    ds_read_b128 v[168:171], v30 offset:18432
    v_mul_f32 v100, v100, v220
    v_mfma_f32_32x32x16_bf16 v[80:95], a[76:79], v[212:215], v[80:95]
    v_mul_f32 v101, v101, v220
    ds_read_b128 v[172:175], v30 offset:19456
    v_mul_f32 v102, v102, v220
    s_waitcnt vmcnt(29)
    ds_write_b128 v26, a[236:239] offset:3072
    v_mul_f32 v103, v103, v220
    v_mul_f32 v104, v104, v220
    v_mul_f32 v105, v105, v220
    v_mul_f32 v106, v106, v220
    v_mul_f32 v107, v107, v220
    v_mul_f32 v108, v108, v220
    v_mul_f32 v109, v109, v220
    v_mul_f32 v110, v110, v220
    v_mul_f32 v111, v111, v220
    s_nop 1
    v_mfma_f32_32x32x16_bf16 v[96:111], a[80:83], v[208:211], v[96:111]
    ds_read_b128 v[176:179], v31 offset:16384
    v_mul_f32 v112, v112, v220
    v_mul_f32 v113, v113, v220
    ds_read_b128 v[180:183], v31 offset:17408
    s_waitcnt vmcnt(28)
    ds_write_b128 v26, a[240:243] offset:4096
    v_mul_f32 v114, v114, v220
    v_mul_f32 v115, v115, v220
    ds_read_b128 v[184:187], v31 offset:18432
    v_mul_f32 v116, v116, v220
    v_mfma_f32_32x32x16_bf16 v[96:111], a[84:87], v[212:215], v[96:111]
    v_mul_f32 v117, v117, v220
    ds_read_b128 v[188:191], v31 offset:19456
    v_mul_f32 v118, v118, v220
    s_waitcnt vmcnt(27)
    ds_write_b128 v26, a[244:247] offset:5120
    buffer_load_dwordx4 a[164:167], v21, s[32:35], s58 offen nt
    v_mul_f32 v119, v119, v220
    v_mul_f32 v120, v120, v220
    v_mul_f32 v121, v121, v220
    v_mul_f32 v122, v122, v220
    v_mul_f32 v123, v123, v220
    v_mul_f32 v124, v124, v220
    v_mul_f32 v125, v125, v220
    v_mul_f32 v126, v126, v220
    v_mul_f32 v127, v127, v220
    s_nop 1
    v_mfma_f32_32x32x16_bf16 v[112:127], a[88:91], v[208:211], v[112:127]
    v_add_f32 v192, v192, v200
    v_add_f32 v193, v193, v201
    v_add_f32 v194, v194, v202
    v_add_f32 v195, v195, v203
    s_waitcnt vmcnt(27)
    ds_write_b128 v26, a[248:251] offset:6144
    v_add_f32 v196, v196, v204
    v_add_f32 v197, v197, v205
    v_add_f32 v198, v198, v206
    v_add_f32 v199, v199, v207
    v_mfma_f32_32x32x16_bf16 v[112:127], a[92:95], v[212:215], v[112:127]
    v_add_f32 v192, v192, v196
    v_add_f32 v193, v193, v197
    v_add_f32 v194, v194, v198
    s_waitcnt vmcnt(26)
    ds_write_b128 v26, a[252:255] offset:7168
    v_add_f32 v195, v195, v199
    v_add_f32 v192, v192, v193
    v_add_f32 v194, v194, v195
    v_add_f32 v192, v192, v194
    v_add_f32 v217, v217, v192
    ds_read_b128 a[32:35], v32 offset:0
    ds_read_b128 a[36:39], v33 offset:0
    ds_read_b128 a[40:43], v34 offset:0
    ds_read_b128 a[44:47], v35 offset:0
    ds_read_b128 a[48:51], v36 offset:0
    ds_read_b128 a[52:55], v37 offset:0
    ds_read_b128 a[56:59], v38 offset:0
    ds_read_b128 a[60:63], v39 offset:0
    s_waitcnt lgkmcnt(8)
    v_add_f32 v144, v144, v128
    v_add_f32 v145, v145, v129
    v_add_f32 v146, v146, v130
    v_add_f32 v147, v147, v131
    buffer_load_dwordx4 a[168:171], v22, s[32:35], s58 offen nt
    v_add_f32 v148, v148, v132
    v_add_f32 v149, v149, v133
    v_add_f32 v150, v150, v134
    v_add_f32 v151, v151, v135
    v_add_f32 v152, v152, v136
    v_add_f32 v153, v153, v137
    v_add_f32 v154, v154, v138
    v_add_f32 v155, v155, v139
    v_add_f32 v156, v156, v140
    v_add_f32 v157, v157, v141
    v_add_f32 v158, v158, v142
    v_add_f32 v159, v159, v143
    s_waitcnt lgkmcnt(0)
    v_mfma_f32_32x32x16_bf16 v[128:143], a[32:35], a[0:3], 0
    ds_read_b64_tr_b16 a[64:65], v40 offset:24576
    ds_read_b64_tr_b16 a[66:67], v41 offset:26624
    v_add_f32 v160, v160, v176
    v_add_f32 v161, v161, v177
    v_add_f32 v162, v162, v178
    v_add_f32 v163, v163, v179
    v_add_f32 v164, v164, v180
    v_mfma_f32_32x32x16_bf16 v[128:143], a[36:39], a[4:7], v[128:143]
    ds_read_b64_tr_b16 a[72:73], v42 offset:24576
    ds_read_b64_tr_b16 a[74:75], v43 offset:26624
    v_add_f32 v165, v165, v181
    v_add_f32 v166, v166, v182
    v_add_f32 v167, v167, v183
    v_add_f32 v168, v168, v184
    v_add_f32 v169, v169, v185
    v_mfma_f32_32x32x16_bf16 v[128:143], a[40:43], a[8:11], v[128:143]
    ds_read_b64_tr_b16 a[80:81], v44 offset:24576
    ds_read_b64_tr_b16 a[82:83], v45 offset:26624
    v_add_f32 v170, v170, v186
    v_add_f32 v171, v171, v187
    v_add_f32 v172, v172, v188
    v_add_f32 v173, v173, v189
    v_add_f32 v174, v174, v190
    v_mfma_f32_32x32x16_bf16 v[128:143], a[44:47], a[12:15], v[128:143]
    ds_read_b64_tr_b16 a[88:89], v46 offset:24576
    ds_read_b64_tr_b16 a[90:91], v47 offset:26624
    v_add_f32 v175, v175, v191
    v_add_f32 v144, v144, v160
    v_add_f32 v145, v145, v161
    v_add_f32 v146, v146, v162
    v_add_f32 v147, v147, v163
    v_mfma_f32_32x32x16_bf16 v[128:143], a[48:51], a[16:19], v[128:143]
    ds_read_b64_tr_b16 a[68:69], v40 offset:28672
    ds_read_b64_tr_b16 a[70:71], v41 offset:30720
    v_add_f32 v148, v148, v164
    v_add_f32 v149, v149, v165
    v_add_f32 v150, v150, v166
    v_add_f32 v151, v151, v167
    v_add_f32 v152, v152, v168
    v_mfma_f32_32x32x16_bf16 v[128:143], a[52:55], a[20:23], v[128:143]
    ds_read_b64_tr_b16 a[76:77], v42 offset:28672
    ds_read_b64_tr_b16 a[78:79], v43 offset:30720
    v_add_f32 v153, v153, v169
    v_add_f32 v154, v154, v170
    v_add_f32 v155, v155, v171
    v_add_f32 v156, v156, v172
    v_add_f32 v157, v157, v173
    v_mfma_f32_32x32x16_bf16 v[128:143], a[56:59], a[24:27], v[128:143]
    ds_read_b64_tr_b16 a[84:85], v44 offset:28672
    ds_read_b64_tr_b16 a[86:87], v45 offset:30720
    v_add_f32 v158, v158, v174
    v_add_f32 v159, v159, v175
    v_max3_f32 v218, v144, v145, v146
    v_max3_f32 v219, v147, v148, v149
    v_max3_f32 v220, v150, v151, v152
    v_mfma_f32_32x32x16_bf16 v[128:143], a[60:63], a[28:31], v[128:143]
    ds_read_b64_tr_b16 a[92:93], v46 offset:28672
    ds_read_b64_tr_b16 a[94:95], v47 offset:30720
    v_max3_f32 v221, v153, v154, v155
    v_max3_f32 v218, v218, v156, v157
    v_max3_f32 v219, v219, v158, v159
    v_max3_f32 v218, v218, v219, v220
    v_max_f32 v218, v218, v221
    v_mov_b32 v219, v218
    s_nop 1
    v_permlane32_swap_b32 v218, v219
    v_max3_f32 v218, v218, v219, v216
    v_sub_f32 v220, v216, v218
    v_mov_b32 v216, v218
    v_exp_f32 v220, v220
    v_sub_f32 v192, v144, v218
    v_sub_f32 v193, v145, v218
    buffer_load_dwordx4 a[172:175], v23, s[32:35], s58 offen nt
    s_add_u32 s58, s58, 16384
    v_sub_f32 v194, v146, v218
    v_sub_f32 v195, v147, v218
    v_sub_f32 v196, v148, v218
    v_sub_f32 v197, v149, v218
    v_sub_f32 v198, v150, v218
    buffer_load_dwordx4 a[176:179], v20, s[32:35], s58 offen nt
    v_sub_f32 v199, v151, v218
    v_sub_f32 v200, v152, v218
    v_sub_f32 v201, v153, v218
    v_sub_f32 v202, v154, v218
    v_sub_f32 v203, v155, v218
    v_sub_f32 v204, v156, v218
    v_sub_f32 v205, v157, v218
    v_sub_f32 v206, v158, v218
    v_sub_f32 v207, v159, v218
    ds_write_b128 v28, v[128:131] offset:0
    v_exp_f32 v192, v192
    v_exp_f32 v193, v193
    v_exp_f32 v194, v194
    v_exp_f32 v195, v195
    ds_write_b128 v28, v[132:135] offset:1024
    v_exp_f32 v196, v196
    v_exp_f32 v197, v197
    v_exp_f32 v198, v198
    v_exp_f32 v199, v199
    ds_write_b128 v28, v[136:139] offset:2048
    v_exp_f32 v200, v200
    v_exp_f32 v201, v201
    v_exp_f32 v202, v202
    v_exp_f32 v203, v203
    ds_write_b128 v28, v[140:143] offset:3072
    v_exp_f32 v204, v204
    v_exp_f32 v205, v205
    v_exp_f32 v206, v206
    v_exp_f32 v207, v207
    v_mul_f32 v217, v217, v220
    v_cvt_pk_bf16_f32 v208, v192, v193
    v_cvt_pk_bf16_f32 v209, v194, v195
    v_cvt_pk_bf16_f32 v210, v196, v197
    v_cvt_pk_bf16_f32 v211, v198, v199
    v_cvt_pk_bf16_f32 v212, v200, v201
    v_cvt_pk_bf16_f32 v213, v202, v203
    v_cvt_pk_bf16_f32 v214, v204, v205
    v_cvt_pk_bf16_f32 v215, v206, v207
    v_mul_f32 v64, v64, v220
    v_mul_f32 v65, v65, v220
    v_mul_f32 v66, v66, v220
    v_mul_f32 v67, v67, v220
    v_mul_f32 v68, v68, v220
    v_mul_f32 v69, v69, v220
    v_mul_f32 v70, v70, v220
    v_mul_f32 v71, v71, v220
    v_mul_f32 v72, v72, v220
    v_mul_f32 v73, v73, v220
    v_mul_f32 v74, v74, v220
    v_mul_f32 v75, v75, v220
    v_mul_f32 v76, v76, v220
    v_mul_f32 v77, v77, v220
    v_mul_f32 v78, v78, v220
    v_mul_f32 v79, v79, v220
    s_waitcnt lgkmcnt(0)
    s_barrier
    v_mfma_f32_32x32x16_bf16 v[64:79], a[64:67], v[208:211], v[64:79]
    ds_read_b128 v[144:147], v29 offset:0
    v_mul_f32 v80, v80, v220
    v_mul_f32 v81, v81, v220
    ds_read_b128 v[148:151], v29 offset:1024
    s_waitcnt vmcnt(28)
    ds_write_b128 v26, v[224:227] offset:8192
    buffer_load_dwordx4 a[180:183], v21, s[32:35], s58 offen nt
    v_mul_f32 v82, v82, v220
    v_mul_f32 v83, v83, v220
    ds_read_b128 v[152:155], v29 offset:2048
    v_mul_f32 v84, v84, v220
    v_mfma_f32_32x32x16_bf16 v[64:79], a[68:71], v[212:215], v[64:79]
    v_mul_f32 v85, v85, v220
    ds_read_b128 v[156:159], v29 offset:3072
    v_mul_f32 v86, v86, v220
    s_waitcnt vmcnt(28)
    ds_write_b128 v26, v[228:231] offset:9216
    v_mul_f32 v87, v87, v220
    v_mul_f32 v88, v88, v220
    v_mul_f32 v89, v89, v220
    v_mul_f32 v90, v90, v220
    v_mul_f32 v91, v91, v220
    v_mul_f32 v92, v92, v220
    v_mul_f32 v93, v93, v220
    v_mul_f32 v94, v94, v220
    v_mul_f32 v95, v95, v220
    s_nop 1
    v_mfma_f32_32x32x16_bf16 v[80:95], a[72:75], v[208:211], v[80:95]
    ds_read_b128 v[160:163], v30 offset:0
    v_mul_f32 v96, v96, v220
    v_mul_f32 v97, v97, v220
    ds_read_b128 v[164:167], v30 offset:1024
    s_waitcnt vmcnt(27)
    ds_write_b128 v26, v[232:235] offset:10240
    buffer_load_dwordx4 a[184:187], v22, s[32:35], s58 offen nt
    v_mul_f32 v98, v98, v220
    v_mul_f32 v99, v99, v220
    ds_read_b128 v[168:171], v30 offset:2048
    v_mul_f32 v100, v100, v220
    v_mfma_f32_32x32x16_bf16 v[80:95], a[76:79], v[212:215], v[80:95]
    v_mul_f32 v101, v101, v220
    ds_read_b128 v[172:175], v30 offset:3072
    v_mul_f32 v102, v102, v220
    s_waitcnt vmcnt(27)
    ds_write_b128 v26, v[236:239] offset:11264
    v_mul_f32 v103, v103, v220
    v_mul_f32 v104, v104, v220
    v_mul_f32 v105, v105, v220
    v_mul_f32 v106, v106, v220
    v_mul_f32 v107, v107, v220
    v_mul_f32 v108, v108, v220
    v_mul_f32 v109, v109, v220
    v_mul_f32 v110, v110, v220
    v_mul_f32 v111, v111, v220
    s_nop 1
    v_mfma_f32_32x32x16_bf16 v[96:111], a[80:83], v[208:211], v[96:111]
    ds_read_b128 v[176:179], v31 offset:0
    v_mul_f32 v112, v112, v220
    v_mul_f32 v113, v113, v220
    ds_read_b128 v[180:183], v31 offset:1024
    s_waitcnt vmcnt(26)
    ds_write_b128 v26, v[240:243] offset:12288
    v_mul_f32 v114, v114, v220
    v_mul_f32 v115, v115, v220
    ds_read_b128 v[184:187], v31 offset:2048
    v_mul_f32 v116, v116, v220
    v_mfma_f32_32x32x16_bf16 v[96:111], a[84:87], v[212:215], v[96:111]
    v_mul_f32 v117, v117, v220
    ds_read_b128 v[188:191], v31 offset:3072
    v_mul_f32 v118, v118, v220
    s_waitcnt vmcnt(25)
    ds_write_b128 v26, v[244:247] offset:13312
    buffer_load_dwordx4 a[188:191], v23, s[32:35], s58 offen nt
    s_add_u32 s58, s58, 16384
    v_mul_f32 v119, v119, v220
    v_mul_f32 v120, v120, v220
    v_mul_f32 v121, v121, v220
    v_mul_f32 v122, v122, v220
    v_mul_f32 v123, v123, v220
    v_mul_f32 v124, v124, v220
    v_mul_f32 v125, v125, v220
    v_mul_f32 v126, v126, v220
    v_mul_f32 v127, v127, v220
    s_nop 1
    v_mfma_f32_32x32x16_bf16 v[112:127], a[88:91], v[208:211], v[112:127]
    v_add_f32 v192, v192, v200
    v_add_f32 v193, v193, v201
    v_add_f32 v194, v194, v202
    v_add_f32 v195, v195, v203
    s_waitcnt vmcnt(25)
    ds_write_b128 v26, v[248:251] offset:14336
    v_add_f32 v196, v196, v204
    v_add_f32 v197, v197, v205
    v_add_f32 v198, v198, v206
    v_add_f32 v199, v199, v207
    v_mfma_f32_32x32x16_bf16 v[112:127], a[92:95], v[212:215], v[112:127]
    v_add_f32 v192, v192, v196
    v_add_f32 v193, v193, v197
    v_add_f32 v194, v194, v198
    s_waitcnt vmcnt(24)
    ds_write_b128 v26, v[252:255] offset:15360
    v_add_f32 v195, v195, v199
    v_add_f32 v192, v192, v193
    v_add_f32 v194, v194, v195
    v_add_f32 v192, v192, v194
    v_add_f32 v217, v217, v192
    ds_read_b128 a[32:35], v32 offset:8192
    ds_read_b128 a[36:39], v33 offset:8192
    ds_read_b128 a[40:43], v34 offset:8192
    ds_read_b128 a[44:47], v35 offset:8192
    ds_read_b128 a[48:51], v36 offset:8192
    ds_read_b128 a[52:55], v37 offset:8192
    ds_read_b128 a[56:59], v38 offset:8192
    ds_read_b128 a[60:63], v39 offset:8192
    s_waitcnt lgkmcnt(8)
    v_add_f32 v144, v144, v128
    v_add_f32 v145, v145, v129
    v_add_f32 v146, v146, v130
    v_add_f32 v147, v147, v131
    buffer_load_dwordx4 a[192:195], v20, s[32:35], s58 offen nt
    v_add_f32 v148, v148, v132
    v_add_f32 v149, v149, v133
    v_add_f32 v150, v150, v134
    v_add_f32 v151, v151, v135
    v_add_f32 v152, v152, v136
    v_add_f32 v153, v153, v137
    v_add_f32 v154, v154, v138
    v_add_f32 v155, v155, v139
    v_add_f32 v156, v156, v140
    v_add_f32 v157, v157, v141
    v_add_f32 v158, v158, v142
    v_add_f32 v159, v159, v143
    s_waitcnt lgkmcnt(0)
    v_mfma_f32_32x32x16_bf16 v[128:143], a[32:35], a[0:3], 0
    ds_read_b64_tr_b16 a[64:65], v40 offset:0
    ds_read_b64_tr_b16 a[66:67], v41 offset:2048
    v_add_f32 v160, v160, v176
    v_add_f32 v161, v161, v177
    v_add_f32 v162, v162, v178
    v_add_f32 v163, v163, v179
    v_add_f32 v164, v164, v180
    v_mfma_f32_32x32x16_bf16 v[128:143], a[36:39], a[4:7], v[128:143]
    ds_read_b64_tr_b16 a[72:73], v42 offset:0
    ds_read_b64_tr_b16 a[74:75], v43 offset:2048
    v_add_f32 v165, v165, v181
    v_add_f32 v166, v166, v182
    v_add_f32 v167, v167, v183
    v_add_f32 v168, v168, v184
    v_add_f32 v169, v169, v185
    v_mfma_f32_32x32x16_bf16 v[128:143], a[40:43], a[8:11], v[128:143]
    ds_read_b64_tr_b16 a[80:81], v44 offset:0
    ds_read_b64_tr_b16 a[82:83], v45 offset:2048
    v_add_f32 v170, v170, v186
    v_add_f32 v171, v171, v187
    v_add_f32 v172, v172, v188
    v_add_f32 v173, v173, v189
    v_add_f32 v174, v174, v190
    v_mfma_f32_32x32x16_bf16 v[128:143], a[44:47], a[12:15], v[128:143]
    ds_read_b64_tr_b16 a[88:89], v46 offset:0
    ds_read_b64_tr_b16 a[90:91], v47 offset:2048
    v_add_f32 v175, v175, v191
    v_add_f32 v144, v144, v160
    v_add_f32 v145, v145, v161
    v_add_f32 v146, v146, v162
    v_add_f32 v147, v147, v163
    v_mfma_f32_32x32x16_bf16 v[128:143], a[48:51], a[16:19], v[128:143]
    ds_read_b64_tr_b16 a[68:69], v40 offset:4096
    ds_read_b64_tr_b16 a[70:71], v41 offset:6144
    v_add_f32 v148, v148, v164
    v_add_f32 v149, v149, v165
    v_add_f32 v150, v150, v166
    v_add_f32 v151, v151, v167
    v_add_f32 v152, v152, v168
    v_mfma_f32_32x32x16_bf16 v[128:143], a[52:55], a[20:23], v[128:143]
    ds_read_b64_tr_b16 a[76:77], v42 offset:4096
    ds_read_b64_tr_b16 a[78:79], v43 offset:6144
    v_add_f32 v153, v153, v169
    v_add_f32 v154, v154, v170
    v_add_f32 v155, v155, v171
    v_add_f32 v156, v156, v172
    v_add_f32 v157, v157, v173
    v_mfma_f32_32x32x16_bf16 v[128:143], a[56:59], a[24:27], v[128:143]
    ds_read_b64_tr_b16 a[84:85], v44 offset:4096
    ds_read_b64_tr_b16 a[86:87], v45 offset:6144
    v_add_f32 v158, v158, v174
    v_add_f32 v159, v159, v175
    v_max3_f32 v218, v144, v145, v146
    v_max3_f32 v219, v147, v148, v149
    v_max3_f32 v220, v150, v151, v152
    v_mfma_f32_32x32x16_bf16 v[128:143], a[60:63], a[28:31], v[128:143]
    ds_read_b64_tr_b16 a[92:93], v46 offset:4096
    ds_read_b64_tr_b16 a[94:95], v47 offset:6144
    v_max3_f32 v221, v153, v154, v155
    v_max3_f32 v218, v218, v156, v157
    v_max3_f32 v219, v219, v158, v159
    v_max3_f32 v218, v218, v219, v220
    v_max_f32 v218, v218, v221
    v_mov_b32 v219, v218
    s_nop 1
    v_permlane32_swap_b32 v218, v219
    v_max3_f32 v218, v218, v219, v216
    v_sub_f32 v220, v216, v218
    v_mov_b32 v216, v218
    v_exp_f32 v220, v220
    v_sub_f32 v192, v144, v218
    v_sub_f32 v193, v145, v218
    buffer_load_dwordx4 a[196:199], v21, s[32:35], s58 offen nt
    v_sub_f32 v194, v146, v218
    v_sub_f32 v195, v147, v218
    v_sub_f32 v196, v148, v218
    v_sub_f32 v197, v149, v218
    v_sub_f32 v198, v150, v218
    buffer_load_dwordx4 a[200:203], v22, s[32:35], s58 offen nt
    v_sub_f32 v199, v151, v218
    v_sub_f32 v200, v152, v218
    v_sub_f32 v201, v153, v218
    v_sub_f32 v202, v154, v218
    v_sub_f32 v203, v155, v218
    v_sub_f32 v204, v156, v218
    v_sub_f32 v205, v157, v218
    v_sub_f32 v206, v158, v218
    v_sub_f32 v207, v159, v218
    ds_write_b128 v28, v[128:131] offset:16384
    v_exp_f32 v192, v192
    v_exp_f32 v193, v193
    v_exp_f32 v194, v194
    v_exp_f32 v195, v195
    ds_write_b128 v28, v[132:135] offset:17408
    v_exp_f32 v196, v196
    v_exp_f32 v197, v197
    v_exp_f32 v198, v198
    v_exp_f32 v199, v199
    ds_write_b128 v28, v[136:139] offset:18432
    v_exp_f32 v200, v200
    v_exp_f32 v201, v201
    v_exp_f32 v202, v202
    v_exp_f32 v203, v203
    ds_write_b128 v28, v[140:143] offset:19456
    v_exp_f32 v204, v204
    v_exp_f32 v205, v205
    v_exp_f32 v206, v206
    v_exp_f32 v207, v207
    v_mul_f32 v217, v217, v220
    v_cvt_pk_bf16_f32 v208, v192, v193
    v_cvt_pk_bf16_f32 v209, v194, v195
    v_cvt_pk_bf16_f32 v210, v196, v197
    v_cvt_pk_bf16_f32 v211, v198, v199
    v_cvt_pk_bf16_f32 v212, v200, v201
    v_cvt_pk_bf16_f32 v213, v202, v203
    v_cvt_pk_bf16_f32 v214, v204, v205
    v_cvt_pk_bf16_f32 v215, v206, v207
    v_mul_f32 v64, v64, v220
    v_mul_f32 v65, v65, v220
    v_mul_f32 v66, v66, v220
    v_mul_f32 v67, v67, v220
    v_mul_f32 v68, v68, v220
    v_mul_f32 v69, v69, v220
    v_mul_f32 v70, v70, v220
    v_mul_f32 v71, v71, v220
    v_mul_f32 v72, v72, v220
    v_mul_f32 v73, v73, v220
    v_mul_f32 v74, v74, v220
    v_mul_f32 v75, v75, v220
    v_mul_f32 v76, v76, v220
    v_mul_f32 v77, v77, v220
    v_mul_f32 v78, v78, v220
    v_mul_f32 v79, v79, v220
    s_waitcnt lgkmcnt(0)
    s_barrier
    v_mfma_f32_32x32x16_bf16 v[64:79], a[64:67], v[208:211], v[64:79]
    ds_read_b128 v[144:147], v29 offset:16384
    v_mul_f32 v80, v80, v220
    v_mul_f32 v81, v81, v220
    ds_read_b128 v[148:151], v29 offset:17408
    s_waitcnt vmcnt(26)
    ds_write_b128 v26, a[96:99] offset:16384
    buffer_load_dwordx4 a[204:207], v23, s[32:35], s58 offen nt
    s_add_u32 s58, s58, 16384
    v_mul_f32 v82, v82, v220
    v_mul_f32 v83, v83, v220
    ds_read_b128 v[152:155], v29 offset:18432
    v_mul_f32 v84, v84, v220
    v_mfma_f32_32x32x16_bf16 v[64:79], a[68:71], v[212:215], v[64:79]
    v_mul_f32 v85, v85, v220
    ds_read_b128 v[156:159], v29 offset:19456
    v_mul_f32 v86, v86, v220
    s_waitcnt vmcnt(26)
    ds_write_b128 v26, a[100:103] offset:17408
    v_mul_f32 v87, v87, v220
    v_mul_f32 v88, v88, v220
    v_mul_f32 v89, v89, v220
    v_mul_f32 v90, v90, v220
    v_mul_f32 v91, v91, v220
    v_mul_f32 v92, v92, v220
    v_mul_f32 v93, v93, v220
    v_mul_f32 v94, v94, v220
    v_mul_f32 v95, v95, v220
    s_nop 1
    v_mfma_f32_32x32x16_bf16 v[80:95], a[72:75], v[208:211], v[80:95]
    ds_read_b128 v[160:163], v30 offset:16384
    v_mul_f32 v96, v96, v220
    v_mul_f32 v97, v97, v220
    ds_read_b128 v[164:167], v30 offset:17408
    s_waitcnt vmcnt(25)
    ds_write_b128 v26, a[104:107] offset:18432
    buffer_load_dwordx4 a[208:211], v20, s[32:35], s58 offen nt
    v_mul_f32 v98, v98, v220
    v_mul_f32 v99, v99, v220
    ds_read_b128 v[168:171], v30 offset:18432
    v_mul_f32 v100, v100, v220
    v_mfma_f32_32x32x16_bf16 v[80:95], a[76:79], v[212:215], v[80:95]
    v_mul_f32 v101, v101, v220
    ds_read_b128 v[172:175], v30 offset:19456
    v_mul_f32 v102, v102, v220
    s_waitcnt vmcnt(25)
    ds_write_b128 v26, a[108:111] offset:19456
    v_mul_f32 v103, v103, v220
    v_mul_f32 v104, v104, v220
    v_mul_f32 v105, v105, v220
    v_mul_f32 v106, v106, v220
    v_mul_f32 v107, v107, v220
    v_mul_f32 v108, v108, v220
    v_mul_f32 v109, v109, v220
    v_mul_f32 v110, v110, v220
    v_mul_f32 v111, v111, v220
    s_nop 1
    v_mfma_f32_32x32x16_bf16 v[96:111], a[80:83], v[208:211], v[96:111]
    ds_read_b128 v[176:179], v31 offset:16384
    v_mul_f32 v112, v112, v220
    v_mul_f32 v113, v113, v220
    ds_read_b128 v[180:183], v31 offset:17408
    s_waitcnt vmcnt(24)
    ds_write_b128 v26, a[112:115] offset:20480
    v_mul_f32 v114, v114, v220
    v_mul_f32 v115, v115, v220
    ds_read_b128 v[184:187], v31 offset:18432
    v_mul_f32 v116, v116, v220
    v_mfma_f32_32x32x16_bf16 v[96:111], a[84:87], v[212:215], v[96:111]
    v_mul_f32 v117, v117, v220
    ds_read_b128 v[188:191], v31 offset:19456
    v_mul_f32 v118, v118, v220
    s_waitcnt vmcnt(23)
    ds_write_b128 v26, a[116:119] offset:21504
    buffer_load_dwordx4 a[212:215], v21, s[32:35], s58 offen nt
    v_mul_f32 v119, v119, v220
    v_mul_f32 v120, v120, v220
    v_mul_f32 v121, v121, v220
    v_mul_f32 v122, v122, v220
    v_mul_f32 v123, v123, v220
    v_mul_f32 v124, v124, v220
    v_mul_f32 v125, v125, v220
    v_mul_f32 v126, v126, v220
    v_mul_f32 v127, v127, v220
    s_nop 1
    v_mfma_f32_32x32x16_bf16 v[112:127], a[88:91], v[208:211], v[112:127]
    v_add_f32 v192, v192, v200
    v_add_f32 v193, v193, v201
    v_add_f32 v194, v194, v202
    v_add_f32 v195, v195, v203
    s_waitcnt vmcnt(23)
    ds_write_b128 v26, a[120:123] offset:22528
    v_add_f32 v196, v196, v204
    v_add_f32 v197, v197, v205
    v_add_f32 v198, v198, v206
    v_add_f32 v199, v199, v207
    v_mfma_f32_32x32x16_bf16 v[112:127], a[92:95], v[212:215], v[112:127]
    v_add_f32 v192, v192, v196
    v_add_f32 v193, v193, v197
    v_add_f32 v194, v194, v198
    s_waitcnt vmcnt(22)
    ds_write_b128 v26, a[124:127] offset:23552
    v_add_f32 v195, v195, v199
    v_add_f32 v192, v192, v193
    v_add_f32 v194, v194, v195
    v_add_f32 v192, v192, v194
    v_add_f32 v217, v217, v192
    ds_read_b128 a[32:35], v32 offset:16384
    ds_read_b128 a[36:39], v33 offset:16384
    ds_read_b128 a[40:43], v34 offset:16384
    ds_read_b128 a[44:47], v35 offset:16384
    ds_read_b128 a[48:51], v36 offset:16384
    ds_read_b128 a[52:55], v37 offset:16384
    ds_read_b128 a[56:59], v38 offset:16384
    ds_read_b128 a[60:63], v39 offset:16384
    s_waitcnt lgkmcnt(8)
    v_add_f32 v144, v144, v128
    v_add_f32 v145, v145, v129
    v_add_f32 v146, v146, v130
    v_add_f32 v147, v147, v131
    buffer_load_dwordx4 a[216:219], v22, s[32:35], s58 offen nt
    v_add_f32 v148, v148, v132
    v_add_f32 v149, v149, v133
    v_add_f32 v150, v150, v134
    v_add_f32 v151, v151, v135
    v_add_f32 v152, v152, v136
    v_add_f32 v153, v153, v137
    v_add_f32 v154, v154, v138
    v_add_f32 v155, v155, v139
    v_add_f32 v156, v156, v140
    v_add_f32 v157, v157, v141
    v_add_f32 v158, v158, v142
    v_add_f32 v159, v159, v143
    s_waitcnt lgkmcnt(0)
    v_mfma_f32_32x32x16_bf16 v[128:143], a[32:35], a[0:3], 0
    ds_read_b64_tr_b16 a[64:65], v40 offset:8192
    ds_read_b64_tr_b16 a[66:67], v41 offset:10240
    v_add_f32 v160, v160, v176
    v_add_f32 v161, v161, v177
    v_add_f32 v162, v162, v178
    v_add_f32 v163, v163, v179
    v_add_f32 v164, v164, v180
    v_mfma_f32_32x32x16_bf16 v[128:143], a[36:39], a[4:7], v[128:143]
    ds_read_b64_tr_b16 a[72:73], v42 offset:8192
    ds_read_b64_tr_b16 a[74:75], v43 offset:10240
    v_add_f32 v165, v165, v181
    v_add_f32 v166, v166, v182
    v_add_f32 v167, v167, v183
    v_add_f32 v168, v168, v184
    v_add_f32 v169, v169, v185
    v_mfma_f32_32x32x16_bf16 v[128:143], a[40:43], a[8:11], v[128:143]
    ds_read_b64_tr_b16 a[80:81], v44 offset:8192
    ds_read_b64_tr_b16 a[82:83], v45 offset:10240
    v_add_f32 v170, v170, v186
    v_add_f32 v171, v171, v187
    v_add_f32 v172, v172, v188
    v_add_f32 v173, v173, v189
    v_add_f32 v174, v174, v190
    v_mfma_f32_32x32x16_bf16 v[128:143], a[44:47], a[12:15], v[128:143]
    ds_read_b64_tr_b16 a[88:89], v46 offset:8192
    ds_read_b64_tr_b16 a[90:91], v47 offset:10240
    v_add_f32 v175, v175, v191
    v_add_f32 v144, v144, v160
    v_add_f32 v145, v145, v161
    v_add_f32 v146, v146, v162
    v_add_f32 v147, v147, v163
    v_mfma_f32_32x32x16_bf16 v[128:143], a[48:51], a[16:19], v[128:143]
    ds_read_b64_tr_b16 a[68:69], v40 offset:12288
    ds_read_b64_tr_b16 a[70:71], v41 offset:14336
    v_add_f32 v148, v148, v164
    v_add_f32 v149, v149, v165
    v_add_f32 v150, v150, v166
    v_add_f32 v151, v151, v167
    v_add_f32 v152, v152, v168
    v_mfma_f32_32x32x16_bf16 v[128:143], a[52:55], a[20:23], v[128:143]
    ds_read_b64_tr_b16 a[76:77], v42 offset:12288
    ds_read_b64_tr_b16 a[78:79], v43 offset:14336
    v_add_f32 v153, v153, v169
    v_add_f32 v154, v154, v170
    v_add_f32 v155, v155, v171
    v_add_f32 v156, v156, v172
    v_add_f32 v157, v157, v173
    v_mfma_f32_32x32x16_bf16 v[128:143], a[56:59], a[24:27], v[128:143]
    ds_read_b64_tr_b16 a[84:85], v44 offset:12288
    ds_read_b64_tr_b16 a[86:87], v45 offset:14336
    v_add_f32 v158, v158, v174
    v_add_f32 v159, v159, v175
    v_max3_f32 v218, v144, v145, v146
    v_max3_f32 v219, v147, v148, v149
    v_max3_f32 v220, v150, v151, v152
    v_mfma_f32_32x32x16_bf16 v[128:143], a[60:63], a[28:31], v[128:143]
    ds_read_b64_tr_b16 a[92:93], v46 offset:12288
    ds_read_b64_tr_b16 a[94:95], v47 offset:14336
    v_max3_f32 v221, v153, v154, v155
    v_max3_f32 v218, v218, v156, v157
    v_max3_f32 v219, v219, v158, v159
    v_max3_f32 v218, v218, v219, v220
    v_max_f32 v218, v218, v221
    v_mov_b32 v219, v218
    s_nop 1
    v_permlane32_swap_b32 v218, v219
    v_max3_f32 v218, v218, v219, v216
    v_sub_f32 v220, v216, v218
    v_mov_b32 v216, v218
    v_exp_f32 v220, v220
    v_sub_f32 v192, v144, v218
    v_sub_f32 v193, v145, v218
    buffer_load_dwordx4 a[220:223], v23, s[32:35], s58 offen nt
    s_add_u32 s58, s58, 16384
    v_sub_f32 v194, v146, v218
    v_sub_f32 v195, v147, v218
    v_sub_f32 v196, v148, v218
    v_sub_f32 v197, v149, v218
    v_sub_f32 v198, v150, v218
    buffer_load_dwordx4 a[224:227], v20, s[32:35], s58 offen nt
    v_sub_f32 v199, v151, v218
    v_sub_f32 v200, v152, v218
    v_sub_f32 v201, v153, v218
    v_sub_f32 v202, v154, v218
    v_sub_f32 v203, v155, v218
    v_sub_f32 v204, v156, v218
    v_sub_f32 v205, v157, v218
    v_sub_f32 v206, v158, v218
    v_sub_f32 v207, v159, v218
    ds_write_b128 v28, v[128:131] offset:0
    v_exp_f32 v192, v192
    v_exp_f32 v193, v193
    v_exp_f32 v194, v194
    v_exp_f32 v195, v195
    ds_write_b128 v28, v[132:135] offset:1024
    v_exp_f32 v196, v196
    v_exp_f32 v197, v197
    v_exp_f32 v198, v198
    v_exp_f32 v199, v199
    ds_write_b128 v28, v[136:139] offset:2048
    v_exp_f32 v200, v200
    v_exp_f32 v201, v201
    v_exp_f32 v202, v202
    v_exp_f32 v203, v203
    ds_write_b128 v28, v[140:143] offset:3072
    v_exp_f32 v204, v204
    v_exp_f32 v205, v205
    v_exp_f32 v206, v206
    v_exp_f32 v207, v207
    v_mul_f32 v217, v217, v220
    v_cvt_pk_bf16_f32 v208, v192, v193
    v_cvt_pk_bf16_f32 v209, v194, v195
    v_cvt_pk_bf16_f32 v210, v196, v197
    v_cvt_pk_bf16_f32 v211, v198, v199
    v_cvt_pk_bf16_f32 v212, v200, v201
    v_cvt_pk_bf16_f32 v213, v202, v203
    v_cvt_pk_bf16_f32 v214, v204, v205
    v_cvt_pk_bf16_f32 v215, v206, v207
    v_mul_f32 v64, v64, v220
    v_mul_f32 v65, v65, v220
    v_mul_f32 v66, v66, v220
    v_mul_f32 v67, v67, v220
    v_mul_f32 v68, v68, v220
    v_mul_f32 v69, v69, v220
    v_mul_f32 v70, v70, v220
    v_mul_f32 v71, v71, v220
    v_mul_f32 v72, v72, v220
    v_mul_f32 v73, v73, v220
    v_mul_f32 v74, v74, v220
    v_mul_f32 v75, v75, v220
    v_mul_f32 v76, v76, v220
    v_mul_f32 v77, v77, v220
    v_mul_f32 v78, v78, v220
    v_mul_f32 v79, v79, v220
    s_waitcnt lgkmcnt(0)
    s_barrier
    v_mfma_f32_32x32x16_bf16 v[64:79], a[64:67], v[208:211], v[64:79]
    ds_read_b128 v[144:147], v29 offset:0
    v_mul_f32 v80, v80, v220
    v_mul_f32 v81, v81, v220
    ds_read_b128 v[148:151], v29 offset:1024
    s_waitcnt vmcnt(24)
    ds_write_b128 v26, a[128:131] offset:24576
    buffer_load_dwordx4 a[228:231], v21, s[32:35], s58 offen nt
    v_mul_f32 v82, v82, v220
    v_mul_f32 v83, v83, v220
    ds_read_b128 v[152:155], v29 offset:2048
    v_mul_f32 v84, v84, v220
    v_mfma_f32_32x32x16_bf16 v[64:79], a[68:71], v[212:215], v[64:79]
    v_mul_f32 v85, v85, v220
    ds_read_b128 v[156:159], v29 offset:3072
    v_mul_f32 v86, v86, v220
    s_waitcnt vmcnt(24)
    ds_write_b128 v26, a[132:135] offset:25600
    v_mul_f32 v87, v87, v220
    v_mul_f32 v88, v88, v220
    v_mul_f32 v89, v89, v220
    v_mul_f32 v90, v90, v220
    v_mul_f32 v91, v91, v220
    v_mul_f32 v92, v92, v220
    v_mul_f32 v93, v93, v220
    v_mul_f32 v94, v94, v220
    v_mul_f32 v95, v95, v220
    s_nop 1
    v_mfma_f32_32x32x16_bf16 v[80:95], a[72:75], v[208:211], v[80:95]
    ds_read_b128 v[160:163], v30 offset:0
    v_mul_f32 v96, v96, v220
    v_mul_f32 v97, v97, v220
    ds_read_b128 v[164:167], v30 offset:1024
    s_waitcnt vmcnt(23)
    ds_write_b128 v26, a[136:139] offset:26624
    buffer_load_dwordx4 a[232:235], v22, s[32:35], s58 offen nt
    v_mul_f32 v98, v98, v220
    v_mul_f32 v99, v99, v220
    ds_read_b128 v[168:171], v30 offset:2048
    v_mul_f32 v100, v100, v220
    v_mfma_f32_32x32x16_bf16 v[80:95], a[76:79], v[212:215], v[80:95]
    v_mul_f32 v101, v101, v220
    ds_read_b128 v[172:175], v30 offset:3072
    v_mul_f32 v102, v102, v220
    s_waitcnt vmcnt(23)
    ds_write_b128 v26, a[140:143] offset:27648
    v_mul_f32 v103, v103, v220
    v_mul_f32 v104, v104, v220
    v_mul_f32 v105, v105, v220
    v_mul_f32 v106, v106, v220
    v_mul_f32 v107, v107, v220
    v_mul_f32 v108, v108, v220
    v_mul_f32 v109, v109, v220
    v_mul_f32 v110, v110, v220
    v_mul_f32 v111, v111, v220
    s_nop 1
    v_mfma_f32_32x32x16_bf16 v[96:111], a[80:83], v[208:211], v[96:111]
    ds_read_b128 v[176:179], v31 offset:0
    v_mul_f32 v112, v112, v220
    v_mul_f32 v113, v113, v220
    ds_read_b128 v[180:183], v31 offset:1024
    s_waitcnt vmcnt(22)
    ds_write_b128 v26, a[144:147] offset:28672
    v_mul_f32 v114, v114, v220
    v_mul_f32 v115, v115, v220
    ds_read_b128 v[184:187], v31 offset:2048
    v_mul_f32 v116, v116, v220
    v_mfma_f32_32x32x16_bf16 v[96:111], a[84:87], v[212:215], v[96:111]
    v_mul_f32 v117, v117, v220
    ds_read_b128 v[188:191], v31 offset:3072
    v_mul_f32 v118, v118, v220
    s_waitcnt vmcnt(21)
    ds_write_b128 v26, a[148:151] offset:29696
    buffer_load_dwordx4 a[236:239], v23, s[32:35], s58 offen nt
    s_add_u32 s58, s58, 16384
    v_mul_f32 v119, v119, v220
    v_mul_f32 v120, v120, v220
    v_mul_f32 v121, v121, v220
    v_mul_f32 v122, v122, v220
    v_mul_f32 v123, v123, v220
    v_mul_f32 v124, v124, v220
    v_mul_f32 v125, v125, v220
    v_mul_f32 v126, v126, v220
    v_mul_f32 v127, v127, v220
    s_nop 1
    v_mfma_f32_32x32x16_bf16 v[112:127], a[88:91], v[208:211], v[112:127]
    v_add_f32 v192, v192, v200
    v_add_f32 v193, v193, v201
    v_add_f32 v194, v194, v202
    v_add_f32 v195, v195, v203
    s_waitcnt vmcnt(21)
    ds_write_b128 v26, a[152:155] offset:30720
    v_add_f32 v196, v196, v204
    v_add_f32 v197, v197, v205
    v_add_f32 v198, v198, v206
    v_add_f32 v199, v199, v207
    v_mfma_f32_32x32x16_bf16 v[112:127], a[92:95], v[212:215], v[112:127]
    v_add_f32 v192, v192, v196
    v_add_f32 v193, v193, v197
    v_add_f32 v194, v194, v198
    s_waitcnt vmcnt(20)
    ds_write_b128 v26, a[156:159] offset:31744
    v_add_f32 v195, v195, v199
    v_add_f32 v192, v192, v193
    v_add_f32 v194, v194, v195
    v_add_f32 v192, v192, v194
    v_add_f32 v217, v217, v192
    ds_read_b128 a[32:35], v32 offset:24576
    ds_read_b128 a[36:39], v33 offset:24576
    ds_read_b128 a[40:43], v34 offset:24576
    ds_read_b128 a[44:47], v35 offset:24576
    ds_read_b128 a[48:51], v36 offset:24576
    ds_read_b128 a[52:55], v37 offset:24576
    ds_read_b128 a[56:59], v38 offset:24576
    ds_read_b128 a[60:63], v39 offset:24576
    s_waitcnt lgkmcnt(8)
    v_add_f32 v144, v144, v128
    v_add_f32 v145, v145, v129
    v_add_f32 v146, v146, v130
    v_add_f32 v147, v147, v131
    buffer_load_dwordx4 a[240:243], v20, s[32:35], s58 offen nt
    v_add_f32 v148, v148, v132
    v_add_f32 v149, v149, v133
    v_add_f32 v150, v150, v134
    v_add_f32 v151, v151, v135
    v_add_f32 v152, v152, v136
    v_add_f32 v153, v153, v137
    v_add_f32 v154, v154, v138
    v_add_f32 v155, v155, v139
    v_add_f32 v156, v156, v140
    v_add_f32 v157, v157, v141
    v_add_f32 v158, v158, v142
    v_add_f32 v159, v159, v143
    s_waitcnt lgkmcnt(0)
    v_mfma_f32_32x32x16_bf16 v[128:143], a[32:35], a[0:3], 0
    ds_read_b64_tr_b16 a[64:65], v40 offset:16384
    ds_read_b64_tr_b16 a[66:67], v41 offset:18432
    v_add_f32 v160, v160, v176
    v_add_f32 v161, v161, v177
    v_add_f32 v162, v162, v178
    v_add_f32 v163, v163, v179
    v_add_f32 v164, v164, v180
    v_mfma_f32_32x32x16_bf16 v[128:143], a[36:39], a[4:7], v[128:143]
    ds_read_b64_tr_b16 a[72:73], v42 offset:16384
    ds_read_b64_tr_b16 a[74:75], v43 offset:18432
    v_add_f32 v165, v165, v181
    v_add_f32 v166, v166, v182
    v_add_f32 v167, v167, v183
    v_add_f32 v168, v168, v184
    v_add_f32 v169, v169, v185
    v_mfma_f32_32x32x16_bf16 v[128:143], a[40:43], a[8:11], v[128:143]
    ds_read_b64_tr_b16 a[80:81], v44 offset:16384
    ds_read_b64_tr_b16 a[82:83], v45 offset:18432
    v_add_f32 v170, v170, v186
    v_add_f32 v171, v171, v187
    v_add_f32 v172, v172, v188
    v_add_f32 v173, v173, v189
    v_add_f32 v174, v174, v190
    v_mfma_f32_32x32x16_bf16 v[128:143], a[44:47], a[12:15], v[128:143]
    ds_read_b64_tr_b16 a[88:89], v46 offset:16384
    ds_read_b64_tr_b16 a[90:91], v47 offset:18432
    v_add_f32 v175, v175, v191
    v_add_f32 v144, v144, v160
    v_add_f32 v145, v145, v161
    v_add_f32 v146, v146, v162
    v_add_f32 v147, v147, v163
    v_mfma_f32_32x32x16_bf16 v[128:143], a[48:51], a[16:19], v[128:143]
    ds_read_b64_tr_b16 a[68:69], v40 offset:20480
    ds_read_b64_tr_b16 a[70:71], v41 offset:22528
    v_add_f32 v148, v148, v164
    v_add_f32 v149, v149, v165
    v_add_f32 v150, v150, v166
    v_add_f32 v151, v151, v167
    v_add_f32 v152, v152, v168
    v_mfma_f32_32x32x16_bf16 v[128:143], a[52:55], a[20:23], v[128:143]
    ds_read_b64_tr_b16 a[76:77], v42 offset:20480
    ds_read_b64_tr_b16 a[78:79], v43 offset:22528
    v_add_f32 v153, v153, v169
    v_add_f32 v154, v154, v170
    v_add_f32 v155, v155, v171
    v_add_f32 v156, v156, v172
    v_add_f32 v157, v157, v173
    v_mfma_f32_32x32x16_bf16 v[128:143], a[56:59], a[24:27], v[128:143]
    ds_read_b64_tr_b16 a[84:85], v44 offset:20480
    ds_read_b64_tr_b16 a[86:87], v45 offset:22528
    v_add_f32 v158, v158, v174
    v_add_f32 v159, v159, v175
    v_max3_f32 v218, v144, v145, v146
    v_max3_f32 v219, v147, v148, v149
    v_max3_f32 v220, v150, v151, v152
    v_mfma_f32_32x32x16_bf16 v[128:143], a[60:63], a[28:31], v[128:143]
    ds_read_b64_tr_b16 a[92:93], v46 offset:20480
    ds_read_b64_tr_b16 a[94:95], v47 offset:22528
    v_max3_f32 v221, v153, v154, v155
    v_max3_f32 v218, v218, v156, v157
    v_max3_f32 v219, v219, v158, v159
    v_max3_f32 v218, v218, v219, v220
    v_max_f32 v218, v218, v221
    v_mov_b32 v219, v218
    s_nop 1
    v_permlane32_swap_b32 v218, v219
    v_max3_f32 v218, v218, v219, v216
    v_sub_f32 v220, v216, v218
    v_mov_b32 v216, v218
    v_exp_f32 v220, v220
    v_sub_f32 v192, v144, v218
    v_sub_f32 v193, v145, v218
    buffer_load_dwordx4 a[244:247], v21, s[32:35], s58 offen nt
    v_sub_f32 v194, v146, v218
    v_sub_f32 v195, v147, v218
    v_sub_f32 v196, v148, v218
    v_sub_f32 v197, v149, v218
    v_sub_f32 v198, v150, v218
    buffer_load_dwordx4 a[248:251], v22, s[32:35], s58 offen nt
    v_sub_f32 v199, v151, v218
    v_sub_f32 v200, v152, v218
    v_sub_f32 v201, v153, v218
    v_sub_f32 v202, v154, v218
    v_sub_f32 v203, v155, v218
    v_sub_f32 v204, v156, v218
    v_sub_f32 v205, v157, v218
    v_sub_f32 v206, v158, v218
    v_sub_f32 v207, v159, v218
    ds_write_b128 v28, v[128:131] offset:16384
    v_exp_f32 v192, v192
    v_exp_f32 v193, v193
    v_exp_f32 v194, v194
    v_exp_f32 v195, v195
    ds_write_b128 v28, v[132:135] offset:17408
    v_exp_f32 v196, v196
    v_exp_f32 v197, v197
    v_exp_f32 v198, v198
    v_exp_f32 v199, v199
    ds_write_b128 v28, v[136:139] offset:18432
    v_exp_f32 v200, v200
    v_exp_f32 v201, v201
    v_exp_f32 v202, v202
    v_exp_f32 v203, v203
    ds_write_b128 v28, v[140:143] offset:19456
    v_exp_f32 v204, v204
    v_exp_f32 v205, v205
    v_exp_f32 v206, v206
    v_exp_f32 v207, v207
    v_mul_f32 v217, v217, v220
    v_cvt_pk_bf16_f32 v208, v192, v193
    v_cvt_pk_bf16_f32 v209, v194, v195
    v_cvt_pk_bf16_f32 v210, v196, v197
    v_cvt_pk_bf16_f32 v211, v198, v199
    v_cvt_pk_bf16_f32 v212, v200, v201
    v_cvt_pk_bf16_f32 v213, v202, v203
    v_cvt_pk_bf16_f32 v214, v204, v205
    v_cvt_pk_bf16_f32 v215, v206, v207
    v_mul_f32 v64, v64, v220
    v_mul_f32 v65, v65, v220
    v_mul_f32 v66, v66, v220
    v_mul_f32 v67, v67, v220
    v_mul_f32 v68, v68, v220
    v_mul_f32 v69, v69, v220
    v_mul_f32 v70, v70, v220
    v_mul_f32 v71, v71, v220
    v_mul_f32 v72, v72, v220
    v_mul_f32 v73, v73, v220
    v_mul_f32 v74, v74, v220
    v_mul_f32 v75, v75, v220
    v_mul_f32 v76, v76, v220
    v_mul_f32 v77, v77, v220
    v_mul_f32 v78, v78, v220
    v_mul_f32 v79, v79, v220
    s_waitcnt lgkmcnt(0)
    s_barrier
    v_mfma_f32_32x32x16_bf16 v[64:79], a[64:67], v[208:211], v[64:79]
    ds_read_b128 v[144:147], v29 offset:16384
    v_mul_f32 v80, v80, v220
    v_mul_f32 v81, v81, v220
    ds_read_b128 v[148:151], v29 offset:17408
    s_waitcnt vmcnt(22)
    ds_write_b128 v26, a[160:163] offset:0
    buffer_load_dwordx4 a[252:255], v23, s[32:35], s58 offen nt
    s_add_u32 s58, s58, 16384
    v_mul_f32 v82, v82, v220
    v_mul_f32 v83, v83, v220
    ds_read_b128 v[152:155], v29 offset:18432
    v_mul_f32 v84, v84, v220
    v_mfma_f32_32x32x16_bf16 v[64:79], a[68:71], v[212:215], v[64:79]
    v_mul_f32 v85, v85, v220
    ds_read_b128 v[156:159], v29 offset:19456
    v_mul_f32 v86, v86, v220
    s_waitcnt vmcnt(22)
    ds_write_b128 v26, a[164:167] offset:1024
    v_mul_f32 v87, v87, v220
    v_mul_f32 v88, v88, v220
    v_mul_f32 v89, v89, v220
    v_mul_f32 v90, v90, v220
    v_mul_f32 v91, v91, v220
    v_mul_f32 v92, v92, v220
    v_mul_f32 v93, v93, v220
    v_mul_f32 v94, v94, v220
    v_mul_f32 v95, v95, v220
    s_nop 1
    v_mfma_f32_32x32x16_bf16 v[80:95], a[72:75], v[208:211], v[80:95]
    ds_read_b128 v[160:163], v30 offset:16384
    v_mul_f32 v96, v96, v220
    v_mul_f32 v97, v97, v220
    ds_read_b128 v[164:167], v30 offset:17408
    s_waitcnt vmcnt(21)
    ds_write_b128 v26, a[168:171] offset:2048
    buffer_load_dwordx4 v[224:227], v20, s[32:35], s58 offen nt
    v_mul_f32 v98, v98, v220
    v_mul_f32 v99, v99, v220
    ds_read_b128 v[168:171], v30 offset:18432
    v_mul_f32 v100, v100, v220
    v_mfma_f32_32x32x16_bf16 v[80:95], a[76:79], v[212:215], v[80:95]
    v_mul_f32 v101, v101, v220
    ds_read_b128 v[172:175], v30 offset:19456
    v_mul_f32 v102, v102, v220
    s_waitcnt vmcnt(21)
    ds_write_b128 v26, a[172:175] offset:3072
    v_mul_f32 v103, v103, v220
    v_mul_f32 v104, v104, v220
    v_mul_f32 v105, v105, v220
    v_mul_f32 v106, v106, v220
    v_mul_f32 v107, v107, v220
    v_mul_f32 v108, v108, v220
    v_mul_f32 v109, v109, v220
    v_mul_f32 v110, v110, v220
    v_mul_f32 v111, v111, v220
    s_nop 1
    v_mfma_f32_32x32x16_bf16 v[96:111], a[80:83], v[208:211], v[96:111]
    ds_read_b128 v[176:179], v31 offset:16384
    v_mul_f32 v112, v112, v220
    v_mul_f32 v113, v113, v220
    ds_read_b128 v[180:183], v31 offset:17408
    s_waitcnt vmcnt(20)
    ds_write_b128 v26, a[176:179] offset:4096
    v_mul_f32 v114, v114, v220
    v_mul_f32 v115, v115, v220
    ds_read_b128 v[184:187], v31 offset:18432
    v_mul_f32 v116, v116, v220
    v_mfma_f32_32x32x16_bf16 v[96:111], a[84:87], v[212:215], v[96:111]
    v_mul_f32 v117, v117, v220
    ds_read_b128 v[188:191], v31 offset:19456
    v_mul_f32 v118, v118, v220
    s_waitcnt vmcnt(19)
    ds_write_b128 v26, a[180:183] offset:5120
    buffer_load_dwordx4 v[228:231], v21, s[32:35], s58 offen nt
    v_mul_f32 v119, v119, v220
    v_mul_f32 v120, v120, v220
    v_mul_f32 v121, v121, v220
    v_mul_f32 v122, v122, v220
    v_mul_f32 v123, v123, v220
    v_mul_f32 v124, v124, v220
    v_mul_f32 v125, v125, v220
    v_mul_f32 v126, v126, v220
    v_mul_f32 v127, v127, v220
    s_nop 1
    v_mfma_f32_32x32x16_bf16 v[112:127], a[88:91], v[208:211], v[112:127]
    v_add_f32 v192, v192, v200
    v_add_f32 v193, v193, v201
    v_add_f32 v194, v194, v202
    v_add_f32 v195, v195, v203
    s_waitcnt vmcnt(19)
    ds_write_b128 v26, a[184:187] offset:6144
    v_add_f32 v196, v196, v204
    v_add_f32 v197, v197, v205
    v_add_f32 v198, v198, v206
    v_add_f32 v199, v199, v207
    v_mfma_f32_32x32x16_bf16 v[112:127], a[92:95], v[212:215], v[112:127]
    v_add_f32 v192, v192, v196
    v_add_f32 v193, v193, v197
    v_add_f32 v194, v194, v198
    s_waitcnt vmcnt(18)
    ds_write_b128 v26, a[188:191] offset:7168
    v_add_f32 v195, v195, v199
    v_add_f32 v192, v192, v193
    v_add_f32 v194, v194, v195
    v_add_f32 v192, v192, v194
    v_add_f32 v217, v217, v192
    ds_read_b128 a[32:35], v32 offset:0
    ds_read_b128 a[36:39], v33 offset:0
    ds_read_b128 a[40:43], v34 offset:0
    ds_read_b128 a[44:47], v35 offset:0
    ds_read_b128 a[48:51], v36 offset:0
    ds_read_b128 a[52:55], v37 offset:0
    ds_read_b128 a[56:59], v38 offset:0
    ds_read_b128 a[60:63], v39 offset:0
    s_waitcnt lgkmcnt(8)
    v_add_f32 v144, v144, v128
    v_add_f32 v145, v145, v129
    v_add_f32 v146, v146, v130
    v_add_f32 v147, v147, v131
    buffer_load_dwordx4 v[232:235], v22, s[32:35], s58 offen nt
    v_add_f32 v148, v148, v132
    v_add_f32 v149, v149, v133
    v_add_f32 v150, v150, v134
    v_add_f32 v151, v151, v135
    v_add_f32 v152, v152, v136
    v_add_f32 v153, v153, v137
    v_add_f32 v154, v154, v138
    v_add_f32 v155, v155, v139
    v_add_f32 v156, v156, v140
    v_add_f32 v157, v157, v141
    v_add_f32 v158, v158, v142
    v_add_f32 v159, v159, v143
    s_waitcnt lgkmcnt(0)
    v_mfma_f32_32x32x16_bf16 v[128:143], a[32:35], a[0:3], 0
    ds_read_b64_tr_b16 a[64:65], v40 offset:24576
    ds_read_b64_tr_b16 a[66:67], v41 offset:26624
    v_add_f32 v160, v160, v176
    v_add_f32 v161, v161, v177
    v_add_f32 v162, v162, v178
    v_add_f32 v163, v163, v179
    v_add_f32 v164, v164, v180
    v_mfma_f32_32x32x16_bf16 v[128:143], a[36:39], a[4:7], v[128:143]
    ds_read_b64_tr_b16 a[72:73], v42 offset:24576
    ds_read_b64_tr_b16 a[74:75], v43 offset:26624
    v_add_f32 v165, v165, v181
    v_add_f32 v166, v166, v182
    v_add_f32 v167, v167, v183
    v_add_f32 v168, v168, v184
    v_add_f32 v169, v169, v185
    v_mfma_f32_32x32x16_bf16 v[128:143], a[40:43], a[8:11], v[128:143]
    ds_read_b64_tr_b16 a[80:81], v44 offset:24576
    ds_read_b64_tr_b16 a[82:83], v45 offset:26624
    v_add_f32 v170, v170, v186
    v_add_f32 v171, v171, v187
    v_add_f32 v172, v172, v188
    v_add_f32 v173, v173, v189
    v_add_f32 v174, v174, v190
    v_mfma_f32_32x32x16_bf16 v[128:143], a[44:47], a[12:15], v[128:143]
    ds_read_b64_tr_b16 a[88:89], v46 offset:24576
    ds_read_b64_tr_b16 a[90:91], v47 offset:26624
    v_add_f32 v175, v175, v191
    v_add_f32 v144, v144, v160
    v_add_f32 v145, v145, v161
    v_add_f32 v146, v146, v162
    v_add_f32 v147, v147, v163
    v_mfma_f32_32x32x16_bf16 v[128:143], a[48:51], a[16:19], v[128:143]
    ds_read_b64_tr_b16 a[68:69], v40 offset:28672
    ds_read_b64_tr_b16 a[70:71], v41 offset:30720
    v_add_f32 v148, v148, v164
    v_add_f32 v149, v149, v165
    v_add_f32 v150, v150, v166
    v_add_f32 v151, v151, v167
    v_add_f32 v152, v152, v168
    v_mfma_f32_32x32x16_bf16 v[128:143], a[52:55], a[20:23], v[128:143]
    ds_read_b64_tr_b16 a[76:77], v42 offset:28672
    ds_read_b64_tr_b16 a[78:79], v43 offset:30720
    v_add_f32 v153, v153, v169
    v_add_f32 v154, v154, v170
    v_add_f32 v155, v155, v171
    v_add_f32 v156, v156, v172
    v_add_f32 v157, v157, v173
    v_mfma_f32_32x32x16_bf16 v[128:143], a[56:59], a[24:27], v[128:143]
    ds_read_b64_tr_b16 a[84:85], v44 offset:28672
    ds_read_b64_tr_b16 a[86:87], v45 offset:30720
    v_add_f32 v158, v158, v174
    v_add_f32 v159, v159, v175
    v_max3_f32 v218, v144, v145, v146
    v_max3_f32 v219, v147, v148, v149
    v_max3_f32 v220, v150, v151, v152
    v_mfma_f32_32x32x16_bf16 v[128:143], a[60:63], a[28:31], v[128:143]
    ds_read_b64_tr_b16 a[92:93], v46 offset:28672
    ds_read_b64_tr_b16 a[94:95], v47 offset:30720
    v_max3_f32 v221, v153, v154, v155
    v_max3_f32 v218, v218, v156, v157
    v_max3_f32 v219, v219, v158, v159
    v_max3_f32 v218, v218, v219, v220
    v_max_f32 v218, v218, v221
    v_mov_b32 v219, v218
    s_nop 1
    v_permlane32_swap_b32 v218, v219
    v_max3_f32 v218, v218, v219, v216
    v_sub_f32 v220, v216, v218
    v_mov_b32 v216, v218
    v_exp_f32 v220, v220
    v_sub_f32 v192, v144, v218
    v_sub_f32 v193, v145, v218
    buffer_load_dwordx4 v[236:239], v23, s[32:35], s58 offen nt
    s_add_u32 s58, s58, 16384
    v_sub_f32 v194, v146, v218
    v_sub_f32 v195, v147, v218
    v_sub_f32 v196, v148, v218
    v_sub_f32 v197, v149, v218
    v_sub_f32 v198, v150, v218
    buffer_load_dwordx4 v[240:243], v20, s[32:35], s58 offen nt
    v_sub_f32 v199, v151, v218
    v_sub_f32 v200, v152, v218
    v_sub_f32 v201, v153, v218
    v_sub_f32 v202, v154, v218
    v_sub_f32 v203, v155, v218
    v_sub_f32 v204, v156, v218
    v_sub_f32 v205, v157, v218
    v_sub_f32 v206, v158, v218
    v_sub_f32 v207, v159, v218
    ds_write_b128 v28, v[128:131] offset:0
    v_exp_f32 v192, v192
    v_exp_f32 v193, v193
    v_exp_f32 v194, v194
    v_exp_f32 v195, v195
    ds_write_b128 v28, v[132:135] offset:1024
    v_exp_f32 v196, v196
    v_exp_f32 v197, v197
    v_exp_f32 v198, v198
    v_exp_f32 v199, v199
    ds_write_b128 v28, v[136:139] offset:2048
    v_exp_f32 v200, v200
    v_exp_f32 v201, v201
    v_exp_f32 v202, v202
    v_exp_f32 v203, v203
    ds_write_b128 v28, v[140:143] offset:3072
    v_exp_f32 v204, v204
    v_exp_f32 v205, v205
    v_exp_f32 v206, v206
    v_exp_f32 v207, v207
    v_mul_f32 v217, v217, v220
    v_cvt_pk_bf16_f32 v208, v192, v193
    v_cvt_pk_bf16_f32 v209, v194, v195
    v_cvt_pk_bf16_f32 v210, v196, v197
    v_cvt_pk_bf16_f32 v211, v198, v199
    v_cvt_pk_bf16_f32 v212, v200, v201
    v_cvt_pk_bf16_f32 v213, v202, v203
    v_cvt_pk_bf16_f32 v214, v204, v205
    v_cvt_pk_bf16_f32 v215, v206, v207
    v_mul_f32 v64, v64, v220
    v_mul_f32 v65, v65, v220
    v_mul_f32 v66, v66, v220
    v_mul_f32 v67, v67, v220
    v_mul_f32 v68, v68, v220
    v_mul_f32 v69, v69, v220
    v_mul_f32 v70, v70, v220
    v_mul_f32 v71, v71, v220
    v_mul_f32 v72, v72, v220
    v_mul_f32 v73, v73, v220
    v_mul_f32 v74, v74, v220
    v_mul_f32 v75, v75, v220
    v_mul_f32 v76, v76, v220
    v_mul_f32 v77, v77, v220
    v_mul_f32 v78, v78, v220
    v_mul_f32 v79, v79, v220
    s_waitcnt lgkmcnt(0)
    s_barrier
    v_mfma_f32_32x32x16_bf16 v[64:79], a[64:67], v[208:211], v[64:79]
    ds_read_b128 v[144:147], v29 offset:0
    v_mul_f32 v80, v80, v220
    v_mul_f32 v81, v81, v220
    ds_read_b128 v[148:151], v29 offset:1024
    s_waitcnt vmcnt(20)
    ds_write_b128 v26, a[192:195] offset:8192
    buffer_load_dwordx4 v[244:247], v21, s[32:35], s58 offen nt
    v_mul_f32 v82, v82, v220
    v_mul_f32 v83, v83, v220
    ds_read_b128 v[152:155], v29 offset:2048
    v_mul_f32 v84, v84, v220
    v_mfma_f32_32x32x16_bf16 v[64:79], a[68:71], v[212:215], v[64:79]
    v_mul_f32 v85, v85, v220
    ds_read_b128 v[156:159], v29 offset:3072
    v_mul_f32 v86, v86, v220
    s_waitcnt vmcnt(20)
    ds_write_b128 v26, a[196:199] offset:9216
    v_mul_f32 v87, v87, v220
    v_mul_f32 v88, v88, v220
    v_mul_f32 v89, v89, v220
    v_mul_f32 v90, v90, v220
    v_mul_f32 v91, v91, v220
    v_mul_f32 v92, v92, v220
    v_mul_f32 v93, v93, v220
    v_mul_f32 v94, v94, v220
    v_mul_f32 v95, v95, v220
    s_nop 1
    v_mfma_f32_32x32x16_bf16 v[80:95], a[72:75], v[208:211], v[80:95]
    ds_read_b128 v[160:163], v30 offset:0
    v_mul_f32 v96, v96, v220
    v_mul_f32 v97, v97, v220
    ds_read_b128 v[164:167], v30 offset:1024
    s_waitcnt vmcnt(19)
    ds_write_b128 v26, a[200:203] offset:10240
    buffer_load_dwordx4 v[248:251], v22, s[32:35], s58 offen nt
    v_mul_f32 v98, v98, v220
    v_mul_f32 v99, v99, v220
    ds_read_b128 v[168:171], v30 offset:2048
    v_mul_f32 v100, v100, v220
    v_mfma_f32_32x32x16_bf16 v[80:95], a[76:79], v[212:215], v[80:95]
    v_mul_f32 v101, v101, v220
    ds_read_b128 v[172:175], v30 offset:3072
    v_mul_f32 v102, v102, v220
    s_waitcnt vmcnt(19)
    ds_write_b128 v26, a[204:207] offset:11264
    v_mul_f32 v103, v103, v220
    v_mul_f32 v104, v104, v220
    v_mul_f32 v105, v105, v220
    v_mul_f32 v106, v106, v220
    v_mul_f32 v107, v107, v220
    v_mul_f32 v108, v108, v220
    v_mul_f32 v109, v109, v220
    v_mul_f32 v110, v110, v220
    v_mul_f32 v111, v111, v220
    s_nop 1
    v_mfma_f32_32x32x16_bf16 v[96:111], a[80:83], v[208:211], v[96:111]
    ds_read_b128 v[176:179], v31 offset:0
    v_mul_f32 v112, v112, v220
    v_mul_f32 v113, v113, v220
    ds_read_b128 v[180:183], v31 offset:1024
    s_waitcnt vmcnt(18)
    ds_write_b128 v26, a[208:211] offset:12288
    v_mul_f32 v114, v114, v220
    v_mul_f32 v115, v115, v220
    ds_read_b128 v[184:187], v31 offset:2048
    v_mul_f32 v116, v116, v220
    v_mfma_f32_32x32x16_bf16 v[96:111], a[84:87], v[212:215], v[96:111]
    v_mul_f32 v117, v117, v220
    ds_read_b128 v[188:191], v31 offset:3072
    v_mul_f32 v118, v118, v220
    s_waitcnt vmcnt(17)
    ds_write_b128 v26, a[212:215] offset:13312
    buffer_load_dwordx4 v[252:255], v23, s[32:35], s58 offen nt
    s_add_u32 s58, s58, 16384
    v_mul_f32 v119, v119, v220
    v_mul_f32 v120, v120, v220
    v_mul_f32 v121, v121, v220
    v_mul_f32 v122, v122, v220
    v_mul_f32 v123, v123, v220
    v_mul_f32 v124, v124, v220
    v_mul_f32 v125, v125, v220
    v_mul_f32 v126, v126, v220
    v_mul_f32 v127, v127, v220
    s_nop 1
    v_mfma_f32_32x32x16_bf16 v[112:127], a[88:91], v[208:211], v[112:127]
    v_add_f32 v192, v192, v200
    v_add_f32 v193, v193, v201
    v_add_f32 v194, v194, v202
    v_add_f32 v195, v195, v203
    s_waitcnt vmcnt(17)
    ds_write_b128 v26, a[216:219] offset:14336
    v_add_f32 v196, v196, v204
    v_add_f32 v197, v197, v205
    v_add_f32 v198, v198, v206
    v_add_f32 v199, v199, v207
    v_mfma_f32_32x32x16_bf16 v[112:127], a[92:95], v[212:215], v[112:127]
    v_add_f32 v192, v192, v196
    v_add_f32 v193, v193, v197
    v_add_f32 v194, v194, v198
    s_waitcnt vmcnt(16)
    ds_write_b128 v26, a[220:223] offset:15360
    v_add_f32 v195, v195, v199
    v_add_f32 v192, v192, v193
    v_add_f32 v194, v194, v195
    v_add_f32 v192, v192, v194
    v_add_f32 v217, v217, v192
    ds_read_b128 a[32:35], v32 offset:8192
    ds_read_b128 a[36:39], v33 offset:8192
    ds_read_b128 a[40:43], v34 offset:8192
    ds_read_b128 a[44:47], v35 offset:8192
    ds_read_b128 a[48:51], v36 offset:8192
    ds_read_b128 a[52:55], v37 offset:8192
    ds_read_b128 a[56:59], v38 offset:8192
    ds_read_b128 a[60:63], v39 offset:8192
    s_waitcnt lgkmcnt(8)
    v_add_f32 v144, v144, v128
    v_add_f32 v145, v145, v129
    v_add_f32 v146, v146, v130
    v_add_f32 v147, v147, v131
    v_add_f32 v148, v148, v132
    v_add_f32 v149, v149, v133
    v_add_f32 v150, v150, v134
    v_add_f32 v151, v151, v135
    v_add_f32 v152, v152, v136
    v_add_f32 v153, v153, v137
    v_add_f32 v154, v154, v138
    v_add_f32 v155, v155, v139
    v_add_f32 v156, v156, v140
    v_add_f32 v157, v157, v141
    v_add_f32 v158, v158, v142
    v_add_f32 v159, v159, v143
    s_waitcnt lgkmcnt(0)
    v_mfma_f32_32x32x16_bf16 v[128:143], a[32:35], a[0:3], 0
    ds_read_b64_tr_b16 a[64:65], v40 offset:0
    ds_read_b64_tr_b16 a[66:67], v41 offset:2048
    v_add_f32 v160, v160, v176
    v_add_f32 v161, v161, v177
    v_add_f32 v162, v162, v178
    v_add_f32 v163, v163, v179
    v_add_f32 v164, v164, v180
    v_mfma_f32_32x32x16_bf16 v[128:143], a[36:39], a[4:7], v[128:143]
    ds_read_b64_tr_b16 a[72:73], v42 offset:0
    ds_read_b64_tr_b16 a[74:75], v43 offset:2048
    v_add_f32 v165, v165, v181
    v_add_f32 v166, v166, v182
    v_add_f32 v167, v167, v183
    v_add_f32 v168, v168, v184
    v_add_f32 v169, v169, v185
    v_mfma_f32_32x32x16_bf16 v[128:143], a[40:43], a[8:11], v[128:143]
    ds_read_b64_tr_b16 a[80:81], v44 offset:0
    ds_read_b64_tr_b16 a[82:83], v45 offset:2048
    v_add_f32 v170, v170, v186
    v_add_f32 v171, v171, v187
    v_add_f32 v172, v172, v188
    v_add_f32 v173, v173, v189
    v_add_f32 v174, v174, v190
    v_mfma_f32_32x32x16_bf16 v[128:143], a[44:47], a[12:15], v[128:143]
    ds_read_b64_tr_b16 a[88:89], v46 offset:0
    ds_read_b64_tr_b16 a[90:91], v47 offset:2048
    v_add_f32 v175, v175, v191
    v_add_f32 v144, v144, v160
    v_add_f32 v145, v145, v161
    v_add_f32 v146, v146, v162
    v_add_f32 v147, v147, v163
    v_mfma_f32_32x32x16_bf16 v[128:143], a[48:51], a[16:19], v[128:143]
    ds_read_b64_tr_b16 a[68:69], v40 offset:4096
    ds_read_b64_tr_b16 a[70:71], v41 offset:6144
    v_add_f32 v148, v148, v164
    v_add_f32 v149, v149, v165
    v_add_f32 v150, v150, v166
    v_add_f32 v151, v151, v167
    v_add_f32 v152, v152, v168
    v_mfma_f32_32x32x16_bf16 v[128:143], a[52:55], a[20:23], v[128:143]
    ds_read_b64_tr_b16 a[76:77], v42 offset:4096
    ds_read_b64_tr_b16 a[78:79], v43 offset:6144
    v_add_f32 v153, v153, v169
    v_add_f32 v154, v154, v170
    v_add_f32 v155, v155, v171
    v_add_f32 v156, v156, v172
    v_add_f32 v157, v157, v173
    v_mfma_f32_32x32x16_bf16 v[128:143], a[56:59], a[24:27], v[128:143]
    ds_read_b64_tr_b16 a[84:85], v44 offset:4096
    ds_read_b64_tr_b16 a[86:87], v45 offset:6144
    v_add_f32 v158, v158, v174
    v_add_f32 v159, v159, v175
    v_max3_f32 v218, v144, v145, v146
    v_max3_f32 v219, v147, v148, v149
    v_max3_f32 v220, v150, v151, v152
    v_mfma_f32_32x32x16_bf16 v[128:143], a[60:63], a[28:31], v[128:143]
    ds_read_b64_tr_b16 a[92:93], v46 offset:4096
    ds_read_b64_tr_b16 a[94:95], v47 offset:6144
    v_max3_f32 v221, v153, v154, v155
    v_max3_f32 v218, v218, v156, v157
    v_max3_f32 v219, v219, v158, v159
    v_max3_f32 v218, v218, v219, v220
    v_max_f32 v218, v218, v221
    v_mov_b32 v219, v218
    s_nop 1
    v_permlane32_swap_b32 v218, v219
    v_max3_f32 v218, v218, v219, v216
    v_sub_f32 v220, v216, v218
    v_mov_b32 v216, v218
    v_exp_f32 v220, v220
    v_sub_f32 v192, v144, v218
    v_sub_f32 v193, v145, v218
    v_sub_f32 v194, v146, v218
    v_sub_f32 v195, v147, v218
    v_sub_f32 v196, v148, v218
    v_sub_f32 v197, v149, v218
    v_sub_f32 v198, v150, v218
    v_sub_f32 v199, v151, v218
    v_sub_f32 v200, v152, v218
    v_sub_f32 v201, v153, v218
    v_sub_f32 v202, v154, v218
    v_sub_f32 v203, v155, v218
    v_sub_f32 v204, v156, v218
    v_sub_f32 v205, v157, v218
    v_sub_f32 v206, v158, v218
    v_sub_f32 v207, v159, v218
    ds_write_b128 v28, v[128:131] offset:16384
    v_exp_f32 v192, v192
    v_exp_f32 v193, v193
    v_exp_f32 v194, v194
    v_exp_f32 v195, v195
    ds_write_b128 v28, v[132:135] offset:17408
    v_exp_f32 v196, v196
    v_exp_f32 v197, v197
    v_exp_f32 v198, v198
    v_exp_f32 v199, v199
    ds_write_b128 v28, v[136:139] offset:18432
    v_exp_f32 v200, v200
    v_exp_f32 v201, v201
    v_exp_f32 v202, v202
    v_exp_f32 v203, v203
    ds_write_b128 v28, v[140:143] offset:19456
    v_exp_f32 v204, v204
    v_exp_f32 v205, v205
    v_exp_f32 v206, v206
    v_exp_f32 v207, v207
    v_mul_f32 v217, v217, v220
    v_cvt_pk_bf16_f32 v208, v192, v193
    v_cvt_pk_bf16_f32 v209, v194, v195
    v_cvt_pk_bf16_f32 v210, v196, v197
    v_cvt_pk_bf16_f32 v211, v198, v199
    v_cvt_pk_bf16_f32 v212, v200, v201
    v_cvt_pk_bf16_f32 v213, v202, v203
    v_cvt_pk_bf16_f32 v214, v204, v205
    v_cvt_pk_bf16_f32 v215, v206, v207
    v_mul_f32 v64, v64, v220
    v_mul_f32 v65, v65, v220
    v_mul_f32 v66, v66, v220
    v_mul_f32 v67, v67, v220
    v_mul_f32 v68, v68, v220
    v_mul_f32 v69, v69, v220
    v_mul_f32 v70, v70, v220
    v_mul_f32 v71, v71, v220
    v_mul_f32 v72, v72, v220
    v_mul_f32 v73, v73, v220
    v_mul_f32 v74, v74, v220
    v_mul_f32 v75, v75, v220
    v_mul_f32 v76, v76, v220
    v_mul_f32 v77, v77, v220
    v_mul_f32 v78, v78, v220
    v_mul_f32 v79, v79, v220
    s_waitcnt lgkmcnt(0)
    s_barrier
    v_mfma_f32_32x32x16_bf16 v[64:79], a[64:67], v[208:211], v[64:79]
    ds_read_b128 v[144:147], v29 offset:16384
    v_mul_f32 v80, v80, v220
    v_mul_f32 v81, v81, v220
    ds_read_b128 v[148:151], v29 offset:17408
    s_waitcnt vmcnt(15)
    ds_write_b128 v26, a[224:227] offset:16384
    v_mul_f32 v82, v82, v220
    v_mul_f32 v83, v83, v220
    ds_read_b128 v[152:155], v29 offset:18432
    v_mul_f32 v84, v84, v220
    v_mfma_f32_32x32x16_bf16 v[64:79], a[68:71], v[212:215], v[64:79]
    v_mul_f32 v85, v85, v220
    ds_read_b128 v[156:159], v29 offset:19456
    v_mul_f32 v86, v86, v220
    s_waitcnt vmcnt(14)
    ds_write_b128 v26, a[228:231] offset:17408
    v_mul_f32 v87, v87, v220
    v_mul_f32 v88, v88, v220
    v_mul_f32 v89, v89, v220
    v_mul_f32 v90, v90, v220
    v_mul_f32 v91, v91, v220
    v_mul_f32 v92, v92, v220
    v_mul_f32 v93, v93, v220
    v_mul_f32 v94, v94, v220
    v_mul_f32 v95, v95, v220
    s_nop 1
    v_mfma_f32_32x32x16_bf16 v[80:95], a[72:75], v[208:211], v[80:95]
    ds_read_b128 v[160:163], v30 offset:16384
    v_mul_f32 v96, v96, v220
    v_mul_f32 v97, v97, v220
    ds_read_b128 v[164:167], v30 offset:17408
    s_waitcnt vmcnt(13)
    ds_write_b128 v26, a[232:235] offset:18432
    v_mul_f32 v98, v98, v220
    v_mul_f32 v99, v99, v220
    ds_read_b128 v[168:171], v30 offset:18432
    v_mul_f32 v100, v100, v220
    v_mfma_f32_32x32x16_bf16 v[80:95], a[76:79], v[212:215], v[80:95]
    v_mul_f32 v101, v101, v220
    ds_read_b128 v[172:175], v30 offset:19456
    v_mul_f32 v102, v102, v220
    s_waitcnt vmcnt(12)
    ds_write_b128 v26, a[236:239] offset:19456
    v_mul_f32 v103, v103, v220
    v_mul_f32 v104, v104, v220
    v_mul_f32 v105, v105, v220
    v_mul_f32 v106, v106, v220
    v_mul_f32 v107, v107, v220
    v_mul_f32 v108, v108, v220
    v_mul_f32 v109, v109, v220
    v_mul_f32 v110, v110, v220
    v_mul_f32 v111, v111, v220
    s_nop 1
    v_mfma_f32_32x32x16_bf16 v[96:111], a[80:83], v[208:211], v[96:111]
    ds_read_b128 v[176:179], v31 offset:16384
    v_mul_f32 v112, v112, v220
    v_mul_f32 v113, v113, v220
    ds_read_b128 v[180:183], v31 offset:17408
    s_waitcnt vmcnt(11)
    ds_write_b128 v26, a[240:243] offset:20480
    v_mul_f32 v114, v114, v220
    v_mul_f32 v115, v115, v220
    ds_read_b128 v[184:187], v31 offset:18432
    v_mul_f32 v116, v116, v220
    v_mfma_f32_32x32x16_bf16 v[96:111], a[84:87], v[212:215], v[96:111]
    v_mul_f32 v117, v117, v220
    ds_read_b128 v[188:191], v31 offset:19456
    v_mul_f32 v118, v118, v220
    s_waitcnt vmcnt(10)
    ds_write_b128 v26, a[244:247] offset:21504
    v_mul_f32 v119, v119, v220
    v_mul_f32 v120, v120, v220
    v_mul_f32 v121, v121, v220
    v_mul_f32 v122, v122, v220
    v_mul_f32 v123, v123, v220
    v_mul_f32 v124, v124, v220
    v_mul_f32 v125, v125, v220
    v_mul_f32 v126, v126, v220
    v_mul_f32 v127, v127, v220
    s_nop 1
    v_mfma_f32_32x32x16_bf16 v[112:127], a[88:91], v[208:211], v[112:127]
    v_add_f32 v192, v192, v200
    v_add_f32 v193, v193, v201
    v_add_f32 v194, v194, v202
    v_add_f32 v195, v195, v203
    s_waitcnt vmcnt(9)
    ds_write_b128 v26, a[248:251] offset:22528
    v_add_f32 v196, v196, v204
    v_add_f32 v197, v197, v205
    v_add_f32 v198, v198, v206
    v_add_f32 v199, v199, v207
    v_mfma_f32_32x32x16_bf16 v[112:127], a[92:95], v[212:215], v[112:127]
    v_add_f32 v192, v192, v196
    v_add_f32 v193, v193, v197
    v_add_f32 v194, v194, v198
    s_waitcnt vmcnt(8)
    ds_write_b128 v26, a[252:255] offset:23552
    v_add_f32 v195, v195, v199
    v_add_f32 v192, v192, v193
    v_add_f32 v194, v194, v195
    v_add_f32 v192, v192, v194
    v_add_f32 v217, v217, v192
    ds_read_b128 a[32:35], v32 offset:16384
    ds_read_b128 a[36:39], v33 offset:16384
    ds_read_b128 a[40:43], v34 offset:16384
    ds_read_b128 a[44:47], v35 offset:16384
    ds_read_b128 a[48:51], v36 offset:16384
    ds_read_b128 a[52:55], v37 offset:16384
    ds_read_b128 a[56:59], v38 offset:16384
    ds_read_b128 a[60:63], v39 offset:16384
    s_waitcnt lgkmcnt(8)
    v_add_f32 v144, v144, v128
    v_add_f32 v145, v145, v129
    v_add_f32 v146, v146, v130
    v_add_f32 v147, v147, v131
    v_add_f32 v148, v148, v132
    v_add_f32 v149, v149, v133
    v_add_f32 v150, v150, v134
    v_add_f32 v151, v151, v135
    v_add_f32 v152, v152, v136
    v_add_f32 v153, v153, v137
    v_add_f32 v154, v154, v138
    v_add_f32 v155, v155, v139
    v_add_f32 v156, v156, v140
    v_add_f32 v157, v157, v141
    v_add_f32 v158, v158, v142
    v_add_f32 v159, v159, v143
    s_waitcnt lgkmcnt(0)
    v_mfma_f32_32x32x16_bf16 v[128:143], a[32:35], a[0:3], 0
    ds_read_b64_tr_b16 a[64:65], v40 offset:8192
    ds_read_b64_tr_b16 a[66:67], v41 offset:10240
    v_add_f32 v160, v160, v176
    v_add_f32 v161, v161, v177
    v_add_f32 v162, v162, v178
    v_add_f32 v163, v163, v179
    v_add_f32 v164, v164, v180
    v_mfma_f32_32x32x16_bf16 v[128:143], a[36:39], a[4:7], v[128:143]
    ds_read_b64_tr_b16 a[72:73], v42 offset:8192
    ds_read_b64_tr_b16 a[74:75], v43 offset:10240
    v_add_f32 v165, v165, v181
    v_add_f32 v166, v166, v182
    v_add_f32 v167, v167, v183
    v_add_f32 v168, v168, v184
    v_add_f32 v169, v169, v185
    v_mfma_f32_32x32x16_bf16 v[128:143], a[40:43], a[8:11], v[128:143]
    ds_read_b64_tr_b16 a[80:81], v44 offset:8192
    ds_read_b64_tr_b16 a[82:83], v45 offset:10240
    v_add_f32 v170, v170, v186
    v_add_f32 v171, v171, v187
    v_add_f32 v172, v172, v188
    v_add_f32 v173, v173, v189
    v_add_f32 v174, v174, v190
    v_mfma_f32_32x32x16_bf16 v[128:143], a[44:47], a[12:15], v[128:143]
    ds_read_b64_tr_b16 a[88:89], v46 offset:8192
    ds_read_b64_tr_b16 a[90:91], v47 offset:10240
    v_add_f32 v175, v175, v191
    v_add_f32 v144, v144, v160
    v_add_f32 v145, v145, v161
    v_add_f32 v146, v146, v162
    v_add_f32 v147, v147, v163
    v_mfma_f32_32x32x16_bf16 v[128:143], a[48:51], a[16:19], v[128:143]
    ds_read_b64_tr_b16 a[68:69], v40 offset:12288
    ds_read_b64_tr_b16 a[70:71], v41 offset:14336
    v_add_f32 v148, v148, v164
    v_add_f32 v149, v149, v165
    v_add_f32 v150, v150, v166
    v_add_f32 v151, v151, v167
    v_add_f32 v152, v152, v168
    v_mfma_f32_32x32x16_bf16 v[128:143], a[52:55], a[20:23], v[128:143]
    ds_read_b64_tr_b16 a[76:77], v42 offset:12288
    ds_read_b64_tr_b16 a[78:79], v43 offset:14336
    v_add_f32 v153, v153, v169
    v_add_f32 v154, v154, v170
    v_add_f32 v155, v155, v171
    v_add_f32 v156, v156, v172
    v_add_f32 v157, v157, v173
    v_mfma_f32_32x32x16_bf16 v[128:143], a[56:59], a[24:27], v[128:143]
    ds_read_b64_tr_b16 a[84:85], v44 offset:12288
    ds_read_b64_tr_b16 a[86:87], v45 offset:14336
    v_add_f32 v158, v158, v174
    v_add_f32 v159, v159, v175
    v_max3_f32 v218, v144, v145, v146
    v_max3_f32 v219, v147, v148, v149
    v_max3_f32 v220, v150, v151, v152
    v_mfma_f32_32x32x16_bf16 v[128:143], a[60:63], a[28:31], v[128:143]
    ds_read_b64_tr_b16 a[92:93], v46 offset:12288
    ds_read_b64_tr_b16 a[94:95], v47 offset:14336
    v_max3_f32 v221, v153, v154, v155
    v_max3_f32 v218, v218, v156, v157
    v_max3_f32 v219, v219, v158, v159
    v_max3_f32 v218, v218, v219, v220
    v_max_f32 v218, v218, v221
    v_mov_b32 v219, v218
    s_nop 1
    v_permlane32_swap_b32 v218, v219
    v_max3_f32 v218, v218, v219, v216
    v_sub_f32 v220, v216, v218
    v_mov_b32 v216, v218
    v_exp_f32 v220, v220
    v_sub_f32 v192, v144, v218
    v_sub_f32 v193, v145, v218
    v_sub_f32 v194, v146, v218
    v_sub_f32 v195, v147, v218
    v_sub_f32 v196, v148, v218
    v_sub_f32 v197, v149, v218
    v_sub_f32 v198, v150, v218
    v_sub_f32 v199, v151, v218
    v_sub_f32 v200, v152, v218
    v_sub_f32 v201, v153, v218
    v_sub_f32 v202, v154, v218
    v_sub_f32 v203, v155, v218
    v_sub_f32 v204, v156, v218
    v_sub_f32 v205, v157, v218
    v_sub_f32 v206, v158, v218
    v_sub_f32 v207, v159, v218
    ds_write_b128 v28, v[128:131] offset:0
    v_exp_f32 v192, v192
    v_exp_f32 v193, v193
    v_exp_f32 v194, v194
    v_exp_f32 v195, v195
    ds_write_b128 v28, v[132:135] offset:1024
    v_exp_f32 v196, v196
    v_exp_f32 v197, v197
    v_exp_f32 v198, v198
    v_exp_f32 v199, v199
    ds_write_b128 v28, v[136:139] offset:2048
    v_exp_f32 v200, v200
    v_exp_f32 v201, v201
    v_exp_f32 v202, v202
    v_exp_f32 v203, v203
    ds_write_b128 v28, v[140:143] offset:3072
    v_exp_f32 v204, v204
    v_exp_f32 v205, v205
    v_exp_f32 v206, v206
    v_exp_f32 v207, v207
    v_mul_f32 v217, v217, v220
    v_cvt_pk_bf16_f32 v208, v192, v193
    v_cvt_pk_bf16_f32 v209, v194, v195
    v_cvt_pk_bf16_f32 v210, v196, v197
    v_cvt_pk_bf16_f32 v211, v198, v199
    v_cvt_pk_bf16_f32 v212, v200, v201
    v_cvt_pk_bf16_f32 v213, v202, v203
    v_cvt_pk_bf16_f32 v214, v204, v205
    v_cvt_pk_bf16_f32 v215, v206, v207
    v_mul_f32 v64, v64, v220
    v_mul_f32 v65, v65, v220
    v_mul_f32 v66, v66, v220
    v_mul_f32 v67, v67, v220
    v_mul_f32 v68, v68, v220
    v_mul_f32 v69, v69, v220
    v_mul_f32 v70, v70, v220
    v_mul_f32 v71, v71, v220
    v_mul_f32 v72, v72, v220
    v_mul_f32 v73, v73, v220
    v_mul_f32 v74, v74, v220
    v_mul_f32 v75, v75, v220
    v_mul_f32 v76, v76, v220
    v_mul_f32 v77, v77, v220
    v_mul_f32 v78, v78, v220
    v_mul_f32 v79, v79, v220
    s_waitcnt lgkmcnt(0)
    s_barrier
    v_mfma_f32_32x32x16_bf16 v[64:79], a[64:67], v[208:211], v[64:79]
    ds_read_b128 v[144:147], v29 offset:0
    v_mul_f32 v80, v80, v220
    v_mul_f32 v81, v81, v220
    ds_read_b128 v[148:151], v29 offset:1024
    s_waitcnt vmcnt(7)
    ds_write_b128 v26, v[224:227] offset:24576
    v_mul_f32 v82, v82, v220
    v_mul_f32 v83, v83, v220
    ds_read_b128 v[152:155], v29 offset:2048
    v_mul_f32 v84, v84, v220
    v_mfma_f32_32x32x16_bf16 v[64:79], a[68:71], v[212:215], v[64:79]
    v_mul_f32 v85, v85, v220
    ds_read_b128 v[156:159], v29 offset:3072
    v_mul_f32 v86, v86, v220
    s_waitcnt vmcnt(6)
    ds_write_b128 v26, v[228:231] offset:25600
    v_mul_f32 v87, v87, v220
    v_mul_f32 v88, v88, v220
    v_mul_f32 v89, v89, v220
    v_mul_f32 v90, v90, v220
    v_mul_f32 v91, v91, v220
    v_mul_f32 v92, v92, v220
    v_mul_f32 v93, v93, v220
    v_mul_f32 v94, v94, v220
    v_mul_f32 v95, v95, v220
    s_nop 1
    v_mfma_f32_32x32x16_bf16 v[80:95], a[72:75], v[208:211], v[80:95]
    ds_read_b128 v[160:163], v30 offset:0
    v_mul_f32 v96, v96, v220
    v_mul_f32 v97, v97, v220
    ds_read_b128 v[164:167], v30 offset:1024
    s_waitcnt vmcnt(5)
    ds_write_b128 v26, v[232:235] offset:26624
    v_mul_f32 v98, v98, v220
    v_mul_f32 v99, v99, v220
    ds_read_b128 v[168:171], v30 offset:2048
    v_mul_f32 v100, v100, v220
    v_mfma_f32_32x32x16_bf16 v[80:95], a[76:79], v[212:215], v[80:95]
    v_mul_f32 v101, v101, v220
    ds_read_b128 v[172:175], v30 offset:3072
    v_mul_f32 v102, v102, v220
    s_waitcnt vmcnt(4)
    ds_write_b128 v26, v[236:239] offset:27648
    v_mul_f32 v103, v103, v220
    v_mul_f32 v104, v104, v220
    v_mul_f32 v105, v105, v220
    v_mul_f32 v106, v106, v220
    v_mul_f32 v107, v107, v220
    v_mul_f32 v108, v108, v220
    v_mul_f32 v109, v109, v220
    v_mul_f32 v110, v110, v220
    v_mul_f32 v111, v111, v220
    s_nop 1
    v_mfma_f32_32x32x16_bf16 v[96:111], a[80:83], v[208:211], v[96:111]
    ds_read_b128 v[176:179], v31 offset:0
    v_mul_f32 v112, v112, v220
    v_mul_f32 v113, v113, v220
    ds_read_b128 v[180:183], v31 offset:1024
    s_waitcnt vmcnt(3)
    ds_write_b128 v26, v[240:243] offset:28672
    v_mul_f32 v114, v114, v220
    v_mul_f32 v115, v115, v220
    ds_read_b128 v[184:187], v31 offset:2048
    v_mul_f32 v116, v116, v220
    v_mfma_f32_32x32x16_bf16 v[96:111], a[84:87], v[212:215], v[96:111]
    v_mul_f32 v117, v117, v220
    ds_read_b128 v[188:191], v31 offset:3072
    v_mul_f32 v118, v118, v220
    s_waitcnt vmcnt(2)
    ds_write_b128 v26, v[244:247] offset:29696
    v_mul_f32 v119, v119, v220
    v_mul_f32 v120, v120, v220
    v_mul_f32 v121, v121, v220
    v_mul_f32 v122, v122, v220
    v_mul_f32 v123, v123, v220
    v_mul_f32 v124, v124, v220
    v_mul_f32 v125, v125, v220
    v_mul_f32 v126, v126, v220
    v_mul_f32 v127, v127, v220
    s_nop 1
    v_mfma_f32_32x32x16_bf16 v[112:127], a[88:91], v[208:211], v[112:127]
    v_add_f32 v192, v192, v200
    v_add_f32 v193, v193, v201
    v_add_f32 v194, v194, v202
    v_add_f32 v195, v195, v203
    s_waitcnt vmcnt(1)
    ds_write_b128 v26, v[248:251] offset:30720
    v_add_f32 v196, v196, v204
    v_add_f32 v197, v197, v205
    v_add_f32 v198, v198, v206
    v_add_f32 v199, v199, v207
    v_mfma_f32_32x32x16_bf16 v[112:127], a[92:95], v[212:215], v[112:127]
    v_add_f32 v192, v192, v196
    v_add_f32 v193, v193, v197
    v_add_f32 v194, v194, v198
    s_waitcnt vmcnt(0)
    ds_write_b128 v26, v[252:255] offset:31744
    v_add_f32 v195, v195, v199
    v_add_f32 v192, v192, v193
    v_add_f32 v194, v194, v195
    v_add_f32 v192, v192, v194
    v_add_f32 v217, v217, v192
    ds_read_b128 a[32:35], v32 offset:24576
    ds_read_b128 a[36:39], v33 offset:24576
    ds_read_b128 a[40:43], v34 offset:24576
    ds_read_b128 a[44:47], v35 offset:24576
    ds_read_b128 a[48:51], v36 offset:24576
    ds_read_b128 a[52:55], v37 offset:24576
    ds_read_b128 a[56:59], v38 offset:24576
    ds_read_b128 a[60:63], v39 offset:24576
    s_waitcnt lgkmcnt(8)
    v_add_f32 v144, v144, v128
    v_add_f32 v145, v145, v129
    v_add_f32 v146, v146, v130
    v_add_f32 v147, v147, v131
    v_add_f32 v148, v148, v132
    v_add_f32 v149, v149, v133
    v_add_f32 v150, v150, v134
    v_add_f32 v151, v151, v135
    v_add_f32 v152, v152, v136
    v_add_f32 v153, v153, v137
    v_add_f32 v154, v154, v138
    v_add_f32 v155, v155, v139
    v_add_f32 v156, v156, v140
    v_add_f32 v157, v157, v141
    v_add_f32 v158, v158, v142
    v_add_f32 v159, v159, v143
    s_waitcnt lgkmcnt(0)
    v_mfma_f32_32x32x16_bf16 v[128:143], a[32:35], a[0:3], 0
    ds_read_b64_tr_b16 a[64:65], v40 offset:16384
    ds_read_b64_tr_b16 a[66:67], v41 offset:18432
    v_add_f32 v160, v160, v176
    v_add_f32 v161, v161, v177
    v_add_f32 v162, v162, v178
    v_add_f32 v163, v163, v179
    v_add_f32 v164, v164, v180
    v_mfma_f32_32x32x16_bf16 v[128:143], a[36:39], a[4:7], v[128:143]
    ds_read_b64_tr_b16 a[72:73], v42 offset:16384
    ds_read_b64_tr_b16 a[74:75], v43 offset:18432
    v_add_f32 v165, v165, v181
    v_add_f32 v166, v166, v182
    v_add_f32 v167, v167, v183
    v_add_f32 v168, v168, v184
    v_add_f32 v169, v169, v185
    v_mfma_f32_32x32x16_bf16 v[128:143], a[40:43], a[8:11], v[128:143]
    ds_read_b64_tr_b16 a[80:81], v44 offset:16384
    ds_read_b64_tr_b16 a[82:83], v45 offset:18432
    v_add_f32 v170, v170, v186
    v_add_f32 v171, v171, v187
    v_add_f32 v172, v172, v188
    v_add_f32 v173, v173, v189
    v_add_f32 v174, v174, v190
    v_mfma_f32_32x32x16_bf16 v[128:143], a[44:47], a[12:15], v[128:143]
    ds_read_b64_tr_b16 a[88:89], v46 offset:16384
    ds_read_b64_tr_b16 a[90:91], v47 offset:18432
    v_add_f32 v175, v175, v191
    v_add_f32 v144, v144, v160
    v_add_f32 v145, v145, v161
    v_add_f32 v146, v146, v162
    v_add_f32 v147, v147, v163
    v_mfma_f32_32x32x16_bf16 v[128:143], a[48:51], a[16:19], v[128:143]
    ds_read_b64_tr_b16 a[68:69], v40 offset:20480
    ds_read_b64_tr_b16 a[70:71], v41 offset:22528
    v_add_f32 v148, v148, v164
    v_add_f32 v149, v149, v165
    v_add_f32 v150, v150, v166
    v_add_f32 v151, v151, v167
    v_add_f32 v152, v152, v168
    v_mfma_f32_32x32x16_bf16 v[128:143], a[52:55], a[20:23], v[128:143]
    ds_read_b64_tr_b16 a[76:77], v42 offset:20480
    ds_read_b64_tr_b16 a[78:79], v43 offset:22528
    v_add_f32 v153, v153, v169
    v_add_f32 v154, v154, v170
    v_add_f32 v155, v155, v171
    v_add_f32 v156, v156, v172
    v_add_f32 v157, v157, v173
    v_mfma_f32_32x32x16_bf16 v[128:143], a[56:59], a[24:27], v[128:143]
    ds_read_b64_tr_b16 a[84:85], v44 offset:20480
    ds_read_b64_tr_b16 a[86:87], v45 offset:22528
    v_add_f32 v158, v158, v174
    v_add_f32 v159, v159, v175
    v_max3_f32 v218, v144, v145, v146
    v_max3_f32 v219, v147, v148, v149
    v_max3_f32 v220, v150, v151, v152
    v_mfma_f32_32x32x16_bf16 v[128:143], a[60:63], a[28:31], v[128:143]
    ds_read_b64_tr_b16 a[92:93], v46 offset:20480
    ds_read_b64_tr_b16 a[94:95], v47 offset:22528
    v_max3_f32 v221, v153, v154, v155
    v_max3_f32 v218, v218, v156, v157
    v_max3_f32 v219, v219, v158, v159
    v_max3_f32 v218, v218, v219, v220
    v_max_f32 v218, v218, v221
    v_mov_b32 v219, v218
    s_nop 1
    v_permlane32_swap_b32 v218, v219
    v_max3_f32 v218, v218, v219, v216
    v_sub_f32 v220, v216, v218
    v_mov_b32 v216, v218
    v_exp_f32 v220, v220
    v_sub_f32 v192, v144, v218
    v_sub_f32 v193, v145, v218
    v_sub_f32 v194, v146, v218
    v_sub_f32 v195, v147, v218
    v_sub_f32 v196, v148, v218
    v_sub_f32 v197, v149, v218
    v_sub_f32 v198, v150, v218
    v_sub_f32 v199, v151, v218
    v_sub_f32 v200, v152, v218
    v_sub_f32 v201, v153, v218
    v_sub_f32 v202, v154, v218
    v_sub_f32 v203, v155, v218
    v_sub_f32 v204, v156, v218
    v_sub_f32 v205, v157, v218
    v_sub_f32 v206, v158, v218
    v_sub_f32 v207, v159, v218
    ds_write_b128 v28, v[128:131] offset:16384
    v_exp_f32 v192, v192
    v_exp_f32 v193, v193
    v_exp_f32 v194, v194
    v_exp_f32 v195, v195
    ds_write_b128 v28, v[132:135] offset:17408
    v_exp_f32 v196, v196
    v_exp_f32 v197, v197
    v_exp_f32 v198, v198
    v_exp_f32 v199, v199
    ds_write_b128 v28, v[136:139] offset:18432
    v_exp_f32 v200, v200
    v_exp_f32 v201, v201
    v_exp_f32 v202, v202
    v_exp_f32 v203, v203
    ds_write_b128 v28, v[140:143] offset:19456
    v_exp_f32 v204, v204
    v_exp_f32 v205, v205
    v_exp_f32 v206, v206
    v_exp_f32 v207, v207
    v_mul_f32 v217, v217, v220
    v_cvt_pk_bf16_f32 v208, v192, v193
    v_cvt_pk_bf16_f32 v209, v194, v195
    v_cvt_pk_bf16_f32 v210, v196, v197
    v_cvt_pk_bf16_f32 v211, v198, v199
    v_cvt_pk_bf16_f32 v212, v200, v201
    v_cvt_pk_bf16_f32 v213, v202, v203
    v_cvt_pk_bf16_f32 v214, v204, v205
    v_cvt_pk_bf16_f32 v215, v206, v207
    v_mul_f32 v64, v64, v220
    v_mul_f32 v65, v65, v220
    v_mul_f32 v66, v66, v220
    v_mul_f32 v67, v67, v220
    v_mul_f32 v68, v68, v220
    v_mul_f32 v69, v69, v220
    v_mul_f32 v70, v70, v220
    v_mul_f32 v71, v71, v220
    v_mul_f32 v72, v72, v220
    v_mul_f32 v73, v73, v220
    v_mul_f32 v74, v74, v220
    v_mul_f32 v75, v75, v220
    v_mul_f32 v76, v76, v220
    v_mul_f32 v77, v77, v220
    v_mul_f32 v78, v78, v220
    v_mul_f32 v79, v79, v220
    s_waitcnt lgkmcnt(0)
    s_barrier
    v_mfma_f32_32x32x16_bf16 v[64:79], a[64:67], v[208:211], v[64:79]
    ds_read_b128 v[144:147], v29 offset:16384
    v_mul_f32 v80, v80, v220
    v_mul_f32 v81, v81, v220
    ds_read_b128 v[148:151], v29 offset:17408
    v_mul_f32 v82, v82, v220
    v_mul_f32 v83, v83, v220
    ds_read_b128 v[152:155], v29 offset:18432
    v_mul_f32 v84, v84, v220
    v_mfma_f32_32x32x16_bf16 v[64:79], a[68:71], v[212:215], v[64:79]
    v_mul_f32 v85, v85, v220
    ds_read_b128 v[156:159], v29 offset:19456
    v_mul_f32 v86, v86, v220
    v_mul_f32 v87, v87, v220
    v_mul_f32 v88, v88, v220
    v_mul_f32 v89, v89, v220
    v_mul_f32 v90, v90, v220
    v_mul_f32 v91, v91, v220
    v_mul_f32 v92, v92, v220
    v_mul_f32 v93, v93, v220
    v_mul_f32 v94, v94, v220
    v_mul_f32 v95, v95, v220
    s_nop 1
    v_mfma_f32_32x32x16_bf16 v[80:95], a[72:75], v[208:211], v[80:95]
    ds_read_b128 v[160:163], v30 offset:16384
    v_mul_f32 v96, v96, v220
    v_mul_f32 v97, v97, v220
    ds_read_b128 v[164:167], v30 offset:17408
    v_mul_f32 v98, v98, v220
    v_mul_f32 v99, v99, v220
    ds_read_b128 v[168:171], v30 offset:18432
    v_mul_f32 v100, v100, v220
    v_mfma_f32_32x32x16_bf16 v[80:95], a[76:79], v[212:215], v[80:95]
    v_mul_f32 v101, v101, v220
    ds_read_b128 v[172:175], v30 offset:19456
    v_mul_f32 v102, v102, v220
    v_mul_f32 v103, v103, v220
    v_mul_f32 v104, v104, v220
    v_mul_f32 v105, v105, v220
    v_mul_f32 v106, v106, v220
    v_mul_f32 v107, v107, v220
    v_mul_f32 v108, v108, v220
    v_mul_f32 v109, v109, v220
    v_mul_f32 v110, v110, v220
    v_mul_f32 v111, v111, v220
    s_nop 1
    v_mfma_f32_32x32x16_bf16 v[96:111], a[80:83], v[208:211], v[96:111]
    ds_read_b128 v[176:179], v31 offset:16384
    v_mul_f32 v112, v112, v220
    v_mul_f32 v113, v113, v220
    ds_read_b128 v[180:183], v31 offset:17408
    v_mul_f32 v114, v114, v220
    v_mul_f32 v115, v115, v220
    ds_read_b128 v[184:187], v31 offset:18432
    v_mul_f32 v116, v116, v220
    v_mfma_f32_32x32x16_bf16 v[96:111], a[84:87], v[212:215], v[96:111]
    v_mul_f32 v117, v117, v220
    ds_read_b128 v[188:191], v31 offset:19456
    v_mul_f32 v118, v118, v220
    v_mul_f32 v119, v119, v220
    v_mul_f32 v120, v120, v220
    v_mul_f32 v121, v121, v220
    v_mul_f32 v122, v122, v220
    v_mul_f32 v123, v123, v220
    v_mul_f32 v124, v124, v220
    v_mul_f32 v125, v125, v220
    v_mul_f32 v126, v126, v220
    v_mul_f32 v127, v127, v220
    s_nop 1
    v_mfma_f32_32x32x16_bf16 v[112:127], a[88:91], v[208:211], v[112:127]
    v_add_f32 v192, v192, v200
    v_add_f32 v193, v193, v201
    v_add_f32 v194, v194, v202
    v_add_f32 v195, v195, v203
    v_add_f32 v196, v196, v204
    v_add_f32 v197, v197, v205
    v_add_f32 v198, v198, v206
    v_add_f32 v199, v199, v207
    v_mfma_f32_32x32x16_bf16 v[112:127], a[92:95], v[212:215], v[112:127]
    v_add_f32 v192, v192, v196
    v_add_f32 v193, v193, v197
    v_add_f32 v194, v194, v198
    v_add_f32 v195, v195, v199
    v_add_f32 v192, v192, v193
    v_add_f32 v194, v194, v195
    v_add_f32 v192, v192, v194
    v_add_f32 v217, v217, v192
    s_waitcnt lgkmcnt(0)
    v_add_f32 v144, v144, v128
    v_add_f32 v145, v145, v129
    v_add_f32 v146, v146, v130
    v_add_f32 v147, v147, v131
    v_add_f32 v148, v148, v132
    v_add_f32 v149, v149, v133
    v_add_f32 v150, v150, v134
    v_add_f32 v151, v151, v135
    v_add_f32 v152, v152, v136
    v_add_f32 v153, v153, v137
    v_add_f32 v154, v154, v138
    v_add_f32 v155, v155, v139
    v_add_f32 v156, v156, v140
    v_add_f32 v157, v157, v141
    v_add_f32 v158, v158, v142
    v_add_f32 v159, v159, v143
    s_waitcnt lgkmcnt(0)
    ds_read_b64_tr_b16 a[64:65], v40 offset:24576
    ds_read_b64_tr_b16 a[66:67], v41 offset:26624
    v_add_f32 v160, v160, v176
    v_add_f32 v161, v161, v177
    v_add_f32 v162, v162, v178
    v_add_f32 v163, v163, v179
    v_add_f32 v164, v164, v180
    ds_read_b64_tr_b16 a[72:73], v42 offset:24576
    ds_read_b64_tr_b16 a[74:75], v43 offset:26624
    v_add_f32 v165, v165, v181
    v_add_f32 v166, v166, v182
    v_add_f32 v167, v167, v183
    v_add_f32 v168, v168, v184
    v_add_f32 v169, v169, v185
    ds_read_b64_tr_b16 a[80:81], v44 offset:24576
    ds_read_b64_tr_b16 a[82:83], v45 offset:26624
    v_add_f32 v170, v170, v186
    v_add_f32 v171, v171, v187
    v_add_f32 v172, v172, v188
    v_add_f32 v173, v173, v189
    v_add_f32 v174, v174, v190
    ds_read_b64_tr_b16 a[88:89], v46 offset:24576
    ds_read_b64_tr_b16 a[90:91], v47 offset:26624
    v_add_f32 v175, v175, v191
    v_add_f32 v144, v144, v160
    v_add_f32 v145, v145, v161
    v_add_f32 v146, v146, v162
    v_add_f32 v147, v147, v163
    ds_read_b64_tr_b16 a[68:69], v40 offset:28672
    ds_read_b64_tr_b16 a[70:71], v41 offset:30720
    v_add_f32 v148, v148, v164
    v_add_f32 v149, v149, v165
    v_add_f32 v150, v150, v166
    v_add_f32 v151, v151, v167
    v_add_f32 v152, v152, v168
    ds_read_b64_tr_b16 a[76:77], v42 offset:28672
    ds_read_b64_tr_b16 a[78:79], v43 offset:30720
    v_add_f32 v153, v153, v169
    v_add_f32 v154, v154, v170
    v_add_f32 v155, v155, v171
    v_add_f32 v156, v156, v172
    v_add_f32 v157, v157, v173
    ds_read_b64_tr_b16 a[84:85], v44 offset:28672
    ds_read_b64_tr_b16 a[86:87], v45 offset:30720
    v_add_f32 v158, v158, v174
    v_add_f32 v159, v159, v175
    v_max3_f32 v218, v144, v145, v146
    v_max3_f32 v219, v147, v148, v149
    v_max3_f32 v220, v150, v151, v152
    ds_read_b64_tr_b16 a[92:93], v46 offset:28672
    ds_read_b64_tr_b16 a[94:95], v47 offset:30720
    v_max3_f32 v221, v153, v154, v155
    v_max3_f32 v218, v218, v156, v157
    v_max3_f32 v219, v219, v158, v159
    v_max3_f32 v218, v218, v219, v220
    v_max_f32 v218, v218, v221
    v_mov_b32 v219, v218
    s_nop 1
    v_permlane32_swap_b32 v218, v219
    v_max3_f32 v218, v218, v219, v216
    v_sub_f32 v220, v216, v218
    v_mov_b32 v216, v218
    v_exp_f32 v220, v220
    v_sub_f32 v192, v144, v218
    v_sub_f32 v193, v145, v218
    v_sub_f32 v194, v146, v218
    v_sub_f32 v195, v147, v218
    v_sub_f32 v196, v148, v218
    v_sub_f32 v197, v149, v218
    v_sub_f32 v198, v150, v218
    v_sub_f32 v199, v151, v218
    v_sub_f32 v200, v152, v218
    v_sub_f32 v201, v153, v218
    v_sub_f32 v202, v154, v218
    v_sub_f32 v203, v155, v218
    v_sub_f32 v204, v156, v218
    v_sub_f32 v205, v157, v218
    v_sub_f32 v206, v158, v218
    v_sub_f32 v207, v159, v218
    v_exp_f32 v192, v192
    v_exp_f32 v193, v193
    v_exp_f32 v194, v194
    v_exp_f32 v195, v195
    v_exp_f32 v196, v196
    v_exp_f32 v197, v197
    v_exp_f32 v198, v198
    v_exp_f32 v199, v199
    v_exp_f32 v200, v200
    v_exp_f32 v201, v201
    v_exp_f32 v202, v202
    v_exp_f32 v203, v203
    v_exp_f32 v204, v204
    v_exp_f32 v205, v205
    v_exp_f32 v206, v206
    v_exp_f32 v207, v207
    v_mul_f32 v217, v217, v220
    v_cvt_pk_bf16_f32 v208, v192, v193
    v_cvt_pk_bf16_f32 v209, v194, v195
    v_cvt_pk_bf16_f32 v210, v196, v197
    v_cvt_pk_bf16_f32 v211, v198, v199
    v_cvt_pk_bf16_f32 v212, v200, v201
    v_cvt_pk_bf16_f32 v213, v202, v203
    v_cvt_pk_bf16_f32 v214, v204, v205
    v_cvt_pk_bf16_f32 v215, v206, v207
    v_mul_f32 v64, v64, v220
    v_mul_f32 v65, v65, v220
    v_mul_f32 v66, v66, v220
    v_mul_f32 v67, v67, v220
    v_mul_f32 v68, v68, v220
    v_mul_f32 v69, v69, v220
    v_mul_f32 v70, v70, v220
    v_mul_f32 v71, v71, v220
    v_mul_f32 v72, v72, v220
    v_mul_f32 v73, v73, v220
    v_mul_f32 v74, v74, v220
    v_mul_f32 v75, v75, v220
    v_mul_f32 v76, v76, v220
    v_mul_f32 v77, v77, v220
    v_mul_f32 v78, v78, v220
    v_mul_f32 v79, v79, v220
    s_waitcnt lgkmcnt(0)
    s_nop 0
    v_mfma_f32_32x32x16_bf16 v[64:79], a[64:67], v[208:211], v[64:79]
    v_mul_f32 v80, v80, v220
    v_mul_f32 v81, v81, v220
    v_mul_f32 v82, v82, v220
    v_mul_f32 v83, v83, v220
    v_mul_f32 v84, v84, v220
    v_mul_f32 v85, v85, v220
    v_mul_f32 v86, v86, v220
    v_mul_f32 v87, v87, v220
    v_mfma_f32_32x32x16_bf16 v[64:79], a[68:71], v[212:215], v[64:79]
    v_mul_f32 v88, v88, v220
    v_mul_f32 v89, v89, v220
    v_mul_f32 v90, v90, v220
    v_mul_f32 v91, v91, v220
    v_mul_f32 v92, v92, v220
    v_mul_f32 v93, v93, v220
    v_mul_f32 v94, v94, v220
    v_mul_f32 v95, v95, v220
    s_nop 1
    v_mfma_f32_32x32x16_bf16 v[80:95], a[72:75], v[208:211], v[80:95]
    v_mul_f32 v96, v96, v220
    v_mul_f32 v97, v97, v220
    v_mul_f32 v98, v98, v220
    v_mul_f32 v99, v99, v220
    v_mul_f32 v100, v100, v220
    v_mul_f32 v101, v101, v220
    v_mul_f32 v102, v102, v220
    v_mul_f32 v103, v103, v220
    v_mfma_f32_32x32x16_bf16 v[80:95], a[76:79], v[212:215], v[80:95]
    v_mul_f32 v104, v104, v220
    v_mul_f32 v105, v105, v220
    v_mul_f32 v106, v106, v220
    v_mul_f32 v107, v107, v220
    v_mul_f32 v108, v108, v220
    v_mul_f32 v109, v109, v220
    v_mul_f32 v110, v110, v220
    v_mul_f32 v111, v111, v220
    s_nop 1
    v_mfma_f32_32x32x16_bf16 v[96:111], a[80:83], v[208:211], v[96:111]
    v_mul_f32 v112, v112, v220
    v_mul_f32 v113, v113, v220
    v_mul_f32 v114, v114, v220
    v_mul_f32 v115, v115, v220
    v_mul_f32 v116, v116, v220
    v_mul_f32 v117, v117, v220
    v_mul_f32 v118, v118, v220
    v_mul_f32 v119, v119, v220
    v_mfma_f32_32x32x16_bf16 v[96:111], a[84:87], v[212:215], v[96:111]
    v_mul_f32 v120, v120, v220
    v_mul_f32 v121, v121, v220
    v_mul_f32 v122, v122, v220
    v_mul_f32 v123, v123, v220
    v_mul_f32 v124, v124, v220
    v_mul_f32 v125, v125, v220
    v_mul_f32 v126, v126, v220
    v_mul_f32 v127, v127, v220
    s_nop 1
    v_mfma_f32_32x32x16_bf16 v[112:127], a[88:91], v[208:211], v[112:127]
    v_add_f32 v192, v192, v200
    v_add_f32 v193, v193, v201
    v_add_f32 v194, v194, v202
    v_add_f32 v195, v195, v203
    v_add_f32 v196, v196, v204
    v_add_f32 v197, v197, v205
    v_add_f32 v198, v198, v206
    v_add_f32 v199, v199, v207
    v_mfma_f32_32x32x16_bf16 v[112:127], a[92:95], v[212:215], v[112:127]
    v_add_f32 v192, v192, v196
    v_add_f32 v193, v193, v197
    v_add_f32 v194, v194, v198
    v_add_f32 v195, v195, v199
    v_add_f32 v192, v192, v193
    v_add_f32 v194, v194, v195
    v_add_f32 v192, v192, v194
    v_add_f32 v217, v217, v192
    s_waitcnt lgkmcnt(0)
    v_mov_b32 v219, v217
    s_nop 1
    v_permlane32_swap_b32 v217, v219
    v_add_f32 v217, v217, v219
    v_rcp_f32 v220, v217
    v_mul_u32_u24 v5, 272, v24
    v_lshl_add_u32 v5, v25, 3, v5
    v_add_u32 v5, s63, v5
    v_mul_f32 v64, v64, v220
    v_mul_f32 v65, v65, v220
    v_mul_f32 v66, v66, v220
    v_mul_f32 v67, v67, v220
    v_mul_f32 v68, v68, v220
    v_mul_f32 v69, v69, v220
    v_mul_f32 v70, v70, v220
    v_mul_f32 v71, v71, v220
    v_mul_f32 v72, v72, v220
    v_mul_f32 v73, v73, v220
    v_mul_f32 v74, v74, v220
    v_mul_f32 v75, v75, v220
    v_mul_f32 v76, v76, v220
    v_mul_f32 v77, v77, v220
    v_mul_f32 v78, v78, v220
    v_mul_f32 v79, v79, v220
    v_mul_f32 v80, v80, v220
    v_mul_f32 v81, v81, v220
    v_mul_f32 v82, v82, v220
    v_mul_f32 v83, v83, v220
    v_mul_f32 v84, v84, v220
    v_mul_f32 v85, v85, v220
    v_mul_f32 v86, v86, v220
    v_mul_f32 v87, v87, v220
    v_mul_f32 v88, v88, v220
    v_mul_f32 v89, v89, v220
    v_mul_f32 v90, v90, v220
    v_mul_f32 v91, v91, v220
    v_mul_f32 v92, v92, v220
    v_mul_f32 v93, v93, v220
    v_mul_f32 v94, v94, v220
    v_mul_f32 v95, v95, v220
    v_mul_f32 v96, v96, v220
    v_mul_f32 v97, v97, v220
    v_mul_f32 v98, v98, v220
    v_mul_f32 v99, v99, v220
    v_mul_f32 v100, v100, v220
    v_mul_f32 v101, v101, v220
    v_mul_f32 v102, v102, v220
    v_mul_f32 v103, v103, v220
    v_mul_f32 v104, v104, v220
    v_mul_f32 v105, v105, v220
    v_mul_f32 v106, v106, v220
    v_mul_f32 v107, v107, v220
    v_mul_f32 v108, v108, v220
    v_mul_f32 v109, v109, v220
    v_mul_f32 v110, v110, v220
    v_mul_f32 v111, v111, v220
    v_mul_f32 v112, v112, v220
    v_mul_f32 v113, v113, v220
    v_mul_f32 v114, v114, v220
    v_mul_f32 v115, v115, v220
    v_mul_f32 v116, v116, v220
    v_mul_f32 v117, v117, v220
    v_mul_f32 v118, v118, v220
    v_mul_f32 v119, v119, v220
    v_mul_f32 v120, v120, v220
    v_mul_f32 v121, v121, v220
    v_mul_f32 v122, v122, v220
    v_mul_f32 v123, v123, v220
    v_mul_f32 v124, v124, v220
    v_mul_f32 v125, v125, v220
    v_mul_f32 v126, v126, v220
    v_mul_f32 v127, v127, v220
    v_cvt_pk_bf16_f32 v128, v64, v65
    v_cvt_pk_bf16_f32 v129, v66, v67
    v_cvt_pk_bf16_f32 v130, v68, v69
    v_cvt_pk_bf16_f32 v131, v70, v71
    v_cvt_pk_bf16_f32 v132, v72, v73
    v_cvt_pk_bf16_f32 v133, v74, v75
    v_cvt_pk_bf16_f32 v134, v76, v77
    v_cvt_pk_bf16_f32 v135, v78, v79
    v_cvt_pk_bf16_f32 v136, v80, v81
    v_cvt_pk_bf16_f32 v137, v82, v83
    v_cvt_pk_bf16_f32 v138, v84, v85
    v_cvt_pk_bf16_f32 v139, v86, v87
    v_cvt_pk_bf16_f32 v140, v88, v89
    v_cvt_pk_bf16_f32 v141, v90, v91
    v_cvt_pk_bf16_f32 v142, v92, v93
    v_cvt_pk_bf16_f32 v143, v94, v95
    v_cvt_pk_bf16_f32 v144, v96, v97
    v_cvt_pk_bf16_f32 v145, v98, v99
    v_cvt_pk_bf16_f32 v146, v100, v101
    v_cvt_pk_bf16_f32 v147, v102, v103
    v_cvt_pk_bf16_f32 v148, v104, v105
    v_cvt_pk_bf16_f32 v149, v106, v107
    v_cvt_pk_bf16_f32 v150, v108, v109
    v_cvt_pk_bf16_f32 v151, v110, v111
    v_cvt_pk_bf16_f32 v152, v112, v113
    v_cvt_pk_bf16_f32 v153, v114, v115
    v_cvt_pk_bf16_f32 v154, v116, v117
    v_cvt_pk_bf16_f32 v155, v118, v119
    v_cvt_pk_bf16_f32 v156, v120, v121
    v_cvt_pk_bf16_f32 v157, v122, v123
    v_cvt_pk_bf16_f32 v158, v124, v125
    v_cvt_pk_bf16_f32 v159, v126, v127
    v_min_u32 v216, -2, v216
    v_min_u32 v217, -2, v217
    s_nop 0
    v_mov_b32_dpp v218, v216 quad_perm:[1,1,3,3] row_mask:0xf bank_mask:0xf
    v_mov_b32_dpp v219, v217 quad_perm:[1,1,3,3] row_mask:0xf bank_mask:0xf
    ds_write_b64 v5, v[128:129] offset:0
    ds_write_b64 v5, v[130:131] offset:16
    ds_write_b64 v5, v[132:133] offset:32
    ds_write_b64 v5, v[134:135] offset:48
    ds_write_b64 v5, v[136:137] offset:64
    ds_write_b64 v5, v[138:139] offset:80
    ds_write_b64 v5, v[140:141] offset:96
    ds_write_b64 v5, v[142:143] offset:112
    ds_write_b64 v5, v[144:145] offset:128
    ds_write_b64 v5, v[146:147] offset:144
    ds_write_b64 v5, v[148:149] offset:160
    ds_write_b64 v5, v[150:151] offset:176
    ds_write_b64 v5, v[152:153] offset:192
    ds_write_b64 v5, v[154:155] offset:208
    ds_write_b64 v5, v[156:157] offset:224
    ds_write_b64 v5, v[158:159] offset:240
    v_mul_u32_u24 v6, 272, v4
    v_lshl_add_u32 v6, v3, 4, v6
    v_add_u32 v6, s63, v6
    s_waitcnt lgkmcnt(0)
    ds_read_b128 v[64:67], v6 offset:0
    ds_read_b128 v[68:71], v6 offset:1088
    ds_read_b128 v[72:75], v6 offset:2176
    ds_read_b128 v[76:79], v6 offset:3264
    ds_read_b128 v[80:83], v6 offset:4352
    ds_read_b128 v[84:87], v6 offset:5440
    ds_read_b128 v[88:91], v6 offset:6528
    ds_read_b128 v[92:95], v6 offset:7616
    v_lshlrev_b32 v7, 10, v4
    v_lshl_add_u32 v7, v3, 4, v7
    s_lshl_b32 s54, s53, 15
    s_lshl_b32 s55, s3, 8
    s_add_u32 s54, s54, s55
    s_add_u32 s54, s54, 2097152
    s_waitcnt lgkmcnt(7)
    buffer_store_dwordx4 v[64:67], v7, s[44:47], s54 offen sc1
    s_add_u32 s54, s54, 4096
    s_waitcnt lgkmcnt(6)
    buffer_store_dwordx4 v[68:71], v7, s[44:47], s54 offen sc1
    s_add_u32 s54, s54, 4096
    s_waitcnt lgkmcnt(5)
    buffer_store_dwordx4 v[72:75], v7, s[44:47], s54 offen sc1
    s_add_u32 s54, s54, 4096
    s_waitcnt lgkmcnt(4)
    buffer_store_dwordx4 v[76:79], v7, s[44:47], s54 offen sc1
    s_add_u32 s54, s54, 4096
    s_waitcnt lgkmcnt(3)
    buffer_store_dwordx4 v[80:83], v7, s[44:47], s54 offen sc1
    s_add_u32 s54, s54, 4096
    s_waitcnt lgkmcnt(2)
    buffer_store_dwordx4 v[84:87], v7, s[44:47], s54 offen sc1
    s_add_u32 s54, s54, 4096
    s_waitcnt lgkmcnt(1)
    buffer_store_dwordx4 v[88:91], v7, s[44:47], s54 offen sc1
    s_add_u32 s54, s54, 4096
    s_waitcnt lgkmcnt(0)
    buffer_store_dwordx4 v[92:95], v7, s[44:47], s54 offen sc1
    s_add_u32 s54, s54, 4096
    v_lshlrev_b32 v5, 3, v1
    s_lshl_b32 s54, s53, 8
    s_add_u32 s54, s54, 3145728
    s_cmp_eq_u32 s3, 0
    s_cselect_b32 s56, 0x55555555, 0
    s_mov_b32 s57, 0
    s_waitcnt vmcnt(0)
    s_barrier
    s_mov_b64 exec, s[56:57]
    buffer_store_dwordx4 v[216:219], v5, s[44:47], s54 offen sc1
    s_mov_b64 exec, -1
    s_mov_b32 s48, s26
    s_mov_b32 s49, s27
    s_mov_b32 s50, 9216
    s_mov_b32 s51, 0x20000
    s_lshl_b32 s54, s3, 5
    s_add_u32 s54, s54, s53
    s_cmp_ge_u32 s54, 72
    s_cbranch_scc1 L_nored_38
    s_waitcnt vmcnt(0)
    v_mov_b32 v48, -1
    v_mov_b32 v49, -1
    v_mov_b32 v50, -1
    v_mov_b32 v51, -1
    v_mov_b32 v52, -1
    v_mov_b32 v53, -1
    v_mov_b32 v54, -1
    v_mov_b32 v55, -1
    v_mov_b32 v56, -1
    v_mov_b32 v57, -1
    v_mov_b32 v58, -1
    v_mov_b32 v59, -1
    v_mov_b32 v60, -1
    v_mov_b32 v61, -1
    v_mov_b32 v62, -1
    v_mov_b32 v63, -1
    s_lshl_b32 s55, s54, 12
    s_add_u32 s55, s55, 4194304
    s_mul_hi_u32 s56, s54, 238609295
    s_add_u32 s56, s56, 0
    s_mul_i32 s56, s56, 1152
    s_lshl_b32 s57, s54, 6
    s_add_u32 s56, s56, s57
    v_lshlrev_b32 v5, 3, v3
    v_lshl_add_u32 v5, v4, 1, v5
    v_mov_b32 v6, 0x4000
    v_cmp_gt_u32 vcc, 8, v3
    s_nop 1
    v_cndmask_b32 v5, v6, v5, vcc
    s_mov_b64 s[4:5], -1
    s_mov_b64 s[6:7], -1
    s_mov_b64 s[8:9], -1
    s_mov_b64 s[10:11], -1
L_mpoll_39:
    s_mov_b64 exec, s[4:5]
    buffer_load_dwordx4 v[48:51], v2, s[44:47], s55 offen offset:0 sc1
    s_mov_b64 exec, s[6:7]
    buffer_load_dwordx4 v[52:55], v2, s[44:47], s55 offen offset:1024 sc1
    s_mov_b64 exec, s[8:9]
    buffer_load_dwordx4 v[56:59], v2, s[44:47], s55 offen offset:2048 sc1
    s_mov_b64 exec, s[10:11]
    buffer_load_dwordx4 v[60:63], v2, s[44:47], s55 offen offset:3072 sc1
    s_mov_b64 exec, -1
    s_waitcnt vmcnt(4)
    v_max3_u32 v32, v48, v49, v50
    v_max3_u32 v33, v52, v53, v54
    v_max3_u32 v34, v56, v57, v58
    v_max3_u32 v35, v60, v61, v62
    v_max_u32 v32, v32, v51
    v_max_u32 v33, v33, v55
    v_max_u32 v34, v34, v59
    v_max_u32 v35, v35, v63
    v_cmp_eq_u32 s[4:5], -1, v32
    v_cmp_eq_u32 s[6:7], -1, v33
    v_cmp_eq_u32 s[8:9], -1, v34
    v_cmp_eq_u32 s[10:11], -1, v35
    s_or_b64 vcc, s[4:5], s[6:7]
    s_or_b64 vcc, vcc, s[8:9]
    s_or_b64 vcc, vcc, s[10:11]
    s_cbranch_scc0 L_mpollok_40
    s_and_b64 vcc, s[4:5], s[6:7]
    s_and_b64 vcc, vcc, s[8:9]
    s_and_b64 vcc, vcc, s[10:11]
    s_cmp_eq_u64 vcc, -1
    s_cbranch_scc0 L_mpoll_39_b
    s_sleep 4
L_mpoll_39_b:
    s_sub_u32 s101, s101, 1
    s_cbranch_scc0 L_mpoll_39
    s_mov_b32 s101, 0
L_mpollok_40:
    v_add_f32 v16, v48, v52
    v_add_f32 v24, v56, v60
    v_add_f32 v18, v50, v54
    v_add_f32 v26, v58, v62
    v_add_f32 v17, v49, v53
    v_add_f32 v25, v57, v61
    v_add_f32 v19, v51, v55
    v_add_f32 v27, v59, v63
    v_add_f32 v16, v16, v24
    v_add_f32 v18, v18, v26
    v_add_f32 v17, v17, v25
    v_add_f32 v19, v19, v27
    v_permlane32_swap_b32 v16, v18
    s_nop 0
    v_permlane32_swap_b32 v17, v19
    v_add_f32 v16, v16, v18
    v_add_f32 v17, v17, v19
    s_nop 1
    v_permlane16_swap_b32 v16, v17
    v_add_f32 v16, v16, v17
    s_nop 1
    v_add_f32_dpp v16, v16, v16 row_ror:8 row_mask:0xf bank_mask:0xf
    v_cvt_pk_bf16_f32 v16, v16, v16
    buffer_store_short v16, v5, s[48:51], s56 offen
L_nored_38:
    s_endpgm
L_roleC_end:
L_exit:
    s_endpgm
.section .rodata,"a"
.p2align 6
.amdhsa_kernel concat_heads__mha_block_cached__compressed_kv_cla__decode_kernel
  .amdhsa_next_free_vgpr 512
  .amdhsa_next_free_sgpr 102
  .amdhsa_accum_offset 256
  .amdhsa_group_segment_fixed_size 0
  .amdhsa_kernarg_size 112
  .amdhsa_user_sgpr_count 2
  .amdhsa_user_sgpr_kernarg_segment_ptr 1
  .amdhsa_system_sgpr_workgroup_id_x 1
.end_amdhsa_kernel
```

```asm
; @launch grid=(256,1,1) block=(256,1,1) lds=163840
.amdgcn_target "amdgcn-amd-amdhsa--gfx950"
.text
.globl concat_heads__mha_block_cached__compressed_kv_cla__decode_kernel
.p2align 12
.p2align 8
.type concat_heads__mha_block_cached__compressed_kv_cla__decode_kernel,@function
concat_heads__mha_block_cached__compressed_kv_cla__decode_kernel:
    s_cmp_ge_u32 s2, 256
    s_cbranch_scc1 L_exit
    s_load_dwordx16 s[4:19], s[0:1], 0
    s_load_dwordx8 s[20:27], s[0:1], 64
    s_load_dwordx4 s[28:31], s[0:1], 96
    v_lshrrev_b32 v2, 6, v0
    v_and_b32 v1, 63, v0
    v_readfirstlane_b32 s3, v2
    v_and_b32 v3, 15, v0
    v_bfe_u32 v4, v0, 4, 2
    v_lshlrev_b32 v2, 4, v1
    s_add_u32 s52, s2, 1
    s_and_b32 s52, s52, 31
    s_mov_b32 s53, s52
    s_cmp_lt_u32 s2, 32
    s_cbranch_scc1 L_roleH
    s_cmp_lt_u32 s2, 64
    s_cbranch_scc1 L_roleC
L_roleA:
    s_sub_u32 s54, s2, 64
    s_mul_hi_u32 s96, s54, 178956971
    s_mul_i32 s56, s96, 24
    s_sub_u32 s97, s54, s56
    s_lshr_b32 s55, s97, 3
    s_add_u32 s3, s3, s97
    s_add_u32 s3, s3, s55
    s_and_b32 s3, s3, 3
    s_add_u32 s56, s96, s3
    s_and_b32 s56, s56, 3
    s_lshr_b32 s55, s97, 3
    s_and_b32 s53, s97, 7
    s_lshl_b32 s96, s96, 2
    s_add_u32 s55, s55, s56
    s_add_u32 s55, s55, 1
    s_and_b32 s55, s55, 3
    s_add_u32 s52, s96, s55
    s_add_u32 s96, s96, s56
    s_lshl_b32 s100, s53, 11
    s_and_b32 s100, s100, 0x800
    s_lshl_b32 s55, s53, 12
    s_and_b32 s55, s55, 0x6000
    s_or_b32 s100, s100, s55
    s_lshl_b32 s55, s3, 25
    s_or_b32 s100, s100, s55
    s_lshl_b32 s55, s52, 20
    s_or_b32 s100, s100, s55
    s_lshl_b32 s58, s52, 2
    s_add_u32 s58, s58, s3
    s_mul_i32 s58, s58, 0
    s_lshl_b32 s61, s58, 9
    s_and_b32 s61, s61, 0x600
    s_lshl_b32 s55, s58, 15
    s_and_b32 s55, s55, 0xe0000
    s_or_b32 s61, s61, s55
    s_mov_b32 s58, 393216
    s_mov_b32 s59, 1048576
    s_and_b32 s99, s96, 28
    s_add_u32 s99, s99, s3
    s_mul_i32 s99, s99, 0
    s_mov_b32 s63, s53
    s_getpc_b64 s[56:57]
L_pc_1:
    s_sub_u32 s56, s56, L_pc_1-L_roleA
    s_subb_u32 s57, s57, 0
    v_lshlrev_b32 v5, 7, v0
    v_min_u32 v6, L_roleA_end-L_roleA-4, v5
    global_load_dword v56, v6, s[56:57]
    s_mov_b32 s53, 536870912
    v_cmp_eq_u32 vcc, 0, v1
    v_lshlrev_b32 v0, 4, v3
    v_and_b32 v5, 1, v4
    v_lshl_add_u32 v0, v5, 8, v0
    v_lshrrev_b32 v5, 1, v4
    v_lshl_add_u32 v0, v5, 12, v0
    v_add_u32 v18, 32768, v0
    v_add_u32 v48, 65536, v0
    v_add_u32 v49, 98304, v0
    s_waitcnt lgkmcnt(0)
    s_mov_b32 s32, s6
    s_mov_b32 s33, s7
    s_mov_b32 s34, 134217728
    s_mov_b32 s35, 0x20000
    s_mov_b32 s36, s8
    s_mov_b32 s37, s9
    s_mov_b32 s38, 134217728
    s_mov_b32 s39, 0x20000
    s_mov_b32 s44, s30
    s_mov_b32 s45, s31
    s_mov_b32 s46, 536870912
    s_mov_b32 s47, 0x20000
    s_or_b32 s60, s61, s100
    s_or_b32 s61, s61, 0xfff1f9ff
    s_add_u32 s61, s61, 1
    s_and_b32 s61, s61, 0xe0600
    buffer_load_dwordx4 v[64:67], v0, s[32:35], s60 offen nt
    buffer_load_dwordx4 v[68:71], v18, s[32:35], s60 offen nt
    buffer_load_dwordx4 v[72:75], v48, s[32:35], s60 offen nt
    buffer_load_dwordx4 v[76:79], v49, s[32:35], s60 offen nt
    s_or_b32 s60, s61, s100
    s_or_b32 s61, s61, 0xfff1f9ff
    s_add_u32 s61, s61, 1
    s_and_b32 s61, s61, 0xe0600
    buffer_load_dwordx4 v[80:83], v0, s[32:35], s60 offen nt
    buffer_load_dwordx4 v[84:87], v18, s[32:35], s60 offen nt
    buffer_load_dwordx4 v[88:91], v48, s[32:35], s60 offen nt
    buffer_load_dwordx4 v[92:95], v49, s[32:35], s60 offen nt
    s_or_b32 s60, s61, s100
    s_or_b32 s61, s61, 0xfff1f9ff
    s_add_u32 s61, s61, 1
    s_and_b32 s61, s61, 0xe0600
    buffer_load_dwordx4 v[96:99], v0, s[32:35], s60 offen nt
    buffer_load_dwordx4 v[100:103], v18, s[32:35], s60 offen nt
    buffer_load_dwordx4 v[104:107], v48, s[32:35], s60 offen nt
    buffer_load_dwordx4 v[108:111], v49, s[32:35], s60 offen nt
    s_or_b32 s60, s61, s100
    s_or_b32 s61, s61, 0xfff1f9ff
    s_add_u32 s61, s61, 1
    s_and_b32 s61, s61, 0xe0600
    buffer_load_dwordx4 v[112:115], v0, s[32:35], s60 offen nt
    buffer_load_dwordx4 v[116:119], v18, s[32:35], s60 offen nt
    buffer_load_dwordx4 v[120:123], v48, s[32:35], s60 offen nt
    buffer_load_dwordx4 v[124:127], v49, s[32:35], s60 offen nt
    s_or_b32 s60, s61, s100
    s_or_b32 s61, s61, 0xfff1f9ff
    s_add_u32 s61, s61, 1
    s_and_b32 s61, s61, 0xe0600
    buffer_load_dwordx4 v[128:131], v0, s[32:35], s60 offen nt
    buffer_load_dwordx4 v[132:135], v18, s[32:35], s60 offen nt
    buffer_load_dwordx4 v[136:139], v48, s[32:35], s60 offen nt
    buffer_load_dwordx4 v[140:143], v49, s[32:35], s60 offen nt
    s_or_b32 s60, s61, s100
    s_or_b32 s61, s61, 0xfff1f9ff
    s_add_u32 s61, s61, 1
    s_and_b32 s61, s61, 0xe0600
    buffer_load_dwordx4 v[144:147], v0, s[32:35], s60 offen nt
    buffer_load_dwordx4 v[148:151], v18, s[32:35], s60 offen nt
    buffer_load_dwordx4 v[152:155], v48, s[32:35], s60 offen nt
    buffer_load_dwordx4 v[156:159], v49, s[32:35], s60 offen nt
    s_or_b32 s60, s61, s100
    s_or_b32 s61, s61, 0xfff1f9ff
    s_add_u32 s61, s61, 1
    s_and_b32 s61, s61, 0xe0600
    buffer_load_dwordx4 v[160:163], v0, s[32:35], s60 offen nt
    buffer_load_dwordx4 v[164:167], v18, s[32:35], s60 offen nt
    buffer_load_dwordx4 v[168:171], v48, s[32:35], s60 offen nt
    buffer_load_dwordx4 v[172:175], v49, s[32:35], s60 offen nt
    s_or_b32 s60, s61, s100
    s_or_b32 s61, s61, 0xfff1f9ff
    s_add_u32 s61, s61, 1
    s_and_b32 s61, s61, 0xe0600
    buffer_load_dwordx4 v[176:179], v0, s[32:35], s60 offen nt
    buffer_load_dwordx4 v[180:183], v18, s[32:35], s60 offen nt
    buffer_load_dwordx4 v[184:187], v48, s[32:35], s60 offen nt
    buffer_load_dwordx4 v[188:191], v49, s[32:35], s60 offen nt
    s_or_b32 s60, s61, s100
    s_or_b32 s61, s61, 0xfff1f9ff
    s_add_u32 s61, s61, 1
    s_and_b32 s61, s61, 0xe0600
    buffer_load_dwordx4 v[192:195], v0, s[32:35], s60 offen nt
    buffer_load_dwordx4 v[196:199], v18, s[32:35], s60 offen nt
    buffer_load_dwordx4 v[200:203], v48, s[32:35], s60 offen nt
    buffer_load_dwordx4 v[204:207], v49, s[32:35], s60 offen nt
    s_or_b32 s60, s61, s100
    s_or_b32 s61, s61, 0xfff1f9ff
    s_add_u32 s61, s61, 1
    s_and_b32 s61, s61, 0xe0600
    buffer_load_dwordx4 v[208:211], v0, s[32:35], s60 offen nt
    buffer_load_dwordx4 v[212:215], v18, s[32:35], s60 offen nt
    buffer_load_dwordx4 v[216:219], v48, s[32:35], s60 offen nt
    buffer_load_dwordx4 v[220:223], v49, s[32:35], s60 offen nt
    s_or_b32 s60, s61, s100
    s_or_b32 s61, s61, 0xfff1f9ff
    s_add_u32 s61, s61, 1
    s_and_b32 s61, s61, 0xe0600
    buffer_load_dwordx4 v[224:227], v0, s[32:35], s60 offen nt
    buffer_load_dwordx4 v[228:231], v18, s[32:35], s60 offen nt
    buffer_load_dwordx4 v[232:235], v48, s[32:35], s60 offen nt
    buffer_load_dwordx4 v[236:239], v49, s[32:35], s60 offen nt
    s_or_b32 s60, s61, s100
    s_or_b32 s61, s61, 0xfff1f9ff
    s_add_u32 s61, s61, 1
    s_and_b32 s61, s61, 0xe0600
    buffer_load_dwordx4 v[240:243], v0, s[32:35], s60 offen nt
    buffer_load_dwordx4 v[244:247], v18, s[32:35], s60 offen nt
    buffer_load_dwordx4 v[248:251], v48, s[32:35], s60 offen nt
    buffer_load_dwordx4 v[252:255], v49, s[32:35], s60 offen nt
    s_or_b32 s60, s61, s100
    s_or_b32 s61, s61, 0xfff1f9ff
    s_add_u32 s61, s61, 1
    s_and_b32 s61, s61, 0xe0600
    buffer_load_dwordx4 a[0:3], v0, s[32:35], s60 offen nt
    buffer_load_dwordx4 a[4:7], v18, s[32:35], s60 offen nt
    buffer_load_dwordx4 a[8:11], v48, s[32:35], s60 offen nt
    buffer_load_dwordx4 a[12:15], v49, s[32:35], s60 offen nt
    s_or_b32 s60, s61, s100
    s_or_b32 s61, s61, 0xfff1f9ff
    s_add_u32 s61, s61, 1
    s_and_b32 s61, s61, 0xe0600
    buffer_load_dwordx4 a[16:19], v0, s[32:35], s60 offen nt
    buffer_load_dwordx4 a[20:23], v18, s[32:35], s60 offen nt
    buffer_load_dwordx4 a[24:27], v48, s[32:35], s60 offen nt
    buffer_load_dwordx4 a[28:31], v49, s[32:35], s60 offen nt
    s_sub_u32 s23, s2, 64
    s_and_b32 s26, s23, 7
    s_lshr_b32 s23, s23, 3
    s_mul_i32 s27, s23, 43
    s_lshr_b32 s27, s27, 8
    s_lshl_b32 s26, s26, 2
    s_add_u32 s26, s26, s27
    s_mul_i32 s27, s27, 6
    s_sub_u32 s23, s23, s27
    v_mov_b32 v58, 0
    s_load_dword s18, s[28:29], 0
    s_or_b32 s60, s61, s100
    s_or_b32 s61, s61, 0xfff1f9ff
    s_add_u32 s61, s61, 1
    s_and_b32 s61, s61, 0xe0600
    buffer_load_dwordx4 a[32:35], v0, s[32:35], s60 offen nt
    buffer_load_dwordx4 a[36:39], v18, s[32:35], s60 offen nt
    buffer_load_dwordx4 a[40:43], v48, s[32:35], s60 offen nt
    buffer_load_dwordx4 a[44:47], v49, s[32:35], s60 offen nt
    s_waitcnt vmcnt(56)
    s_or_b32 s60, s61, s100
    s_or_b32 s61, s61, 0xfff1f9ff
    s_add_u32 s61, s61, 1
    s_and_b32 s61, s61, 0xe0600
    buffer_load_dwordx4 a[48:51], v0, s[32:35], s60 offen nt
    buffer_load_dwordx4 a[52:55], v18, s[32:35], s60 offen nt
    buffer_load_dwordx4 a[56:59], v48, s[32:35], s60 offen nt
    buffer_load_dwordx4 a[60:63], v49, s[32:35], s60 offen nt
    s_waitcnt vmcnt(56)
    s_or_b32 s60, s61, s100
    s_or_b32 s61, s61, 0xfff1f9ff
    s_add_u32 s61, s61, 1
    s_and_b32 s61, s61, 0xe0600
    buffer_load_dwordx4 a[64:67], v0, s[32:35], s60 offen nt
    buffer_load_dwordx4 a[68:71], v18, s[32:35], s60 offen nt
    buffer_load_dwordx4 a[72:75], v48, s[32:35], s60 offen nt
    buffer_load_dwordx4 a[76:79], v49, s[32:35], s60 offen nt
    s_waitcnt vmcnt(56)
    s_or_b32 s60, s61, s100
    s_or_b32 s61, s61, 0xfff1f9ff
    s_add_u32 s61, s61, 1
    s_and_b32 s61, s61, 0xe0600
    buffer_load_dwordx4 a[80:83], v0, s[32:35], s60 offen nt
    buffer_load_dwordx4 a[84:87], v18, s[32:35], s60 offen nt
    buffer_load_dwordx4 a[88:91], v48, s[32:35], s60 offen nt
    buffer_load_dwordx4 a[92:95], v49, s[32:35], s60 offen nt
    v_and_b32 v5, 1, v3
    v_cmp_eq_u32 vcc, 1, v5
    v_mov_b32 v5, 0xffff
    v_mov_b32 v6, 0xffff0000
    v_cndmask_b32 v5, v5, v6, vcc
    v_lshrrev_b32 v6, 1, v3
    v_cmp_eq_u32 vcc, 0, v6
    s_nop 1
    v_cndmask_b32 v8, 0, v5, vcc
    v_cmp_eq_u32 vcc, 1, v6
    s_nop 1
    v_cndmask_b32 v9, 0, v5, vcc
    v_cmp_eq_u32 vcc, 2, v6
    s_nop 1
    v_cndmask_b32 v10, 0, v5, vcc
    v_cmp_eq_u32 vcc, 3, v6
    s_nop 1
    v_cndmask_b32 v11, 0, v5, vcc
    s_bitcmp1_b32 s23, 0
    s_cselect_b32 s40, s24, s12
    s_cselect_b32 s41, s25, s13
    s_cselect_b32 s25, 524288, 0
    s_add_u32 s25, s25, 4194304
    s_mov_b32 s42, 4718592
    s_mov_b32 s43, 0x20000
    s_lshr_b32 s54, s23, 1
    s_mul_i32 s54, s54, 3
    s_add_u32 s54, s54, s3
    s_and_b32 s23, s23, 1
    s_mul_i32 s24, s26, 147456
    s_lshl_b32 s55, s54, 7
    s_add_u32 s24, s24, s55
    s_lshl_b32 s54, s54, 13
    s_lshl_b32 s55, s26, 7
    s_add_u32 s54, s54, s55
    s_add_u32 s25, s25, s54
    s_lshl_b32 s27, s26, 10
    s_add_u32 s27, s27, 5439488
    s_lshl_b32 s22, s26, 2
    s_add_u32 s22, s22, s3
    s_lshl_b32 s22, s22, 13
    s_add_u32 s22, s22, 8388608
    s_lshr_b32 s55, s26, 2
    s_add_u32 s55, s55, s3
    s_and_b32 s55, s55, 3
    s_and_b32 s54, s26, 3
    s_cmp_eq_u32 s54, s55
    s_cselect_b32 s54, 7, 1
    s_cselect_b32 s55, 5, 1
    s_cselect_b32 s26, 2, 0
    s_or_b32 s23, s23, s26
    v_and_b32 v30, s54, v3
    v_min_u32 v30, s55, v30
    v_lshl_add_u32 v30, v30, 2, v4
    v_lshlrev_b32 v30, 4, v30
    v_add_u32 v30, 6144, v30
    v_lshrrev_b32 v19, 3, v3
    v_lshl_add_u32 v19, v19, 2, v4
    v_mul_u32_u24 v19, 9216, v19
    v_and_b32 v5, 7, v3
    v_lshl_add_u32 v19, v5, 4, v19
    v_mov_b32 v12, 0
    v_mov_b32 v13, 0
    v_mov_b32 v14, 0
    v_mov_b32 v15, 0
    v_mov_b32 v16, 0xff800000
    v_mov_b32 v17, 0
    v_lshlrev_b32 v59, 4, v3
    v_and_b32 v5, 1, v4
    s_lshl_b32 s54, s52, 2
    s_add_u32 s54, s54, s3
    s_lshl_b32 s54, s54, 13
    s_lshl_b32 s55, s96, 2
    s_add_u32 s55, s55, s3
    s_lshl_b32 s55, s55, 13
    v_cmp_eq_u32 vcc, 1, v5
    v_mov_b32 v6, s54
    v_mov_b32 v7, s55
    v_cndmask_b32 v6, v6, v7, vcc
    v_mov_b32 v20, s63
    v_mov_b32 v7, s97
    v_cndmask_b32 v7, v20, v7, vcc
    v_lshl_add_u32 v20, v7, 4, v3
    v_lshl_add_u32 v20, v20, 4, v6
    v_lshl_add_u32 v21, v7, 4, v6
    v_add_u32 v21, 6144, v21
    v_mov_b32 v7, s53
    v_cmp_eq_u32 vcc, 0, v3
    s_nop 1
    v_cndmask_b32 v21, v7, v21, vcc
    v_cmp_gt_u32 vcc, 32, v1
    s_nop 1
    v_cndmask_b32 v3, v21, v20, vcc
    s_mov_b32 s8, 919040
    s_mov_b32 s9, s100
    s_mov_b32 s10, 0xff000
    s_lshl_b32 s11, s3, 25
    s_lshl_b32 s54, s96, 20
    s_add_u32 s11, s11, s54
    s_andn2_b32 s9, s9, 0x6000
    s_lshl_b32 s54, s63, 13
    s_and_b32 s54, s54, 0x4000
    s_or_b32 s9, s9, s54
    s_lshl_b32 s54, s63, 11
    s_lshr_b32 s55, s100, 8
    s_xor_b32 s54, s54, s55
    s_and_b32 s54, s54, 0x2000
    s_or_b32 s9, s9, s54
    s_and_b32 s57, s96, 28
    s_add_u32 s57, s57, s3
    s_mul_i32 s57, s57, 256
    s_add_u32 s57, s57, 16777216
    s_lshl_b32 s54, s3, 8
    s_add_u32 s54, s54, 5242880
    s_lshl_b32 s56, s52, 10
    s_add_u32 s56, s56, s54
    s_lshl_b32 s12, s96, 10
    s_add_u32 s12, s12, s54
    s_mov_b32 s13, 0
    s_lshr_b32 s54, s97, 1
    s_mul_i32 s54, s54, 12
    s_bitcmp1_b32 s97, 0
    s_cselect_b32 s55, 8, 0
    s_cselect_b32 s20, 36, 40
    s_add_u32 s54, s54, s55
    s_add_u32 s54, s54, s99
    s_lshl_b32 s21, s54, 9
    s_and_b32 s21, s21, 0xe00
    s_lshl_b32 s55, s54, 10
    s_and_b32 s55, s55, 0x6000
    s_or_b32 s21, s21, s55
    s_lshl_b32 s55, s54, 12
    s_and_b32 s55, s55, 0xe0000
    s_or_b32 s21, s21, s55
    s_add_u32 s15, s59, 65536
    s_sub_u32 s14, s15, 131072
    s_mov_b32 s96, 1035273459
    s_mov_b32 s97, 1069066811
    s_mov_b32 s98, 0xffff0000
    s_mov_b32 s62, 2
    s_mov_b32 s101, 100000
    s_waitcnt lgkmcnt(0)
    s_cmp_lt_u32 s18, 1073741824
    s_cbranch_scc1 L_aflag
L_aflag_ok:
    s_and_b32 s54, s18, 0xfff
    s_bfe_u32 s55, s18, 0xc000c
    s_min_u32 s17, s54, s55
    s_max_u32 s54, s54, s55
    s_xor_b32 s55, s9, 0x2000
    s_cmp_ge_u32 s17, 42
    s_cselect_b32 s9, s9, s100
    s_cmp_le_u32 s54, 22
    s_cselect_b32 s9, s55, s9
    s_mov_b32 s18, 20
    s_mov_b64 s[6:7], s[8:9]
    s_mov_b32 s63, 0
    s_cmp_eq_u32 s3, 3
    s_cselect_b32 s19, -1, 256
    buffer_load_dwordx4 v[60:63], v59, s[44:47], s56 offen sc1
    s_waitcnt vmcnt(57)
    s_or_b32 s60, s61, s100
    s_or_b32 s61, s61, 0xfff1f9ff
    s_add_u32 s61, s61, 1
    s_and_b32 s61, s61, 0xe0600
    buffer_load_dwordx4 a[96:99], v0, s[32:35], s60 offen nt
    buffer_load_dwordx4 a[100:103], v18, s[32:35], s60 offen nt
    buffer_load_dwordx4 a[104:107], v48, s[32:35], s60 offen nt
    buffer_load_dwordx4 a[108:111], v49, s[32:35], s60 offen nt
    s_waitcnt vmcnt(57)
    s_or_b32 s60, s61, s100
    s_or_b32 s61, s61, 0xfff1f9ff
    s_add_u32 s61, s61, 1
    s_and_b32 s61, s61, 0xe0600
    buffer_load_dwordx4 a[112:115], v0, s[32:35], s60 offen nt
    buffer_load_dwordx4 a[116:119], v18, s[32:35], s60 offen nt
    buffer_load_dwordx4 a[120:123], v48, s[32:35], s60 offen nt
    buffer_load_dwordx4 a[124:127], v49, s[32:35], s60 offen nt
    s_waitcnt vmcnt(57)
    s_or_b32 s60, s61, s9
    s_or_b32 s61, s61, 0xfff1f9ff
    s_add_u32 s61, s61, 1
    s_and_b32 s61, s61, 0xe0600
    buffer_load_dwordx4 a[128:131], v0, s[32:35], s60 offen nt
    buffer_load_dwordx4 a[132:135], v18, s[32:35], s60 offen nt
    buffer_load_dwordx4 a[136:139], v48, s[32:35], s60 offen nt
    buffer_load_dwordx4 a[140:143], v49, s[32:35], s60 offen nt
    s_waitcnt vmcnt(57)
    s_or_b32 s60, s61, s9
    s_or_b32 s61, s61, 0xfff1f9ff
    s_add_u32 s61, s61, 1
    s_and_b32 s61, s61, 0xe0600
    buffer_load_dwordx4 a[144:147], v0, s[32:35], s60 offen nt
    buffer_load_dwordx4 a[148:151], v18, s[32:35], s60 offen nt
    buffer_load_dwordx4 a[152:155], v48, s[32:35], s60 offen nt
    buffer_load_dwordx4 a[156:159], v49, s[32:35], s60 offen nt
    s_waitcnt vmcnt(57)
    s_or_b32 s60, s61, s9
    s_or_b32 s61, s61, 0xfff1f9ff
    s_add_u32 s61, s61, 1
    s_and_b32 s61, s61, 0xe0600
    buffer_load_dwordx4 a[160:163], v0, s[32:35], s60 offen nt
    buffer_load_dwordx4 a[164:167], v18, s[32:35], s60 offen nt
    buffer_load_dwordx4 a[168:171], v48, s[32:35], s60 offen nt
    buffer_load_dwordx4 a[172:175], v49, s[32:35], s60 offen nt
    s_waitcnt vmcnt(57)
    s_or_b32 s60, s61, s9
    s_or_b32 s61, s61, 0xfff1f9ff
    s_add_u32 s61, s61, 1
    s_and_b32 s61, s61, 0xe0600
    buffer_load_dwordx4 a[176:179], v0, s[32:35], s60 offen nt
    buffer_load_dwordx4 a[180:183], v18, s[32:35], s60 offen nt
    buffer_load_dwordx4 a[184:187], v48, s[32:35], s60 offen nt
    buffer_load_dwordx4 a[188:191], v49, s[32:35], s60 offen nt
    s_waitcnt vmcnt(24)
L_aq1:
    v_max3_u32 v20, v60, v61, v62
    v_max_u32 v20, v20, v63
    v_cmp_eq_u32 vcc, -1, v20
    s_cbranch_vccz L_aq1_ok
    buffer_load_dwordx4 v[60:63], v59, s[44:47], s56 offen sc1
    s_waitcnt vmcnt(0)
    s_sub_u32 s101, s101, 1
    s_cbranch_scc0 L_aq1
    s_mov_b32 s101, 0
L_aq1_ok:
    v_mov_b32 v4, v60
    v_mov_b32 v5, v61
    v_mov_b32 v6, v62
    v_mov_b32 v7, v63
    s_mov_b32 s56, 1
    v_mov_b32 v57, v16
    buffer_load_dwordx4 v[60:63], v59, s[44:47], s12 offen sc1
    v_dot2_f32_bf16 v20, v64, v4, 0
    v_dot2_f32_bf16 v21, v68, v4, 0
    v_dot2_f32_bf16 v22, v72, v4, 0
    v_dot2_f32_bf16 v23, v76, v4, 0
    v_dot2_f32_bf16 v20, v65, v5, v20
    v_dot2_f32_bf16 v21, v69, v5, v21
    v_dot2_f32_bf16 v22, v73, v5, v22
    v_dot2_f32_bf16 v23, v77, v5, v23
    v_dot2_f32_bf16 v20, v66, v6, v20
    v_dot2_f32_bf16 v21, v70, v6, v21
    v_dot2_f32_bf16 v22, v74, v6, v22
    v_dot2_f32_bf16 v23, v78, v6, v23
    v_dot2_f32_bf16 v20, v67, v7, v20
    v_dot2_f32_bf16 v21, v71, v7, v21
    v_dot2_f32_bf16 v22, v75, v7, v22
    v_dot2_f32_bf16 v23, v79, v7, v23
    s_waitcnt vmcnt(5)
    s_or_b32 s60, s61, s9
    s_or_b32 s61, s61, 0xfff1f9ff
    s_add_u32 s61, s61, 1
    s_and_b32 s61, s61, 0xe0600
    buffer_load_dwordx4 v[64:67], v0, s[32:35], s60 offen nt
    buffer_load_dwordx4 v[68:71], v18, s[32:35], s60 offen nt
    buffer_load_dwordx4 v[72:75], v48, s[32:35], s60 offen nt
    buffer_load_dwordx4 v[76:79], v49, s[32:35], s60 offen nt
    v_add_f32_dpp v24, v20, v20 row_ror:8 row_mask:0xf bank_mask:0x3
    v_add_f32_dpp v25, v22, v22 row_ror:8 row_mask:0xf bank_mask:0x3
    v_add_f32_dpp v24, v21, v21 row_ror:8 row_mask:0xf bank_mask:0xc
    v_add_f32_dpp v25, v23, v23 row_ror:8 row_mask:0xf bank_mask:0xc
    s_nop 0
    v_add_f32_dpp v26, v24, v24 row_shl:4 row_mask:0xf bank_mask:0x5
    v_add_f32_dpp v26, v25, v25 row_shr:4 row_mask:0xf bank_mask:0xa
    s_nop 1
    v_add_f32_dpp v26, v26, v26 quad_perm:[1,0,3,2] row_mask:0xf bank_mask:0xf
    s_nop 1
    v_add_f32_dpp v26, v26, v26 quad_perm:[2,3,0,1] row_mask:0xf bank_mask:0xf
    v_cvt_pk_bf16_f32 v26, v26, v26
    v_and_b32 v26, s98, v26
    v_mul_f32 v26, s96, v26
    v_cvt_pk_bf16_f32 v26, v26, v26
    v_and_b32 v26, s98, v26
    v_max_f32 v16, v16, v26
    v_accvgpr_write_b32 a192, v26
    v_dot2_f32_bf16 v20, v80, v4, 0
    v_dot2_f32_bf16 v21, v84, v4, 0
    v_dot2_f32_bf16 v22, v88, v4, 0
    v_dot2_f32_bf16 v23, v92, v4, 0
    v_dot2_f32_bf16 v20, v81, v5, v20
    v_dot2_f32_bf16 v21, v85, v5, v21
    v_dot2_f32_bf16 v22, v89, v5, v22
    v_dot2_f32_bf16 v23, v93, v5, v23
    v_dot2_f32_bf16 v20, v82, v6, v20
    v_dot2_f32_bf16 v21, v86, v6, v21
    v_dot2_f32_bf16 v22, v90, v6, v22
    v_dot2_f32_bf16 v23, v94, v6, v23
    v_dot2_f32_bf16 v20, v83, v7, v20
    v_dot2_f32_bf16 v21, v87, v7, v21
    v_dot2_f32_bf16 v22, v91, v7, v22
    v_dot2_f32_bf16 v23, v95, v7, v23
    s_waitcnt vmcnt(5)
    s_or_b32 s60, s61, s9
    s_or_b32 s61, s61, 0xfff1f9ff
    s_add_u32 s61, s61, 1
    s_and_b32 s61, s61, 0xe0600
    buffer_load_dwordx4 v[80:83], v0, s[32:35], s60 offen nt
    buffer_load_dwordx4 v[84:87], v18, s[32:35], s60 offen nt
    buffer_load_dwordx4 v[88:91], v48, s[32:35], s60 offen nt
    buffer_load_dwordx4 v[92:95], v49, s[32:35], s60 offen nt
    v_add_f32_dpp v24, v20, v20 row_ror:8 row_mask:0xf bank_mask:0x3
    v_add_f32_dpp v25, v22, v22 row_ror:8 row_mask:0xf bank_mask:0x3
    v_add_f32_dpp v24, v21, v21 row_ror:8 row_mask:0xf bank_mask:0xc
    v_add_f32_dpp v25, v23, v23 row_ror:8 row_mask:0xf bank_mask:0xc
    s_nop 0
    v_add_f32_dpp v26, v24, v24 row_shl:4 row_mask:0xf bank_mask:0x5
    v_add_f32_dpp v26, v25, v25 row_shr:4 row_mask:0xf bank_mask:0xa
    s_nop 1
    v_add_f32_dpp v26, v26, v26 quad_perm:[1,0,3,2] row_mask:0xf bank_mask:0xf
    s_nop 1
    v_add_f32_dpp v26, v26, v26 quad_perm:[2,3,0,1] row_mask:0xf bank_mask:0xf
    v_cvt_pk_bf16_f32 v26, v26, v26
    v_and_b32 v26, s98, v26
    v_mul_f32 v26, s96, v26
    v_cvt_pk_bf16_f32 v26, v26, v26
    v_and_b32 v26, s98, v26
    v_max_f32 v16, v16, v26
    v_accvgpr_write_b32 a193, v26
    v_dot2_f32_bf16 v20, v96, v4, 0
    v_dot2_f32_bf16 v21, v100, v4, 0
    v_dot2_f32_bf16 v22, v104, v4, 0
    v_dot2_f32_bf16 v23, v108, v4, 0
    v_dot2_f32_bf16 v20, v97, v5, v20
    v_dot2_f32_bf16 v21, v101, v5, v21
    v_dot2_f32_bf16 v22, v105, v5, v22
    v_dot2_f32_bf16 v23, v109, v5, v23
    v_dot2_f32_bf16 v20, v98, v6, v20
    v_dot2_f32_bf16 v21, v102, v6, v21
    v_dot2_f32_bf16 v22, v106, v6, v22
    v_dot2_f32_bf16 v23, v110, v6, v23
    v_dot2_f32_bf16 v20, v99, v7, v20
    v_dot2_f32_bf16 v21, v103, v7, v21
    v_dot2_f32_bf16 v22, v107, v7, v22
    v_dot2_f32_bf16 v23, v111, v7, v23
    s_waitcnt vmcnt(5)
    s_or_b32 s60, s61, s9
    s_or_b32 s61, s61, 0xfff1f9ff
    s_add_u32 s61, s61, 1
    s_and_b32 s61, s61, 0xe0600
    buffer_load_dwordx4 v[96:99], v0, s[32:35], s60 offen nt
    buffer_load_dwordx4 v[100:103], v18, s[32:35], s60 offen nt
    buffer_load_dwordx4 v[104:107], v48, s[32:35], s60 offen nt
    buffer_load_dwordx4 v[108:111], v49, s[32:35], s60 offen nt
    v_add_f32_dpp v24, v20, v20 row_ror:8 row_mask:0xf bank_mask:0x3
    v_add_f32_dpp v25, v22, v22 row_ror:8 row_mask:0xf bank_mask:0x3
    v_add_f32_dpp v24, v21, v21 row_ror:8 row_mask:0xf bank_mask:0xc
    v_add_f32_dpp v25, v23, v23 row_ror:8 row_mask:0xf bank_mask:0xc
    s_nop 0
    v_add_f32_dpp v26, v24, v24 row_shl:4 row_mask:0xf bank_mask:0x5
    v_add_f32_dpp v26, v25, v25 row_shr:4 row_mask:0xf bank_mask:0xa
    s_nop 1
    v_add_f32_dpp v26, v26, v26 quad_perm:[1,0,3,2] row_mask:0xf bank_mask:0xf
    s_nop 1
    v_add_f32_dpp v26, v26, v26 quad_perm:[2,3,0,1] row_mask:0xf bank_mask:0xf
    v_cvt_pk_bf16_f32 v26, v26, v26
    v_and_b32 v26, s98, v26
    v_mul_f32 v26, s96, v26
    v_cvt_pk_bf16_f32 v26, v26, v26
    v_and_b32 v26, s98, v26
    v_max_f32 v16, v16, v26
    v_accvgpr_write_b32 a194, v26
    v_dot2_f32_bf16 v20, v112, v4, 0
    v_dot2_f32_bf16 v21, v116, v4, 0
    v_dot2_f32_bf16 v22, v120, v4, 0
    v_dot2_f32_bf16 v23, v124, v4, 0
    v_dot2_f32_bf16 v20, v113, v5, v20
    v_dot2_f32_bf16 v21, v117, v5, v21
    v_dot2_f32_bf16 v22, v121, v5, v22
    v_dot2_f32_bf16 v23, v125, v5, v23
    v_dot2_f32_bf16 v20, v114, v6, v20
    v_dot2_f32_bf16 v21, v118, v6, v21
    v_dot2_f32_bf16 v22, v122, v6, v22
    v_dot2_f32_bf16 v23, v126, v6, v23
    v_dot2_f32_bf16 v20, v115, v7, v20
    v_dot2_f32_bf16 v21, v119, v7, v21
    v_dot2_f32_bf16 v22, v123, v7, v22
    v_dot2_f32_bf16 v23, v127, v7, v23
    s_waitcnt vmcnt(5)
    s_or_b32 s60, s61, s9
    s_or_b32 s61, s61, 0xfff1f9ff
    s_add_u32 s61, s61, 1
    s_and_b32 s61, s61, 0xe0600
    buffer_load_dwordx4 v[112:115], v0, s[32:35], s60 offen nt
    buffer_load_dwordx4 v[116:119], v18, s[32:35], s60 offen nt
    buffer_load_dwordx4 v[120:123], v48, s[32:35], s60 offen nt
    buffer_load_dwordx4 v[124:127], v49, s[32:35], s60 offen nt
    v_add_f32_dpp v24, v20, v20 row_ror:8 row_mask:0xf bank_mask:0x3
    v_add_f32_dpp v25, v22, v22 row_ror:8 row_mask:0xf bank_mask:0x3
    v_add_f32_dpp v24, v21, v21 row_ror:8 row_mask:0xf bank_mask:0xc
    v_add_f32_dpp v25, v23, v23 row_ror:8 row_mask:0xf bank_mask:0xc
    s_nop 0
    v_add_f32_dpp v26, v24, v24 row_shl:4 row_mask:0xf bank_mask:0x5
    v_add_f32_dpp v26, v25, v25 row_shr:4 row_mask:0xf bank_mask:0xa
    s_nop 1
    v_add_f32_dpp v26, v26, v26 quad_perm:[1,0,3,2] row_mask:0xf bank_mask:0xf
    s_nop 1
    v_add_f32_dpp v26, v26, v26 quad_perm:[2,3,0,1] row_mask:0xf bank_mask:0xf
    v_cvt_pk_bf16_f32 v26, v26, v26
    v_and_b32 v26, s98, v26
    v_mul_f32 v26, s96, v26
    v_cvt_pk_bf16_f32 v26, v26, v26
    v_and_b32 v26, s98, v26
    v_max_f32 v16, v16, v26
    v_accvgpr_write_b32 a195, v26
    v_dot2_f32_bf16 v20, v128, v4, 0
    v_dot2_f32_bf16 v21, v132, v4, 0
    v_dot2_f32_bf16 v22, v136, v4, 0
    v_dot2_f32_bf16 v23, v140, v4, 0
    v_dot2_f32_bf16 v20, v129, v5, v20
    v_dot2_f32_bf16 v21, v133, v5, v21
    v_dot2_f32_bf16 v22, v137, v5, v22
    v_dot2_f32_bf16 v23, v141, v5, v23
    v_dot2_f32_bf16 v20, v130, v6, v20
    v_dot2_f32_bf16 v21, v134, v6, v21
    v_dot2_f32_bf16 v22, v138, v6, v22
    v_dot2_f32_bf16 v23, v142, v6, v23
    v_dot2_f32_bf16 v20, v131, v7, v20
    v_dot2_f32_bf16 v21, v135, v7, v21
    v_dot2_f32_bf16 v22, v139, v7, v22
    v_dot2_f32_bf16 v23, v143, v7, v23
    v_add_f32_dpp v24, v20, v20 row_ror:8 row_mask:0xf bank_mask:0x3
    s_nop 0
    v_add_f32_dpp v25, v22, v22 row_ror:8 row_mask:0xf bank_mask:0x3
    v_add_f32_dpp v24, v21, v21 row_ror:8 row_mask:0xf bank_mask:0xc
    v_add_f32_dpp v25, v23, v23 row_ror:8 row_mask:0xf bank_mask:0xc
    s_nop 0
    v_add_f32_dpp v26, v24, v24 row_shl:4 row_mask:0xf bank_mask:0x5
    v_add_f32_dpp v26, v25, v25 row_shr:4 row_mask:0xf bank_mask:0xa
    s_nop 1
    v_add_f32_dpp v26, v26, v26 quad_perm:[1,0,3,2] row_mask:0xf bank_mask:0xf
    s_nop 1
    v_add_f32_dpp v26, v26, v26 quad_perm:[2,3,0,1] row_mask:0xf bank_mask:0xf
    v_cvt_pk_bf16_f32 v26, v26, v26
    v_and_b32 v26, s98, v26
    v_mul_f32 v26, s96, v26
    v_cvt_pk_bf16_f32 v26, v26, v26
    v_and_b32 v26, s98, v26
    v_max_f32 v16, v16, v26
    v_accvgpr_write_b32 a196, v26
    v_dot2_f32_bf16 v20, v144, v4, 0
    v_dot2_f32_bf16 v21, v148, v4, 0
    v_dot2_f32_bf16 v22, v152, v4, 0
    v_dot2_f32_bf16 v23, v156, v4, 0
    v_dot2_f32_bf16 v20, v145, v5, v20
    v_dot2_f32_bf16 v21, v149, v5, v21
    v_dot2_f32_bf16 v22, v153, v5, v22
    v_dot2_f32_bf16 v23, v157, v5, v23
    v_dot2_f32_bf16 v20, v146, v6, v20
    v_dot2_f32_bf16 v21, v150, v6, v21
    v_dot2_f32_bf16 v22, v154, v6, v22
    v_dot2_f32_bf16 v23, v158, v6, v23
    v_dot2_f32_bf16 v20, v147, v7, v20
    v_dot2_f32_bf16 v21, v151, v7, v21
    v_dot2_f32_bf16 v22, v155, v7, v22
    v_dot2_f32_bf16 v23, v159, v7, v23
    v_add_f32_dpp v24, v20, v20 row_ror:8 row_mask:0xf bank_mask:0x3
    s_nop 0
    v_add_f32_dpp v25, v22, v22 row_ror:8 row_mask:0xf bank_mask:0x3
    v_add_f32_dpp v24, v21, v21 row_ror:8 row_mask:0xf bank_mask:0xc
    v_add_f32_dpp v25, v23, v23 row_ror:8 row_mask:0xf bank_mask:0xc
    s_nop 0
    v_add_f32_dpp v26, v24, v24 row_shl:4 row_mask:0xf bank_mask:0x5
    v_add_f32_dpp v26, v25, v25 row_shr:4 row_mask:0xf bank_mask:0xa
    s_nop 1
    v_add_f32_dpp v26, v26, v26 quad_perm:[1,0,3,2] row_mask:0xf bank_mask:0xf
    s_nop 1
    v_add_f32_dpp v26, v26, v26 quad_perm:[2,3,0,1] row_mask:0xf bank_mask:0xf
    v_cvt_pk_bf16_f32 v26, v26, v26
    v_and_b32 v26, s98, v26
    v_mul_f32 v26, s96, v26
    v_cvt_pk_bf16_f32 v26, v26, v26
    v_and_b32 v26, s98, v26
    v_max_f32 v16, v16, v26
    v_accvgpr_write_b32 a197, v26
    v_dot2_f32_bf16 v20, v160, v4, 0
    v_dot2_f32_bf16 v21, v164, v4, 0
    v_dot2_f32_bf16 v22, v168, v4, 0
    v_dot2_f32_bf16 v23, v172, v4, 0
    v_dot2_f32_bf16 v20, v161, v5, v20
    v_dot2_f32_bf16 v21, v165, v5, v21
    v_dot2_f32_bf16 v22, v169, v5, v22
    v_dot2_f32_bf16 v23, v173, v5, v23
    v_dot2_f32_bf16 v20, v162, v6, v20
    v_dot2_f32_bf16 v21, v166, v6, v21
    v_dot2_f32_bf16 v22, v170, v6, v22
    v_dot2_f32_bf16 v23, v174, v6, v23
    v_dot2_f32_bf16 v20, v163, v7, v20
    v_dot2_f32_bf16 v21, v167, v7, v21
    v_dot2_f32_bf16 v22, v171, v7, v22
    v_dot2_f32_bf16 v23, v175, v7, v23
    v_add_f32_dpp v24, v20, v20 row_ror:8 row_mask:0xf bank_mask:0x3
    s_nop 0
    v_add_f32_dpp v25, v22, v22 row_ror:8 row_mask:0xf bank_mask:0x3
    v_add_f32_dpp v24, v21, v21 row_ror:8 row_mask:0xf bank_mask:0xc
    v_add_f32_dpp v25, v23, v23 row_ror:8 row_mask:0xf bank_mask:0xc
    s_nop 0
    v_add_f32_dpp v26, v24, v24 row_shl:4 row_mask:0xf bank_mask:0x5
    v_add_f32_dpp v26, v25, v25 row_shr:4 row_mask:0xf bank_mask:0xa
    s_nop 1
    v_add_f32_dpp v26, v26, v26 quad_perm:[1,0,3,2] row_mask:0xf bank_mask:0xf
    s_nop 1
    v_add_f32_dpp v26, v26, v26 quad_perm:[2,3,0,1] row_mask:0xf bank_mask:0xf
    v_cvt_pk_bf16_f32 v26, v26, v26
    v_and_b32 v26, s98, v26
    v_mul_f32 v26, s96, v26
    v_cvt_pk_bf16_f32 v26, v26, v26
    v_and_b32 v26, s98, v26
    v_max_f32 v16, v16, v26
    v_accvgpr_write_b32 a198, v26
    s_waitcnt vmcnt(5)
    s_or_b32 s60, s61, s9
    s_or_b32 s61, s61, 0xfff1f9ff
    s_add_u32 s61, s61, 1
    s_and_b32 s61, s61, 0xe0600
    buffer_load_dwordx4 v[128:131], v0, s[32:35], s60 offen nt
    buffer_load_dwordx4 v[132:135], v18, s[32:35], s60 offen nt
    buffer_load_dwordx4 v[136:139], v48, s[32:35], s60 offen nt
    buffer_load_dwordx4 v[140:143], v49, s[32:35], s60 offen nt
    v_dot2_f32_bf16 v20, v176, v4, 0
    v_dot2_f32_bf16 v21, v180, v4, 0
    v_dot2_f32_bf16 v22, v184, v4, 0
    v_dot2_f32_bf16 v23, v188, v4, 0
    v_dot2_f32_bf16 v20, v177, v5, v20
    v_dot2_f32_bf16 v21, v181, v5, v21
    v_dot2_f32_bf16 v22, v185, v5, v22
    v_dot2_f32_bf16 v23, v189, v5, v23
    v_dot2_f32_bf16 v20, v178, v6, v20
    v_dot2_f32_bf16 v21, v182, v6, v21
    v_dot2_f32_bf16 v22, v186, v6, v22
    v_dot2_f32_bf16 v23, v190, v6, v23
    v_dot2_f32_bf16 v20, v179, v7, v20
    v_dot2_f32_bf16 v21, v183, v7, v21
    v_dot2_f32_bf16 v22, v187, v7, v22
    v_dot2_f32_bf16 v23, v191, v7, v23
    v_add_f32_dpp v24, v20, v20 row_ror:8 row_mask:0xf bank_mask:0x3
    s_nop 0
    v_add_f32_dpp v25, v22, v22 row_ror:8 row_mask:0xf bank_mask:0x3
    v_add_f32_dpp v24, v21, v21 row_ror:8 row_mask:0xf bank_mask:0xc
    v_add_f32_dpp v25, v23, v23 row_ror:8 row_mask:0xf bank_mask:0xc
    s_nop 0
    v_add_f32_dpp v26, v24, v24 row_shl:4 row_mask:0xf bank_mask:0x5
    v_add_f32_dpp v26, v25, v25 row_shr:4 row_mask:0xf bank_mask:0xa
    s_nop 1
    v_add_f32_dpp v26, v26, v26 quad_perm:[1,0,3,2] row_mask:0xf bank_mask:0xf
    s_nop 1
    v_add_f32_dpp v26, v26, v26 quad_perm:[2,3,0,1] row_mask:0xf bank_mask:0xf
    v_cvt_pk_bf16_f32 v26, v26, v26
    v_and_b32 v26, s98, v26
    v_mul_f32 v26, s96, v26
    v_cvt_pk_bf16_f32 v26, v26, v26
    v_and_b32 v26, s98, v26
    v_max_f32 v16, v16, v26
    v_accvgpr_write_b32 a199, v26
    v_dot2_f32_bf16 v20, v192, v4, 0
    v_dot2_f32_bf16 v21, v196, v4, 0
    v_dot2_f32_bf16 v22, v200, v4, 0
    v_dot2_f32_bf16 v23, v204, v4, 0
    v_dot2_f32_bf16 v20, v193, v5, v20
    v_dot2_f32_bf16 v21, v197, v5, v21
    v_dot2_f32_bf16 v22, v201, v5, v22
    v_dot2_f32_bf16 v23, v205, v5, v23
    v_dot2_f32_bf16 v20, v194, v6, v20
    v_dot2_f32_bf16 v21, v198, v6, v21
    v_dot2_f32_bf16 v22, v202, v6, v22
    v_dot2_f32_bf16 v23, v206, v6, v23
    v_dot2_f32_bf16 v20, v195, v7, v20
    v_dot2_f32_bf16 v21, v199, v7, v21
    v_dot2_f32_bf16 v22, v203, v7, v22
    v_dot2_f32_bf16 v23, v207, v7, v23
    v_add_f32_dpp v24, v20, v20 row_ror:8 row_mask:0xf bank_mask:0x3
    s_nop 0
    v_add_f32_dpp v25, v22, v22 row_ror:8 row_mask:0xf bank_mask:0x3
    v_add_f32_dpp v24, v21, v21 row_ror:8 row_mask:0xf bank_mask:0xc
    v_add_f32_dpp v25, v23, v23 row_ror:8 row_mask:0xf bank_mask:0xc
    s_nop 0
    v_add_f32_dpp v26, v24, v24 row_shl:4 row_mask:0xf bank_mask:0x5
    v_add_f32_dpp v26, v25, v25 row_shr:4 row_mask:0xf bank_mask:0xa
    s_nop 1
    v_add_f32_dpp v26, v26, v26 quad_perm:[1,0,3,2] row_mask:0xf bank_mask:0xf
    s_nop 1
    v_add_f32_dpp v26, v26, v26 quad_perm:[2,3,0,1] row_mask:0xf bank_mask:0xf
    v_cvt_pk_bf16_f32 v26, v26, v26
    v_and_b32 v26, s98, v26
    v_mul_f32 v26, s96, v26
    v_cvt_pk_bf16_f32 v26, v26, v26
    v_and_b32 v26, s98, v26
    v_max_f32 v16, v16, v26
    v_accvgpr_write_b32 a200, v26
    v_dot2_f32_bf16 v20, v208, v4, 0
    v_dot2_f32_bf16 v21, v212, v4, 0
    v_dot2_f32_bf16 v22, v216, v4, 0
    v_dot2_f32_bf16 v23, v220, v4, 0
    v_dot2_f32_bf16 v20, v209, v5, v20
    v_dot2_f32_bf16 v21, v213, v5, v21
    v_dot2_f32_bf16 v22, v217, v5, v22
    v_dot2_f32_bf16 v23, v221, v5, v23
    v_dot2_f32_bf16 v20, v210, v6, v20
    v_dot2_f32_bf16 v21, v214, v6, v21
    v_dot2_f32_bf16 v22, v218, v6, v22
    v_dot2_f32_bf16 v23, v222, v6, v23
    v_dot2_f32_bf16 v20, v211, v7, v20
    v_dot2_f32_bf16 v21, v215, v7, v21
    v_dot2_f32_bf16 v22, v219, v7, v22
    v_dot2_f32_bf16 v23, v223, v7, v23
    v_add_f32_dpp v24, v20, v20 row_ror:8 row_mask:0xf bank_mask:0x3
    s_nop 0
    v_add_f32_dpp v25, v22, v22 row_ror:8 row_mask:0xf bank_mask:0x3
    v_add_f32_dpp v24, v21, v21 row_ror:8 row_mask:0xf bank_mask:0xc
    v_add_f32_dpp v25, v23, v23 row_ror:8 row_mask:0xf bank_mask:0xc
    s_nop 0
    v_add_f32_dpp v26, v24, v24 row_shl:4 row_mask:0xf bank_mask:0x5
    v_add_f32_dpp v26, v25, v25 row_shr:4 row_mask:0xf bank_mask:0xa
    s_nop 1
    v_add_f32_dpp v26, v26, v26 quad_perm:[1,0,3,2] row_mask:0xf bank_mask:0xf
    s_nop 1
    v_add_f32_dpp v26, v26, v26 quad_perm:[2,3,0,1] row_mask:0xf bank_mask:0xf
    v_cvt_pk_bf16_f32 v26, v26, v26
    v_and_b32 v26, s98, v26
    v_mul_f32 v26, s96, v26
    v_cvt_pk_bf16_f32 v26, v26, v26
    v_and_b32 v26, s98, v26
    v_max_f32 v16, v16, v26
    v_accvgpr_write_b32 a201, v26
    s_waitcnt vmcnt(5)
    s_or_b32 s60, s61, s9
    s_or_b32 s61, s61, 0xfff1f9ff
    s_add_u32 s61, s61, 1
    s_and_b32 s61, s61, 0xe0600
    buffer_load_dwordx4 v[144:147], v0, s[32:35], s60 offen nt
    buffer_load_dwordx4 v[148:151], v18, s[32:35], s60 offen nt
    buffer_load_dwordx4 v[152:155], v48, s[32:35], s60 offen nt
    buffer_load_dwordx4 v[156:159], v49, s[32:35], s60 offen nt
    v_dot2_f32_bf16 v20, v224, v4, 0
    v_dot2_f32_bf16 v21, v228, v4, 0
    v_dot2_f32_bf16 v22, v232, v4, 0
    v_dot2_f32_bf16 v23, v236, v4, 0
    v_dot2_f32_bf16 v20, v225, v5, v20
    v_dot2_f32_bf16 v21, v229, v5, v21
    v_dot2_f32_bf16 v22, v233, v5, v22
    v_dot2_f32_bf16 v23, v237, v5, v23
    v_dot2_f32_bf16 v20, v226, v6, v20
    v_dot2_f32_bf16 v21, v230, v6, v21
    v_dot2_f32_bf16 v22, v234, v6, v22
    v_dot2_f32_bf16 v23, v238, v6, v23
    v_dot2_f32_bf16 v20, v227, v7, v20
    v_dot2_f32_bf16 v21, v231, v7, v21
    v_dot2_f32_bf16 v22, v235, v7, v22
    v_dot2_f32_bf16 v23, v239, v7, v23
    v_add_f32_dpp v24, v20, v20 row_ror:8 row_mask:0xf bank_mask:0x3
    s_nop 0
    v_add_f32_dpp v25, v22, v22 row_ror:8 row_mask:0xf bank_mask:0x3
    v_add_f32_dpp v24, v21, v21 row_ror:8 row_mask:0xf bank_mask:0xc
    v_add_f32_dpp v25, v23, v23 row_ror:8 row_mask:0xf bank_mask:0xc
    s_nop 0
    v_add_f32_dpp v26, v24, v24 row_shl:4 row_mask:0xf bank_mask:0x5
    v_add_f32_dpp v26, v25, v25 row_shr:4 row_mask:0xf bank_mask:0xa
    s_nop 1
    v_add_f32_dpp v26, v26, v26 quad_perm:[1,0,3,2] row_mask:0xf bank_mask:0xf
    s_nop 1
    v_add_f32_dpp v26, v26, v26 quad_perm:[2,3,0,1] row_mask:0xf bank_mask:0xf
    v_cvt_pk_bf16_f32 v26, v26, v26
    v_and_b32 v26, s98, v26
    v_mul_f32 v26, s96, v26
    v_cvt_pk_bf16_f32 v26, v26, v26
    v_and_b32 v26, s98, v26
    v_max_f32 v16, v16, v26
    v_accvgpr_write_b32 a202, v26
    v_dot2_f32_bf16 v20, v240, v4, 0
    v_dot2_f32_bf16 v21, v244, v4, 0
    v_dot2_f32_bf16 v22, v248, v4, 0
    v_dot2_f32_bf16 v23, v252, v4, 0
    v_dot2_f32_bf16 v20, v241, v5, v20
    v_dot2_f32_bf16 v21, v245, v5, v21
    v_dot2_f32_bf16 v22, v249, v5, v22
    v_dot2_f32_bf16 v23, v253, v5, v23
    v_dot2_f32_bf16 v20, v242, v6, v20
    v_dot2_f32_bf16 v21, v246, v6, v21
    v_dot2_f32_bf16 v22, v250, v6, v22
    v_dot2_f32_bf16 v23, v254, v6, v23
    v_dot2_f32_bf16 v20, v243, v7, v20
    v_dot2_f32_bf16 v21, v247, v7, v21
    v_dot2_f32_bf16 v22, v251, v7, v22
    v_dot2_f32_bf16 v23, v255, v7, v23
    v_add_f32_dpp v24, v20, v20 row_ror:8 row_mask:0xf bank_mask:0x3
    s_nop 0
    v_add_f32_dpp v25, v22, v22 row_ror:8 row_mask:0xf bank_mask:0x3
    v_add_f32_dpp v24, v21, v21 row_ror:8 row_mask:0xf bank_mask:0xc
    v_add_f32_dpp v25, v23, v23 row_ror:8 row_mask:0xf bank_mask:0xc
    s_nop 0
    v_add_f32_dpp v26, v24, v24 row_shl:4 row_mask:0xf bank_mask:0x5
    v_add_f32_dpp v26, v25, v25 row_shr:4 row_mask:0xf bank_mask:0xa
    s_nop 1
    v_add_f32_dpp v26, v26, v26 quad_perm:[1,0,3,2] row_mask:0xf bank_mask:0xf
    s_nop 1
    v_add_f32_dpp v26, v26, v26 quad_perm:[2,3,0,1] row_mask:0xf bank_mask:0xf
    v_cvt_pk_bf16_f32 v26, v26, v26
    v_and_b32 v26, s98, v26
    v_mul_f32 v26, s96, v26
    v_cvt_pk_bf16_f32 v26, v26, v26
    v_and_b32 v26, s98, v26
    v_max_f32 v16, v16, v26
    v_accvgpr_write_b32 a203, v26
    v_accvgpr_read_b32 v32, a0
    v_accvgpr_read_b32 v33, a1
    v_accvgpr_read_b32 v34, a2
    v_accvgpr_read_b32 v35, a3
    v_accvgpr_read_b32 v36, a4
    v_accvgpr_read_b32 v37, a5
    v_accvgpr_read_b32 v38, a6
    v_accvgpr_read_b32 v39, a7
    v_accvgpr_read_b32 v40, a8
    v_accvgpr_read_b32 v41, a9
    v_accvgpr_read_b32 v42, a10
    v_accvgpr_read_b32 v43, a11
    v_accvgpr_read_b32 v44, a12
    v_accvgpr_read_b32 v45, a13
    v_accvgpr_read_b32 v46, a14
    v_accvgpr_read_b32 v47, a15
    v_dot2_f32_bf16 v20, v32, v4, 0
    v_dot2_f32_bf16 v21, v36, v4, 0
    v_dot2_f32_bf16 v22, v40, v4, 0
    v_dot2_f32_bf16 v23, v44, v4, 0
    v_dot2_f32_bf16 v20, v33, v5, v20
    v_dot2_f32_bf16 v21, v37, v5, v21
    v_dot2_f32_bf16 v22, v41, v5, v22
    v_dot2_f32_bf16 v23, v45, v5, v23
    v_dot2_f32_bf16 v20, v34, v6, v20
    v_dot2_f32_bf16 v21, v38, v6, v21
    v_dot2_f32_bf16 v22, v42, v6, v22
    v_dot2_f32_bf16 v23, v46, v6, v23
    v_dot2_f32_bf16 v20, v35, v7, v20
    v_dot2_f32_bf16 v21, v39, v7, v21
    v_dot2_f32_bf16 v22, v43, v7, v22
    v_dot2_f32_bf16 v23, v47, v7, v23
    v_add_f32_dpp v24, v20, v20 row_ror:8 row_mask:0xf bank_mask:0x3
    s_nop 0
    v_add_f32_dpp v25, v22, v22 row_ror:8 row_mask:0xf bank_mask:0x3
    v_add_f32_dpp v24, v21, v21 row_ror:8 row_mask:0xf bank_mask:0xc
    v_add_f32_dpp v25, v23, v23 row_ror:8 row_mask:0xf bank_mask:0xc
    s_nop 0
    v_add_f32_dpp v26, v24, v24 row_shl:4 row_mask:0xf bank_mask:0x5
    v_add_f32_dpp v26, v25, v25 row_shr:4 row_mask:0xf bank_mask:0xa
    s_nop 1
    v_add_f32_dpp v26, v26, v26 quad_perm:[1,0,3,2] row_mask:0xf bank_mask:0xf
    s_nop 1
    v_add_f32_dpp v26, v26, v26 quad_perm:[2,3,0,1] row_mask:0xf bank_mask:0xf
    v_cvt_pk_bf16_f32 v26, v26, v26
    v_and_b32 v26, s98, v26
    v_mul_f32 v26, s96, v26
    v_cvt_pk_bf16_f32 v26, v26, v26
    v_and_b32 v26, s98, v26
    v_max_f32 v16, v16, v26
    v_accvgpr_write_b32 a204, v26
    s_waitcnt vmcnt(5)
    s_or_b32 s60, s61, s9
    s_or_b32 s61, s61, 0xfff1f9ff
    s_add_u32 s61, s61, 1
    s_and_b32 s61, s61, 0xe0600
    buffer_load_dwordx4 v[160:163], v0, s[32:35], s60 offen nt
    buffer_load_dwordx4 v[164:167], v18, s[32:35], s60 offen nt
    buffer_load_dwordx4 v[168:171], v48, s[32:35], s60 offen nt
    buffer_load_dwordx4 v[172:175], v49, s[32:35], s60 offen nt
    v_accvgpr_read_b32 v32, a16
    v_accvgpr_read_b32 v33, a17
    v_accvgpr_read_b32 v34, a18
    v_accvgpr_read_b32 v35, a19
    v_accvgpr_read_b32 v36, a20
    v_accvgpr_read_b32 v37, a21
    v_accvgpr_read_b32 v38, a22
    v_accvgpr_read_b32 v39, a23
    v_accvgpr_read_b32 v40, a24
    v_accvgpr_read_b32 v41, a25
    v_accvgpr_read_b32 v42, a26
    v_accvgpr_read_b32 v43, a27
    v_accvgpr_read_b32 v44, a28
    v_accvgpr_read_b32 v45, a29
    v_accvgpr_read_b32 v46, a30
    v_accvgpr_read_b32 v47, a31
    v_dot2_f32_bf16 v20, v32, v4, 0
    v_dot2_f32_bf16 v21, v36, v4, 0
    v_dot2_f32_bf16 v22, v40, v4, 0
    v_dot2_f32_bf16 v23, v44, v4, 0
    v_dot2_f32_bf16 v20, v33, v5, v20
    v_dot2_f32_bf16 v21, v37, v5, v21
    v_dot2_f32_bf16 v22, v41, v5, v22
    v_dot2_f32_bf16 v23, v45, v5, v23
    v_dot2_f32_bf16 v20, v34, v6, v20
    v_dot2_f32_bf16 v21, v38, v6, v21
    v_dot2_f32_bf16 v22, v42, v6, v22
    v_dot2_f32_bf16 v23, v46, v6, v23
    v_dot2_f32_bf16 v20, v35, v7, v20
    v_dot2_f32_bf16 v21, v39, v7, v21
    v_dot2_f32_bf16 v22, v43, v7, v22
    v_dot2_f32_bf16 v23, v47, v7, v23
    v_add_f32_dpp v24, v20, v20 row_ror:8 row_mask:0xf bank_mask:0x3
    s_nop 0
    v_add_f32_dpp v25, v22, v22 row_ror:8 row_mask:0xf bank_mask:0x3
    v_add_f32_dpp v24, v21, v21 row_ror:8 row_mask:0xf bank_mask:0xc
    v_add_f32_dpp v25, v23, v23 row_ror:8 row_mask:0xf bank_mask:0xc
    s_nop 0
    v_add_f32_dpp v26, v24, v24 row_shl:4 row_mask:0xf bank_mask:0x5
    v_add_f32_dpp v26, v25, v25 row_shr:4 row_mask:0xf bank_mask:0xa
    s_nop 1
    v_add_f32_dpp v26, v26, v26 quad_perm:[1,0,3,2] row_mask:0xf bank_mask:0xf
    s_nop 1
    v_add_f32_dpp v26, v26, v26 quad_perm:[2,3,0,1] row_mask:0xf bank_mask:0xf
    v_cvt_pk_bf16_f32 v26, v26, v26
    v_and_b32 v26, s98, v26
    v_mul_f32 v26, s96, v26
    v_cvt_pk_bf16_f32 v26, v26, v26
    v_and_b32 v26, s98, v26
    v_max_f32 v16, v16, v26
    v_accvgpr_write_b32 a205, v26
    v_accvgpr_read_b32 v32, a32
    v_accvgpr_read_b32 v33, a33
    v_accvgpr_read_b32 v34, a34
    v_accvgpr_read_b32 v35, a35
    v_accvgpr_read_b32 v36, a36
    v_accvgpr_read_b32 v37, a37
    v_accvgpr_read_b32 v38, a38
    v_accvgpr_read_b32 v39, a39
    v_accvgpr_read_b32 v40, a40
    v_accvgpr_read_b32 v41, a41
    v_accvgpr_read_b32 v42, a42
    v_accvgpr_read_b32 v43, a43
    v_accvgpr_read_b32 v44, a44
    v_accvgpr_read_b32 v45, a45
    v_accvgpr_read_b32 v46, a46
    v_accvgpr_read_b32 v47, a47
    v_dot2_f32_bf16 v20, v32, v4, 0
    v_dot2_f32_bf16 v21, v36, v4, 0
    v_dot2_f32_bf16 v22, v40, v4, 0
    v_dot2_f32_bf16 v23, v44, v4, 0
    v_dot2_f32_bf16 v20, v33, v5, v20
    v_dot2_f32_bf16 v21, v37, v5, v21
    v_dot2_f32_bf16 v22, v41, v5, v22
    v_dot2_f32_bf16 v23, v45, v5, v23
    v_dot2_f32_bf16 v20, v34, v6, v20
    v_dot2_f32_bf16 v21, v38, v6, v21
    v_dot2_f32_bf16 v22, v42, v6, v22
    v_dot2_f32_bf16 v23, v46, v6, v23
    v_dot2_f32_bf16 v20, v35, v7, v20
    v_dot2_f32_bf16 v21, v39, v7, v21
    v_dot2_f32_bf16 v22, v43, v7, v22
    v_dot2_f32_bf16 v23, v47, v7, v23
    v_add_f32_dpp v24, v20, v20 row_ror:8 row_mask:0xf bank_mask:0x3
    s_nop 0
    v_add_f32_dpp v25, v22, v22 row_ror:8 row_mask:0xf bank_mask:0x3
    v_add_f32_dpp v24, v21, v21 row_ror:8 row_mask:0xf bank_mask:0xc
    v_add_f32_dpp v25, v23, v23 row_ror:8 row_mask:0xf bank_mask:0xc
    s_nop 0
    v_add_f32_dpp v26, v24, v24 row_shl:4 row_mask:0xf bank_mask:0x5
    v_add_f32_dpp v26, v25, v25 row_shr:4 row_mask:0xf bank_mask:0xa
    s_nop 1
    v_add_f32_dpp v26, v26, v26 quad_perm:[1,0,3,2] row_mask:0xf bank_mask:0xf
    s_nop 1
    v_add_f32_dpp v26, v26, v26 quad_perm:[2,3,0,1] row_mask:0xf bank_mask:0xf
    v_cvt_pk_bf16_f32 v26, v26, v26
    v_and_b32 v26, s98, v26
    v_mul_f32 v26, s96, v26
    v_cvt_pk_bf16_f32 v26, v26, v26
    v_and_b32 v26, s98, v26
    v_max_f32 v16, v16, v26
    v_accvgpr_write_b32 a206, v26
    v_accvgpr_read_b32 v32, a48
    v_accvgpr_read_b32 v33, a49
    v_accvgpr_read_b32 v34, a50
    v_accvgpr_read_b32 v35, a51
    v_accvgpr_read_b32 v36, a52
    v_accvgpr_read_b32 v37, a53
    v_accvgpr_read_b32 v38, a54
    v_accvgpr_read_b32 v39, a55
    v_accvgpr_read_b32 v40, a56
    v_accvgpr_read_b32 v41, a57
    v_accvgpr_read_b32 v42, a58
    v_accvgpr_read_b32 v43, a59
    v_accvgpr_read_b32 v44, a60
    v_accvgpr_read_b32 v45, a61
    v_accvgpr_read_b32 v46, a62
    v_accvgpr_read_b32 v47, a63
    v_dot2_f32_bf16 v20, v32, v4, 0
    v_dot2_f32_bf16 v21, v36, v4, 0
    v_dot2_f32_bf16 v22, v40, v4, 0
    v_dot2_f32_bf16 v23, v44, v4, 0
    v_dot2_f32_bf16 v20, v33, v5, v20
    v_dot2_f32_bf16 v21, v37, v5, v21
    v_dot2_f32_bf16 v22, v41, v5, v22
    v_dot2_f32_bf16 v23, v45, v5, v23
    v_dot2_f32_bf16 v20, v34, v6, v20
    v_dot2_f32_bf16 v21, v38, v6, v21
    v_dot2_f32_bf16 v22, v42, v6, v22
    v_dot2_f32_bf16 v23, v46, v6, v23
    v_dot2_f32_bf16 v20, v35, v7, v20
    v_dot2_f32_bf16 v21, v39, v7, v21
    v_dot2_f32_bf16 v22, v43, v7, v22
    v_dot2_f32_bf16 v23, v47, v7, v23
    v_add_f32_dpp v24, v20, v20 row_ror:8 row_mask:0xf bank_mask:0x3
    s_nop 0
    v_add_f32_dpp v25, v22, v22 row_ror:8 row_mask:0xf bank_mask:0x3
    v_add_f32_dpp v24, v21, v21 row_ror:8 row_mask:0xf bank_mask:0xc
    v_add_f32_dpp v25, v23, v23 row_ror:8 row_mask:0xf bank_mask:0xc
    s_nop 0
    v_add_f32_dpp v26, v24, v24 row_shl:4 row_mask:0xf bank_mask:0x5
    v_add_f32_dpp v26, v25, v25 row_shr:4 row_mask:0xf bank_mask:0xa
    s_nop 1
    v_add_f32_dpp v26, v26, v26 quad_perm:[1,0,3,2] row_mask:0xf bank_mask:0xf
    s_nop 1
    v_add_f32_dpp v26, v26, v26 quad_perm:[2,3,0,1] row_mask:0xf bank_mask:0xf
    v_cvt_pk_bf16_f32 v26, v26, v26
    v_and_b32 v26, s98, v26
    v_mul_f32 v26, s96, v26
    v_cvt_pk_bf16_f32 v26, v26, v26
    v_and_b32 v26, s98, v26
    v_max_f32 v16, v16, v26
    v_accvgpr_write_b32 a207, v26
    s_waitcnt vmcnt(5)
    s_or_b32 s60, s61, s9
    s_or_b32 s61, s61, 0xfff1f9ff
    s_add_u32 s61, s61, 1
    s_and_b32 s61, s61, 0xe0600
    buffer_load_dwordx4 v[176:179], v0, s[32:35], s60 offen nt
    buffer_load_dwordx4 v[180:183], v18, s[32:35], s60 offen nt
    buffer_load_dwordx4 v[184:187], v48, s[32:35], s60 offen nt
    buffer_load_dwordx4 v[188:191], v49, s[32:35], s60 offen nt
    v_accvgpr_read_b32 v32, a64
    v_accvgpr_read_b32 v33, a65
    v_accvgpr_read_b32 v34, a66
    v_accvgpr_read_b32 v35, a67
    v_accvgpr_read_b32 v36, a68
    v_accvgpr_read_b32 v37, a69
    v_accvgpr_read_b32 v38, a70
    v_accvgpr_read_b32 v39, a71
    v_accvgpr_read_b32 v40, a72
    v_accvgpr_read_b32 v41, a73
    v_accvgpr_read_b32 v42, a74
    v_accvgpr_read_b32 v43, a75
    v_accvgpr_read_b32 v44, a76
    v_accvgpr_read_b32 v45, a77
    v_accvgpr_read_b32 v46, a78
    v_accvgpr_read_b32 v47, a79
    v_dot2_f32_bf16 v20, v32, v4, 0
    v_dot2_f32_bf16 v21, v36, v4, 0
    v_dot2_f32_bf16 v22, v40, v4, 0
    v_dot2_f32_bf16 v23, v44, v4, 0
    v_dot2_f32_bf16 v20, v33, v5, v20
    v_dot2_f32_bf16 v21, v37, v5, v21
    v_dot2_f32_bf16 v22, v41, v5, v22
    v_dot2_f32_bf16 v23, v45, v5, v23
    v_dot2_f32_bf16 v20, v34, v6, v20
    v_dot2_f32_bf16 v21, v38, v6, v21
    v_dot2_f32_bf16 v22, v42, v6, v22
    v_dot2_f32_bf16 v23, v46, v6, v23
    v_dot2_f32_bf16 v20, v35, v7, v20
    v_dot2_f32_bf16 v21, v39, v7, v21
    v_dot2_f32_bf16 v22, v43, v7, v22
    v_dot2_f32_bf16 v23, v47, v7, v23
    v_add_f32_dpp v24, v20, v20 row_ror:8 row_mask:0xf bank_mask:0x3
    s_nop 0
    v_add_f32_dpp v25, v22, v22 row_ror:8 row_mask:0xf bank_mask:0x3
    v_add_f32_dpp v24, v21, v21 row_ror:8 row_mask:0xf bank_mask:0xc
    v_add_f32_dpp v25, v23, v23 row_ror:8 row_mask:0xf bank_mask:0xc
    s_nop 0
    v_add_f32_dpp v26, v24, v24 row_shl:4 row_mask:0xf bank_mask:0x5
    v_add_f32_dpp v26, v25, v25 row_shr:4 row_mask:0xf bank_mask:0xa
    s_nop 1
    v_add_f32_dpp v26, v26, v26 quad_perm:[1,0,3,2] row_mask:0xf bank_mask:0xf
    s_nop 1
    v_add_f32_dpp v26, v26, v26 quad_perm:[2,3,0,1] row_mask:0xf bank_mask:0xf
    v_cvt_pk_bf16_f32 v26, v26, v26
    v_and_b32 v26, s98, v26
    v_mul_f32 v26, s96, v26
    v_cvt_pk_bf16_f32 v26, v26, v26
    v_and_b32 v26, s98, v26
    v_max_f32 v16, v16, v26
    v_accvgpr_write_b32 a208, v26
    v_accvgpr_read_b32 v32, a80
    v_accvgpr_read_b32 v33, a81
    v_accvgpr_read_b32 v34, a82
    v_accvgpr_read_b32 v35, a83
    v_accvgpr_read_b32 v36, a84
    v_accvgpr_read_b32 v37, a85
    v_accvgpr_read_b32 v38, a86
    v_accvgpr_read_b32 v39, a87
    v_accvgpr_read_b32 v40, a88
    v_accvgpr_read_b32 v41, a89
    v_accvgpr_read_b32 v42, a90
    v_accvgpr_read_b32 v43, a91
    v_accvgpr_read_b32 v44, a92
    v_accvgpr_read_b32 v45, a93
    v_accvgpr_read_b32 v46, a94
    v_accvgpr_read_b32 v47, a95
    v_dot2_f32_bf16 v20, v32, v4, 0
    v_dot2_f32_bf16 v21, v36, v4, 0
    v_dot2_f32_bf16 v22, v40, v4, 0
    v_dot2_f32_bf16 v23, v44, v4, 0
    v_dot2_f32_bf16 v20, v33, v5, v20
    v_dot2_f32_bf16 v21, v37, v5, v21
    v_dot2_f32_bf16 v22, v41, v5, v22
    v_dot2_f32_bf16 v23, v45, v5, v23
    v_dot2_f32_bf16 v20, v34, v6, v20
    v_dot2_f32_bf16 v21, v38, v6, v21
    v_dot2_f32_bf16 v22, v42, v6, v22
    v_dot2_f32_bf16 v23, v46, v6, v23
    v_dot2_f32_bf16 v20, v35, v7, v20
    v_dot2_f32_bf16 v21, v39, v7, v21
    v_dot2_f32_bf16 v22, v43, v7, v22
    v_dot2_f32_bf16 v23, v47, v7, v23
    v_add_f32_dpp v24, v20, v20 row_ror:8 row_mask:0xf bank_mask:0x3
    s_nop 0
    v_add_f32_dpp v25, v22, v22 row_ror:8 row_mask:0xf bank_mask:0x3
    v_add_f32_dpp v24, v21, v21 row_ror:8 row_mask:0xf bank_mask:0xc
    v_add_f32_dpp v25, v23, v23 row_ror:8 row_mask:0xf bank_mask:0xc
    s_nop 0
    v_add_f32_dpp v26, v24, v24 row_shl:4 row_mask:0xf bank_mask:0x5
    v_add_f32_dpp v26, v25, v25 row_shr:4 row_mask:0xf bank_mask:0xa
    s_nop 1
    v_add_f32_dpp v26, v26, v26 quad_perm:[1,0,3,2] row_mask:0xf bank_mask:0xf
    s_nop 1
    v_add_f32_dpp v26, v26, v26 quad_perm:[2,3,0,1] row_mask:0xf bank_mask:0xf
    v_cvt_pk_bf16_f32 v26, v26, v26
    v_and_b32 v26, s98, v26
    v_mul_f32 v26, s96, v26
    v_cvt_pk_bf16_f32 v26, v26, v26
    v_and_b32 v26, s98, v26
    v_max_f32 v16, v16, v26
    v_accvgpr_write_b32 a209, v26
    v_accvgpr_read_b32 v32, a96
    v_accvgpr_read_b32 v33, a97
    v_accvgpr_read_b32 v34, a98
    v_accvgpr_read_b32 v35, a99
    v_accvgpr_read_b32 v36, a100
    v_accvgpr_read_b32 v37, a101
    v_accvgpr_read_b32 v38, a102
    v_accvgpr_read_b32 v39, a103
    v_accvgpr_read_b32 v40, a104
    v_accvgpr_read_b32 v41, a105
    v_accvgpr_read_b32 v42, a106
    v_accvgpr_read_b32 v43, a107
    v_accvgpr_read_b32 v44, a108
    v_accvgpr_read_b32 v45, a109
    v_accvgpr_read_b32 v46, a110
    v_accvgpr_read_b32 v47, a111
    v_dot2_f32_bf16 v20, v32, v4, 0
    v_dot2_f32_bf16 v21, v36, v4, 0
    v_dot2_f32_bf16 v22, v40, v4, 0
    v_dot2_f32_bf16 v23, v44, v4, 0
    v_dot2_f32_bf16 v20, v33, v5, v20
    v_dot2_f32_bf16 v21, v37, v5, v21
    v_dot2_f32_bf16 v22, v41, v5, v22
    v_dot2_f32_bf16 v23, v45, v5, v23
    v_dot2_f32_bf16 v20, v34, v6, v20
    v_dot2_f32_bf16 v21, v38, v6, v21
    v_dot2_f32_bf16 v22, v42, v6, v22
    v_dot2_f32_bf16 v23, v46, v6, v23
    v_dot2_f32_bf16 v20, v35, v7, v20
    v_dot2_f32_bf16 v21, v39, v7, v21
    v_dot2_f32_bf16 v22, v43, v7, v22
    v_dot2_f32_bf16 v23, v47, v7, v23
    v_add_f32_dpp v24, v20, v20 row_ror:8 row_mask:0xf bank_mask:0x3
    s_nop 0
    v_add_f32_dpp v25, v22, v22 row_ror:8 row_mask:0xf bank_mask:0x3
    v_add_f32_dpp v24, v21, v21 row_ror:8 row_mask:0xf bank_mask:0xc
    v_add_f32_dpp v25, v23, v23 row_ror:8 row_mask:0xf bank_mask:0xc
    s_nop 0
    v_add_f32_dpp v26, v24, v24 row_shl:4 row_mask:0xf bank_mask:0x5
    v_add_f32_dpp v26, v25, v25 row_shr:4 row_mask:0xf bank_mask:0xa
    s_nop 1
    v_add_f32_dpp v26, v26, v26 quad_perm:[1,0,3,2] row_mask:0xf bank_mask:0xf
    s_nop 1
    v_add_f32_dpp v26, v26, v26 quad_perm:[2,3,0,1] row_mask:0xf bank_mask:0xf
    v_cvt_pk_bf16_f32 v26, v26, v26
    v_and_b32 v26, s98, v26
    v_mul_f32 v26, s96, v26
    v_cvt_pk_bf16_f32 v26, v26, v26
    v_and_b32 v26, s98, v26
    v_max_f32 v16, v16, v26
    v_accvgpr_write_b32 a210, v26
    s_waitcnt vmcnt(5)
    s_mov_b32 s15, s61
    s_mov_b32 s61, s21
    s_mov_b32 s6, 0xe6e00
    s_mov_b32 s7, s11
    s_or_b32 s60, s61, s7
    s_orn2_b32 s61, s61, s6
    s_add_u32 s61, s61, 1
    s_and_b32 s61, s61, s6
    buffer_load_dwordx4 v[192:195], v0, s[32:35], s60 offen nt
    buffer_load_dwordx4 v[196:199], v18, s[32:35], s60 offen nt
    buffer_load_dwordx4 v[200:203], v48, s[32:35], s60 offen nt
    buffer_load_dwordx4 v[204:207], v49, s[32:35], s60 offen nt
    v_accvgpr_read_b32 v32, a112
    v_accvgpr_read_b32 v33, a113
    v_accvgpr_read_b32 v34, a114
    v_accvgpr_read_b32 v35, a115
    v_accvgpr_read_b32 v36, a116
    v_accvgpr_read_b32 v37, a117
    v_accvgpr_read_b32 v38, a118
    v_accvgpr_read_b32 v39, a119
    v_accvgpr_read_b32 v40, a120
    v_accvgpr_read_b32 v41, a121
    v_accvgpr_read_b32 v42, a122
    v_accvgpr_read_b32 v43, a123
    v_accvgpr_read_b32 v44, a124
    v_accvgpr_read_b32 v45, a125
    v_accvgpr_read_b32 v46, a126
    v_accvgpr_read_b32 v47, a127
    v_dot2_f32_bf16 v20, v32, v4, 0
    v_dot2_f32_bf16 v21, v36, v4, 0
    v_dot2_f32_bf16 v22, v40, v4, 0
    v_dot2_f32_bf16 v23, v44, v4, 0
    v_dot2_f32_bf16 v20, v33, v5, v20
    v_dot2_f32_bf16 v21, v37, v5, v21
    v_dot2_f32_bf16 v22, v41, v5, v22
    v_dot2_f32_bf16 v23, v45, v5, v23
    v_dot2_f32_bf16 v20, v34, v6, v20
    v_dot2_f32_bf16 v21, v38, v6, v21
    v_dot2_f32_bf16 v22, v42, v6, v22
    v_dot2_f32_bf16 v23, v46, v6, v23
    v_dot2_f32_bf16 v20, v35, v7, v20
    v_dot2_f32_bf16 v21, v39, v7, v21
    v_dot2_f32_bf16 v22, v43, v7, v22
    v_dot2_f32_bf16 v23, v47, v7, v23
    v_add_f32_dpp v24, v20, v20 row_ror:8 row_mask:0xf bank_mask:0x3
    s_nop 0
    v_add_f32_dpp v25, v22, v22 row_ror:8 row_mask:0xf bank_mask:0x3
    v_add_f32_dpp v24, v21, v21 row_ror:8 row_mask:0xf bank_mask:0xc
    v_add_f32_dpp v25, v23, v23 row_ror:8 row_mask:0xf bank_mask:0xc
    s_nop 0
    v_add_f32_dpp v26, v24, v24 row_shl:4 row_mask:0xf bank_mask:0x5
    v_add_f32_dpp v26, v25, v25 row_shr:4 row_mask:0xf bank_mask:0xa
    s_nop 1
    v_add_f32_dpp v26, v26, v26 quad_perm:[1,0,3,2] row_mask:0xf bank_mask:0xf
    s_nop 1
    v_add_f32_dpp v26, v26, v26 quad_perm:[2,3,0,1] row_mask:0xf bank_mask:0xf
    v_cvt_pk_bf16_f32 v26, v26, v26
    v_and_b32 v26, s98, v26
    v_mul_f32 v26, s96, v26
    v_cvt_pk_bf16_f32 v26, v26, v26
    v_and_b32 v26, s98, v26
    v_max_f32 v16, v16, v26
    v_accvgpr_write_b32 a211, v26
    v_accvgpr_read_b32 v32, a128
    v_accvgpr_read_b32 v33, a129
    v_accvgpr_read_b32 v34, a130
    v_accvgpr_read_b32 v35, a131
    v_accvgpr_read_b32 v36, a132
    v_accvgpr_read_b32 v37, a133
    v_accvgpr_read_b32 v38, a134
    v_accvgpr_read_b32 v39, a135
    v_accvgpr_read_b32 v40, a136
    v_accvgpr_read_b32 v41, a137
    v_accvgpr_read_b32 v42, a138
    v_accvgpr_read_b32 v43, a139
    v_accvgpr_read_b32 v44, a140
    v_accvgpr_read_b32 v45, a141
    v_accvgpr_read_b32 v46, a142
    v_accvgpr_read_b32 v47, a143
    v_dot2_f32_bf16 v20, v32, v4, 0
    v_dot2_f32_bf16 v21, v36, v4, 0
    v_dot2_f32_bf16 v22, v40, v4, 0
    v_dot2_f32_bf16 v23, v44, v4, 0
    v_dot2_f32_bf16 v20, v33, v5, v20
    v_dot2_f32_bf16 v21, v37, v5, v21
    v_dot2_f32_bf16 v22, v41, v5, v22
    v_dot2_f32_bf16 v23, v45, v5, v23
    v_dot2_f32_bf16 v20, v34, v6, v20
    v_dot2_f32_bf16 v21, v38, v6, v21
    v_dot2_f32_bf16 v22, v42, v6, v22
    v_dot2_f32_bf16 v23, v46, v6, v23
    v_dot2_f32_bf16 v20, v35, v7, v20
    v_dot2_f32_bf16 v21, v39, v7, v21
    v_dot2_f32_bf16 v22, v43, v7, v22
    v_dot2_f32_bf16 v23, v47, v7, v23
    v_add_f32_dpp v24, v20, v20 row_ror:8 row_mask:0xf bank_mask:0x3
    s_nop 0
    v_add_f32_dpp v25, v22, v22 row_ror:8 row_mask:0xf bank_mask:0x3
    v_add_f32_dpp v24, v21, v21 row_ror:8 row_mask:0xf bank_mask:0xc
    v_add_f32_dpp v25, v23, v23 row_ror:8 row_mask:0xf bank_mask:0xc
    s_nop 0
    v_add_f32_dpp v26, v24, v24 row_shl:4 row_mask:0xf bank_mask:0x5
    v_add_f32_dpp v26, v25, v25 row_shr:4 row_mask:0xf bank_mask:0xa
    s_nop 1
    v_add_f32_dpp v26, v26, v26 quad_perm:[1,0,3,2] row_mask:0xf bank_mask:0xf
    s_nop 1
    v_add_f32_dpp v26, v26, v26 quad_perm:[2,3,0,1] row_mask:0xf bank_mask:0xf
    v_cvt_pk_bf16_f32 v26, v26, v26
    v_and_b32 v26, s98, v26
    v_mul_f32 v26, s96, v26
    v_cvt_pk_bf16_f32 v26, v26, v26
    v_and_b32 v26, s98, v26
    v_max_f32 v16, v16, v26
    v_accvgpr_write_b32 a212, v26
    v_accvgpr_read_b32 v32, a144
    v_accvgpr_read_b32 v33, a145
    v_accvgpr_read_b32 v34, a146
    v_accvgpr_read_b32 v35, a147
    v_accvgpr_read_b32 v36, a148
    v_accvgpr_read_b32 v37, a149
    v_accvgpr_read_b32 v38, a150
    v_accvgpr_read_b32 v39, a151
    v_accvgpr_read_b32 v40, a152
    v_accvgpr_read_b32 v41, a153
    v_accvgpr_read_b32 v42, a154
    v_accvgpr_read_b32 v43, a155
    v_accvgpr_read_b32 v44, a156
    v_accvgpr_read_b32 v45, a157
    v_accvgpr_read_b32 v46, a158
    v_accvgpr_read_b32 v47, a159
    v_dot2_f32_bf16 v20, v32, v4, 0
    v_dot2_f32_bf16 v21, v36, v4, 0
    v_dot2_f32_bf16 v22, v40, v4, 0
    v_dot2_f32_bf16 v23, v44, v4, 0
    v_dot2_f32_bf16 v20, v33, v5, v20
    v_dot2_f32_bf16 v21, v37, v5, v21
    v_dot2_f32_bf16 v22, v41, v5, v22
    v_dot2_f32_bf16 v23, v45, v5, v23
    v_dot2_f32_bf16 v20, v34, v6, v20
    v_dot2_f32_bf16 v21, v38, v6, v21
    v_dot2_f32_bf16 v22, v42, v6, v22
    v_dot2_f32_bf16 v23, v46, v6, v23
    v_dot2_f32_bf16 v20, v35, v7, v20
    v_dot2_f32_bf16 v21, v39, v7, v21
    v_dot2_f32_bf16 v22, v43, v7, v22
    v_dot2_f32_bf16 v23, v47, v7, v23
    v_add_f32_dpp v24, v20, v20 row_ror:8 row_mask:0xf bank_mask:0x3
    s_nop 0
    v_add_f32_dpp v25, v22, v22 row_ror:8 row_mask:0xf bank_mask:0x3
    v_add_f32_dpp v24, v21, v21 row_ror:8 row_mask:0xf bank_mask:0xc
    v_add_f32_dpp v25, v23, v23 row_ror:8 row_mask:0xf bank_mask:0xc
    s_nop 0
    v_add_f32_dpp v26, v24, v24 row_shl:4 row_mask:0xf bank_mask:0x5
    v_add_f32_dpp v26, v25, v25 row_shr:4 row_mask:0xf bank_mask:0xa
    s_nop 1
    v_add_f32_dpp v26, v26, v26 quad_perm:[1,0,3,2] row_mask:0xf bank_mask:0xf
    s_nop 1
    v_add_f32_dpp v26, v26, v26 quad_perm:[2,3,0,1] row_mask:0xf bank_mask:0xf
    v_cvt_pk_bf16_f32 v26, v26, v26
    v_and_b32 v26, s98, v26
    v_mul_f32 v26, s96, v26
    v_cvt_pk_bf16_f32 v26, v26, v26
    v_and_b32 v26, s98, v26
    v_max_f32 v16, v16, v26
    v_accvgpr_write_b32 a213, v26
    s_waitcnt vmcnt(5)
    s_or_b32 s60, s61, s7
    s_orn2_b32 s61, s61, s6
    s_add_u32 s61, s61, 1
    s_and_b32 s61, s61, s6
    buffer_load_dwordx4 v[208:211], v0, s[32:35], s60 offen nt
    buffer_load_dwordx4 v[212:215], v18, s[32:35], s60 offen nt
    buffer_load_dwordx4 v[216:219], v48, s[32:35], s60 offen nt
    buffer_load_dwordx4 v[220:223], v49, s[32:35], s60 offen nt
    v_accvgpr_read_b32 v32, a160
    v_accvgpr_read_b32 v33, a161
    v_accvgpr_read_b32 v34, a162
    v_accvgpr_read_b32 v35, a163
    v_accvgpr_read_b32 v36, a164
    v_accvgpr_read_b32 v37, a165
    v_accvgpr_read_b32 v38, a166
    v_accvgpr_read_b32 v39, a167
    v_accvgpr_read_b32 v40, a168
    v_accvgpr_read_b32 v41, a169
    v_accvgpr_read_b32 v42, a170
    v_accvgpr_read_b32 v43, a171
    v_accvgpr_read_b32 v44, a172
    v_accvgpr_read_b32 v45, a173
    v_accvgpr_read_b32 v46, a174
    v_accvgpr_read_b32 v47, a175
    v_dot2_f32_bf16 v20, v32, v4, 0
    v_dot2_f32_bf16 v21, v36, v4, 0
    v_dot2_f32_bf16 v22, v40, v4, 0
    v_dot2_f32_bf16 v23, v44, v4, 0
    v_dot2_f32_bf16 v20, v33, v5, v20
    v_dot2_f32_bf16 v21, v37, v5, v21
    v_dot2_f32_bf16 v22, v41, v5, v22
    v_dot2_f32_bf16 v23, v45, v5, v23
    v_dot2_f32_bf16 v20, v34, v6, v20
    v_dot2_f32_bf16 v21, v38, v6, v21
    v_dot2_f32_bf16 v22, v42, v6, v22
    v_dot2_f32_bf16 v23, v46, v6, v23
    v_dot2_f32_bf16 v20, v35, v7, v20
    v_dot2_f32_bf16 v21, v39, v7, v21
    v_dot2_f32_bf16 v22, v43, v7, v22
    v_dot2_f32_bf16 v23, v47, v7, v23
    v_add_f32_dpp v24, v20, v20 row_ror:8 row_mask:0xf bank_mask:0x3
    s_nop 0
    v_add_f32_dpp v25, v22, v22 row_ror:8 row_mask:0xf bank_mask:0x3
    v_add_f32_dpp v24, v21, v21 row_ror:8 row_mask:0xf bank_mask:0xc
    v_add_f32_dpp v25, v23, v23 row_ror:8 row_mask:0xf bank_mask:0xc
    s_nop 0
    v_add_f32_dpp v26, v24, v24 row_shl:4 row_mask:0xf bank_mask:0x5
    v_add_f32_dpp v26, v25, v25 row_shr:4 row_mask:0xf bank_mask:0xa
    s_nop 1
    v_add_f32_dpp v26, v26, v26 quad_perm:[1,0,3,2] row_mask:0xf bank_mask:0xf
    s_nop 1
    v_add_f32_dpp v26, v26, v26 quad_perm:[2,3,0,1] row_mask:0xf bank_mask:0xf
    v_cvt_pk_bf16_f32 v26, v26, v26
    v_and_b32 v26, s98, v26
    v_mul_f32 v26, s96, v26
    v_cvt_pk_bf16_f32 v26, v26, v26
    v_and_b32 v26, s98, v26
    v_max_f32 v16, v16, v26
    v_accvgpr_write_b32 a214, v26
    v_accvgpr_read_b32 v32, a176
    v_accvgpr_read_b32 v33, a177
    v_accvgpr_read_b32 v34, a178
    v_accvgpr_read_b32 v35, a179
    v_accvgpr_read_b32 v36, a180
    v_accvgpr_read_b32 v37, a181
    v_accvgpr_read_b32 v38, a182
    v_accvgpr_read_b32 v39, a183
    v_accvgpr_read_b32 v40, a184
    v_accvgpr_read_b32 v41, a185
    v_accvgpr_read_b32 v42, a186
    v_accvgpr_read_b32 v43, a187
    v_accvgpr_read_b32 v44, a188
    v_accvgpr_read_b32 v45, a189
    v_accvgpr_read_b32 v46, a190
    v_accvgpr_read_b32 v47, a191
    v_dot2_f32_bf16 v20, v32, v4, 0
    v_dot2_f32_bf16 v21, v36, v4, 0
    v_dot2_f32_bf16 v22, v40, v4, 0
    v_dot2_f32_bf16 v23, v44, v4, 0
    v_dot2_f32_bf16 v20, v33, v5, v20
    v_dot2_f32_bf16 v21, v37, v5, v21
    v_dot2_f32_bf16 v22, v41, v5, v22
    v_dot2_f32_bf16 v23, v45, v5, v23
    v_dot2_f32_bf16 v20, v34, v6, v20
    v_dot2_f32_bf16 v21, v38, v6, v21
    v_dot2_f32_bf16 v22, v42, v6, v22
    v_dot2_f32_bf16 v23, v46, v6, v23
    v_dot2_f32_bf16 v20, v35, v7, v20
    v_dot2_f32_bf16 v21, v39, v7, v21
    v_dot2_f32_bf16 v22, v43, v7, v22
    v_dot2_f32_bf16 v23, v47, v7, v23
    v_add_f32_dpp v24, v20, v20 row_ror:8 row_mask:0xf bank_mask:0x3
    s_nop 0
    v_add_f32_dpp v25, v22, v22 row_ror:8 row_mask:0xf bank_mask:0x3
    v_add_f32_dpp v24, v21, v21 row_ror:8 row_mask:0xf bank_mask:0xc
    v_add_f32_dpp v25, v23, v23 row_ror:8 row_mask:0xf bank_mask:0xc
    s_nop 0
    v_add_f32_dpp v26, v24, v24 row_shl:4 row_mask:0xf bank_mask:0x5
    v_add_f32_dpp v26, v25, v25 row_shr:4 row_mask:0xf bank_mask:0xa
    s_nop 1
    v_add_f32_dpp v26, v26, v26 quad_perm:[1,0,3,2] row_mask:0xf bank_mask:0xf
    s_nop 1
    v_add_f32_dpp v26, v26, v26 quad_perm:[2,3,0,1] row_mask:0xf bank_mask:0xf
    v_cvt_pk_bf16_f32 v26, v26, v26
    v_and_b32 v26, s98, v26
    v_mul_f32 v26, s96, v26
    v_cvt_pk_bf16_f32 v26, v26, v26
    v_and_b32 v26, s98, v26
    v_max_f32 v16, v16, v26
    v_accvgpr_write_b32 a215, v26
    v_dot2_f32_bf16 v20, v64, v4, 0
    v_dot2_f32_bf16 v21, v68, v4, 0
    v_dot2_f32_bf16 v22, v72, v4, 0
    v_dot2_f32_bf16 v23, v76, v4, 0
    v_dot2_f32_bf16 v20, v65, v5, v20
    v_dot2_f32_bf16 v21, v69, v5, v21
    v_dot2_f32_bf16 v22, v73, v5, v22
    v_dot2_f32_bf16 v23, v77, v5, v23
    v_dot2_f32_bf16 v20, v66, v6, v20
    v_dot2_f32_bf16 v21, v70, v6, v21
    v_dot2_f32_bf16 v22, v74, v6, v22
    v_dot2_f32_bf16 v23, v78, v6, v23
    v_dot2_f32_bf16 v20, v67, v7, v20
    v_dot2_f32_bf16 v21, v71, v7, v21
    v_dot2_f32_bf16 v22, v75, v7, v22
    v_dot2_f32_bf16 v23, v79, v7, v23
    v_add_f32_dpp v24, v20, v20 row_ror:8 row_mask:0xf bank_mask:0x3
    s_nop 0
    v_add_f32_dpp v25, v22, v22 row_ror:8 row_mask:0xf bank_mask:0x3
    v_add_f32_dpp v24, v21, v21 row_ror:8 row_mask:0xf bank_mask:0xc
    v_add_f32_dpp v25, v23, v23 row_ror:8 row_mask:0xf bank_mask:0xc
    s_nop 0
    v_add_f32_dpp v26, v24, v24 row_shl:4 row_mask:0xf bank_mask:0x5
    v_add_f32_dpp v26, v25, v25 row_shr:4 row_mask:0xf bank_mask:0xa
    s_nop 1
    v_add_f32_dpp v26, v26, v26 quad_perm:[1,0,3,2] row_mask:0xf bank_mask:0xf
    s_nop 1
    v_add_f32_dpp v26, v26, v26 quad_perm:[2,3,0,1] row_mask:0xf bank_mask:0xf
    v_cvt_pk_bf16_f32 v26, v26, v26
    v_and_b32 v26, s98, v26
    v_mul_f32 v26, s96, v26
    v_cvt_pk_bf16_f32 v26, v26, v26
    v_and_b32 v26, s98, v26
    v_max_f32 v16, v16, v26
    v_accvgpr_write_b32 a216, v26
    s_waitcnt vmcnt(5)
    s_or_b32 s60, s61, s7
    s_orn2_b32 s61, s61, s6
    s_add_u32 s61, s61, 1
    s_and_b32 s61, s61, s6
    buffer_load_dwordx4 v[224:227], v0, s[32:35], s60 offen nt
    buffer_load_dwordx4 v[228:231], v18, s[32:35], s60 offen nt
    buffer_load_dwordx4 v[232:235], v48, s[32:35], s60 offen nt
    buffer_load_dwordx4 v[236:239], v49, s[32:35], s60 offen nt
    v_dot2_f32_bf16 v20, v80, v4, 0
    v_dot2_f32_bf16 v21, v84, v4, 0
    v_dot2_f32_bf16 v22, v88, v4, 0
    v_dot2_f32_bf16 v23, v92, v4, 0
    v_dot2_f32_bf16 v20, v81, v5, v20
    v_dot2_f32_bf16 v21, v85, v5, v21
    v_dot2_f32_bf16 v22, v89, v5, v22
    v_dot2_f32_bf16 v23, v93, v5, v23
    v_dot2_f32_bf16 v20, v82, v6, v20
    v_dot2_f32_bf16 v21, v86, v6, v21
    v_dot2_f32_bf16 v22, v90, v6, v22
    v_dot2_f32_bf16 v23, v94, v6, v23
    v_dot2_f32_bf16 v20, v83, v7, v20
    v_dot2_f32_bf16 v21, v87, v7, v21
    v_dot2_f32_bf16 v22, v91, v7, v22
    v_dot2_f32_bf16 v23, v95, v7, v23
    v_add_f32_dpp v24, v20, v20 row_ror:8 row_mask:0xf bank_mask:0x3
    s_nop 0
    v_add_f32_dpp v25, v22, v22 row_ror:8 row_mask:0xf bank_mask:0x3
    v_add_f32_dpp v24, v21, v21 row_ror:8 row_mask:0xf bank_mask:0xc
    v_add_f32_dpp v25, v23, v23 row_ror:8 row_mask:0xf bank_mask:0xc
    s_nop 0
    v_add_f32_dpp v26, v24, v24 row_shl:4 row_mask:0xf bank_mask:0x5
    v_add_f32_dpp v26, v25, v25 row_shr:4 row_mask:0xf bank_mask:0xa
    s_nop 1
    v_add_f32_dpp v26, v26, v26 quad_perm:[1,0,3,2] row_mask:0xf bank_mask:0xf
    s_nop 1
    v_add_f32_dpp v26, v26, v26 quad_perm:[2,3,0,1] row_mask:0xf bank_mask:0xf
    v_cvt_pk_bf16_f32 v26, v26, v26
    v_and_b32 v26, s98, v26
    v_mul_f32 v26, s96, v26
    v_cvt_pk_bf16_f32 v26, v26, v26
    v_and_b32 v26, s98, v26
    v_max_f32 v16, v16, v26
    v_accvgpr_write_b32 a217, v26
    v_dot2_f32_bf16 v20, v96, v4, 0
    v_dot2_f32_bf16 v21, v100, v4, 0
    v_dot2_f32_bf16 v22, v104, v4, 0
    v_dot2_f32_bf16 v23, v108, v4, 0
    v_dot2_f32_bf16 v20, v97, v5, v20
    v_dot2_f32_bf16 v21, v101, v5, v21
    v_dot2_f32_bf16 v22, v105, v5, v22
    v_dot2_f32_bf16 v23, v109, v5, v23
    v_dot2_f32_bf16 v20, v98, v6, v20
    v_dot2_f32_bf16 v21, v102, v6, v21
    v_dot2_f32_bf16 v22, v106, v6, v22
    v_dot2_f32_bf16 v23, v110, v6, v23
    v_dot2_f32_bf16 v20, v99, v7, v20
    v_dot2_f32_bf16 v21, v103, v7, v21
    v_dot2_f32_bf16 v22, v107, v7, v22
    v_dot2_f32_bf16 v23, v111, v7, v23
    v_add_f32_dpp v24, v20, v20 row_ror:8 row_mask:0xf bank_mask:0x3
    s_nop 0
    v_add_f32_dpp v25, v22, v22 row_ror:8 row_mask:0xf bank_mask:0x3
    v_add_f32_dpp v24, v21, v21 row_ror:8 row_mask:0xf bank_mask:0xc
    v_add_f32_dpp v25, v23, v23 row_ror:8 row_mask:0xf bank_mask:0xc
    s_nop 0
    v_add_f32_dpp v26, v24, v24 row_shl:4 row_mask:0xf bank_mask:0x5
    v_add_f32_dpp v26, v25, v25 row_shr:4 row_mask:0xf bank_mask:0xa
    s_nop 1
    v_add_f32_dpp v26, v26, v26 quad_perm:[1,0,3,2] row_mask:0xf bank_mask:0xf
    s_nop 1
    v_add_f32_dpp v26, v26, v26 quad_perm:[2,3,0,1] row_mask:0xf bank_mask:0xf
    v_cvt_pk_bf16_f32 v26, v26, v26
    v_and_b32 v26, s98, v26
    v_mul_f32 v26, s96, v26
    v_cvt_pk_bf16_f32 v26, v26, v26
    v_and_b32 v26, s98, v26
    v_max_f32 v16, v16, v26
    v_accvgpr_write_b32 a218, v26
    v_dot2_f32_bf16 v20, v112, v4, 0
    v_dot2_f32_bf16 v21, v116, v4, 0
    v_dot2_f32_bf16 v22, v120, v4, 0
    v_dot2_f32_bf16 v23, v124, v4, 0
    v_dot2_f32_bf16 v20, v113, v5, v20
    v_dot2_f32_bf16 v21, v117, v5, v21
    v_dot2_f32_bf16 v22, v121, v5, v22
    v_dot2_f32_bf16 v23, v125, v5, v23
    v_dot2_f32_bf16 v20, v114, v6, v20
    v_dot2_f32_bf16 v21, v118, v6, v21
    v_dot2_f32_bf16 v22, v122, v6, v22
    v_dot2_f32_bf16 v23, v126, v6, v23
    v_dot2_f32_bf16 v20, v115, v7, v20
    v_dot2_f32_bf16 v21, v119, v7, v21
    v_dot2_f32_bf16 v22, v123, v7, v22
    v_dot2_f32_bf16 v23, v127, v7, v23
    v_add_f32_dpp v24, v20, v20 row_ror:8 row_mask:0xf bank_mask:0x3
    s_nop 0
    v_add_f32_dpp v25, v22, v22 row_ror:8 row_mask:0xf bank_mask:0x3
    v_add_f32_dpp v24, v21, v21 row_ror:8 row_mask:0xf bank_mask:0xc
    v_add_f32_dpp v25, v23, v23 row_ror:8 row_mask:0xf bank_mask:0xc
    s_nop 0
    v_add_f32_dpp v26, v24, v24 row_shl:4 row_mask:0xf bank_mask:0x5
    v_add_f32_dpp v26, v25, v25 row_shr:4 row_mask:0xf bank_mask:0xa
    s_nop 1
    v_add_f32_dpp v26, v26, v26 quad_perm:[1,0,3,2] row_mask:0xf bank_mask:0xf
    s_nop 1
    v_add_f32_dpp v26, v26, v26 quad_perm:[2,3,0,1] row_mask:0xf bank_mask:0xf
    v_cvt_pk_bf16_f32 v26, v26, v26
    v_and_b32 v26, s98, v26
    v_mul_f32 v26, s96, v26
    v_cvt_pk_bf16_f32 v26, v26, v26
    v_and_b32 v26, s98, v26
    v_max_f32 v16, v16, v26
    v_accvgpr_write_b32 a219, v26
    s_waitcnt vmcnt(5)
    s_or_b32 s60, s61, s7
    s_orn2_b32 s61, s61, s6
    s_add_u32 s61, s61, 1
    s_and_b32 s61, s61, s6
    buffer_load_dwordx4 v[240:243], v0, s[32:35], s60 offen nt
    buffer_load_dwordx4 v[244:247], v18, s[32:35], s60 offen nt
    buffer_load_dwordx4 v[248:251], v48, s[32:35], s60 offen nt
    buffer_load_dwordx4 v[252:255], v49, s[32:35], s60 offen nt
    s_cmp_eq_u32 s20, 36
    s_cbranch_scc1 L_x4
    s_waitcnt vmcnt(5)
    s_or_b32 s60, s61, s7
    s_orn2_b32 s61, s61, s6
    s_add_u32 s61, s61, 1
    s_and_b32 s61, s61, s6
    buffer_load_dwordx4 v[64:67], v0, s[32:35], s60 offen nt
    buffer_load_dwordx4 v[68:71], v18, s[32:35], s60 offen nt
    buffer_load_dwordx4 v[72:75], v48, s[32:35], s60 offen nt
    buffer_load_dwordx4 v[76:79], v49, s[32:35], s60 offen nt
    s_waitcnt vmcnt(5)
    s_or_b32 s60, s61, s7
    s_orn2_b32 s61, s61, s6
    s_add_u32 s61, s61, 1
    s_and_b32 s61, s61, s6
    buffer_load_dwordx4 v[80:83], v0, s[32:35], s60 offen nt
    buffer_load_dwordx4 v[84:87], v18, s[32:35], s60 offen nt
    buffer_load_dwordx4 v[88:91], v48, s[32:35], s60 offen nt
    buffer_load_dwordx4 v[92:95], v49, s[32:35], s60 offen nt
    s_waitcnt vmcnt(5)
    s_or_b32 s60, s61, s7
    s_orn2_b32 s61, s61, s6
    s_add_u32 s61, s61, 1
    s_and_b32 s61, s61, s6
    buffer_load_dwordx4 v[96:99], v0, s[32:35], s60 offen nt
    buffer_load_dwordx4 v[100:103], v18, s[32:35], s60 offen nt
    buffer_load_dwordx4 v[104:107], v48, s[32:35], s60 offen nt
    buffer_load_dwordx4 v[108:111], v49, s[32:35], s60 offen nt
    s_waitcnt vmcnt(5)
    s_or_b32 s60, s61, s7
    s_orn2_b32 s61, s61, s6
    s_add_u32 s61, s61, 1
    s_and_b32 s61, s61, s6
    buffer_load_dwordx4 v[112:115], v0, s[32:35], s60 offen nt
    buffer_load_dwordx4 v[116:119], v18, s[32:35], s60 offen nt
    buffer_load_dwordx4 v[120:123], v48, s[32:35], s60 offen nt
    buffer_load_dwordx4 v[124:127], v49, s[32:35], s60 offen nt
L_x4:
    s_mov_b32 s61, s15
    s_mov_b32 s6, s8
    v_dot2_f32_bf16 v20, v128, v4, 0
    v_dot2_f32_bf16 v21, v132, v4, 0
    v_dot2_f32_bf16 v22, v136, v4, 0
    v_dot2_f32_bf16 v23, v140, v4, 0
    v_dot2_f32_bf16 v20, v129, v5, v20
    v_dot2_f32_bf16 v21, v133, v5, v21
    v_dot2_f32_bf16 v22, v137, v5, v22
    v_dot2_f32_bf16 v23, v141, v5, v23
    v_dot2_f32_bf16 v20, v130, v6, v20
    v_dot2_f32_bf16 v21, v134, v6, v21
    v_dot2_f32_bf16 v22, v138, v6, v22
    v_dot2_f32_bf16 v23, v142, v6, v23
    v_dot2_f32_bf16 v20, v131, v7, v20
    v_dot2_f32_bf16 v21, v135, v7, v21
    v_dot2_f32_bf16 v22, v139, v7, v22
    v_dot2_f32_bf16 v23, v143, v7, v23
    v_add_f32_dpp v24, v20, v20 row_ror:8 row_mask:0xf bank_mask:0x3
    s_nop 0
    v_add_f32_dpp v25, v22, v22 row_ror:8 row_mask:0xf bank_mask:0x3
    v_add_f32_dpp v24, v21, v21 row_ror:8 row_mask:0xf bank_mask:0xc
    v_add_f32_dpp v25, v23, v23 row_ror:8 row_mask:0xf bank_mask:0xc
    s_nop 0
    v_add_f32_dpp v26, v24, v24 row_shl:4 row_mask:0xf bank_mask:0x5
    v_add_f32_dpp v26, v25, v25 row_shr:4 row_mask:0xf bank_mask:0xa
    s_nop 1
    v_add_f32_dpp v26, v26, v26 quad_perm:[1,0,3,2] row_mask:0xf bank_mask:0xf
    s_nop 1
    v_add_f32_dpp v26, v26, v26 quad_perm:[2,3,0,1] row_mask:0xf bank_mask:0xf
    v_cvt_pk_bf16_f32 v26, v26, v26
    v_and_b32 v26, s98, v26
    v_mul_f32 v26, s96, v26
    v_cvt_pk_bf16_f32 v26, v26, v26
    v_and_b32 v26, s98, v26
    v_max_f32 v16, v16, v26
    v_accvgpr_write_b32 a220, v26
    s_waitcnt vmcnt(5)
    s_or_b32 s60, s61, s100
    s_or_b32 s61, s61, 0xfff1f9ff
    s_add_u32 s61, s61, 1
    s_and_b32 s61, s61, 0xe0600
    buffer_load_dwordx4 a[0:3], v0, s[36:39], s60 offen nt
    buffer_load_dwordx4 a[4:7], v18, s[36:39], s60 offen nt
    buffer_load_dwordx4 a[8:11], v48, s[36:39], s60 offen nt
    buffer_load_dwordx4 a[12:15], v49, s[36:39], s60 offen nt
    v_dot2_f32_bf16 v20, v144, v4, 0
    v_dot2_f32_bf16 v21, v148, v4, 0
    v_dot2_f32_bf16 v22, v152, v4, 0
    v_dot2_f32_bf16 v23, v156, v4, 0
    v_dot2_f32_bf16 v20, v145, v5, v20
    v_dot2_f32_bf16 v21, v149, v5, v21
    v_dot2_f32_bf16 v22, v153, v5, v22
    v_dot2_f32_bf16 v23, v157, v5, v23
    v_dot2_f32_bf16 v20, v146, v6, v20
    v_dot2_f32_bf16 v21, v150, v6, v21
    v_dot2_f32_bf16 v22, v154, v6, v22
    v_dot2_f32_bf16 v23, v158, v6, v23
    v_dot2_f32_bf16 v20, v147, v7, v20
    v_dot2_f32_bf16 v21, v151, v7, v21
    v_dot2_f32_bf16 v22, v155, v7, v22
    v_dot2_f32_bf16 v23, v159, v7, v23
    v_add_f32_dpp v24, v20, v20 row_ror:8 row_mask:0xf bank_mask:0x3
    s_nop 0
    v_add_f32_dpp v25, v22, v22 row_ror:8 row_mask:0xf bank_mask:0x3
    v_add_f32_dpp v24, v21, v21 row_ror:8 row_mask:0xf bank_mask:0xc
    v_add_f32_dpp v25, v23, v23 row_ror:8 row_mask:0xf bank_mask:0xc
    s_nop 0
    v_add_f32_dpp v26, v24, v24 row_shl:4 row_mask:0xf bank_mask:0x5
    v_add_f32_dpp v26, v25, v25 row_shr:4 row_mask:0xf bank_mask:0xa
    s_nop 1
    v_add_f32_dpp v26, v26, v26 quad_perm:[1,0,3,2] row_mask:0xf bank_mask:0xf
    s_nop 1
    v_add_f32_dpp v26, v26, v26 quad_perm:[2,3,0,1] row_mask:0xf bank_mask:0xf
    v_cvt_pk_bf16_f32 v26, v26, v26
    v_and_b32 v26, s98, v26
    v_mul_f32 v26, s96, v26
    v_cvt_pk_bf16_f32 v26, v26, v26
    v_and_b32 v26, s98, v26
    v_max_f32 v16, v16, v26
    v_accvgpr_write_b32 a221, v26
    s_waitcnt vmcnt(5)
    s_or_b32 s60, s61, s100
    s_or_b32 s61, s61, 0xfff1f9ff
    s_add_u32 s61, s61, 1
    s_and_b32 s61, s61, 0xe0600
    buffer_load_dwordx4 a[16:19], v0, s[36:39], s60 offen nt
    buffer_load_dwordx4 a[20:23], v18, s[36:39], s60 offen nt
    buffer_load_dwordx4 a[24:27], v48, s[36:39], s60 offen nt
    buffer_load_dwordx4 a[28:31], v49, s[36:39], s60 offen nt
    v_dot2_f32_bf16 v20, v160, v4, 0
    v_dot2_f32_bf16 v21, v164, v4, 0
    v_dot2_f32_bf16 v22, v168, v4, 0
    v_dot2_f32_bf16 v23, v172, v4, 0
    v_dot2_f32_bf16 v20, v161, v5, v20
    v_dot2_f32_bf16 v21, v165, v5, v21
    v_dot2_f32_bf16 v22, v169, v5, v22
    v_dot2_f32_bf16 v23, v173, v5, v23
    v_dot2_f32_bf16 v20, v162, v6, v20
    v_dot2_f32_bf16 v21, v166, v6, v21
    v_dot2_f32_bf16 v22, v170, v6, v22
    v_dot2_f32_bf16 v23, v174, v6, v23
    v_dot2_f32_bf16 v20, v163, v7, v20
    v_dot2_f32_bf16 v21, v167, v7, v21
    v_dot2_f32_bf16 v22, v171, v7, v22
    v_dot2_f32_bf16 v23, v175, v7, v23
    v_add_f32_dpp v24, v20, v20 row_ror:8 row_mask:0xf bank_mask:0x3
    s_nop 0
    v_add_f32_dpp v25, v22, v22 row_ror:8 row_mask:0xf bank_mask:0x3
    v_add_f32_dpp v24, v21, v21 row_ror:8 row_mask:0xf bank_mask:0xc
    v_add_f32_dpp v25, v23, v23 row_ror:8 row_mask:0xf bank_mask:0xc
    s_nop 0
    v_add_f32_dpp v26, v24, v24 row_shl:4 row_mask:0xf bank_mask:0x5
    v_add_f32_dpp v26, v25, v25 row_shr:4 row_mask:0xf bank_mask:0xa
    s_nop 1
    v_add_f32_dpp v26, v26, v26 quad_perm:[1,0,3,2] row_mask:0xf bank_mask:0xf
    s_nop 1
    v_add_f32_dpp v26, v26, v26 quad_perm:[2,3,0,1] row_mask:0xf bank_mask:0xf
    v_cvt_pk_bf16_f32 v26, v26, v26
    v_and_b32 v26, s98, v26
    v_mul_f32 v26, s96, v26
    v_cvt_pk_bf16_f32 v26, v26, v26
    v_and_b32 v26, s98, v26
    v_max_f32 v16, v16, v26
    v_accvgpr_write_b32 a222, v26
    s_waitcnt vmcnt(5)
    s_or_b32 s60, s61, s100
    s_or_b32 s61, s61, 0xfff1f9ff
    s_add_u32 s61, s61, 1
    s_and_b32 s61, s61, 0xe0600
    buffer_load_dwordx4 a[32:35], v0, s[36:39], s60 offen nt
    buffer_load_dwordx4 a[36:39], v18, s[36:39], s60 offen nt
    buffer_load_dwordx4 a[40:43], v48, s[36:39], s60 offen nt
    buffer_load_dwordx4 a[44:47], v49, s[36:39], s60 offen nt
    v_dot2_f32_bf16 v20, v176, v4, 0
    v_dot2_f32_bf16 v21, v180, v4, 0
    v_dot2_f32_bf16 v22, v184, v4, 0
    v_dot2_f32_bf16 v23, v188, v4, 0
    v_dot2_f32_bf16 v20, v177, v5, v20
    v_dot2_f32_bf16 v21, v181, v5, v21
    v_dot2_f32_bf16 v22, v185, v5, v22
    v_dot2_f32_bf16 v23, v189, v5, v23
    v_dot2_f32_bf16 v20, v178, v6, v20
    v_dot2_f32_bf16 v21, v182, v6, v21
    v_dot2_f32_bf16 v22, v186, v6, v22
    v_dot2_f32_bf16 v23, v190, v6, v23
    v_dot2_f32_bf16 v20, v179, v7, v20
    v_dot2_f32_bf16 v21, v183, v7, v21
    v_dot2_f32_bf16 v22, v187, v7, v22
    v_dot2_f32_bf16 v23, v191, v7, v23
    v_add_f32_dpp v24, v20, v20 row_ror:8 row_mask:0xf bank_mask:0x3
    s_nop 0
    v_add_f32_dpp v25, v22, v22 row_ror:8 row_mask:0xf bank_mask:0x3
    v_add_f32_dpp v24, v21, v21 row_ror:8 row_mask:0xf bank_mask:0xc
    v_add_f32_dpp v25, v23, v23 row_ror:8 row_mask:0xf bank_mask:0xc
    s_nop 0
    v_add_f32_dpp v26, v24, v24 row_shl:4 row_mask:0xf bank_mask:0x5
    v_add_f32_dpp v26, v25, v25 row_shr:4 row_mask:0xf bank_mask:0xa
    s_nop 1
    v_add_f32_dpp v26, v26, v26 quad_perm:[1,0,3,2] row_mask:0xf bank_mask:0xf
    s_nop 1
    v_add_f32_dpp v26, v26, v26 quad_perm:[2,3,0,1] row_mask:0xf bank_mask:0xf
    v_cvt_pk_bf16_f32 v26, v26, v26
    v_and_b32 v26, s98, v26
    v_mul_f32 v26, s96, v26
    v_cvt_pk_bf16_f32 v26, v26, v26
    v_and_b32 v26, s98, v26
    v_max_f32 v16, v16, v26
    v_accvgpr_write_b32 a223, v26
    s_waitcnt vmcnt(5)
    s_or_b32 s60, s61, s100
    s_or_b32 s61, s61, 0xfff1f9ff
    s_add_u32 s61, s61, 1
    s_and_b32 s61, s61, 0xe0600
    buffer_load_dwordx4 a[48:51], v0, s[36:39], s60 offen nt
    buffer_load_dwordx4 a[52:55], v18, s[36:39], s60 offen nt
    buffer_load_dwordx4 a[56:59], v48, s[36:39], s60 offen nt
    buffer_load_dwordx4 a[60:63], v49, s[36:39], s60 offen nt
    v_max_f32_dpp v27, v16, v16 row_ror:4 row_mask:0xf bank_mask:0xf
    s_nop 1
    v_max_f32_dpp v27, v27, v27 row_ror:8 row_mask:0xf bank_mask:0xf
    v_mov_b32 v28, v27
    s_nop 1
    v_permlane16_swap_b32 v27, v28
    v_max_f32 v27, v27, v28
    v_mov_b32 v28, v27
    s_nop 1
    v_permlane32_swap_b32 v27, v28
    v_max_f32 v16, v27, v28
L_aq2:
    v_max3_u32 v20, v60, v61, v62
    v_max_u32 v20, v20, v63
    v_cmp_eq_u32 vcc, -1, v20
    s_cbranch_vccz L_aq2_ok
    buffer_load_dwordx4 v[60:63], v59, s[44:47], s12 offen sc1
    s_waitcnt vmcnt(0)
    s_sub_u32 s101, s101, 1
    s_cbranch_scc0 L_aq2
    s_mov_b32 s101, 0
L_aq2_ok:
    v_mov_b32 v4, v60
    v_mov_b32 v5, v61
    v_mov_b32 v6, v62
    v_mov_b32 v7, v63
    v_dot2_f32_bf16 v20, v192, v4, 0
    v_dot2_f32_bf16 v21, v196, v4, 0
    v_dot2_f32_bf16 v22, v200, v4, 0
    v_dot2_f32_bf16 v23, v204, v4, 0
    v_dot2_f32_bf16 v20, v193, v5, v20
    v_dot2_f32_bf16 v21, v197, v5, v21
    v_dot2_f32_bf16 v22, v201, v5, v22
    v_dot2_f32_bf16 v23, v205, v5, v23
    v_dot2_f32_bf16 v20, v194, v6, v20
    v_dot2_f32_bf16 v21, v198, v6, v21
    v_dot2_f32_bf16 v22, v202, v6, v22
    v_dot2_f32_bf16 v23, v206, v6, v23
    v_dot2_f32_bf16 v20, v195, v7, v20
    v_dot2_f32_bf16 v21, v199, v7, v21
    v_dot2_f32_bf16 v22, v203, v7, v22
    v_dot2_f32_bf16 v23, v207, v7, v23
    v_add_f32_dpp v24, v20, v20 row_ror:8 row_mask:0xf bank_mask:0x3
    s_nop 0
    v_add_f32_dpp v25, v22, v22 row_ror:8 row_mask:0xf bank_mask:0x3
    v_add_f32_dpp v24, v21, v21 row_ror:8 row_mask:0xf bank_mask:0xc
    v_add_f32_dpp v25, v23, v23 row_ror:8 row_mask:0xf bank_mask:0xc
    s_nop 0
    v_add_f32_dpp v26, v24, v24 row_shl:4 row_mask:0xf bank_mask:0x5
    v_add_f32_dpp v26, v25, v25 row_shr:4 row_mask:0xf bank_mask:0xa
    s_nop 1
    v_add_f32_dpp v26, v26, v26 quad_perm:[1,0,3,2] row_mask:0xf bank_mask:0xf
    s_nop 1
    v_add_f32_dpp v26, v26, v26 quad_perm:[2,3,0,1] row_mask:0xf bank_mask:0xf
    v_cvt_pk_bf16_f32 v26, v26, v26
    v_and_b32 v26, s98, v26
    v_mul_f32 v26, s96, v26
    v_cvt_pk_bf16_f32 v26, v26, v26
    v_and_b32 v26, s98, v26
    v_max_f32 v57, v57, v26
    v_accvgpr_write_b32 a224, v26
    v_dot2_f32_bf16 v20, v208, v4, 0
    v_dot2_f32_bf16 v21, v212, v4, 0
    v_dot2_f32_bf16 v22, v216, v4, 0
    v_dot2_f32_bf16 v23, v220, v4, 0
    v_dot2_f32_bf16 v20, v209, v5, v20
    v_dot2_f32_bf16 v21, v213, v5, v21
    v_dot2_f32_bf16 v22, v217, v5, v22
    v_dot2_f32_bf16 v23, v221, v5, v23
    v_dot2_f32_bf16 v20, v210, v6, v20
    v_dot2_f32_bf16 v21, v214, v6, v21
    v_dot2_f32_bf16 v22, v218, v6, v22
    v_dot2_f32_bf16 v23, v222, v6, v23
    v_dot2_f32_bf16 v20, v211, v7, v20
    v_dot2_f32_bf16 v21, v215, v7, v21
    v_dot2_f32_bf16 v22, v219, v7, v22
    v_dot2_f32_bf16 v23, v223, v7, v23
    v_add_f32_dpp v24, v20, v20 row_ror:8 row_mask:0xf bank_mask:0x3
    s_nop 0
    v_add_f32_dpp v25, v22, v22 row_ror:8 row_mask:0xf bank_mask:0x3
    v_add_f32_dpp v24, v21, v21 row_ror:8 row_mask:0xf bank_mask:0xc
    v_add_f32_dpp v25, v23, v23 row_ror:8 row_mask:0xf bank_mask:0xc
    s_nop 0
    v_add_f32_dpp v26, v24, v24 row_shl:4 row_mask:0xf bank_mask:0x5
    v_add_f32_dpp v26, v25, v25 row_shr:4 row_mask:0xf bank_mask:0xa
    s_nop 1
    v_add_f32_dpp v26, v26, v26 quad_perm:[1,0,3,2] row_mask:0xf bank_mask:0xf
    s_nop 1
    v_add_f32_dpp v26, v26, v26 quad_perm:[2,3,0,1] row_mask:0xf bank_mask:0xf
    v_cvt_pk_bf16_f32 v26, v26, v26
    v_and_b32 v26, s98, v26
    v_mul_f32 v26, s96, v26
    v_cvt_pk_bf16_f32 v26, v26, v26
    v_and_b32 v26, s98, v26
    v_max_f32 v57, v57, v26
    v_accvgpr_write_b32 a225, v26
    v_dot2_f32_bf16 v20, v224, v4, 0
    v_dot2_f32_bf16 v21, v228, v4, 0
    v_dot2_f32_bf16 v22, v232, v4, 0
    v_dot2_f32_bf16 v23, v236, v4, 0
    v_dot2_f32_bf16 v20, v225, v5, v20
    v_dot2_f32_bf16 v21, v229, v5, v21
    v_dot2_f32_bf16 v22, v233, v5, v22
    v_dot2_f32_bf16 v23, v237, v5, v23
    v_dot2_f32_bf16 v20, v226, v6, v20
    v_dot2_f32_bf16 v21, v230, v6, v21
    v_dot2_f32_bf16 v22, v234, v6, v22
    v_dot2_f32_bf16 v23, v238, v6, v23
    v_dot2_f32_bf16 v20, v227, v7, v20
    v_dot2_f32_bf16 v21, v231, v7, v21
    v_dot2_f32_bf16 v22, v235, v7, v22
    v_dot2_f32_bf16 v23, v239, v7, v23
    v_add_f32_dpp v24, v20, v20 row_ror:8 row_mask:0xf bank_mask:0x3
    s_nop 0
    v_add_f32_dpp v25, v22, v22 row_ror:8 row_mask:0xf bank_mask:0x3
    v_add_f32_dpp v24, v21, v21 row_ror:8 row_mask:0xf bank_mask:0xc
    v_add_f32_dpp v25, v23, v23 row_ror:8 row_mask:0xf bank_mask:0xc
    s_nop 0
    v_add_f32_dpp v26, v24, v24 row_shl:4 row_mask:0xf bank_mask:0x5
    v_add_f32_dpp v26, v25, v25 row_shr:4 row_mask:0xf bank_mask:0xa
    s_nop 1
    v_add_f32_dpp v26, v26, v26 quad_perm:[1,0,3,2] row_mask:0xf bank_mask:0xf
    s_nop 1
    v_add_f32_dpp v26, v26, v26 quad_perm:[2,3,0,1] row_mask:0xf bank_mask:0xf
    v_cvt_pk_bf16_f32 v26, v26, v26
    v_and_b32 v26, s98, v26
    v_mul_f32 v26, s96, v26
    v_cvt_pk_bf16_f32 v26, v26, v26
    v_and_b32 v26, s98, v26
    v_max_f32 v57, v57, v26
    v_accvgpr_write_b32 a226, v26
    v_dot2_f32_bf16 v20, v240, v4, 0
    v_dot2_f32_bf16 v21, v244, v4, 0
    v_dot2_f32_bf16 v22, v248, v4, 0
    v_dot2_f32_bf16 v23, v252, v4, 0
    v_dot2_f32_bf16 v20, v241, v5, v20
    v_dot2_f32_bf16 v21, v245, v5, v21
    v_dot2_f32_bf16 v22, v249, v5, v22
    v_dot2_f32_bf16 v23, v253, v5, v23
    v_dot2_f32_bf16 v20, v242, v6, v20
    v_dot2_f32_bf16 v21, v246, v6, v21
    v_dot2_f32_bf16 v22, v250, v6, v22
    v_dot2_f32_bf16 v23, v254, v6, v23
    v_dot2_f32_bf16 v20, v243, v7, v20
    v_dot2_f32_bf16 v21, v247, v7, v21
    v_dot2_f32_bf16 v22, v251, v7, v22
    v_dot2_f32_bf16 v23, v255, v7, v23
    v_add_f32_dpp v24, v20, v20 row_ror:8 row_mask:0xf bank_mask:0x3
    s_nop 0
    v_add_f32_dpp v25, v22, v22 row_ror:8 row_mask:0xf bank_mask:0x3
    v_add_f32_dpp v24, v21, v21 row_ror:8 row_mask:0xf bank_mask:0xc
    v_add_f32_dpp v25, v23, v23 row_ror:8 row_mask:0xf bank_mask:0xc
    s_nop 0
    v_add_f32_dpp v26, v24, v24 row_shl:4 row_mask:0xf bank_mask:0x5
    v_add_f32_dpp v26, v25, v25 row_shr:4 row_mask:0xf bank_mask:0xa
    s_nop 1
    v_add_f32_dpp v26, v26, v26 quad_perm:[1,0,3,2] row_mask:0xf bank_mask:0xf
    s_nop 1
    v_add_f32_dpp v26, v26, v26 quad_perm:[2,3,0,1] row_mask:0xf bank_mask:0xf
    v_cvt_pk_bf16_f32 v26, v26, v26
    v_and_b32 v26, s98, v26
    v_mul_f32 v26, s96, v26
    v_cvt_pk_bf16_f32 v26, v26, v26
    v_and_b32 v26, s98, v26
    v_max_f32 v57, v57, v26
    v_accvgpr_write_b32 a227, v26
    s_mov_b32 s56, 4
    s_cmp_eq_u32 s20, 36
    s_cbranch_scc1 L_vloop
    v_dot2_f32_bf16 v20, v64, v4, 0
    v_dot2_f32_bf16 v21, v68, v4, 0
    v_dot2_f32_bf16 v22, v72, v4, 0
    v_dot2_f32_bf16 v23, v76, v4, 0
    v_dot2_f32_bf16 v20, v65, v5, v20
    v_dot2_f32_bf16 v21, v69, v5, v21
    v_dot2_f32_bf16 v22, v73, v5, v22
    v_dot2_f32_bf16 v23, v77, v5, v23
    v_dot2_f32_bf16 v20, v66, v6, v20
    v_dot2_f32_bf16 v21, v70, v6, v21
    v_dot2_f32_bf16 v22, v74, v6, v22
    v_dot2_f32_bf16 v23, v78, v6, v23
    v_dot2_f32_bf16 v20, v67, v7, v20
    v_dot2_f32_bf16 v21, v71, v7, v21
    v_dot2_f32_bf16 v22, v75, v7, v22
    v_dot2_f32_bf16 v23, v79, v7, v23
    v_add_f32_dpp v24, v20, v20 row_ror:8 row_mask:0xf bank_mask:0x3
    s_nop 0
    v_add_f32_dpp v25, v22, v22 row_ror:8 row_mask:0xf bank_mask:0x3
    v_add_f32_dpp v24, v21, v21 row_ror:8 row_mask:0xf bank_mask:0xc
    v_add_f32_dpp v25, v23, v23 row_ror:8 row_mask:0xf bank_mask:0xc
    s_nop 0
    v_add_f32_dpp v26, v24, v24 row_shl:4 row_mask:0xf bank_mask:0x5
    v_add_f32_dpp v26, v25, v25 row_shr:4 row_mask:0xf bank_mask:0xa
    s_nop 1
    v_add_f32_dpp v26, v26, v26 quad_perm:[1,0,3,2] row_mask:0xf bank_mask:0xf
    s_nop 1
    v_add_f32_dpp v26, v26, v26 quad_perm:[2,3,0,1] row_mask:0xf bank_mask:0xf
    v_cvt_pk_bf16_f32 v26, v26, v26
    v_and_b32 v26, s98, v26
    v_mul_f32 v26, s96, v26
    v_cvt_pk_bf16_f32 v26, v26, v26
    v_and_b32 v26, s98, v26
    v_max_f32 v57, v57, v26
    v_accvgpr_write_b32 a228, v26
    v_dot2_f32_bf16 v20, v80, v4, 0
    v_dot2_f32_bf16 v21, v84, v4, 0
    v_dot2_f32_bf16 v22, v88, v4, 0
    v_dot2_f32_bf16 v23, v92, v4, 0
    v_dot2_f32_bf16 v20, v81, v5, v20
    v_dot2_f32_bf16 v21, v85, v5, v21
    v_dot2_f32_bf16 v22, v89, v5, v22
    v_dot2_f32_bf16 v23, v93, v5, v23
    v_dot2_f32_bf16 v20, v82, v6, v20
    v_dot2_f32_bf16 v21, v86, v6, v21
    v_dot2_f32_bf16 v22, v90, v6, v22
    v_dot2_f32_bf16 v23, v94, v6, v23
    v_dot2_f32_bf16 v20, v83, v7, v20
    v_dot2_f32_bf16 v21, v87, v7, v21
    v_dot2_f32_bf16 v22, v91, v7, v22
    v_dot2_f32_bf16 v23, v95, v7, v23
    v_add_f32_dpp v24, v20, v20 row_ror:8 row_mask:0xf bank_mask:0x3
    s_nop 0
    v_add_f32_dpp v25, v22, v22 row_ror:8 row_mask:0xf bank_mask:0x3
    v_add_f32_dpp v24, v21, v21 row_ror:8 row_mask:0xf bank_mask:0xc
    v_add_f32_dpp v25, v23, v23 row_ror:8 row_mask:0xf bank_mask:0xc
    s_nop 0
    v_add_f32_dpp v26, v24, v24 row_shl:4 row_mask:0xf bank_mask:0x5
    v_add_f32_dpp v26, v25, v25 row_shr:4 row_mask:0xf bank_mask:0xa
    s_nop 1
    v_add_f32_dpp v26, v26, v26 quad_perm:[1,0,3,2] row_mask:0xf bank_mask:0xf
    s_nop 1
    v_add_f32_dpp v26, v26, v26 quad_perm:[2,3,0,1] row_mask:0xf bank_mask:0xf
    v_cvt_pk_bf16_f32 v26, v26, v26
    v_and_b32 v26, s98, v26
    v_mul_f32 v26, s96, v26
    v_cvt_pk_bf16_f32 v26, v26, v26
    v_and_b32 v26, s98, v26
    v_max_f32 v57, v57, v26
    v_accvgpr_write_b32 a229, v26
    v_dot2_f32_bf16 v20, v96, v4, 0
    v_dot2_f32_bf16 v21, v100, v4, 0
    v_dot2_f32_bf16 v22, v104, v4, 0
    v_dot2_f32_bf16 v23, v108, v4, 0
    v_dot2_f32_bf16 v20, v97, v5, v20
    v_dot2_f32_bf16 v21, v101, v5, v21
    v_dot2_f32_bf16 v22, v105, v5, v22
    v_dot2_f32_bf16 v23, v109, v5, v23
    v_dot2_f32_bf16 v20, v98, v6, v20
    v_dot2_f32_bf16 v21, v102, v6, v21
    v_dot2_f32_bf16 v22, v106, v6, v22
    v_dot2_f32_bf16 v23, v110, v6, v23
    v_dot2_f32_bf16 v20, v99, v7, v20
    v_dot2_f32_bf16 v21, v103, v7, v21
    v_dot2_f32_bf16 v22, v107, v7, v22
    v_dot2_f32_bf16 v23, v111, v7, v23
    v_add_f32_dpp v24, v20, v20 row_ror:8 row_mask:0xf bank_mask:0x3
    s_nop 0
    v_add_f32_dpp v25, v22, v22 row_ror:8 row_mask:0xf bank_mask:0x3
    v_add_f32_dpp v24, v21, v21 row_ror:8 row_mask:0xf bank_mask:0xc
    v_add_f32_dpp v25, v23, v23 row_ror:8 row_mask:0xf bank_mask:0xc
    s_nop 0
    v_add_f32_dpp v26, v24, v24 row_shl:4 row_mask:0xf bank_mask:0x5
    v_add_f32_dpp v26, v25, v25 row_shr:4 row_mask:0xf bank_mask:0xa
    s_nop 1
    v_add_f32_dpp v26, v26, v26 quad_perm:[1,0,3,2] row_mask:0xf bank_mask:0xf
    s_nop 1
    v_add_f32_dpp v26, v26, v26 quad_perm:[2,3,0,1] row_mask:0xf bank_mask:0xf
    v_cvt_pk_bf16_f32 v26, v26, v26
    v_and_b32 v26, s98, v26
    v_mul_f32 v26, s96, v26
    v_cvt_pk_bf16_f32 v26, v26, v26
    v_and_b32 v26, s98, v26
    v_max_f32 v57, v57, v26
    v_accvgpr_write_b32 a230, v26
    v_dot2_f32_bf16 v20, v112, v4, 0
    v_dot2_f32_bf16 v21, v116, v4, 0
    v_dot2_f32_bf16 v22, v120, v4, 0
    v_dot2_f32_bf16 v23, v124, v4, 0
    v_dot2_f32_bf16 v20, v113, v5, v20
    v_dot2_f32_bf16 v21, v117, v5, v21
    v_dot2_f32_bf16 v22, v121, v5, v22
    v_dot2_f32_bf16 v23, v125, v5, v23
    v_dot2_f32_bf16 v20, v114, v6, v20
    v_dot2_f32_bf16 v21, v118, v6, v21
    v_dot2_f32_bf16 v22, v122, v6, v22
    v_dot2_f32_bf16 v23, v126, v6, v23
    v_dot2_f32_bf16 v20, v115, v7, v20
    v_dot2_f32_bf16 v21, v119, v7, v21
    v_dot2_f32_bf16 v22, v123, v7, v22
    v_dot2_f32_bf16 v23, v127, v7, v23
    v_add_f32_dpp v24, v20, v20 row_ror:8 row_mask:0xf bank_mask:0x3
    s_nop 0
    v_add_f32_dpp v25, v22, v22 row_ror:8 row_mask:0xf bank_mask:0x3
    v_add_f32_dpp v24, v21, v21 row_ror:8 row_mask:0xf bank_mask:0xc
    v_add_f32_dpp v25, v23, v23 row_ror:8 row_mask:0xf bank_mask:0xc
    s_nop 0
    v_add_f32_dpp v26, v24, v24 row_shl:4 row_mask:0xf bank_mask:0x5
    v_add_f32_dpp v26, v25, v25 row_shr:4 row_mask:0xf bank_mask:0xa
    s_nop 1
    v_add_f32_dpp v26, v26, v26 quad_perm:[1,0,3,2] row_mask:0xf bank_mask:0xf
    s_nop 1
    v_add_f32_dpp v26, v26, v26 quad_perm:[2,3,0,1] row_mask:0xf bank_mask:0xf
    v_cvt_pk_bf16_f32 v26, v26, v26
    v_and_b32 v26, s98, v26
    v_mul_f32 v26, s96, v26
    v_cvt_pk_bf16_f32 v26, v26, v26
    v_and_b32 v26, s98, v26
    v_max_f32 v57, v57, v26
    v_accvgpr_write_b32 a231, v26
L_vloop:
    s_cmp_lt_u32 s56, 20
    s_cselect_b32 s7, s100, s9
    s_cmp_lt_u32 s56, 32
    s_cselect_b32 s7, s7, s11
    s_cselect_b32 s6, s8, 0xe6e00
    s_cmp_eq_u32 s56, 32
    s_cselect_b32 s61, s21, s61
    v_accvgpr_read_b32 v29, a192
    v_sub_f32 v29, v29, v16
    v_mul_f32 v29, s97, v29
    v_exp_f32 v29, v29
    s_nop 0
    v_add_f32 v17, v17, v29
    v_cvt_pk_bf16_f32 v29, v29, v29
    s_nop 1
    v_and_b32_dpp v32, v29, v8 row_newbcast:0 row_mask:0xf bank_mask:0xf
    v_and_b32_dpp v33, v29, v9 row_newbcast:0 row_mask:0xf bank_mask:0xf
    v_and_b32_dpp v34, v29, v10 row_newbcast:0 row_mask:0xf bank_mask:0xf
    v_and_b32_dpp v35, v29, v11 row_newbcast:0 row_mask:0xf bank_mask:0xf
    v_and_b32_dpp v36, v29, v8 row_newbcast:8 row_mask:0xf bank_mask:0xf
    v_and_b32_dpp v37, v29, v9 row_newbcast:8 row_mask:0xf bank_mask:0xf
    v_and_b32_dpp v38, v29, v10 row_newbcast:8 row_mask:0xf bank_mask:0xf
    v_and_b32_dpp v39, v29, v11 row_newbcast:8 row_mask:0xf bank_mask:0xf
    v_and_b32_dpp v40, v29, v8 row_newbcast:4 row_mask:0xf bank_mask:0xf
    v_and_b32_dpp v41, v29, v9 row_newbcast:4 row_mask:0xf bank_mask:0xf
    v_and_b32_dpp v42, v29, v10 row_newbcast:4 row_mask:0xf bank_mask:0xf
    v_and_b32_dpp v43, v29, v11 row_newbcast:4 row_mask:0xf bank_mask:0xf
    v_and_b32_dpp v44, v29, v8 row_newbcast:12 row_mask:0xf bank_mask:0xf
    v_and_b32_dpp v45, v29, v9 row_newbcast:12 row_mask:0xf bank_mask:0xf
    v_and_b32_dpp v46, v29, v10 row_newbcast:12 row_mask:0xf bank_mask:0xf
    v_and_b32_dpp v47, v29, v11 row_newbcast:12 row_mask:0xf bank_mask:0xf
    s_waitcnt vmcnt(5)
    v_mfma_f32_16x16x32_bf16 v[12:15], v[32:35], a[0:3], v[12:15]
    v_mfma_f32_16x16x32_bf16 v[12:15], v[36:39], a[4:7], v[12:15]
    v_mfma_f32_16x16x32_bf16 v[12:15], v[40:43], a[8:11], v[12:15]
    v_mfma_f32_16x16x32_bf16 v[12:15], v[44:47], a[12:15], v[12:15]
    s_or_b32 s60, s61, s7
    s_orn2_b32 s61, s61, s6
    s_add_u32 s61, s61, 1
    s_and_b32 s61, s61, s6
    buffer_load_dwordx4 a[0:3], v0, s[36:39], s60 offen nt
    buffer_load_dwordx4 a[4:7], v18, s[36:39], s60 offen nt
    buffer_load_dwordx4 a[8:11], v48, s[36:39], s60 offen nt
    buffer_load_dwordx4 a[12:15], v49, s[36:39], s60 offen nt
    v_accvgpr_mov_b32 a192, a196
    v_accvgpr_mov_b32 a196, a200
    v_accvgpr_mov_b32 a200, a204
    v_accvgpr_mov_b32 a204, a208
    v_accvgpr_mov_b32 a208, a212
    v_accvgpr_mov_b32 a212, a216
    v_accvgpr_mov_b32 a216, a220
    v_accvgpr_mov_b32 a220, a224
    v_accvgpr_mov_b32 a224, a228
    v_accvgpr_read_b32 v29, a193
    v_sub_f32 v29, v29, v16
    v_mul_f32 v29, s97, v29
    v_exp_f32 v29, v29
    s_nop 0
    v_add_f32 v17, v17, v29
    v_cvt_pk_bf16_f32 v29, v29, v29
    s_nop 1
    v_and_b32_dpp v32, v29, v8 row_newbcast:0 row_mask:0xf bank_mask:0xf
    v_and_b32_dpp v33, v29, v9 row_newbcast:0 row_mask:0xf bank_mask:0xf
    v_and_b32_dpp v34, v29, v10 row_newbcast:0 row_mask:0xf bank_mask:0xf
    v_and_b32_dpp v35, v29, v11 row_newbcast:0 row_mask:0xf bank_mask:0xf
    v_and_b32_dpp v36, v29, v8 row_newbcast:8 row_mask:0xf bank_mask:0xf
    v_and_b32_dpp v37, v29, v9 row_newbcast:8 row_mask:0xf bank_mask:0xf
    v_and_b32_dpp v38, v29, v10 row_newbcast:8 row_mask:0xf bank_mask:0xf
    v_and_b32_dpp v39, v29, v11 row_newbcast:8 row_mask:0xf bank_mask:0xf
    v_and_b32_dpp v40, v29, v8 row_newbcast:4 row_mask:0xf bank_mask:0xf
    v_and_b32_dpp v41, v29, v9 row_newbcast:4 row_mask:0xf bank_mask:0xf
    v_and_b32_dpp v42, v29, v10 row_newbcast:4 row_mask:0xf bank_mask:0xf
    v_and_b32_dpp v43, v29, v11 row_newbcast:4 row_mask:0xf bank_mask:0xf
    v_and_b32_dpp v44, v29, v8 row_newbcast:12 row_mask:0xf bank_mask:0xf
    v_and_b32_dpp v45, v29, v9 row_newbcast:12 row_mask:0xf bank_mask:0xf
    v_and_b32_dpp v46, v29, v10 row_newbcast:12 row_mask:0xf bank_mask:0xf
    v_and_b32_dpp v47, v29, v11 row_newbcast:12 row_mask:0xf bank_mask:0xf
    s_waitcnt vmcnt(5)
    v_mfma_f32_16x16x32_bf16 v[12:15], v[32:35], a[16:19], v[12:15]
    v_mfma_f32_16x16x32_bf16 v[12:15], v[36:39], a[20:23], v[12:15]
    v_mfma_f32_16x16x32_bf16 v[12:15], v[40:43], a[24:27], v[12:15]
    v_mfma_f32_16x16x32_bf16 v[12:15], v[44:47], a[28:31], v[12:15]
    s_or_b32 s60, s61, s7
    s_orn2_b32 s61, s61, s6
    s_add_u32 s61, s61, 1
    s_and_b32 s61, s61, s6
    buffer_load_dwordx4 a[16:19], v0, s[36:39], s60 offen nt
    buffer_load_dwordx4 a[20:23], v18, s[36:39], s60 offen nt
    buffer_load_dwordx4 a[24:27], v48, s[36:39], s60 offen nt
    buffer_load_dwordx4 a[28:31], v49, s[36:39], s60 offen nt
    v_accvgpr_mov_b32 a193, a197
    v_accvgpr_mov_b32 a197, a201
    v_accvgpr_mov_b32 a201, a205
    v_accvgpr_mov_b32 a205, a209
    v_accvgpr_mov_b32 a209, a213
    v_accvgpr_mov_b32 a213, a217
    v_accvgpr_mov_b32 a217, a221
    v_accvgpr_mov_b32 a221, a225
    v_accvgpr_mov_b32 a225, a229
    v_accvgpr_read_b32 v29, a194
    v_sub_f32 v29, v29, v16
    v_mul_f32 v29, s97, v29
    v_exp_f32 v29, v29
    s_nop 0
    v_add_f32 v17, v17, v29
    v_cvt_pk_bf16_f32 v29, v29, v29
    s_nop 1
    v_and_b32_dpp v32, v29, v8 row_newbcast:0 row_mask:0xf bank_mask:0xf
    v_and_b32_dpp v33, v29, v9 row_newbcast:0 row_mask:0xf bank_mask:0xf
    v_and_b32_dpp v34, v29, v10 row_newbcast:0 row_mask:0xf bank_mask:0xf
    v_and_b32_dpp v35, v29, v11 row_newbcast:0 row_mask:0xf bank_mask:0xf
    v_and_b32_dpp v36, v29, v8 row_newbcast:8 row_mask:0xf bank_mask:0xf
    v_and_b32_dpp v37, v29, v9 row_newbcast:8 row_mask:0xf bank_mask:0xf
    v_and_b32_dpp v38, v29, v10 row_newbcast:8 row_mask:0xf bank_mask:0xf
    v_and_b32_dpp v39, v29, v11 row_newbcast:8 row_mask:0xf bank_mask:0xf
    v_and_b32_dpp v40, v29, v8 row_newbcast:4 row_mask:0xf bank_mask:0xf
    v_and_b32_dpp v41, v29, v9 row_newbcast:4 row_mask:0xf bank_mask:0xf
    v_and_b32_dpp v42, v29, v10 row_newbcast:4 row_mask:0xf bank_mask:0xf
    v_and_b32_dpp v43, v29, v11 row_newbcast:4 row_mask:0xf bank_mask:0xf
    v_and_b32_dpp v44, v29, v8 row_newbcast:12 row_mask:0xf bank_mask:0xf
    v_and_b32_dpp v45, v29, v9 row_newbcast:12 row_mask:0xf bank_mask:0xf
    v_and_b32_dpp v46, v29, v10 row_newbcast:12 row_mask:0xf bank_mask:0xf
    v_and_b32_dpp v47, v29, v11 row_newbcast:12 row_mask:0xf bank_mask:0xf
    s_waitcnt vmcnt(5)
    v_mfma_f32_16x16x32_bf16 v[12:15], v[32:35], a[32:35], v[12:15]
    v_mfma_f32_16x16x32_bf16 v[12:15], v[36:39], a[36:39], v[12:15]
    v_mfma_f32_16x16x32_bf16 v[12:15], v[40:43], a[40:43], v[12:15]
    v_mfma_f32_16x16x32_bf16 v[12:15], v[44:47], a[44:47], v[12:15]
    s_or_b32 s60, s61, s7
    s_orn2_b32 s61, s61, s6
    s_add_u32 s61, s61, 1
    s_and_b32 s61, s61, s6
    buffer_load_dwordx4 a[32:35], v0, s[36:39], s60 offen nt
    buffer_load_dwordx4 a[36:39], v18, s[36:39], s60 offen nt
    buffer_load_dwordx4 a[40:43], v48, s[36:39], s60 offen nt
    buffer_load_dwordx4 a[44:47], v49, s[36:39], s60 offen nt
    v_accvgpr_mov_b32 a194, a198
    v_accvgpr_mov_b32 a198, a202
    v_accvgpr_mov_b32 a202, a206
    v_accvgpr_mov_b32 a206, a210
    v_accvgpr_mov_b32 a210, a214
    v_accvgpr_mov_b32 a214, a218
    v_accvgpr_mov_b32 a218, a222
    v_accvgpr_mov_b32 a222, a226
    v_accvgpr_mov_b32 a226, a230
    v_accvgpr_read_b32 v29, a195
    v_sub_f32 v29, v29, v16
    v_mul_f32 v29, s97, v29
    v_exp_f32 v29, v29
    s_nop 0
    v_add_f32 v17, v17, v29
    v_cvt_pk_bf16_f32 v29, v29, v29
    s_nop 1
    v_and_b32_dpp v32, v29, v8 row_newbcast:0 row_mask:0xf bank_mask:0xf
    v_and_b32_dpp v33, v29, v9 row_newbcast:0 row_mask:0xf bank_mask:0xf
    v_and_b32_dpp v34, v29, v10 row_newbcast:0 row_mask:0xf bank_mask:0xf
    v_and_b32_dpp v35, v29, v11 row_newbcast:0 row_mask:0xf bank_mask:0xf
    v_and_b32_dpp v36, v29, v8 row_newbcast:8 row_mask:0xf bank_mask:0xf
    v_and_b32_dpp v37, v29, v9 row_newbcast:8 row_mask:0xf bank_mask:0xf
    v_and_b32_dpp v38, v29, v10 row_newbcast:8 row_mask:0xf bank_mask:0xf
    v_and_b32_dpp v39, v29, v11 row_newbcast:8 row_mask:0xf bank_mask:0xf
    v_and_b32_dpp v40, v29, v8 row_newbcast:4 row_mask:0xf bank_mask:0xf
    v_and_b32_dpp v41, v29, v9 row_newbcast:4 row_mask:0xf bank_mask:0xf
    v_and_b32_dpp v42, v29, v10 row_newbcast:4 row_mask:0xf bank_mask:0xf
    v_and_b32_dpp v43, v29, v11 row_newbcast:4 row_mask:0xf bank_mask:0xf
    v_and_b32_dpp v44, v29, v8 row_newbcast:12 row_mask:0xf bank_mask:0xf
    v_and_b32_dpp v45, v29, v9 row_newbcast:12 row_mask:0xf bank_mask:0xf
    v_and_b32_dpp v46, v29, v10 row_newbcast:12 row_mask:0xf bank_mask:0xf
    v_and_b32_dpp v47, v29, v11 row_newbcast:12 row_mask:0xf bank_mask:0xf
    s_waitcnt vmcnt(5)
    v_mfma_f32_16x16x32_bf16 v[12:15], v[32:35], a[48:51], v[12:15]
    v_mfma_f32_16x16x32_bf16 v[12:15], v[36:39], a[52:55], v[12:15]
    v_mfma_f32_16x16x32_bf16 v[12:15], v[40:43], a[56:59], v[12:15]
    v_mfma_f32_16x16x32_bf16 v[12:15], v[44:47], a[60:63], v[12:15]
    s_or_b32 s60, s61, s7
    s_orn2_b32 s61, s61, s6
    s_add_u32 s61, s61, 1
    s_and_b32 s61, s61, s6
    buffer_load_dwordx4 a[48:51], v0, s[36:39], s60 offen nt
    buffer_load_dwordx4 a[52:55], v18, s[36:39], s60 offen nt
    buffer_load_dwordx4 a[56:59], v48, s[36:39], s60 offen nt
    buffer_load_dwordx4 a[60:63], v49, s[36:39], s60 offen nt
    v_accvgpr_mov_b32 a195, a199
    v_accvgpr_mov_b32 a199, a203
    v_accvgpr_mov_b32 a203, a207
    v_accvgpr_mov_b32 a207, a211
    v_accvgpr_mov_b32 a211, a215
    v_accvgpr_mov_b32 a215, a219
    v_accvgpr_mov_b32 a219, a223
    v_accvgpr_mov_b32 a223, a227
    v_accvgpr_mov_b32 a227, a231
    s_add_u32 s56, s56, 4
    s_cmp_lg_u32 s56, 36
    s_cbranch_scc1 L_vnext
    v_add_f32_dpp v17, v17, v17 row_ror:4 row_mask:0xf bank_mask:0xf
    s_nop 1
    v_add_f32_dpp v17, v17, v17 row_ror:8 row_mask:0xf bank_mask:0xf
    v_mov_b32 v28, v17
    s_nop 1
    v_permlane16_swap_b32 v17, v28
    v_add_f32 v17, v17, v28
    v_mov_b32 v28, v17
    s_nop 1
    v_permlane32_swap_b32 v17, v28
    v_add_f32 v51, v17, v28
    v_mov_b32 v50, v16
    v_cvt_pk_bf16_f32 v52, v12, v13
    v_cvt_pk_bf16_f32 v53, v14, v15
    v_mov_b32 v12, 0
    v_mov_b32 v13, 0
    v_mov_b32 v14, 0
    v_mov_b32 v15, 0
    v_mov_b32 v16, 0xff800000
    v_mov_b32 v17, 0
    v_max_f32_dpp v27, v57, v57 row_ror:4 row_mask:0xf bank_mask:0xf
    s_nop 1
    v_max_f32_dpp v27, v27, v27 row_ror:8 row_mask:0xf bank_mask:0xf
    v_mov_b32 v28, v27
    s_nop 1
    v_permlane16_swap_b32 v27, v28
    v_max_f32 v27, v27, v28
    v_mov_b32 v28, v27
    s_nop 1
    v_permlane32_swap_b32 v27, v28
    v_max_f32 v16, v27, v28
L_vnext:
    s_cmp_lt_u32 s56, s20
    s_cbranch_scc1 L_vloop
    s_mov_b32 s18, 0
    s_mov_b32 s14, 0
    s_mov_b32 s58, s59
    s_mov_b32 s13, 1
    s_cmp_eq_u32 s18, 0
    s_cbranch_scc0 L_notk_2
    s_mov_b32 s16, 1
    s_atomic_add s16, s[30:31], s57 glc
L_notk_2:
    v_accvgpr_read_b32 v29, a192
    v_sub_f32 v29, v29, v16
    v_mul_f32 v29, s97, v29
    v_exp_f32 v29, v29
    s_nop 0
    v_add_f32 v17, v17, v29
    v_cvt_pk_bf16_f32 v29, v29, v29
    s_nop 1
    v_and_b32_dpp v32, v29, v8 row_newbcast:0 row_mask:0xf bank_mask:0xf
    v_and_b32_dpp v33, v29, v9 row_newbcast:0 row_mask:0xf bank_mask:0xf
    v_and_b32_dpp v34, v29, v10 row_newbcast:0 row_mask:0xf bank_mask:0xf
    v_and_b32_dpp v35, v29, v11 row_newbcast:0 row_mask:0xf bank_mask:0xf
    v_and_b32_dpp v36, v29, v8 row_newbcast:8 row_mask:0xf bank_mask:0xf
    v_and_b32_dpp v37, v29, v9 row_newbcast:8 row_mask:0xf bank_mask:0xf
    v_and_b32_dpp v38, v29, v10 row_newbcast:8 row_mask:0xf bank_mask:0xf
    v_and_b32_dpp v39, v29, v11 row_newbcast:8 row_mask:0xf bank_mask:0xf
    v_and_b32_dpp v40, v29, v8 row_newbcast:4 row_mask:0xf bank_mask:0xf
    v_and_b32_dpp v41, v29, v9 row_newbcast:4 row_mask:0xf bank_mask:0xf
    v_and_b32_dpp v42, v29, v10 row_newbcast:4 row_mask:0xf bank_mask:0xf
    v_and_b32_dpp v43, v29, v11 row_newbcast:4 row_mask:0xf bank_mask:0xf
    v_and_b32_dpp v44, v29, v8 row_newbcast:12 row_mask:0xf bank_mask:0xf
    v_and_b32_dpp v45, v29, v9 row_newbcast:12 row_mask:0xf bank_mask:0xf
    v_and_b32_dpp v46, v29, v10 row_newbcast:12 row_mask:0xf bank_mask:0xf
    v_and_b32_dpp v47, v29, v11 row_newbcast:12 row_mask:0xf bank_mask:0xf
    s_waitcnt vmcnt(12)
    v_mfma_f32_16x16x32_bf16 v[12:15], v[32:35], a[0:3], v[12:15]
    v_mfma_f32_16x16x32_bf16 v[12:15], v[36:39], a[4:7], v[12:15]
    v_mfma_f32_16x16x32_bf16 v[12:15], v[40:43], a[8:11], v[12:15]
    v_mfma_f32_16x16x32_bf16 v[12:15], v[44:47], a[12:15], v[12:15]
    s_cmp_lg_u32 s18, 0
    s_cbranch_scc1 L_have_3
    s_waitcnt lgkmcnt(0)
    s_add_u32 s17, s16, 144
    s_mov_b32 s18, 1
    s_min_u32 s54, s16, 28
    s_cselect_b32 s18, 2, s18
    s_mul_i32 s54, s54, 1
    s_add_u32 s17, s17, s54
    s_cmp_ge_u32 s17, s19
    s_cbranch_scc1 L_vdry0
    s_add_u32 s54, s17, s99
    s_lshl_b32 s61, s54, 9
    s_and_b32 s61, s61, 0xe00
    s_lshl_b32 s55, s54, 10
    s_and_b32 s55, s55, 0x6000
    s_or_b32 s61, s61, s55
    s_lshl_b32 s55, s54, 12
    s_and_b32 s55, s55, 0xe0000
    s_or_b32 s61, s61, s55
    s_cmp_lt_u32 s17, 256
    s_cselect_b32 s7, s11, 0x8000000
    s_cselect_b32 s18, s18, 9
    s_cselect_b32 s63, 0, 1
    s_mov_b32 s6, 0xe6e00
L_have_3:
    s_or_b32 s60, s61, s7
    buffer_load_dwordx4 v[64:67], v0, s[32:35], s60 offen nt
    buffer_load_dwordx4 v[68:71], v18, s[32:35], s60 offen nt
    buffer_load_dwordx4 v[72:75], v48, s[32:35], s60 offen nt
    buffer_load_dwordx4 v[76:79], v49, s[32:35], s60 offen nt
    s_orn2_b32 s61, s61, s6
    s_add_u32 s61, s61, 1
    s_and_b32 s61, s61, s6
    s_add_u32 s58, s58, 32768
    s_sub_u32 s18, s18, 1
    s_sub_u32 s62, s62, s63
    v_accvgpr_read_b32 v29, a193
    v_sub_f32 v29, v29, v16
    v_mul_f32 v29, s97, v29
    v_exp_f32 v29, v29
    s_nop 0
    v_add_f32 v17, v17, v29
    v_cvt_pk_bf16_f32 v29, v29, v29
    s_nop 1
    v_and_b32_dpp v32, v29, v8 row_newbcast:0 row_mask:0xf bank_mask:0xf
    v_and_b32_dpp v33, v29, v9 row_newbcast:0 row_mask:0xf bank_mask:0xf
    v_and_b32_dpp v34, v29, v10 row_newbcast:0 row_mask:0xf bank_mask:0xf
    v_and_b32_dpp v35, v29, v11 row_newbcast:0 row_mask:0xf bank_mask:0xf
    v_and_b32_dpp v36, v29, v8 row_newbcast:8 row_mask:0xf bank_mask:0xf
    v_and_b32_dpp v37, v29, v9 row_newbcast:8 row_mask:0xf bank_mask:0xf
    v_and_b32_dpp v38, v29, v10 row_newbcast:8 row_mask:0xf bank_mask:0xf
    v_and_b32_dpp v39, v29, v11 row_newbcast:8 row_mask:0xf bank_mask:0xf
    v_and_b32_dpp v40, v29, v8 row_newbcast:4 row_mask:0xf bank_mask:0xf
    v_and_b32_dpp v41, v29, v9 row_newbcast:4 row_mask:0xf bank_mask:0xf
    v_and_b32_dpp v42, v29, v10 row_newbcast:4 row_mask:0xf bank_mask:0xf
    v_and_b32_dpp v43, v29, v11 row_newbcast:4 row_mask:0xf bank_mask:0xf
    v_and_b32_dpp v44, v29, v8 row_newbcast:12 row_mask:0xf bank_mask:0xf
    v_and_b32_dpp v45, v29, v9 row_newbcast:12 row_mask:0xf bank_mask:0xf
    v_and_b32_dpp v46, v29, v10 row_newbcast:12 row_mask:0xf bank_mask:0xf
    v_and_b32_dpp v47, v29, v11 row_newbcast:12 row_mask:0xf bank_mask:0xf
    s_waitcnt vmcnt(12)
    v_mfma_f32_16x16x32_bf16 v[12:15], v[32:35], a[16:19], v[12:15]
    v_mfma_f32_16x16x32_bf16 v[12:15], v[36:39], a[20:23], v[12:15]
    v_mfma_f32_16x16x32_bf16 v[12:15], v[40:43], a[24:27], v[12:15]
    v_mfma_f32_16x16x32_bf16 v[12:15], v[44:47], a[28:31], v[12:15]
    buffer_load_dwordx4 a[0:3], v0, s[36:39], s60 offen nt
    buffer_load_dwordx4 a[4:7], v18, s[36:39], s60 offen nt
    buffer_load_dwordx4 a[8:11], v48, s[36:39], s60 offen nt
    buffer_load_dwordx4 a[12:15], v49, s[36:39], s60 offen nt
    s_cmp_eq_u32 s18, 0
    s_cbranch_scc0 L_notk_4
    s_mov_b32 s16, 1
    s_atomic_add s16, s[30:31], s57 glc
L_notk_4:
    v_accvgpr_read_b32 v29, a194
    v_sub_f32 v29, v29, v16
    v_mul_f32 v29, s97, v29
    v_exp_f32 v29, v29
    s_nop 0
    v_add_f32 v17, v17, v29
    v_cvt_pk_bf16_f32 v29, v29, v29
    s_nop 1
    v_and_b32_dpp v32, v29, v8 row_newbcast:0 row_mask:0xf bank_mask:0xf
    v_and_b32_dpp v33, v29, v9 row_newbcast:0 row_mask:0xf bank_mask:0xf
    v_and_b32_dpp v34, v29, v10 row_newbcast:0 row_mask:0xf bank_mask:0xf
    v_and_b32_dpp v35, v29, v11 row_newbcast:0 row_mask:0xf bank_mask:0xf
    v_and_b32_dpp v36, v29, v8 row_newbcast:8 row_mask:0xf bank_mask:0xf
    v_and_b32_dpp v37, v29, v9 row_newbcast:8 row_mask:0xf bank_mask:0xf
    v_and_b32_dpp v38, v29, v10 row_newbcast:8 row_mask:0xf bank_mask:0xf
    v_and_b32_dpp v39, v29, v11 row_newbcast:8 row_mask:0xf bank_mask:0xf
    v_and_b32_dpp v40, v29, v8 row_newbcast:4 row_mask:0xf bank_mask:0xf
    v_and_b32_dpp v41, v29, v9 row_newbcast:4 row_mask:0xf bank_mask:0xf
    v_and_b32_dpp v42, v29, v10 row_newbcast:4 row_mask:0xf bank_mask:0xf
    v_and_b32_dpp v43, v29, v11 row_newbcast:4 row_mask:0xf bank_mask:0xf
    v_and_b32_dpp v44, v29, v8 row_newbcast:12 row_mask:0xf bank_mask:0xf
    v_and_b32_dpp v45, v29, v9 row_newbcast:12 row_mask:0xf bank_mask:0xf
    v_and_b32_dpp v46, v29, v10 row_newbcast:12 row_mask:0xf bank_mask:0xf
    v_and_b32_dpp v47, v29, v11 row_newbcast:12 row_mask:0xf bank_mask:0xf
    s_waitcnt vmcnt(12)
    v_mfma_f32_16x16x32_bf16 v[12:15], v[32:35], a[32:35], v[12:15]
    v_mfma_f32_16x16x32_bf16 v[12:15], v[36:39], a[36:39], v[12:15]
    v_mfma_f32_16x16x32_bf16 v[12:15], v[40:43], a[40:43], v[12:15]
    v_mfma_f32_16x16x32_bf16 v[12:15], v[44:47], a[44:47], v[12:15]
    s_cmp_lg_u32 s18, 0
    s_cbranch_scc1 L_have_5
    s_waitcnt lgkmcnt(0)
    s_add_u32 s17, s16, 144
    s_mov_b32 s18, 1
    s_min_u32 s54, s16, 28
    s_cselect_b32 s18, 2, s18
    s_mul_i32 s54, s54, 1
    s_add_u32 s17, s17, s54
    s_cmp_ge_u32 s17, s19
    s_cbranch_scc1 L_vdry1
    s_add_u32 s54, s17, s99
    s_lshl_b32 s61, s54, 9
    s_and_b32 s61, s61, 0xe00
    s_lshl_b32 s55, s54, 10
    s_and_b32 s55, s55, 0x6000
    s_or_b32 s61, s61, s55
    s_lshl_b32 s55, s54, 12
    s_and_b32 s55, s55, 0xe0000
    s_or_b32 s61, s61, s55
    s_cmp_lt_u32 s17, 256
    s_cselect_b32 s7, s11, 0x8000000
    s_cselect_b32 s18, s18, 9
    s_cselect_b32 s63, 0, 1
    s_mov_b32 s6, 0xe6e00
L_have_5:
    s_or_b32 s60, s61, s7
    buffer_load_dwordx4 v[80:83], v0, s[32:35], s60 offen nt
    buffer_load_dwordx4 v[84:87], v18, s[32:35], s60 offen nt
    buffer_load_dwordx4 v[88:91], v48, s[32:35], s60 offen nt
    buffer_load_dwordx4 v[92:95], v49, s[32:35], s60 offen nt
    s_orn2_b32 s61, s61, s6
    s_add_u32 s61, s61, 1
    s_and_b32 s61, s61, s6
    s_add_u32 s58, s58, 32768
    s_sub_u32 s18, s18, 1
    s_sub_u32 s62, s62, s63
    v_accvgpr_read_b32 v29, a195
    v_sub_f32 v29, v29, v16
    v_mul_f32 v29, s97, v29
    v_exp_f32 v29, v29
    s_nop 0
    v_add_f32 v17, v17, v29
    v_cvt_pk_bf16_f32 v29, v29, v29
    s_nop 1
    v_and_b32_dpp v32, v29, v8 row_newbcast:0 row_mask:0xf bank_mask:0xf
    v_and_b32_dpp v33, v29, v9 row_newbcast:0 row_mask:0xf bank_mask:0xf
    v_and_b32_dpp v34, v29, v10 row_newbcast:0 row_mask:0xf bank_mask:0xf
    v_and_b32_dpp v35, v29, v11 row_newbcast:0 row_mask:0xf bank_mask:0xf
    v_and_b32_dpp v36, v29, v8 row_newbcast:8 row_mask:0xf bank_mask:0xf
    v_and_b32_dpp v37, v29, v9 row_newbcast:8 row_mask:0xf bank_mask:0xf
    v_and_b32_dpp v38, v29, v10 row_newbcast:8 row_mask:0xf bank_mask:0xf
    v_and_b32_dpp v39, v29, v11 row_newbcast:8 row_mask:0xf bank_mask:0xf
    v_and_b32_dpp v40, v29, v8 row_newbcast:4 row_mask:0xf bank_mask:0xf
    v_and_b32_dpp v41, v29, v9 row_newbcast:4 row_mask:0xf bank_mask:0xf
    v_and_b32_dpp v42, v29, v10 row_newbcast:4 row_mask:0xf bank_mask:0xf
    v_and_b32_dpp v43, v29, v11 row_newbcast:4 row_mask:0xf bank_mask:0xf
    v_and_b32_dpp v44, v29, v8 row_newbcast:12 row_mask:0xf bank_mask:0xf
    v_and_b32_dpp v45, v29, v9 row_newbcast:12 row_mask:0xf bank_mask:0xf
    v_and_b32_dpp v46, v29, v10 row_newbcast:12 row_mask:0xf bank_mask:0xf
    v_and_b32_dpp v47, v29, v11 row_newbcast:12 row_mask:0xf bank_mask:0xf
    s_waitcnt vmcnt(12)
    v_mfma_f32_16x16x32_bf16 v[12:15], v[32:35], a[48:51], v[12:15]
    v_mfma_f32_16x16x32_bf16 v[12:15], v[36:39], a[52:55], v[12:15]
    v_mfma_f32_16x16x32_bf16 v[12:15], v[40:43], a[56:59], v[12:15]
    v_mfma_f32_16x16x32_bf16 v[12:15], v[44:47], a[60:63], v[12:15]
    buffer_load_dwordx4 a[16:19], v0, s[36:39], s60 offen nt
    buffer_load_dwordx4 a[20:23], v18, s[36:39], s60 offen nt
    buffer_load_dwordx4 a[24:27], v48, s[36:39], s60 offen nt
    buffer_load_dwordx4 a[28:31], v49, s[36:39], s60 offen nt
    s_cmp_eq_u32 s18, 0
    s_cbranch_scc0 L_notk_6
    s_mov_b32 s16, 1
    s_atomic_add s16, s[30:31], s57 glc
L_notk_6:
    s_nop 3
    s_cmp_eq_u32 s62, 0
    s_cbranch_scc1 L_adone2
L_aloop:
    s_waitcnt vmcnt(12)
    v_dot2_f32_bf16 v20, v64, v4, 0
    v_dot2_f32_bf16 v21, v68, v4, 0
    v_dot2_f32_bf16 v22, v72, v4, 0
    v_dot2_f32_bf16 v23, v76, v4, 0
    v_dot2_f32_bf16 v20, v65, v5, v20
    v_dot2_f32_bf16 v21, v69, v5, v21
    v_dot2_f32_bf16 v22, v73, v5, v22
    v_dot2_f32_bf16 v23, v77, v5, v23
    v_dot2_f32_bf16 v20, v66, v6, v20
    v_dot2_f32_bf16 v21, v70, v6, v21
    v_dot2_f32_bf16 v22, v74, v6, v22
    v_dot2_f32_bf16 v23, v78, v6, v23
    v_dot2_f32_bf16 v20, v67, v7, v20
    v_dot2_f32_bf16 v21, v71, v7, v21
    v_dot2_f32_bf16 v22, v75, v7, v22
    v_dot2_f32_bf16 v23, v79, v7, v23
    s_cmp_lg_u32 s18, 0
    s_cbranch_scc1 L_have_7
    s_waitcnt lgkmcnt(0)
    s_add_u32 s17, s16, 144
    s_mov_b32 s18, 1
    s_min_u32 s54, s16, 28
    s_cselect_b32 s18, 2, s18
    s_mul_i32 s54, s54, 1
    s_add_u32 s17, s17, s54
    s_cmp_ge_u32 s17, s19
    s_cbranch_scc1 L_adrain0
    s_add_u32 s54, s17, s99
    s_lshl_b32 s61, s54, 9
    s_and_b32 s61, s61, 0xe00
    s_lshl_b32 s55, s54, 10
    s_and_b32 s55, s55, 0x6000
    s_or_b32 s61, s61, s55
    s_lshl_b32 s55, s54, 12
    s_and_b32 s55, s55, 0xe0000
    s_or_b32 s61, s61, s55
    s_cmp_lt_u32 s17, 256
    s_cselect_b32 s7, s11, 0x8000000
    s_cselect_b32 s18, s18, 9
    s_cselect_b32 s63, 0, 1
    s_mov_b32 s6, 0xe6e00
L_have_7:
    s_or_b32 s60, s61, s7
    buffer_load_dwordx4 v[64:67], v0, s[32:35], s60 offen nt
    buffer_load_dwordx4 v[68:71], v18, s[32:35], s60 offen nt
    buffer_load_dwordx4 v[72:75], v48, s[32:35], s60 offen nt
    buffer_load_dwordx4 v[76:79], v49, s[32:35], s60 offen nt
    s_orn2_b32 s61, s61, s6
    s_add_u32 s61, s61, 1
    s_and_b32 s61, s61, s6
    s_add_u32 s58, s58, 32768
    s_sub_u32 s18, s18, 1
    s_sub_u32 s62, s62, s63
    v_add_f32_dpp v24, v20, v20 row_ror:8 row_mask:0xf bank_mask:0x3
    v_add_f32_dpp v25, v22, v22 row_ror:8 row_mask:0xf bank_mask:0x3
    v_add_f32_dpp v24, v21, v21 row_ror:8 row_mask:0xf bank_mask:0xc
    v_add_f32_dpp v25, v23, v23 row_ror:8 row_mask:0xf bank_mask:0xc
    s_nop 0
    v_add_f32_dpp v26, v24, v24 row_shl:4 row_mask:0xf bank_mask:0x5
    v_add_f32_dpp v26, v25, v25 row_shr:4 row_mask:0xf bank_mask:0xa
    s_nop 1
    v_add_f32_dpp v26, v26, v26 quad_perm:[1,0,3,2] row_mask:0xf bank_mask:0xf
    s_nop 1
    v_add_f32_dpp v26, v26, v26 quad_perm:[2,3,0,1] row_mask:0xf bank_mask:0xf
    v_cvt_pk_bf16_f32 v26, v26, v26
    v_and_b32 v26, s98, v26
    v_mul_f32 v26, s96, v26
    v_cvt_pk_bf16_f32 v26, v26, v26
    v_and_b32 v26, s98, v26
    s_nop 1
    v_max_f32_dpp v27, v26, v26 row_ror:4 row_mask:0xf bank_mask:0xf
    s_nop 1
    v_max_f32_dpp v27, v27, v27 row_ror:8 row_mask:0xf bank_mask:0xf
    v_mov_b32 v28, v27
    s_nop 1
    v_permlane16_swap_b32 v27, v28
    v_max_f32 v27, v27, v28
    v_mov_b32 v28, v27
    s_nop 1
    v_permlane32_swap_b32 v27, v28
    v_max3_f32 v27, v27, v28, v16
    v_sub_f32 v28, v16, v27
    v_sub_f32 v29, v26, v27
    v_mul_f32 v28, s97, v28
    v_mul_f32 v29, s97, v29
    v_exp_f32 v28, v28
    v_exp_f32 v29, v29
    v_mov_b32 v16, v27
    v_fma_f32 v17, v17, v28, v29
    v_cvt_pk_bf16_f32 v29, v29, v29
    v_mul_f32 v12, v12, v28
    v_mul_f32 v13, v13, v28
    v_mul_f32 v14, v14, v28
    v_mul_f32 v15, v15, v28
    s_waitcnt vmcnt(12)
    v_and_b32_dpp v32, v29, v8 row_newbcast:0 row_mask:0xf bank_mask:0xf
    v_and_b32_dpp v33, v29, v9 row_newbcast:0 row_mask:0xf bank_mask:0xf
    v_and_b32_dpp v34, v29, v10 row_newbcast:0 row_mask:0xf bank_mask:0xf
    v_and_b32_dpp v35, v29, v11 row_newbcast:0 row_mask:0xf bank_mask:0xf
    v_and_b32_dpp v36, v29, v8 row_newbcast:8 row_mask:0xf bank_mask:0xf
    v_and_b32_dpp v37, v29, v9 row_newbcast:8 row_mask:0xf bank_mask:0xf
    v_and_b32_dpp v38, v29, v10 row_newbcast:8 row_mask:0xf bank_mask:0xf
    v_and_b32_dpp v39, v29, v11 row_newbcast:8 row_mask:0xf bank_mask:0xf
    v_and_b32_dpp v40, v29, v8 row_newbcast:4 row_mask:0xf bank_mask:0xf
    v_and_b32_dpp v41, v29, v9 row_newbcast:4 row_mask:0xf bank_mask:0xf
    v_and_b32_dpp v42, v29, v10 row_newbcast:4 row_mask:0xf bank_mask:0xf
    v_and_b32_dpp v43, v29, v11 row_newbcast:4 row_mask:0xf bank_mask:0xf
    v_and_b32_dpp v44, v29, v8 row_newbcast:12 row_mask:0xf bank_mask:0xf
    v_and_b32_dpp v45, v29, v9 row_newbcast:12 row_mask:0xf bank_mask:0xf
    v_and_b32_dpp v46, v29, v10 row_newbcast:12 row_mask:0xf bank_mask:0xf
    v_and_b32_dpp v47, v29, v11 row_newbcast:12 row_mask:0xf bank_mask:0xf
    v_mfma_f32_16x16x32_bf16 v[12:15], v[32:35], a[0:3], v[12:15]
    v_mfma_f32_16x16x32_bf16 v[12:15], v[36:39], a[4:7], v[12:15]
    v_mfma_f32_16x16x32_bf16 v[12:15], v[40:43], a[8:11], v[12:15]
    v_mfma_f32_16x16x32_bf16 v[12:15], v[44:47], a[12:15], v[12:15]
    buffer_load_dwordx4 a[0:3], v0, s[36:39], s60 offen nt
    buffer_load_dwordx4 a[4:7], v18, s[36:39], s60 offen nt
    buffer_load_dwordx4 a[8:11], v48, s[36:39], s60 offen nt
    buffer_load_dwordx4 a[12:15], v49, s[36:39], s60 offen nt
    s_cmp_eq_u32 s18, 0
    s_cbranch_scc0 L_notk_8
    s_mov_b32 s16, 1
    s_atomic_add s16, s[30:31], s57 glc
L_notk_8:
    s_cmp_eq_u32 s62, 0
    s_cbranch_scc1 L_adone
    s_waitcnt vmcnt(12)
    v_dot2_f32_bf16 v20, v80, v4, 0
    v_dot2_f32_bf16 v21, v84, v4, 0
    v_dot2_f32_bf16 v22, v88, v4, 0
    v_dot2_f32_bf16 v23, v92, v4, 0
    v_dot2_f32_bf16 v20, v81, v5, v20
    v_dot2_f32_bf16 v21, v85, v5, v21
    v_dot2_f32_bf16 v22, v89, v5, v22
    v_dot2_f32_bf16 v23, v93, v5, v23
    v_dot2_f32_bf16 v20, v82, v6, v20
    v_dot2_f32_bf16 v21, v86, v6, v21
    v_dot2_f32_bf16 v22, v90, v6, v22
    v_dot2_f32_bf16 v23, v94, v6, v23
    v_dot2_f32_bf16 v20, v83, v7, v20
    v_dot2_f32_bf16 v21, v87, v7, v21
    v_dot2_f32_bf16 v22, v91, v7, v22
    v_dot2_f32_bf16 v23, v95, v7, v23
    s_cmp_lg_u32 s18, 0
    s_cbranch_scc1 L_have_9
    s_waitcnt lgkmcnt(0)
    s_add_u32 s17, s16, 144
    s_mov_b32 s18, 1
    s_min_u32 s54, s16, 28
    s_cselect_b32 s18, 2, s18
    s_mul_i32 s54, s54, 1
    s_add_u32 s17, s17, s54
    s_cmp_ge_u32 s17, s19
    s_cbranch_scc1 L_adrain1
    s_add_u32 s54, s17, s99
    s_lshl_b32 s61, s54, 9
    s_and_b32 s61, s61, 0xe00
    s_lshl_b32 s55, s54, 10
    s_and_b32 s55, s55, 0x6000
    s_or_b32 s61, s61, s55
    s_lshl_b32 s55, s54, 12
    s_and_b32 s55, s55, 0xe0000
    s_or_b32 s61, s61, s55
    s_cmp_lt_u32 s17, 256
    s_cselect_b32 s7, s11, 0x8000000
    s_cselect_b32 s18, s18, 9
    s_cselect_b32 s63, 0, 1
    s_mov_b32 s6, 0xe6e00
L_have_9:
    s_or_b32 s60, s61, s7
    buffer_load_dwordx4 v[80:83], v0, s[32:35], s60 offen nt
    buffer_load_dwordx4 v[84:87], v18, s[32:35], s60 offen nt
    buffer_load_dwordx4 v[88:91], v48, s[32:35], s60 offen nt
    buffer_load_dwordx4 v[92:95], v49, s[32:35], s60 offen nt
    s_orn2_b32 s61, s61, s6
    s_add_u32 s61, s61, 1
    s_and_b32 s61, s61, s6
    s_add_u32 s58, s58, 32768
    s_sub_u32 s18, s18, 1
    s_sub_u32 s62, s62, s63
    v_add_f32_dpp v24, v20, v20 row_ror:8 row_mask:0xf bank_mask:0x3
    v_add_f32_dpp v25, v22, v22 row_ror:8 row_mask:0xf bank_mask:0x3
    v_add_f32_dpp v24, v21, v21 row_ror:8 row_mask:0xf bank_mask:0xc
    v_add_f32_dpp v25, v23, v23 row_ror:8 row_mask:0xf bank_mask:0xc
    s_nop 0
    v_add_f32_dpp v26, v24, v24 row_shl:4 row_mask:0xf bank_mask:0x5
    v_add_f32_dpp v26, v25, v25 row_shr:4 row_mask:0xf bank_mask:0xa
    s_nop 1
    v_add_f32_dpp v26, v26, v26 quad_perm:[1,0,3,2] row_mask:0xf bank_mask:0xf
    s_nop 1
    v_add_f32_dpp v26, v26, v26 quad_perm:[2,3,0,1] row_mask:0xf bank_mask:0xf
    v_cvt_pk_bf16_f32 v26, v26, v26
    v_and_b32 v26, s98, v26
    v_mul_f32 v26, s96, v26
    v_cvt_pk_bf16_f32 v26, v26, v26
    v_and_b32 v26, s98, v26
    s_nop 1
    v_max_f32_dpp v27, v26, v26 row_ror:4 row_mask:0xf bank_mask:0xf
    s_nop 1
    v_max_f32_dpp v27, v27, v27 row_ror:8 row_mask:0xf bank_mask:0xf
    v_mov_b32 v28, v27
    s_nop 1
    v_permlane16_swap_b32 v27, v28
    v_max_f32 v27, v27, v28
    v_mov_b32 v28, v27
    s_nop 1
    v_permlane32_swap_b32 v27, v28
    v_max3_f32 v27, v27, v28, v16
    v_sub_f32 v28, v16, v27
    v_sub_f32 v29, v26, v27
    v_mul_f32 v28, s97, v28
    v_mul_f32 v29, s97, v29
    v_exp_f32 v28, v28
    v_exp_f32 v29, v29
    v_mov_b32 v16, v27
    v_fma_f32 v17, v17, v28, v29
    v_cvt_pk_bf16_f32 v29, v29, v29
    v_mul_f32 v12, v12, v28
    v_mul_f32 v13, v13, v28
    v_mul_f32 v14, v14, v28
    v_mul_f32 v15, v15, v28
    s_waitcnt vmcnt(12)
    v_and_b32_dpp v32, v29, v8 row_newbcast:0 row_mask:0xf bank_mask:0xf
    v_and_b32_dpp v33, v29, v9 row_newbcast:0 row_mask:0xf bank_mask:0xf
    v_and_b32_dpp v34, v29, v10 row_newbcast:0 row_mask:0xf bank_mask:0xf
    v_and_b32_dpp v35, v29, v11 row_newbcast:0 row_mask:0xf bank_mask:0xf
    v_and_b32_dpp v36, v29, v8 row_newbcast:8 row_mask:0xf bank_mask:0xf
    v_and_b32_dpp v37, v29, v9 row_newbcast:8 row_mask:0xf bank_mask:0xf
    v_and_b32_dpp v38, v29, v10 row_newbcast:8 row_mask:0xf bank_mask:0xf
    v_and_b32_dpp v39, v29, v11 row_newbcast:8 row_mask:0xf bank_mask:0xf
    v_and_b32_dpp v40, v29, v8 row_newbcast:4 row_mask:0xf bank_mask:0xf
    v_and_b32_dpp v41, v29, v9 row_newbcast:4 row_mask:0xf bank_mask:0xf
    v_and_b32_dpp v42, v29, v10 row_newbcast:4 row_mask:0xf bank_mask:0xf
    v_and_b32_dpp v43, v29, v11 row_newbcast:4 row_mask:0xf bank_mask:0xf
    v_and_b32_dpp v44, v29, v8 row_newbcast:12 row_mask:0xf bank_mask:0xf
    v_and_b32_dpp v45, v29, v9 row_newbcast:12 row_mask:0xf bank_mask:0xf
    v_and_b32_dpp v46, v29, v10 row_newbcast:12 row_mask:0xf bank_mask:0xf
    v_and_b32_dpp v47, v29, v11 row_newbcast:12 row_mask:0xf bank_mask:0xf
    v_mfma_f32_16x16x32_bf16 v[12:15], v[32:35], a[16:19], v[12:15]
    v_mfma_f32_16x16x32_bf16 v[12:15], v[36:39], a[20:23], v[12:15]
    v_mfma_f32_16x16x32_bf16 v[12:15], v[40:43], a[24:27], v[12:15]
    v_mfma_f32_16x16x32_bf16 v[12:15], v[44:47], a[28:31], v[12:15]
    buffer_load_dwordx4 a[16:19], v0, s[36:39], s60 offen nt
    buffer_load_dwordx4 a[20:23], v18, s[36:39], s60 offen nt
    buffer_load_dwordx4 a[24:27], v48, s[36:39], s60 offen nt
    buffer_load_dwordx4 a[28:31], v49, s[36:39], s60 offen nt
    s_cmp_eq_u32 s18, 0
    s_cbranch_scc0 L_notk_10
    s_mov_b32 s16, 1
    s_atomic_add s16, s[30:31], s57 glc
L_notk_10:
    s_cmp_eq_u32 s62, 0
    s_cbranch_scc1 L_adone
    s_cmp_lg_u32 s58, s14
    s_cbranch_scc1 L_aloop
    s_cmp_eq_u32 s14, s15
    s_cbranch_scc1 L_aswitch
    buffer_load_dwordx4 v[60:63], v59, s[44:47], s12 offen sc1
    s_mov_b32 s14, s15
    s_branch L_aloop
L_aswitch:
    s_nop 11
    v_add_f32_dpp v17, v17, v17 row_ror:4 row_mask:0xf bank_mask:0xf
    s_nop 1
    v_add_f32_dpp v17, v17, v17 row_ror:8 row_mask:0xf bank_mask:0xf
    v_mov_b32 v28, v17
    s_nop 1
    v_permlane16_swap_b32 v17, v28
    v_add_f32 v17, v17, v28
    v_mov_b32 v28, v17
    s_nop 1
    v_permlane32_swap_b32 v17, v28
    v_add_f32 v51, v17, v28
    v_mov_b32 v50, v16
    v_cvt_pk_bf16_f32 v52, v12, v13
    v_cvt_pk_bf16_f32 v53, v14, v15
    v_mov_b32 v12, 0
    v_mov_b32 v13, 0
    v_mov_b32 v14, 0
    v_mov_b32 v15, 0
    v_mov_b32 v16, 0xff800000
    v_mov_b32 v17, 0
    s_mov_b32 s13, 1
    s_cmp_eq_u32 s62, 0
    s_cbranch_scc1 L_adone
    s_cmp_lg_u32 s62, 3
    s_cbranch_scc1 L_aloop
    s_branch L_alast0
L_adrain1:
    buffer_load_dwordx4 v[128:131], v19, s[40:43], s24 offen offset:0 nt
    buffer_load_dwordx4 v[132:135], v19, s[40:43], s24 offen offset:1152 nt
    buffer_load_dwordx4 v[136:139], v19, s[40:43], s24 offen offset:2304 nt
    buffer_load_dwordx4 v[140:143], v19, s[40:43], s24 offen offset:3456 nt
    s_add_u32 s24, s24, 4608
    buffer_load_dwordx4 v[144:147], v19, s[40:43], s24 offen offset:0 nt
    buffer_load_dwordx4 v[148:151], v19, s[40:43], s24 offen offset:1152 nt
    buffer_load_dwordx4 v[152:155], v19, s[40:43], s24 offen offset:2304 nt
    buffer_load_dwordx4 v[156:159], v19, s[40:43], s24 offen offset:3456 nt
    s_add_u32 s24, s24, 69120
    v_add_f32_dpp v24, v20, v20 row_ror:8 row_mask:0xf bank_mask:0x3
    v_add_f32_dpp v25, v22, v22 row_ror:8 row_mask:0xf bank_mask:0x3
    v_add_f32_dpp v24, v21, v21 row_ror:8 row_mask:0xf bank_mask:0xc
    v_add_f32_dpp v25, v23, v23 row_ror:8 row_mask:0xf bank_mask:0xc
    s_nop 0
    v_add_f32_dpp v26, v24, v24 row_shl:4 row_mask:0xf bank_mask:0x5
    v_add_f32_dpp v26, v25, v25 row_shr:4 row_mask:0xf bank_mask:0xa
    s_nop 1
    v_add_f32_dpp v26, v26, v26 quad_perm:[1,0,3,2] row_mask:0xf bank_mask:0xf
    s_nop 1
    v_add_f32_dpp v26, v26, v26 quad_perm:[2,3,0,1] row_mask:0xf bank_mask:0xf
    v_cvt_pk_bf16_f32 v26, v26, v26
    v_and_b32 v26, s98, v26
    v_mul_f32 v26, s96, v26
    v_cvt_pk_bf16_f32 v26, v26, v26
    v_and_b32 v26, s98, v26
    s_nop 1
    v_max_f32_dpp v27, v26, v26 row_ror:4 row_mask:0xf bank_mask:0xf
    s_nop 1
    v_max_f32_dpp v27, v27, v27 row_ror:8 row_mask:0xf bank_mask:0xf
    v_mov_b32 v28, v27
    s_nop 1
    v_permlane16_swap_b32 v27, v28
    v_max_f32 v27, v27, v28
    v_mov_b32 v28, v27
    s_nop 1
    v_permlane32_swap_b32 v27, v28
    v_max3_f32 v27, v27, v28, v16
    v_sub_f32 v28, v16, v27
    v_sub_f32 v29, v26, v27
    v_mul_f32 v28, s97, v28
    v_mul_f32 v29, s97, v29
    v_exp_f32 v28, v28
    v_exp_f32 v29, v29
    v_mov_b32 v16, v27
    v_fma_f32 v17, v17, v28, v29
    v_cvt_pk_bf16_f32 v29, v29, v29
    v_mul_f32 v12, v12, v28
    v_mul_f32 v13, v13, v28
    v_mul_f32 v14, v14, v28
    v_mul_f32 v15, v15, v28
    s_waitcnt vmcnt(16)
    v_and_b32_dpp v32, v29, v8 row_newbcast:0 row_mask:0xf bank_mask:0xf
    v_and_b32_dpp v33, v29, v9 row_newbcast:0 row_mask:0xf bank_mask:0xf
    v_and_b32_dpp v34, v29, v10 row_newbcast:0 row_mask:0xf bank_mask:0xf
    v_and_b32_dpp v35, v29, v11 row_newbcast:0 row_mask:0xf bank_mask:0xf
    v_and_b32_dpp v36, v29, v8 row_newbcast:8 row_mask:0xf bank_mask:0xf
    v_and_b32_dpp v37, v29, v9 row_newbcast:8 row_mask:0xf bank_mask:0xf
    v_and_b32_dpp v38, v29, v10 row_newbcast:8 row_mask:0xf bank_mask:0xf
    v_and_b32_dpp v39, v29, v11 row_newbcast:8 row_mask:0xf bank_mask:0xf
    v_and_b32_dpp v40, v29, v8 row_newbcast:4 row_mask:0xf bank_mask:0xf
    v_and_b32_dpp v41, v29, v9 row_newbcast:4 row_mask:0xf bank_mask:0xf
    v_and_b32_dpp v42, v29, v10 row_newbcast:4 row_mask:0xf bank_mask:0xf
    v_and_b32_dpp v43, v29, v11 row_newbcast:4 row_mask:0xf bank_mask:0xf
    v_and_b32_dpp v44, v29, v8 row_newbcast:12 row_mask:0xf bank_mask:0xf
    v_and_b32_dpp v45, v29, v9 row_newbcast:12 row_mask:0xf bank_mask:0xf
    v_and_b32_dpp v46, v29, v10 row_newbcast:12 row_mask:0xf bank_mask:0xf
    v_and_b32_dpp v47, v29, v11 row_newbcast:12 row_mask:0xf bank_mask:0xf
    v_mfma_f32_16x16x32_bf16 v[12:15], v[32:35], a[16:19], v[12:15]
    v_mfma_f32_16x16x32_bf16 v[12:15], v[36:39], a[20:23], v[12:15]
    v_mfma_f32_16x16x32_bf16 v[12:15], v[40:43], a[24:27], v[12:15]
    v_mfma_f32_16x16x32_bf16 v[12:15], v[44:47], a[28:31], v[12:15]
    s_mov_b32 s62, 3
    s_cmp_eq_u32 s13, 0
    s_cbranch_scc1 L_aswitch
L_alast0:
    s_waitcnt vmcnt(12)
    v_dot2_f32_bf16 v20, v64, v4, 0
    v_dot2_f32_bf16 v21, v68, v4, 0
    v_dot2_f32_bf16 v22, v72, v4, 0
    v_dot2_f32_bf16 v23, v76, v4, 0
    v_dot2_f32_bf16 v20, v65, v5, v20
    v_dot2_f32_bf16 v21, v69, v5, v21
    v_dot2_f32_bf16 v22, v73, v5, v22
    v_dot2_f32_bf16 v23, v77, v5, v23
    v_dot2_f32_bf16 v20, v66, v6, v20
    v_dot2_f32_bf16 v21, v70, v6, v21
    v_dot2_f32_bf16 v22, v74, v6, v22
    v_dot2_f32_bf16 v23, v78, v6, v23
    v_dot2_f32_bf16 v20, v67, v7, v20
    v_dot2_f32_bf16 v21, v71, v7, v21
    v_dot2_f32_bf16 v22, v75, v7, v22
    v_dot2_f32_bf16 v23, v79, v7, v23
    buffer_load_dwordx4 v[160:163], v19, s[40:43], s24 offen offset:0 nt
    buffer_load_dwordx4 v[164:167], v19, s[40:43], s24 offen offset:1152 nt
    buffer_load_dwordx4 v[168:171], v19, s[40:43], s24 offen offset:2304 nt
    buffer_load_dwordx4 v[172:175], v19, s[40:43], s24 offen offset:3456 nt
    s_add_u32 s24, s24, 4608
    buffer_load_dwordx4 v[176:179], v19, s[40:43], s24 offen offset:0 nt
    buffer_load_dwordx4 v[180:183], v19, s[40:43], s24 offen offset:1152 nt
    buffer_load_dwordx4 v[184:187], v19, s[40:43], s24 offen offset:2304 nt
    buffer_load_dwordx4 v[188:191], v19, s[40:43], s24 offen offset:3456 nt
    v_add_f32_dpp v24, v20, v20 row_ror:8 row_mask:0xf bank_mask:0x3
    v_add_f32_dpp v25, v22, v22 row_ror:8 row_mask:0xf bank_mask:0x3
    v_add_f32_dpp v24, v21, v21 row_ror:8 row_mask:0xf bank_mask:0xc
    v_add_f32_dpp v25, v23, v23 row_ror:8 row_mask:0xf bank_mask:0xc
    s_nop 0
    v_add_f32_dpp v26, v24, v24 row_shl:4 row_mask:0xf bank_mask:0x5
    v_add_f32_dpp v26, v25, v25 row_shr:4 row_mask:0xf bank_mask:0xa
    s_nop 1
    v_add_f32_dpp v26, v26, v26 quad_perm:[1,0,3,2] row_mask:0xf bank_mask:0xf
    s_nop 1
    v_add_f32_dpp v26, v26, v26 quad_perm:[2,3,0,1] row_mask:0xf bank_mask:0xf
    v_cvt_pk_bf16_f32 v26, v26, v26
    v_and_b32 v26, s98, v26
    v_mul_f32 v26, s96, v26
    v_cvt_pk_bf16_f32 v26, v26, v26
    v_and_b32 v26, s98, v26
    s_nop 1
    v_max_f32_dpp v27, v26, v26 row_ror:4 row_mask:0xf bank_mask:0xf
    s_nop 1
    v_max_f32_dpp v27, v27, v27 row_ror:8 row_mask:0xf bank_mask:0xf
    v_mov_b32 v28, v27
    s_nop 1
    v_permlane16_swap_b32 v27, v28
    v_max_f32 v27, v27, v28
    v_mov_b32 v28, v27
    s_nop 1
    v_permlane32_swap_b32 v27, v28
    v_max3_f32 v27, v27, v28, v16
    v_sub_f32 v28, v16, v27
    v_sub_f32 v29, v26, v27
    v_mul_f32 v28, s97, v28
    v_mul_f32 v29, s97, v29
    v_exp_f32 v28, v28
    v_exp_f32 v29, v29
    v_mov_b32 v16, v27
    v_fma_f32 v17, v17, v28, v29
    v_cvt_pk_bf16_f32 v29, v29, v29
    v_mul_f32 v12, v12, v28
    v_mul_f32 v13, v13, v28
    v_mul_f32 v14, v14, v28
    v_mul_f32 v15, v15, v28
    s_waitcnt vmcnt(16)
    v_and_b32_dpp v32, v29, v8 row_newbcast:0 row_mask:0xf bank_mask:0xf
    v_and_b32_dpp v33, v29, v9 row_newbcast:0 row_mask:0xf bank_mask:0xf
    v_and_b32_dpp v34, v29, v10 row_newbcast:0 row_mask:0xf bank_mask:0xf
    v_and_b32_dpp v35, v29, v11 row_newbcast:0 row_mask:0xf bank_mask:0xf
    v_and_b32_dpp v36, v29, v8 row_newbcast:8 row_mask:0xf bank_mask:0xf
    v_and_b32_dpp v37, v29, v9 row_newbcast:8 row_mask:0xf bank_mask:0xf
    v_and_b32_dpp v38, v29, v10 row_newbcast:8 row_mask:0xf bank_mask:0xf
    v_and_b32_dpp v39, v29, v11 row_newbcast:8 row_mask:0xf bank_mask:0xf
    v_and_b32_dpp v40, v29, v8 row_newbcast:4 row_mask:0xf bank_mask:0xf
    v_and_b32_dpp v41, v29, v9 row_newbcast:4 row_mask:0xf bank_mask:0xf
    v_and_b32_dpp v42, v29, v10 row_newbcast:4 row_mask:0xf bank_mask:0xf
    v_and_b32_dpp v43, v29, v11 row_newbcast:4 row_mask:0xf bank_mask:0xf
    v_and_b32_dpp v44, v29, v8 row_newbcast:12 row_mask:0xf bank_mask:0xf
    v_and_b32_dpp v45, v29, v9 row_newbcast:12 row_mask:0xf bank_mask:0xf
    v_and_b32_dpp v46, v29, v10 row_newbcast:12 row_mask:0xf bank_mask:0xf
    v_and_b32_dpp v47, v29, v11 row_newbcast:12 row_mask:0xf bank_mask:0xf
    v_mfma_f32_16x16x32_bf16 v[12:15], v[32:35], a[0:3], v[12:15]
    v_mfma_f32_16x16x32_bf16 v[12:15], v[36:39], a[4:7], v[12:15]
    v_mfma_f32_16x16x32_bf16 v[12:15], v[40:43], a[8:11], v[12:15]
    v_mfma_f32_16x16x32_bf16 v[12:15], v[44:47], a[12:15], v[12:15]
    s_nop 3
    s_branch L_adone2
L_adrain0:
    buffer_load_dwordx4 v[128:131], v19, s[40:43], s24 offen offset:0 nt
    buffer_load_dwordx4 v[132:135], v19, s[40:43], s24 offen offset:1152 nt
    buffer_load_dwordx4 v[136:139], v19, s[40:43], s24 offen offset:2304 nt
    buffer_load_dwordx4 v[140:143], v19, s[40:43], s24 offen offset:3456 nt
    s_add_u32 s24, s24, 4608
    buffer_load_dwordx4 v[144:147], v19, s[40:43], s24 offen offset:0 nt
    buffer_load_dwordx4 v[148:151], v19, s[40:43], s24 offen offset:1152 nt
    buffer_load_dwordx4 v[152:155], v19, s[40:43], s24 offen offset:2304 nt
    buffer_load_dwordx4 v[156:159], v19, s[40:43], s24 offen offset:3456 nt
    s_add_u32 s24, s24, 69120
    v_add_f32_dpp v24, v20, v20 row_ror:8 row_mask:0xf bank_mask:0x3
    v_add_f32_dpp v25, v22, v22 row_ror:8 row_mask:0xf bank_mask:0x3
    v_add_f32_dpp v24, v21, v21 row_ror:8 row_mask:0xf bank_mask:0xc
    v_add_f32_dpp v25, v23, v23 row_ror:8 row_mask:0xf bank_mask:0xc
    s_nop 0
    v_add_f32_dpp v26, v24, v24 row_shl:4 row_mask:0xf bank_mask:0x5
    v_add_f32_dpp v26, v25, v25 row_shr:4 row_mask:0xf bank_mask:0xa
    s_nop 1
    v_add_f32_dpp v26, v26, v26 quad_perm:[1,0,3,2] row_mask:0xf bank_mask:0xf
    s_nop 1
    v_add_f32_dpp v26, v26, v26 quad_perm:[2,3,0,1] row_mask:0xf bank_mask:0xf
    v_cvt_pk_bf16_f32 v26, v26, v26
    v_and_b32 v26, s98, v26
    v_mul_f32 v26, s96, v26
    v_cvt_pk_bf16_f32 v26, v26, v26
    v_and_b32 v26, s98, v26
    s_nop 1
    v_max_f32_dpp v27, v26, v26 row_ror:4 row_mask:0xf bank_mask:0xf
    s_nop 1
    v_max_f32_dpp v27, v27, v27 row_ror:8 row_mask:0xf bank_mask:0xf
    v_mov_b32 v28, v27
    s_nop 1
    v_permlane16_swap_b32 v27, v28
    v_max_f32 v27, v27, v28
    v_mov_b32 v28, v27
    s_nop 1
    v_permlane32_swap_b32 v27, v28
    v_max3_f32 v27, v27, v28, v16
    v_sub_f32 v28, v16, v27
    v_sub_f32 v29, v26, v27
    v_mul_f32 v28, s97, v28
    v_mul_f32 v29, s97, v29
    v_exp_f32 v28, v28
    v_exp_f32 v29, v29
    v_mov_b32 v16, v27
    v_fma_f32 v17, v17, v28, v29
    v_cvt_pk_bf16_f32 v29, v29, v29
    v_mul_f32 v12, v12, v28
    v_mul_f32 v13, v13, v28
    v_mul_f32 v14, v14, v28
    v_mul_f32 v15, v15, v28
    s_waitcnt vmcnt(16)
    v_and_b32_dpp v32, v29, v8 row_newbcast:0 row_mask:0xf bank_mask:0xf
    v_and_b32_dpp v33, v29, v9 row_newbcast:0 row_mask:0xf bank_mask:0xf
    v_and_b32_dpp v34, v29, v10 row_newbcast:0 row_mask:0xf bank_mask:0xf
    v_and_b32_dpp v35, v29, v11 row_newbcast:0 row_mask:0xf bank_mask:0xf
    v_and_b32_dpp v36, v29, v8 row_newbcast:8 row_mask:0xf bank_mask:0xf
    v_and_b32_dpp v37, v29, v9 row_newbcast:8 row_mask:0xf bank_mask:0xf
    v_and_b32_dpp v38, v29, v10 row_newbcast:8 row_mask:0xf bank_mask:0xf
    v_and_b32_dpp v39, v29, v11 row_newbcast:8 row_mask:0xf bank_mask:0xf
    v_and_b32_dpp v40, v29, v8 row_newbcast:4 row_mask:0xf bank_mask:0xf
    v_and_b32_dpp v41, v29, v9 row_newbcast:4 row_mask:0xf bank_mask:0xf
    v_and_b32_dpp v42, v29, v10 row_newbcast:4 row_mask:0xf bank_mask:0xf
    v_and_b32_dpp v43, v29, v11 row_newbcast:4 row_mask:0xf bank_mask:0xf
    v_and_b32_dpp v44, v29, v8 row_newbcast:12 row_mask:0xf bank_mask:0xf
    v_and_b32_dpp v45, v29, v9 row_newbcast:12 row_mask:0xf bank_mask:0xf
    v_and_b32_dpp v46, v29, v10 row_newbcast:12 row_mask:0xf bank_mask:0xf
    v_and_b32_dpp v47, v29, v11 row_newbcast:12 row_mask:0xf bank_mask:0xf
    v_mfma_f32_16x16x32_bf16 v[12:15], v[32:35], a[0:3], v[12:15]
    v_mfma_f32_16x16x32_bf16 v[12:15], v[36:39], a[4:7], v[12:15]
    v_mfma_f32_16x16x32_bf16 v[12:15], v[40:43], a[8:11], v[12:15]
    v_mfma_f32_16x16x32_bf16 v[12:15], v[44:47], a[12:15], v[12:15]
    s_waitcnt vmcnt(12)
    v_dot2_f32_bf16 v20, v80, v4, 0
    v_dot2_f32_bf16 v21, v84, v4, 0
    v_dot2_f32_bf16 v22, v88, v4, 0
    v_dot2_f32_bf16 v23, v92, v4, 0
    v_dot2_f32_bf16 v20, v81, v5, v20
    v_dot2_f32_bf16 v21, v85, v5, v21
    v_dot2_f32_bf16 v22, v89, v5, v22
    v_dot2_f32_bf16 v23, v93, v5, v23
    v_dot2_f32_bf16 v20, v82, v6, v20
    v_dot2_f32_bf16 v21, v86, v6, v21
    v_dot2_f32_bf16 v22, v90, v6, v22
    v_dot2_f32_bf16 v23, v94, v6, v23
    v_dot2_f32_bf16 v20, v83, v7, v20
    v_dot2_f32_bf16 v21, v87, v7, v21
    v_dot2_f32_bf16 v22, v91, v7, v22
    v_dot2_f32_bf16 v23, v95, v7, v23
    buffer_load_dwordx4 v[160:163], v19, s[40:43], s24 offen offset:0 nt
    buffer_load_dwordx4 v[164:167], v19, s[40:43], s24 offen offset:1152 nt
    buffer_load_dwordx4 v[168:171], v19, s[40:43], s24 offen offset:2304 nt
    buffer_load_dwordx4 v[172:175], v19, s[40:43], s24 offen offset:3456 nt
    s_add_u32 s24, s24, 4608
    buffer_load_dwordx4 v[176:179], v19, s[40:43], s24 offen offset:0 nt
    buffer_load_dwordx4 v[180:183], v19, s[40:43], s24 offen offset:1152 nt
    buffer_load_dwordx4 v[184:187], v19, s[40:43], s24 offen offset:2304 nt
    buffer_load_dwordx4 v[188:191], v19, s[40:43], s24 offen offset:3456 nt
    v_add_f32_dpp v24, v20, v20 row_ror:8 row_mask:0xf bank_mask:0x3
    v_add_f32_dpp v25, v22, v22 row_ror:8 row_mask:0xf bank_mask:0x3
    v_add_f32_dpp v24, v21, v21 row_ror:8 row_mask:0xf bank_mask:0xc
    v_add_f32_dpp v25, v23, v23 row_ror:8 row_mask:0xf bank_mask:0xc
    s_nop 0
    v_add_f32_dpp v26, v24, v24 row_shl:4 row_mask:0xf bank_mask:0x5
    v_add_f32_dpp v26, v25, v25 row_shr:4 row_mask:0xf bank_mask:0xa
    s_nop 1
    v_add_f32_dpp v26, v26, v26 quad_perm:[1,0,3,2] row_mask:0xf bank_mask:0xf
    s_nop 1
    v_add_f32_dpp v26, v26, v26 quad_perm:[2,3,0,1] row_mask:0xf bank_mask:0xf
    v_cvt_pk_bf16_f32 v26, v26, v26
    v_and_b32 v26, s98, v26
    v_mul_f32 v26, s96, v26
    v_cvt_pk_bf16_f32 v26, v26, v26
    v_and_b32 v26, s98, v26
    s_nop 1
    v_max_f32_dpp v27, v26, v26 row_ror:4 row_mask:0xf bank_mask:0xf
    s_nop 1
    v_max_f32_dpp v27, v27, v27 row_ror:8 row_mask:0xf bank_mask:0xf
    v_mov_b32 v28, v27
    s_nop 1
    v_permlane16_swap_b32 v27, v28
    v_max_f32 v27, v27, v28
    v_mov_b32 v28, v27
    s_nop 1
    v_permlane32_swap_b32 v27, v28
    v_max3_f32 v27, v27, v28, v16
    v_sub_f32 v28, v16, v27
    v_sub_f32 v29, v26, v27
    v_mul_f32 v28, s97, v28
    v_mul_f32 v29, s97, v29
    v_exp_f32 v28, v28
    v_exp_f32 v29, v29
    v_mov_b32 v16, v27
    v_fma_f32 v17, v17, v28, v29
    v_cvt_pk_bf16_f32 v29, v29, v29
    v_mul_f32 v12, v12, v28
    v_mul_f32 v13, v13, v28
    v_mul_f32 v14, v14, v28
    v_mul_f32 v15, v15, v28
    s_waitcnt vmcnt(16)
    v_and_b32_dpp v32, v29, v8 row_newbcast:0 row_mask:0xf bank_mask:0xf
    v_and_b32_dpp v33, v29, v9 row_newbcast:0 row_mask:0xf bank_mask:0xf
    v_and_b32_dpp v34, v29, v10 row_newbcast:0 row_mask:0xf bank_mask:0xf
    v_and_b32_dpp v35, v29, v11 row_newbcast:0 row_mask:0xf bank_mask:0xf
    v_and_b32_dpp v36, v29, v8 row_newbcast:8 row_mask:0xf bank_mask:0xf
    v_and_b32_dpp v37, v29, v9 row_newbcast:8 row_mask:0xf bank_mask:0xf
    v_and_b32_dpp v38, v29, v10 row_newbcast:8 row_mask:0xf bank_mask:0xf
    v_and_b32_dpp v39, v29, v11 row_newbcast:8 row_mask:0xf bank_mask:0xf
    v_and_b32_dpp v40, v29, v8 row_newbcast:4 row_mask:0xf bank_mask:0xf
    v_and_b32_dpp v41, v29, v9 row_newbcast:4 row_mask:0xf bank_mask:0xf
    v_and_b32_dpp v42, v29, v10 row_newbcast:4 row_mask:0xf bank_mask:0xf
    v_and_b32_dpp v43, v29, v11 row_newbcast:4 row_mask:0xf bank_mask:0xf
    v_and_b32_dpp v44, v29, v8 row_newbcast:12 row_mask:0xf bank_mask:0xf
    v_and_b32_dpp v45, v29, v9 row_newbcast:12 row_mask:0xf bank_mask:0xf
    v_and_b32_dpp v46, v29, v10 row_newbcast:12 row_mask:0xf bank_mask:0xf
    v_and_b32_dpp v47, v29, v11 row_newbcast:12 row_mask:0xf bank_mask:0xf
    v_mfma_f32_16x16x32_bf16 v[12:15], v[32:35], a[16:19], v[12:15]
    v_mfma_f32_16x16x32_bf16 v[12:15], v[36:39], a[20:23], v[12:15]
    v_mfma_f32_16x16x32_bf16 v[12:15], v[40:43], a[24:27], v[12:15]
    v_mfma_f32_16x16x32_bf16 v[12:15], v[44:47], a[28:31], v[12:15]
    s_mov_b32 s62, 0
L_adone:
    s_cmp_eq_u32 s13, 0
    s_cbranch_scc1 L_aswitch
L_adone2:
    v_add_f32_dpp v17, v17, v17 row_ror:4 row_mask:0xf bank_mask:0xf
    s_nop 1
    v_add_f32_dpp v17, v17, v17 row_ror:8 row_mask:0xf bank_mask:0xf
    v_mov_b32 v28, v17
    s_nop 1
    v_permlane16_swap_b32 v17, v28
    v_add_f32 v17, v17, v28
    v_mov_b32 v28, v17
    s_nop 1
    v_permlane32_swap_b32 v17, v28
    v_add_f32 v17, v17, v28
    v_cvt_pk_bf16_f32 v54, v12, v13
    v_cvt_pk_bf16_f32 v55, v14, v15
    v_cmp_gt_u32 vcc, 48, v1
    s_nop 1
    v_cndmask_b32 v16, v16, v50, vcc
    v_cndmask_b32 v17, v17, v51, vcc
    v_permlane16_swap_b32 v52, v54
    v_permlane16_swap_b32 v53, v55
    v_cmp_gt_u32 vcc, 32, v1
    s_nop 1
    v_cndmask_b32 v52, v16, v52, vcc
    v_cndmask_b32 v53, v17, v53, vcc
    v_cndmask_b32 v54, v16, v54, vcc
    v_cndmask_b32 v55, v17, v55, vcc
    v_min_u32 v52, -2, v52
    v_min_u32 v53, -2, v53
    v_min_u32 v54, -2, v54
    v_min_u32 v55, -2, v55
    s_mov_b32 s54, 8388608
    buffer_store_dwordx4 v[52:55], v3, s[44:47], s54 offen sc1
    s_barrier
    s_mov_b32 s58, s22
    s_add_u32 s59, s22, 4096
    s_cmp_eq_u32 s23, 2
    s_cbranch_scc1 L_eshared
    s_cmp_lg_u32 s23, 0
    s_cbranch_scc1 L_epiB
    buffer_load_dwordx4 v[40:43], v30, s[44:47], s58 offen sc1
    buffer_load_dwordx4 v[192:195], v2, s[44:47], s58 offen offset:0 sc1
    buffer_load_dwordx4 v[196:199], v2, s[44:47], s58 offen offset:1024 sc1
    v_and_b32 v3, 15, v1
    v_lshrrev_b32 v4, 4, v1
    s_mov_b32 s60, 0x05040100
    s_mov_b32 s61, 0x07060302
    v_mul_u32_u24 v0, 73728, v4
    v_bfe_u32 v5, v1, 2, 1
    v_lshl_add_u32 v0, v5, 12, v0
    v_and_b32 v5, 3, v1
    v_lshl_add_u32 v0, v5, 5, v0
    v_bfe_u32 v5, v1, 3, 1
    v_lshl_add_u32 v0, v5, 4, v0
    s_lshl_b32 s54, s3, 9
    v_lshl_add_u32 v5, v3, 4, s54
    v_and_b32 v6, 1, v4
    v_lshl_add_u32 v5, v6, 3, v5
    v_lshrrev_b32 v6, 1, v4
    v_lshl_add_u32 v5, v6, 8, v5
    v_lshrrev_b32 v7, 2, v3
    v_lshlrev_b32 v7, 9, v7
    v_lshl_add_u32 v7, v4, 4, v7
    v_and_b32 v6, 1, v1
    v_lshl_add_u32 v7, v6, 6, v7
    v_and_b32 v6, 1, v3
    v_cmp_gt_u32 s[20:21], 2, v6
    s_waitcnt vmcnt(17)
    v_perm_b32 v64, v132, v128, s60
    v_perm_b32 v68, v132, v128, s61
    v_perm_b32 v72, v133, v129, s60
    v_perm_b32 v76, v133, v129, s61
    v_perm_b32 v80, v134, v130, s60
    v_perm_b32 v84, v134, v130, s61
    v_perm_b32 v88, v135, v131, s60
    v_perm_b32 v92, v135, v131, s61
    s_waitcnt vmcnt(15)
    v_perm_b32 v65, v140, v136, s60
    v_perm_b32 v69, v140, v136, s61
    v_perm_b32 v73, v141, v137, s60
    v_perm_b32 v77, v141, v137, s61
    v_perm_b32 v81, v142, v138, s60
    v_perm_b32 v85, v142, v138, s61
    v_perm_b32 v89, v143, v139, s60
    v_perm_b32 v93, v143, v139, s61
    s_waitcnt vmcnt(13)
    v_perm_b32 v66, v148, v144, s60
    v_perm_b32 v70, v148, v144, s61
    v_perm_b32 v74, v149, v145, s60
    v_perm_b32 v78, v149, v145, s61
    v_perm_b32 v82, v150, v146, s60
    v_perm_b32 v86, v150, v146, s61
    v_perm_b32 v90, v151, v147, s60
    v_perm_b32 v94, v151, v147, s61
    s_waitcnt vmcnt(11)
    v_perm_b32 v67, v156, v152, s60
    v_perm_b32 v71, v156, v152, s61
    v_perm_b32 v75, v157, v153, s60
    v_perm_b32 v79, v157, v153, s61
    v_perm_b32 v83, v158, v154, s60
    v_perm_b32 v87, v158, v154, s61
    v_perm_b32 v91, v159, v155, s60
    v_perm_b32 v95, v159, v155, s61
    s_waitcnt vmcnt(9)
    v_perm_b32 v96, v164, v160, s60
    v_perm_b32 v100, v164, v160, s61
    v_perm_b32 v104, v165, v161, s60
    v_perm_b32 v108, v165, v161, s61
    v_perm_b32 v112, v166, v162, s60
    v_perm_b32 v116, v166, v162, s61
    v_perm_b32 v120, v167, v163, s60
    v_perm_b32 v124, v167, v163, s61
    s_waitcnt vmcnt(7)
    v_perm_b32 v97, v172, v168, s60
    v_perm_b32 v101, v172, v168, s61
    v_perm_b32 v105, v173, v169, s60
    v_perm_b32 v109, v173, v169, s61
    v_perm_b32 v113, v174, v170, s60
    v_perm_b32 v117, v174, v170, s61
    v_perm_b32 v121, v175, v171, s60
    v_perm_b32 v125, v175, v171, s61
    s_waitcnt vmcnt(5)
    v_perm_b32 v98, v180, v176, s60
    v_perm_b32 v102, v180, v176, s61
    v_perm_b32 v106, v181, v177, s60
    v_perm_b32 v110, v181, v177, s61
    v_perm_b32 v114, v182, v178, s60
    v_perm_b32 v118, v182, v178, s61
    v_perm_b32 v122, v183, v179, s60
    v_perm_b32 v126, v183, v179, s61
    s_waitcnt vmcnt(3)
    v_perm_b32 v99, v188, v184, s60
    v_perm_b32 v103, v188, v184, s61
    v_perm_b32 v107, v189, v185, s60
    v_perm_b32 v111, v189, v185, s61
    v_perm_b32 v115, v190, v186, s60
    v_perm_b32 v119, v190, v186, s61
    v_perm_b32 v123, v191, v187, s60
    v_perm_b32 v127, v191, v187, s61
    s_waitcnt vmcnt(0)
    s_branch L_mpoll_13_c
L_mpoll_13:
    s_mov_b64 exec, s[4:5]
    buffer_load_dwordx4 v[40:43], v30, s[44:47], s58 offen sc1
    s_mov_b64 exec, s[6:7]
    buffer_load_dwordx4 v[192:195], v2, s[44:47], s58 offen offset:0 sc1
    s_mov_b64 exec, s[8:9]
    buffer_load_dwordx4 v[196:199], v2, s[44:47], s58 offen offset:1024 sc1
    s_mov_b64 exec, -1
    s_waitcnt vmcnt(3)
L_mpoll_13_c:
    v_max3_u32 v236, v40, v41, v42
    v_max3_u32 v237, v192, v193, v194
    v_max3_u32 v238, v196, v197, v198
    v_max_u32 v236, v236, v43
    v_max_u32 v237, v237, v195
    v_max_u32 v238, v238, v199
    v_cmp_eq_u32 s[4:5], -1, v236
    v_cmp_eq_u32 s[6:7], -1, v237
    v_cmp_eq_u32 s[8:9], -1, v238
    s_or_b64 vcc, s[4:5], s[6:7]
    s_or_b64 vcc, vcc, s[8:9]
    s_cbranch_scc0 L_mpollok_14
    s_sub_u32 s101, s101, 1
    s_cbranch_scc0 L_mpoll_13
    s_mov_b32 s101, 0
L_mpollok_14:
    v_max_f32_dpp v44, v40, v40 row_ror:1 row_mask:0xf bank_mask:0xf
    v_cndmask_b32 v47, 0, v41, s[20:21]
    v_mov_b32 v45, v44
    s_nop 1
    v_permlane16_swap_b32 v44, v45
    v_max_f32 v44, v44, v45
    v_mov_b32 v45, v44
    s_nop 1
    v_permlane32_swap_b32 v44, v45
    v_max_f32 v44, v44, v45
    v_sub_f32 v45, v40, v44
    v_mul_f32 v45, s97, v45
    v_exp_f32 v45, v45
    s_nop 0
    v_cvt_pk_bf16_f32 v46, v45, v45
    v_and_b32 v45, s98, v46
    v_mul_f32 v47, v47, v45
    v_and_b32_dpp v232, v46, v8 row_newbcast:0 row_mask:0xf bank_mask:0xf
    v_and_b32_dpp v233, v46, v9 row_newbcast:0 row_mask:0xf bank_mask:0xf
    v_add_f32_dpp v47, v47, v47 row_ror:1 row_mask:0xf bank_mask:0xf
    v_and_b32_dpp v234, v46, v10 row_newbcast:0 row_mask:0xf bank_mask:0xf
    v_and_b32_dpp v235, v46, v11 row_newbcast:0 row_mask:0xf bank_mask:0xf
    v_and_b32_dpp v236, v46, v8 row_newbcast:1 row_mask:0xf bank_mask:0xf
    v_mov_b32 v45, v47
    v_and_b32_dpp v237, v46, v9 row_newbcast:1 row_mask:0xf bank_mask:0xf
    v_and_b32_dpp v238, v46, v10 row_newbcast:1 row_mask:0xf bank_mask:0xf
    v_and_b32_dpp v239, v46, v11 row_newbcast:1 row_mask:0xf bank_mask:0xf
    v_permlane16_swap_b32 v47, v45
    v_mfma_f32_16x16x32_bf16 v[228:231], v[232:235], v[192:195], 0
    v_add_f32 v47, v47, v45
    v_mfma_f32_16x16x32_bf16 v[228:231], v[236:239], v[196:199], v[228:231]
    v_mov_b32 v45, v47
    s_nop 1
    v_permlane32_swap_b32 v47, v45
    v_add_f32 v47, v47, v45
    v_rcp_f32 v47, v47
    s_nop 1
    v_mul_f32 v228, v228, v47
    v_mul_f32 v229, v229, v47
    v_mul_f32 v230, v230, v47
    v_mul_f32 v231, v231, v47
    v_cvt_pk_bf16_f32 v224, v228, v229
    v_cvt_pk_bf16_f32 v225, v230, v231
    s_branch L_emerged
L_eshared:
    buffer_load_dwordx4 v[40:43], v30, s[44:47], s58 offen sc1
    buffer_load_dwordx4 v[192:195], v2, s[44:47], s58 offen offset:0 sc1
    buffer_load_dwordx4 v[196:199], v2, s[44:47], s58 offen offset:1024 sc1
    buffer_load_dwordx4 v[200:203], v2, s[44:47], s58 offen offset:2048 sc1
    buffer_load_dwordx4 v[204:207], v2, s[44:47], s58 offen offset:3072 sc1
    buffer_load_dwordx4 v[208:211], v2, s[44:47], s59 offen offset:0 sc1
    buffer_load_dwordx4 v[212:215], v2, s[44:47], s59 offen offset:1024 sc1
    v_and_b32 v3, 15, v1
    v_lshrrev_b32 v4, 4, v1
    s_mov_b32 s60, 0x05040100
    s_mov_b32 s61, 0x07060302
    v_mul_u32_u24 v0, 73728, v4
    v_bfe_u32 v5, v1, 2, 1
    v_lshl_add_u32 v0, v5, 12, v0
    v_and_b32 v5, 3, v1
    v_lshl_add_u32 v0, v5, 5, v0
    v_bfe_u32 v5, v1, 3, 1
    v_lshl_add_u32 v0, v5, 4, v0
    s_lshl_b32 s54, s3, 9
    v_lshl_add_u32 v5, v3, 4, s54
    v_and_b32 v6, 1, v4
    v_lshl_add_u32 v5, v6, 3, v5
    v_lshrrev_b32 v6, 1, v4
    v_lshl_add_u32 v5, v6, 8, v5
    v_lshrrev_b32 v7, 2, v3
    v_lshlrev_b32 v7, 9, v7
    v_lshl_add_u32 v7, v4, 4, v7
    v_and_b32 v6, 1, v1
    v_lshl_add_u32 v7, v6, 6, v7
    v_and_b32 v6, 7, v3
    v_cmp_gt_u32 s[20:21], 6, v6
    s_waitcnt vmcnt(21)
    v_perm_b32 v64, v132, v128, s60
    v_perm_b32 v68, v132, v128, s61
    v_perm_b32 v72, v133, v129, s60
    v_perm_b32 v76, v133, v129, s61
    v_perm_b32 v80, v134, v130, s60
    v_perm_b32 v84, v134, v130, s61
    v_perm_b32 v88, v135, v131, s60
    v_perm_b32 v92, v135, v131, s61
    s_waitcnt vmcnt(19)
    v_perm_b32 v65, v140, v136, s60
    v_perm_b32 v69, v140, v136, s61
    v_perm_b32 v73, v141, v137, s60
    v_perm_b32 v77, v141, v137, s61
    v_perm_b32 v81, v142, v138, s60
    v_perm_b32 v85, v142, v138, s61
    v_perm_b32 v89, v143, v139, s60
    v_perm_b32 v93, v143, v139, s61
    s_waitcnt vmcnt(17)
    v_perm_b32 v66, v148, v144, s60
    v_perm_b32 v70, v148, v144, s61
    v_perm_b32 v74, v149, v145, s60
    v_perm_b32 v78, v149, v145, s61
    v_perm_b32 v82, v150, v146, s60
    v_perm_b32 v86, v150, v146, s61
    v_perm_b32 v90, v151, v147, s60
    v_perm_b32 v94, v151, v147, s61
    s_waitcnt vmcnt(15)
    v_perm_b32 v67, v156, v152, s60
    v_perm_b32 v71, v156, v152, s61
    v_perm_b32 v75, v157, v153, s60
    v_perm_b32 v79, v157, v153, s61
    v_perm_b32 v83, v158, v154, s60
    v_perm_b32 v87, v158, v154, s61
    v_perm_b32 v91, v159, v155, s60
    v_perm_b32 v95, v159, v155, s61
    s_waitcnt vmcnt(13)
    v_perm_b32 v96, v164, v160, s60
    v_perm_b32 v100, v164, v160, s61
    v_perm_b32 v104, v165, v161, s60
    v_perm_b32 v108, v165, v161, s61
    v_perm_b32 v112, v166, v162, s60
    v_perm_b32 v116, v166, v162, s61
    v_perm_b32 v120, v167, v163, s60
    v_perm_b32 v124, v167, v163, s61
    s_waitcnt vmcnt(11)
    v_perm_b32 v97, v172, v168, s60
    v_perm_b32 v101, v172, v168, s61
    v_perm_b32 v105, v173, v169, s60
    v_perm_b32 v109, v173, v169, s61
    v_perm_b32 v113, v174, v170, s60
    v_perm_b32 v117, v174, v170, s61
    v_perm_b32 v121, v175, v171, s60
    v_perm_b32 v125, v175, v171, s61
    s_waitcnt vmcnt(9)
    v_perm_b32 v98, v180, v176, s60
    v_perm_b32 v102, v180, v176, s61
    v_perm_b32 v106, v181, v177, s60
    v_perm_b32 v110, v181, v177, s61
    v_perm_b32 v114, v182, v178, s60
    v_perm_b32 v118, v182, v178, s61
    v_perm_b32 v122, v183, v179, s60
    v_perm_b32 v126, v183, v179, s61
    s_waitcnt vmcnt(7)
    v_perm_b32 v99, v188, v184, s60
    v_perm_b32 v103, v188, v184, s61
    v_perm_b32 v107, v189, v185, s60
    v_perm_b32 v111, v189, v185, s61
    v_perm_b32 v115, v190, v186, s60
    v_perm_b32 v119, v190, v186, s61
    v_perm_b32 v123, v191, v187, s60
    v_perm_b32 v127, v191, v187, s61
    s_waitcnt vmcnt(0)
    s_branch L_mpoll_17_c
L_mpoll_17:
    s_mov_b64 exec, s[4:5]
    buffer_load_dwordx4 v[40:43], v30, s[44:47], s58 offen sc1
    s_mov_b64 exec, s[6:7]
    buffer_load_dwordx4 v[192:195], v2, s[44:47], s58 offen offset:0 sc1
    s_mov_b64 exec, s[8:9]
    buffer_load_dwordx4 v[196:199], v2, s[44:47], s58 offen offset:1024 sc1
    s_mov_b64 exec, s[10:11]
    buffer_load_dwordx4 v[200:203], v2, s[44:47], s58 offen offset:2048 sc1
    s_mov_b64 exec, s[12:13]
    buffer_load_dwordx4 v[204:207], v2, s[44:47], s58 offen offset:3072 sc1
    s_mov_b64 exec, s[14:15]
    buffer_load_dwordx4 v[208:211], v2, s[44:47], s59 offen offset:0 sc1
    s_mov_b64 exec, s[16:17]
    buffer_load_dwordx4 v[212:215], v2, s[44:47], s59 offen offset:1024 sc1
    s_mov_b64 exec, -1
    s_waitcnt vmcnt(7)
L_mpoll_17_c:
    v_max3_u32 v236, v40, v41, v42
    v_max3_u32 v237, v192, v193, v194
    v_max3_u32 v238, v196, v197, v198
    v_max3_u32 v239, v200, v201, v202
    v_max3_u32 v240, v204, v205, v206
    v_max3_u32 v241, v208, v209, v210
    v_max3_u32 v242, v212, v213, v214
    v_max_u32 v236, v236, v43
    v_max_u32 v237, v237, v195
    v_max_u32 v238, v238, v199
    v_max_u32 v239, v239, v203
    v_max_u32 v240, v240, v207
    v_max_u32 v241, v241, v211
    v_max_u32 v242, v242, v215
    v_cmp_eq_u32 s[4:5], -1, v236
    v_cmp_eq_u32 s[6:7], -1, v237
    v_cmp_eq_u32 s[8:9], -1, v238
    v_cmp_eq_u32 s[10:11], -1, v239
    v_cmp_eq_u32 s[12:13], -1, v240
    v_cmp_eq_u32 s[14:15], -1, v241
    v_cmp_eq_u32 s[16:17], -1, v242
    s_or_b64 vcc, s[4:5], s[6:7]
    s_or_b64 vcc, vcc, s[8:9]
    s_or_b64 vcc, vcc, s[10:11]
    s_or_b64 vcc, vcc, s[12:13]
    s_or_b64 vcc, vcc, s[14:15]
    s_or_b64 vcc, vcc, s[16:17]
    s_cbranch_scc0 L_mpollok_18
    s_sub_u32 s101, s101, 1
    s_cbranch_scc0 L_mpoll_17
    s_mov_b32 s101, 0
L_mpollok_18:
    v_max_f32_dpp v44, v40, v40 row_ror:1 row_mask:0xf bank_mask:0xf
    v_cndmask_b32 v47, 0, v41, s[20:21]
    s_nop 0
    v_max_f32_dpp v44, v44, v44 row_ror:2 row_mask:0xf bank_mask:0xf
    s_nop 1
    v_max_f32_dpp v44, v44, v44 row_ror:4 row_mask:0xf bank_mask:0xf
    v_mov_b32 v45, v44
    s_nop 1
    v_permlane16_swap_b32 v44, v45
    v_max_f32 v44, v44, v45
    v_mov_b32 v45, v44
    s_nop 1
    v_permlane32_swap_b32 v44, v45
    v_max_f32 v44, v44, v45
    v_sub_f32 v45, v40, v44
    v_mul_f32 v45, s97, v45
    v_exp_f32 v45, v45
    s_nop 0
    v_cvt_pk_bf16_f32 v46, v45, v45
    v_and_b32 v45, s98, v46
    v_mul_f32 v47, v47, v45
    v_and_b32_dpp v232, v46, v8 row_newbcast:0 row_mask:0xf bank_mask:0xf
    v_and_b32_dpp v233, v46, v9 row_newbcast:0 row_mask:0xf bank_mask:0xf
    v_add_f32_dpp v47, v47, v47 row_ror:1 row_mask:0xf bank_mask:0xf
    v_and_b32_dpp v234, v46, v10 row_newbcast:0 row_mask:0xf bank_mask:0xf
    v_and_b32_dpp v235, v46, v11 row_newbcast:0 row_mask:0xf bank_mask:0xf
    v_and_b32_dpp v236, v46, v8 row_newbcast:1 row_mask:0xf bank_mask:0xf
    v_and_b32_dpp v237, v46, v9 row_newbcast:1 row_mask:0xf bank_mask:0xf
    v_add_f32_dpp v47, v47, v47 row_ror:2 row_mask:0xf bank_mask:0xf
    v_and_b32_dpp v238, v46, v10 row_newbcast:1 row_mask:0xf bank_mask:0xf
    v_and_b32_dpp v239, v46, v11 row_newbcast:1 row_mask:0xf bank_mask:0xf
    v_mfma_f32_16x16x32_bf16 v[228:231], v[232:235], v[192:195], 0
    v_and_b32_dpp v240, v46, v8 row_newbcast:2 row_mask:0xf bank_mask:0xf
    v_add_f32_dpp v47, v47, v47 row_ror:4 row_mask:0xf bank_mask:0xf
    v_and_b32_dpp v241, v46, v9 row_newbcast:2 row_mask:0xf bank_mask:0xf
    v_and_b32_dpp v242, v46, v10 row_newbcast:2 row_mask:0xf bank_mask:0xf
    v_and_b32_dpp v243, v46, v11 row_newbcast:2 row_mask:0xf bank_mask:0xf
    v_mfma_f32_16x16x32_bf16 v[228:231], v[236:239], v[196:199], v[228:231]
    v_mov_b32 v45, v47
    v_and_b32_dpp v244, v46, v8 row_newbcast:3 row_mask:0xf bank_mask:0xf
    v_and_b32_dpp v245, v46, v9 row_newbcast:3 row_mask:0xf bank_mask:0xf
    v_and_b32_dpp v246, v46, v10 row_newbcast:3 row_mask:0xf bank_mask:0xf
    v_and_b32_dpp v247, v46, v11 row_newbcast:3 row_mask:0xf bank_mask:0xf
    v_permlane16_swap_b32 v47, v45
    v_mfma_f32_16x16x32_bf16 v[228:231], v[240:243], v[200:203], v[228:231]
    v_and_b32_dpp v248, v46, v8 row_newbcast:4 row_mask:0xf bank_mask:0xf
    v_and_b32_dpp v249, v46, v9 row_newbcast:4 row_mask:0xf bank_mask:0xf
    v_and_b32_dpp v250, v46, v10 row_newbcast:4 row_mask:0xf bank_mask:0xf
    v_add_f32 v47, v47, v45
    v_and_b32_dpp v251, v46, v11 row_newbcast:4 row_mask:0xf bank_mask:0xf
    v_mfma_f32_16x16x32_bf16 v[228:231], v[244:247], v[204:207], v[228:231]
    v_and_b32_dpp v252, v46, v8 row_newbcast:5 row_mask:0xf bank_mask:0xf
    v_and_b32_dpp v253, v46, v9 row_newbcast:5 row_mask:0xf bank_mask:0xf
    v_mov_b32 v45, v47
    v_and_b32_dpp v254, v46, v10 row_newbcast:5 row_mask:0xf bank_mask:0xf
    v_and_b32_dpp v255, v46, v11 row_newbcast:5 row_mask:0xf bank_mask:0xf
    v_mfma_f32_16x16x32_bf16 v[228:231], v[248:251], v[208:211], v[228:231]
    v_permlane32_swap_b32 v47, v45
    v_add_f32 v47, v47, v45
    v_mfma_f32_16x16x32_bf16 v[228:231], v[252:255], v[212:215], v[228:231]
    v_rcp_f32 v47, v47
    s_nop 6
    v_mul_f32 v228, v228, v47
    v_mul_f32 v229, v229, v47
    v_mul_f32 v230, v230, v47
    v_mul_f32 v231, v231, v47
    v_cvt_pk_bf16_f32 v224, v228, v229
    v_cvt_pk_bf16_f32 v225, v230, v231
L_emerged:
    ds_write_b64 v5, v[224:225]
    s_cmp_eq_u32 s3, 3
    s_waitcnt lgkmcnt(0)
    s_barrier
    s_cbranch_scc1 L_eendA
    ds_read_b128 v[48:51], v7 offset:0
    ds_read_b128 v[52:55], v7 offset:128
    s_waitcnt lgkmcnt(1)
    v_mfma_f32_16x16x32_bf16 v[224:227], v[48:51], v[64:67], 0
    v_mfma_f32_16x16x32_bf16 v[228:231], v[48:51], v[68:71], 0
    v_mfma_f32_16x16x32_bf16 v[232:235], v[48:51], v[72:75], 0
    v_mfma_f32_16x16x32_bf16 v[236:239], v[48:51], v[76:79], 0
    v_mfma_f32_16x16x32_bf16 v[240:243], v[48:51], v[80:83], 0
    v_mfma_f32_16x16x32_bf16 v[244:247], v[48:51], v[84:87], 0
    v_mfma_f32_16x16x32_bf16 v[248:251], v[48:51], v[88:91], 0
    v_mfma_f32_16x16x32_bf16 v[252:255], v[48:51], v[92:95], 0
    s_waitcnt lgkmcnt(0)
    v_mfma_f32_16x16x32_bf16 v[224:227], v[52:55], v[96:99], v[224:227]
    s_nop 1
    v_mfma_f32_16x16x32_bf16 v[228:231], v[52:55], v[100:103], v[228:231]
    s_nop 1
    v_mfma_f32_16x16x32_bf16 v[232:235], v[52:55], v[104:107], v[232:235]
    s_nop 1
    v_mfma_f32_16x16x32_bf16 v[236:239], v[52:55], v[108:111], v[236:239]
    s_nop 0
    v_add_f32_dpp v56, v225, v224 row_ror:8 row_mask:0xf bank_mask:0x3
    v_mfma_f32_16x16x32_bf16 v[240:243], v[52:55], v[112:115], v[240:243]
    s_nop 0
    v_add_f32_dpp v57, v229, v228 row_ror:8 row_mask:0xf bank_mask:0x3
    v_mfma_f32_16x16x32_bf16 v[244:247], v[52:55], v[116:119], v[244:247]
    s_nop 0
    v_add_f32_dpp v58, v233, v232 row_ror:8 row_mask:0xf bank_mask:0x3
    v_mfma_f32_16x16x32_bf16 v[248:251], v[52:55], v[120:123], v[248:251]
    s_nop 0
    v_add_f32_dpp v59, v237, v236 row_ror:8 row_mask:0xf bank_mask:0x3
    v_mfma_f32_16x16x32_bf16 v[252:255], v[52:55], v[124:127], v[252:255]
    s_nop 0
    v_add_f32_dpp v56, v240, v241 row_ror:8 row_mask:0xf bank_mask:0xc
    v_add_f32_dpp v57, v244, v245 row_ror:8 row_mask:0xf bank_mask:0xc
    v_min_u32 v56, -2, v56
    s_nop 0
    v_add_f32_dpp v58, v248, v249 row_ror:8 row_mask:0xf bank_mask:0xc
    v_min_u32 v57, -2, v57
    s_nop 0
    v_add_f32_dpp v59, v252, v253 row_ror:8 row_mask:0xf bank_mask:0xc
    v_min_u32 v58, -2, v58
    v_min_u32 v59, -2, v59
    buffer_store_dwordx4 v[56:59], v0, s[44:47], s25 offen sc1
L_eendA:
    s_endpgm
L_epiB:
    s_cmp_eq_u32 s3, 3
    s_cbranch_scc1 L_eendB
    v_bfe_u32 v6, v1, 2, 2
    v_lshlrev_b32 v6, 6, v6
    v_and_b32 v5, 48, v1
    v_add_u32 v6, v6, v5
    v_and_b32 v5, 1, v1
    v_lshl_add_u32 v6, v5, 8, v6
    buffer_load_dwordx4 v[48:51], v6, s[44:47], s27 offen offset:0 sc1
    buffer_load_dwordx4 v[52:55], v6, s[44:47], s27 offen offset:512 sc1
    v_and_b32 v3, 15, v1
    v_lshrrev_b32 v4, 4, v1
    s_mov_b32 s60, 0x05040100
    s_mov_b32 s61, 0x07060302
    v_mul_u32_u24 v0, 73728, v4
    v_bfe_u32 v5, v1, 2, 1
    v_lshl_add_u32 v0, v5, 12, v0
    v_and_b32 v5, 3, v1
    v_lshl_add_u32 v0, v5, 5, v0
    v_bfe_u32 v5, v1, 3, 1
    v_lshl_add_u32 v0, v5, 4, v0
    s_waitcnt vmcnt(16)
    v_perm_b32 v64, v132, v128, s60
    v_perm_b32 v68, v132, v128, s61
    v_perm_b32 v72, v133, v129, s60
    v_perm_b32 v76, v133, v129, s61
    v_perm_b32 v80, v134, v130, s60
    v_perm_b32 v84, v134, v130, s61
    v_perm_b32 v88, v135, v131, s60
    v_perm_b32 v92, v135, v131, s61
    s_waitcnt vmcnt(14)
    v_perm_b32 v65, v140, v136, s60
    v_perm_b32 v69, v140, v136, s61
    v_perm_b32 v73, v141, v137, s60
    v_perm_b32 v77, v141, v137, s61
    v_perm_b32 v81, v142, v138, s60
    v_perm_b32 v85, v142, v138, s61
    v_perm_b32 v89, v143, v139, s60
    v_perm_b32 v93, v143, v139, s61
    s_waitcnt vmcnt(12)
    v_perm_b32 v66, v148, v144, s60
    v_perm_b32 v70, v148, v144, s61
    v_perm_b32 v74, v149, v145, s60
    v_perm_b32 v78, v149, v145, s61
    v_perm_b32 v82, v150, v146, s60
    v_perm_b32 v86, v150, v146, s61
    v_perm_b32 v90, v151, v147, s60
    v_perm_b32 v94, v151, v147, s61
    s_waitcnt vmcnt(10)
    v_perm_b32 v67, v156, v152, s60
    v_perm_b32 v71, v156, v152, s61
    v_perm_b32 v75, v157, v153, s60
    v_perm_b32 v79, v157, v153, s61
    v_perm_b32 v83, v158, v154, s60
    v_perm_b32 v87, v158, v154, s61
    v_perm_b32 v91, v159, v155, s60
    v_perm_b32 v95, v159, v155, s61
    s_waitcnt vmcnt(8)
    v_perm_b32 v96, v164, v160, s60
    v_perm_b32 v100, v164, v160, s61
    v_perm_b32 v104, v165, v161, s60
    v_perm_b32 v108, v165, v161, s61
    v_perm_b32 v112, v166, v162, s60
    v_perm_b32 v116, v166, v162, s61
    v_perm_b32 v120, v167, v163, s60
    v_perm_b32 v124, v167, v163, s61
    s_waitcnt vmcnt(6)
    v_perm_b32 v97, v172, v168, s60
    v_perm_b32 v101, v172, v168, s61
    v_perm_b32 v105, v173, v169, s60
    v_perm_b32 v109, v173, v169, s61
    v_perm_b32 v113, v174, v170, s60
    v_perm_b32 v117, v174, v170, s61
    v_perm_b32 v121, v175, v171, s60
    v_perm_b32 v125, v175, v171, s61
    s_waitcnt vmcnt(4)
    v_perm_b32 v98, v180, v176, s60
    v_perm_b32 v102, v180, v176, s61
    v_perm_b32 v106, v181, v177, s60
    v_perm_b32 v110, v181, v177, s61
    v_perm_b32 v114, v182, v178, s60
    v_perm_b32 v118, v182, v178, s61
    v_perm_b32 v122, v183, v179, s60
    v_perm_b32 v126, v183, v179, s61
    s_waitcnt vmcnt(2)
    v_perm_b32 v99, v188, v184, s60
    v_perm_b32 v103, v188, v184, s61
    v_perm_b32 v107, v189, v185, s60
    v_perm_b32 v111, v189, v185, s61
    v_perm_b32 v115, v190, v186, s60
    v_perm_b32 v119, v190, v186, s61
    v_perm_b32 v123, v191, v187, s60
    v_perm_b32 v127, v191, v187, s61
    s_waitcnt vmcnt(0)
    s_branch L_mpoll_19_c
L_mpoll_19:
    s_mov_b64 exec, s[4:5]
    buffer_load_dwordx4 v[48:51], v6, s[44:47], s27 offen offset:0 sc1
    s_mov_b64 exec, s[6:7]
    buffer_load_dwordx4 v[52:55], v6, s[44:47], s27 offen offset:512 sc1
    s_mov_b64 exec, -1
    s_waitcnt vmcnt(0)
L_mpoll_19_c:
    v_max3_u32 v236, v48, v49, v50
    v_max3_u32 v237, v52, v53, v54
    v_max_u32 v236, v236, v51
    v_max_u32 v237, v237, v55
    v_cmp_eq_u32 s[4:5], -1, v236
    v_cmp_eq_u32 s[6:7], -1, v237
    s_nop 0
    s_or_b64 vcc, s[4:5], s[6:7]
    s_cbranch_scc0 L_mpollok_20
    s_sub_u32 s101, s101, 1
    s_cbranch_scc0 L_mpoll_19
    s_mov_b32 s101, 0
L_mpollok_20:
    v_mfma_f32_16x16x32_bf16 v[224:227], v[48:51], v[64:67], 0
    v_mfma_f32_16x16x32_bf16 v[228:231], v[48:51], v[68:71], 0
    v_mfma_f32_16x16x32_bf16 v[232:235], v[48:51], v[72:75], 0
    v_mfma_f32_16x16x32_bf16 v[236:239], v[48:51], v[76:79], 0
    v_mfma_f32_16x16x32_bf16 v[240:243], v[48:51], v[80:83], 0
    v_mfma_f32_16x16x32_bf16 v[244:247], v[48:51], v[84:87], 0
    v_mfma_f32_16x16x32_bf16 v[248:251], v[48:51], v[88:91], 0
    v_mfma_f32_16x16x32_bf16 v[252:255], v[48:51], v[92:95], 0
    v_mfma_f32_16x16x32_bf16 v[224:227], v[52:55], v[96:99], v[224:227]
    s_nop 1
    v_mfma_f32_16x16x32_bf16 v[228:231], v[52:55], v[100:103], v[228:231]
    s_nop 1
    v_mfma_f32_16x16x32_bf16 v[232:235], v[52:55], v[104:107], v[232:235]
    s_nop 1
    v_mfma_f32_16x16x32_bf16 v[236:239], v[52:55], v[108:111], v[236:239]
    s_nop 0
    v_add_f32_dpp v56, v225, v224 row_ror:8 row_mask:0xf bank_mask:0x3
    v_mfma_f32_16x16x32_bf16 v[240:243], v[52:55], v[112:115], v[240:243]
    s_nop 0
    v_add_f32_dpp v57, v229, v228 row_ror:8 row_mask:0xf bank_mask:0x3
    v_mfma_f32_16x16x32_bf16 v[244:247], v[52:55], v[116:119], v[244:247]
    s_nop 0
    v_add_f32_dpp v58, v233, v232 row_ror:8 row_mask:0xf bank_mask:0x3
    v_mfma_f32_16x16x32_bf16 v[248:251], v[52:55], v[120:123], v[248:251]
    s_nop 0
    v_add_f32_dpp v59, v237, v236 row_ror:8 row_mask:0xf bank_mask:0x3
    v_mfma_f32_16x16x32_bf16 v[252:255], v[52:55], v[124:127], v[252:255]
    s_nop 0
    v_add_f32_dpp v56, v240, v241 row_ror:8 row_mask:0xf bank_mask:0xc
    v_add_f32_dpp v57, v244, v245 row_ror:8 row_mask:0xf bank_mask:0xc
    v_min_u32 v56, -2, v56
    s_nop 0
    v_add_f32_dpp v58, v248, v249 row_ror:8 row_mask:0xf bank_mask:0xc
    v_min_u32 v57, -2, v57
    s_nop 0
    v_add_f32_dpp v59, v252, v253 row_ror:8 row_mask:0xf bank_mask:0xc
    v_min_u32 v58, -2, v58
    v_min_u32 v59, -2, v59
    buffer_store_dwordx4 v[56:59], v0, s[44:47], s25 offen sc1
L_eendB:
    s_endpgm
L_vdry0:
    v_accvgpr_read_b32 v29, a193
    v_sub_f32 v29, v29, v16
    v_mul_f32 v29, s97, v29
    v_exp_f32 v29, v29
    s_nop 0
    v_add_f32 v17, v17, v29
    v_cvt_pk_bf16_f32 v29, v29, v29
    s_nop 1
    v_and_b32_dpp v32, v29, v8 row_newbcast:0 row_mask:0xf bank_mask:0xf
    v_and_b32_dpp v33, v29, v9 row_newbcast:0 row_mask:0xf bank_mask:0xf
    v_and_b32_dpp v34, v29, v10 row_newbcast:0 row_mask:0xf bank_mask:0xf
    v_and_b32_dpp v35, v29, v11 row_newbcast:0 row_mask:0xf bank_mask:0xf
    v_and_b32_dpp v36, v29, v8 row_newbcast:8 row_mask:0xf bank_mask:0xf
    v_and_b32_dpp v37, v29, v9 row_newbcast:8 row_mask:0xf bank_mask:0xf
    v_and_b32_dpp v38, v29, v10 row_newbcast:8 row_mask:0xf bank_mask:0xf
    v_and_b32_dpp v39, v29, v11 row_newbcast:8 row_mask:0xf bank_mask:0xf
    v_and_b32_dpp v40, v29, v8 row_newbcast:4 row_mask:0xf bank_mask:0xf
    v_and_b32_dpp v41, v29, v9 row_newbcast:4 row_mask:0xf bank_mask:0xf
    v_and_b32_dpp v42, v29, v10 row_newbcast:4 row_mask:0xf bank_mask:0xf
    v_and_b32_dpp v43, v29, v11 row_newbcast:4 row_mask:0xf bank_mask:0xf
    v_and_b32_dpp v44, v29, v8 row_newbcast:12 row_mask:0xf bank_mask:0xf
    v_and_b32_dpp v45, v29, v9 row_newbcast:12 row_mask:0xf bank_mask:0xf
    v_and_b32_dpp v46, v29, v10 row_newbcast:12 row_mask:0xf bank_mask:0xf
    v_and_b32_dpp v47, v29, v11 row_newbcast:12 row_mask:0xf bank_mask:0xf
    s_waitcnt vmcnt(0)
    v_mfma_f32_16x16x32_bf16 v[12:15], v[32:35], a[16:19], v[12:15]
    v_mfma_f32_16x16x32_bf16 v[12:15], v[36:39], a[20:23], v[12:15]
    v_mfma_f32_16x16x32_bf16 v[12:15], v[40:43], a[24:27], v[12:15]
    v_mfma_f32_16x16x32_bf16 v[12:15], v[44:47], a[28:31], v[12:15]
    v_accvgpr_read_b32 v29, a194
    v_sub_f32 v29, v29, v16
    v_mul_f32 v29, s97, v29
    v_exp_f32 v29, v29
    s_nop 0
    v_add_f32 v17, v17, v29
    v_cvt_pk_bf16_f32 v29, v29, v29
    s_nop 1
    v_and_b32_dpp v32, v29, v8 row_newbcast:0 row_mask:0xf bank_mask:0xf
    v_and_b32_dpp v33, v29, v9 row_newbcast:0 row_mask:0xf bank_mask:0xf
    v_and_b32_dpp v34, v29, v10 row_newbcast:0 row_mask:0xf bank_mask:0xf
    v_and_b32_dpp v35, v29, v11 row_newbcast:0 row_mask:0xf bank_mask:0xf
    v_and_b32_dpp v36, v29, v8 row_newbcast:8 row_mask:0xf bank_mask:0xf
    v_and_b32_dpp v37, v29, v9 row_newbcast:8 row_mask:0xf bank_mask:0xf
    v_and_b32_dpp v38, v29, v10 row_newbcast:8 row_mask:0xf bank_mask:0xf
    v_and_b32_dpp v39, v29, v11 row_newbcast:8 row_mask:0xf bank_mask:0xf
    v_and_b32_dpp v40, v29, v8 row_newbcast:4 row_mask:0xf bank_mask:0xf
    v_and_b32_dpp v41, v29, v9 row_newbcast:4 row_mask:0xf bank_mask:0xf
    v_and_b32_dpp v42, v29, v10 row_newbcast:4 row_mask:0xf bank_mask:0xf
    v_and_b32_dpp v43, v29, v11 row_newbcast:4 row_mask:0xf bank_mask:0xf
    v_and_b32_dpp v44, v29, v8 row_newbcast:12 row_mask:0xf bank_mask:0xf
    v_and_b32_dpp v45, v29, v9 row_newbcast:12 row_mask:0xf bank_mask:0xf
    v_and_b32_dpp v46, v29, v10 row_newbcast:12 row_mask:0xf bank_mask:0xf
    v_and_b32_dpp v47, v29, v11 row_newbcast:12 row_mask:0xf bank_mask:0xf
    v_mfma_f32_16x16x32_bf16 v[12:15], v[32:35], a[32:35], v[12:15]
    v_mfma_f32_16x16x32_bf16 v[12:15], v[36:39], a[36:39], v[12:15]
    v_mfma_f32_16x16x32_bf16 v[12:15], v[40:43], a[40:43], v[12:15]
    v_mfma_f32_16x16x32_bf16 v[12:15], v[44:47], a[44:47], v[12:15]
    v_accvgpr_read_b32 v29, a195
    v_sub_f32 v29, v29, v16
    v_mul_f32 v29, s97, v29
    v_exp_f32 v29, v29
    s_nop 0
    v_add_f32 v17, v17, v29
    v_cvt_pk_bf16_f32 v29, v29, v29
    s_nop 1
    v_and_b32_dpp v32, v29, v8 row_newbcast:0 row_mask:0xf bank_mask:0xf
    v_and_b32_dpp v33, v29, v9 row_newbcast:0 row_mask:0xf bank_mask:0xf
    v_and_b32_dpp v34, v29, v10 row_newbcast:0 row_mask:0xf bank_mask:0xf
    v_and_b32_dpp v35, v29, v11 row_newbcast:0 row_mask:0xf bank_mask:0xf
    v_and_b32_dpp v36, v29, v8 row_newbcast:8 row_mask:0xf bank_mask:0xf
    v_and_b32_dpp v37, v29, v9 row_newbcast:8 row_mask:0xf bank_mask:0xf
    v_and_b32_dpp v38, v29, v10 row_newbcast:8 row_mask:0xf bank_mask:0xf
    v_and_b32_dpp v39, v29, v11 row_newbcast:8 row_mask:0xf bank_mask:0xf
    v_and_b32_dpp v40, v29, v8 row_newbcast:4 row_mask:0xf bank_mask:0xf
    v_and_b32_dpp v41, v29, v9 row_newbcast:4 row_mask:0xf bank_mask:0xf
    v_and_b32_dpp v42, v29, v10 row_newbcast:4 row_mask:0xf bank_mask:0xf
    v_and_b32_dpp v43, v29, v11 row_newbcast:4 row_mask:0xf bank_mask:0xf
    v_and_b32_dpp v44, v29, v8 row_newbcast:12 row_mask:0xf bank_mask:0xf
    v_and_b32_dpp v45, v29, v9 row_newbcast:12 row_mask:0xf bank_mask:0xf
    v_and_b32_dpp v46, v29, v10 row_newbcast:12 row_mask:0xf bank_mask:0xf
    v_and_b32_dpp v47, v29, v11 row_newbcast:12 row_mask:0xf bank_mask:0xf
    v_mfma_f32_16x16x32_bf16 v[12:15], v[32:35], a[48:51], v[12:15]
    v_mfma_f32_16x16x32_bf16 v[12:15], v[36:39], a[52:55], v[12:15]
    v_mfma_f32_16x16x32_bf16 v[12:15], v[40:43], a[56:59], v[12:15]
    v_mfma_f32_16x16x32_bf16 v[12:15], v[44:47], a[60:63], v[12:15]
    buffer_load_dwordx4 v[128:131], v19, s[40:43], s24 offen offset:0 nt
    buffer_load_dwordx4 v[132:135], v19, s[40:43], s24 offen offset:1152 nt
    buffer_load_dwordx4 v[136:139], v19, s[40:43], s24 offen offset:2304 nt
    buffer_load_dwordx4 v[140:143], v19, s[40:43], s24 offen offset:3456 nt
    s_add_u32 s24, s24, 4608
    buffer_load_dwordx4 v[144:147], v19, s[40:43], s24 offen offset:0 nt
    buffer_load_dwordx4 v[148:151], v19, s[40:43], s24 offen offset:1152 nt
    buffer_load_dwordx4 v[152:155], v19, s[40:43], s24 offen offset:2304 nt
    buffer_load_dwordx4 v[156:159], v19, s[40:43], s24 offen offset:3456 nt
    s_add_u32 s24, s24, 69120
    buffer_load_dwordx4 v[160:163], v19, s[40:43], s24 offen offset:0 nt
    buffer_load_dwordx4 v[164:167], v19, s[40:43], s24 offen offset:1152 nt
    buffer_load_dwordx4 v[168:171], v19, s[40:43], s24 offen offset:2304 nt
    buffer_load_dwordx4 v[172:175], v19, s[40:43], s24 offen offset:3456 nt
    s_add_u32 s24, s24, 4608
    buffer_load_dwordx4 v[176:179], v19, s[40:43], s24 offen offset:0 nt
    buffer_load_dwordx4 v[180:183], v19, s[40:43], s24 offen offset:1152 nt
    buffer_load_dwordx4 v[184:187], v19, s[40:43], s24 offen offset:2304 nt
    buffer_load_dwordx4 v[188:191], v19, s[40:43], s24 offen offset:3456 nt
    s_branch L_adone2
L_vdry1:
    v_accvgpr_read_b32 v29, a195
    v_sub_f32 v29, v29, v16
    v_mul_f32 v29, s97, v29
    v_exp_f32 v29, v29
    s_nop 0
    v_add_f32 v17, v17, v29
    v_cvt_pk_bf16_f32 v29, v29, v29
    s_nop 1
    v_and_b32_dpp v32, v29, v8 row_newbcast:0 row_mask:0xf bank_mask:0xf
    v_and_b32_dpp v33, v29, v9 row_newbcast:0 row_mask:0xf bank_mask:0xf
    v_and_b32_dpp v34, v29, v10 row_newbcast:0 row_mask:0xf bank_mask:0xf
    v_and_b32_dpp v35, v29, v11 row_newbcast:0 row_mask:0xf bank_mask:0xf
    v_and_b32_dpp v36, v29, v8 row_newbcast:8 row_mask:0xf bank_mask:0xf
    v_and_b32_dpp v37, v29, v9 row_newbcast:8 row_mask:0xf bank_mask:0xf
    v_and_b32_dpp v38, v29, v10 row_newbcast:8 row_mask:0xf bank_mask:0xf
    v_and_b32_dpp v39, v29, v11 row_newbcast:8 row_mask:0xf bank_mask:0xf
    v_and_b32_dpp v40, v29, v8 row_newbcast:4 row_mask:0xf bank_mask:0xf
    v_and_b32_dpp v41, v29, v9 row_newbcast:4 row_mask:0xf bank_mask:0xf
    v_and_b32_dpp v42, v29, v10 row_newbcast:4 row_mask:0xf bank_mask:0xf
    v_and_b32_dpp v43, v29, v11 row_newbcast:4 row_mask:0xf bank_mask:0xf
    v_and_b32_dpp v44, v29, v8 row_newbcast:12 row_mask:0xf bank_mask:0xf
    v_and_b32_dpp v45, v29, v9 row_newbcast:12 row_mask:0xf bank_mask:0xf
    v_and_b32_dpp v46, v29, v10 row_newbcast:12 row_mask:0xf bank_mask:0xf
    v_and_b32_dpp v47, v29, v11 row_newbcast:12 row_mask:0xf bank_mask:0xf
    s_waitcnt vmcnt(8)
    v_mfma_f32_16x16x32_bf16 v[12:15], v[32:35], a[48:51], v[12:15]
    v_mfma_f32_16x16x32_bf16 v[12:15], v[36:39], a[52:55], v[12:15]
    v_mfma_f32_16x16x32_bf16 v[12:15], v[40:43], a[56:59], v[12:15]
    v_mfma_f32_16x16x32_bf16 v[12:15], v[44:47], a[60:63], v[12:15]
    buffer_load_dwordx4 v[128:131], v19, s[40:43], s24 offen offset:0 nt
    buffer_load_dwordx4 v[132:135], v19, s[40:43], s24 offen offset:1152 nt
    buffer_load_dwordx4 v[136:139], v19, s[40:43], s24 offen offset:2304 nt
    buffer_load_dwordx4 v[140:143], v19, s[40:43], s24 offen offset:3456 nt
    s_add_u32 s24, s24, 4608
    buffer_load_dwordx4 v[144:147], v19, s[40:43], s24 offen offset:0 nt
    buffer_load_dwordx4 v[148:151], v19, s[40:43], s24 offen offset:1152 nt
    buffer_load_dwordx4 v[152:155], v19, s[40:43], s24 offen offset:2304 nt
    buffer_load_dwordx4 v[156:159], v19, s[40:43], s24 offen offset:3456 nt
    s_add_u32 s24, s24, 69120
    s_branch L_alast0
L_aflag:
    s_sleep 2
    global_load_dword v57, v58, s[28:29] sc1
    s_waitcnt vmcnt(0)
    v_readfirstlane_b32 s18, v57
    v_cmp_gt_u32 vcc, 1073741824, v57
    s_cbranch_vccz L_aflag_ok
    s_sub_u32 s101, s101, 1
    s_cbranch_scc0 L_aflag
    s_mov_b32 s101, 0
    s_branch L_aflag_ok
L_roleA_end:
L_roleH:
    s_mov_b32 s101, 100000
    s_getpc_b64 s[56:57]
L_pc_21:
    s_sub_u32 s56, s56, L_pc_21-L_roleH
    s_subb_u32 s57, s57, 0
    v_lshlrev_b32 v5, 7, v0
    v_min_u32 v6, L_roleH_end-L_roleH-4, v5
    global_load_dword v122, v6, s[56:57]
    v_mov_b32 v20, -1
    v_mov_b32 v21, -1
    v_mov_b32 v22, -1
    v_mov_b32 v23, -1
    v_mul_u32_u24 v7, 73728, v4
    v_lshrrev_b32 v5, 3, v3
    v_lshl_add_u32 v6, v5, 13, v7
    v_and_b32 v5, 7, v3
    v_lshl_add_u32 v6, v5, 4, v6
    v_lshl_add_u32 v7, v3, 3, v7
    v_add_u32 v7, 65536, v7
    s_lshl_b32 s56, s52, 7
    s_add_u32 s56, s56, 4718592
    s_lshl_b32 s54, s3, 14
    s_add_u32 s54, s54, s56
    s_add_u32 s55, s54, 4096
    s_and_b32 s57, s3, 1
    s_lshl_b32 s57, s57, 12
    s_add_u32 s56, s56, s57
    s_waitcnt lgkmcnt(0)
    s_mov_b32 s44, s30
    s_mov_b32 s45, s31
    s_mov_b32 s46, 536870912
    s_mov_b32 s47, 0x20000
    buffer_store_dwordx4 v[20:23], v6, s[44:47], s54 offen sc1
    buffer_store_dwordx4 v[20:23], v6, s[44:47], s55 offen sc1
    buffer_store_dwordx2 v[20:21], v7, s[44:47], s56 offen sc1
    v_lshrrev_b32 v5, 2, v3
    v_lshlrev_b32 v5, 15, v5
    v_lshl_add_u32 v5, v4, 4, v5
    v_and_b32 v6, 3, v3
    v_lshl_add_u32 v5, v6, 6, v5
    s_lshl_b32 s54, s52, 10
    s_lshl_b32 s55, s3, 8
    s_add_u32 s54, s54, s55
    s_add_u32 s54, s54, 1048576
    buffer_store_dwordx4 v[20:23], v5, s[44:47], s54 offen sc1
    v_bfe_u32 v6, v1, 2, 2
    v_lshlrev_b32 v6, 6, v6
    v_and_b32 v5, 48, v1
    v_add_u32 v6, v6, v5
    v_and_b32 v5, 3, v1
    v_lshl_add_u32 v6, v5, 29, v6
    s_lshl_b32 s54, s52, 10
    s_lshl_b32 s55, s3, 8
    s_add_u32 s54, s54, s55
    s_add_u32 s54, s54, 5439488
    buffer_store_dwordx4 v[20:23], v6, s[44:47], s54 offen sc1
    s_mov_b32 s32, s18
    s_mov_b32 s33, s19
    s_mov_b32 s34, 4718592
    s_mov_b32 s35, 0x20000
    s_mov_b32 s36, s14
    s_mov_b32 s37, s15
    s_mov_b32 s38, 4608
    s_mov_b32 s39, 0x20000
    v_lshrrev_b32 v5, 3, v3
    v_mul_u32_u24 v5, 1152, v5
    v_mul_u32_u24 v6, 72, v4
    v_add_u32 v5, v5, v6
    s_mul_i32 s54, s3, 288
    buffer_load_dwordx4 v[48:51], v5, s[36:39], s54 offen offset:0
    buffer_load_dwordx4 v[52:55], v5, s[36:39], s54 offen offset:16
    buffer_load_dwordx4 v[56:59], v5, s[36:39], s54 offen offset:32
    buffer_load_dwordx4 v[60:63], v5, s[36:39], s54 offen offset:48
    buffer_load_dwordx2 v[64:65], v5, s[36:39], s54 offen offset:64
    buffer_load_dwordx4 v[68:71], v5, s[36:39], s54 offen offset:2304
    buffer_load_dwordx4 v[72:75], v5, s[36:39], s54 offen offset:2320
    buffer_load_dwordx4 v[76:79], v5, s[36:39], s54 offen offset:2336
    buffer_load_dwordx4 v[80:83], v5, s[36:39], s54 offen offset:2352
    buffer_load_dwordx2 v[84:85], v5, s[36:39], s54 offen offset:2368
    v_mul_u32_u24 v120, 294912, v4
    v_lshl_add_u32 v120, v3, 4, v120
    s_mul_i32 s61, s3, 1179648
    s_lshl_b32 s54, s52, 8
    s_add_u32 s61, s61, s54
    buffer_load_dwordx4 a[112:115], v120, s[32:35], s61 offen nt
    s_add_u32 s61, s61, 8192
    buffer_load_dwordx4 a[116:119], v120, s[32:35], s61 offen nt
    s_add_u32 s61, s61, 8192
    buffer_load_dwordx4 a[120:123], v120, s[32:35], s61 offen nt
    s_add_u32 s61, s61, 8192
    buffer_load_dwordx4 a[124:127], v120, s[32:35], s61 offen nt
    s_add_u32 s61, s61, 8192
    buffer_load_dwordx4 a[128:131], v120, s[32:35], s61 offen nt
    s_add_u32 s61, s61, 8192
    buffer_load_dwordx4 a[132:135], v120, s[32:35], s61 offen nt
    s_add_u32 s61, s61, 8192
    buffer_load_dwordx4 a[136:139], v120, s[32:35], s61 offen nt
    s_add_u32 s61, s61, 8192
    buffer_load_dwordx4 a[140:143], v120, s[32:35], s61 offen nt
    s_add_u32 s61, s61, 8192
    buffer_load_dwordx4 a[144:147], v120, s[32:35], s61 offen nt
    s_add_u32 s61, s61, 8192
    s_cmp_lg_u32 s3, 0
    s_cbranch_scc1 L_norace_22
    s_sub_u32 s84, s52, 1
    s_lshl_b32 s84, s84, 11
    s_lshl_b32 s85, s52, 12
    s_xor_b32 s84, s84, s85
    s_lshl_b32 s85, s52, 10
    s_xor_b32 s84, s84, s85
    s_and_b32 s84, s84, 0x2000
    s_lshr_b32 s85, s52, 2
    s_xor_b32 s85, s85, s52
    s_and_b32 s85, s85, 3
    s_lshl_b32 s85, s85, 25
    s_or_b32 s84, s84, s85
    s_lshl_b32 s85, s52, 20
    s_or_b32 s84, s84, s85
    s_xor_b32 s85, s84, 0x2000
    s_mov_b32 s86, -1
    s_mov_b32 s87, -1
    s_load_dword s87, s[6:7], s85 offset:0x80500
    s_load_dword s86, s[6:7], s84 offset:0x80000
    s_mov_b32 s97, 1
    s_waitcnt lgkmcnt(1)
    s_cmp_lg_u32 s87, -1
    s_subb_u32 s97, s97, 0
    s_cmp_lg_u32 s86, -1
    s_addc_u32 s97, s97, 0
    s_sub_u32 s96, 2, s97
    s_bitcmp1_b32 s52, 3
    s_cselect_b32 s97, s96, s97
    s_lshl_b32 s97, s97, 0
    s_or_b32 s97, s97, 0x1000000
L_norace_22:
    s_waitcnt vmcnt(19)
    s_barrier
    s_cmp_lg_u32 s3, 0
    s_cbranch_scc1 L_nosig_23
    s_atomic_add s97, s[28:29], 0 glc
L_nosig_23:
    buffer_load_dwordx4 a[148:151], v120, s[32:35], s61 offen nt
    s_add_u32 s61, s61, 8192
    buffer_load_dwordx4 a[152:155], v120, s[32:35], s61 offen nt
    s_add_u32 s61, s61, 8192
    buffer_load_dwordx4 a[156:159], v120, s[32:35], s61 offen nt
    s_add_u32 s61, s61, 8192
    buffer_load_dwordx4 a[160:163], v120, s[32:35], s61 offen nt
    s_add_u32 s61, s61, 8192
    buffer_load_dwordx4 a[164:167], v120, s[32:35], s61 offen nt
    s_add_u32 s61, s61, 8192
    buffer_load_dwordx4 a[168:171], v120, s[32:35], s61 offen nt
    s_add_u32 s61, s61, 8192
    buffer_load_dwordx4 a[172:175], v120, s[32:35], s61 offen nt
    s_add_u32 s61, s61, 8192
    buffer_load_dwordx4 a[176:179], v120, s[32:35], s61 offen nt
    s_add_u32 s61, s61, 8192
    buffer_load_dwordx4 a[180:183], v120, s[32:35], s61 offen nt
    s_add_u32 s61, s61, 8192
    s_mov_b32 s36, s20
    s_mov_b32 s37, s21
    s_mov_b32 s38, 4194304
    s_mov_b32 s39, 0x20000
    s_mov_b32 s40, s22
    s_mov_b32 s41, s23
    s_mov_b32 s42, 4194304
    s_mov_b32 s43, 0x20000
    v_lshlrev_b32 v5, 2, v4
    v_xor_b32 v5, v5, v3
    v_lshlrev_b32 v6, 13, v4
    v_xor_b32 v7, 0, v5
    v_lshl_add_u32 v88, v7, 4, v6
    v_xor_b32 v7, 1, v5
    v_lshl_add_u32 v89, v7, 4, v6
    v_xor_b32 v7, 2, v5
    v_lshl_add_u32 v90, v7, 4, v6
    v_xor_b32 v7, 3, v5
    v_lshl_add_u32 v91, v7, 4, v6
    s_lshl_b32 s62, s3, 20
    s_lshl_b32 s54, s52, 8
    s_add_u32 s62, s62, s54
    s_mov_b32 s60, s62
    s_lshl_b32 s63, s3, 15
    v_lshlrev_b32 v121, 18, v4
    v_lshl_add_u32 v121, v3, 4, v121
    v_lshrrev_b32 v5, 2, v3
    v_and_b32 v6, 3, v3
    v_lshl_add_u32 v7, v5, 3, v6
    v_lshlrev_b32 v92, 8, v7
    v_lshl_or_b32 v5, v6, 2, v5
    v_xor_b32 v5, v5, v4
    v_lshl_add_u32 v92, v5, 4, v92
    v_add_u32 v92, s63, v92
    v_xor_b32 v93, 64, v92
    v_xor_b32 v94, 128, v92
    v_xor_b32 v95, 192, v92
    v_and_b32 v5, 1, v3
    v_cmp_eq_u32 vcc, 1, v5
    v_mov_b32 v5, 0x0c0c0100
    v_mov_b32 v6, 0x01000c0c
    v_cndmask_b32 v5, v5, v6, vcc
    v_mov_b32 v6, 0x0c0c0302
    v_mov_b32 v7, 0x03020c0c
    v_cndmask_b32 v6, v6, v7, vcc
    v_bfe_u32 v7, v3, 1, 2
    v_mov_b32 v16, 0x0c0c0c0c
    v_cmp_eq_u32 vcc, 0, v7
    s_nop 1
    v_cndmask_b32 v8, v16, v5, vcc
    v_cndmask_b32 v9, v16, v6, vcc
    v_cmp_eq_u32 vcc, 1, v7
    s_nop 1
    v_cndmask_b32 v10, v16, v5, vcc
    v_cndmask_b32 v11, v16, v6, vcc
    v_cmp_eq_u32 vcc, 2, v7
    s_nop 1
    v_cndmask_b32 v12, v16, v5, vcc
    v_cndmask_b32 v13, v16, v6, vcc
    v_cmp_eq_u32 vcc, 3, v7
    s_nop 1
    v_cndmask_b32 v14, v16, v5, vcc
    v_cndmask_b32 v15, v16, v6, vcc
    s_waitcnt vmcnt(9)
    buffer_load_dwordx4 a[184:187], v120, s[32:35], s61 offen nt
    s_add_u32 s61, s61, 8192
    buffer_load_dwordx4 a[188:191], v120, s[32:35], s61 offen nt
    s_add_u32 s61, s61, 8192
    buffer_load_dwordx4 a[192:195], v120, s[32:35], s61 offen nt
    s_add_u32 s61, s61, 8192
    buffer_load_dwordx4 a[196:199], v120, s[32:35], s61 offen nt
    s_add_u32 s61, s61, 8192
    buffer_load_dwordx4 a[200:203], v120, s[32:35], s61 offen nt
    s_add_u32 s61, s61, 8192
    buffer_load_dwordx4 a[204:207], v120, s[32:35], s61 offen nt
    s_add_u32 s61, s61, 8192
    buffer_load_dwordx4 a[208:211], v120, s[32:35], s61 offen nt
    s_add_u32 s61, s61, 8192
    buffer_load_dwordx4 a[212:215], v120, s[32:35], s61 offen nt
    s_add_u32 s61, s61, 8192
    buffer_load_dwordx4 a[216:219], v120, s[32:35], s61 offen nt
    s_add_u32 s61, s61, 8192
    buffer_load_dwordx4 a[220:223], v120, s[32:35], s61 offen nt
    s_add_u32 s61, s61, 8192
    buffer_load_dwordx4 a[224:227], v120, s[32:35], s61 offen nt
    s_add_u32 s61, s61, 8192
    buffer_load_dwordx4 a[228:231], v120, s[32:35], s61 offen nt
    s_add_u32 s61, s61, 8192
    buffer_load_dwordx4 a[232:235], v120, s[32:35], s61 offen nt
    s_add_u32 s61, s61, 8192
    buffer_load_dwordx4 a[236:239], v120, s[32:35], s61 offen nt
    s_add_u32 s61, s61, 8192
    buffer_load_dwordx4 a[240:243], v120, s[32:35], s61 offen nt
    s_add_u32 s61, s61, 8192
    buffer_load_dwordx4 a[244:247], v120, s[32:35], s61 offen nt
    s_add_u32 s61, s61, 8192
    buffer_load_dwordx4 a[248:251], v120, s[32:35], s61 offen nt
    s_add_u32 s61, s61, 8192
    buffer_load_dwordx4 a[252:255], v120, s[32:35], s61 offen nt
    s_add_u32 s61, s61, 8192
    s_add_u32 m0, s63, 0
    s_nop 0
    buffer_load_dwordx4 v88, s[36:39], s60 offen nt lds
    s_add_u32 s60, s60, 32768
    v_perm_b32 v96, v48, v48, v8
    v_perm_b32 v97, v48, v48, v10
    v_perm_b32 v98, v48, v48, v12
    v_perm_b32 v99, v48, v48, v14
    s_nop 1
    v_mfma_f32_16x16x32_bf16 v[112:115], v[96:99], a[112:115], 0
    v_perm_b32 v100, v68, v68, v8
    v_perm_b32 v101, v68, v68, v10
    v_perm_b32 v102, v68, v68, v12
    v_perm_b32 v103, v68, v68, v14
    s_nop 1
    v_mfma_f32_16x16x32_bf16 v[116:119], v[100:103], a[112:115], 0
    v_perm_b32 v104, v48, v48, v9
    v_perm_b32 v105, v48, v48, v11
    v_perm_b32 v106, v48, v48, v13
    v_perm_b32 v107, v48, v48, v15
    s_nop 1
    v_mfma_f32_16x16x32_bf16 v[112:115], v[104:107], a[116:119], v[112:115]
    v_perm_b32 v108, v68, v68, v9
    v_perm_b32 v109, v68, v68, v11
    v_perm_b32 v110, v68, v68, v13
    v_perm_b32 v111, v68, v68, v15
    s_nop 1
    v_mfma_f32_16x16x32_bf16 v[116:119], v[108:111], a[116:119], v[116:119]
    v_perm_b32 v96, v49, v49, v8
    v_perm_b32 v97, v49, v49, v10
    v_perm_b32 v98, v49, v49, v12
    v_perm_b32 v99, v49, v49, v14
    s_nop 1
    v_mfma_f32_16x16x32_bf16 v[112:115], v[96:99], a[120:123], v[112:115]
    v_perm_b32 v100, v69, v69, v8
    v_perm_b32 v101, v69, v69, v10
    v_perm_b32 v102, v69, v69, v12
    v_perm_b32 v103, v69, v69, v14
    s_nop 1
    v_mfma_f32_16x16x32_bf16 v[116:119], v[100:103], a[120:123], v[116:119]
    v_perm_b32 v104, v49, v49, v9
    v_perm_b32 v105, v49, v49, v11
    v_perm_b32 v106, v49, v49, v13
    v_perm_b32 v107, v49, v49, v15
    s_nop 1
    v_mfma_f32_16x16x32_bf16 v[112:115], v[104:107], a[124:127], v[112:115]
    v_perm_b32 v108, v69, v69, v9
    v_perm_b32 v109, v69, v69, v11
    v_perm_b32 v110, v69, v69, v13
    v_perm_b32 v111, v69, v69, v15
    s_nop 1
    v_mfma_f32_16x16x32_bf16 v[116:119], v[108:111], a[124:127], v[116:119]
    v_perm_b32 v96, v50, v50, v8
    v_perm_b32 v97, v50, v50, v10
    v_perm_b32 v98, v50, v50, v12
    v_perm_b32 v99, v50, v50, v14
    s_nop 1
    v_mfma_f32_16x16x32_bf16 v[112:115], v[96:99], a[128:131], v[112:115]
    v_perm_b32 v100, v70, v70, v8
    v_perm_b32 v101, v70, v70, v10
    v_perm_b32 v102, v70, v70, v12
    v_perm_b32 v103, v70, v70, v14
    s_nop 1
    v_mfma_f32_16x16x32_bf16 v[116:119], v[100:103], a[128:131], v[116:119]
    v_perm_b32 v104, v50, v50, v9
    v_perm_b32 v105, v50, v50, v11
    v_perm_b32 v106, v50, v50, v13
    v_perm_b32 v107, v50, v50, v15
    s_nop 1
    v_mfma_f32_16x16x32_bf16 v[112:115], v[104:107], a[132:135], v[112:115]
    v_perm_b32 v108, v70, v70, v9
    v_perm_b32 v109, v70, v70, v11
    v_perm_b32 v110, v70, v70, v13
    v_perm_b32 v111, v70, v70, v15
    s_nop 1
    v_mfma_f32_16x16x32_bf16 v[116:119], v[108:111], a[132:135], v[116:119]
    v_perm_b32 v96, v51, v51, v8
    v_perm_b32 v97, v51, v51, v10
    v_perm_b32 v98, v51, v51, v12
    v_perm_b32 v99, v51, v51, v14
    s_nop 1
    v_mfma_f32_16x16x32_bf16 v[112:115], v[96:99], a[136:139], v[112:115]
    v_perm_b32 v100, v71, v71, v8
    v_perm_b32 v101, v71, v71, v10
    v_perm_b32 v102, v71, v71, v12
    v_perm_b32 v103, v71, v71, v14
    s_nop 1
    v_mfma_f32_16x16x32_bf16 v[116:119], v[100:103], a[136:139], v[116:119]
    v_perm_b32 v104, v51, v51, v9
    v_perm_b32 v105, v51, v51, v11
    v_perm_b32 v106, v51, v51, v13
    v_perm_b32 v107, v51, v51, v15
    s_nop 1
    v_mfma_f32_16x16x32_bf16 v[112:115], v[104:107], a[140:143], v[112:115]
    v_perm_b32 v108, v71, v71, v9
    v_perm_b32 v109, v71, v71, v11
    v_perm_b32 v110, v71, v71, v13
    v_perm_b32 v111, v71, v71, v15
    s_nop 1
    v_mfma_f32_16x16x32_bf16 v[116:119], v[108:111], a[140:143], v[116:119]
    v_perm_b32 v96, v52, v52, v8
    v_perm_b32 v97, v52, v52, v10
    v_perm_b32 v98, v52, v52, v12
    v_perm_b32 v99, v52, v52, v14
    s_nop 1
    v_mfma_f32_16x16x32_bf16 v[112:115], v[96:99], a[144:147], v[112:115]
    v_perm_b32 v100, v72, v72, v8
    v_perm_b32 v101, v72, v72, v10
    v_perm_b32 v102, v72, v72, v12
    v_perm_b32 v103, v72, v72, v14
    s_nop 1
    v_mfma_f32_16x16x32_bf16 v[116:119], v[100:103], a[144:147], v[116:119]
    s_waitcnt vmcnt(19)
    s_add_u32 m0, s63, 1024
    s_nop 0
    buffer_load_dwordx4 v88, s[36:39], s60 offen nt lds
    s_add_u32 s60, s60, 32768
    s_add_u32 m0, s63, 2048
    s_nop 0
    buffer_load_dwordx4 v89, s[36:39], s60 offen nt lds
    s_add_u32 s60, s60, 32768
    s_add_u32 m0, s63, 3072
    s_nop 0
    buffer_load_dwordx4 v89, s[36:39], s60 offen nt lds
    s_add_u32 s60, s60, 32768
    s_add_u32 m0, s63, 4096
    s_nop 0
    buffer_load_dwordx4 v90, s[36:39], s60 offen nt lds
    s_add_u32 s60, s60, 32768
    s_add_u32 m0, s63, 5120
    s_nop 0
    buffer_load_dwordx4 v90, s[36:39], s60 offen nt lds
    s_add_u32 s60, s60, 32768
    s_add_u32 m0, s63, 6144
    s_nop 0
    buffer_load_dwordx4 v91, s[36:39], s60 offen nt lds
    s_add_u32 s60, s60, 32768
    s_add_u32 m0, s63, 7168
    s_nop 0
    buffer_load_dwordx4 v91, s[36:39], s60 offen nt lds
    s_add_u32 s60, s60, 32768
    s_add_u32 m0, s63, 8192
    s_nop 0
    buffer_load_dwordx4 v88, s[36:39], s60 offen nt lds
    s_add_u32 s60, s60, 32768
    s_add_u32 m0, s63, 9216
    s_nop 0
    buffer_load_dwordx4 v88, s[36:39], s60 offen nt lds
    s_add_u32 s60, s60, 32768
    v_perm_b32 v104, v52, v52, v9
    v_perm_b32 v105, v52, v52, v11
    v_perm_b32 v106, v52, v52, v13
    v_perm_b32 v107, v52, v52, v15
    s_nop 1
    v_mfma_f32_16x16x32_bf16 v[112:115], v[104:107], a[148:151], v[112:115]
    v_perm_b32 v108, v72, v72, v9
    v_perm_b32 v109, v72, v72, v11
    v_perm_b32 v110, v72, v72, v13
    v_perm_b32 v111, v72, v72, v15
    s_nop 1
    v_mfma_f32_16x16x32_bf16 v[116:119], v[108:111], a[148:151], v[116:119]
    v_perm_b32 v96, v53, v53, v8
    v_perm_b32 v97, v53, v53, v10
    v_perm_b32 v98, v53, v53, v12
    v_perm_b32 v99, v53, v53, v14
    s_nop 1
    v_mfma_f32_16x16x32_bf16 v[112:115], v[96:99], a[152:155], v[112:115]
    v_perm_b32 v100, v73, v73, v8
    v_perm_b32 v101, v73, v73, v10
    v_perm_b32 v102, v73, v73, v12
    v_perm_b32 v103, v73, v73, v14
    s_nop 1
    v_mfma_f32_16x16x32_bf16 v[116:119], v[100:103], a[152:155], v[116:119]
    v_perm_b32 v104, v53, v53, v9
    v_perm_b32 v105, v53, v53, v11
    v_perm_b32 v106, v53, v53, v13
    v_perm_b32 v107, v53, v53, v15
    s_nop 1
    v_mfma_f32_16x16x32_bf16 v[112:115], v[104:107], a[156:159], v[112:115]
    v_perm_b32 v108, v73, v73, v9
    v_perm_b32 v109, v73, v73, v11
    v_perm_b32 v110, v73, v73, v13
    v_perm_b32 v111, v73, v73, v15
    s_nop 1
    v_mfma_f32_16x16x32_bf16 v[116:119], v[108:111], a[156:159], v[116:119]
    v_perm_b32 v96, v54, v54, v8
    v_perm_b32 v97, v54, v54, v10
    v_perm_b32 v98, v54, v54, v12
    v_perm_b32 v99, v54, v54, v14
    s_nop 1
    v_mfma_f32_16x16x32_bf16 v[112:115], v[96:99], a[160:163], v[112:115]
    v_perm_b32 v100, v74, v74, v8
    v_perm_b32 v101, v74, v74, v10
    v_perm_b32 v102, v74, v74, v12
    v_perm_b32 v103, v74, v74, v14
    s_nop 1
    v_mfma_f32_16x16x32_bf16 v[116:119], v[100:103], a[160:163], v[116:119]
    v_perm_b32 v104, v54, v54, v9
    v_perm_b32 v105, v54, v54, v11
    v_perm_b32 v106, v54, v54, v13
    v_perm_b32 v107, v54, v54, v15
    s_nop 1
    v_mfma_f32_16x16x32_bf16 v[112:115], v[104:107], a[164:167], v[112:115]
    v_perm_b32 v108, v74, v74, v9
    v_perm_b32 v109, v74, v74, v11
    v_perm_b32 v110, v74, v74, v13
    v_perm_b32 v111, v74, v74, v15
    s_nop 1
    v_mfma_f32_16x16x32_bf16 v[116:119], v[108:111], a[164:167], v[116:119]
    v_perm_b32 v96, v55, v55, v8
    v_perm_b32 v97, v55, v55, v10
    v_perm_b32 v98, v55, v55, v12
    v_perm_b32 v99, v55, v55, v14
    s_nop 1
    v_mfma_f32_16x16x32_bf16 v[112:115], v[96:99], a[168:171], v[112:115]
    v_perm_b32 v100, v75, v75, v8
    v_perm_b32 v101, v75, v75, v10
    v_perm_b32 v102, v75, v75, v12
    v_perm_b32 v103, v75, v75, v14
    s_nop 1
    v_mfma_f32_16x16x32_bf16 v[116:119], v[100:103], a[168:171], v[116:119]
    v_perm_b32 v104, v55, v55, v9
    v_perm_b32 v105, v55, v55, v11
    v_perm_b32 v106, v55, v55, v13
    v_perm_b32 v107, v55, v55, v15
    s_nop 1
    v_mfma_f32_16x16x32_bf16 v[112:115], v[104:107], a[172:175], v[112:115]
    v_perm_b32 v108, v75, v75, v9
    v_perm_b32 v109, v75, v75, v11
    v_perm_b32 v110, v75, v75, v13
    v_perm_b32 v111, v75, v75, v15
    s_nop 1
    v_mfma_f32_16x16x32_bf16 v[116:119], v[108:111], a[172:175], v[116:119]
    v_perm_b32 v96, v56, v56, v8
    v_perm_b32 v97, v56, v56, v10
    v_perm_b32 v98, v56, v56, v12
    v_perm_b32 v99, v56, v56, v14
    s_nop 1
    v_mfma_f32_16x16x32_bf16 v[112:115], v[96:99], a[176:179], v[112:115]
    v_perm_b32 v100, v76, v76, v8
    v_perm_b32 v101, v76, v76, v10
    v_perm_b32 v102, v76, v76, v12
    v_perm_b32 v103, v76, v76, v14
    s_nop 1
    v_mfma_f32_16x16x32_bf16 v[116:119], v[100:103], a[176:179], v[116:119]
    v_perm_b32 v104, v56, v56, v9
    v_perm_b32 v105, v56, v56, v11
    v_perm_b32 v106, v56, v56, v13
    v_perm_b32 v107, v56, v56, v15
    s_nop 1
    v_mfma_f32_16x16x32_bf16 v[112:115], v[104:107], a[180:183], v[112:115]
    v_perm_b32 v108, v76, v76, v9
    v_perm_b32 v109, v76, v76, v11
    v_perm_b32 v110, v76, v76, v13
    v_perm_b32 v111, v76, v76, v15
    s_nop 1
    v_mfma_f32_16x16x32_bf16 v[116:119], v[108:111], a[180:183], v[116:119]
    s_waitcnt vmcnt(19)
    s_add_u32 m0, s63, 10240
    s_nop 0
    buffer_load_dwordx4 v89, s[36:39], s60 offen nt lds
    s_add_u32 s60, s60, 32768
    s_add_u32 m0, s63, 11264
    s_nop 0
    buffer_load_dwordx4 v89, s[36:39], s60 offen nt lds
    s_add_u32 s60, s60, 32768
    s_add_u32 m0, s63, 12288
    s_nop 0
    buffer_load_dwordx4 v90, s[36:39], s60 offen nt lds
    s_add_u32 s60, s60, 32768
    s_add_u32 m0, s63, 13312
    s_nop 0
    buffer_load_dwordx4 v90, s[36:39], s60 offen nt lds
    s_add_u32 s60, s60, 32768
    s_add_u32 m0, s63, 14336
    s_nop 0
    buffer_load_dwordx4 v91, s[36:39], s60 offen nt lds
    s_add_u32 s60, s60, 32768
    s_add_u32 m0, s63, 15360
    s_nop 0
    buffer_load_dwordx4 v91, s[36:39], s60 offen nt lds
    s_add_u32 s60, s60, 32768
    s_add_u32 m0, s63, 16384
    s_nop 0
    buffer_load_dwordx4 v88, s[36:39], s60 offen nt lds
    s_add_u32 s60, s60, 32768
    s_add_u32 m0, s63, 17408
    s_nop 0
    buffer_load_dwordx4 v88, s[36:39], s60 offen nt lds
    s_add_u32 s60, s60, 32768
    s_add_u32 m0, s63, 18432
    s_nop 0
    buffer_load_dwordx4 v89, s[36:39], s60 offen nt lds
    s_add_u32 s60, s60, 32768
    v_perm_b32 v96, v57, v57, v8
    v_perm_b32 v97, v57, v57, v10
    v_perm_b32 v98, v57, v57, v12
    v_perm_b32 v99, v57, v57, v14
    s_nop 1
    v_mfma_f32_16x16x32_bf16 v[112:115], v[96:99], a[184:187], v[112:115]
    v_perm_b32 v100, v77, v77, v8
    v_perm_b32 v101, v77, v77, v10
    v_perm_b32 v102, v77, v77, v12
    v_perm_b32 v103, v77, v77, v14
    s_nop 1
    v_mfma_f32_16x16x32_bf16 v[116:119], v[100:103], a[184:187], v[116:119]
    v_perm_b32 v104, v57, v57, v9
    v_perm_b32 v105, v57, v57, v11
    v_perm_b32 v106, v57, v57, v13
    v_perm_b32 v107, v57, v57, v15
    s_nop 1
    v_mfma_f32_16x16x32_bf16 v[112:115], v[104:107], a[188:191], v[112:115]
    v_perm_b32 v108, v77, v77, v9
    v_perm_b32 v109, v77, v77, v11
    v_perm_b32 v110, v77, v77, v13
    v_perm_b32 v111, v77, v77, v15
    s_nop 1
    v_mfma_f32_16x16x32_bf16 v[116:119], v[108:111], a[188:191], v[116:119]
    v_perm_b32 v96, v58, v58, v8
    v_perm_b32 v97, v58, v58, v10
    v_perm_b32 v98, v58, v58, v12
    v_perm_b32 v99, v58, v58, v14
    s_nop 1
    v_mfma_f32_16x16x32_bf16 v[112:115], v[96:99], a[192:195], v[112:115]
    v_perm_b32 v100, v78, v78, v8
    v_perm_b32 v101, v78, v78, v10
    v_perm_b32 v102, v78, v78, v12
    v_perm_b32 v103, v78, v78, v14
    s_nop 1
    v_mfma_f32_16x16x32_bf16 v[116:119], v[100:103], a[192:195], v[116:119]
    v_perm_b32 v104, v58, v58, v9
    v_perm_b32 v105, v58, v58, v11
    v_perm_b32 v106, v58, v58, v13
    v_perm_b32 v107, v58, v58, v15
    s_nop 1
    v_mfma_f32_16x16x32_bf16 v[112:115], v[104:107], a[196:199], v[112:115]
    v_perm_b32 v108, v78, v78, v9
    v_perm_b32 v109, v78, v78, v11
    v_perm_b32 v110, v78, v78, v13
    v_perm_b32 v111, v78, v78, v15
    s_nop 1
    v_mfma_f32_16x16x32_bf16 v[116:119], v[108:111], a[196:199], v[116:119]
    v_perm_b32 v96, v59, v59, v8
    v_perm_b32 v97, v59, v59, v10
    v_perm_b32 v98, v59, v59, v12
    v_perm_b32 v99, v59, v59, v14
    s_nop 1
    v_mfma_f32_16x16x32_bf16 v[112:115], v[96:99], a[200:203], v[112:115]
    v_perm_b32 v100, v79, v79, v8
    v_perm_b32 v101, v79, v79, v10
    v_perm_b32 v102, v79, v79, v12
    v_perm_b32 v103, v79, v79, v14
    s_nop 1
    v_mfma_f32_16x16x32_bf16 v[116:119], v[100:103], a[200:203], v[116:119]
    v_perm_b32 v104, v59, v59, v9
    v_perm_b32 v105, v59, v59, v11
    v_perm_b32 v106, v59, v59, v13
    v_perm_b32 v107, v59, v59, v15
    s_nop 1
    v_mfma_f32_16x16x32_bf16 v[112:115], v[104:107], a[204:207], v[112:115]
    v_perm_b32 v108, v79, v79, v9
    v_perm_b32 v109, v79, v79, v11
    v_perm_b32 v110, v79, v79, v13
    v_perm_b32 v111, v79, v79, v15
    s_nop 1
    v_mfma_f32_16x16x32_bf16 v[116:119], v[108:111], a[204:207], v[116:119]
    v_perm_b32 v96, v60, v60, v8
    v_perm_b32 v97, v60, v60, v10
    v_perm_b32 v98, v60, v60, v12
    v_perm_b32 v99, v60, v60, v14
    s_nop 1
    v_mfma_f32_16x16x32_bf16 v[112:115], v[96:99], a[208:211], v[112:115]
    v_perm_b32 v100, v80, v80, v8
    v_perm_b32 v101, v80, v80, v10
    v_perm_b32 v102, v80, v80, v12
    v_perm_b32 v103, v80, v80, v14
    s_nop 1
    v_mfma_f32_16x16x32_bf16 v[116:119], v[100:103], a[208:211], v[116:119]
    v_perm_b32 v104, v60, v60, v9
    v_perm_b32 v105, v60, v60, v11
    v_perm_b32 v106, v60, v60, v13
    v_perm_b32 v107, v60, v60, v15
    s_nop 1
    v_mfma_f32_16x16x32_bf16 v[112:115], v[104:107], a[212:215], v[112:115]
    v_perm_b32 v108, v80, v80, v9
    v_perm_b32 v109, v80, v80, v11
    v_perm_b32 v110, v80, v80, v13
    v_perm_b32 v111, v80, v80, v15
    s_nop 1
    v_mfma_f32_16x16x32_bf16 v[116:119], v[108:111], a[212:215], v[116:119]
    v_perm_b32 v96, v61, v61, v8
    v_perm_b32 v97, v61, v61, v10
    v_perm_b32 v98, v61, v61, v12
    v_perm_b32 v99, v61, v61, v14
    s_nop 1
    v_mfma_f32_16x16x32_bf16 v[112:115], v[96:99], a[216:219], v[112:115]
    v_perm_b32 v100, v81, v81, v8
    v_perm_b32 v101, v81, v81, v10
    v_perm_b32 v102, v81, v81, v12
    v_perm_b32 v103, v81, v81, v14
    s_nop 1
    v_mfma_f32_16x16x32_bf16 v[116:119], v[100:103], a[216:219], v[116:119]
    s_waitcnt vmcnt(19)
    s_add_u32 m0, s63, 19456
    s_nop 0
    buffer_load_dwordx4 v89, s[36:39], s60 offen nt lds
    s_add_u32 s60, s60, 32768
    s_add_u32 m0, s63, 20480
    s_nop 0
    buffer_load_dwordx4 v90, s[36:39], s60 offen nt lds
    s_add_u32 s60, s60, 32768
    s_add_u32 m0, s63, 21504
    s_nop 0
    buffer_load_dwordx4 v90, s[36:39], s60 offen nt lds
    s_add_u32 s60, s60, 32768
    s_add_u32 m0, s63, 22528
    s_nop 0
    buffer_load_dwordx4 v91, s[36:39], s60 offen nt lds
    s_add_u32 s60, s60, 32768
    s_add_u32 m0, s63, 23552
    s_nop 0
    buffer_load_dwordx4 v91, s[36:39], s60 offen nt lds
    s_add_u32 s60, s60, 32768
    s_add_u32 m0, s63, 24576
    s_nop 0
    buffer_load_dwordx4 v88, s[36:39], s60 offen nt lds
    s_add_u32 s60, s60, 32768
    s_add_u32 m0, s63, 25600
    s_nop 0
    buffer_load_dwordx4 v88, s[36:39], s60 offen nt lds
    s_add_u32 s60, s60, 32768
    s_add_u32 m0, s63, 26624
    s_nop 0
    buffer_load_dwordx4 v89, s[36:39], s60 offen nt lds
    s_add_u32 s60, s60, 32768
    s_add_u32 m0, s63, 27648
    s_nop 0
    buffer_load_dwordx4 v89, s[36:39], s60 offen nt lds
    s_add_u32 s60, s60, 32768
    v_perm_b32 v104, v61, v61, v9
    v_perm_b32 v105, v61, v61, v11
    v_perm_b32 v106, v61, v61, v13
    v_perm_b32 v107, v61, v61, v15
    s_nop 1
    v_mfma_f32_16x16x32_bf16 v[112:115], v[104:107], a[220:223], v[112:115]
    v_perm_b32 v108, v81, v81, v9
    v_perm_b32 v109, v81, v81, v11
    v_perm_b32 v110, v81, v81, v13
    v_perm_b32 v111, v81, v81, v15
    s_nop 1
    v_mfma_f32_16x16x32_bf16 v[116:119], v[108:111], a[220:223], v[116:119]
    v_perm_b32 v96, v62, v62, v8
    v_perm_b32 v97, v62, v62, v10
    v_perm_b32 v98, v62, v62, v12
    v_perm_b32 v99, v62, v62, v14
    s_nop 1
    v_mfma_f32_16x16x32_bf16 v[112:115], v[96:99], a[224:227], v[112:115]
    v_perm_b32 v100, v82, v82, v8
    v_perm_b32 v101, v82, v82, v10
    v_perm_b32 v102, v82, v82, v12
    v_perm_b32 v103, v82, v82, v14
    s_nop 1
    v_mfma_f32_16x16x32_bf16 v[116:119], v[100:103], a[224:227], v[116:119]
    v_perm_b32 v104, v62, v62, v9
    v_perm_b32 v105, v62, v62, v11
    v_perm_b32 v106, v62, v62, v13
    v_perm_b32 v107, v62, v62, v15
    s_nop 1
    v_mfma_f32_16x16x32_bf16 v[112:115], v[104:107], a[228:231], v[112:115]
    v_perm_b32 v108, v82, v82, v9
    v_perm_b32 v109, v82, v82, v11
    v_perm_b32 v110, v82, v82, v13
    v_perm_b32 v111, v82, v82, v15
    s_nop 1
    v_mfma_f32_16x16x32_bf16 v[116:119], v[108:111], a[228:231], v[116:119]
    v_perm_b32 v96, v63, v63, v8
    v_perm_b32 v97, v63, v63, v10
    v_perm_b32 v98, v63, v63, v12
    v_perm_b32 v99, v63, v63, v14
    s_nop 1
    v_mfma_f32_16x16x32_bf16 v[112:115], v[96:99], a[232:235], v[112:115]
    v_perm_b32 v100, v83, v83, v8
    v_perm_b32 v101, v83, v83, v10
    v_perm_b32 v102, v83, v83, v12
    v_perm_b32 v103, v83, v83, v14
    s_nop 1
    v_mfma_f32_16x16x32_bf16 v[116:119], v[100:103], a[232:235], v[116:119]
    v_perm_b32 v104, v63, v63, v9
    v_perm_b32 v105, v63, v63, v11
    v_perm_b32 v106, v63, v63, v13
    v_perm_b32 v107, v63, v63, v15
    s_nop 1
    v_mfma_f32_16x16x32_bf16 v[112:115], v[104:107], a[236:239], v[112:115]
    v_perm_b32 v108, v83, v83, v9
    v_perm_b32 v109, v83, v83, v11
    v_perm_b32 v110, v83, v83, v13
    v_perm_b32 v111, v83, v83, v15
    s_nop 1
    v_mfma_f32_16x16x32_bf16 v[116:119], v[108:111], a[236:239], v[116:119]
    v_perm_b32 v96, v64, v64, v8
    v_perm_b32 v97, v64, v64, v10
    v_perm_b32 v98, v64, v64, v12
    v_perm_b32 v99, v64, v64, v14
    s_nop 1
    v_mfma_f32_16x16x32_bf16 v[112:115], v[96:99], a[240:243], v[112:115]
    v_perm_b32 v100, v84, v84, v8
    v_perm_b32 v101, v84, v84, v10
    v_perm_b32 v102, v84, v84, v12
    v_perm_b32 v103, v84, v84, v14
    s_nop 1
    v_mfma_f32_16x16x32_bf16 v[116:119], v[100:103], a[240:243], v[116:119]
    v_perm_b32 v104, v64, v64, v9
    v_perm_b32 v105, v64, v64, v11
    v_perm_b32 v106, v64, v64, v13
    v_perm_b32 v107, v64, v64, v15
    s_nop 1
    v_mfma_f32_16x16x32_bf16 v[112:115], v[104:107], a[244:247], v[112:115]
    v_perm_b32 v108, v84, v84, v9
    v_perm_b32 v109, v84, v84, v11
    v_perm_b32 v110, v84, v84, v13
    v_perm_b32 v111, v84, v84, v15
    s_nop 1
    v_mfma_f32_16x16x32_bf16 v[116:119], v[108:111], a[244:247], v[116:119]
    v_perm_b32 v96, v65, v65, v8
    v_perm_b32 v97, v65, v65, v10
    v_perm_b32 v98, v65, v65, v12
    v_perm_b32 v99, v65, v65, v14
    s_nop 1
    v_mfma_f32_16x16x32_bf16 v[112:115], v[96:99], a[248:251], v[112:115]
    v_perm_b32 v100, v85, v85, v8
    v_perm_b32 v101, v85, v85, v10
    v_perm_b32 v102, v85, v85, v12
    v_perm_b32 v103, v85, v85, v14
    s_nop 1
    v_mfma_f32_16x16x32_bf16 v[116:119], v[100:103], a[248:251], v[116:119]
    v_perm_b32 v104, v65, v65, v9
    v_perm_b32 v105, v65, v65, v11
    v_perm_b32 v106, v65, v65, v13
    v_perm_b32 v107, v65, v65, v15
    s_nop 1
    v_mfma_f32_16x16x32_bf16 v[112:115], v[104:107], a[252:255], v[112:115]
    v_perm_b32 v108, v85, v85, v9
    v_perm_b32 v109, v85, v85, v11
    v_perm_b32 v110, v85, v85, v13
    v_perm_b32 v111, v85, v85, v15
    s_nop 1
    v_mfma_f32_16x16x32_bf16 v[116:119], v[108:111], a[252:255], v[116:119]
    v_lshrrev_b32 v5, 1, v4
    v_lshlrev_b32 v5, 9, v5
    v_lshl_add_u32 v5, v3, 5, v5
    v_and_b32 v6, 1, v4
    v_lshl_add_u32 v5, v6, 4, v5
    s_lshl_b32 s54, s3, 11
    s_add_u32 s54, s54, 131072
    v_add_u32 v5, s54, v5
    ds_write_b128 v5, v[112:115]
    ds_write_b128 v5, v[116:119] offset:1024
    s_waitcnt lgkmcnt(0)
    s_barrier
    s_add_u32 m0, s63, 28672
    s_nop 0
    buffer_load_dwordx4 v90, s[36:39], s60 offen nt lds
    s_add_u32 s60, s60, 32768
    s_add_u32 m0, s63, 29696
    s_nop 0
    buffer_load_dwordx4 v90, s[36:39], s60 offen nt lds
    s_add_u32 s60, s60, 32768
    s_add_u32 m0, s63, 30720
    s_nop 0
    buffer_load_dwordx4 v91, s[36:39], s60 offen nt lds
    s_add_u32 s60, s60, 32768
    s_add_u32 m0, s63, 31744
    s_nop 0
    buffer_load_dwordx4 v91, s[36:39], s60 offen nt lds
    s_add_u32 s60, s60, 32768
    v_lshrrev_b32 v5, 2, v3
    v_lshlrev_b32 v5, 9, v5
    v_lshl_add_u32 v5, v4, 5, v5
    v_add_u32 v5, 131072, v5
    ds_read_b128 v[48:51], v5 offset:0
    ds_read_b128 v[52:55], v5 offset:16
    ds_read_b128 v[56:59], v5 offset:2048
    ds_read_b128 v[60:63], v5 offset:2064
    ds_read_b128 v[64:67], v5 offset:4096
    ds_read_b128 v[68:71], v5 offset:4112
    ds_read_b128 v[72:75], v5 offset:6144
    ds_read_b128 v[76:79], v5 offset:6160
    s_waitcnt lgkmcnt(0)
    v_add_f32 v48, v48, v56
    v_add_f32 v64, v64, v72
    v_add_f32 v49, v49, v57
    v_add_f32 v65, v65, v73
    v_add_f32 v50, v50, v58
    v_add_f32 v66, v66, v74
    v_add_f32 v51, v51, v59
    v_add_f32 v67, v67, v75
    v_add_f32 v52, v52, v60
    v_add_f32 v68, v68, v76
    v_add_f32 v53, v53, v61
    v_add_f32 v69, v69, v77
    v_add_f32 v54, v54, v62
    v_add_f32 v70, v70, v78
    v_add_f32 v55, v55, v63
    v_add_f32 v71, v71, v79
    v_add_f32 v48, v48, v64
    v_add_f32 v49, v49, v65
    v_add_f32 v50, v50, v66
    v_add_f32 v51, v51, v67
    v_add_f32 v52, v52, v68
    v_add_f32 v53, v53, v69
    v_add_f32 v54, v54, v70
    v_add_f32 v55, v55, v71
    v_cvt_pk_bf16_f32 v96, v48, v49
    v_cvt_pk_bf16_f32 v97, v50, v51
    v_cvt_pk_bf16_f32 v98, v52, v53
    v_cvt_pk_bf16_f32 v99, v54, v55
    ds_read_b128 v[48:51], v5 offset:128
    ds_read_b128 v[52:55], v5 offset:144
    ds_read_b128 v[56:59], v5 offset:2176
    ds_read_b128 v[60:63], v5 offset:2192
    ds_read_b128 v[64:67], v5 offset:4224
    ds_read_b128 v[68:71], v5 offset:4240
    ds_read_b128 v[72:75], v5 offset:6272
    ds_read_b128 v[76:79], v5 offset:6288
    s_waitcnt lgkmcnt(0)
    v_add_f32 v48, v48, v56
    v_add_f32 v64, v64, v72
    v_add_f32 v49, v49, v57
    v_add_f32 v65, v65, v73
    v_add_f32 v50, v50, v58
    v_add_f32 v66, v66, v74
    v_add_f32 v51, v51, v59
    v_add_f32 v67, v67, v75
    v_add_f32 v52, v52, v60
    v_add_f32 v68, v68, v76
    v_add_f32 v53, v53, v61
    v_add_f32 v69, v69, v77
    v_add_f32 v54, v54, v62
    v_add_f32 v70, v70, v78
    v_add_f32 v55, v55, v63
    v_add_f32 v71, v71, v79
    v_add_f32 v48, v48, v64
    v_add_f32 v49, v49, v65
    v_add_f32 v50, v50, v66
    v_add_f32 v51, v51, v67
    v_add_f32 v52, v52, v68
    v_add_f32 v53, v53, v69
    v_add_f32 v54, v54, v70
    v_add_f32 v55, v55, v71
    v_cvt_pk_bf16_f32 v100, v48, v49
    v_cvt_pk_bf16_f32 v101, v50, v51
    v_cvt_pk_bf16_f32 v102, v52, v53
    v_cvt_pk_bf16_f32 v103, v54, v55
    ds_read_b128 v[48:51], v5 offset:256
    ds_read_b128 v[52:55], v5 offset:272
    ds_read_b128 v[56:59], v5 offset:2304
    ds_read_b128 v[60:63], v5 offset:2320
    ds_read_b128 v[64:67], v5 offset:4352
    ds_read_b128 v[68:71], v5 offset:4368
    ds_read_b128 v[72:75], v5 offset:6400
    ds_read_b128 v[76:79], v5 offset:6416
    s_waitcnt lgkmcnt(0)
    v_add_f32 v48, v48, v56
    v_add_f32 v64, v64, v72
    v_add_f32 v49, v49, v57
    v_add_f32 v65, v65, v73
    v_add_f32 v50, v50, v58
    v_add_f32 v66, v66, v74
    v_add_f32 v51, v51, v59
    v_add_f32 v67, v67, v75
    v_add_f32 v52, v52, v60
    v_add_f32 v68, v68, v76
    v_add_f32 v53, v53, v61
    v_add_f32 v69, v69, v77
    v_add_f32 v54, v54, v62
    v_add_f32 v70, v70, v78
    v_add_f32 v55, v55, v63
    v_add_f32 v71, v71, v79
    v_add_f32 v48, v48, v64
    v_add_f32 v49, v49, v65
    v_add_f32 v50, v50, v66
    v_add_f32 v51, v51, v67
    v_add_f32 v52, v52, v68
    v_add_f32 v53, v53, v69
    v_add_f32 v54, v54, v70
    v_add_f32 v55, v55, v71
    v_cvt_pk_bf16_f32 v104, v48, v49
    v_cvt_pk_bf16_f32 v105, v50, v51
    v_cvt_pk_bf16_f32 v106, v52, v53
    v_cvt_pk_bf16_f32 v107, v54, v55
    ds_read_b128 v[48:51], v5 offset:384
    ds_read_b128 v[52:55], v5 offset:400
    ds_read_b128 v[56:59], v5 offset:2432
    ds_read_b128 v[60:63], v5 offset:2448
    ds_read_b128 v[64:67], v5 offset:4480
    ds_read_b128 v[68:71], v5 offset:4496
    ds_read_b128 v[72:75], v5 offset:6528
    ds_read_b128 v[76:79], v5 offset:6544
    s_waitcnt lgkmcnt(0)
    v_add_f32 v48, v48, v56
    v_add_f32 v64, v64, v72
    v_add_f32 v49, v49, v57
    v_add_f32 v65, v65, v73
    v_add_f32 v50, v50, v58
    v_add_f32 v66, v66, v74
    v_add_f32 v51, v51, v59
    v_add_f32 v67, v67, v75
    v_add_f32 v52, v52, v60
    v_add_f32 v68, v68, v76
    v_add_f32 v53, v53, v61
    v_add_f32 v69, v69, v77
    v_add_f32 v54, v54, v62
    v_add_f32 v70, v70, v78
    v_add_f32 v55, v55, v63
    v_add_f32 v71, v71, v79
    v_add_f32 v48, v48, v64
    v_add_f32 v49, v49, v65
    v_add_f32 v50, v50, v66
    v_add_f32 v51, v51, v67
    v_add_f32 v52, v52, v68
    v_add_f32 v53, v53, v69
    v_add_f32 v54, v54, v70
    v_add_f32 v55, v55, v71
    v_cvt_pk_bf16_f32 v108, v48, v49
    v_cvt_pk_bf16_f32 v109, v50, v51
    v_cvt_pk_bf16_f32 v110, v52, v53
    v_cvt_pk_bf16_f32 v111, v54, v55
    s_waitcnt vmcnt(24)
    ds_read_b128 v[128:131], v92 offset:0
    ds_read_b128 v[132:135], v93 offset:0
    ds_read_b128 v[136:139], v94 offset:0
    ds_read_b128 v[140:143], v95 offset:0
    ds_read_b128 v[144:147], v92 offset:1024
    ds_read_b128 v[148:151], v93 offset:1024
    ds_read_b128 v[152:155], v94 offset:1024
    ds_read_b128 v[156:159], v95 offset:1024
    s_waitcnt lgkmcnt(7)
    v_mfma_f32_16x16x32_bf16 v[48:51], v[128:131], v[96:99], 0
    s_waitcnt lgkmcnt(6)
    v_mfma_f32_16x16x32_bf16 v[48:51], v[132:135], v[100:103], v[48:51]
    s_waitcnt lgkmcnt(5)
    v_mfma_f32_16x16x32_bf16 v[48:51], v[136:139], v[104:107], v[48:51]
    s_waitcnt lgkmcnt(4)
    v_mfma_f32_16x16x32_bf16 v[48:51], v[140:143], v[108:111], v[48:51]
    s_waitcnt lgkmcnt(3)
    v_mfma_f32_16x16x32_bf16 v[52:55], v[144:147], v[96:99], 0
    s_waitcnt lgkmcnt(2)
    v_mfma_f32_16x16x32_bf16 v[52:55], v[148:151], v[100:103], v[52:55]
    s_waitcnt lgkmcnt(1)
    v_mfma_f32_16x16x32_bf16 v[52:55], v[152:155], v[104:107], v[52:55]
    s_waitcnt lgkmcnt(0)
    v_mfma_f32_16x16x32_bf16 v[52:55], v[156:159], v[108:111], v[52:55]
    s_waitcnt vmcnt(16)
    ds_read_b128 v[160:163], v92 offset:8192
    ds_read_b128 v[164:167], v93 offset:8192
    ds_read_b128 v[168:171], v94 offset:8192
    ds_read_b128 v[172:175], v95 offset:8192
    ds_read_b128 v[176:179], v92 offset:9216
    ds_read_b128 v[180:183], v93 offset:9216
    ds_read_b128 v[184:187], v94 offset:9216
    ds_read_b128 v[188:191], v95 offset:9216
    s_waitcnt lgkmcnt(7)
    v_mfma_f32_16x16x32_bf16 v[56:59], v[160:163], v[96:99], 0
    s_waitcnt lgkmcnt(6)
    v_mfma_f32_16x16x32_bf16 v[56:59], v[164:167], v[100:103], v[56:59]
    s_waitcnt lgkmcnt(5)
    v_mfma_f32_16x16x32_bf16 v[56:59], v[168:171], v[104:107], v[56:59]
    s_waitcnt lgkmcnt(4)
    v_mfma_f32_16x16x32_bf16 v[56:59], v[172:175], v[108:111], v[56:59]
    s_waitcnt lgkmcnt(3)
    v_mfma_f32_16x16x32_bf16 v[60:63], v[176:179], v[96:99], 0
    s_waitcnt lgkmcnt(2)
    v_mfma_f32_16x16x32_bf16 v[60:63], v[180:183], v[100:103], v[60:63]
    s_waitcnt lgkmcnt(1)
    v_mfma_f32_16x16x32_bf16 v[60:63], v[184:187], v[104:107], v[60:63]
    s_waitcnt lgkmcnt(0)
    v_mfma_f32_16x16x32_bf16 v[60:63], v[188:191], v[108:111], v[60:63]
    s_waitcnt vmcnt(8)
    ds_read_b128 v[128:131], v92 offset:16384
    ds_read_b128 v[132:135], v93 offset:16384
    ds_read_b128 v[136:139], v94 offset:16384
    ds_read_b128 v[140:143], v95 offset:16384
    ds_read_b128 v[144:147], v92 offset:17408
    ds_read_b128 v[148:151], v93 offset:17408
    ds_read_b128 v[152:155], v94 offset:17408
    ds_read_b128 v[156:159], v95 offset:17408
    s_waitcnt lgkmcnt(7)
    v_mfma_f32_16x16x32_bf16 v[64:67], v[128:131], v[96:99], 0
    s_waitcnt lgkmcnt(6)
    v_mfma_f32_16x16x32_bf16 v[64:67], v[132:135], v[100:103], v[64:67]
    s_waitcnt lgkmcnt(5)
    v_mfma_f32_16x16x32_bf16 v[64:67], v[136:139], v[104:107], v[64:67]
    s_waitcnt lgkmcnt(4)
    v_mfma_f32_16x16x32_bf16 v[64:67], v[140:143], v[108:111], v[64:67]
    s_waitcnt lgkmcnt(3)
    v_mfma_f32_16x16x32_bf16 v[68:71], v[144:147], v[96:99], 0
    s_waitcnt lgkmcnt(2)
    v_mfma_f32_16x16x32_bf16 v[68:71], v[148:151], v[100:103], v[68:71]
    s_waitcnt lgkmcnt(1)
    v_mfma_f32_16x16x32_bf16 v[68:71], v[152:155], v[104:107], v[68:71]
    s_waitcnt lgkmcnt(0)
    v_mfma_f32_16x16x32_bf16 v[68:71], v[156:159], v[108:111], v[68:71]
    s_waitcnt vmcnt(0)
    ds_read_b128 v[160:163], v92 offset:24576
    ds_read_b128 v[164:167], v93 offset:24576
    ds_read_b128 v[168:171], v94 offset:24576
    ds_read_b128 v[172:175], v95 offset:24576
    ds_read_b128 v[176:179], v92 offset:25600
    ds_read_b128 v[180:183], v93 offset:25600
    ds_read_b128 v[184:187], v94 offset:25600
    ds_read_b128 v[188:191], v95 offset:25600
    s_waitcnt lgkmcnt(7)
    v_mfma_f32_16x16x32_bf16 v[72:75], v[160:163], v[96:99], 0
    s_waitcnt lgkmcnt(6)
    v_mfma_f32_16x16x32_bf16 v[72:75], v[164:167], v[100:103], v[72:75]
    s_waitcnt lgkmcnt(5)
    v_mfma_f32_16x16x32_bf16 v[72:75], v[168:171], v[104:107], v[72:75]
    s_waitcnt lgkmcnt(4)
    v_mfma_f32_16x16x32_bf16 v[72:75], v[172:175], v[108:111], v[72:75]
    s_waitcnt lgkmcnt(3)
    v_mfma_f32_16x16x32_bf16 v[76:79], v[176:179], v[96:99], 0
    s_waitcnt lgkmcnt(2)
    v_mfma_f32_16x16x32_bf16 v[76:79], v[180:183], v[100:103], v[76:79]
    s_waitcnt lgkmcnt(1)
    v_mfma_f32_16x16x32_bf16 v[76:79], v[184:187], v[104:107], v[76:79]
    s_waitcnt lgkmcnt(0)
    v_mfma_f32_16x16x32_bf16 v[76:79], v[188:191], v[108:111], v[76:79]
    s_mov_b32 s96, 1040356334
    v_and_b32 v6, 3, v3
    v_cmp_eq_u32 vcc, 1, v6
    s_nop 1
    v_cndmask_b32 v48, v48, v56, vcc
    v_cndmask_b32 v49, v49, v57, vcc
    v_cndmask_b32 v50, v50, v58, vcc
    v_cndmask_b32 v51, v51, v59, vcc
    v_cndmask_b32 v52, v52, v60, vcc
    v_cndmask_b32 v53, v53, v61, vcc
    v_cndmask_b32 v54, v54, v62, vcc
    v_cndmask_b32 v55, v55, v63, vcc
    v_cmp_eq_u32 vcc, 2, v6
    s_nop 1
    v_cndmask_b32 v48, v48, v64, vcc
    v_cndmask_b32 v49, v49, v65, vcc
    v_cndmask_b32 v50, v50, v66, vcc
    v_cndmask_b32 v51, v51, v67, vcc
    v_cndmask_b32 v52, v52, v68, vcc
    v_cndmask_b32 v53, v53, v69, vcc
    v_cndmask_b32 v54, v54, v70, vcc
    v_cndmask_b32 v55, v55, v71, vcc
    v_cmp_eq_u32 vcc, 3, v6
    s_nop 1
    v_cndmask_b32 v48, v48, v72, vcc
    v_cndmask_b32 v49, v49, v73, vcc
    v_cndmask_b32 v50, v50, v74, vcc
    v_cndmask_b32 v51, v51, v75, vcc
    v_cndmask_b32 v52, v52, v76, vcc
    v_cndmask_b32 v53, v53, v77, vcc
    v_cndmask_b32 v54, v54, v78, vcc
    v_cndmask_b32 v55, v55, v79, vcc
    v_mul_f32 v48, s96, v48
    v_mul_f32 v49, s96, v49
    v_mul_f32 v50, s96, v50
    v_mul_f32 v51, s96, v51
    v_mul_f32 v52, s96, v52
    v_mul_f32 v53, s96, v53
    v_mul_f32 v54, s96, v54
    v_mul_f32 v55, s96, v55
    v_cvt_pk_bf16_f32 v24, v48, v49
    v_cvt_pk_bf16_f32 v25, v50, v51
    v_cvt_pk_bf16_f32 v26, v52, v53
    v_cvt_pk_bf16_f32 v27, v54, v55
    v_min_u32 v24, -2, v24
    v_min_u32 v25, -2, v25
    v_min_u32 v26, -2, v26
    v_min_u32 v27, -2, v27
    v_lshrrev_b32 v5, 2, v3
    v_lshlrev_b32 v5, 15, v5
    v_lshl_add_u32 v5, v4, 4, v5
    v_and_b32 v6, 3, v3
    v_lshl_add_u32 v5, v6, 6, v5
    s_lshl_b32 s54, s52, 10
    s_lshl_b32 s55, s3, 8
    s_add_u32 s54, s54, s55
    s_add_u32 s54, s54, 1048576
    buffer_store_dwordx4 v[24:27], v5, s[44:47], s54 offen sc1
    buffer_load_dwordx4 a[0:3], v121, s[40:43], s62 offen nt
    s_add_u32 s62, s62, 8192
    buffer_load_dwordx4 a[4:7], v121, s[40:43], s62 offen nt
    s_add_u32 s62, s62, 8192
    buffer_load_dwordx4 a[8:11], v121, s[40:43], s62 offen nt
    s_add_u32 s62, s62, 8192
    buffer_load_dwordx4 a[12:15], v121, s[40:43], s62 offen nt
    s_add_u32 s62, s62, 8192
    buffer_load_dwordx4 a[16:19], v121, s[40:43], s62 offen nt
    s_add_u32 s62, s62, 8192
    buffer_load_dwordx4 a[20:23], v121, s[40:43], s62 offen nt
    s_add_u32 s62, s62, 8192
    buffer_load_dwordx4 a[24:27], v121, s[40:43], s62 offen nt
    s_add_u32 s62, s62, 8192
    buffer_load_dwordx4 a[28:31], v121, s[40:43], s62 offen nt
    s_add_u32 s62, s62, 8192
    buffer_load_dwordx4 a[32:35], v121, s[40:43], s62 offen nt
    s_add_u32 s62, s62, 8192
    buffer_load_dwordx4 a[36:39], v121, s[40:43], s62 offen nt
    s_add_u32 s62, s62, 8192
    buffer_load_dwordx4 a[40:43], v121, s[40:43], s62 offen nt
    s_add_u32 s62, s62, 8192
    buffer_load_dwordx4 a[44:47], v121, s[40:43], s62 offen nt
    s_add_u32 s62, s62, 8192
    buffer_load_dwordx4 a[48:51], v121, s[40:43], s62 offen nt
    s_add_u32 s62, s62, 8192
    buffer_load_dwordx4 a[52:55], v121, s[40:43], s62 offen nt
    s_add_u32 s62, s62, 8192
    buffer_load_dwordx4 a[56:59], v121, s[40:43], s62 offen nt
    s_add_u32 s62, s62, 8192
    buffer_load_dwordx4 a[60:63], v121, s[40:43], s62 offen nt
    s_add_u32 s62, s62, 8192
    buffer_load_dwordx4 a[64:67], v121, s[40:43], s62 offen nt
    s_add_u32 s62, s62, 8192
    buffer_load_dwordx4 a[68:71], v121, s[40:43], s62 offen nt
    s_add_u32 s62, s62, 8192
    buffer_load_dwordx4 a[72:75], v121, s[40:43], s62 offen nt
    s_add_u32 s62, s62, 8192
    buffer_load_dwordx4 a[76:79], v121, s[40:43], s62 offen nt
    s_add_u32 s62, s62, 8192
    buffer_load_dwordx4 a[80:83], v121, s[40:43], s62 offen nt
    s_add_u32 s62, s62, 8192
    buffer_load_dwordx4 a[84:87], v121, s[40:43], s62 offen nt
    s_add_u32 s62, s62, 8192
    buffer_load_dwordx4 a[88:91], v121, s[40:43], s62 offen nt
    s_add_u32 s62, s62, 8192
    buffer_load_dwordx4 a[92:95], v121, s[40:43], s62 offen nt
    s_add_u32 s62, s62, 8192
    buffer_load_dwordx4 a[96:99], v121, s[40:43], s62 offen nt
    s_add_u32 s62, s62, 8192
    buffer_load_dwordx4 a[100:103], v121, s[40:43], s62 offen nt
    s_add_u32 s62, s62, 8192
    buffer_load_dwordx4 a[104:107], v121, s[40:43], s62 offen nt
    s_add_u32 s62, s62, 8192
    buffer_load_dwordx4 a[108:111], v121, s[40:43], s62 offen nt
    s_add_u32 s62, s62, 8192
    buffer_load_dwordx4 a[112:115], v121, s[40:43], s62 offen nt
    s_add_u32 s62, s62, 8192
    buffer_load_dwordx4 a[116:119], v121, s[40:43], s62 offen nt
    s_add_u32 s62, s62, 8192
    buffer_load_dwordx4 a[120:123], v121, s[40:43], s62 offen nt
    s_add_u32 s62, s62, 8192
    buffer_load_dwordx4 a[124:127], v121, s[40:43], s62 offen nt
    s_add_u32 s62, s62, 8192
    v_mov_b32 v16, 0
    global_load_dword v17, v16, s[28:29] sc1
    s_waitcnt vmcnt(0)
    s_barrier
L_flags_24:
    v_cmp_gt_u32 vcc, 1073741824, v17
    s_cbranch_vccz L_flagsok_25
    s_sleep 2
    global_load_dword v17, v16, s[28:29] sc1
    s_waitcnt vmcnt(0)
    s_sub_u32 s101, s101, 1
    s_cbranch_scc0 L_flags_24
    s_mov_b32 s101, 0
L_flagsok_25:
    s_lshl_b32 s58, s3, 18
    s_lshl_b32 s54, s52, 10
    s_add_u32 s58, s58, s54
    s_add_u32 s58, s58, 2097152
    s_lshl_b32 s59, s3, 11
    s_lshl_b32 s54, s52, 3
    s_add_u32 s59, s59, s54
    s_add_u32 s59, s59, 3145728
    s_mov_b32 s98, 0xffff0000
    v_and_b32 v5, 7, v1
    v_lshlrev_b32 v5, 8, v5
L_blight_26:
    buffer_load_dwordx2 v[232:233], v5, s[44:47], s59 offen sc1
    s_waitcnt vmcnt(0)
    v_max_u32 v6, v232, v233
    v_cmp_eq_u32 vcc, -1, v6
    s_cbranch_vccz L_bheavy_27
    s_sleep 2
    s_sub_u32 s101, s101, 1
    s_cbranch_scc0 L_blight_26
    s_mov_b32 s101, 0
L_bheavy_27:
    buffer_load_dwordx4 v[16:19], v2, s[44:47], s58 offen sc1 nt
    s_add_u32 s58, s58, 32768
    buffer_load_dwordx4 v[20:23], v2, s[44:47], s58 offen sc1 nt
    s_add_u32 s58, s58, 32768
    buffer_load_dwordx4 v[24:27], v2, s[44:47], s58 offen sc1 nt
    s_add_u32 s58, s58, 32768
    buffer_load_dwordx4 v[28:31], v2, s[44:47], s58 offen sc1 nt
    s_add_u32 s58, s58, 32768
    buffer_load_dwordx4 v[32:35], v2, s[44:47], s58 offen sc1 nt
    s_add_u32 s58, s58, 32768
    buffer_load_dwordx4 v[36:39], v2, s[44:47], s58 offen sc1 nt
    s_add_u32 s58, s58, 32768
    buffer_load_dwordx4 v[40:43], v2, s[44:47], s58 offen sc1 nt
    s_add_u32 s58, s58, 32768
    buffer_load_dwordx4 v[44:47], v2, s[44:47], s58 offen sc1 nt
    s_add_u32 s58, s58, 32768
    v_max_f32_dpp v234, v232, v232 row_ror:1 row_mask:0xf bank_mask:0xf
    s_nop 1
    v_max_f32_dpp v234, v234, v234 row_ror:2 row_mask:0xf bank_mask:0xf
    s_nop 1
    v_max_f32_dpp v234, v234, v234 row_ror:4 row_mask:0xf bank_mask:0xf
    v_sub_f32 v232, v232, v234
    v_exp_f32 v232, v232
    s_nop 0
    v_mul_f32 v232, v232, v233
    s_nop 1
    v_add_f32_dpp v234, v232, v232 row_ror:1 row_mask:0xf bank_mask:0xf
    s_nop 1
    v_add_f32_dpp v234, v234, v234 row_ror:2 row_mask:0xf bank_mask:0xf
    s_nop 1
    v_add_f32_dpp v234, v234, v234 row_ror:4 row_mask:0xf bank_mask:0xf
    v_rcp_f32 v234, v234
    s_nop 0
    v_mul_f32 v232, v232, v234
    s_waitcnt vmcnt(7)
    v_lshlrev_b32 v240, 16, v16
    v_and_b32 v16, s98, v16
    v_lshlrev_b32 v241, 16, v17
    v_and_b32 v17, s98, v17
    v_lshlrev_b32 v242, 16, v18
    v_and_b32 v18, s98, v18
    v_lshlrev_b32 v243, 16, v19
    v_and_b32 v19, s98, v19
    v_mul_f32_dpp v224, v232, v240 row_newbcast:0 row_mask:0xf bank_mask:0xf
    v_mul_f32_dpp v225, v232, v16 row_newbcast:0 row_mask:0xf bank_mask:0xf
    v_mul_f32_dpp v226, v232, v241 row_newbcast:0 row_mask:0xf bank_mask:0xf
    v_mul_f32_dpp v227, v232, v17 row_newbcast:0 row_mask:0xf bank_mask:0xf
    v_mul_f32_dpp v228, v232, v242 row_newbcast:0 row_mask:0xf bank_mask:0xf
    v_mul_f32_dpp v229, v232, v18 row_newbcast:0 row_mask:0xf bank_mask:0xf
    v_mul_f32_dpp v230, v232, v243 row_newbcast:0 row_mask:0xf bank_mask:0xf
    v_mul_f32_dpp v231, v232, v19 row_newbcast:0 row_mask:0xf bank_mask:0xf
    s_waitcnt vmcnt(6)
    v_lshlrev_b32 v240, 16, v20
    v_and_b32 v20, s98, v20
    v_lshlrev_b32 v241, 16, v21
    v_and_b32 v21, s98, v21
    v_lshlrev_b32 v242, 16, v22
    v_and_b32 v22, s98, v22
    v_lshlrev_b32 v243, 16, v23
    v_and_b32 v23, s98, v23
    v_fmac_f32_dpp v224, v232, v240 row_newbcast:1 row_mask:0xf bank_mask:0xf
    v_fmac_f32_dpp v225, v232, v20 row_newbcast:1 row_mask:0xf bank_mask:0xf
    v_fmac_f32_dpp v226, v232, v241 row_newbcast:1 row_mask:0xf bank_mask:0xf
    v_fmac_f32_dpp v227, v232, v21 row_newbcast:1 row_mask:0xf bank_mask:0xf
    v_fmac_f32_dpp v228, v232, v242 row_newbcast:1 row_mask:0xf bank_mask:0xf
    v_fmac_f32_dpp v229, v232, v22 row_newbcast:1 row_mask:0xf bank_mask:0xf
    v_fmac_f32_dpp v230, v232, v243 row_newbcast:1 row_mask:0xf bank_mask:0xf
    v_fmac_f32_dpp v231, v232, v23 row_newbcast:1 row_mask:0xf bank_mask:0xf
    s_waitcnt vmcnt(5)
    v_lshlrev_b32 v240, 16, v24
    v_and_b32 v24, s98, v24
    v_lshlrev_b32 v241, 16, v25
    v_and_b32 v25, s98, v25
    v_lshlrev_b32 v242, 16, v26
    v_and_b32 v26, s98, v26
    v_lshlrev_b32 v243, 16, v27
    v_and_b32 v27, s98, v27
    v_fmac_f32_dpp v224, v232, v240 row_newbcast:2 row_mask:0xf bank_mask:0xf
    v_fmac_f32_dpp v225, v232, v24 row_newbcast:2 row_mask:0xf bank_mask:0xf
    v_fmac_f32_dpp v226, v232, v241 row_newbcast:2 row_mask:0xf bank_mask:0xf
    v_fmac_f32_dpp v227, v232, v25 row_newbcast:2 row_mask:0xf bank_mask:0xf
    v_fmac_f32_dpp v228, v232, v242 row_newbcast:2 row_mask:0xf bank_mask:0xf
    v_fmac_f32_dpp v229, v232, v26 row_newbcast:2 row_mask:0xf bank_mask:0xf
    v_fmac_f32_dpp v230, v232, v243 row_newbcast:2 row_mask:0xf bank_mask:0xf
    v_fmac_f32_dpp v231, v232, v27 row_newbcast:2 row_mask:0xf bank_mask:0xf
    s_waitcnt vmcnt(4)
    v_lshlrev_b32 v240, 16, v28
    v_and_b32 v28, s98, v28
    v_lshlrev_b32 v241, 16, v29
    v_and_b32 v29, s98, v29
    v_lshlrev_b32 v242, 16, v30
    v_and_b32 v30, s98, v30
    v_lshlrev_b32 v243, 16, v31
    v_and_b32 v31, s98, v31
    v_fmac_f32_dpp v224, v232, v240 row_newbcast:3 row_mask:0xf bank_mask:0xf
    v_fmac_f32_dpp v225, v232, v28 row_newbcast:3 row_mask:0xf bank_mask:0xf
    v_fmac_f32_dpp v226, v232, v241 row_newbcast:3 row_mask:0xf bank_mask:0xf
    v_fmac_f32_dpp v227, v232, v29 row_newbcast:3 row_mask:0xf bank_mask:0xf
    v_fmac_f32_dpp v228, v232, v242 row_newbcast:3 row_mask:0xf bank_mask:0xf
    v_fmac_f32_dpp v229, v232, v30 row_newbcast:3 row_mask:0xf bank_mask:0xf
    v_fmac_f32_dpp v230, v232, v243 row_newbcast:3 row_mask:0xf bank_mask:0xf
    v_fmac_f32_dpp v231, v232, v31 row_newbcast:3 row_mask:0xf bank_mask:0xf
    s_waitcnt vmcnt(3)
    v_lshlrev_b32 v240, 16, v32
    v_and_b32 v32, s98, v32
    v_lshlrev_b32 v241, 16, v33
    v_and_b32 v33, s98, v33
    v_lshlrev_b32 v242, 16, v34
    v_and_b32 v34, s98, v34
    v_lshlrev_b32 v243, 16, v35
    v_and_b32 v35, s98, v35
    v_fmac_f32_dpp v224, v232, v240 row_newbcast:4 row_mask:0xf bank_mask:0xf
    v_fmac_f32_dpp v225, v232, v32 row_newbcast:4 row_mask:0xf bank_mask:0xf
    v_fmac_f32_dpp v226, v232, v241 row_newbcast:4 row_mask:0xf bank_mask:0xf
    v_fmac_f32_dpp v227, v232, v33 row_newbcast:4 row_mask:0xf bank_mask:0xf
    v_fmac_f32_dpp v228, v232, v242 row_newbcast:4 row_mask:0xf bank_mask:0xf
    v_fmac_f32_dpp v229, v232, v34 row_newbcast:4 row_mask:0xf bank_mask:0xf
    v_fmac_f32_dpp v230, v232, v243 row_newbcast:4 row_mask:0xf bank_mask:0xf
    v_fmac_f32_dpp v231, v232, v35 row_newbcast:4 row_mask:0xf bank_mask:0xf
    s_waitcnt vmcnt(2)
    v_lshlrev_b32 v240, 16, v36
    v_and_b32 v36, s98, v36
    v_lshlrev_b32 v241, 16, v37
    v_and_b32 v37, s98, v37
    v_lshlrev_b32 v242, 16, v38
    v_and_b32 v38, s98, v38
    v_lshlrev_b32 v243, 16, v39
    v_and_b32 v39, s98, v39
    v_fmac_f32_dpp v224, v232, v240 row_newbcast:5 row_mask:0xf bank_mask:0xf
    v_fmac_f32_dpp v225, v232, v36 row_newbcast:5 row_mask:0xf bank_mask:0xf
    v_fmac_f32_dpp v226, v232, v241 row_newbcast:5 row_mask:0xf bank_mask:0xf
    v_fmac_f32_dpp v227, v232, v37 row_newbcast:5 row_mask:0xf bank_mask:0xf
    v_fmac_f32_dpp v228, v232, v242 row_newbcast:5 row_mask:0xf bank_mask:0xf
    v_fmac_f32_dpp v229, v232, v38 row_newbcast:5 row_mask:0xf bank_mask:0xf
    v_fmac_f32_dpp v230, v232, v243 row_newbcast:5 row_mask:0xf bank_mask:0xf
    v_fmac_f32_dpp v231, v232, v39 row_newbcast:5 row_mask:0xf bank_mask:0xf
    s_waitcnt vmcnt(1)
    v_lshlrev_b32 v240, 16, v40
    v_and_b32 v40, s98, v40
    v_lshlrev_b32 v241, 16, v41
    v_and_b32 v41, s98, v41
    v_lshlrev_b32 v242, 16, v42
    v_and_b32 v42, s98, v42
    v_lshlrev_b32 v243, 16, v43
    v_and_b32 v43, s98, v43
    v_fmac_f32_dpp v224, v232, v240 row_newbcast:6 row_mask:0xf bank_mask:0xf
    v_fmac_f32_dpp v225, v232, v40 row_newbcast:6 row_mask:0xf bank_mask:0xf
    v_fmac_f32_dpp v226, v232, v241 row_newbcast:6 row_mask:0xf bank_mask:0xf
    v_fmac_f32_dpp v227, v232, v41 row_newbcast:6 row_mask:0xf bank_mask:0xf
    v_fmac_f32_dpp v228, v232, v242 row_newbcast:6 row_mask:0xf bank_mask:0xf
    v_fmac_f32_dpp v229, v232, v42 row_newbcast:6 row_mask:0xf bank_mask:0xf
    v_fmac_f32_dpp v230, v232, v243 row_newbcast:6 row_mask:0xf bank_mask:0xf
    v_fmac_f32_dpp v231, v232, v43 row_newbcast:6 row_mask:0xf bank_mask:0xf
    s_waitcnt vmcnt(0)
    v_lshlrev_b32 v240, 16, v44
    v_and_b32 v44, s98, v44
    v_lshlrev_b32 v241, 16, v45
    v_and_b32 v45, s98, v45
    v_lshlrev_b32 v242, 16, v46
    v_and_b32 v46, s98, v46
    v_lshlrev_b32 v243, 16, v47
    v_and_b32 v47, s98, v47
    v_fmac_f32_dpp v224, v232, v240 row_newbcast:7 row_mask:0xf bank_mask:0xf
    v_fmac_f32_dpp v225, v232, v44 row_newbcast:7 row_mask:0xf bank_mask:0xf
    v_fmac_f32_dpp v226, v232, v241 row_newbcast:7 row_mask:0xf bank_mask:0xf
    v_fmac_f32_dpp v227, v232, v45 row_newbcast:7 row_mask:0xf bank_mask:0xf
    v_fmac_f32_dpp v228, v232, v242 row_newbcast:7 row_mask:0xf bank_mask:0xf
    v_fmac_f32_dpp v229, v232, v46 row_newbcast:7 row_mask:0xf bank_mask:0xf
    v_fmac_f32_dpp v230, v232, v243 row_newbcast:7 row_mask:0xf bank_mask:0xf
    v_fmac_f32_dpp v231, v232, v47 row_newbcast:7 row_mask:0xf bank_mask:0xf
    v_cvt_pk_bf16_f32 v244, v224, v225
    v_cvt_pk_bf16_f32 v245, v226, v227
    v_cvt_pk_bf16_f32 v246, v228, v229
    v_cvt_pk_bf16_f32 v247, v230, v231
    s_lshl_b32 s54, s3, 10
    v_add_u32 v5, s54, v2
    ds_write_b128 v5, v[244:247]
    v_lshrrev_b32 v5, 3, v3
    v_lshlrev_b32 v5, 10, v5
    v_lshl_add_u32 v5, v4, 6, v5
    s_lshl_b32 s54, s3, 8
    v_add_u32 v5, s54, v5
    s_waitcnt lgkmcnt(0)
    s_barrier
    ds_read_b128 v[16:19], v5 offset:0
    ds_read_b128 v[20:23], v5 offset:16
    ds_read_b128 v[24:27], v5 offset:32
    ds_read_b128 v[28:31], v5 offset:48
    ds_read_b128 v[32:35], v5 offset:2048
    ds_read_b128 v[36:39], v5 offset:2064
    ds_read_b128 v[40:43], v5 offset:2080
    ds_read_b128 v[44:47], v5 offset:2096
    s_waitcnt lgkmcnt(0)
    v_perm_b32 v48, v16, v16, v8
    v_perm_b32 v49, v16, v16, v10
    v_perm_b32 v50, v16, v16, v12
    v_perm_b32 v51, v16, v16, v14
    s_nop 1
    v_mfma_f32_16x16x32_bf16 v[224:227], v[48:51], a[0:3], 0
    v_perm_b32 v52, v32, v32, v8
    v_perm_b32 v53, v32, v32, v10
    v_perm_b32 v54, v32, v32, v12
    v_perm_b32 v55, v32, v32, v14
    s_nop 1
    v_mfma_f32_16x16x32_bf16 v[228:231], v[52:55], a[0:3], 0
    v_perm_b32 v56, v16, v16, v9
    v_perm_b32 v57, v16, v16, v11
    v_perm_b32 v58, v16, v16, v13
    v_perm_b32 v59, v16, v16, v15
    s_nop 1
    v_mfma_f32_16x16x32_bf16 v[224:227], v[56:59], a[4:7], v[224:227]
    v_perm_b32 v60, v32, v32, v9
    v_perm_b32 v61, v32, v32, v11
    v_perm_b32 v62, v32, v32, v13
    v_perm_b32 v63, v32, v32, v15
    s_nop 1
    v_mfma_f32_16x16x32_bf16 v[228:231], v[60:63], a[4:7], v[228:231]
    v_perm_b32 v48, v17, v17, v8
    v_perm_b32 v49, v17, v17, v10
    v_perm_b32 v50, v17, v17, v12
    v_perm_b32 v51, v17, v17, v14
    s_nop 1
    v_mfma_f32_16x16x32_bf16 v[224:227], v[48:51], a[8:11], v[224:227]
    v_perm_b32 v52, v33, v33, v8
    v_perm_b32 v53, v33, v33, v10
    v_perm_b32 v54, v33, v33, v12
    v_perm_b32 v55, v33, v33, v14
    s_nop 1
    v_mfma_f32_16x16x32_bf16 v[228:231], v[52:55], a[8:11], v[228:231]
    v_perm_b32 v56, v17, v17, v9
    v_perm_b32 v57, v17, v17, v11
    v_perm_b32 v58, v17, v17, v13
    v_perm_b32 v59, v17, v17, v15
    s_nop 1
    v_mfma_f32_16x16x32_bf16 v[224:227], v[56:59], a[12:15], v[224:227]
    v_perm_b32 v60, v33, v33, v9
    v_perm_b32 v61, v33, v33, v11
    v_perm_b32 v62, v33, v33, v13
    v_perm_b32 v63, v33, v33, v15
    s_nop 1
    v_mfma_f32_16x16x32_bf16 v[228:231], v[60:63], a[12:15], v[228:231]
    v_perm_b32 v48, v18, v18, v8
    v_perm_b32 v49, v18, v18, v10
    v_perm_b32 v50, v18, v18, v12
    v_perm_b32 v51, v18, v18, v14
    s_nop 1
    v_mfma_f32_16x16x32_bf16 v[224:227], v[48:51], a[16:19], v[224:227]
    v_perm_b32 v52, v34, v34, v8
    v_perm_b32 v53, v34, v34, v10
    v_perm_b32 v54, v34, v34, v12
    v_perm_b32 v55, v34, v34, v14
    s_nop 1
    v_mfma_f32_16x16x32_bf16 v[228:231], v[52:55], a[16:19], v[228:231]
    v_perm_b32 v56, v18, v18, v9
    v_perm_b32 v57, v18, v18, v11
    v_perm_b32 v58, v18, v18, v13
    v_perm_b32 v59, v18, v18, v15
    s_nop 1
    v_mfma_f32_16x16x32_bf16 v[224:227], v[56:59], a[20:23], v[224:227]
    v_perm_b32 v60, v34, v34, v9
    v_perm_b32 v61, v34, v34, v11
    v_perm_b32 v62, v34, v34, v13
    v_perm_b32 v63, v34, v34, v15
    s_nop 1
    v_mfma_f32_16x16x32_bf16 v[228:231], v[60:63], a[20:23], v[228:231]
    v_perm_b32 v48, v19, v19, v8
    v_perm_b32 v49, v19, v19, v10
    v_perm_b32 v50, v19, v19, v12
    v_perm_b32 v51, v19, v19, v14
    s_nop 1
    v_mfma_f32_16x16x32_bf16 v[224:227], v[48:51], a[24:27], v[224:227]
    v_perm_b32 v52, v35, v35, v8
    v_perm_b32 v53, v35, v35, v10
    v_perm_b32 v54, v35, v35, v12
    v_perm_b32 v55, v35, v35, v14
    s_nop 1
    v_mfma_f32_16x16x32_bf16 v[228:231], v[52:55], a[24:27], v[228:231]
    v_perm_b32 v56, v19, v19, v9
    v_perm_b32 v57, v19, v19, v11
    v_perm_b32 v58, v19, v19, v13
    v_perm_b32 v59, v19, v19, v15
    s_nop 1
    v_mfma_f32_16x16x32_bf16 v[224:227], v[56:59], a[28:31], v[224:227]
    v_perm_b32 v60, v35, v35, v9
    v_perm_b32 v61, v35, v35, v11
    v_perm_b32 v62, v35, v35, v13
    v_perm_b32 v63, v35, v35, v15
    s_nop 1
    v_mfma_f32_16x16x32_bf16 v[228:231], v[60:63], a[28:31], v[228:231]
    v_perm_b32 v48, v20, v20, v8
    v_perm_b32 v49, v20, v20, v10
    v_perm_b32 v50, v20, v20, v12
    v_perm_b32 v51, v20, v20, v14
    s_nop 1
    v_mfma_f32_16x16x32_bf16 v[224:227], v[48:51], a[32:35], v[224:227]
    v_perm_b32 v52, v36, v36, v8
    v_perm_b32 v53, v36, v36, v10
    v_perm_b32 v54, v36, v36, v12
    v_perm_b32 v55, v36, v36, v14
    s_nop 1
    v_mfma_f32_16x16x32_bf16 v[228:231], v[52:55], a[32:35], v[228:231]
    v_perm_b32 v56, v20, v20, v9
    v_perm_b32 v57, v20, v20, v11
    v_perm_b32 v58, v20, v20, v13
    v_perm_b32 v59, v20, v20, v15
    s_nop 1
    v_mfma_f32_16x16x32_bf16 v[224:227], v[56:59], a[36:39], v[224:227]
    v_perm_b32 v60, v36, v36, v9
    v_perm_b32 v61, v36, v36, v11
    v_perm_b32 v62, v36, v36, v13
    v_perm_b32 v63, v36, v36, v15
    s_nop 1
    v_mfma_f32_16x16x32_bf16 v[228:231], v[60:63], a[36:39], v[228:231]
    v_perm_b32 v48, v21, v21, v8
    v_perm_b32 v49, v21, v21, v10
    v_perm_b32 v50, v21, v21, v12
    v_perm_b32 v51, v21, v21, v14
    s_nop 1
    v_mfma_f32_16x16x32_bf16 v[224:227], v[48:51], a[40:43], v[224:227]
    v_perm_b32 v52, v37, v37, v8
    v_perm_b32 v53, v37, v37, v10
    v_perm_b32 v54, v37, v37, v12
    v_perm_b32 v55, v37, v37, v14
    s_nop 1
    v_mfma_f32_16x16x32_bf16 v[228:231], v[52:55], a[40:43], v[228:231]
    v_perm_b32 v56, v21, v21, v9
    v_perm_b32 v57, v21, v21, v11
    v_perm_b32 v58, v21, v21, v13
    v_perm_b32 v59, v21, v21, v15
    s_nop 1
    v_mfma_f32_16x16x32_bf16 v[224:227], v[56:59], a[44:47], v[224:227]
    v_perm_b32 v60, v37, v37, v9
    v_perm_b32 v61, v37, v37, v11
    v_perm_b32 v62, v37, v37, v13
    v_perm_b32 v63, v37, v37, v15
    s_nop 1
    v_mfma_f32_16x16x32_bf16 v[228:231], v[60:63], a[44:47], v[228:231]
    v_perm_b32 v48, v22, v22, v8
    v_perm_b32 v49, v22, v22, v10
    v_perm_b32 v50, v22, v22, v12
    v_perm_b32 v51, v22, v22, v14
    s_nop 1
    v_mfma_f32_16x16x32_bf16 v[224:227], v[48:51], a[48:51], v[224:227]
    v_perm_b32 v52, v38, v38, v8
    v_perm_b32 v53, v38, v38, v10
    v_perm_b32 v54, v38, v38, v12
    v_perm_b32 v55, v38, v38, v14
    s_nop 1
    v_mfma_f32_16x16x32_bf16 v[228:231], v[52:55], a[48:51], v[228:231]
    v_perm_b32 v56, v22, v22, v9
    v_perm_b32 v57, v22, v22, v11
    v_perm_b32 v58, v22, v22, v13
    v_perm_b32 v59, v22, v22, v15
    s_nop 1
    v_mfma_f32_16x16x32_bf16 v[224:227], v[56:59], a[52:55], v[224:227]
    v_perm_b32 v60, v38, v38, v9
    v_perm_b32 v61, v38, v38, v11
    v_perm_b32 v62, v38, v38, v13
    v_perm_b32 v63, v38, v38, v15
    s_nop 1
    v_mfma_f32_16x16x32_bf16 v[228:231], v[60:63], a[52:55], v[228:231]
    v_perm_b32 v48, v23, v23, v8
    v_perm_b32 v49, v23, v23, v10
    v_perm_b32 v50, v23, v23, v12
    v_perm_b32 v51, v23, v23, v14
    s_nop 1
    v_mfma_f32_16x16x32_bf16 v[224:227], v[48:51], a[56:59], v[224:227]
    v_perm_b32 v52, v39, v39, v8
    v_perm_b32 v53, v39, v39, v10
    v_perm_b32 v54, v39, v39, v12
    v_perm_b32 v55, v39, v39, v14
    s_nop 1
    v_mfma_f32_16x16x32_bf16 v[228:231], v[52:55], a[56:59], v[228:231]
    v_perm_b32 v56, v23, v23, v9
    v_perm_b32 v57, v23, v23, v11
    v_perm_b32 v58, v23, v23, v13
    v_perm_b32 v59, v23, v23, v15
    s_nop 1
    v_mfma_f32_16x16x32_bf16 v[224:227], v[56:59], a[60:63], v[224:227]
    v_perm_b32 v60, v39, v39, v9
    v_perm_b32 v61, v39, v39, v11
    v_perm_b32 v62, v39, v39, v13
    v_perm_b32 v63, v39, v39, v15
    s_nop 1
    v_mfma_f32_16x16x32_bf16 v[228:231], v[60:63], a[60:63], v[228:231]
    v_perm_b32 v48, v24, v24, v8
    v_perm_b32 v49, v24, v24, v10
    v_perm_b32 v50, v24, v24, v12
    v_perm_b32 v51, v24, v24, v14
    s_nop 1
    v_mfma_f32_16x16x32_bf16 v[224:227], v[48:51], a[64:67], v[224:227]
    v_perm_b32 v52, v40, v40, v8
    v_perm_b32 v53, v40, v40, v10
    v_perm_b32 v54, v40, v40, v12
    v_perm_b32 v55, v40, v40, v14
    s_nop 1
    v_mfma_f32_16x16x32_bf16 v[228:231], v[52:55], a[64:67], v[228:231]
    v_perm_b32 v56, v24, v24, v9
    v_perm_b32 v57, v24, v24, v11
    v_perm_b32 v58, v24, v24, v13
    v_perm_b32 v59, v24, v24, v15
    s_nop 1
    v_mfma_f32_16x16x32_bf16 v[224:227], v[56:59], a[68:71], v[224:227]
    v_perm_b32 v60, v40, v40, v9
    v_perm_b32 v61, v40, v40, v11
    v_perm_b32 v62, v40, v40, v13
    v_perm_b32 v63, v40, v40, v15
    s_nop 1
    v_mfma_f32_16x16x32_bf16 v[228:231], v[60:63], a[68:71], v[228:231]
    v_perm_b32 v48, v25, v25, v8
    v_perm_b32 v49, v25, v25, v10
    v_perm_b32 v50, v25, v25, v12
    v_perm_b32 v51, v25, v25, v14
    s_nop 1
    v_mfma_f32_16x16x32_bf16 v[224:227], v[48:51], a[72:75], v[224:227]
    v_perm_b32 v52, v41, v41, v8
    v_perm_b32 v53, v41, v41, v10
    v_perm_b32 v54, v41, v41, v12
    v_perm_b32 v55, v41, v41, v14
    s_nop 1
    v_mfma_f32_16x16x32_bf16 v[228:231], v[52:55], a[72:75], v[228:231]
    v_perm_b32 v56, v25, v25, v9
    v_perm_b32 v57, v25, v25, v11
    v_perm_b32 v58, v25, v25, v13
    v_perm_b32 v59, v25, v25, v15
    s_nop 1
    v_mfma_f32_16x16x32_bf16 v[224:227], v[56:59], a[76:79], v[224:227]
    v_perm_b32 v60, v41, v41, v9
    v_perm_b32 v61, v41, v41, v11
    v_perm_b32 v62, v41, v41, v13
    v_perm_b32 v63, v41, v41, v15
    s_nop 1
    v_mfma_f32_16x16x32_bf16 v[228:231], v[60:63], a[76:79], v[228:231]
    v_perm_b32 v48, v26, v26, v8
    v_perm_b32 v49, v26, v26, v10
    v_perm_b32 v50, v26, v26, v12
    v_perm_b32 v51, v26, v26, v14
    s_nop 1
    v_mfma_f32_16x16x32_bf16 v[224:227], v[48:51], a[80:83], v[224:227]
    v_perm_b32 v52, v42, v42, v8
    v_perm_b32 v53, v42, v42, v10
    v_perm_b32 v54, v42, v42, v12
    v_perm_b32 v55, v42, v42, v14
    s_nop 1
    v_mfma_f32_16x16x32_bf16 v[228:231], v[52:55], a[80:83], v[228:231]
    v_perm_b32 v56, v26, v26, v9
    v_perm_b32 v57, v26, v26, v11
    v_perm_b32 v58, v26, v26, v13
    v_perm_b32 v59, v26, v26, v15
    s_nop 1
    v_mfma_f32_16x16x32_bf16 v[224:227], v[56:59], a[84:87], v[224:227]
    v_perm_b32 v60, v42, v42, v9
    v_perm_b32 v61, v42, v42, v11
    v_perm_b32 v62, v42, v42, v13
    v_perm_b32 v63, v42, v42, v15
    s_nop 1
    v_mfma_f32_16x16x32_bf16 v[228:231], v[60:63], a[84:87], v[228:231]
    v_perm_b32 v48, v27, v27, v8
    v_perm_b32 v49, v27, v27, v10
    v_perm_b32 v50, v27, v27, v12
    v_perm_b32 v51, v27, v27, v14
    s_nop 1
    v_mfma_f32_16x16x32_bf16 v[224:227], v[48:51], a[88:91], v[224:227]
    v_perm_b32 v52, v43, v43, v8
    v_perm_b32 v53, v43, v43, v10
    v_perm_b32 v54, v43, v43, v12
    v_perm_b32 v55, v43, v43, v14
    s_nop 1
    v_mfma_f32_16x16x32_bf16 v[228:231], v[52:55], a[88:91], v[228:231]
    v_perm_b32 v56, v27, v27, v9
    v_perm_b32 v57, v27, v27, v11
    v_perm_b32 v58, v27, v27, v13
    v_perm_b32 v59, v27, v27, v15
    s_nop 1
    v_mfma_f32_16x16x32_bf16 v[224:227], v[56:59], a[92:95], v[224:227]
    v_perm_b32 v60, v43, v43, v9
    v_perm_b32 v61, v43, v43, v11
    v_perm_b32 v62, v43, v43, v13
    v_perm_b32 v63, v43, v43, v15
    s_nop 1
    v_mfma_f32_16x16x32_bf16 v[228:231], v[60:63], a[92:95], v[228:231]
    v_perm_b32 v48, v28, v28, v8
    v_perm_b32 v49, v28, v28, v10
    v_perm_b32 v50, v28, v28, v12
    v_perm_b32 v51, v28, v28, v14
    s_nop 1
    v_mfma_f32_16x16x32_bf16 v[224:227], v[48:51], a[96:99], v[224:227]
    v_perm_b32 v52, v44, v44, v8
    v_perm_b32 v53, v44, v44, v10
    v_perm_b32 v54, v44, v44, v12
    v_perm_b32 v55, v44, v44, v14
    s_nop 1
    v_mfma_f32_16x16x32_bf16 v[228:231], v[52:55], a[96:99], v[228:231]
    v_perm_b32 v56, v28, v28, v9
    v_perm_b32 v57, v28, v28, v11
    v_perm_b32 v58, v28, v28, v13
    v_perm_b32 v59, v28, v28, v15
    s_nop 1
    v_mfma_f32_16x16x32_bf16 v[224:227], v[56:59], a[100:103], v[224:227]
    v_perm_b32 v60, v44, v44, v9
    v_perm_b32 v61, v44, v44, v11
    v_perm_b32 v62, v44, v44, v13
    v_perm_b32 v63, v44, v44, v15
    s_nop 1
    v_mfma_f32_16x16x32_bf16 v[228:231], v[60:63], a[100:103], v[228:231]
    v_perm_b32 v48, v29, v29, v8
    v_perm_b32 v49, v29, v29, v10
    v_perm_b32 v50, v29, v29, v12
    v_perm_b32 v51, v29, v29, v14
    s_nop 1
    v_mfma_f32_16x16x32_bf16 v[224:227], v[48:51], a[104:107], v[224:227]
    v_perm_b32 v52, v45, v45, v8
    v_perm_b32 v53, v45, v45, v10
    v_perm_b32 v54, v45, v45, v12
    v_perm_b32 v55, v45, v45, v14
    s_nop 1
    v_mfma_f32_16x16x32_bf16 v[228:231], v[52:55], a[104:107], v[228:231]
    v_perm_b32 v56, v29, v29, v9
    v_perm_b32 v57, v29, v29, v11
    v_perm_b32 v58, v29, v29, v13
    v_perm_b32 v59, v29, v29, v15
    s_nop 1
    v_mfma_f32_16x16x32_bf16 v[224:227], v[56:59], a[108:111], v[224:227]
    v_perm_b32 v60, v45, v45, v9
    v_perm_b32 v61, v45, v45, v11
    v_perm_b32 v62, v45, v45, v13
    v_perm_b32 v63, v45, v45, v15
    s_nop 1
    v_mfma_f32_16x16x32_bf16 v[228:231], v[60:63], a[108:111], v[228:231]
    v_perm_b32 v48, v30, v30, v8
    v_perm_b32 v49, v30, v30, v10
    v_perm_b32 v50, v30, v30, v12
    v_perm_b32 v51, v30, v30, v14
    s_nop 1
    v_mfma_f32_16x16x32_bf16 v[224:227], v[48:51], a[112:115], v[224:227]
    v_perm_b32 v52, v46, v46, v8
    v_perm_b32 v53, v46, v46, v10
    v_perm_b32 v54, v46, v46, v12
    v_perm_b32 v55, v46, v46, v14
    s_nop 1
    v_mfma_f32_16x16x32_bf16 v[228:231], v[52:55], a[112:115], v[228:231]
    v_perm_b32 v56, v30, v30, v9
    v_perm_b32 v57, v30, v30, v11
    v_perm_b32 v58, v30, v30, v13
    v_perm_b32 v59, v30, v30, v15
    s_nop 1
    v_mfma_f32_16x16x32_bf16 v[224:227], v[56:59], a[116:119], v[224:227]
    v_perm_b32 v60, v46, v46, v9
    v_perm_b32 v61, v46, v46, v11
    v_perm_b32 v62, v46, v46, v13
    v_perm_b32 v63, v46, v46, v15
    s_nop 1
    v_mfma_f32_16x16x32_bf16 v[228:231], v[60:63], a[116:119], v[228:231]
    v_perm_b32 v48, v31, v31, v8
    v_perm_b32 v49, v31, v31, v10
    v_perm_b32 v50, v31, v31, v12
    v_perm_b32 v51, v31, v31, v14
    s_nop 1
    v_mfma_f32_16x16x32_bf16 v[224:227], v[48:51], a[120:123], v[224:227]
    v_perm_b32 v52, v47, v47, v8
    v_perm_b32 v53, v47, v47, v10
    v_perm_b32 v54, v47, v47, v12
    v_perm_b32 v55, v47, v47, v14
    s_nop 1
    v_mfma_f32_16x16x32_bf16 v[228:231], v[52:55], a[120:123], v[228:231]
    v_perm_b32 v56, v31, v31, v9
    v_perm_b32 v57, v31, v31, v11
    v_perm_b32 v58, v31, v31, v13
    v_perm_b32 v59, v31, v31, v15
    s_nop 1
    v_mfma_f32_16x16x32_bf16 v[224:227], v[56:59], a[124:127], v[224:227]
    v_perm_b32 v60, v47, v47, v9
    v_perm_b32 v61, v47, v47, v11
    v_perm_b32 v62, v47, v47, v13
    v_perm_b32 v63, v47, v47, v15
    s_nop 1
    v_mfma_f32_16x16x32_bf16 v[228:231], v[60:63], a[124:127], v[228:231]
    v_lshrrev_b32 v5, 1, v4
    v_lshlrev_b32 v5, 9, v5
    v_lshl_add_u32 v5, v3, 5, v5
    v_and_b32 v6, 1, v4
    v_lshl_add_u32 v5, v6, 4, v5
    s_lshl_b32 s54, s3, 11
    s_add_u32 s54, s54, 131072
    v_add_u32 v5, s54, v5
    ds_write_b128 v5, v[224:227]
    ds_write_b128 v5, v[228:231] offset:1024
    s_waitcnt lgkmcnt(0)
    s_barrier
    v_lshrrev_b32 v5, 2, v3
    v_lshlrev_b32 v5, 9, v5
    v_lshl_add_u32 v5, v4, 5, v5
    s_lshl_b32 s54, s3, 7
    s_add_u32 s54, s54, 131072
    v_add_u32 v5, s54, v5
    ds_read_b128 v[16:19], v5 offset:0
    ds_read_b128 v[20:23], v5 offset:16
    ds_read_b128 v[24:27], v5 offset:2048
    ds_read_b128 v[28:31], v5 offset:2064
    ds_read_b128 v[32:35], v5 offset:4096
    ds_read_b128 v[36:39], v5 offset:4112
    ds_read_b128 v[40:43], v5 offset:6144
    ds_read_b128 v[44:47], v5 offset:6160
    s_waitcnt lgkmcnt(0)
    v_add_f32 v16, v16, v24
    v_add_f32 v32, v32, v40
    v_add_f32 v17, v17, v25
    v_add_f32 v33, v33, v41
    v_add_f32 v18, v18, v26
    v_add_f32 v34, v34, v42
    v_add_f32 v19, v19, v27
    v_add_f32 v35, v35, v43
    v_add_f32 v20, v20, v28
    v_add_f32 v36, v36, v44
    v_add_f32 v21, v21, v29
    v_add_f32 v37, v37, v45
    v_add_f32 v22, v22, v30
    v_add_f32 v38, v38, v46
    v_add_f32 v23, v23, v31
    v_add_f32 v39, v39, v47
    v_add_f32 v16, v16, v32
    v_add_f32 v17, v17, v33
    v_add_f32 v18, v18, v34
    v_add_f32 v19, v19, v35
    v_add_f32 v20, v20, v36
    v_add_f32 v21, v21, v37
    v_add_f32 v22, v22, v38
    v_add_f32 v23, v23, v39
    v_cvt_pk_bf16_f32 v64, v16, v17
    v_cvt_pk_bf16_f32 v65, v18, v19
    v_cvt_pk_bf16_f32 v66, v20, v21
    v_cvt_pk_bf16_f32 v67, v22, v23
    v_min_u32 v64, -2, v64
    v_min_u32 v65, -2, v65
    v_min_u32 v66, -2, v66
    v_min_u32 v67, -2, v67
    v_bfe_u32 v6, v1, 2, 2
    v_lshlrev_b32 v6, 6, v6
    v_and_b32 v5, 48, v1
    v_add_u32 v6, v6, v5
    v_and_b32 v5, 3, v1
    v_lshl_add_u32 v6, v5, 29, v6
    s_lshl_b32 s54, s52, 10
    s_lshl_b32 s55, s3, 8
    s_add_u32 s54, s54, s55
    s_add_u32 s54, s54, 5439488
    buffer_store_dwordx4 v[64:67], v6, s[44:47], s54 offen sc1
    s_mov_b32 s48, s26
    s_mov_b32 s49, s27
    s_mov_b32 s50, 9216
    s_mov_b32 s51, 0x20000
    s_lshl_b32 s54, s3, 5
    s_add_u32 s54, s54, s53
    s_cmp_ge_u32 s54, 72
    s_cbranch_scc1 L_nored_28
    v_mov_b32 v48, -1
    v_mov_b32 v49, -1
    v_mov_b32 v50, -1
    v_mov_b32 v51, -1
    v_mov_b32 v52, -1
    v_mov_b32 v53, -1
    v_mov_b32 v54, -1
    v_mov_b32 v55, -1
    v_mov_b32 v56, -1
    v_mov_b32 v57, -1
    v_mov_b32 v58, -1
    v_mov_b32 v59, -1
    v_mov_b32 v60, -1
    v_mov_b32 v61, -1
    v_mov_b32 v62, -1
    v_mov_b32 v63, -1
    s_lshl_b32 s55, s54, 12
    s_add_u32 s55, s55, 4718592
    s_mul_hi_u32 s56, s54, 238609295
    s_add_u32 s56, s56, 1
    s_mul_i32 s56, s56, 1152
    s_lshl_b32 s57, s54, 6
    s_add_u32 s56, s56, s57
    v_lshlrev_b32 v5, 3, v3
    v_lshl_add_u32 v5, v4, 1, v5
    v_mov_b32 v6, 0x4000
    v_cmp_gt_u32 vcc, 8, v3
    s_nop 1
    v_cndmask_b32 v5, v6, v5, vcc
    s_mov_b64 s[4:5], -1
    s_mov_b64 s[6:7], -1
    s_mov_b64 s[8:9], -1
    s_mov_b64 s[10:11], -1
L_mpoll_29:
    s_mov_b64 exec, s[4:5]
    buffer_load_dwordx4 v[48:51], v2, s[44:47], s55 offen offset:0 sc1
    s_mov_b64 exec, s[6:7]
    buffer_load_dwordx4 v[52:55], v2, s[44:47], s55 offen offset:1024 sc1
    s_mov_b64 exec, s[8:9]
    buffer_load_dwordx4 v[56:59], v2, s[44:47], s55 offen offset:2048 sc1
    s_mov_b64 exec, s[10:11]
    buffer_load_dwordx4 v[60:63], v2, s[44:47], s55 offen offset:3072 sc1
    s_mov_b64 exec, -1
    s_waitcnt vmcnt(4)
    v_max3_u32 v32, v48, v49, v50
    v_max3_u32 v33, v52, v53, v54
    v_max3_u32 v34, v56, v57, v58
    v_max3_u32 v35, v60, v61, v62
    v_max_u32 v32, v32, v51
    v_max_u32 v33, v33, v55
    v_max_u32 v34, v34, v59
    v_max_u32 v35, v35, v63
    v_cmp_eq_u32 s[4:5], -1, v32
    v_cmp_eq_u32 s[6:7], -1, v33
    v_cmp_eq_u32 s[8:9], -1, v34
    v_cmp_eq_u32 s[10:11], -1, v35
    s_or_b64 vcc, s[4:5], s[6:7]
    s_or_b64 vcc, vcc, s[8:9]
    s_or_b64 vcc, vcc, s[10:11]
    s_cbranch_scc0 L_mpollok_30
    s_and_b64 vcc, s[4:5], s[6:7]
    s_and_b64 vcc, vcc, s[8:9]
    s_and_b64 vcc, vcc, s[10:11]
    s_cmp_eq_u64 vcc, -1
    s_cbranch_scc0 L_mpoll_29_b
    s_sleep 4
L_mpoll_29_b:
    s_sub_u32 s101, s101, 1
    s_cbranch_scc0 L_mpoll_29
    s_mov_b32 s101, 0
L_mpollok_30:
    v_add_f32 v16, v48, v52
    v_add_f32 v24, v56, v60
    v_add_f32 v18, v50, v54
    v_add_f32 v26, v58, v62
    v_add_f32 v17, v49, v53
    v_add_f32 v25, v57, v61
    v_add_f32 v19, v51, v55
    v_add_f32 v27, v59, v63
    v_add_f32 v16, v16, v24
    v_add_f32 v18, v18, v26
    v_add_f32 v17, v17, v25
    v_add_f32 v19, v19, v27
    v_permlane32_swap_b32 v16, v18
    s_nop 0
    v_permlane32_swap_b32 v17, v19
    v_add_f32 v16, v16, v18
    v_add_f32 v17, v17, v19
    s_nop 1
    v_permlane16_swap_b32 v16, v17
    v_add_f32 v16, v16, v17
    s_nop 1
    v_add_f32_dpp v16, v16, v16 row_ror:8 row_mask:0xf bank_mask:0xf
    v_cvt_pk_bf16_f32 v16, v16, v16
    buffer_store_short v16, v5, s[48:51], s56 offen
L_nored_28:
    s_endpgm
L_roleH_end:
L_roleC:
    s_mov_b32 s101, 100000
    s_getpc_b64 s[56:57]
L_pc_31:
    s_sub_u32 s56, s56, L_pc_31-L_roleC
    s_subb_u32 s57, s57, 0
    v_lshlrev_b32 v5, 7, v0
    v_min_u32 v6, L_roleC_end-L_roleC-4, v5
    global_load_dword v122, v6, s[56:57]
    v_add_u32 v5, 32768, v5
    v_min_u32 v6, L_roleC_end-L_roleC-4, v5
    global_load_dword v122, v6, s[56:57]
    v_mov_b32 v20, -1
    v_mov_b32 v21, -1
    v_mov_b32 v22, -1
    v_mov_b32 v23, -1
    v_mul_u32_u24 v7, 73728, v4
    v_lshrrev_b32 v5, 3, v3
    v_lshl_add_u32 v6, v5, 13, v7
    v_and_b32 v5, 7, v3
    v_lshl_add_u32 v6, v5, 4, v6
    v_lshl_add_u32 v7, v3, 3, v7
    v_add_u32 v7, 65536, v7
    s_lshl_b32 s56, s52, 7
    s_add_u32 s56, s56, 4194304
    s_lshl_b32 s54, s3, 14
    s_add_u32 s54, s54, s56
    s_add_u32 s55, s54, 4096
    s_and_b32 s57, s3, 1
    s_lshl_b32 s57, s57, 12
    s_add_u32 s56, s56, s57
    s_waitcnt lgkmcnt(0)
    s_mov_b32 s44, s30
    s_mov_b32 s45, s31
    s_mov_b32 s46, 536870912
    s_mov_b32 s47, 0x20000
    buffer_store_dwordx4 v[20:23], v6, s[44:47], s54 offen sc1
    buffer_store_dwordx4 v[20:23], v6, s[44:47], s55 offen sc1
    buffer_store_dwordx2 v[20:21], v7, s[44:47], s56 offen sc1
    v_mov_b32 v7, 536870912
    v_cmp_gt_u32 vcc, 16, v1
    s_nop 1
    v_cndmask_b32 v123, v7, v2, vcc
    s_lshl_b32 s98, s52, 10
    s_lshl_b32 s54, s3, 8
    s_add_u32 s98, s98, s54
    s_add_u32 s98, s98, 5242880
    buffer_store_dwordx4 v[20:23], v123, s[44:47], s98 offen sc1
    s_lshl_b32 s58, s52, 2
    s_add_u32 s58, s58, s3
    s_lshl_b32 s58, s58, 13
    s_add_u32 s58, s58, 8388608
    s_add_u32 s59, s58, 4096
    v_min_u32 v6, 1, v3
    v_lshl_add_u32 v6, v6, 2, v4
    v_lshlrev_b32 v6, 4, v6
    s_lshr_b32 s55, s52, 2
    s_add_u32 s55, s55, s3
    s_and_b32 s55, s55, 3
    s_and_b32 s54, s52, 3
    s_cmp_eq_u32 s54, s55
    s_mov_b32 s56, 255
    s_cselect_b32 s56, 16777215, s56
    s_mov_b32 s57, 0
    s_cbranch_scc0 L_cclr
    buffer_store_dwordx4 v[20:23], v2, s[44:47], s58 offen offset:2048 sc1
    buffer_store_dwordx4 v[20:23], v2, s[44:47], s58 offen offset:3072 sc1
    buffer_store_dwordx4 v[20:23], v2, s[44:47], s59 offen offset:0 sc1
    buffer_store_dwordx4 v[20:23], v2, s[44:47], s59 offen offset:1024 sc1
    s_and_b32 s55, s52, 28
    s_add_u32 s55, s55, s3
    s_mul_i32 s55, s55, 256
    s_add_u32 s55, s55, 16777216
    v_mov_b32 v5, 0
    s_mov_b64 exec, 1
    buffer_store_dword v5, v5, s[44:47], s55 offen sc1
    s_lshl_b32 s55, s53, 8
    s_add_u32 s55, s55, 3145728
    s_mov_b64 exec, 0xffff
    buffer_store_dwordx4 v[20:23], v2, s[44:47], s55 offen sc1
    s_mov_b64 exec, -1
L_cclr:
    buffer_store_dwordx4 v[20:23], v2, s[44:47], s58 offen offset:0 sc1
    buffer_store_dwordx4 v[20:23], v2, s[44:47], s58 offen offset:1024 sc1
    s_mov_b64 exec, s[56:57]
    buffer_store_dwordx4 v[20:23], v2, s[44:47], s59 offen offset:2048 sc1
    s_mov_b64 exec, -1
    s_mov_b32 s40, s10
    s_mov_b32 s41, s11
    s_mov_b32 s42, 4718592
    s_mov_b32 s43, 0x20000
    s_mov_b32 s48, s4
    s_mov_b32 s49, s5
    s_mov_b32 s50, 4608
    s_mov_b32 s51, 0x20000
    s_mov_b32 s32, s16
    s_mov_b32 s33, s17
    s_mov_b32 s34, 16777216
    s_mov_b32 s35, 0x20000
    v_lshrrev_b32 v5, 3, v3
    v_mul_u32_u24 v5, 1152, v5
    v_mul_u32_u24 v6, 72, v4
    v_add_u32 v5, v5, v6
    s_mul_i32 s54, s3, 288
    buffer_load_dwordx4 v[48:51], v5, s[48:51], s54 offen offset:0
    buffer_load_dwordx4 v[52:55], v5, s[48:51], s54 offen offset:16
    buffer_load_dwordx4 v[56:59], v5, s[48:51], s54 offen offset:32
    buffer_load_dwordx4 v[60:63], v5, s[48:51], s54 offen offset:48
    buffer_load_dwordx2 v[64:65], v5, s[48:51], s54 offen offset:64
    buffer_load_dwordx4 v[68:71], v5, s[48:51], s54 offen offset:2304
    buffer_load_dwordx4 v[72:75], v5, s[48:51], s54 offen offset:2320
    buffer_load_dwordx4 v[76:79], v5, s[48:51], s54 offen offset:2336
    buffer_load_dwordx4 v[80:83], v5, s[48:51], s54 offen offset:2352
    buffer_load_dwordx2 v[84:85], v5, s[48:51], s54 offen offset:2368
    v_mul_u32_u24 v120, 294912, v4
    v_lshl_add_u32 v120, v3, 4, v120
    s_mul_i32 s61, s3, 1179648
    s_lshl_b32 s54, s52, 8
    s_add_u32 s61, s61, s54
    buffer_load_dwordx4 a[0:3], v120, s[40:43], s61 offen nt
    s_add_u32 s61, s61, 8192
    buffer_load_dwordx4 a[4:7], v120, s[40:43], s61 offen nt
    s_add_u32 s61, s61, 8192
    buffer_load_dwordx4 a[8:11], v120, s[40:43], s61 offen nt
    s_add_u32 s61, s61, 8192
    buffer_load_dwordx4 a[12:15], v120, s[40:43], s61 offen nt
    s_add_u32 s61, s61, 8192
    buffer_load_dwordx4 a[16:19], v120, s[40:43], s61 offen nt
    s_add_u32 s61, s61, 8192
    buffer_load_dwordx4 a[20:23], v120, s[40:43], s61 offen nt
    s_add_u32 s61, s61, 8192
    buffer_load_dwordx4 a[24:27], v120, s[40:43], s61 offen nt
    s_add_u32 s61, s61, 8192
    buffer_load_dwordx4 a[28:31], v120, s[40:43], s61 offen nt
    s_add_u32 s61, s61, 8192
    buffer_load_dwordx4 a[32:35], v120, s[40:43], s61 offen nt
    s_add_u32 s61, s61, 8192
    s_cmp_lg_u32 s3, 0
    s_cbranch_scc1 L_norace_32
    s_sub_u32 s84, s52, 1
    s_lshl_b32 s84, s84, 11
    s_lshl_b32 s85, s52, 12
    s_xor_b32 s84, s84, s85
    s_lshl_b32 s85, s52, 10
    s_xor_b32 s84, s84, s85
    s_and_b32 s84, s84, 0x2000
    s_lshr_b32 s85, s52, 2
    s_xor_b32 s85, s85, s52
    s_and_b32 s85, s85, 3
    s_lshl_b32 s85, s85, 25
    s_or_b32 s84, s84, s85
    s_lshl_b32 s85, s52, 20
    s_or_b32 s84, s84, s85
    s_xor_b32 s85, s84, 0x2000
    s_mov_b32 s86, -1
    s_mov_b32 s87, -1
    s_load_dword s87, s[8:9], s85 offset:0x80500
    s_load_dword s86, s[8:9], s84 offset:0x80000
    s_mov_b32 s97, 1
    s_waitcnt lgkmcnt(1)
    s_cmp_lg_u32 s87, -1
    s_subb_u32 s97, s97, 0
    s_cmp_lg_u32 s86, -1
    s_addc_u32 s97, s97, 0
    s_sub_u32 s96, 2, s97
    s_bitcmp1_b32 s52, 3
    s_cselect_b32 s97, s96, s97
    s_lshl_b32 s97, s97, 12
    s_or_b32 s97, s97, 0x1000000
L_norace_32:
    s_waitcnt vmcnt(19)
    s_barrier
    s_cmp_lg_u32 s3, 0
    s_cbranch_scc1 L_nosig_33
    s_atomic_add s97, s[28:29], 0 glc
L_nosig_33:
    buffer_load_dwordx4 a[36:39], v120, s[40:43], s61 offen nt
    s_add_u32 s61, s61, 8192
    buffer_load_dwordx4 a[40:43], v120, s[40:43], s61 offen nt
    s_add_u32 s61, s61, 8192
    buffer_load_dwordx4 a[44:47], v120, s[40:43], s61 offen nt
    s_add_u32 s61, s61, 8192
    buffer_load_dwordx4 a[48:51], v120, s[40:43], s61 offen nt
    s_add_u32 s61, s61, 8192
    buffer_load_dwordx4 a[52:55], v120, s[40:43], s61 offen nt
    s_add_u32 s61, s61, 8192
    buffer_load_dwordx4 a[56:59], v120, s[40:43], s61 offen nt
    s_add_u32 s61, s61, 8192
    buffer_load_dwordx4 a[60:63], v120, s[40:43], s61 offen nt
    s_add_u32 s61, s61, 8192
    buffer_load_dwordx4 a[64:67], v120, s[40:43], s61 offen nt
    s_add_u32 s61, s61, 8192
    buffer_load_dwordx4 a[68:71], v120, s[40:43], s61 offen nt
    s_add_u32 s61, s61, 8192
    buffer_load_dwordx4 a[72:75], v120, s[40:43], s61 offen nt
    s_add_u32 s61, s61, 8192
    buffer_load_dwordx4 a[76:79], v120, s[40:43], s61 offen nt
    s_add_u32 s61, s61, 8192
    buffer_load_dwordx4 a[80:83], v120, s[40:43], s61 offen nt
    s_add_u32 s61, s61, 8192
    buffer_load_dwordx4 a[84:87], v120, s[40:43], s61 offen nt
    s_add_u32 s61, s61, 8192
    buffer_load_dwordx4 a[88:91], v120, s[40:43], s61 offen nt
    s_add_u32 s61, s61, 8192
    buffer_load_dwordx4 a[92:95], v120, s[40:43], s61 offen nt
    s_add_u32 s61, s61, 8192
    buffer_load_dwordx4 a[96:99], v120, s[40:43], s61 offen nt
    s_add_u32 s61, s61, 8192
    buffer_load_dwordx4 a[100:103], v120, s[40:43], s61 offen nt
    s_add_u32 s61, s61, 8192
    buffer_load_dwordx4 a[104:107], v120, s[40:43], s61 offen nt
    s_add_u32 s61, s61, 8192
    buffer_load_dwordx4 a[108:111], v120, s[40:43], s61 offen nt
    s_add_u32 s61, s61, 8192
    buffer_load_dwordx4 a[112:115], v120, s[40:43], s61 offen nt
    s_add_u32 s61, s61, 8192
    buffer_load_dwordx4 a[116:119], v120, s[40:43], s61 offen nt
    s_add_u32 s61, s61, 8192
    buffer_load_dwordx4 a[120:123], v120, s[40:43], s61 offen nt
    s_add_u32 s61, s61, 8192
    buffer_load_dwordx4 a[124:127], v120, s[40:43], s61 offen nt
    s_add_u32 s61, s61, 8192
    buffer_load_dwordx4 a[128:131], v120, s[40:43], s61 offen nt
    s_add_u32 s61, s61, 8192
    buffer_load_dwordx4 a[132:135], v120, s[40:43], s61 offen nt
    s_add_u32 s61, s61, 8192
    buffer_load_dwordx4 a[136:139], v120, s[40:43], s61 offen nt
    s_add_u32 s61, s61, 8192
    buffer_load_dwordx4 a[140:143], v120, s[40:43], s61 offen nt
    s_add_u32 s61, s61, 8192
    v_and_b32 v5, 1, v3
    v_cmp_eq_u32 vcc, 1, v5
    v_mov_b32 v5, 0x0c0c0100
    v_mov_b32 v6, 0x01000c0c
    v_cndmask_b32 v5, v5, v6, vcc
    v_mov_b32 v6, 0x0c0c0302
    v_mov_b32 v7, 0x03020c0c
    v_cndmask_b32 v6, v6, v7, vcc
    v_bfe_u32 v7, v3, 1, 2
    v_mov_b32 v16, 0x0c0c0c0c
    v_cmp_eq_u32 vcc, 0, v7
    s_nop 1
    v_cndmask_b32 v8, v16, v5, vcc
    v_cndmask_b32 v9, v16, v6, vcc
    v_cmp_eq_u32 vcc, 1, v7
    s_nop 1
    v_cndmask_b32 v10, v16, v5, vcc
    v_cndmask_b32 v11, v16, v6, vcc
    v_cmp_eq_u32 vcc, 2, v7
    s_nop 1
    v_cndmask_b32 v12, v16, v5, vcc
    v_cndmask_b32 v13, v16, v6, vcc
    v_cmp_eq_u32 vcc, 3, v7
    s_nop 1
    v_cndmask_b32 v14, v16, v5, vcc
    v_cndmask_b32 v15, v16, v6, vcc
    v_lshlrev_b32 v5, 2, v4
    v_xor_b32 v5, v5, v3
    v_lshlrev_b32 v6, 10, v4
    v_xor_b32 v7, 0, v5
    v_lshl_add_u32 v20, v7, 4, v6
    v_xor_b32 v7, 1, v5
    v_lshl_add_u32 v21, v7, 4, v6
    v_add_u32 v21, 4096, v21
    v_xor_b32 v7, 2, v5
    v_lshl_add_u32 v22, v7, 4, v6
    v_add_u32 v22, 8192, v22
    v_xor_b32 v7, 3, v5
    v_lshl_add_u32 v23, v7, 4, v6
    v_add_u32 v23, 12288, v23
    s_lshl_b32 s58, s53, 19
    s_lshl_b32 s54, s3, 8
    s_add_u32 s58, s58, s54
    s_lshl_b32 s63, s3, 15
    s_mov_b32 s59, s63
    s_add_u32 m0, s59, 0
    s_add_u32 s54, s58, 0
    buffer_load_dwordx4 v20, s[32:35], s54 offen nt lds
    s_add_u32 m0, s59, 1024
    s_add_u32 s54, s58, 0
    buffer_load_dwordx4 v21, s[32:35], s54 offen nt lds
    s_add_u32 m0, s59, 2048
    s_add_u32 s54, s58, 0
    buffer_load_dwordx4 v22, s[32:35], s54 offen nt lds
    s_add_u32 m0, s59, 3072
    s_add_u32 s54, s58, 0
    buffer_load_dwordx4 v23, s[32:35], s54 offen nt lds
    s_add_u32 m0, s59, 4096
    s_add_u32 s54, s58, 16384
    buffer_load_dwordx4 v20, s[32:35], s54 offen nt lds
    s_add_u32 m0, s59, 5120
    s_add_u32 s54, s58, 16384
    buffer_load_dwordx4 v21, s[32:35], s54 offen nt lds
    s_add_u32 m0, s59, 6144
    s_add_u32 s54, s58, 16384
    buffer_load_dwordx4 v22, s[32:35], s54 offen nt lds
    s_add_u32 m0, s59, 7168
    s_add_u32 s54, s58, 16384
    buffer_load_dwordx4 v23, s[32:35], s54 offen nt lds
    s_add_u32 s58, s58, 32768
    s_add_u32 s59, s59, 8192
    s_waitcnt vmcnt(35)
    v_perm_b32 v96, v48, v48, v8
    v_perm_b32 v97, v48, v48, v10
    v_perm_b32 v98, v48, v48, v12
    v_perm_b32 v99, v48, v48, v14
    s_nop 1
    v_mfma_f32_16x16x32_bf16 v[112:115], v[96:99], a[0:3], 0
    v_perm_b32 v100, v68, v68, v8
    v_perm_b32 v101, v68, v68, v10
    v_perm_b32 v102, v68, v68, v12
    v_perm_b32 v103, v68, v68, v14
    s_nop 1
    v_mfma_f32_16x16x32_bf16 v[116:119], v[100:103], a[0:3], 0
    v_perm_b32 v104, v48, v48, v9
    v_perm_b32 v105, v48, v48, v11
    v_perm_b32 v106, v48, v48, v13
    v_perm_b32 v107, v48, v48, v15
    s_nop 1
    v_mfma_f32_16x16x32_bf16 v[112:115], v[104:107], a[4:7], v[112:115]
    v_perm_b32 v108, v68, v68, v9
    v_perm_b32 v109, v68, v68, v11
    v_perm_b32 v110, v68, v68, v13
    v_perm_b32 v111, v68, v68, v15
    s_nop 1
    v_mfma_f32_16x16x32_bf16 v[116:119], v[108:111], a[4:7], v[116:119]
    v_perm_b32 v96, v49, v49, v8
    v_perm_b32 v97, v49, v49, v10
    v_perm_b32 v98, v49, v49, v12
    v_perm_b32 v99, v49, v49, v14
    s_nop 1
    v_mfma_f32_16x16x32_bf16 v[112:115], v[96:99], a[8:11], v[112:115]
    v_perm_b32 v100, v69, v69, v8
    v_perm_b32 v101, v69, v69, v10
    v_perm_b32 v102, v69, v69, v12
    v_perm_b32 v103, v69, v69, v14
    s_nop 1
    v_mfma_f32_16x16x32_bf16 v[116:119], v[100:103], a[8:11], v[116:119]
    v_perm_b32 v104, v49, v49, v9
    v_perm_b32 v105, v49, v49, v11
    v_perm_b32 v106, v49, v49, v13
    v_perm_b32 v107, v49, v49, v15
    s_nop 1
    v_mfma_f32_16x16x32_bf16 v[112:115], v[104:107], a[12:15], v[112:115]
    v_perm_b32 v108, v69, v69, v9
    v_perm_b32 v109, v69, v69, v11
    v_perm_b32 v110, v69, v69, v13
    v_perm_b32 v111, v69, v69, v15
    s_nop 1
    v_mfma_f32_16x16x32_bf16 v[116:119], v[108:111], a[12:15], v[116:119]
    v_perm_b32 v96, v50, v50, v8
    v_perm_b32 v97, v50, v50, v10
    v_perm_b32 v98, v50, v50, v12
    v_perm_b32 v99, v50, v50, v14
    s_nop 1
    v_mfma_f32_16x16x32_bf16 v[112:115], v[96:99], a[16:19], v[112:115]
    v_perm_b32 v100, v70, v70, v8
    v_perm_b32 v101, v70, v70, v10
    v_perm_b32 v102, v70, v70, v12
    v_perm_b32 v103, v70, v70, v14
    s_nop 1
    v_mfma_f32_16x16x32_bf16 v[116:119], v[100:103], a[16:19], v[116:119]
    v_perm_b32 v104, v50, v50, v9
    v_perm_b32 v105, v50, v50, v11
    v_perm_b32 v106, v50, v50, v13
    v_perm_b32 v107, v50, v50, v15
    s_nop 1
    v_mfma_f32_16x16x32_bf16 v[112:115], v[104:107], a[20:23], v[112:115]
    v_perm_b32 v108, v70, v70, v9
    v_perm_b32 v109, v70, v70, v11
    v_perm_b32 v110, v70, v70, v13
    v_perm_b32 v111, v70, v70, v15
    s_nop 1
    v_mfma_f32_16x16x32_bf16 v[116:119], v[108:111], a[20:23], v[116:119]
    v_perm_b32 v96, v51, v51, v8
    v_perm_b32 v97, v51, v51, v10
    v_perm_b32 v98, v51, v51, v12
    v_perm_b32 v99, v51, v51, v14
    s_nop 1
    v_mfma_f32_16x16x32_bf16 v[112:115], v[96:99], a[24:27], v[112:115]
    v_perm_b32 v100, v71, v71, v8
    v_perm_b32 v101, v71, v71, v10
    v_perm_b32 v102, v71, v71, v12
    v_perm_b32 v103, v71, v71, v14
    s_nop 1
    v_mfma_f32_16x16x32_bf16 v[116:119], v[100:103], a[24:27], v[116:119]
    v_perm_b32 v104, v51, v51, v9
    v_perm_b32 v105, v51, v51, v11
    v_perm_b32 v106, v51, v51, v13
    v_perm_b32 v107, v51, v51, v15
    s_nop 1
    v_mfma_f32_16x16x32_bf16 v[112:115], v[104:107], a[28:31], v[112:115]
    v_perm_b32 v108, v71, v71, v9
    v_perm_b32 v109, v71, v71, v11
    v_perm_b32 v110, v71, v71, v13
    v_perm_b32 v111, v71, v71, v15
    s_nop 1
    v_mfma_f32_16x16x32_bf16 v[116:119], v[108:111], a[28:31], v[116:119]
    v_perm_b32 v96, v52, v52, v8
    v_perm_b32 v97, v52, v52, v10
    v_perm_b32 v98, v52, v52, v12
    v_perm_b32 v99, v52, v52, v14
    s_nop 1
    v_mfma_f32_16x16x32_bf16 v[112:115], v[96:99], a[32:35], v[112:115]
    v_perm_b32 v100, v72, v72, v8
    v_perm_b32 v101, v72, v72, v10
    v_perm_b32 v102, v72, v72, v12
    v_perm_b32 v103, v72, v72, v14
    s_nop 1
    v_mfma_f32_16x16x32_bf16 v[116:119], v[100:103], a[32:35], v[116:119]
    s_waitcnt vmcnt(26)
    v_perm_b32 v104, v52, v52, v9
    v_perm_b32 v105, v52, v52, v11
    v_perm_b32 v106, v52, v52, v13
    v_perm_b32 v107, v52, v52, v15
    s_nop 1
    v_mfma_f32_16x16x32_bf16 v[112:115], v[104:107], a[36:39], v[112:115]
    v_perm_b32 v108, v72, v72, v9
    v_perm_b32 v109, v72, v72, v11
    v_perm_b32 v110, v72, v72, v13
    v_perm_b32 v111, v72, v72, v15
    s_nop 1
    v_mfma_f32_16x16x32_bf16 v[116:119], v[108:111], a[36:39], v[116:119]
    v_perm_b32 v96, v53, v53, v8
    v_perm_b32 v97, v53, v53, v10
    v_perm_b32 v98, v53, v53, v12
    v_perm_b32 v99, v53, v53, v14
    s_nop 1
    v_mfma_f32_16x16x32_bf16 v[112:115], v[96:99], a[40:43], v[112:115]
    v_perm_b32 v100, v73, v73, v8
    v_perm_b32 v101, v73, v73, v10
    v_perm_b32 v102, v73, v73, v12
    v_perm_b32 v103, v73, v73, v14
    s_nop 1
    v_mfma_f32_16x16x32_bf16 v[116:119], v[100:103], a[40:43], v[116:119]
    v_perm_b32 v104, v53, v53, v9
    v_perm_b32 v105, v53, v53, v11
    v_perm_b32 v106, v53, v53, v13
    v_perm_b32 v107, v53, v53, v15
    s_nop 1
    v_mfma_f32_16x16x32_bf16 v[112:115], v[104:107], a[44:47], v[112:115]
    v_perm_b32 v108, v73, v73, v9
    v_perm_b32 v109, v73, v73, v11
    v_perm_b32 v110, v73, v73, v13
    v_perm_b32 v111, v73, v73, v15
    s_nop 1
    v_mfma_f32_16x16x32_bf16 v[116:119], v[108:111], a[44:47], v[116:119]
    v_perm_b32 v96, v54, v54, v8
    v_perm_b32 v97, v54, v54, v10
    v_perm_b32 v98, v54, v54, v12
    v_perm_b32 v99, v54, v54, v14
    s_nop 1
    v_mfma_f32_16x16x32_bf16 v[112:115], v[96:99], a[48:51], v[112:115]
    v_perm_b32 v100, v74, v74, v8
    v_perm_b32 v101, v74, v74, v10
    v_perm_b32 v102, v74, v74, v12
    v_perm_b32 v103, v74, v74, v14
    s_nop 1
    v_mfma_f32_16x16x32_bf16 v[116:119], v[100:103], a[48:51], v[116:119]
    v_perm_b32 v104, v54, v54, v9
    v_perm_b32 v105, v54, v54, v11
    v_perm_b32 v106, v54, v54, v13
    v_perm_b32 v107, v54, v54, v15
    s_nop 1
    v_mfma_f32_16x16x32_bf16 v[112:115], v[104:107], a[52:55], v[112:115]
    v_perm_b32 v108, v74, v74, v9
    v_perm_b32 v109, v74, v74, v11
    v_perm_b32 v110, v74, v74, v13
    v_perm_b32 v111, v74, v74, v15
    s_nop 1
    v_mfma_f32_16x16x32_bf16 v[116:119], v[108:111], a[52:55], v[116:119]
    v_perm_b32 v96, v55, v55, v8
    v_perm_b32 v97, v55, v55, v10
    v_perm_b32 v98, v55, v55, v12
    v_perm_b32 v99, v55, v55, v14
    s_nop 1
    v_mfma_f32_16x16x32_bf16 v[112:115], v[96:99], a[56:59], v[112:115]
    v_perm_b32 v100, v75, v75, v8
    v_perm_b32 v101, v75, v75, v10
    v_perm_b32 v102, v75, v75, v12
    v_perm_b32 v103, v75, v75, v14
    s_nop 1
    v_mfma_f32_16x16x32_bf16 v[116:119], v[100:103], a[56:59], v[116:119]
    v_perm_b32 v104, v55, v55, v9
    v_perm_b32 v105, v55, v55, v11
    v_perm_b32 v106, v55, v55, v13
    v_perm_b32 v107, v55, v55, v15
    s_nop 1
    v_mfma_f32_16x16x32_bf16 v[112:115], v[104:107], a[60:63], v[112:115]
    v_perm_b32 v108, v75, v75, v9
    v_perm_b32 v109, v75, v75, v11
    v_perm_b32 v110, v75, v75, v13
    v_perm_b32 v111, v75, v75, v15
    s_nop 1
    v_mfma_f32_16x16x32_bf16 v[116:119], v[108:111], a[60:63], v[116:119]
    v_perm_b32 v96, v56, v56, v8
    v_perm_b32 v97, v56, v56, v10
    v_perm_b32 v98, v56, v56, v12
    v_perm_b32 v99, v56, v56, v14
    s_nop 1
    v_mfma_f32_16x16x32_bf16 v[112:115], v[96:99], a[64:67], v[112:115]
    v_perm_b32 v100, v76, v76, v8
    v_perm_b32 v101, v76, v76, v10
    v_perm_b32 v102, v76, v76, v12
    v_perm_b32 v103, v76, v76, v14
    s_nop 1
    v_mfma_f32_16x16x32_bf16 v[116:119], v[100:103], a[64:67], v[116:119]
    v_perm_b32 v104, v56, v56, v9
    v_perm_b32 v105, v56, v56, v11
    v_perm_b32 v106, v56, v56, v13
    v_perm_b32 v107, v56, v56, v15
    s_nop 1
    v_mfma_f32_16x16x32_bf16 v[112:115], v[104:107], a[68:71], v[112:115]
    v_perm_b32 v108, v76, v76, v9
    v_perm_b32 v109, v76, v76, v11
    v_perm_b32 v110, v76, v76, v13
    v_perm_b32 v111, v76, v76, v15
    s_nop 1
    v_mfma_f32_16x16x32_bf16 v[116:119], v[108:111], a[68:71], v[116:119]
    s_waitcnt vmcnt(17)
    v_perm_b32 v96, v57, v57, v8
    v_perm_b32 v97, v57, v57, v10
    v_perm_b32 v98, v57, v57, v12
    v_perm_b32 v99, v57, v57, v14
    s_nop 1
    v_mfma_f32_16x16x32_bf16 v[112:115], v[96:99], a[72:75], v[112:115]
    v_perm_b32 v100, v77, v77, v8
    v_perm_b32 v101, v77, v77, v10
    v_perm_b32 v102, v77, v77, v12
    v_perm_b32 v103, v77, v77, v14
    s_nop 1
    v_mfma_f32_16x16x32_bf16 v[116:119], v[100:103], a[72:75], v[116:119]
    v_perm_b32 v104, v57, v57, v9
    v_perm_b32 v105, v57, v57, v11
    v_perm_b32 v106, v57, v57, v13
    v_perm_b32 v107, v57, v57, v15
    s_nop 1
    v_mfma_f32_16x16x32_bf16 v[112:115], v[104:107], a[76:79], v[112:115]
    v_perm_b32 v108, v77, v77, v9
    v_perm_b32 v109, v77, v77, v11
    v_perm_b32 v110, v77, v77, v13
    v_perm_b32 v111, v77, v77, v15
    s_nop 1
    v_mfma_f32_16x16x32_bf16 v[116:119], v[108:111], a[76:79], v[116:119]
    v_perm_b32 v96, v58, v58, v8
    v_perm_b32 v97, v58, v58, v10
    v_perm_b32 v98, v58, v58, v12
    v_perm_b32 v99, v58, v58, v14
    s_nop 1
    v_mfma_f32_16x16x32_bf16 v[112:115], v[96:99], a[80:83], v[112:115]
    v_perm_b32 v100, v78, v78, v8
    v_perm_b32 v101, v78, v78, v10
    v_perm_b32 v102, v78, v78, v12
    v_perm_b32 v103, v78, v78, v14
    s_nop 1
    v_mfma_f32_16x16x32_bf16 v[116:119], v[100:103], a[80:83], v[116:119]
    v_perm_b32 v104, v58, v58, v9
    v_perm_b32 v105, v58, v58, v11
    v_perm_b32 v106, v58, v58, v13
    v_perm_b32 v107, v58, v58, v15
    s_nop 1
    v_mfma_f32_16x16x32_bf16 v[112:115], v[104:107], a[84:87], v[112:115]
    v_perm_b32 v108, v78, v78, v9
    v_perm_b32 v109, v78, v78, v11
    v_perm_b32 v110, v78, v78, v13
    v_perm_b32 v111, v78, v78, v15
    s_nop 1
    v_mfma_f32_16x16x32_bf16 v[116:119], v[108:111], a[84:87], v[116:119]
    v_perm_b32 v96, v59, v59, v8
    v_perm_b32 v97, v59, v59, v10
    v_perm_b32 v98, v59, v59, v12
    v_perm_b32 v99, v59, v59, v14
    s_nop 1
    v_mfma_f32_16x16x32_bf16 v[112:115], v[96:99], a[88:91], v[112:115]
    v_perm_b32 v100, v79, v79, v8
    v_perm_b32 v101, v79, v79, v10
    v_perm_b32 v102, v79, v79, v12
    v_perm_b32 v103, v79, v79, v14
    s_nop 1
    v_mfma_f32_16x16x32_bf16 v[116:119], v[100:103], a[88:91], v[116:119]
    v_perm_b32 v104, v59, v59, v9
    v_perm_b32 v105, v59, v59, v11
    v_perm_b32 v106, v59, v59, v13
    v_perm_b32 v107, v59, v59, v15
    s_nop 1
    v_mfma_f32_16x16x32_bf16 v[112:115], v[104:107], a[92:95], v[112:115]
    v_perm_b32 v108, v79, v79, v9
    v_perm_b32 v109, v79, v79, v11
    v_perm_b32 v110, v79, v79, v13
    v_perm_b32 v111, v79, v79, v15
    s_nop 1
    v_mfma_f32_16x16x32_bf16 v[116:119], v[108:111], a[92:95], v[116:119]
    v_perm_b32 v96, v60, v60, v8
    v_perm_b32 v97, v60, v60, v10
    v_perm_b32 v98, v60, v60, v12
    v_perm_b32 v99, v60, v60, v14
    s_nop 1
    v_mfma_f32_16x16x32_bf16 v[112:115], v[96:99], a[96:99], v[112:115]
    v_perm_b32 v100, v80, v80, v8
    v_perm_b32 v101, v80, v80, v10
    v_perm_b32 v102, v80, v80, v12
    v_perm_b32 v103, v80, v80, v14
    s_nop 1
    v_mfma_f32_16x16x32_bf16 v[116:119], v[100:103], a[96:99], v[116:119]
    v_perm_b32 v104, v60, v60, v9
    v_perm_b32 v105, v60, v60, v11
    v_perm_b32 v106, v60, v60, v13
    v_perm_b32 v107, v60, v60, v15
    s_nop 1
    v_mfma_f32_16x16x32_bf16 v[112:115], v[104:107], a[100:103], v[112:115]
    v_perm_b32 v108, v80, v80, v9
    v_perm_b32 v109, v80, v80, v11
    v_perm_b32 v110, v80, v80, v13
    v_perm_b32 v111, v80, v80, v15
    s_nop 1
    v_mfma_f32_16x16x32_bf16 v[116:119], v[108:111], a[100:103], v[116:119]
    v_perm_b32 v96, v61, v61, v8
    v_perm_b32 v97, v61, v61, v10
    v_perm_b32 v98, v61, v61, v12
    v_perm_b32 v99, v61, v61, v14
    s_nop 1
    v_mfma_f32_16x16x32_bf16 v[112:115], v[96:99], a[104:107], v[112:115]
    v_perm_b32 v100, v81, v81, v8
    v_perm_b32 v101, v81, v81, v10
    v_perm_b32 v102, v81, v81, v12
    v_perm_b32 v103, v81, v81, v14
    s_nop 1
    v_mfma_f32_16x16x32_bf16 v[116:119], v[100:103], a[104:107], v[116:119]
    s_waitcnt vmcnt(8)
    v_perm_b32 v104, v61, v61, v9
    v_perm_b32 v105, v61, v61, v11
    v_perm_b32 v106, v61, v61, v13
    v_perm_b32 v107, v61, v61, v15
    s_nop 1
    v_mfma_f32_16x16x32_bf16 v[112:115], v[104:107], a[108:111], v[112:115]
    v_perm_b32 v108, v81, v81, v9
    v_perm_b32 v109, v81, v81, v11
    v_perm_b32 v110, v81, v81, v13
    v_perm_b32 v111, v81, v81, v15
    s_nop 1
    v_mfma_f32_16x16x32_bf16 v[116:119], v[108:111], a[108:111], v[116:119]
    v_perm_b32 v96, v62, v62, v8
    v_perm_b32 v97, v62, v62, v10
    v_perm_b32 v98, v62, v62, v12
    v_perm_b32 v99, v62, v62, v14
    s_nop 1
    v_mfma_f32_16x16x32_bf16 v[112:115], v[96:99], a[112:115], v[112:115]
    v_perm_b32 v100, v82, v82, v8
    v_perm_b32 v101, v82, v82, v10
    v_perm_b32 v102, v82, v82, v12
    v_perm_b32 v103, v82, v82, v14
    s_nop 1
    v_mfma_f32_16x16x32_bf16 v[116:119], v[100:103], a[112:115], v[116:119]
    v_perm_b32 v104, v62, v62, v9
    v_perm_b32 v105, v62, v62, v11
    v_perm_b32 v106, v62, v62, v13
    v_perm_b32 v107, v62, v62, v15
    s_nop 1
    v_mfma_f32_16x16x32_bf16 v[112:115], v[104:107], a[116:119], v[112:115]
    v_perm_b32 v108, v82, v82, v9
    v_perm_b32 v109, v82, v82, v11
    v_perm_b32 v110, v82, v82, v13
    v_perm_b32 v111, v82, v82, v15
    s_nop 1
    v_mfma_f32_16x16x32_bf16 v[116:119], v[108:111], a[116:119], v[116:119]
    v_perm_b32 v96, v63, v63, v8
    v_perm_b32 v97, v63, v63, v10
    v_perm_b32 v98, v63, v63, v12
    v_perm_b32 v99, v63, v63, v14
    s_nop 1
    v_mfma_f32_16x16x32_bf16 v[112:115], v[96:99], a[120:123], v[112:115]
    v_perm_b32 v100, v83, v83, v8
    v_perm_b32 v101, v83, v83, v10
    v_perm_b32 v102, v83, v83, v12
    v_perm_b32 v103, v83, v83, v14
    s_nop 1
    v_mfma_f32_16x16x32_bf16 v[116:119], v[100:103], a[120:123], v[116:119]
    v_perm_b32 v104, v63, v63, v9
    v_perm_b32 v105, v63, v63, v11
    v_perm_b32 v106, v63, v63, v13
    v_perm_b32 v107, v63, v63, v15
    s_nop 1
    v_mfma_f32_16x16x32_bf16 v[112:115], v[104:107], a[124:127], v[112:115]
    v_perm_b32 v108, v83, v83, v9
    v_perm_b32 v109, v83, v83, v11
    v_perm_b32 v110, v83, v83, v13
    v_perm_b32 v111, v83, v83, v15
    s_nop 1
    v_mfma_f32_16x16x32_bf16 v[116:119], v[108:111], a[124:127], v[116:119]
    v_perm_b32 v96, v64, v64, v8
    v_perm_b32 v97, v64, v64, v10
    v_perm_b32 v98, v64, v64, v12
    v_perm_b32 v99, v64, v64, v14
    s_nop 1
    v_mfma_f32_16x16x32_bf16 v[112:115], v[96:99], a[128:131], v[112:115]
    v_perm_b32 v100, v84, v84, v8
    v_perm_b32 v101, v84, v84, v10
    v_perm_b32 v102, v84, v84, v12
    v_perm_b32 v103, v84, v84, v14
    s_nop 1
    v_mfma_f32_16x16x32_bf16 v[116:119], v[100:103], a[128:131], v[116:119]
    v_perm_b32 v104, v64, v64, v9
    v_perm_b32 v105, v64, v64, v11
    v_perm_b32 v106, v64, v64, v13
    v_perm_b32 v107, v64, v64, v15
    s_nop 1
    v_mfma_f32_16x16x32_bf16 v[112:115], v[104:107], a[132:135], v[112:115]
    v_perm_b32 v108, v84, v84, v9
    v_perm_b32 v109, v84, v84, v11
    v_perm_b32 v110, v84, v84, v13
    v_perm_b32 v111, v84, v84, v15
    s_nop 1
    v_mfma_f32_16x16x32_bf16 v[116:119], v[108:111], a[132:135], v[116:119]
    v_perm_b32 v96, v65, v65, v8
    v_perm_b32 v97, v65, v65, v10
    v_perm_b32 v98, v65, v65, v12
    v_perm_b32 v99, v65, v65, v14
    s_nop 1
    v_mfma_f32_16x16x32_bf16 v[112:115], v[96:99], a[136:139], v[112:115]
    v_perm_b32 v100, v85, v85, v8
    v_perm_b32 v101, v85, v85, v10
    v_perm_b32 v102, v85, v85, v12
    v_perm_b32 v103, v85, v85, v14
    s_nop 1
    v_mfma_f32_16x16x32_bf16 v[116:119], v[100:103], a[136:139], v[116:119]
    v_perm_b32 v104, v65, v65, v9
    v_perm_b32 v105, v65, v65, v11
    v_perm_b32 v106, v65, v65, v13
    v_perm_b32 v107, v65, v65, v15
    s_nop 1
    v_mfma_f32_16x16x32_bf16 v[112:115], v[104:107], a[140:143], v[112:115]
    v_perm_b32 v108, v85, v85, v9
    v_perm_b32 v109, v85, v85, v11
    v_perm_b32 v110, v85, v85, v13
    v_perm_b32 v111, v85, v85, v15
    s_nop 1
    v_mfma_f32_16x16x32_bf16 v[116:119], v[108:111], a[140:143], v[116:119]
    v_lshrrev_b32 v5, 1, v4
    v_lshlrev_b32 v5, 9, v5
    v_lshl_add_u32 v5, v3, 5, v5
    v_and_b32 v6, 1, v4
    v_lshl_add_u32 v5, v6, 4, v5
    s_lshl_b32 s54, s3, 11
    s_add_u32 s54, s54, 139264
    v_add_u32 v5, s54, v5
    ds_write_b128 v5, v[112:115]
    ds_write_b128 v5, v[116:119] offset:1024
    s_waitcnt lgkmcnt(0)
    s_barrier
    s_lshl_b32 s54, s3, 9
    s_add_u32 s54, s54, 139264
    v_lshl_add_u32 v5, v3, 5, s54
    ds_read_b128 v[48:51], v5 offset:0
    ds_read_b128 v[52:55], v5 offset:16
    ds_read_b128 v[56:59], v5 offset:2048
    ds_read_b128 v[60:63], v5 offset:2064
    ds_read_b128 v[64:67], v5 offset:4096
    ds_read_b128 v[68:71], v5 offset:4112
    ds_read_b128 v[72:75], v5 offset:6144
    ds_read_b128 v[76:79], v5 offset:6160
    s_waitcnt lgkmcnt(0)
    v_add_f32 v48, v48, v56
    v_add_f32 v64, v64, v72
    v_add_f32 v49, v49, v57
    v_add_f32 v65, v65, v73
    v_add_f32 v50, v50, v58
    v_add_f32 v66, v66, v74
    v_add_f32 v51, v51, v59
    v_add_f32 v67, v67, v75
    v_add_f32 v52, v52, v60
    v_add_f32 v68, v68, v76
    v_add_f32 v53, v53, v61
    v_add_f32 v69, v69, v77
    v_add_f32 v54, v54, v62
    v_add_f32 v70, v70, v78
    v_add_f32 v55, v55, v63
    v_add_f32 v71, v71, v79
    v_add_f32 v48, v48, v64
    v_add_f32 v49, v49, v65
    v_add_f32 v50, v50, v66
    v_add_f32 v51, v51, v67
    v_add_f32 v52, v52, v68
    v_add_f32 v53, v53, v69
    v_add_f32 v54, v54, v70
    v_add_f32 v55, v55, v71
    v_cvt_pk_bf16_f32 v124, v48, v49
    v_cvt_pk_bf16_f32 v125, v50, v51
    v_cvt_pk_bf16_f32 v126, v52, v53
    v_cvt_pk_bf16_f32 v127, v54, v55
    v_min_u32 v124, -2, v124
    v_min_u32 v125, -2, v125
    v_min_u32 v126, -2, v126
    v_min_u32 v127, -2, v127
    buffer_store_dwordx4 v[124:127], v123, s[44:47], s98 offen sc1
    s_add_u32 m0, s59, 0
    s_add_u32 s54, s58, 0
    buffer_load_dwordx4 v20, s[32:35], s54 offen nt lds
    s_add_u32 m0, s59, 1024
    s_add_u32 s54, s58, 0
    buffer_load_dwordx4 v21, s[32:35], s54 offen nt lds
    s_add_u32 m0, s59, 2048
    s_add_u32 s54, s58, 0
    buffer_load_dwordx4 v22, s[32:35], s54 offen nt lds
    s_add_u32 m0, s59, 3072
    s_add_u32 s54, s58, 0
    buffer_load_dwordx4 v23, s[32:35], s54 offen nt lds
    s_add_u32 m0, s59, 4096
    s_add_u32 s54, s58, 16384
    buffer_load_dwordx4 v20, s[32:35], s54 offen nt lds
    s_add_u32 m0, s59, 5120
    s_add_u32 s54, s58, 16384
    buffer_load_dwordx4 v21, s[32:35], s54 offen nt lds
    s_add_u32 m0, s59, 6144
    s_add_u32 s54, s58, 16384
    buffer_load_dwordx4 v22, s[32:35], s54 offen nt lds
    s_add_u32 m0, s59, 7168
    s_add_u32 s54, s58, 16384
    buffer_load_dwordx4 v23, s[32:35], s54 offen nt lds
    s_add_u32 s58, s58, 32768
    s_add_u32 s59, s59, 8192
    s_add_u32 m0, s59, 0
    s_add_u32 s54, s58, 0
    buffer_load_dwordx4 v20, s[32:35], s54 offen nt lds
    s_add_u32 m0, s59, 1024
    s_add_u32 s54, s58, 0
    buffer_load_dwordx4 v21, s[32:35], s54 offen nt lds
    s_add_u32 m0, s59, 2048
    s_add_u32 s54, s58, 0
    buffer_load_dwordx4 v22, s[32:35], s54 offen nt lds
    s_add_u32 m0, s59, 3072
    s_add_u32 s54, s58, 0
    buffer_load_dwordx4 v23, s[32:35], s54 offen nt lds
    s_add_u32 m0, s59, 4096
    s_add_u32 s54, s58, 16384
    buffer_load_dwordx4 v20, s[32:35], s54 offen nt lds
    s_add_u32 m0, s59, 5120
    s_add_u32 s54, s58, 16384
    buffer_load_dwordx4 v21, s[32:35], s54 offen nt lds
    s_add_u32 m0, s59, 6144
    s_add_u32 s54, s58, 16384
    buffer_load_dwordx4 v22, s[32:35], s54 offen nt lds
    s_add_u32 m0, s59, 7168
    s_add_u32 s54, s58, 16384
    buffer_load_dwordx4 v23, s[32:35], s54 offen nt lds
    s_add_u32 s58, s58, 32768
    s_add_u32 s59, s59, 8192
    s_add_u32 m0, s59, 0
    s_add_u32 s54, s58, 0
    buffer_load_dwordx4 v20, s[32:35], s54 offen nt lds
    s_add_u32 m0, s59, 1024
    s_add_u32 s54, s58, 0
    buffer_load_dwordx4 v21, s[32:35], s54 offen nt lds
    s_add_u32 m0, s59, 2048
    s_add_u32 s54, s58, 0
    buffer_load_dwordx4 v22, s[32:35], s54 offen nt lds
    s_add_u32 m0, s59, 3072
    s_add_u32 s54, s58, 0
    buffer_load_dwordx4 v23, s[32:35], s54 offen nt lds
    s_add_u32 m0, s59, 4096
    s_add_u32 s54, s58, 16384
    buffer_load_dwordx4 v20, s[32:35], s54 offen nt lds
    s_add_u32 m0, s59, 5120
    s_add_u32 s54, s58, 16384
    buffer_load_dwordx4 v21, s[32:35], s54 offen nt lds
    s_add_u32 m0, s59, 6144
    s_add_u32 s54, s58, 16384
    buffer_load_dwordx4 v22, s[32:35], s54 offen nt lds
    s_add_u32 m0, s59, 7168
    s_add_u32 s54, s58, 16384
    buffer_load_dwordx4 v23, s[32:35], s54 offen nt lds
    s_add_u32 s58, s58, 32768
    s_add_u32 s59, s59, 8192
    s_waitcnt vmcnt(40)
    v_mov_b32 v27, 0
    global_load_dword v18, v27, s[28:29] sc1
    buffer_load_dwordx4 a[96:99], v20, s[32:35], s58 offen nt
    buffer_load_dwordx4 a[100:103], v21, s[32:35], s58 offen nt
    buffer_load_dwordx4 a[104:107], v22, s[32:35], s58 offen nt
    buffer_load_dwordx4 a[108:111], v23, s[32:35], s58 offen nt
    s_add_u32 s58, s58, 16384
    buffer_load_dwordx4 a[112:115], v20, s[32:35], s58 offen nt
    buffer_load_dwordx4 a[116:119], v21, s[32:35], s58 offen nt
    buffer_load_dwordx4 a[120:123], v22, s[32:35], s58 offen nt
    buffer_load_dwordx4 a[124:127], v23, s[32:35], s58 offen nt
    s_add_u32 s58, s58, 16384
    s_waitcnt vmcnt(40)
    buffer_load_dwordx4 a[128:131], v20, s[32:35], s58 offen nt
    buffer_load_dwordx4 a[132:135], v21, s[32:35], s58 offen nt
    buffer_load_dwordx4 a[136:139], v22, s[32:35], s58 offen nt
    buffer_load_dwordx4 a[140:143], v23, s[32:35], s58 offen nt
    s_add_u32 s58, s58, 16384
    buffer_load_dwordx4 a[144:147], v20, s[32:35], s58 offen nt
    buffer_load_dwordx4 a[148:151], v21, s[32:35], s58 offen nt
    buffer_load_dwordx4 a[152:155], v22, s[32:35], s58 offen nt
    buffer_load_dwordx4 a[156:159], v23, s[32:35], s58 offen nt
    s_add_u32 s58, s58, 16384
    s_mov_b32 s36, s12
    s_mov_b32 s37, s13
    s_mov_b32 s38, 4718592
    s_mov_b32 s39, 0x20000
    v_mul_u32_u24 v49, 9216, v4
    v_lshl_add_u32 v48, v3, 4, v49
    v_lshl_add_u32 v49, v3, 2, v49
    s_mul_i32 s100, s52, 147456
    s_lshl_b32 s54, s3, 8
    s_add_u32 s99, s100, s54
    s_and_b32 s54, s3, 1
    s_lshl_b32 s54, s54, 6
    s_add_u32 s100, s100, s54
    s_add_u32 s100, s100, 1024
    v_add_u32 v26, s63, v2
    v_and_b32 v24, 31, v1
    v_lshrrev_b32 v25, 5, v1
    v_lshlrev_b32 v19, 10, v24
    v_lshl_add_u32 v19, v25, 4, v19
    s_lshr_b32 s96, s53, 3
    s_lshl_b32 s96, s96, 15
    s_lshl_b32 s55, s3, 8
    s_add_u32 s96, s96, s55
    s_add_u32 s96, s96, 1048576
    v_and_b32 v5, 3, v24
    v_lshlrev_b32 v5, 2, v5
    v_bfe_u32 v6, v24, 2, 2
    v_or_b32 v5, v5, v6
    v_xor_b32 v5, v5, v25
    v_lshlrev_b32 v32, 8, v24
    v_lshl_add_u32 v32, v5, 4, v32
    v_add_u32 v32, s63, v32
    v_bfe_u32 v5, v1, 2, 2
    v_lshl_add_u32 v6, v25, 2, v5
    v_lshlrev_b32 v40, 8, v6
    v_and_b32 v6, 1, v1
    v_lshl_add_u32 v40, v6, 3, v40
    v_bfe_u32 v6, v1, 4, 1
    v_lshlrev_b32 v6, 1, v6
    v_bfe_u32 v7, v1, 1, 1
    v_or_b32 v6, v6, v7
    v_xor_b32 v6, v6, v25
    v_lshl_or_b32 v6, v5, 2, v6
    v_lshl_add_u32 v40, v6, 4, v40
    v_add_u32 v40, s63, v40
    v_xor_b32 v33, 32, v32
    v_xor_b32 v41, 32, v40
    v_xor_b32 v34, 64, v32
    v_xor_b32 v42, 64, v40
    v_xor_b32 v35, 96, v32
    v_xor_b32 v43, 96, v40
    v_xor_b32 v36, 128, v32
    v_xor_b32 v44, 128, v40
    v_xor_b32 v37, 160, v32
    v_xor_b32 v45, 160, v40
    v_xor_b32 v38, 192, v32
    v_xor_b32 v46, 192, v40
    v_xor_b32 v39, 224, v32
    v_xor_b32 v47, 224, v40
    s_lshl_b32 s54, s3, 12
    s_add_u32 s54, s54, 131072
    v_add_u32 v28, s54, v2
    v_xor_b32 v29, 4096, v28
    v_xor_b32 v30, 8192, v28
    v_xor_b32 v31, 12288, v28
    v_lshlrev_b32 v192, 10, v4
    v_lshl_add_u32 v192, v3, 4, v192
    v_add_u32 v193, 4096, v192
    v_add_u32 v194, 8192, v192
    v_add_u32 v195, 12288, v192
    v_add_u32 v196, 16384, v192
    v_add_u32 v197, 20480, v192
    v_add_u32 v198, 24576, v192
    v_add_u32 v199, 28672, v192
    v_xor_b32 v5, v3, v4
    v_lshlrev_b32 v200, 8, v4
    v_lshl_add_u32 v200, v5, 4, v200
    v_add_u32 v200, s54, v200
    v_xor_b32 v201, 64, v200
    v_xor_b32 v202, 128, v200
    v_xor_b32 v203, 192, v200
    v_xor_b32 v5, v3, v25
    v_lshlrev_b32 v204, 8, v3
    v_lshl_add_u32 v204, v5, 4, v204
    v_and_b32 v5, 1, v4
    v_lshl_add_u32 v204, v5, 14, v204
    v_add_u32 v204, s54, v204
    v_mov_b32 v64, 0
    v_mov_b32 v65, 0
    v_mov_b32 v66, 0
    v_mov_b32 v67, 0
    v_mov_b32 v68, 0
    v_mov_b32 v69, 0
    v_mov_b32 v70, 0
    v_mov_b32 v71, 0
    v_mov_b32 v72, 0
    v_mov_b32 v73, 0
    v_mov_b32 v74, 0
    v_mov_b32 v75, 0
    v_mov_b32 v76, 0
    v_mov_b32 v77, 0
    v_mov_b32 v78, 0
    v_mov_b32 v79, 0
    v_mov_b32 v80, 0
    v_mov_b32 v81, 0
    v_mov_b32 v82, 0
    v_mov_b32 v83, 0
    v_mov_b32 v84, 0
    v_mov_b32 v85, 0
    v_mov_b32 v86, 0
    v_mov_b32 v87, 0
    v_mov_b32 v88, 0
    v_mov_b32 v89, 0
    v_mov_b32 v90, 0
    v_mov_b32 v91, 0
    v_mov_b32 v92, 0
    v_mov_b32 v93, 0
    v_mov_b32 v94, 0
    v_mov_b32 v95, 0
    v_mov_b32 v96, 0
    v_mov_b32 v97, 0
    v_mov_b32 v98, 0
    v_mov_b32 v99, 0
    v_mov_b32 v100, 0
    v_mov_b32 v101, 0
    v_mov_b32 v102, 0
    v_mov_b32 v103, 0
    v_mov_b32 v104, 0
    v_mov_b32 v105, 0
    v_mov_b32 v106, 0
    v_mov_b32 v107, 0
    v_mov_b32 v108, 0
    v_mov_b32 v109, 0
    v_mov_b32 v110, 0
    v_mov_b32 v111, 0
    v_mov_b32 v112, 0
    v_mov_b32 v113, 0
    v_mov_b32 v114, 0
    v_mov_b32 v115, 0
    v_mov_b32 v116, 0
    v_mov_b32 v117, 0
    v_mov_b32 v118, 0
    v_mov_b32 v119, 0
    v_mov_b32 v120, 0
    v_mov_b32 v121, 0
    v_mov_b32 v122, 0
    v_mov_b32 v123, 0
    v_mov_b32 v124, 0
    v_mov_b32 v125, 0
    v_mov_b32 v126, 0
    v_mov_b32 v127, 0
    v_mov_b32 v216, 0xff800000
    v_mov_b32 v217, 0
    s_waitcnt vmcnt(16)
L_flags_34:
    v_cmp_gt_u32 vcc, 1073741824, v18
    s_cbranch_vccz L_flagsok_35
    s_sleep 2
    global_load_dword v18, v27, s[28:29] sc1
    s_waitcnt vmcnt(0)
    s_sub_u32 s101, s101, 1
    s_cbranch_scc0 L_flags_34
    s_mov_b32 s101, 0
L_flagsok_35:
    s_barrier
    ds_read_b128 a[32:35], v32 offset:0
    ds_read_b128 a[36:39], v33 offset:0
    ds_read_b128 a[40:43], v34 offset:0
    ds_read_b128 a[44:47], v35 offset:0
    ds_read_b128 a[48:51], v36 offset:0
    ds_read_b128 a[52:55], v37 offset:0
    ds_read_b128 a[56:59], v38 offset:0
    ds_read_b128 a[60:63], v39 offset:0
    buffer_load_dwordx4 v[128:131], v192, s[44:47], s96 offen sc1
    buffer_load_dwordx4 v[132:135], v193, s[44:47], s96 offen sc1
    buffer_load_dwordx4 v[136:139], v194, s[44:47], s96 offen sc1
    buffer_load_dwordx4 v[140:143], v195, s[44:47], s96 offen sc1
    buffer_load_dwordx4 v[144:147], v196, s[44:47], s96 offen sc1
    buffer_load_dwordx4 v[148:151], v197, s[44:47], s96 offen sc1
    buffer_load_dwordx4 v[152:155], v198, s[44:47], s96 offen sc1
    buffer_load_dwordx4 v[156:159], v199, s[44:47], s96 offen sc1
    buffer_load_dwordx4 a[160:163], v20, s[32:35], s58 offen nt
    buffer_load_dwordx4 a[164:167], v21, s[32:35], s58 offen nt
    buffer_load_dwordx4 a[168:171], v22, s[32:35], s58 offen nt
    buffer_load_dwordx4 a[172:175], v23, s[32:35], s58 offen nt
    s_add_u32 s58, s58, 16384
    buffer_load_dwordx4 a[176:179], v20, s[32:35], s58 offen nt
    buffer_load_dwordx4 a[180:183], v21, s[32:35], s58 offen nt
    buffer_load_dwordx4 a[184:187], v22, s[32:35], s58 offen nt
    buffer_load_dwordx4 a[188:191], v23, s[32:35], s58 offen nt
    s_add_u32 s58, s58, 16384
    s_waitcnt vmcnt(8)
    s_branch L_qpoll_36_c
L_qpoll_36:
    s_sleep 4
    buffer_load_dwordx4 v[128:131], v192, s[44:47], s96 offen sc1
    buffer_load_dwordx4 v[132:135], v193, s[44:47], s96 offen sc1
    buffer_load_dwordx4 v[136:139], v194, s[44:47], s96 offen sc1
    buffer_load_dwordx4 v[140:143], v195, s[44:47], s96 offen sc1
    buffer_load_dwordx4 v[144:147], v196, s[44:47], s96 offen sc1
    buffer_load_dwordx4 v[148:151], v197, s[44:47], s96 offen sc1
    buffer_load_dwordx4 v[152:155], v198, s[44:47], s96 offen sc1
    buffer_load_dwordx4 v[156:159], v199, s[44:47], s96 offen sc1
    s_waitcnt vmcnt(0)
L_qpoll_36_c:
    v_max3_u32 v5, v128, v129, v130
    v_max3_u32 v6, v144, v145, v146
    v_max3_u32 v5, v5, v131, v132
    v_max3_u32 v6, v6, v147, v148
    v_max3_u32 v5, v5, v133, v134
    v_max3_u32 v6, v6, v149, v150
    v_max3_u32 v5, v5, v135, v136
    v_max3_u32 v6, v6, v151, v152
    v_max3_u32 v5, v5, v137, v138
    v_max3_u32 v6, v6, v153, v154
    v_max3_u32 v5, v5, v139, v140
    v_max3_u32 v6, v6, v155, v156
    v_max3_u32 v5, v5, v141, v142
    v_max3_u32 v6, v6, v157, v158
    v_max3_u32 v5, v5, v143, v159
    v_max_u32 v5, v5, v6
    v_cmp_eq_u32 vcc, -1, v5
    s_nop 0
    s_mov_b64 exec, vcc
    s_cbranch_execz L_qok_37
    s_sub_u32 s101, s101, 1
    s_cbranch_scc0 L_qpoll_36
    s_mov_b32 s101, 0
L_qok_37:
    s_mov_b64 exec, -1
    ds_write_b128 v200, v[128:131] offset:0
    ds_write_b128 v201, v[132:135] offset:1024
    ds_write_b128 v202, v[136:139] offset:2048
    ds_write_b128 v203, v[140:143] offset:3072
    ds_write_b128 v200, v[144:147] offset:16384
    ds_write_b128 v201, v[148:151] offset:17408
    ds_write_b128 v202, v[152:155] offset:18432
    ds_write_b128 v203, v[156:159] offset:19456
    v_xor_b32 v192, 0, v204
    v_xor_b32 v193, 32, v204
    v_xor_b32 v194, 64, v204
    v_xor_b32 v195, 96, v204
    v_xor_b32 v196, 128, v204
    v_xor_b32 v197, 160, v204
    v_xor_b32 v198, 192, v204
    v_xor_b32 v199, 224, v204
    s_waitcnt lgkmcnt(0)
    ds_read_b128 a[0:3], v192
    ds_read_b128 a[4:7], v193
    ds_read_b128 a[8:11], v194
    ds_read_b128 a[12:15], v195
    ds_read_b128 a[16:19], v196
    ds_read_b128 a[20:23], v197
    ds_read_b128 a[24:27], v198
    ds_read_b128 a[28:31], v199
    s_waitcnt lgkmcnt(0)
    v_mfma_f32_32x32x16_bf16 v[128:143], a[32:35], a[0:3], 0
    v_mfma_f32_32x32x16_bf16 v[128:143], a[36:39], a[4:7], v[128:143]
    v_mfma_f32_32x32x16_bf16 v[128:143], a[40:43], a[8:11], v[128:143]
    v_mfma_f32_32x32x16_bf16 v[128:143], a[44:47], a[12:15], v[128:143]
    v_mfma_f32_32x32x16_bf16 v[128:143], a[48:51], a[16:19], v[128:143]
    v_mfma_f32_32x32x16_bf16 v[128:143], a[52:55], a[20:23], v[128:143]
    v_mfma_f32_32x32x16_bf16 v[128:143], a[56:59], a[24:27], v[128:143]
    v_mfma_f32_32x32x16_bf16 v[128:143], a[60:63], a[28:31], v[128:143]
    s_nop 11
    ds_write_b128 v28, v[128:131] offset:0
    ds_write_b128 v28, v[132:135] offset:1024
    ds_write_b128 v28, v[136:139] offset:2048
    ds_write_b128 v28, v[140:143] offset:3072
    s_waitcnt lgkmcnt(0)
    s_barrier
    ds_read_b128 v[144:147], v29 offset:0
    ds_read_b128 v[148:151], v29 offset:1024
    ds_read_b128 v[152:155], v29 offset:2048
    ds_read_b128 v[156:159], v29 offset:3072
    ds_read_b128 v[160:163], v30 offset:0
    ds_read_b128 v[164:167], v30 offset:1024
    ds_read_b128 v[168:171], v30 offset:2048
    ds_read_b128 v[172:175], v30 offset:3072
    ds_read_b128 v[176:179], v31 offset:0
    ds_read_b128 v[180:183], v31 offset:1024
    ds_read_b128 v[184:187], v31 offset:2048
    ds_read_b128 v[188:191], v31 offset:3072
    ds_read_b128 a[32:35], v32 offset:8192
    ds_read_b128 a[36:39], v33 offset:8192
    ds_read_b128 a[40:43], v34 offset:8192
    ds_read_b128 a[44:47], v35 offset:8192
    ds_read_b128 a[48:51], v36 offset:8192
    ds_read_b128 a[52:55], v37 offset:8192
    ds_read_b128 a[56:59], v38 offset:8192
    ds_read_b128 a[60:63], v39 offset:8192
    s_waitcnt lgkmcnt(8)
    v_add_f32 v144, v144, v128
    v_add_f32 v145, v145, v129
    v_add_f32 v146, v146, v130
    v_add_f32 v147, v147, v131
    buffer_load_dwordx4 a[192:195], v20, s[32:35], s58 offen nt
    v_add_f32 v148, v148, v132
    v_add_f32 v149, v149, v133
    v_add_f32 v150, v150, v134
    v_add_f32 v151, v151, v135
    v_add_f32 v152, v152, v136
    v_add_f32 v153, v153, v137
    v_add_f32 v154, v154, v138
    v_add_f32 v155, v155, v139
    v_add_f32 v156, v156, v140
    v_add_f32 v157, v157, v141
    v_add_f32 v158, v158, v142
    v_add_f32 v159, v159, v143
    s_waitcnt lgkmcnt(0)
    v_mfma_f32_32x32x16_bf16 v[128:143], a[32:35], a[0:3], 0
    ds_read_b64_tr_b16 a[64:65], v40 offset:0
    ds_read_b64_tr_b16 a[66:67], v41 offset:2048
    v_add_f32 v160, v160, v176
    v_add_f32 v161, v161, v177
    v_add_f32 v162, v162, v178
    v_add_f32 v163, v163, v179
    v_add_f32 v164, v164, v180
    v_mfma_f32_32x32x16_bf16 v[128:143], a[36:39], a[4:7], v[128:143]
    ds_read_b64_tr_b16 a[72:73], v42 offset:0
    ds_read_b64_tr_b16 a[74:75], v43 offset:2048
    v_add_f32 v165, v165, v181
    v_add_f32 v166, v166, v182
    v_add_f32 v167, v167, v183
    v_add_f32 v168, v168, v184
    v_add_f32 v169, v169, v185
    v_mfma_f32_32x32x16_bf16 v[128:143], a[40:43], a[8:11], v[128:143]
    ds_read_b64_tr_b16 a[80:81], v44 offset:0
    ds_read_b64_tr_b16 a[82:83], v45 offset:2048
    v_add_f32 v170, v170, v186
    v_add_f32 v171, v171, v187
    v_add_f32 v172, v172, v188
    v_add_f32 v173, v173, v189
    v_add_f32 v174, v174, v190
    v_mfma_f32_32x32x16_bf16 v[128:143], a[44:47], a[12:15], v[128:143]
    ds_read_b64_tr_b16 a[88:89], v46 offset:0
    ds_read_b64_tr_b16 a[90:91], v47 offset:2048
    v_add_f32 v175, v175, v191
    v_add_f32 v144, v144, v160
    v_add_f32 v145, v145, v161
    v_add_f32 v146, v146, v162
    v_add_f32 v147, v147, v163
    v_mfma_f32_32x32x16_bf16 v[128:143], a[48:51], a[16:19], v[128:143]
    ds_read_b64_tr_b16 a[68:69], v40 offset:4096
    ds_read_b64_tr_b16 a[70:71], v41 offset:6144
    v_add_f32 v148, v148, v164
    v_add_f32 v149, v149, v165
    v_add_f32 v150, v150, v166
    v_add_f32 v151, v151, v167
    v_add_f32 v152, v152, v168
    v_mfma_f32_32x32x16_bf16 v[128:143], a[52:55], a[20:23], v[128:143]
    ds_read_b64_tr_b16 a[76:77], v42 offset:4096
    ds_read_b64_tr_b16 a[78:79], v43 offset:6144
    v_add_f32 v153, v153, v169
    v_add_f32 v154, v154, v170
    v_add_f32 v155, v155, v171
    v_add_f32 v156, v156, v172
    v_add_f32 v157, v157, v173
    v_mfma_f32_32x32x16_bf16 v[128:143], a[56:59], a[24:27], v[128:143]
    ds_read_b64_tr_b16 a[84:85], v44 offset:4096
    ds_read_b64_tr_b16 a[86:87], v45 offset:6144
    v_add_f32 v158, v158, v174
    v_add_f32 v159, v159, v175
    v_max3_f32 v218, v144, v145, v146
    v_max3_f32 v219, v147, v148, v149
    v_max3_f32 v220, v150, v151, v152
    v_mfma_f32_32x32x16_bf16 v[128:143], a[60:63], a[28:31], v[128:143]
    ds_read_b64_tr_b16 a[92:93], v46 offset:4096
    ds_read_b64_tr_b16 a[94:95], v47 offset:6144
    v_max3_f32 v221, v153, v154, v155
    v_max3_f32 v218, v218, v156, v157
    v_max3_f32 v219, v219, v158, v159
    v_max3_f32 v218, v218, v219, v220
    v_max_f32 v218, v218, v221
    v_mov_b32 v219, v218
    s_nop 1
    v_permlane32_swap_b32 v218, v219
    v_max3_f32 v218, v218, v219, v216
    v_sub_f32 v220, v216, v218
    v_mov_b32 v216, v218
    v_exp_f32 v220, v220
    v_sub_f32 v192, v144, v218
    v_sub_f32 v193, v145, v218
    buffer_load_dwordx4 a[196:199], v21, s[32:35], s58 offen nt
    v_sub_f32 v194, v146, v218
    v_sub_f32 v195, v147, v218
    v_sub_f32 v196, v148, v218
    v_sub_f32 v197, v149, v218
    v_sub_f32 v198, v150, v218
    buffer_load_dwordx4 a[200:203], v22, s[32:35], s58 offen nt
    v_sub_f32 v199, v151, v218
    v_sub_f32 v200, v152, v218
    v_sub_f32 v201, v153, v218
    v_sub_f32 v202, v154, v218
    v_sub_f32 v203, v155, v218
    v_sub_f32 v204, v156, v218
    v_sub_f32 v205, v157, v218
    v_sub_f32 v206, v158, v218
    v_sub_f32 v207, v159, v218
    ds_write_b128 v28, v[128:131] offset:16384
    v_exp_f32 v192, v192
    v_exp_f32 v193, v193
    v_exp_f32 v194, v194
    v_exp_f32 v195, v195
    ds_write_b128 v28, v[132:135] offset:17408
    v_exp_f32 v196, v196
    v_exp_f32 v197, v197
    v_exp_f32 v198, v198
    v_exp_f32 v199, v199
    ds_write_b128 v28, v[136:139] offset:18432
    v_exp_f32 v200, v200
    v_exp_f32 v201, v201
    v_exp_f32 v202, v202
    v_exp_f32 v203, v203
    ds_write_b128 v28, v[140:143] offset:19456
    v_exp_f32 v204, v204
    v_exp_f32 v205, v205
    v_exp_f32 v206, v206
    v_exp_f32 v207, v207
    v_mul_f32 v217, v217, v220
    v_cvt_pk_bf16_f32 v208, v192, v193
    v_cvt_pk_bf16_f32 v209, v194, v195
    v_cvt_pk_bf16_f32 v210, v196, v197
    v_cvt_pk_bf16_f32 v211, v198, v199
    v_cvt_pk_bf16_f32 v212, v200, v201
    v_cvt_pk_bf16_f32 v213, v202, v203
    v_cvt_pk_bf16_f32 v214, v204, v205
    v_cvt_pk_bf16_f32 v215, v206, v207
    v_mul_f32 v64, v64, v220
    v_mul_f32 v65, v65, v220
    v_mul_f32 v66, v66, v220
    v_mul_f32 v67, v67, v220
    v_mul_f32 v68, v68, v220
    v_mul_f32 v69, v69, v220
    v_mul_f32 v70, v70, v220
    v_mul_f32 v71, v71, v220
    v_mul_f32 v72, v72, v220
    v_mul_f32 v73, v73, v220
    v_mul_f32 v74, v74, v220
    v_mul_f32 v75, v75, v220
    v_mul_f32 v76, v76, v220
    v_mul_f32 v77, v77, v220
    v_mul_f32 v78, v78, v220
    v_mul_f32 v79, v79, v220
    s_waitcnt lgkmcnt(0)
    s_barrier
    v_mfma_f32_32x32x16_bf16 v[64:79], a[64:67], v[208:211], v[64:79]
    ds_read_b128 v[144:147], v29 offset:16384
    v_mul_f32 v80, v80, v220
    v_mul_f32 v81, v81, v220
    ds_read_b128 v[148:151], v29 offset:17408
    ds_write_b128 v26, a[96:99] offset:0
    buffer_load_dwordx4 a[204:207], v23, s[32:35], s58 offen nt
    s_add_u32 s58, s58, 16384
    v_mul_f32 v82, v82, v220
    v_mul_f32 v83, v83, v220
    ds_read_b128 v[152:155], v29 offset:18432
    v_mul_f32 v84, v84, v220
    v_mfma_f32_32x32x16_bf16 v[64:79], a[68:71], v[212:215], v[64:79]
    v_mul_f32 v85, v85, v220
    ds_read_b128 v[156:159], v29 offset:19456
    v_mul_f32 v86, v86, v220
    ds_write_b128 v26, a[100:103] offset:1024
    v_mul_f32 v87, v87, v220
    v_mul_f32 v88, v88, v220
    v_mul_f32 v89, v89, v220
    v_mul_f32 v90, v90, v220
    v_mul_f32 v91, v91, v220
    v_mul_f32 v92, v92, v220
    v_mul_f32 v93, v93, v220
    v_mul_f32 v94, v94, v220
    v_mul_f32 v95, v95, v220
    s_nop 1
    v_mfma_f32_32x32x16_bf16 v[80:95], a[72:75], v[208:211], v[80:95]
    ds_read_b128 v[160:163], v30 offset:16384
    v_mul_f32 v96, v96, v220
    v_mul_f32 v97, v97, v220
    ds_read_b128 v[164:167], v30 offset:17408
    ds_write_b128 v26, a[104:107] offset:2048
    buffer_load_dwordx4 a[208:211], v20, s[32:35], s58 offen nt
    v_mul_f32 v98, v98, v220
    v_mul_f32 v99, v99, v220
    ds_read_b128 v[168:171], v30 offset:18432
    v_mul_f32 v100, v100, v220
    v_mfma_f32_32x32x16_bf16 v[80:95], a[76:79], v[212:215], v[80:95]
    v_mul_f32 v101, v101, v220
    ds_read_b128 v[172:175], v30 offset:19456
    v_mul_f32 v102, v102, v220
    ds_write_b128 v26, a[108:111] offset:3072
    v_mul_f32 v103, v103, v220
    v_mul_f32 v104, v104, v220
    v_mul_f32 v105, v105, v220
    v_mul_f32 v106, v106, v220
    v_mul_f32 v107, v107, v220
    v_mul_f32 v108, v108, v220
    v_mul_f32 v109, v109, v220
    v_mul_f32 v110, v110, v220
    v_mul_f32 v111, v111, v220
    s_nop 1
    v_mfma_f32_32x32x16_bf16 v[96:111], a[80:83], v[208:211], v[96:111]
    ds_read_b128 v[176:179], v31 offset:16384
    v_mul_f32 v112, v112, v220
    v_mul_f32 v113, v113, v220
    ds_read_b128 v[180:183], v31 offset:17408
    ds_write_b128 v26, a[112:115] offset:4096
    v_mul_f32 v114, v114, v220
    v_mul_f32 v115, v115, v220
    ds_read_b128 v[184:187], v31 offset:18432
    v_mul_f32 v116, v116, v220
    v_mfma_f32_32x32x16_bf16 v[96:111], a[84:87], v[212:215], v[96:111]
    v_mul_f32 v117, v117, v220
    ds_read_b128 v[188:191], v31 offset:19456
    v_mul_f32 v118, v118, v220
    ds_write_b128 v26, a[116:119] offset:5120
    buffer_load_dwordx4 a[212:215], v21, s[32:35], s58 offen nt
    v_mul_f32 v119, v119, v220
    v_mul_f32 v120, v120, v220
    v_mul_f32 v121, v121, v220
    v_mul_f32 v122, v122, v220
    v_mul_f32 v123, v123, v220
    v_mul_f32 v124, v124, v220
    v_mul_f32 v125, v125, v220
    v_mul_f32 v126, v126, v220
    v_mul_f32 v127, v127, v220
    s_nop 1
    v_mfma_f32_32x32x16_bf16 v[112:127], a[88:91], v[208:211], v[112:127]
    v_add_f32 v192, v192, v200
    v_add_f32 v193, v193, v201
    v_add_f32 v194, v194, v202
    v_add_f32 v195, v195, v203
    ds_write_b128 v26, a[120:123] offset:6144
    v_add_f32 v196, v196, v204
    v_add_f32 v197, v197, v205
    v_add_f32 v198, v198, v206
    v_add_f32 v199, v199, v207
    v_mfma_f32_32x32x16_bf16 v[112:127], a[92:95], v[212:215], v[112:127]
    v_add_f32 v192, v192, v196
    v_add_f32 v193, v193, v197
    v_add_f32 v194, v194, v198
    ds_write_b128 v26, a[124:127] offset:7168
    v_add_f32 v195, v195, v199
    v_add_f32 v192, v192, v193
    v_add_f32 v194, v194, v195
    v_add_f32 v192, v192, v194
    v_add_f32 v217, v217, v192
    ds_read_b128 a[32:35], v32 offset:16384
    ds_read_b128 a[36:39], v33 offset:16384
    ds_read_b128 a[40:43], v34 offset:16384
    ds_read_b128 a[44:47], v35 offset:16384
    ds_read_b128 a[48:51], v36 offset:16384
    ds_read_b128 a[52:55], v37 offset:16384
    ds_read_b128 a[56:59], v38 offset:16384
    ds_read_b128 a[60:63], v39 offset:16384
    s_waitcnt lgkmcnt(8)
    v_add_f32 v144, v144, v128
    v_add_f32 v145, v145, v129
    v_add_f32 v146, v146, v130
    v_add_f32 v147, v147, v131
    buffer_load_dwordx4 a[216:219], v22, s[32:35], s58 offen nt
    v_add_f32 v148, v148, v132
    v_add_f32 v149, v149, v133
    v_add_f32 v150, v150, v134
    v_add_f32 v151, v151, v135
    v_add_f32 v152, v152, v136
    v_add_f32 v153, v153, v137
    v_add_f32 v154, v154, v138
    v_add_f32 v155, v155, v139
    v_add_f32 v156, v156, v140
    v_add_f32 v157, v157, v141
    v_add_f32 v158, v158, v142
    v_add_f32 v159, v159, v143
    s_waitcnt lgkmcnt(0)
    v_mfma_f32_32x32x16_bf16 v[128:143], a[32:35], a[0:3], 0
    ds_read_b64_tr_b16 a[64:65], v40 offset:8192
    ds_read_b64_tr_b16 a[66:67], v41 offset:10240
    v_add_f32 v160, v160, v176
    v_add_f32 v161, v161, v177
    v_add_f32 v162, v162, v178
    v_add_f32 v163, v163, v179
    v_add_f32 v164, v164, v180
    v_mfma_f32_32x32x16_bf16 v[128:143], a[36:39], a[4:7], v[128:143]
    ds_read_b64_tr_b16 a[72:73], v42 offset:8192
    ds_read_b64_tr_b16 a[74:75], v43 offset:10240
    v_add_f32 v165, v165, v181
    v_add_f32 v166, v166, v182
    v_add_f32 v167, v167, v183
    v_add_f32 v168, v168, v184
    v_add_f32 v169, v169, v185
    v_mfma_f32_32x32x16_bf16 v[128:143], a[40:43], a[8:11], v[128:143]
    ds_read_b64_tr_b16 a[80:81], v44 offset:8192
    ds_read_b64_tr_b16 a[82:83], v45 offset:10240
    v_add_f32 v170, v170, v186
    v_add_f32 v171, v171, v187
    v_add_f32 v172, v172, v188
    v_add_f32 v173, v173, v189
    v_add_f32 v174, v174, v190
    v_mfma_f32_32x32x16_bf16 v[128:143], a[44:47], a[12:15], v[128:143]
    ds_read_b64_tr_b16 a[88:89], v46 offset:8192
    ds_read_b64_tr_b16 a[90:91], v47 offset:10240
    v_add_f32 v175, v175, v191
    v_add_f32 v144, v144, v160
    v_add_f32 v145, v145, v161
    v_add_f32 v146, v146, v162
    v_add_f32 v147, v147, v163
    v_mfma_f32_32x32x16_bf16 v[128:143], a[48:51], a[16:19], v[128:143]
    ds_read_b64_tr_b16 a[68:69], v40 offset:12288
    ds_read_b64_tr_b16 a[70:71], v41 offset:14336
    v_add_f32 v148, v148, v164
    v_add_f32 v149, v149, v165
    v_add_f32 v150, v150, v166
    v_add_f32 v151, v151, v167
    v_add_f32 v152, v152, v168
    v_mfma_f32_32x32x16_bf16 v[128:143], a[52:55], a[20:23], v[128:143]
    ds_read_b64_tr_b16 a[76:77], v42 offset:12288
    ds_read_b64_tr_b16 a[78:79], v43 offset:14336
    v_add_f32 v153, v153, v169
    v_add_f32 v154, v154, v170
    v_add_f32 v155, v155, v171
    v_add_f32 v156, v156, v172
    v_add_f32 v157, v157, v173
    v_mfma_f32_32x32x16_bf16 v[128:143], a[56:59], a[24:27], v[128:143]
    ds_read_b64_tr_b16 a[84:85], v44 offset:12288
    ds_read_b64_tr_b16 a[86:87], v45 offset:14336
    v_add_f32 v158, v158, v174
    v_add_f32 v159, v159, v175
    v_max3_f32 v218, v144, v145, v146
    v_max3_f32 v219, v147, v148, v149
    v_max3_f32 v220, v150, v151, v152
    v_mfma_f32_32x32x16_bf16 v[128:143], a[60:63], a[28:31], v[128:143]
    ds_read_b64_tr_b16 a[92:93], v46 offset:12288
    ds_read_b64_tr_b16 a[94:95], v47 offset:14336
    v_max3_f32 v221, v153, v154, v155
    v_max3_f32 v218, v218, v156, v157
    v_max3_f32 v219, v219, v158, v159
    v_max3_f32 v218, v218, v219, v220
    v_max_f32 v218, v218, v221
    v_mov_b32 v219, v218
    s_nop 1
    v_permlane32_swap_b32 v218, v219
    v_max3_f32 v218, v218, v219, v216
    v_sub_f32 v220, v216, v218
    v_mov_b32 v216, v218
    v_exp_f32 v220, v220
    v_sub_f32 v192, v144, v218
    v_sub_f32 v193, v145, v218
    buffer_load_dwordx4 a[220:223], v23, s[32:35], s58 offen nt
    s_add_u32 s58, s58, 16384
    v_sub_f32 v194, v146, v218
    v_sub_f32 v195, v147, v218
    v_sub_f32 v196, v148, v218
    v_sub_f32 v197, v149, v218
    v_sub_f32 v198, v150, v218
    buffer_load_dwordx4 a[224:227], v20, s[32:35], s58 offen nt
    v_sub_f32 v199, v151, v218
    v_sub_f32 v200, v152, v218
    v_sub_f32 v201, v153, v218
    v_sub_f32 v202, v154, v218
    v_sub_f32 v203, v155, v218
    v_sub_f32 v204, v156, v218
    v_sub_f32 v205, v157, v218
    v_sub_f32 v206, v158, v218
    v_sub_f32 v207, v159, v218
    ds_write_b128 v28, v[128:131] offset:0
    v_exp_f32 v192, v192
    v_exp_f32 v193, v193
    v_exp_f32 v194, v194
    v_exp_f32 v195, v195
    ds_write_b128 v28, v[132:135] offset:1024
    v_exp_f32 v196, v196
    v_exp_f32 v197, v197
    v_exp_f32 v198, v198
    v_exp_f32 v199, v199
    ds_write_b128 v28, v[136:139] offset:2048
    v_exp_f32 v200, v200
    v_exp_f32 v201, v201
    v_exp_f32 v202, v202
    v_exp_f32 v203, v203
    ds_write_b128 v28, v[140:143] offset:3072
    v_exp_f32 v204, v204
    v_exp_f32 v205, v205
    v_exp_f32 v206, v206
    v_exp_f32 v207, v207
    v_mul_f32 v217, v217, v220
    v_cvt_pk_bf16_f32 v208, v192, v193
    v_cvt_pk_bf16_f32 v209, v194, v195
    v_cvt_pk_bf16_f32 v210, v196, v197
    v_cvt_pk_bf16_f32 v211, v198, v199
    v_cvt_pk_bf16_f32 v212, v200, v201
    v_cvt_pk_bf16_f32 v213, v202, v203
    v_cvt_pk_bf16_f32 v214, v204, v205
    v_cvt_pk_bf16_f32 v215, v206, v207
    v_mul_f32 v64, v64, v220
    v_mul_f32 v65, v65, v220
    v_mul_f32 v66, v66, v220
    v_mul_f32 v67, v67, v220
    v_mul_f32 v68, v68, v220
    v_mul_f32 v69, v69, v220
    v_mul_f32 v70, v70, v220
    v_mul_f32 v71, v71, v220
    v_mul_f32 v72, v72, v220
    v_mul_f32 v73, v73, v220
    v_mul_f32 v74, v74, v220
    v_mul_f32 v75, v75, v220
    v_mul_f32 v76, v76, v220
    v_mul_f32 v77, v77, v220
    v_mul_f32 v78, v78, v220
    v_mul_f32 v79, v79, v220
    s_waitcnt lgkmcnt(0)
    s_barrier
    v_mfma_f32_32x32x16_bf16 v[64:79], a[64:67], v[208:211], v[64:79]
    ds_read_b128 v[144:147], v29 offset:0
    v_mul_f32 v80, v80, v220
    v_mul_f32 v81, v81, v220
    ds_read_b128 v[148:151], v29 offset:1024
    ds_write_b128 v26, a[128:131] offset:8192
    buffer_load_dwordx4 a[228:231], v21, s[32:35], s58 offen nt
    v_mul_f32 v82, v82, v220
    v_mul_f32 v83, v83, v220
    ds_read_b128 v[152:155], v29 offset:2048
    v_mul_f32 v84, v84, v220
    v_mfma_f32_32x32x16_bf16 v[64:79], a[68:71], v[212:215], v[64:79]
    v_mul_f32 v85, v85, v220
    ds_read_b128 v[156:159], v29 offset:3072
    v_mul_f32 v86, v86, v220
    ds_write_b128 v26, a[132:135] offset:9216
    v_mul_f32 v87, v87, v220
    v_mul_f32 v88, v88, v220
    v_mul_f32 v89, v89, v220
    v_mul_f32 v90, v90, v220
    v_mul_f32 v91, v91, v220
    v_mul_f32 v92, v92, v220
    v_mul_f32 v93, v93, v220
    v_mul_f32 v94, v94, v220
    v_mul_f32 v95, v95, v220
    s_nop 1
    v_mfma_f32_32x32x16_bf16 v[80:95], a[72:75], v[208:211], v[80:95]
    ds_read_b128 v[160:163], v30 offset:0
    v_mul_f32 v96, v96, v220
    v_mul_f32 v97, v97, v220
    ds_read_b128 v[164:167], v30 offset:1024
    ds_write_b128 v26, a[136:139] offset:10240
    buffer_load_dwordx4 a[232:235], v22, s[32:35], s58 offen nt
    v_mul_f32 v98, v98, v220
    v_mul_f32 v99, v99, v220
    ds_read_b128 v[168:171], v30 offset:2048
    v_mul_f32 v100, v100, v220
    v_mfma_f32_32x32x16_bf16 v[80:95], a[76:79], v[212:215], v[80:95]
    v_mul_f32 v101, v101, v220
    ds_read_b128 v[172:175], v30 offset:3072
    v_mul_f32 v102, v102, v220
    ds_write_b128 v26, a[140:143] offset:11264
    v_mul_f32 v103, v103, v220
    v_mul_f32 v104, v104, v220
    v_mul_f32 v105, v105, v220
    v_mul_f32 v106, v106, v220
    v_mul_f32 v107, v107, v220
    v_mul_f32 v108, v108, v220
    v_mul_f32 v109, v109, v220
    v_mul_f32 v110, v110, v220
    v_mul_f32 v111, v111, v220
    s_nop 1
    v_mfma_f32_32x32x16_bf16 v[96:111], a[80:83], v[208:211], v[96:111]
    ds_read_b128 v[176:179], v31 offset:0
    v_mul_f32 v112, v112, v220
    v_mul_f32 v113, v113, v220
    ds_read_b128 v[180:183], v31 offset:1024
    ds_write_b128 v26, a[144:147] offset:12288
    v_mul_f32 v114, v114, v220
    v_mul_f32 v115, v115, v220
    ds_read_b128 v[184:187], v31 offset:2048
    v_mul_f32 v116, v116, v220
    v_mfma_f32_32x32x16_bf16 v[96:111], a[84:87], v[212:215], v[96:111]
    v_mul_f32 v117, v117, v220
    ds_read_b128 v[188:191], v31 offset:3072
    v_mul_f32 v118, v118, v220
    ds_write_b128 v26, a[148:151] offset:13312
    buffer_load_dwordx4 a[236:239], v23, s[32:35], s58 offen nt
    s_add_u32 s58, s58, 16384
    v_mul_f32 v119, v119, v220
    v_mul_f32 v120, v120, v220
    v_mul_f32 v121, v121, v220
    v_mul_f32 v122, v122, v220
    v_mul_f32 v123, v123, v220
    v_mul_f32 v124, v124, v220
    v_mul_f32 v125, v125, v220
    v_mul_f32 v126, v126, v220
    v_mul_f32 v127, v127, v220
    s_nop 1
    v_mfma_f32_32x32x16_bf16 v[112:127], a[88:91], v[208:211], v[112:127]
    v_add_f32 v192, v192, v200
    v_add_f32 v193, v193, v201
    v_add_f32 v194, v194, v202
    v_add_f32 v195, v195, v203
    ds_write_b128 v26, a[152:155] offset:14336
    v_add_f32 v196, v196, v204
    v_add_f32 v197, v197, v205
    v_add_f32 v198, v198, v206
    v_add_f32 v199, v199, v207
    v_mfma_f32_32x32x16_bf16 v[112:127], a[92:95], v[212:215], v[112:127]
    v_add_f32 v192, v192, v196
    v_add_f32 v193, v193, v197
    v_add_f32 v194, v194, v198
    ds_write_b128 v26, a[156:159] offset:15360
    v_add_f32 v195, v195, v199
    v_add_f32 v192, v192, v193
    v_add_f32 v194, v194, v195
    v_add_f32 v192, v192, v194
    v_add_f32 v217, v217, v192
    ds_read_b128 a[32:35], v32 offset:24576
    ds_read_b128 a[36:39], v33 offset:24576
    ds_read_b128 a[40:43], v34 offset:24576
    ds_read_b128 a[44:47], v35 offset:24576
    ds_read_b128 a[48:51], v36 offset:24576
    ds_read_b128 a[52:55], v37 offset:24576
    ds_read_b128 a[56:59], v38 offset:24576
    ds_read_b128 a[60:63], v39 offset:24576
    s_waitcnt lgkmcnt(8)
    v_add_f32 v144, v144, v128
    v_add_f32 v145, v145, v129
    v_add_f32 v146, v146, v130
    v_add_f32 v147, v147, v131
    buffer_load_dwordx4 a[240:243], v20, s[32:35], s58 offen nt
    v_add_f32 v148, v148, v132
    v_add_f32 v149, v149, v133
    v_add_f32 v150, v150, v134
    v_add_f32 v151, v151, v135
    v_add_f32 v152, v152, v136
    v_add_f32 v153, v153, v137
    v_add_f32 v154, v154, v138
    v_add_f32 v155, v155, v139
    v_add_f32 v156, v156, v140
    v_add_f32 v157, v157, v141
    v_add_f32 v158, v158, v142
    v_add_f32 v159, v159, v143
    s_waitcnt lgkmcnt(0)
    v_mfma_f32_32x32x16_bf16 v[128:143], a[32:35], a[0:3], 0
    ds_read_b64_tr_b16 a[64:65], v40 offset:16384
    ds_read_b64_tr_b16 a[66:67], v41 offset:18432
    v_add_f32 v160, v160, v176
    v_add_f32 v161, v161, v177
    v_add_f32 v162, v162, v178
    v_add_f32 v163, v163, v179
    v_add_f32 v164, v164, v180
    v_mfma_f32_32x32x16_bf16 v[128:143], a[36:39], a[4:7], v[128:143]
    ds_read_b64_tr_b16 a[72:73], v42 offset:16384
    ds_read_b64_tr_b16 a[74:75], v43 offset:18432
    v_add_f32 v165, v165, v181
    v_add_f32 v166, v166, v182
    v_add_f32 v167, v167, v183
    v_add_f32 v168, v168, v184
    v_add_f32 v169, v169, v185
    v_mfma_f32_32x32x16_bf16 v[128:143], a[40:43], a[8:11], v[128:143]
    ds_read_b64_tr_b16 a[80:81], v44 offset:16384
    ds_read_b64_tr_b16 a[82:83], v45 offset:18432
    v_add_f32 v170, v170, v186
    v_add_f32 v171, v171, v187
    v_add_f32 v172, v172, v188
    v_add_f32 v173, v173, v189
    v_add_f32 v174, v174, v190
    v_mfma_f32_32x32x16_bf16 v[128:143], a[44:47], a[12:15], v[128:143]
    ds_read_b64_tr_b16 a[88:89], v46 offset:16384
    ds_read_b64_tr_b16 a[90:91], v47 offset:18432
    v_add_f32 v175, v175, v191
    v_add_f32 v144, v144, v160
    v_add_f32 v145, v145, v161
    v_add_f32 v146, v146, v162
    v_add_f32 v147, v147, v163
    v_mfma_f32_32x32x16_bf16 v[128:143], a[48:51], a[16:19], v[128:143]
    ds_read_b64_tr_b16 a[68:69], v40 offset:20480
    ds_read_b64_tr_b16 a[70:71], v41 offset:22528
    v_add_f32 v148, v148, v164
    v_add_f32 v149, v149, v165
    v_add_f32 v150, v150, v166
    v_add_f32 v151, v151, v167
    v_add_f32 v152, v152, v168
    v_mfma_f32_32x32x16_bf16 v[128:143], a[52:55], a[20:23], v[128:143]
    ds_read_b64_tr_b16 a[76:77], v42 offset:20480
    ds_read_b64_tr_b16 a[78:79], v43 offset:22528
    v_add_f32 v153, v153, v169
    v_add_f32 v154, v154, v170
    v_add_f32 v155, v155, v171
    v_add_f32 v156, v156, v172
    v_add_f32 v157, v157, v173
    v_mfma_f32_32x32x16_bf16 v[128:143], a[56:59], a[24:27], v[128:143]
    ds_read_b64_tr_b16 a[84:85], v44 offset:20480
    ds_read_b64_tr_b16 a[86:87], v45 offset:22528
    v_add_f32 v158, v158, v174
    v_add_f32 v159, v159, v175
    v_max3_f32 v218, v144, v145, v146
    v_max3_f32 v219, v147, v148, v149
    v_max3_f32 v220, v150, v151, v152
    v_mfma_f32_32x32x16_bf16 v[128:143], a[60:63], a[28:31], v[128:143]
    ds_read_b64_tr_b16 a[92:93], v46 offset:20480
    ds_read_b64_tr_b16 a[94:95], v47 offset:22528
    v_max3_f32 v221, v153, v154, v155
    v_max3_f32 v218, v218, v156, v157
    v_max3_f32 v219, v219, v158, v159
    v_max3_f32 v218, v218, v219, v220
    v_max_f32 v218, v218, v221
    v_mov_b32 v219, v218
    s_nop 1
    v_permlane32_swap_b32 v218, v219
    v_max3_f32 v218, v218, v219, v216
    v_sub_f32 v220, v216, v218
    v_mov_b32 v216, v218
    v_exp_f32 v220, v220
    v_sub_f32 v192, v144, v218
    v_sub_f32 v193, v145, v218
    buffer_load_dwordx4 a[244:247], v21, s[32:35], s58 offen nt
    v_sub_f32 v194, v146, v218
    v_sub_f32 v195, v147, v218
    v_sub_f32 v196, v148, v218
    v_sub_f32 v197, v149, v218
    v_sub_f32 v198, v150, v218
    buffer_load_dwordx4 a[248:251], v22, s[32:35], s58 offen nt
    v_sub_f32 v199, v151, v218
    v_sub_f32 v200, v152, v218
    v_sub_f32 v201, v153, v218
    v_sub_f32 v202, v154, v218
    v_sub_f32 v203, v155, v218
    v_sub_f32 v204, v156, v218
    v_sub_f32 v205, v157, v218
    v_sub_f32 v206, v158, v218
    v_sub_f32 v207, v159, v218
    ds_write_b128 v28, v[128:131] offset:16384
    v_exp_f32 v192, v192
    v_exp_f32 v193, v193
    v_exp_f32 v194, v194
    v_exp_f32 v195, v195
    ds_write_b128 v28, v[132:135] offset:17408
    v_exp_f32 v196, v196
    v_exp_f32 v197, v197
    v_exp_f32 v198, v198
    v_exp_f32 v199, v199
    ds_write_b128 v28, v[136:139] offset:18432
    v_exp_f32 v200, v200
    v_exp_f32 v201, v201
    v_exp_f32 v202, v202
    v_exp_f32 v203, v203
    ds_write_b128 v28, v[140:143] offset:19456
    v_exp_f32 v204, v204
    v_exp_f32 v205, v205
    v_exp_f32 v206, v206
    v_exp_f32 v207, v207
    v_mul_f32 v217, v217, v220
    v_cvt_pk_bf16_f32 v208, v192, v193
    v_cvt_pk_bf16_f32 v209, v194, v195
    v_cvt_pk_bf16_f32 v210, v196, v197
    v_cvt_pk_bf16_f32 v211, v198, v199
    v_cvt_pk_bf16_f32 v212, v200, v201
    v_cvt_pk_bf16_f32 v213, v202, v203
    v_cvt_pk_bf16_f32 v214, v204, v205
    v_cvt_pk_bf16_f32 v215, v206, v207
    v_mul_f32 v64, v64, v220
    v_mul_f32 v65, v65, v220
    v_mul_f32 v66, v66, v220
    v_mul_f32 v67, v67, v220
    v_mul_f32 v68, v68, v220
    v_mul_f32 v69, v69, v220
    v_mul_f32 v70, v70, v220
    v_mul_f32 v71, v71, v220
    v_mul_f32 v72, v72, v220
    v_mul_f32 v73, v73, v220
    v_mul_f32 v74, v74, v220
    v_mul_f32 v75, v75, v220
    v_mul_f32 v76, v76, v220
    v_mul_f32 v77, v77, v220
    v_mul_f32 v78, v78, v220
    v_mul_f32 v79, v79, v220
    s_waitcnt lgkmcnt(0)
    s_barrier
    v_mfma_f32_32x32x16_bf16 v[64:79], a[64:67], v[208:211], v[64:79]
    ds_read_b128 v[144:147], v29 offset:16384
    v_mul_f32 v80, v80, v220
    v_mul_f32 v81, v81, v220
    ds_read_b128 v[148:151], v29 offset:17408
    s_waitcnt vmcnt(22)
    ds_write_b128 v26, a[160:163] offset:16384
    buffer_load_dwordx4 a[252:255], v23, s[32:35], s58 offen nt
    s_add_u32 s58, s58, 16384
    v_mul_f32 v82, v82, v220
    v_mul_f32 v83, v83, v220
    ds_read_b128 v[152:155], v29 offset:18432
    v_mul_f32 v84, v84, v220
    v_mfma_f32_32x32x16_bf16 v[64:79], a[68:71], v[212:215], v[64:79]
    v_mul_f32 v85, v85, v220
    ds_read_b128 v[156:159], v29 offset:19456
    v_mul_f32 v86, v86, v220
    s_waitcnt vmcnt(22)
    ds_write_b128 v26, a[164:167] offset:17408
    v_mul_f32 v87, v87, v220
    v_mul_f32 v88, v88, v220
    v_mul_f32 v89, v89, v220
    v_mul_f32 v90, v90, v220
    v_mul_f32 v91, v91, v220
    v_mul_f32 v92, v92, v220
    v_mul_f32 v93, v93, v220
    v_mul_f32 v94, v94, v220
    v_mul_f32 v95, v95, v220
    s_nop 1
    v_mfma_f32_32x32x16_bf16 v[80:95], a[72:75], v[208:211], v[80:95]
    ds_read_b128 v[160:163], v30 offset:16384
    v_mul_f32 v96, v96, v220
    v_mul_f32 v97, v97, v220
    ds_read_b128 v[164:167], v30 offset:17408
    s_waitcnt vmcnt(21)
    ds_write_b128 v26, a[168:171] offset:18432
    buffer_load_dwordx4 v[224:227], v20, s[32:35], s58 offen nt
    v_mul_f32 v98, v98, v220
    v_mul_f32 v99, v99, v220
    ds_read_b128 v[168:171], v30 offset:18432
    v_mul_f32 v100, v100, v220
    v_mfma_f32_32x32x16_bf16 v[80:95], a[76:79], v[212:215], v[80:95]
    v_mul_f32 v101, v101, v220
    ds_read_b128 v[172:175], v30 offset:19456
    v_mul_f32 v102, v102, v220
    s_waitcnt vmcnt(21)
    ds_write_b128 v26, a[172:175] offset:19456
    v_mul_f32 v103, v103, v220
    v_mul_f32 v104, v104, v220
    v_mul_f32 v105, v105, v220
    v_mul_f32 v106, v106, v220
    v_mul_f32 v107, v107, v220
    v_mul_f32 v108, v108, v220
    v_mul_f32 v109, v109, v220
    v_mul_f32 v110, v110, v220
    v_mul_f32 v111, v111, v220
    s_nop 1
    v_mfma_f32_32x32x16_bf16 v[96:111], a[80:83], v[208:211], v[96:111]
    ds_read_b128 v[176:179], v31 offset:16384
    v_mul_f32 v112, v112, v220
    v_mul_f32 v113, v113, v220
    ds_read_b128 v[180:183], v31 offset:17408
    s_waitcnt vmcnt(20)
    ds_write_b128 v26, a[176:179] offset:20480
    v_mul_f32 v114, v114, v220
    v_mul_f32 v115, v115, v220
    ds_read_b128 v[184:187], v31 offset:18432
    v_mul_f32 v116, v116, v220
    v_mfma_f32_32x32x16_bf16 v[96:111], a[84:87], v[212:215], v[96:111]
    v_mul_f32 v117, v117, v220
    ds_read_b128 v[188:191], v31 offset:19456
    v_mul_f32 v118, v118, v220
    s_waitcnt vmcnt(19)
    ds_write_b128 v26, a[180:183] offset:21504
    buffer_load_dwordx4 v[228:231], v21, s[32:35], s58 offen nt
    v_mul_f32 v119, v119, v220
    v_mul_f32 v120, v120, v220
    v_mul_f32 v121, v121, v220
    v_mul_f32 v122, v122, v220
    v_mul_f32 v123, v123, v220
    v_mul_f32 v124, v124, v220
    v_mul_f32 v125, v125, v220
    v_mul_f32 v126, v126, v220
    v_mul_f32 v127, v127, v220
    s_nop 1
    v_mfma_f32_32x32x16_bf16 v[112:127], a[88:91], v[208:211], v[112:127]
    v_add_f32 v192, v192, v200
    v_add_f32 v193, v193, v201
    v_add_f32 v194, v194, v202
    v_add_f32 v195, v195, v203
    s_waitcnt vmcnt(19)
    ds_write_b128 v26, a[184:187] offset:22528
    v_add_f32 v196, v196, v204
    v_add_f32 v197, v197, v205
    v_add_f32 v198, v198, v206
    v_add_f32 v199, v199, v207
    v_mfma_f32_32x32x16_bf16 v[112:127], a[92:95], v[212:215], v[112:127]
    v_add_f32 v192, v192, v196
    v_add_f32 v193, v193, v197
    v_add_f32 v194, v194, v198
    s_waitcnt vmcnt(18)
    ds_write_b128 v26, a[188:191] offset:23552
    v_add_f32 v195, v195, v199
    v_add_f32 v192, v192, v193
    v_add_f32 v194, v194, v195
    v_add_f32 v192, v192, v194
    v_add_f32 v217, v217, v192
    ds_read_b128 a[32:35], v32 offset:0
    ds_read_b128 a[36:39], v33 offset:0
    ds_read_b128 a[40:43], v34 offset:0
    ds_read_b128 a[44:47], v35 offset:0
    ds_read_b128 a[48:51], v36 offset:0
    ds_read_b128 a[52:55], v37 offset:0
    ds_read_b128 a[56:59], v38 offset:0
    ds_read_b128 a[60:63], v39 offset:0
    s_waitcnt lgkmcnt(8)
    v_add_f32 v144, v144, v128
    v_add_f32 v145, v145, v129
    v_add_f32 v146, v146, v130
    v_add_f32 v147, v147, v131
    buffer_load_dwordx4 v[232:235], v22, s[32:35], s58 offen nt
    v_add_f32 v148, v148, v132
    v_add_f32 v149, v149, v133
    v_add_f32 v150, v150, v134
    v_add_f32 v151, v151, v135
    v_add_f32 v152, v152, v136
    v_add_f32 v153, v153, v137
    v_add_f32 v154, v154, v138
    v_add_f32 v155, v155, v139
    v_add_f32 v156, v156, v140
    v_add_f32 v157, v157, v141
    v_add_f32 v158, v158, v142
    v_add_f32 v159, v159, v143
    s_waitcnt lgkmcnt(0)
    v_mfma_f32_32x32x16_bf16 v[128:143], a[32:35], a[0:3], 0
    ds_read_b64_tr_b16 a[64:65], v40 offset:24576
    ds_read_b64_tr_b16 a[66:67], v41 offset:26624
    v_add_f32 v160, v160, v176
    v_add_f32 v161, v161, v177
    v_add_f32 v162, v162, v178
    v_add_f32 v163, v163, v179
    v_add_f32 v164, v164, v180
    v_mfma_f32_32x32x16_bf16 v[128:143], a[36:39], a[4:7], v[128:143]
    ds_read_b64_tr_b16 a[72:73], v42 offset:24576
    ds_read_b64_tr_b16 a[74:75], v43 offset:26624
    v_add_f32 v165, v165, v181
    v_add_f32 v166, v166, v182
    v_add_f32 v167, v167, v183
    v_add_f32 v168, v168, v184
    v_add_f32 v169, v169, v185
    v_mfma_f32_32x32x16_bf16 v[128:143], a[40:43], a[8:11], v[128:143]
    ds_read_b64_tr_b16 a[80:81], v44 offset:24576
    ds_read_b64_tr_b16 a[82:83], v45 offset:26624
    v_add_f32 v170, v170, v186
    v_add_f32 v171, v171, v187
    v_add_f32 v172, v172, v188
    v_add_f32 v173, v173, v189
    v_add_f32 v174, v174, v190
    v_mfma_f32_32x32x16_bf16 v[128:143], a[44:47], a[12:15], v[128:143]
    ds_read_b64_tr_b16 a[88:89], v46 offset:24576
    ds_read_b64_tr_b16 a[90:91], v47 offset:26624
    v_add_f32 v175, v175, v191
    v_add_f32 v144, v144, v160
    v_add_f32 v145, v145, v161
    v_add_f32 v146, v146, v162
    v_add_f32 v147, v147, v163
    v_mfma_f32_32x32x16_bf16 v[128:143], a[48:51], a[16:19], v[128:143]
    ds_read_b64_tr_b16 a[68:69], v40 offset:28672
    ds_read_b64_tr_b16 a[70:71], v41 offset:30720
    v_add_f32 v148, v148, v164
    v_add_f32 v149, v149, v165
    v_add_f32 v150, v150, v166
    v_add_f32 v151, v151, v167
    v_add_f32 v152, v152, v168
    v_mfma_f32_32x32x16_bf16 v[128:143], a[52:55], a[20:23], v[128:143]
    ds_read_b64_tr_b16 a[76:77], v42 offset:28672
    ds_read_b64_tr_b16 a[78:79], v43 offset:30720
    v_add_f32 v153, v153, v169
    v_add_f32 v154, v154, v170
    v_add_f32 v155, v155, v171
    v_add_f32 v156, v156, v172
    v_add_f32 v157, v157, v173
    v_mfma_f32_32x32x16_bf16 v[128:143], a[56:59], a[24:27], v[128:143]
    ds_read_b64_tr_b16 a[84:85], v44 offset:28672
    ds_read_b64_tr_b16 a[86:87], v45 offset:30720
    v_add_f32 v158, v158, v174
    v_add_f32 v159, v159, v175
    v_max3_f32 v218, v144, v145, v146
    v_max3_f32 v219, v147, v148, v149
    v_max3_f32 v220, v150, v151, v152
    v_mfma_f32_32x32x16_bf16 v[128:143], a[60:63], a[28:31], v[128:143]
    ds_read_b64_tr_b16 a[92:93], v46 offset:28672
    ds_read_b64_tr_b16 a[94:95], v47 offset:30720
    v_max3_f32 v221, v153, v154, v155
    v_max3_f32 v218, v218, v156, v157
    v_max3_f32 v219, v219, v158, v159
    v_max3_f32 v218, v218, v219, v220
    v_max_f32 v218, v218, v221
    v_mov_b32 v219, v218
    s_nop 1
    v_permlane32_swap_b32 v218, v219
    v_max3_f32 v218, v218, v219, v216
    v_sub_f32 v220, v216, v218
    v_mov_b32 v216, v218
    v_exp_f32 v220, v220
    v_sub_f32 v192, v144, v218
    v_sub_f32 v193, v145, v218
    buffer_load_dwordx4 v[236:239], v23, s[32:35], s58 offen nt
    s_add_u32 s58, s58, 16384
    v_sub_f32 v194, v146, v218
    v_sub_f32 v195, v147, v218
    v_sub_f32 v196, v148, v218
    v_sub_f32 v197, v149, v218
    v_sub_f32 v198, v150, v218
    buffer_load_dwordx4 v[240:243], v20, s[32:35], s58 offen nt
    v_sub_f32 v199, v151, v218
    v_sub_f32 v200, v152, v218
    v_sub_f32 v201, v153, v218
    v_sub_f32 v202, v154, v218
    v_sub_f32 v203, v155, v218
    v_sub_f32 v204, v156, v218
    v_sub_f32 v205, v157, v218
    v_sub_f32 v206, v158, v218
    v_sub_f32 v207, v159, v218
    ds_write_b128 v28, v[128:131] offset:0
    v_exp_f32 v192, v192
    v_exp_f32 v193, v193
    v_exp_f32 v194, v194
    v_exp_f32 v195, v195
    ds_write_b128 v28, v[132:135] offset:1024
    v_exp_f32 v196, v196
    v_exp_f32 v197, v197
    v_exp_f32 v198, v198
    v_exp_f32 v199, v199
    ds_write_b128 v28, v[136:139] offset:2048
    v_exp_f32 v200, v200
    v_exp_f32 v201, v201
    v_exp_f32 v202, v202
    v_exp_f32 v203, v203
    ds_write_b128 v28, v[140:143] offset:3072
    v_exp_f32 v204, v204
    v_exp_f32 v205, v205
    v_exp_f32 v206, v206
    v_exp_f32 v207, v207
    v_mul_f32 v217, v217, v220
    v_cvt_pk_bf16_f32 v208, v192, v193
    v_cvt_pk_bf16_f32 v209, v194, v195
    v_cvt_pk_bf16_f32 v210, v196, v197
    v_cvt_pk_bf16_f32 v211, v198, v199
    v_cvt_pk_bf16_f32 v212, v200, v201
    v_cvt_pk_bf16_f32 v213, v202, v203
    v_cvt_pk_bf16_f32 v214, v204, v205
    v_cvt_pk_bf16_f32 v215, v206, v207
    v_mul_f32 v64, v64, v220
    v_mul_f32 v65, v65, v220
    v_mul_f32 v66, v66, v220
    v_mul_f32 v67, v67, v220
    v_mul_f32 v68, v68, v220
    v_mul_f32 v69, v69, v220
    v_mul_f32 v70, v70, v220
    v_mul_f32 v71, v71, v220
    v_mul_f32 v72, v72, v220
    v_mul_f32 v73, v73, v220
    v_mul_f32 v74, v74, v220
    v_mul_f32 v75, v75, v220
    v_mul_f32 v76, v76, v220
    v_mul_f32 v77, v77, v220
    v_mul_f32 v78, v78, v220
    v_mul_f32 v79, v79, v220
    s_waitcnt lgkmcnt(0)
    s_barrier
    v_mfma_f32_32x32x16_bf16 v[64:79], a[64:67], v[208:211], v[64:79]
    ds_read_b128 v[144:147], v29 offset:0
    v_mul_f32 v80, v80, v220
    v_mul_f32 v81, v81, v220
    ds_read_b128 v[148:151], v29 offset:1024
    buffer_load_dwordx4 v[244:247], v21, s[32:35], s58 offen nt
    v_mul_f32 v82, v82, v220
    v_mul_f32 v83, v83, v220
    ds_read_b128 v[152:155], v29 offset:2048
    v_mul_f32 v84, v84, v220
    v_mfma_f32_32x32x16_bf16 v[64:79], a[68:71], v[212:215], v[64:79]
    v_mul_f32 v85, v85, v220
    ds_read_b128 v[156:159], v29 offset:3072
    v_mul_f32 v86, v86, v220
    v_mul_f32 v87, v87, v220
    v_mul_f32 v88, v88, v220
    v_mul_f32 v89, v89, v220
    v_mul_f32 v90, v90, v220
    v_mul_f32 v91, v91, v220
    v_mul_f32 v92, v92, v220
    v_mul_f32 v93, v93, v220
    v_mul_f32 v94, v94, v220
    v_mul_f32 v95, v95, v220
    s_nop 1
    v_mfma_f32_32x32x16_bf16 v[80:95], a[72:75], v[208:211], v[80:95]
    ds_read_b128 v[160:163], v30 offset:0
    v_mul_f32 v96, v96, v220
    v_mul_f32 v97, v97, v220
    ds_read_b128 v[164:167], v30 offset:1024
    buffer_load_dwordx4 v[248:251], v22, s[32:35], s58 offen nt
    v_mul_f32 v98, v98, v220
    v_mul_f32 v99, v99, v220
    ds_read_b128 v[168:171], v30 offset:2048
    v_mul_f32 v100, v100, v220
    v_mfma_f32_32x32x16_bf16 v[80:95], a[76:79], v[212:215], v[80:95]
    v_mul_f32 v101, v101, v220
    ds_read_b128 v[172:175], v30 offset:3072
    v_mul_f32 v102, v102, v220
    v_mul_f32 v103, v103, v220
    v_mul_f32 v104, v104, v220
    v_mul_f32 v105, v105, v220
    v_mul_f32 v106, v106, v220
    v_mul_f32 v107, v107, v220
    v_mul_f32 v108, v108, v220
    v_mul_f32 v109, v109, v220
    v_mul_f32 v110, v110, v220
    v_mul_f32 v111, v111, v220
    s_nop 1
    v_mfma_f32_32x32x16_bf16 v[96:111], a[80:83], v[208:211], v[96:111]
    ds_read_b128 v[176:179], v31 offset:0
    v_mul_f32 v112, v112, v220
    v_mul_f32 v113, v113, v220
    ds_read_b128 v[180:183], v31 offset:1024
    v_mul_f32 v114, v114, v220
    v_mul_f32 v115, v115, v220
    ds_read_b128 v[184:187], v31 offset:2048
    v_mul_f32 v116, v116, v220
    v_mfma_f32_32x32x16_bf16 v[96:111], a[84:87], v[212:215], v[96:111]
    v_mul_f32 v117, v117, v220
    ds_read_b128 v[188:191], v31 offset:3072
    v_mul_f32 v118, v118, v220
    buffer_load_dwordx4 v[252:255], v23, s[32:35], s58 offen nt
    s_add_u32 s58, s58, 16384
    v_mul_f32 v119, v119, v220
    v_mul_f32 v120, v120, v220
    v_mul_f32 v121, v121, v220
    v_mul_f32 v122, v122, v220
    v_mul_f32 v123, v123, v220
    v_mul_f32 v124, v124, v220
    v_mul_f32 v125, v125, v220
    v_mul_f32 v126, v126, v220
    v_mul_f32 v127, v127, v220
    s_nop 1
    v_mfma_f32_32x32x16_bf16 v[112:127], a[88:91], v[208:211], v[112:127]
    v_add_f32 v192, v192, v200
    v_add_f32 v193, v193, v201
    v_add_f32 v194, v194, v202
    v_add_f32 v195, v195, v203
    v_add_f32 v196, v196, v204
    v_add_f32 v197, v197, v205
    v_add_f32 v198, v198, v206
    v_add_f32 v199, v199, v207
    v_mfma_f32_32x32x16_bf16 v[112:127], a[92:95], v[212:215], v[112:127]
    v_add_f32 v192, v192, v196
    v_add_f32 v193, v193, v197
    v_add_f32 v194, v194, v198
    v_add_f32 v195, v195, v199
    v_add_f32 v192, v192, v193
    v_add_f32 v194, v194, v195
    v_add_f32 v192, v192, v194
    v_add_f32 v217, v217, v192
    ds_read_b128 a[32:35], v32 offset:8192
    ds_read_b128 a[36:39], v33 offset:8192
    ds_read_b128 a[40:43], v34 offset:8192
    ds_read_b128 a[44:47], v35 offset:8192
    ds_read_b128 a[48:51], v36 offset:8192
    ds_read_b128 a[52:55], v37 offset:8192
    ds_read_b128 a[56:59], v38 offset:8192
    ds_read_b128 a[60:63], v39 offset:8192
    s_waitcnt lgkmcnt(8)
    v_add_f32 v144, v144, v128
    v_add_f32 v145, v145, v129
    v_add_f32 v146, v146, v130
    v_add_f32 v147, v147, v131
    buffer_load_dwordx4 a[96:99], v20, s[32:35], s58 offen nt
    v_add_f32 v148, v148, v132
    v_add_f32 v149, v149, v133
    v_add_f32 v150, v150, v134
    v_add_f32 v151, v151, v135
    v_add_f32 v152, v152, v136
    v_add_f32 v153, v153, v137
    v_add_f32 v154, v154, v138
    v_add_f32 v155, v155, v139
    v_add_f32 v156, v156, v140
    v_add_f32 v157, v157, v141
    v_add_f32 v158, v158, v142
    v_add_f32 v159, v159, v143
    s_waitcnt lgkmcnt(0)
    v_mfma_f32_32x32x16_bf16 v[128:143], a[32:35], a[0:3], 0
    ds_read_b64_tr_b16 a[64:65], v40 offset:0
    ds_read_b64_tr_b16 a[66:67], v41 offset:2048
    v_add_f32 v160, v160, v176
    v_add_f32 v161, v161, v177
    v_add_f32 v162, v162, v178
    v_add_f32 v163, v163, v179
    v_add_f32 v164, v164, v180
    v_mfma_f32_32x32x16_bf16 v[128:143], a[36:39], a[4:7], v[128:143]
    ds_read_b64_tr_b16 a[72:73], v42 offset:0
    ds_read_b64_tr_b16 a[74:75], v43 offset:2048
    v_add_f32 v165, v165, v181
    v_add_f32 v166, v166, v182
    v_add_f32 v167, v167, v183
    v_add_f32 v168, v168, v184
    v_add_f32 v169, v169, v185
    v_mfma_f32_32x32x16_bf16 v[128:143], a[40:43], a[8:11], v[128:143]
    ds_read_b64_tr_b16 a[80:81], v44 offset:0
    ds_read_b64_tr_b16 a[82:83], v45 offset:2048
    v_add_f32 v170, v170, v186
    v_add_f32 v171, v171, v187
    v_add_f32 v172, v172, v188
    v_add_f32 v173, v173, v189
    v_add_f32 v174, v174, v190
    v_mfma_f32_32x32x16_bf16 v[128:143], a[44:47], a[12:15], v[128:143]
    ds_read_b64_tr_b16 a[88:89], v46 offset:0
    ds_read_b64_tr_b16 a[90:91], v47 offset:2048
    v_add_f32 v175, v175, v191
    v_add_f32 v144, v144, v160
    v_add_f32 v145, v145, v161
    v_add_f32 v146, v146, v162
    v_add_f32 v147, v147, v163
    v_mfma_f32_32x32x16_bf16 v[128:143], a[48:51], a[16:19], v[128:143]
    ds_read_b64_tr_b16 a[68:69], v40 offset:4096
    ds_read_b64_tr_b16 a[70:71], v41 offset:6144
    v_add_f32 v148, v148, v164
    v_add_f32 v149, v149, v165
    v_add_f32 v150, v150, v166
    v_add_f32 v151, v151, v167
    v_add_f32 v152, v152, v168
    v_mfma_f32_32x32x16_bf16 v[128:143], a[52:55], a[20:23], v[128:143]
    ds_read_b64_tr_b16 a[76:77], v42 offset:4096
    ds_read_b64_tr_b16 a[78:79], v43 offset:6144
    v_add_f32 v153, v153, v169
    v_add_f32 v154, v154, v170
    v_add_f32 v155, v155, v171
    v_add_f32 v156, v156, v172
    v_add_f32 v157, v157, v173
    v_mfma_f32_32x32x16_bf16 v[128:143], a[56:59], a[24:27], v[128:143]
    ds_read_b64_tr_b16 a[84:85], v44 offset:4096
    ds_read_b64_tr_b16 a[86:87], v45 offset:6144
    v_add_f32 v158, v158, v174
    v_add_f32 v159, v159, v175
    v_max3_f32 v218, v144, v145, v146
    v_max3_f32 v219, v147, v148, v149
    v_max3_f32 v220, v150, v151, v152
    v_mfma_f32_32x32x16_bf16 v[128:143], a[60:63], a[28:31], v[128:143]
    ds_read_b64_tr_b16 a[92:93], v46 offset:4096
    ds_read_b64_tr_b16 a[94:95], v47 offset:6144
    v_max3_f32 v221, v153, v154, v155
    v_max3_f32 v218, v218, v156, v157
    v_max3_f32 v219, v219, v158, v159
    v_max3_f32 v218, v218, v219, v220
    v_max_f32 v218, v218, v221
    v_mov_b32 v219, v218
    s_nop 1
    v_permlane32_swap_b32 v218, v219
    v_max3_f32 v218, v218, v219, v216
    v_sub_f32 v220, v216, v218
    v_mov_b32 v216, v218
    v_exp_f32 v220, v220
    v_sub_f32 v192, v144, v218
    v_sub_f32 v193, v145, v218
    buffer_load_dwordx4 a[100:103], v21, s[32:35], s58 offen nt
    v_sub_f32 v194, v146, v218
    v_sub_f32 v195, v147, v218
    v_sub_f32 v196, v148, v218
    v_sub_f32 v197, v149, v218
    v_sub_f32 v198, v150, v218
    buffer_load_dwordx4 a[104:107], v22, s[32:35], s58 offen nt
    v_sub_f32 v199, v151, v218
    v_sub_f32 v200, v152, v218
    v_sub_f32 v201, v153, v218
    v_sub_f32 v202, v154, v218
    v_sub_f32 v203, v155, v218
    v_sub_f32 v204, v156, v218
    v_sub_f32 v205, v157, v218
    v_sub_f32 v206, v158, v218
    v_sub_f32 v207, v159, v218
    ds_write_b128 v28, v[128:131] offset:16384
    v_exp_f32 v192, v192
    v_exp_f32 v193, v193
    v_exp_f32 v194, v194
    v_exp_f32 v195, v195
    ds_write_b128 v28, v[132:135] offset:17408
    v_exp_f32 v196, v196
    v_exp_f32 v197, v197
    v_exp_f32 v198, v198
    v_exp_f32 v199, v199
    ds_write_b128 v28, v[136:139] offset:18432
    v_exp_f32 v200, v200
    v_exp_f32 v201, v201
    v_exp_f32 v202, v202
    v_exp_f32 v203, v203
    ds_write_b128 v28, v[140:143] offset:19456
    v_exp_f32 v204, v204
    v_exp_f32 v205, v205
    v_exp_f32 v206, v206
    v_exp_f32 v207, v207
    v_mul_f32 v217, v217, v220
    v_cvt_pk_bf16_f32 v208, v192, v193
    v_cvt_pk_bf16_f32 v209, v194, v195
    v_cvt_pk_bf16_f32 v210, v196, v197
    v_cvt_pk_bf16_f32 v211, v198, v199
    v_cvt_pk_bf16_f32 v212, v200, v201
    v_cvt_pk_bf16_f32 v213, v202, v203
    v_cvt_pk_bf16_f32 v214, v204, v205
    v_cvt_pk_bf16_f32 v215, v206, v207
    v_mul_f32 v64, v64, v220
    v_mul_f32 v65, v65, v220
    v_mul_f32 v66, v66, v220
    v_mul_f32 v67, v67, v220
    v_mul_f32 v68, v68, v220
    v_mul_f32 v69, v69, v220
    v_mul_f32 v70, v70, v220
    v_mul_f32 v71, v71, v220
    v_mul_f32 v72, v72, v220
    v_mul_f32 v73, v73, v220
    v_mul_f32 v74, v74, v220
    v_mul_f32 v75, v75, v220
    v_mul_f32 v76, v76, v220
    v_mul_f32 v77, v77, v220
    v_mul_f32 v78, v78, v220
    v_mul_f32 v79, v79, v220
    s_waitcnt lgkmcnt(0)
    s_barrier
    v_mfma_f32_32x32x16_bf16 v[64:79], a[64:67], v[208:211], v[64:79]
    ds_read_b128 v[144:147], v29 offset:16384
    v_mul_f32 v80, v80, v220
    v_mul_f32 v81, v81, v220
    ds_read_b128 v[148:151], v29 offset:17408
    buffer_load_dwordx4 a[108:111], v23, s[32:35], s58 offen nt
    s_add_u32 s58, s58, 16384
    v_mul_f32 v82, v82, v220
    v_mul_f32 v83, v83, v220
    ds_read_b128 v[152:155], v29 offset:18432
    v_mul_f32 v84, v84, v220
    v_mfma_f32_32x32x16_bf16 v[64:79], a[68:71], v[212:215], v[64:79]
    v_mul_f32 v85, v85, v220
    ds_read_b128 v[156:159], v29 offset:19456
    v_mul_f32 v86, v86, v220
    v_mul_f32 v87, v87, v220
    v_mul_f32 v88, v88, v220
    v_mul_f32 v89, v89, v220
    v_mul_f32 v90, v90, v220
    v_mul_f32 v91, v91, v220
    v_mul_f32 v92, v92, v220
    v_mul_f32 v93, v93, v220
    v_mul_f32 v94, v94, v220
    v_mul_f32 v95, v95, v220
    s_nop 1
    v_mfma_f32_32x32x16_bf16 v[80:95], a[72:75], v[208:211], v[80:95]
    ds_read_b128 v[160:163], v30 offset:16384
    v_mul_f32 v96, v96, v220
    v_mul_f32 v97, v97, v220
    ds_read_b128 v[164:167], v30 offset:17408
    buffer_load_dwordx4 a[112:115], v20, s[32:35], s58 offen nt
    v_mul_f32 v98, v98, v220
    v_mul_f32 v99, v99, v220
    ds_read_b128 v[168:171], v30 offset:18432
    v_mul_f32 v100, v100, v220
    v_mfma_f32_32x32x16_bf16 v[80:95], a[76:79], v[212:215], v[80:95]
    v_mul_f32 v101, v101, v220
    ds_read_b128 v[172:175], v30 offset:19456
    v_mul_f32 v102, v102, v220
    v_mul_f32 v103, v103, v220
    v_mul_f32 v104, v104, v220
    v_mul_f32 v105, v105, v220
    v_mul_f32 v106, v106, v220
    v_mul_f32 v107, v107, v220
    v_mul_f32 v108, v108, v220
    v_mul_f32 v109, v109, v220
    v_mul_f32 v110, v110, v220
    v_mul_f32 v111, v111, v220
    s_nop 1
    v_mfma_f32_32x32x16_bf16 v[96:111], a[80:83], v[208:211], v[96:111]
    ds_read_b128 v[176:179], v31 offset:16384
    v_mul_f32 v112, v112, v220
    v_mul_f32 v113, v113, v220
    ds_read_b128 v[180:183], v31 offset:17408
    v_mul_f32 v114, v114, v220
    v_mul_f32 v115, v115, v220
    ds_read_b128 v[184:187], v31 offset:18432
    v_mul_f32 v116, v116, v220
    v_mfma_f32_32x32x16_bf16 v[96:111], a[84:87], v[212:215], v[96:111]
    v_mul_f32 v117, v117, v220
    ds_read_b128 v[188:191], v31 offset:19456
    v_mul_f32 v118, v118, v220
    buffer_load_dwordx4 a[116:119], v21, s[32:35], s58 offen nt
    v_mul_f32 v119, v119, v220
    v_mul_f32 v120, v120, v220
    v_mul_f32 v121, v121, v220
    v_mul_f32 v122, v122, v220
    v_mul_f32 v123, v123, v220
    v_mul_f32 v124, v124, v220
    v_mul_f32 v125, v125, v220
    v_mul_f32 v126, v126, v220
    v_mul_f32 v127, v127, v220
    s_nop 1
    v_mfma_f32_32x32x16_bf16 v[112:127], a[88:91], v[208:211], v[112:127]
    v_add_f32 v192, v192, v200
    v_add_f32 v193, v193, v201
    v_add_f32 v194, v194, v202
    v_add_f32 v195, v195, v203
    v_add_f32 v196, v196, v204
    v_add_f32 v197, v197, v205
    v_add_f32 v198, v198, v206
    v_add_f32 v199, v199, v207
    v_mfma_f32_32x32x16_bf16 v[112:127], a[92:95], v[212:215], v[112:127]
    v_add_f32 v192, v192, v196
    v_add_f32 v193, v193, v197
    v_add_f32 v194, v194, v198
    v_add_f32 v195, v195, v199
    v_add_f32 v192, v192, v193
    v_add_f32 v194, v194, v195
    v_add_f32 v192, v192, v194
    v_add_f32 v217, v217, v192
    ds_read_b128 a[32:35], v32 offset:16384
    ds_read_b128 a[36:39], v33 offset:16384
    ds_read_b128 a[40:43], v34 offset:16384
    ds_read_b128 a[44:47], v35 offset:16384
    ds_read_b128 a[48:51], v36 offset:16384
    ds_read_b128 a[52:55], v37 offset:16384
    ds_read_b128 a[56:59], v38 offset:16384
    ds_read_b128 a[60:63], v39 offset:16384
    s_waitcnt lgkmcnt(8)
    v_add_f32 v144, v144, v128
    v_add_f32 v145, v145, v129
    v_add_f32 v146, v146, v130
    v_add_f32 v147, v147, v131
    buffer_load_dwordx4 a[120:123], v22, s[32:35], s58 offen nt
    v_add_f32 v148, v148, v132
    v_add_f32 v149, v149, v133
    v_add_f32 v150, v150, v134
    v_add_f32 v151, v151, v135
    v_add_f32 v152, v152, v136
    v_add_f32 v153, v153, v137
    v_add_f32 v154, v154, v138
    v_add_f32 v155, v155, v139
    v_add_f32 v156, v156, v140
    v_add_f32 v157, v157, v141
    v_add_f32 v158, v158, v142
    v_add_f32 v159, v159, v143
    s_waitcnt lgkmcnt(0)
    v_mfma_f32_32x32x16_bf16 v[128:143], a[32:35], a[0:3], 0
    ds_read_b64_tr_b16 a[64:65], v40 offset:8192
    ds_read_b64_tr_b16 a[66:67], v41 offset:10240
    v_add_f32 v160, v160, v176
    v_add_f32 v161, v161, v177
    v_add_f32 v162, v162, v178
    v_add_f32 v163, v163, v179
    v_add_f32 v164, v164, v180
    v_mfma_f32_32x32x16_bf16 v[128:143], a[36:39], a[4:7], v[128:143]
    ds_read_b64_tr_b16 a[72:73], v42 offset:8192
    ds_read_b64_tr_b16 a[74:75], v43 offset:10240
    v_add_f32 v165, v165, v181
    v_add_f32 v166, v166, v182
    v_add_f32 v167, v167, v183
    v_add_f32 v168, v168, v184
    v_add_f32 v169, v169, v185
    v_mfma_f32_32x32x16_bf16 v[128:143], a[40:43], a[8:11], v[128:143]
    ds_read_b64_tr_b16 a[80:81], v44 offset:8192
    ds_read_b64_tr_b16 a[82:83], v45 offset:10240
    v_add_f32 v170, v170, v186
    v_add_f32 v171, v171, v187
    v_add_f32 v172, v172, v188
    v_add_f32 v173, v173, v189
    v_add_f32 v174, v174, v190
    v_mfma_f32_32x32x16_bf16 v[128:143], a[44:47], a[12:15], v[128:143]
    ds_read_b64_tr_b16 a[88:89], v46 offset:8192
    ds_read_b64_tr_b16 a[90:91], v47 offset:10240
    v_add_f32 v175, v175, v191
    v_add_f32 v144, v144, v160
    v_add_f32 v145, v145, v161
    v_add_f32 v146, v146, v162
    v_add_f32 v147, v147, v163
    v_mfma_f32_32x32x16_bf16 v[128:143], a[48:51], a[16:19], v[128:143]
    ds_read_b64_tr_b16 a[68:69], v40 offset:12288
    ds_read_b64_tr_b16 a[70:71], v41 offset:14336
    v_add_f32 v148, v148, v164
    v_add_f32 v149, v149, v165
    v_add_f32 v150, v150, v166
    v_add_f32 v151, v151, v167
    v_add_f32 v152, v152, v168
    v_mfma_f32_32x32x16_bf16 v[128:143], a[52:55], a[20:23], v[128:143]
    ds_read_b64_tr_b16 a[76:77], v42 offset:12288
    ds_read_b64_tr_b16 a[78:79], v43 offset:14336
    v_add_f32 v153, v153, v169
    v_add_f32 v154, v154, v170
    v_add_f32 v155, v155, v171
    v_add_f32 v156, v156, v172
    v_add_f32 v157, v157, v173
    v_mfma_f32_32x32x16_bf16 v[128:143], a[56:59], a[24:27], v[128:143]
    ds_read_b64_tr_b16 a[84:85], v44 offset:12288
    ds_read_b64_tr_b16 a[86:87], v45 offset:14336
    v_add_f32 v158, v158, v174
    v_add_f32 v159, v159, v175
    v_max3_f32 v218, v144, v145, v146
    v_max3_f32 v219, v147, v148, v149
    v_max3_f32 v220, v150, v151, v152
    v_mfma_f32_32x32x16_bf16 v[128:143], a[60:63], a[28:31], v[128:143]
    ds_read_b64_tr_b16 a[92:93], v46 offset:12288
    ds_read_b64_tr_b16 a[94:95], v47 offset:14336
    v_max3_f32 v221, v153, v154, v155
    v_max3_f32 v218, v218, v156, v157
    v_max3_f32 v219, v219, v158, v159
    v_max3_f32 v218, v218, v219, v220
    v_max_f32 v218, v218, v221
    v_mov_b32 v219, v218
    s_nop 1
    v_permlane32_swap_b32 v218, v219
    v_max3_f32 v218, v218, v219, v216
    v_sub_f32 v220, v216, v218
    v_mov_b32 v216, v218
    v_exp_f32 v220, v220
    v_sub_f32 v192, v144, v218
    v_sub_f32 v193, v145, v218
    buffer_load_dwordx4 a[124:127], v23, s[32:35], s58 offen nt
    s_add_u32 s58, s58, 16384
    v_sub_f32 v194, v146, v218
    v_sub_f32 v195, v147, v218
    v_sub_f32 v196, v148, v218
    v_sub_f32 v197, v149, v218
    v_sub_f32 v198, v150, v218
    buffer_load_dwordx4 a[128:131], v20, s[32:35], s58 offen nt
    v_sub_f32 v199, v151, v218
    v_sub_f32 v200, v152, v218
    v_sub_f32 v201, v153, v218
    v_sub_f32 v202, v154, v218
    v_sub_f32 v203, v155, v218
    v_sub_f32 v204, v156, v218
    v_sub_f32 v205, v157, v218
    v_sub_f32 v206, v158, v218
    v_sub_f32 v207, v159, v218
    ds_write_b128 v28, v[128:131] offset:0
    v_exp_f32 v192, v192
    v_exp_f32 v193, v193
    v_exp_f32 v194, v194
    v_exp_f32 v195, v195
    ds_write_b128 v28, v[132:135] offset:1024
    v_exp_f32 v196, v196
    v_exp_f32 v197, v197
    v_exp_f32 v198, v198
    v_exp_f32 v199, v199
    ds_write_b128 v28, v[136:139] offset:2048
    v_exp_f32 v200, v200
    v_exp_f32 v201, v201
    v_exp_f32 v202, v202
    v_exp_f32 v203, v203
    ds_write_b128 v28, v[140:143] offset:3072
    v_exp_f32 v204, v204
    v_exp_f32 v205, v205
    v_exp_f32 v206, v206
    v_exp_f32 v207, v207
    v_mul_f32 v217, v217, v220
    v_cvt_pk_bf16_f32 v208, v192, v193
    v_cvt_pk_bf16_f32 v209, v194, v195
    v_cvt_pk_bf16_f32 v210, v196, v197
    v_cvt_pk_bf16_f32 v211, v198, v199
    v_cvt_pk_bf16_f32 v212, v200, v201
    v_cvt_pk_bf16_f32 v213, v202, v203
    v_cvt_pk_bf16_f32 v214, v204, v205
    v_cvt_pk_bf16_f32 v215, v206, v207
    v_mul_f32 v64, v64, v220
    v_mul_f32 v65, v65, v220
    v_mul_f32 v66, v66, v220
    v_mul_f32 v67, v67, v220
    v_mul_f32 v68, v68, v220
    v_mul_f32 v69, v69, v220
    v_mul_f32 v70, v70, v220
    v_mul_f32 v71, v71, v220
    v_mul_f32 v72, v72, v220
    v_mul_f32 v73, v73, v220
    v_mul_f32 v74, v74, v220
    v_mul_f32 v75, v75, v220
    v_mul_f32 v76, v76, v220
    v_mul_f32 v77, v77, v220
    v_mul_f32 v78, v78, v220
    v_mul_f32 v79, v79, v220
    s_waitcnt lgkmcnt(0)
    s_barrier
    v_mfma_f32_32x32x16_bf16 v[64:79], a[64:67], v[208:211], v[64:79]
    ds_read_b128 v[144:147], v29 offset:0
    v_mul_f32 v80, v80, v220
    v_mul_f32 v81, v81, v220
    ds_read_b128 v[148:151], v29 offset:1024
    s_waitcnt vmcnt(32)
    ds_write_b128 v26, a[192:195] offset:24576
    buffer_load_dwordx4 a[132:135], v21, s[32:35], s58 offen nt
    v_mul_f32 v82, v82, v220
    v_mul_f32 v83, v83, v220
    ds_read_b128 v[152:155], v29 offset:2048
    v_mul_f32 v84, v84, v220
    v_mfma_f32_32x32x16_bf16 v[64:79], a[68:71], v[212:215], v[64:79]
    v_mul_f32 v85, v85, v220
    ds_read_b128 v[156:159], v29 offset:3072
    v_mul_f32 v86, v86, v220
    s_waitcnt vmcnt(32)
    ds_write_b128 v26, a[196:199] offset:25600
    v_mul_f32 v87, v87, v220
    v_mul_f32 v88, v88, v220
    v_mul_f32 v89, v89, v220
    v_mul_f32 v90, v90, v220
    v_mul_f32 v91, v91, v220
    v_mul_f32 v92, v92, v220
    v_mul_f32 v93, v93, v220
    v_mul_f32 v94, v94, v220
    v_mul_f32 v95, v95, v220
    s_nop 1
    v_mfma_f32_32x32x16_bf16 v[80:95], a[72:75], v[208:211], v[80:95]
    ds_read_b128 v[160:163], v30 offset:0
    v_mul_f32 v96, v96, v220
    v_mul_f32 v97, v97, v220
    ds_read_b128 v[164:167], v30 offset:1024
    s_waitcnt vmcnt(31)
    ds_write_b128 v26, a[200:203] offset:26624
    buffer_load_dwordx4 a[136:139], v22, s[32:35], s58 offen nt
    v_mul_f32 v98, v98, v220
    v_mul_f32 v99, v99, v220
    ds_read_b128 v[168:171], v30 offset:2048
    v_mul_f32 v100, v100, v220
    v_mfma_f32_32x32x16_bf16 v[80:95], a[76:79], v[212:215], v[80:95]
    v_mul_f32 v101, v101, v220
    ds_read_b128 v[172:175], v30 offset:3072
    v_mul_f32 v102, v102, v220
    s_waitcnt vmcnt(31)
    ds_write_b128 v26, a[204:207] offset:27648
    v_mul_f32 v103, v103, v220
    v_mul_f32 v104, v104, v220
    v_mul_f32 v105, v105, v220
    v_mul_f32 v106, v106, v220
    v_mul_f32 v107, v107, v220
    v_mul_f32 v108, v108, v220
    v_mul_f32 v109, v109, v220
    v_mul_f32 v110, v110, v220
    v_mul_f32 v111, v111, v220
    s_nop 1
    v_mfma_f32_32x32x16_bf16 v[96:111], a[80:83], v[208:211], v[96:111]
    ds_read_b128 v[176:179], v31 offset:0
    v_mul_f32 v112, v112, v220
    v_mul_f32 v113, v113, v220
    ds_read_b128 v[180:183], v31 offset:1024
    s_waitcnt vmcnt(30)
    ds_write_b128 v26, a[208:211] offset:28672
    v_mul_f32 v114, v114, v220
    v_mul_f32 v115, v115, v220
    ds_read_b128 v[184:187], v31 offset:2048
    v_mul_f32 v116, v116, v220
    v_mfma_f32_32x32x16_bf16 v[96:111], a[84:87], v[212:215], v[96:111]
    v_mul_f32 v117, v117, v220
    ds_read_b128 v[188:191], v31 offset:3072
    v_mul_f32 v118, v118, v220
    s_waitcnt vmcnt(29)
    ds_write_b128 v26, a[212:215] offset:29696
    buffer_load_dwordx4 a[140:143], v23, s[32:35], s58 offen nt
    s_add_u32 s58, s58, 16384
    v_mul_f32 v119, v119, v220
    v_mul_f32 v120, v120, v220
    v_mul_f32 v121, v121, v220
    v_mul_f32 v122, v122, v220
    v_mul_f32 v123, v123, v220
    v_mul_f32 v124, v124, v220
    v_mul_f32 v125, v125, v220
    v_mul_f32 v126, v126, v220
    v_mul_f32 v127, v127, v220
    s_nop 1
    v_mfma_f32_32x32x16_bf16 v[112:127], a[88:91], v[208:211], v[112:127]
    v_add_f32 v192, v192, v200
    v_add_f32 v193, v193, v201
    v_add_f32 v194, v194, v202
    v_add_f32 v195, v195, v203
    s_waitcnt vmcnt(29)
    ds_write_b128 v26, a[216:219] offset:30720
    v_add_f32 v196, v196, v204
    v_add_f32 v197, v197, v205
    v_add_f32 v198, v198, v206
    v_add_f32 v199, v199, v207
    v_mfma_f32_32x32x16_bf16 v[112:127], a[92:95], v[212:215], v[112:127]
    v_add_f32 v192, v192, v196
    v_add_f32 v193, v193, v197
    v_add_f32 v194, v194, v198
    s_waitcnt vmcnt(28)
    ds_write_b128 v26, a[220:223] offset:31744
    v_add_f32 v195, v195, v199
    v_add_f32 v192, v192, v193
    v_add_f32 v194, v194, v195
    v_add_f32 v192, v192, v194
    v_add_f32 v217, v217, v192
    ds_read_b128 a[32:35], v32 offset:24576
    ds_read_b128 a[36:39], v33 offset:24576
    ds_read_b128 a[40:43], v34 offset:24576
    ds_read_b128 a[44:47], v35 offset:24576
    ds_read_b128 a[48:51], v36 offset:24576
    ds_read_b128 a[52:55], v37 offset:24576
    ds_read_b128 a[56:59], v38 offset:24576
    ds_read_b128 a[60:63], v39 offset:24576
    s_waitcnt lgkmcnt(8)
    v_add_f32 v144, v144, v128
    v_add_f32 v145, v145, v129
    v_add_f32 v146, v146, v130
    v_add_f32 v147, v147, v131
    buffer_load_dwordx4 a[144:147], v20, s[32:35], s58 offen nt
    v_add_f32 v148, v148, v132
    v_add_f32 v149, v149, v133
    v_add_f32 v150, v150, v134
    v_add_f32 v151, v151, v135
    v_add_f32 v152, v152, v136
    v_add_f32 v153, v153, v137
    v_add_f32 v154, v154, v138
    v_add_f32 v155, v155, v139
    v_add_f32 v156, v156, v140
    v_add_f32 v157, v157, v141
    v_add_f32 v158, v158, v142
    v_add_f32 v159, v159, v143
    s_waitcnt lgkmcnt(0)
    v_mfma_f32_32x32x16_bf16 v[128:143], a[32:35], a[0:3], 0
    ds_read_b64_tr_b16 a[64:65], v40 offset:16384
    ds_read_b64_tr_b16 a[66:67], v41 offset:18432
    v_add_f32 v160, v160, v176
    v_add_f32 v161, v161, v177
    v_add_f32 v162, v162, v178
    v_add_f32 v163, v163, v179
    v_add_f32 v164, v164, v180
    v_mfma_f32_32x32x16_bf16 v[128:143], a[36:39], a[4:7], v[128:143]
    ds_read_b64_tr_b16 a[72:73], v42 offset:16384
    ds_read_b64_tr_b16 a[74:75], v43 offset:18432
    v_add_f32 v165, v165, v181
    v_add_f32 v166, v166, v182
    v_add_f32 v167, v167, v183
    v_add_f32 v168, v168, v184
    v_add_f32 v169, v169, v185
    v_mfma_f32_32x32x16_bf16 v[128:143], a[40:43], a[8:11], v[128:143]
    ds_read_b64_tr_b16 a[80:81], v44 offset:16384
    ds_read_b64_tr_b16 a[82:83], v45 offset:18432
    v_add_f32 v170, v170, v186
    v_add_f32 v171, v171, v187
    v_add_f32 v172, v172, v188
    v_add_f32 v173, v173, v189
    v_add_f32 v174, v174, v190
    v_mfma_f32_32x32x16_bf16 v[128:143], a[44:47], a[12:15], v[128:143]
    ds_read_b64_tr_b16 a[88:89], v46 offset:16384
    ds_read_b64_tr_b16 a[90:91], v47 offset:18432
    v_add_f32 v175, v175, v191
    v_add_f32 v144, v144, v160
    v_add_f32 v145, v145, v161
    v_add_f32 v146, v146, v162
    v_add_f32 v147, v147, v163
    v_mfma_f32_32x32x16_bf16 v[128:143], a[48:51], a[16:19], v[128:143]
    ds_read_b64_tr_b16 a[68:69], v40 offset:20480
    ds_read_b64_tr_b16 a[70:71], v41 offset:22528
    v_add_f32 v148, v148, v164
    v_add_f32 v149, v149, v165
    v_add_f32 v150, v150, v166
    v_add_f32 v151, v151, v167
    v_add_f32 v152, v152, v168
    v_mfma_f32_32x32x16_bf16 v[128:143], a[52:55], a[20:23], v[128:143]
    ds_read_b64_tr_b16 a[76:77], v42 offset:20480
    ds_read_b64_tr_b16 a[78:79], v43 offset:22528
    v_add_f32 v153, v153, v169
    v_add_f32 v154, v154, v170
    v_add_f32 v155, v155, v171
    v_add_f32 v156, v156, v172
    v_add_f32 v157, v157, v173
    v_mfma_f32_32x32x16_bf16 v[128:143], a[56:59], a[24:27], v[128:143]
    ds_read_b64_tr_b16 a[84:85], v44 offset:20480
    ds_read_b64_tr_b16 a[86:87], v45 offset:22528
    v_add_f32 v158, v158, v174
    v_add_f32 v159, v159, v175
    v_max3_f32 v218, v144, v145, v146
    v_max3_f32 v219, v147, v148, v149
    v_max3_f32 v220, v150, v151, v152
    v_mfma_f32_32x32x16_bf16 v[128:143], a[60:63], a[28:31], v[128:143]
    ds_read_b64_tr_b16 a[92:93], v46 offset:20480
    ds_read_b64_tr_b16 a[94:95], v47 offset:22528
    v_max3_f32 v221, v153, v154, v155
    v_max3_f32 v218, v218, v156, v157
    v_max3_f32 v219, v219, v158, v159
    v_max3_f32 v218, v218, v219, v220
    v_max_f32 v218, v218, v221
    v_mov_b32 v219, v218
    s_nop 1
    v_permlane32_swap_b32 v218, v219
    v_max3_f32 v218, v218, v219, v216
    v_sub_f32 v220, v216, v218
    v_mov_b32 v216, v218
    v_exp_f32 v220, v220
    v_sub_f32 v192, v144, v218
    v_sub_f32 v193, v145, v218
    buffer_load_dwordx4 a[148:151], v21, s[32:35], s58 offen nt
    v_sub_f32 v194, v146, v218
    v_sub_f32 v195, v147, v218
    v_sub_f32 v196, v148, v218
    v_sub_f32 v197, v149, v218
    v_sub_f32 v198, v150, v218
    buffer_load_dwordx4 a[152:155], v22, s[32:35], s58 offen nt
    v_sub_f32 v199, v151, v218
    v_sub_f32 v200, v152, v218
    v_sub_f32 v201, v153, v218
    v_sub_f32 v202, v154, v218
    v_sub_f32 v203, v155, v218
    v_sub_f32 v204, v156, v218
    v_sub_f32 v205, v157, v218
    v_sub_f32 v206, v158, v218
    v_sub_f32 v207, v159, v218
    ds_write_b128 v28, v[128:131] offset:16384
    v_exp_f32 v192, v192
    v_exp_f32 v193, v193
    v_exp_f32 v194, v194
    v_exp_f32 v195, v195
    ds_write_b128 v28, v[132:135] offset:17408
    v_exp_f32 v196, v196
    v_exp_f32 v197, v197
    v_exp_f32 v198, v198
    v_exp_f32 v199, v199
    ds_write_b128 v28, v[136:139] offset:18432
    v_exp_f32 v200, v200
    v_exp_f32 v201, v201
    v_exp_f32 v202, v202
    v_exp_f32 v203, v203
    ds_write_b128 v28, v[140:143] offset:19456
    v_exp_f32 v204, v204
    v_exp_f32 v205, v205
    v_exp_f32 v206, v206
    v_exp_f32 v207, v207
    v_mul_f32 v217, v217, v220
    v_cvt_pk_bf16_f32 v208, v192, v193
    v_cvt_pk_bf16_f32 v209, v194, v195
    v_cvt_pk_bf16_f32 v210, v196, v197
    v_cvt_pk_bf16_f32 v211, v198, v199
    v_cvt_pk_bf16_f32 v212, v200, v201
    v_cvt_pk_bf16_f32 v213, v202, v203
    v_cvt_pk_bf16_f32 v214, v204, v205
    v_cvt_pk_bf16_f32 v215, v206, v207
    v_mul_f32 v64, v64, v220
    v_mul_f32 v65, v65, v220
    v_mul_f32 v66, v66, v220
    v_mul_f32 v67, v67, v220
    v_mul_f32 v68, v68, v220
    v_mul_f32 v69, v69, v220
    v_mul_f32 v70, v70, v220
    v_mul_f32 v71, v71, v220
    v_mul_f32 v72, v72, v220
    v_mul_f32 v73, v73, v220
    v_mul_f32 v74, v74, v220
    v_mul_f32 v75, v75, v220
    v_mul_f32 v76, v76, v220
    v_mul_f32 v77, v77, v220
    v_mul_f32 v78, v78, v220
    v_mul_f32 v79, v79, v220
    s_waitcnt lgkmcnt(0)
    s_barrier
    v_mfma_f32_32x32x16_bf16 v[64:79], a[64:67], v[208:211], v[64:79]
    ds_read_b128 v[144:147], v29 offset:16384
    v_mul_f32 v80, v80, v220
    v_mul_f32 v81, v81, v220
    ds_read_b128 v[148:151], v29 offset:17408
    s_waitcnt vmcnt(30)
    ds_write_b128 v26, a[224:227] offset:0
    buffer_load_dwordx4 a[156:159], v23, s[32:35], s58 offen nt
    s_add_u32 s58, s58, 16384
    v_mul_f32 v82, v82, v220
    v_mul_f32 v83, v83, v220
    ds_read_b128 v[152:155], v29 offset:18432
    v_mul_f32 v84, v84, v220
    v_mfma_f32_32x32x16_bf16 v[64:79], a[68:71], v[212:215], v[64:79]
    v_mul_f32 v85, v85, v220
    ds_read_b128 v[156:159], v29 offset:19456
    v_mul_f32 v86, v86, v220
    s_waitcnt vmcnt(30)
    ds_write_b128 v26, a[228:231] offset:1024
    v_mul_f32 v87, v87, v220
    v_mul_f32 v88, v88, v220
    v_mul_f32 v89, v89, v220
    v_mul_f32 v90, v90, v220
    v_mul_f32 v91, v91, v220
    v_mul_f32 v92, v92, v220
    v_mul_f32 v93, v93, v220
    v_mul_f32 v94, v94, v220
    v_mul_f32 v95, v95, v220
    s_nop 1
    v_mfma_f32_32x32x16_bf16 v[80:95], a[72:75], v[208:211], v[80:95]
    ds_read_b128 v[160:163], v30 offset:16384
    v_mul_f32 v96, v96, v220
    v_mul_f32 v97, v97, v220
    ds_read_b128 v[164:167], v30 offset:17408
    s_waitcnt vmcnt(29)
    ds_write_b128 v26, a[232:235] offset:2048
    buffer_load_dwordx4 a[160:163], v20, s[32:35], s58 offen nt
    v_mul_f32 v98, v98, v220
    v_mul_f32 v99, v99, v220
    ds_read_b128 v[168:171], v30 offset:18432
    v_mul_f32 v100, v100, v220
    v_mfma_f32_32x32x16_bf16 v[80:95], a[76:79], v[212:215], v[80:95]
    v_mul_f32 v101, v101, v220
    ds_read_b128 v[172:175], v30 offset:19456
    v_mul_f32 v102, v102, v220
    s_waitcnt vmcnt(29)
    ds_write_b128 v26, a[236:239] offset:3072
    v_mul_f32 v103, v103, v220
    v_mul_f32 v104, v104, v220
    v_mul_f32 v105, v105, v220
    v_mul_f32 v106, v106, v220
    v_mul_f32 v107, v107, v220
    v_mul_f32 v108, v108, v220
    v_mul_f32 v109, v109, v220
    v_mul_f32 v110, v110, v220
    v_mul_f32 v111, v111, v220
    s_nop 1
    v_mfma_f32_32x32x16_bf16 v[96:111], a[80:83], v[208:211], v[96:111]
    ds_read_b128 v[176:179], v31 offset:16384
    v_mul_f32 v112, v112, v220
    v_mul_f32 v113, v113, v220
    ds_read_b128 v[180:183], v31 offset:17408
    s_waitcnt vmcnt(28)
    ds_write_b128 v26, a[240:243] offset:4096
    v_mul_f32 v114, v114, v220
    v_mul_f32 v115, v115, v220
    ds_read_b128 v[184:187], v31 offset:18432
    v_mul_f32 v116, v116, v220
    v_mfma_f32_32x32x16_bf16 v[96:111], a[84:87], v[212:215], v[96:111]
    v_mul_f32 v117, v117, v220
    ds_read_b128 v[188:191], v31 offset:19456
    v_mul_f32 v118, v118, v220
    s_waitcnt vmcnt(27)
    ds_write_b128 v26, a[244:247] offset:5120
    buffer_load_dwordx4 a[164:167], v21, s[32:35], s58 offen nt
    v_mul_f32 v119, v119, v220
    v_mul_f32 v120, v120, v220
    v_mul_f32 v121, v121, v220
    v_mul_f32 v122, v122, v220
    v_mul_f32 v123, v123, v220
    v_mul_f32 v124, v124, v220
    v_mul_f32 v125, v125, v220
    v_mul_f32 v126, v126, v220
    v_mul_f32 v127, v127, v220
    s_nop 1
    v_mfma_f32_32x32x16_bf16 v[112:127], a[88:91], v[208:211], v[112:127]
    v_add_f32 v192, v192, v200
    v_add_f32 v193, v193, v201
    v_add_f32 v194, v194, v202
    v_add_f32 v195, v195, v203
    s_waitcnt vmcnt(27)
    ds_write_b128 v26, a[248:251] offset:6144
    v_add_f32 v196, v196, v204
    v_add_f32 v197, v197, v205
    v_add_f32 v198, v198, v206
    v_add_f32 v199, v199, v207
    v_mfma_f32_32x32x16_bf16 v[112:127], a[92:95], v[212:215], v[112:127]
    v_add_f32 v192, v192, v196
    v_add_f32 v193, v193, v197
    v_add_f32 v194, v194, v198
    s_waitcnt vmcnt(26)
    ds_write_b128 v26, a[252:255] offset:7168
    v_add_f32 v195, v195, v199
    v_add_f32 v192, v192, v193
    v_add_f32 v194, v194, v195
    v_add_f32 v192, v192, v194
    v_add_f32 v217, v217, v192
    ds_read_b128 a[32:35], v32 offset:0
    ds_read_b128 a[36:39], v33 offset:0
    ds_read_b128 a[40:43], v34 offset:0
    ds_read_b128 a[44:47], v35 offset:0
    ds_read_b128 a[48:51], v36 offset:0
    ds_read_b128 a[52:55], v37 offset:0
    ds_read_b128 a[56:59], v38 offset:0
    ds_read_b128 a[60:63], v39 offset:0
    s_waitcnt lgkmcnt(8)
    v_add_f32 v144, v144, v128
    v_add_f32 v145, v145, v129
    v_add_f32 v146, v146, v130
    v_add_f32 v147, v147, v131
    buffer_load_dwordx4 a[168:171], v22, s[32:35], s58 offen nt
    v_add_f32 v148, v148, v132
    v_add_f32 v149, v149, v133
    v_add_f32 v150, v150, v134
    v_add_f32 v151, v151, v135
    v_add_f32 v152, v152, v136
    v_add_f32 v153, v153, v137
    v_add_f32 v154, v154, v138
    v_add_f32 v155, v155, v139
    v_add_f32 v156, v156, v140
    v_add_f32 v157, v157, v141
    v_add_f32 v158, v158, v142
    v_add_f32 v159, v159, v143
    s_waitcnt lgkmcnt(0)
    v_mfma_f32_32x32x16_bf16 v[128:143], a[32:35], a[0:3], 0
    ds_read_b64_tr_b16 a[64:65], v40 offset:24576
    ds_read_b64_tr_b16 a[66:67], v41 offset:26624
    v_add_f32 v160, v160, v176
    v_add_f32 v161, v161, v177
    v_add_f32 v162, v162, v178
    v_add_f32 v163, v163, v179
    v_add_f32 v164, v164, v180
    v_mfma_f32_32x32x16_bf16 v[128:143], a[36:39], a[4:7], v[128:143]
    ds_read_b64_tr_b16 a[72:73], v42 offset:24576
    ds_read_b64_tr_b16 a[74:75], v43 offset:26624
    v_add_f32 v165, v165, v181
    v_add_f32 v166, v166, v182
    v_add_f32 v167, v167, v183
    v_add_f32 v168, v168, v184
    v_add_f32 v169, v169, v185
    v_mfma_f32_32x32x16_bf16 v[128:143], a[40:43], a[8:11], v[128:143]
    ds_read_b64_tr_b16 a[80:81], v44 offset:24576
    ds_read_b64_tr_b16 a[82:83], v45 offset:26624
    v_add_f32 v170, v170, v186
    v_add_f32 v171, v171, v187
    v_add_f32 v172, v172, v188
    v_add_f32 v173, v173, v189
    v_add_f32 v174, v174, v190
    v_mfma_f32_32x32x16_bf16 v[128:143], a[44:47], a[12:15], v[128:143]
    ds_read_b64_tr_b16 a[88:89], v46 offset:24576
    ds_read_b64_tr_b16 a[90:91], v47 offset:26624
    v_add_f32 v175, v175, v191
    v_add_f32 v144, v144, v160
    v_add_f32 v145, v145, v161
    v_add_f32 v146, v146, v162
    v_add_f32 v147, v147, v163
    v_mfma_f32_32x32x16_bf16 v[128:143], a[48:51], a[16:19], v[128:143]
    ds_read_b64_tr_b16 a[68:69], v40 offset:28672
    ds_read_b64_tr_b16 a[70:71], v41 offset:30720
    v_add_f32 v148, v148, v164
    v_add_f32 v149, v149, v165
    v_add_f32 v150, v150, v166
    v_add_f32 v151, v151, v167
    v_add_f32 v152, v152, v168
    v_mfma_f32_32x32x16_bf16 v[128:143], a[52:55], a[20:23], v[128:143]
    ds_read_b64_tr_b16 a[76:77], v42 offset:28672
    ds_read_b64_tr_b16 a[78:79], v43 offset:30720
    v_add_f32 v153, v153, v169
    v_add_f32 v154, v154, v170
    v_add_f32 v155, v155, v171
    v_add_f32 v156, v156, v172
    v_add_f32 v157, v157, v173
    v_mfma_f32_32x32x16_bf16 v[128:143], a[56:59], a[24:27], v[128:143]
    ds_read_b64_tr_b16 a[84:85], v44 offset:28672
    ds_read_b64_tr_b16 a[86:87], v45 offset:30720
    v_add_f32 v158, v158, v174
    v_add_f32 v159, v159, v175
    v_max3_f32 v218, v144, v145, v146
    v_max3_f32 v219, v147, v148, v149
    v_max3_f32 v220, v150, v151, v152
    v_mfma_f32_32x32x16_bf16 v[128:143], a[60:63], a[28:31], v[128:143]
    ds_read_b64_tr_b16 a[92:93], v46 offset:28672
    ds_read_b64_tr_b16 a[94:95], v47 offset:30720
    v_max3_f32 v221, v153, v154, v155
    v_max3_f32 v218, v218, v156, v157
    v_max3_f32 v219, v219, v158, v159
    v_max3_f32 v218, v218, v219, v220
    v_max_f32 v218, v218, v221
    v_mov_b32 v219, v218
    s_nop 1
    v_permlane32_swap_b32 v218, v219
    v_max3_f32 v218, v218, v219, v216
    v_sub_f32 v220, v216, v218
    v_mov_b32 v216, v218
    v_exp_f32 v220, v220
    v_sub_f32 v192, v144, v218
    v_sub_f32 v193, v145, v218
    buffer_load_dwordx4 a[172:175], v23, s[32:35], s58 offen nt
    s_add_u32 s58, s58, 16384
    v_sub_f32 v194, v146, v218
    v_sub_f32 v195, v147, v218
    v_sub_f32 v196, v148, v218
    v_sub_f32 v197, v149, v218
    v_sub_f32 v198, v150, v218
    buffer_load_dwordx4 a[176:179], v20, s[32:35], s58 offen nt
    v_sub_f32 v199, v151, v218
    v_sub_f32 v200, v152, v218
    v_sub_f32 v201, v153, v218
    v_sub_f32 v202, v154, v218
    v_sub_f32 v203, v155, v218
    v_sub_f32 v204, v156, v218
    v_sub_f32 v205, v157, v218
    v_sub_f32 v206, v158, v218
    v_sub_f32 v207, v159, v218
    ds_write_b128 v28, v[128:131] offset:0
    v_exp_f32 v192, v192
    v_exp_f32 v193, v193
    v_exp_f32 v194, v194
    v_exp_f32 v195, v195
    ds_write_b128 v28, v[132:135] offset:1024
    v_exp_f32 v196, v196
    v_exp_f32 v197, v197
    v_exp_f32 v198, v198
    v_exp_f32 v199, v199
    ds_write_b128 v28, v[136:139] offset:2048
    v_exp_f32 v200, v200
    v_exp_f32 v201, v201
    v_exp_f32 v202, v202
    v_exp_f32 v203, v203
    ds_write_b128 v28, v[140:143] offset:3072
    v_exp_f32 v204, v204
    v_exp_f32 v205, v205
    v_exp_f32 v206, v206
    v_exp_f32 v207, v207
    v_mul_f32 v217, v217, v220
    v_cvt_pk_bf16_f32 v208, v192, v193
    v_cvt_pk_bf16_f32 v209, v194, v195
    v_cvt_pk_bf16_f32 v210, v196, v197
    v_cvt_pk_bf16_f32 v211, v198, v199
    v_cvt_pk_bf16_f32 v212, v200, v201
    v_cvt_pk_bf16_f32 v213, v202, v203
    v_cvt_pk_bf16_f32 v214, v204, v205
    v_cvt_pk_bf16_f32 v215, v206, v207
    v_mul_f32 v64, v64, v220
    v_mul_f32 v65, v65, v220
    v_mul_f32 v66, v66, v220
    v_mul_f32 v67, v67, v220
    v_mul_f32 v68, v68, v220
    v_mul_f32 v69, v69, v220
    v_mul_f32 v70, v70, v220
    v_mul_f32 v71, v71, v220
    v_mul_f32 v72, v72, v220
    v_mul_f32 v73, v73, v220
    v_mul_f32 v74, v74, v220
    v_mul_f32 v75, v75, v220
    v_mul_f32 v76, v76, v220
    v_mul_f32 v77, v77, v220
    v_mul_f32 v78, v78, v220
    v_mul_f32 v79, v79, v220
    s_waitcnt lgkmcnt(0)
    s_barrier
    v_mfma_f32_32x32x16_bf16 v[64:79], a[64:67], v[208:211], v[64:79]
    ds_read_b128 v[144:147], v29 offset:0
    v_mul_f32 v80, v80, v220
    v_mul_f32 v81, v81, v220
    ds_read_b128 v[148:151], v29 offset:1024
    s_waitcnt vmcnt(28)
    ds_write_b128 v26, v[224:227] offset:8192
    buffer_load_dwordx4 a[180:183], v21, s[32:35], s58 offen nt
    v_mul_f32 v82, v82, v220
    v_mul_f32 v83, v83, v220
    ds_read_b128 v[152:155], v29 offset:2048
    v_mul_f32 v84, v84, v220
    v_mfma_f32_32x32x16_bf16 v[64:79], a[68:71], v[212:215], v[64:79]
    v_mul_f32 v85, v85, v220
    ds_read_b128 v[156:159], v29 offset:3072
    v_mul_f32 v86, v86, v220
    s_waitcnt vmcnt(28)
    ds_write_b128 v26, v[228:231] offset:9216
    v_mul_f32 v87, v87, v220
    v_mul_f32 v88, v88, v220
    v_mul_f32 v89, v89, v220
    v_mul_f32 v90, v90, v220
    v_mul_f32 v91, v91, v220
    v_mul_f32 v92, v92, v220
    v_mul_f32 v93, v93, v220
    v_mul_f32 v94, v94, v220
    v_mul_f32 v95, v95, v220
    s_nop 1
    v_mfma_f32_32x32x16_bf16 v[80:95], a[72:75], v[208:211], v[80:95]
    ds_read_b128 v[160:163], v30 offset:0
    v_mul_f32 v96, v96, v220
    v_mul_f32 v97, v97, v220
    ds_read_b128 v[164:167], v30 offset:1024
    s_waitcnt vmcnt(27)
    ds_write_b128 v26, v[232:235] offset:10240
    buffer_load_dwordx4 a[184:187], v22, s[32:35], s58 offen nt
    v_mul_f32 v98, v98, v220
    v_mul_f32 v99, v99, v220
    ds_read_b128 v[168:171], v30 offset:2048
    v_mul_f32 v100, v100, v220
    v_mfma_f32_32x32x16_bf16 v[80:95], a[76:79], v[212:215], v[80:95]
    v_mul_f32 v101, v101, v220
    ds_read_b128 v[172:175], v30 offset:3072
    v_mul_f32 v102, v102, v220
    s_waitcnt vmcnt(27)
    ds_write_b128 v26, v[236:239] offset:11264
    v_mul_f32 v103, v103, v220
    v_mul_f32 v104, v104, v220
    v_mul_f32 v105, v105, v220
    v_mul_f32 v106, v106, v220
    v_mul_f32 v107, v107, v220
    v_mul_f32 v108, v108, v220
    v_mul_f32 v109, v109, v220
    v_mul_f32 v110, v110, v220
    v_mul_f32 v111, v111, v220
    s_nop 1
    v_mfma_f32_32x32x16_bf16 v[96:111], a[80:83], v[208:211], v[96:111]
    ds_read_b128 v[176:179], v31 offset:0
    v_mul_f32 v112, v112, v220
    v_mul_f32 v113, v113, v220
    ds_read_b128 v[180:183], v31 offset:1024
    s_waitcnt vmcnt(26)
    ds_write_b128 v26, v[240:243] offset:12288
    v_mul_f32 v114, v114, v220
    v_mul_f32 v115, v115, v220
    ds_read_b128 v[184:187], v31 offset:2048
    v_mul_f32 v116, v116, v220
    v_mfma_f32_32x32x16_bf16 v[96:111], a[84:87], v[212:215], v[96:111]
    v_mul_f32 v117, v117, v220
    ds_read_b128 v[188:191], v31 offset:3072
    v_mul_f32 v118, v118, v220
    s_waitcnt vmcnt(25)
    ds_write_b128 v26, v[244:247] offset:13312
    buffer_load_dwordx4 a[188:191], v23, s[32:35], s58 offen nt
    s_add_u32 s58, s58, 16384
    v_mul_f32 v119, v119, v220
    v_mul_f32 v120, v120, v220
    v_mul_f32 v121, v121, v220
    v_mul_f32 v122, v122, v220
    v_mul_f32 v123, v123, v220
    v_mul_f32 v124, v124, v220
    v_mul_f32 v125, v125, v220
    v_mul_f32 v126, v126, v220
    v_mul_f32 v127, v127, v220
    s_nop 1
    v_mfma_f32_32x32x16_bf16 v[112:127], a[88:91], v[208:211], v[112:127]
    v_add_f32 v192, v192, v200
    v_add_f32 v193, v193, v201
    v_add_f32 v194, v194, v202
    v_add_f32 v195, v195, v203
    s_waitcnt vmcnt(25)
    ds_write_b128 v26, v[248:251] offset:14336
    v_add_f32 v196, v196, v204
    v_add_f32 v197, v197, v205
    v_add_f32 v198, v198, v206
    v_add_f32 v199, v199, v207
    v_mfma_f32_32x32x16_bf16 v[112:127], a[92:95], v[212:215], v[112:127]
    v_add_f32 v192, v192, v196
    v_add_f32 v193, v193, v197
    v_add_f32 v194, v194, v198
    s_waitcnt vmcnt(24)
    ds_write_b128 v26, v[252:255] offset:15360
    v_add_f32 v195, v195, v199
    v_add_f32 v192, v192, v193
    v_add_f32 v194, v194, v195
    v_add_f32 v192, v192, v194
    v_add_f32 v217, v217, v192
    ds_read_b128 a[32:35], v32 offset:8192
    ds_read_b128 a[36:39], v33 offset:8192
    ds_read_b128 a[40:43], v34 offset:8192
    ds_read_b128 a[44:47], v35 offset:8192
    ds_read_b128 a[48:51], v36 offset:8192
    ds_read_b128 a[52:55], v37 offset:8192
    ds_read_b128 a[56:59], v38 offset:8192
    ds_read_b128 a[60:63], v39 offset:8192
    s_waitcnt lgkmcnt(8)
    v_add_f32 v144, v144, v128
    v_add_f32 v145, v145, v129
    v_add_f32 v146, v146, v130
    v_add_f32 v147, v147, v131
    buffer_load_dwordx4 a[192:195], v20, s[32:35], s58 offen nt
    v_add_f32 v148, v148, v132
    v_add_f32 v149, v149, v133
    v_add_f32 v150, v150, v134
    v_add_f32 v151, v151, v135
    v_add_f32 v152, v152, v136
    v_add_f32 v153, v153, v137
    v_add_f32 v154, v154, v138
    v_add_f32 v155, v155, v139
    v_add_f32 v156, v156, v140
    v_add_f32 v157, v157, v141
    v_add_f32 v158, v158, v142
    v_add_f32 v159, v159, v143
    s_waitcnt lgkmcnt(0)
    v_mfma_f32_32x32x16_bf16 v[128:143], a[32:35], a[0:3], 0
    ds_read_b64_tr_b16 a[64:65], v40 offset:0
    ds_read_b64_tr_b16 a[66:67], v41 offset:2048
    v_add_f32 v160, v160, v176
    v_add_f32 v161, v161, v177
    v_add_f32 v162, v162, v178
    v_add_f32 v163, v163, v179
    v_add_f32 v164, v164, v180
    v_mfma_f32_32x32x16_bf16 v[128:143], a[36:39], a[4:7], v[128:143]
    ds_read_b64_tr_b16 a[72:73], v42 offset:0
    ds_read_b64_tr_b16 a[74:75], v43 offset:2048
    v_add_f32 v165, v165, v181
    v_add_f32 v166, v166, v182
    v_add_f32 v167, v167, v183
    v_add_f32 v168, v168, v184
    v_add_f32 v169, v169, v185
    v_mfma_f32_32x32x16_bf16 v[128:143], a[40:43], a[8:11], v[128:143]
    ds_read_b64_tr_b16 a[80:81], v44 offset:0
    ds_read_b64_tr_b16 a[82:83], v45 offset:2048
    v_add_f32 v170, v170, v186
    v_add_f32 v171, v171, v187
    v_add_f32 v172, v172, v188
    v_add_f32 v173, v173, v189
    v_add_f32 v174, v174, v190
    v_mfma_f32_32x32x16_bf16 v[128:143], a[44:47], a[12:15], v[128:143]
    ds_read_b64_tr_b16 a[88:89], v46 offset:0
    ds_read_b64_tr_b16 a[90:91], v47 offset:2048
    v_add_f32 v175, v175, v191
    v_add_f32 v144, v144, v160
    v_add_f32 v145, v145, v161
    v_add_f32 v146, v146, v162
    v_add_f32 v147, v147, v163
    v_mfma_f32_32x32x16_bf16 v[128:143], a[48:51], a[16:19], v[128:143]
    ds_read_b64_tr_b16 a[68:69], v40 offset:4096
    ds_read_b64_tr_b16 a[70:71], v41 offset:6144
    v_add_f32 v148, v148, v164
    v_add_f32 v149, v149, v165
    v_add_f32 v150, v150, v166
    v_add_f32 v151, v151, v167
    v_add_f32 v152, v152, v168
    v_mfma_f32_32x32x16_bf16 v[128:143], a[52:55], a[20:23], v[128:143]
    ds_read_b64_tr_b16 a[76:77], v42 offset:4096
    ds_read_b64_tr_b16 a[78:79], v43 offset:6144
    v_add_f32 v153, v153, v169
    v_add_f32 v154, v154, v170
    v_add_f32 v155, v155, v171
    v_add_f32 v156, v156, v172
    v_add_f32 v157, v157, v173
    v_mfma_f32_32x32x16_bf16 v[128:143], a[56:59], a[24:27], v[128:143]
    ds_read_b64_tr_b16 a[84:85], v44 offset:4096
    ds_read_b64_tr_b16 a[86:87], v45 offset:6144
    v_add_f32 v158, v158, v174
    v_add_f32 v159, v159, v175
    v_max3_f32 v218, v144, v145, v146
    v_max3_f32 v219, v147, v148, v149
    v_max3_f32 v220, v150, v151, v152
    v_mfma_f32_32x32x16_bf16 v[128:143], a[60:63], a[28:31], v[128:143]
    ds_read_b64_tr_b16 a[92:93], v46 offset:4096
    ds_read_b64_tr_b16 a[94:95], v47 offset:6144
    v_max3_f32 v221, v153, v154, v155
    v_max3_f32 v218, v218, v156, v157
    v_max3_f32 v219, v219, v158, v159
    v_max3_f32 v218, v218, v219, v220
    v_max_f32 v218, v218, v221
    v_mov_b32 v219, v218
    s_nop 1
    v_permlane32_swap_b32 v218, v219
    v_max3_f32 v218, v218, v219, v216
    v_sub_f32 v220, v216, v218
    v_mov_b32 v216, v218
    v_exp_f32 v220, v220
    v_sub_f32 v192, v144, v218
    v_sub_f32 v193, v145, v218
    buffer_load_dwordx4 a[196:199], v21, s[32:35], s58 offen nt
    v_sub_f32 v194, v146, v218
    v_sub_f32 v195, v147, v218
    v_sub_f32 v196, v148, v218
    v_sub_f32 v197, v149, v218
    v_sub_f32 v198, v150, v218
    buffer_load_dwordx4 a[200:203], v22, s[32:35], s58 offen nt
    v_sub_f32 v199, v151, v218
    v_sub_f32 v200, v152, v218
    v_sub_f32 v201, v153, v218
    v_sub_f32 v202, v154, v218
    v_sub_f32 v203, v155, v218
    v_sub_f32 v204, v156, v218
    v_sub_f32 v205, v157, v218
    v_sub_f32 v206, v158, v218
    v_sub_f32 v207, v159, v218
    ds_write_b128 v28, v[128:131] offset:16384
    v_exp_f32 v192, v192
    v_exp_f32 v193, v193
    v_exp_f32 v194, v194
    v_exp_f32 v195, v195
    ds_write_b128 v28, v[132:135] offset:17408
    v_exp_f32 v196, v196
    v_exp_f32 v197, v197
    v_exp_f32 v198, v198
    v_exp_f32 v199, v199
    ds_write_b128 v28, v[136:139] offset:18432
    v_exp_f32 v200, v200
    v_exp_f32 v201, v201
    v_exp_f32 v202, v202
    v_exp_f32 v203, v203
    ds_write_b128 v28, v[140:143] offset:19456
    v_exp_f32 v204, v204
    v_exp_f32 v205, v205
    v_exp_f32 v206, v206
    v_exp_f32 v207, v207
    v_mul_f32 v217, v217, v220
    v_cvt_pk_bf16_f32 v208, v192, v193
    v_cvt_pk_bf16_f32 v209, v194, v195
    v_cvt_pk_bf16_f32 v210, v196, v197
    v_cvt_pk_bf16_f32 v211, v198, v199
    v_cvt_pk_bf16_f32 v212, v200, v201
    v_cvt_pk_bf16_f32 v213, v202, v203
    v_cvt_pk_bf16_f32 v214, v204, v205
    v_cvt_pk_bf16_f32 v215, v206, v207
    v_mul_f32 v64, v64, v220
    v_mul_f32 v65, v65, v220
    v_mul_f32 v66, v66, v220
    v_mul_f32 v67, v67, v220
    v_mul_f32 v68, v68, v220
    v_mul_f32 v69, v69, v220
    v_mul_f32 v70, v70, v220
    v_mul_f32 v71, v71, v220
    v_mul_f32 v72, v72, v220
    v_mul_f32 v73, v73, v220
    v_mul_f32 v74, v74, v220
    v_mul_f32 v75, v75, v220
    v_mul_f32 v76, v76, v220
    v_mul_f32 v77, v77, v220
    v_mul_f32 v78, v78, v220
    v_mul_f32 v79, v79, v220
    s_waitcnt lgkmcnt(0)
    s_barrier
    v_mfma_f32_32x32x16_bf16 v[64:79], a[64:67], v[208:211], v[64:79]
    ds_read_b128 v[144:147], v29 offset:16384
    v_mul_f32 v80, v80, v220
    v_mul_f32 v81, v81, v220
    ds_read_b128 v[148:151], v29 offset:17408
    s_waitcnt vmcnt(26)
    ds_write_b128 v26, a[96:99] offset:16384
    buffer_load_dwordx4 a[204:207], v23, s[32:35], s58 offen nt
    s_add_u32 s58, s58, 16384
    v_mul_f32 v82, v82, v220
    v_mul_f32 v83, v83, v220
    ds_read_b128 v[152:155], v29 offset:18432
    v_mul_f32 v84, v84, v220
    v_mfma_f32_32x32x16_bf16 v[64:79], a[68:71], v[212:215], v[64:79]
    v_mul_f32 v85, v85, v220
    ds_read_b128 v[156:159], v29 offset:19456
    v_mul_f32 v86, v86, v220
    s_waitcnt vmcnt(26)
    ds_write_b128 v26, a[100:103] offset:17408
    v_mul_f32 v87, v87, v220
    v_mul_f32 v88, v88, v220
    v_mul_f32 v89, v89, v220
    v_mul_f32 v90, v90, v220
    v_mul_f32 v91, v91, v220
    v_mul_f32 v92, v92, v220
    v_mul_f32 v93, v93, v220
    v_mul_f32 v94, v94, v220
    v_mul_f32 v95, v95, v220
    s_nop 1
    v_mfma_f32_32x32x16_bf16 v[80:95], a[72:75], v[208:211], v[80:95]
    ds_read_b128 v[160:163], v30 offset:16384
    v_mul_f32 v96, v96, v220
    v_mul_f32 v97, v97, v220
    ds_read_b128 v[164:167], v30 offset:17408
    s_waitcnt vmcnt(25)
    ds_write_b128 v26, a[104:107] offset:18432
    buffer_load_dwordx4 a[208:211], v20, s[32:35], s58 offen nt
    v_mul_f32 v98, v98, v220
    v_mul_f32 v99, v99, v220
    ds_read_b128 v[168:171], v30 offset:18432
    v_mul_f32 v100, v100, v220
    v_mfma_f32_32x32x16_bf16 v[80:95], a[76:79], v[212:215], v[80:95]
    v_mul_f32 v101, v101, v220
    ds_read_b128 v[172:175], v30 offset:19456
    v_mul_f32 v102, v102, v220
    s_waitcnt vmcnt(25)
    ds_write_b128 v26, a[108:111] offset:19456
    v_mul_f32 v103, v103, v220
    v_mul_f32 v104, v104, v220
    v_mul_f32 v105, v105, v220
    v_mul_f32 v106, v106, v220
    v_mul_f32 v107, v107, v220
    v_mul_f32 v108, v108, v220
    v_mul_f32 v109, v109, v220
    v_mul_f32 v110, v110, v220
    v_mul_f32 v111, v111, v220
    s_nop 1
    v_mfma_f32_32x32x16_bf16 v[96:111], a[80:83], v[208:211], v[96:111]
    ds_read_b128 v[176:179], v31 offset:16384
    v_mul_f32 v112, v112, v220
    v_mul_f32 v113, v113, v220
    ds_read_b128 v[180:183], v31 offset:17408
    s_waitcnt vmcnt(24)
    ds_write_b128 v26, a[112:115] offset:20480
    v_mul_f32 v114, v114, v220
    v_mul_f32 v115, v115, v220
    ds_read_b128 v[184:187], v31 offset:18432
    v_mul_f32 v116, v116, v220
    v_mfma_f32_32x32x16_bf16 v[96:111], a[84:87], v[212:215], v[96:111]
    v_mul_f32 v117, v117, v220
    ds_read_b128 v[188:191], v31 offset:19456
    v_mul_f32 v118, v118, v220
    s_waitcnt vmcnt(23)
    ds_write_b128 v26, a[116:119] offset:21504
    buffer_load_dwordx4 a[212:215], v21, s[32:35], s58 offen nt
    v_mul_f32 v119, v119, v220
    v_mul_f32 v120, v120, v220
    v_mul_f32 v121, v121, v220
    v_mul_f32 v122, v122, v220
    v_mul_f32 v123, v123, v220
    v_mul_f32 v124, v124, v220
    v_mul_f32 v125, v125, v220
    v_mul_f32 v126, v126, v220
    v_mul_f32 v127, v127, v220
    s_nop 1
    v_mfma_f32_32x32x16_bf16 v[112:127], a[88:91], v[208:211], v[112:127]
    v_add_f32 v192, v192, v200
    v_add_f32 v193, v193, v201
    v_add_f32 v194, v194, v202
    v_add_f32 v195, v195, v203
    s_waitcnt vmcnt(23)
    ds_write_b128 v26, a[120:123] offset:22528
    v_add_f32 v196, v196, v204
    v_add_f32 v197, v197, v205
    v_add_f32 v198, v198, v206
    v_add_f32 v199, v199, v207
    v_mfma_f32_32x32x16_bf16 v[112:127], a[92:95], v[212:215], v[112:127]
    v_add_f32 v192, v192, v196
    v_add_f32 v193, v193, v197
    v_add_f32 v194, v194, v198
    s_waitcnt vmcnt(22)
    ds_write_b128 v26, a[124:127] offset:23552
    v_add_f32 v195, v195, v199
    v_add_f32 v192, v192, v193
    v_add_f32 v194, v194, v195
    v_add_f32 v192, v192, v194
    v_add_f32 v217, v217, v192
    ds_read_b128 a[32:35], v32 offset:16384
    ds_read_b128 a[36:39], v33 offset:16384
    ds_read_b128 a[40:43], v34 offset:16384
    ds_read_b128 a[44:47], v35 offset:16384
    ds_read_b128 a[48:51], v36 offset:16384
    ds_read_b128 a[52:55], v37 offset:16384
    ds_read_b128 a[56:59], v38 offset:16384
    ds_read_b128 a[60:63], v39 offset:16384
    s_waitcnt lgkmcnt(8)
    v_add_f32 v144, v144, v128
    v_add_f32 v145, v145, v129
    v_add_f32 v146, v146, v130
    v_add_f32 v147, v147, v131
    buffer_load_dwordx4 a[216:219], v22, s[32:35], s58 offen nt
    v_add_f32 v148, v148, v132
    v_add_f32 v149, v149, v133
    v_add_f32 v150, v150, v134
    v_add_f32 v151, v151, v135
    v_add_f32 v152, v152, v136
    v_add_f32 v153, v153, v137
    v_add_f32 v154, v154, v138
    v_add_f32 v155, v155, v139
    v_add_f32 v156, v156, v140
    v_add_f32 v157, v157, v141
    v_add_f32 v158, v158, v142
    v_add_f32 v159, v159, v143
    s_waitcnt lgkmcnt(0)
    v_mfma_f32_32x32x16_bf16 v[128:143], a[32:35], a[0:3], 0
    ds_read_b64_tr_b16 a[64:65], v40 offset:8192
    ds_read_b64_tr_b16 a[66:67], v41 offset:10240
    v_add_f32 v160, v160, v176
    v_add_f32 v161, v161, v177
    v_add_f32 v162, v162, v178
    v_add_f32 v163, v163, v179
    v_add_f32 v164, v164, v180
    v_mfma_f32_32x32x16_bf16 v[128:143], a[36:39], a[4:7], v[128:143]
    ds_read_b64_tr_b16 a[72:73], v42 offset:8192
    ds_read_b64_tr_b16 a[74:75], v43 offset:10240
    v_add_f32 v165, v165, v181
    v_add_f32 v166, v166, v182
    v_add_f32 v167, v167, v183
    v_add_f32 v168, v168, v184
    v_add_f32 v169, v169, v185
    v_mfma_f32_32x32x16_bf16 v[128:143], a[40:43], a[8:11], v[128:143]
    ds_read_b64_tr_b16 a[80:81], v44 offset:8192
    ds_read_b64_tr_b16 a[82:83], v45 offset:10240
    v_add_f32 v170, v170, v186
    v_add_f32 v171, v171, v187
    v_add_f32 v172, v172, v188
    v_add_f32 v173, v173, v189
    v_add_f32 v174, v174, v190
    v_mfma_f32_32x32x16_bf16 v[128:143], a[44:47], a[12:15], v[128:143]
    ds_read_b64_tr_b16 a[88:89], v46 offset:8192
    ds_read_b64_tr_b16 a[90:91], v47 offset:10240
    v_add_f32 v175, v175, v191
    v_add_f32 v144, v144, v160
    v_add_f32 v145, v145, v161
    v_add_f32 v146, v146, v162
    v_add_f32 v147, v147, v163
    v_mfma_f32_32x32x16_bf16 v[128:143], a[48:51], a[16:19], v[128:143]
    ds_read_b64_tr_b16 a[68:69], v40 offset:12288
    ds_read_b64_tr_b16 a[70:71], v41 offset:14336
    v_add_f32 v148, v148, v164
    v_add_f32 v149, v149, v165
    v_add_f32 v150, v150, v166
    v_add_f32 v151, v151, v167
    v_add_f32 v152, v152, v168
    v_mfma_f32_32x32x16_bf16 v[128:143], a[52:55], a[20:23], v[128:143]
    ds_read_b64_tr_b16 a[76:77], v42 offset:12288
    ds_read_b64_tr_b16 a[78:79], v43 offset:14336
    v_add_f32 v153, v153, v169
    v_add_f32 v154, v154, v170
    v_add_f32 v155, v155, v171
    v_add_f32 v156, v156, v172
    v_add_f32 v157, v157, v173
    v_mfma_f32_32x32x16_bf16 v[128:143], a[56:59], a[24:27], v[128:143]
    ds_read_b64_tr_b16 a[84:85], v44 offset:12288
    ds_read_b64_tr_b16 a[86:87], v45 offset:14336
    v_add_f32 v158, v158, v174
    v_add_f32 v159, v159, v175
    v_max3_f32 v218, v144, v145, v146
    v_max3_f32 v219, v147, v148, v149
    v_max3_f32 v220, v150, v151, v152
    v_mfma_f32_32x32x16_bf16 v[128:143], a[60:63], a[28:31], v[128:143]
    ds_read_b64_tr_b16 a[92:93], v46 offset:12288
    ds_read_b64_tr_b16 a[94:95], v47 offset:14336
    v_max3_f32 v221, v153, v154, v155
    v_max3_f32 v218, v218, v156, v157
    v_max3_f32 v219, v219, v158, v159
    v_max3_f32 v218, v218, v219, v220
    v_max_f32 v218, v218, v221
    v_mov_b32 v219, v218
    s_nop 1
    v_permlane32_swap_b32 v218, v219
    v_max3_f32 v218, v218, v219, v216
    v_sub_f32 v220, v216, v218
    v_mov_b32 v216, v218
    v_exp_f32 v220, v220
    v_sub_f32 v192, v144, v218
    v_sub_f32 v193, v145, v218
    buffer_load_dwordx4 a[220:223], v23, s[32:35], s58 offen nt
    s_add_u32 s58, s58, 16384
    v_sub_f32 v194, v146, v218
    v_sub_f32 v195, v147, v218
    v_sub_f32 v196, v148, v218
    v_sub_f32 v197, v149, v218
    v_sub_f32 v198, v150, v218
    buffer_load_dwordx4 a[224:227], v20, s[32:35], s58 offen nt
    v_sub_f32 v199, v151, v218
    v_sub_f32 v200, v152, v218
    v_sub_f32 v201, v153, v218
    v_sub_f32 v202, v154, v218
    v_sub_f32 v203, v155, v218
    v_sub_f32 v204, v156, v218
    v_sub_f32 v205, v157, v218
    v_sub_f32 v206, v158, v218
    v_sub_f32 v207, v159, v218
    ds_write_b128 v28, v[128:131] offset:0
    v_exp_f32 v192, v192
    v_exp_f32 v193, v193
    v_exp_f32 v194, v194
    v_exp_f32 v195, v195
    ds_write_b128 v28, v[132:135] offset:1024
    v_exp_f32 v196, v196
    v_exp_f32 v197, v197
    v_exp_f32 v198, v198
    v_exp_f32 v199, v199
    ds_write_b128 v28, v[136:139] offset:2048
    v_exp_f32 v200, v200
    v_exp_f32 v201, v201
    v_exp_f32 v202, v202
    v_exp_f32 v203, v203
    ds_write_b128 v28, v[140:143] offset:3072
    v_exp_f32 v204, v204
    v_exp_f32 v205, v205
    v_exp_f32 v206, v206
    v_exp_f32 v207, v207
    v_mul_f32 v217, v217, v220
    v_cvt_pk_bf16_f32 v208, v192, v193
    v_cvt_pk_bf16_f32 v209, v194, v195
    v_cvt_pk_bf16_f32 v210, v196, v197
    v_cvt_pk_bf16_f32 v211, v198, v199
    v_cvt_pk_bf16_f32 v212, v200, v201
    v_cvt_pk_bf16_f32 v213, v202, v203
    v_cvt_pk_bf16_f32 v214, v204, v205
    v_cvt_pk_bf16_f32 v215, v206, v207
    v_mul_f32 v64, v64, v220
    v_mul_f32 v65, v65, v220
    v_mul_f32 v66, v66, v220
    v_mul_f32 v67, v67, v220
    v_mul_f32 v68, v68, v220
    v_mul_f32 v69, v69, v220
    v_mul_f32 v70, v70, v220
    v_mul_f32 v71, v71, v220
    v_mul_f32 v72, v72, v220
    v_mul_f32 v73, v73, v220
    v_mul_f32 v74, v74, v220
    v_mul_f32 v75, v75, v220
    v_mul_f32 v76, v76, v220
    v_mul_f32 v77, v77, v220
    v_mul_f32 v78, v78, v220
    v_mul_f32 v79, v79, v220
    s_waitcnt lgkmcnt(0)
    s_barrier
    v_mfma_f32_32x32x16_bf16 v[64:79], a[64:67], v[208:211], v[64:79]
    ds_read_b128 v[144:147], v29 offset:0
    v_mul_f32 v80, v80, v220
    v_mul_f32 v81, v81, v220
    ds_read_b128 v[148:151], v29 offset:1024
    s_waitcnt vmcnt(24)
    ds_write_b128 v26, a[128:131] offset:24576
    buffer_load_dwordx4 a[228:231], v21, s[32:35], s58 offen nt
    v_mul_f32 v82, v82, v220
    v_mul_f32 v83, v83, v220
    ds_read_b128 v[152:155], v29 offset:2048
    v_mul_f32 v84, v84, v220
    v_mfma_f32_32x32x16_bf16 v[64:79], a[68:71], v[212:215], v[64:79]
    v_mul_f32 v85, v85, v220
    ds_read_b128 v[156:159], v29 offset:3072
    v_mul_f32 v86, v86, v220
    s_waitcnt vmcnt(24)
    ds_write_b128 v26, a[132:135] offset:25600
    v_mul_f32 v87, v87, v220
    v_mul_f32 v88, v88, v220
    v_mul_f32 v89, v89, v220
    v_mul_f32 v90, v90, v220
    v_mul_f32 v91, v91, v220
    v_mul_f32 v92, v92, v220
    v_mul_f32 v93, v93, v220
    v_mul_f32 v94, v94, v220
    v_mul_f32 v95, v95, v220
    s_nop 1
    v_mfma_f32_32x32x16_bf16 v[80:95], a[72:75], v[208:211], v[80:95]
    ds_read_b128 v[160:163], v30 offset:0
    v_mul_f32 v96, v96, v220
    v_mul_f32 v97, v97, v220
    ds_read_b128 v[164:167], v30 offset:1024
    s_waitcnt vmcnt(23)
    ds_write_b128 v26, a[136:139] offset:26624
    buffer_load_dwordx4 a[232:235], v22, s[32:35], s58 offen nt
    v_mul_f32 v98, v98, v220
    v_mul_f32 v99, v99, v220
    ds_read_b128 v[168:171], v30 offset:2048
    v_mul_f32 v100, v100, v220
    v_mfma_f32_32x32x16_bf16 v[80:95], a[76:79], v[212:215], v[80:95]
    v_mul_f32 v101, v101, v220
    ds_read_b128 v[172:175], v30 offset:3072
    v_mul_f32 v102, v102, v220
    s_waitcnt vmcnt(23)
    ds_write_b128 v26, a[140:143] offset:27648
    v_mul_f32 v103, v103, v220
    v_mul_f32 v104, v104, v220
    v_mul_f32 v105, v105, v220
    v_mul_f32 v106, v106, v220
    v_mul_f32 v107, v107, v220
    v_mul_f32 v108, v108, v220
    v_mul_f32 v109, v109, v220
    v_mul_f32 v110, v110, v220
    v_mul_f32 v111, v111, v220
    s_nop 1
    v_mfma_f32_32x32x16_bf16 v[96:111], a[80:83], v[208:211], v[96:111]
    ds_read_b128 v[176:179], v31 offset:0
    v_mul_f32 v112, v112, v220
    v_mul_f32 v113, v113, v220
    ds_read_b128 v[180:183], v31 offset:1024
    s_waitcnt vmcnt(22)
    ds_write_b128 v26, a[144:147] offset:28672
    v_mul_f32 v114, v114, v220
    v_mul_f32 v115, v115, v220
    ds_read_b128 v[184:187], v31 offset:2048
    v_mul_f32 v116, v116, v220
    v_mfma_f32_32x32x16_bf16 v[96:111], a[84:87], v[212:215], v[96:111]
    v_mul_f32 v117, v117, v220
    ds_read_b128 v[188:191], v31 offset:3072
    v_mul_f32 v118, v118, v220
    s_waitcnt vmcnt(21)
    ds_write_b128 v26, a[148:151] offset:29696
    buffer_load_dwordx4 a[236:239], v23, s[32:35], s58 offen nt
    s_add_u32 s58, s58, 16384
    v_mul_f32 v119, v119, v220
    v_mul_f32 v120, v120, v220
    v_mul_f32 v121, v121, v220
    v_mul_f32 v122, v122, v220
    v_mul_f32 v123, v123, v220
    v_mul_f32 v124, v124, v220
    v_mul_f32 v125, v125, v220
    v_mul_f32 v126, v126, v220
    v_mul_f32 v127, v127, v220
    s_nop 1
    v_mfma_f32_32x32x16_bf16 v[112:127], a[88:91], v[208:211], v[112:127]
    v_add_f32 v192, v192, v200
    v_add_f32 v193, v193, v201
    v_add_f32 v194, v194, v202
    v_add_f32 v195, v195, v203
    s_waitcnt vmcnt(21)
    ds_write_b128 v26, a[152:155] offset:30720
    v_add_f32 v196, v196, v204
    v_add_f32 v197, v197, v205
    v_add_f32 v198, v198, v206
    v_add_f32 v199, v199, v207
    v_mfma_f32_32x32x16_bf16 v[112:127], a[92:95], v[212:215], v[112:127]
    v_add_f32 v192, v192, v196
    v_add_f32 v193, v193, v197
    v_add_f32 v194, v194, v198
    s_waitcnt vmcnt(20)
    ds_write_b128 v26, a[156:159] offset:31744
    v_add_f32 v195, v195, v199
    v_add_f32 v192, v192, v193
    v_add_f32 v194, v194, v195
    v_add_f32 v192, v192, v194
    v_add_f32 v217, v217, v192
    ds_read_b128 a[32:35], v32 offset:24576
    ds_read_b128 a[36:39], v33 offset:24576
    ds_read_b128 a[40:43], v34 offset:24576
    ds_read_b128 a[44:47], v35 offset:24576
    ds_read_b128 a[48:51], v36 offset:24576
    ds_read_b128 a[52:55], v37 offset:24576
    ds_read_b128 a[56:59], v38 offset:24576
    ds_read_b128 a[60:63], v39 offset:24576
    s_waitcnt lgkmcnt(8)
    v_add_f32 v144, v144, v128
    v_add_f32 v145, v145, v129
    v_add_f32 v146, v146, v130
    v_add_f32 v147, v147, v131
    buffer_load_dwordx4 a[240:243], v20, s[32:35], s58 offen nt
    v_add_f32 v148, v148, v132
    v_add_f32 v149, v149, v133
    v_add_f32 v150, v150, v134
    v_add_f32 v151, v151, v135
    v_add_f32 v152, v152, v136
    v_add_f32 v153, v153, v137
    v_add_f32 v154, v154, v138
    v_add_f32 v155, v155, v139
    v_add_f32 v156, v156, v140
    v_add_f32 v157, v157, v141
    v_add_f32 v158, v158, v142
    v_add_f32 v159, v159, v143
    s_waitcnt lgkmcnt(0)
    v_mfma_f32_32x32x16_bf16 v[128:143], a[32:35], a[0:3], 0
    ds_read_b64_tr_b16 a[64:65], v40 offset:16384
    ds_read_b64_tr_b16 a[66:67], v41 offset:18432
    v_add_f32 v160, v160, v176
    v_add_f32 v161, v161, v177
    v_add_f32 v162, v162, v178
    v_add_f32 v163, v163, v179
    v_add_f32 v164, v164, v180
    v_mfma_f32_32x32x16_bf16 v[128:143], a[36:39], a[4:7], v[128:143]
    ds_read_b64_tr_b16 a[72:73], v42 offset:16384
    ds_read_b64_tr_b16 a[74:75], v43 offset:18432
    v_add_f32 v165, v165, v181
    v_add_f32 v166, v166, v182
    v_add_f32 v167, v167, v183
    v_add_f32 v168, v168, v184
    v_add_f32 v169, v169, v185
    v_mfma_f32_32x32x16_bf16 v[128:143], a[40:43], a[8:11], v[128:143]
    ds_read_b64_tr_b16 a[80:81], v44 offset:16384
    ds_read_b64_tr_b16 a[82:83], v45 offset:18432
    v_add_f32 v170, v170, v186
    v_add_f32 v171, v171, v187
    v_add_f32 v172, v172, v188
    v_add_f32 v173, v173, v189
    v_add_f32 v174, v174, v190
    v_mfma_f32_32x32x16_bf16 v[128:143], a[44:47], a[12:15], v[128:143]
    ds_read_b64_tr_b16 a[88:89], v46 offset:16384
    ds_read_b64_tr_b16 a[90:91], v47 offset:18432
    v_add_f32 v175, v175, v191
    v_add_f32 v144, v144, v160
    v_add_f32 v145, v145, v161
    v_add_f32 v146, v146, v162
    v_add_f32 v147, v147, v163
    v_mfma_f32_32x32x16_bf16 v[128:143], a[48:51], a[16:19], v[128:143]
    ds_read_b64_tr_b16 a[68:69], v40 offset:20480
    ds_read_b64_tr_b16 a[70:71], v41 offset:22528
    v_add_f32 v148, v148, v164
    v_add_f32 v149, v149, v165
    v_add_f32 v150, v150, v166
    v_add_f32 v151, v151, v167
    v_add_f32 v152, v152, v168
    v_mfma_f32_32x32x16_bf16 v[128:143], a[52:55], a[20:23], v[128:143]
    ds_read_b64_tr_b16 a[76:77], v42 offset:20480
    ds_read_b64_tr_b16 a[78:79], v43 offset:22528
    v_add_f32 v153, v153, v169
    v_add_f32 v154, v154, v170
    v_add_f32 v155, v155, v171
    v_add_f32 v156, v156, v172
    v_add_f32 v157, v157, v173
    v_mfma_f32_32x32x16_bf16 v[128:143], a[56:59], a[24:27], v[128:143]
    ds_read_b64_tr_b16 a[84:85], v44 offset:20480
    ds_read_b64_tr_b16 a[86:87], v45 offset:22528
    v_add_f32 v158, v158, v174
    v_add_f32 v159, v159, v175
    v_max3_f32 v218, v144, v145, v146
    v_max3_f32 v219, v147, v148, v149
    v_max3_f32 v220, v150, v151, v152
    v_mfma_f32_32x32x16_bf16 v[128:143], a[60:63], a[28:31], v[128:143]
    ds_read_b64_tr_b16 a[92:93], v46 offset:20480
    ds_read_b64_tr_b16 a[94:95], v47 offset:22528
    v_max3_f32 v221, v153, v154, v155
    v_max3_f32 v218, v218, v156, v157
    v_max3_f32 v219, v219, v158, v159
    v_max3_f32 v218, v218, v219, v220
    v_max_f32 v218, v218, v221
    v_mov_b32 v219, v218
    s_nop 1
    v_permlane32_swap_b32 v218, v219
    v_max3_f32 v218, v218, v219, v216
    v_sub_f32 v220, v216, v218
    v_mov_b32 v216, v218
    v_exp_f32 v220, v220
    v_sub_f32 v192, v144, v218
    v_sub_f32 v193, v145, v218
    buffer_load_dwordx4 a[244:247], v21, s[32:35], s58 offen nt
    v_sub_f32 v194, v146, v218
    v_sub_f32 v195, v147, v218
    v_sub_f32 v196, v148, v218
    v_sub_f32 v197, v149, v218
    v_sub_f32 v198, v150, v218
    buffer_load_dwordx4 a[248:251], v22, s[32:35], s58 offen nt
    v_sub_f32 v199, v151, v218
    v_sub_f32 v200, v152, v218
    v_sub_f32 v201, v153, v218
    v_sub_f32 v202, v154, v218
    v_sub_f32 v203, v155, v218
    v_sub_f32 v204, v156, v218
    v_sub_f32 v205, v157, v218
    v_sub_f32 v206, v158, v218
    v_sub_f32 v207, v159, v218
    ds_write_b128 v28, v[128:131] offset:16384
    v_exp_f32 v192, v192
    v_exp_f32 v193, v193
    v_exp_f32 v194, v194
    v_exp_f32 v195, v195
    ds_write_b128 v28, v[132:135] offset:17408
    v_exp_f32 v196, v196
    v_exp_f32 v197, v197
    v_exp_f32 v198, v198
    v_exp_f32 v199, v199
    ds_write_b128 v28, v[136:139] offset:18432
    v_exp_f32 v200, v200
    v_exp_f32 v201, v201
    v_exp_f32 v202, v202
    v_exp_f32 v203, v203
    ds_write_b128 v28, v[140:143] offset:19456
    v_exp_f32 v204, v204
    v_exp_f32 v205, v205
    v_exp_f32 v206, v206
    v_exp_f32 v207, v207
    v_mul_f32 v217, v217, v220
    v_cvt_pk_bf16_f32 v208, v192, v193
    v_cvt_pk_bf16_f32 v209, v194, v195
    v_cvt_pk_bf16_f32 v210, v196, v197
    v_cvt_pk_bf16_f32 v211, v198, v199
    v_cvt_pk_bf16_f32 v212, v200, v201
    v_cvt_pk_bf16_f32 v213, v202, v203
    v_cvt_pk_bf16_f32 v214, v204, v205
    v_cvt_pk_bf16_f32 v215, v206, v207
    v_mul_f32 v64, v64, v220
    v_mul_f32 v65, v65, v220
    v_mul_f32 v66, v66, v220
    v_mul_f32 v67, v67, v220
    v_mul_f32 v68, v68, v220
    v_mul_f32 v69, v69, v220
    v_mul_f32 v70, v70, v220
    v_mul_f32 v71, v71, v220
    v_mul_f32 v72, v72, v220
    v_mul_f32 v73, v73, v220
    v_mul_f32 v74, v74, v220
    v_mul_f32 v75, v75, v220
    v_mul_f32 v76, v76, v220
    v_mul_f32 v77, v77, v220
    v_mul_f32 v78, v78, v220
    v_mul_f32 v79, v79, v220
    s_waitcnt lgkmcnt(0)
    s_barrier
    v_mfma_f32_32x32x16_bf16 v[64:79], a[64:67], v[208:211], v[64:79]
    ds_read_b128 v[144:147], v29 offset:16384
    v_mul_f32 v80, v80, v220
    v_mul_f32 v81, v81, v220
    ds_read_b128 v[148:151], v29 offset:17408
    s_waitcnt vmcnt(22)
    ds_write_b128 v26, a[160:163] offset:0
    buffer_load_dwordx4 a[252:255], v23, s[32:35], s58 offen nt
    s_add_u32 s58, s58, 16384
    v_mul_f32 v82, v82, v220
    v_mul_f32 v83, v83, v220
    ds_read_b128 v[152:155], v29 offset:18432
    v_mul_f32 v84, v84, v220
    v_mfma_f32_32x32x16_bf16 v[64:79], a[68:71], v[212:215], v[64:79]
    v_mul_f32 v85, v85, v220
    ds_read_b128 v[156:159], v29 offset:19456
    v_mul_f32 v86, v86, v220
    s_waitcnt vmcnt(22)
    ds_write_b128 v26, a[164:167] offset:1024
    v_mul_f32 v87, v87, v220
    v_mul_f32 v88, v88, v220
    v_mul_f32 v89, v89, v220
    v_mul_f32 v90, v90, v220
    v_mul_f32 v91, v91, v220
    v_mul_f32 v92, v92, v220
    v_mul_f32 v93, v93, v220
    v_mul_f32 v94, v94, v220
    v_mul_f32 v95, v95, v220
    s_nop 1
    v_mfma_f32_32x32x16_bf16 v[80:95], a[72:75], v[208:211], v[80:95]
    ds_read_b128 v[160:163], v30 offset:16384
    v_mul_f32 v96, v96, v220
    v_mul_f32 v97, v97, v220
    ds_read_b128 v[164:167], v30 offset:17408
    s_waitcnt vmcnt(21)
    ds_write_b128 v26, a[168:171] offset:2048
    buffer_load_dwordx4 v[224:227], v20, s[32:35], s58 offen nt
    v_mul_f32 v98, v98, v220
    v_mul_f32 v99, v99, v220
    ds_read_b128 v[168:171], v30 offset:18432
    v_mul_f32 v100, v100, v220
    v_mfma_f32_32x32x16_bf16 v[80:95], a[76:79], v[212:215], v[80:95]
    v_mul_f32 v101, v101, v220
    ds_read_b128 v[172:175], v30 offset:19456
    v_mul_f32 v102, v102, v220
    s_waitcnt vmcnt(21)
    ds_write_b128 v26, a[172:175] offset:3072
    v_mul_f32 v103, v103, v220
    v_mul_f32 v104, v104, v220
    v_mul_f32 v105, v105, v220
    v_mul_f32 v106, v106, v220
    v_mul_f32 v107, v107, v220
    v_mul_f32 v108, v108, v220
    v_mul_f32 v109, v109, v220
    v_mul_f32 v110, v110, v220
    v_mul_f32 v111, v111, v220
    s_nop 1
    v_mfma_f32_32x32x16_bf16 v[96:111], a[80:83], v[208:211], v[96:111]
    ds_read_b128 v[176:179], v31 offset:16384
    v_mul_f32 v112, v112, v220
    v_mul_f32 v113, v113, v220
    ds_read_b128 v[180:183], v31 offset:17408
    s_waitcnt vmcnt(20)
    ds_write_b128 v26, a[176:179] offset:4096
    v_mul_f32 v114, v114, v220
    v_mul_f32 v115, v115, v220
    ds_read_b128 v[184:187], v31 offset:18432
    v_mul_f32 v116, v116, v220
    v_mfma_f32_32x32x16_bf16 v[96:111], a[84:87], v[212:215], v[96:111]
    v_mul_f32 v117, v117, v220
    ds_read_b128 v[188:191], v31 offset:19456
    v_mul_f32 v118, v118, v220
    s_waitcnt vmcnt(19)
    ds_write_b128 v26, a[180:183] offset:5120
    buffer_load_dwordx4 v[228:231], v21, s[32:35], s58 offen nt
    v_mul_f32 v119, v119, v220
    v_mul_f32 v120, v120, v220
    v_mul_f32 v121, v121, v220
    v_mul_f32 v122, v122, v220
    v_mul_f32 v123, v123, v220
    v_mul_f32 v124, v124, v220
    v_mul_f32 v125, v125, v220
    v_mul_f32 v126, v126, v220
    v_mul_f32 v127, v127, v220
    s_nop 1
    v_mfma_f32_32x32x16_bf16 v[112:127], a[88:91], v[208:211], v[112:127]
    v_add_f32 v192, v192, v200
    v_add_f32 v193, v193, v201
    v_add_f32 v194, v194, v202
    v_add_f32 v195, v195, v203
    s_waitcnt vmcnt(19)
    ds_write_b128 v26, a[184:187] offset:6144
    v_add_f32 v196, v196, v204
    v_add_f32 v197, v197, v205
    v_add_f32 v198, v198, v206
    v_add_f32 v199, v199, v207
    v_mfma_f32_32x32x16_bf16 v[112:127], a[92:95], v[212:215], v[112:127]
    v_add_f32 v192, v192, v196
    v_add_f32 v193, v193, v197
    v_add_f32 v194, v194, v198
    s_waitcnt vmcnt(18)
    ds_write_b128 v26, a[188:191] offset:7168
    v_add_f32 v195, v195, v199
    v_add_f32 v192, v192, v193
    v_add_f32 v194, v194, v195
    v_add_f32 v192, v192, v194
    v_add_f32 v217, v217, v192
    ds_read_b128 a[32:35], v32 offset:0
    ds_read_b128 a[36:39], v33 offset:0
    ds_read_b128 a[40:43], v34 offset:0
    ds_read_b128 a[44:47], v35 offset:0
    ds_read_b128 a[48:51], v36 offset:0
    ds_read_b128 a[52:55], v37 offset:0
    ds_read_b128 a[56:59], v38 offset:0
    ds_read_b128 a[60:63], v39 offset:0
    s_waitcnt lgkmcnt(8)
    v_add_f32 v144, v144, v128
    v_add_f32 v145, v145, v129
    v_add_f32 v146, v146, v130
    v_add_f32 v147, v147, v131
    buffer_load_dwordx4 v[232:235], v22, s[32:35], s58 offen nt
    v_add_f32 v148, v148, v132
    v_add_f32 v149, v149, v133
    v_add_f32 v150, v150, v134
    v_add_f32 v151, v151, v135
    v_add_f32 v152, v152, v136
    v_add_f32 v153, v153, v137
    v_add_f32 v154, v154, v138
    v_add_f32 v155, v155, v139
    v_add_f32 v156, v156, v140
    v_add_f32 v157, v157, v141
    v_add_f32 v158, v158, v142
    v_add_f32 v159, v159, v143
    s_waitcnt lgkmcnt(0)
    v_mfma_f32_32x32x16_bf16 v[128:143], a[32:35], a[0:3], 0
    ds_read_b64_tr_b16 a[64:65], v40 offset:24576
    ds_read_b64_tr_b16 a[66:67], v41 offset:26624
    v_add_f32 v160, v160, v176
    v_add_f32 v161, v161, v177
    v_add_f32 v162, v162, v178
    v_add_f32 v163, v163, v179
    v_add_f32 v164, v164, v180
    v_mfma_f32_32x32x16_bf16 v[128:143], a[36:39], a[4:7], v[128:143]
    ds_read_b64_tr_b16 a[72:73], v42 offset:24576
    ds_read_b64_tr_b16 a[74:75], v43 offset:26624
    v_add_f32 v165, v165, v181
    v_add_f32 v166, v166, v182
    v_add_f32 v167, v167, v183
    v_add_f32 v168, v168, v184
    v_add_f32 v169, v169, v185
    v_mfma_f32_32x32x16_bf16 v[128:143], a[40:43], a[8:11], v[128:143]
    ds_read_b64_tr_b16 a[80:81], v44 offset:24576
    ds_read_b64_tr_b16 a[82:83], v45 offset:26624
    v_add_f32 v170, v170, v186
    v_add_f32 v171, v171, v187
    v_add_f32 v172, v172, v188
    v_add_f32 v173, v173, v189
    v_add_f32 v174, v174, v190
    v_mfma_f32_32x32x16_bf16 v[128:143], a[44:47], a[12:15], v[128:143]
    ds_read_b64_tr_b16 a[88:89], v46 offset:24576
    ds_read_b64_tr_b16 a[90:91], v47 offset:26624
    v_add_f32 v175, v175, v191
    v_add_f32 v144, v144, v160
    v_add_f32 v145, v145, v161
    v_add_f32 v146, v146, v162
    v_add_f32 v147, v147, v163
    v_mfma_f32_32x32x16_bf16 v[128:143], a[48:51], a[16:19], v[128:143]
    ds_read_b64_tr_b16 a[68:69], v40 offset:28672
    ds_read_b64_tr_b16 a[70:71], v41 offset:30720
    v_add_f32 v148, v148, v164
    v_add_f32 v149, v149, v165
    v_add_f32 v150, v150, v166
    v_add_f32 v151, v151, v167
    v_add_f32 v152, v152, v168
    v_mfma_f32_32x32x16_bf16 v[128:143], a[52:55], a[20:23], v[128:143]
    ds_read_b64_tr_b16 a[76:77], v42 offset:28672
    ds_read_b64_tr_b16 a[78:79], v43 offset:30720
    v_add_f32 v153, v153, v169
    v_add_f32 v154, v154, v170
    v_add_f32 v155, v155, v171
    v_add_f32 v156, v156, v172
    v_add_f32 v157, v157, v173
    v_mfma_f32_32x32x16_bf16 v[128:143], a[56:59], a[24:27], v[128:143]
    ds_read_b64_tr_b16 a[84:85], v44 offset:28672
    ds_read_b64_tr_b16 a[86:87], v45 offset:30720
    v_add_f32 v158, v158, v174
    v_add_f32 v159, v159, v175
    v_max3_f32 v218, v144, v145, v146
    v_max3_f32 v219, v147, v148, v149
    v_max3_f32 v220, v150, v151, v152
    v_mfma_f32_32x32x16_bf16 v[128:143], a[60:63], a[28:31], v[128:143]
    ds_read_b64_tr_b16 a[92:93], v46 offset:28672
    ds_read_b64_tr_b16 a[94:95], v47 offset:30720
    v_max3_f32 v221, v153, v154, v155
    v_max3_f32 v218, v218, v156, v157
    v_max3_f32 v219, v219, v158, v159
    v_max3_f32 v218, v218, v219, v220
    v_max_f32 v218, v218, v221
    v_mov_b32 v219, v218
    s_nop 1
    v_permlane32_swap_b32 v218, v219
    v_max3_f32 v218, v218, v219, v216
    v_sub_f32 v220, v216, v218
    v_mov_b32 v216, v218
    v_exp_f32 v220, v220
    v_sub_f32 v192, v144, v218
    v_sub_f32 v193, v145, v218
    buffer_load_dwordx4 v[236:239], v23, s[32:35], s58 offen nt
    s_add_u32 s58, s58, 16384
    v_sub_f32 v194, v146, v218
    v_sub_f32 v195, v147, v218
    v_sub_f32 v196, v148, v218
    v_sub_f32 v197, v149, v218
    v_sub_f32 v198, v150, v218
    buffer_load_dwordx4 v[240:243], v20, s[32:35], s58 offen nt
    v_sub_f32 v199, v151, v218
    v_sub_f32 v200, v152, v218
    v_sub_f32 v201, v153, v218
    v_sub_f32 v202, v154, v218
    v_sub_f32 v203, v155, v218
    v_sub_f32 v204, v156, v218
    v_sub_f32 v205, v157, v218
    v_sub_f32 v206, v158, v218
    v_sub_f32 v207, v159, v218
    ds_write_b128 v28, v[128:131] offset:0
    v_exp_f32 v192, v192
    v_exp_f32 v193, v193
    v_exp_f32 v194, v194
    v_exp_f32 v195, v195
    ds_write_b128 v28, v[132:135] offset:1024
    v_exp_f32 v196, v196
    v_exp_f32 v197, v197
    v_exp_f32 v198, v198
    v_exp_f32 v199, v199
    ds_write_b128 v28, v[136:139] offset:2048
    v_exp_f32 v200, v200
    v_exp_f32 v201, v201
    v_exp_f32 v202, v202
    v_exp_f32 v203, v203
    ds_write_b128 v28, v[140:143] offset:3072
    v_exp_f32 v204, v204
    v_exp_f32 v205, v205
    v_exp_f32 v206, v206
    v_exp_f32 v207, v207
    v_mul_f32 v217, v217, v220
    v_cvt_pk_bf16_f32 v208, v192, v193
    v_cvt_pk_bf16_f32 v209, v194, v195
    v_cvt_pk_bf16_f32 v210, v196, v197
    v_cvt_pk_bf16_f32 v211, v198, v199
    v_cvt_pk_bf16_f32 v212, v200, v201
    v_cvt_pk_bf16_f32 v213, v202, v203
    v_cvt_pk_bf16_f32 v214, v204, v205
    v_cvt_pk_bf16_f32 v215, v206, v207
    v_mul_f32 v64, v64, v220
    v_mul_f32 v65, v65, v220
    v_mul_f32 v66, v66, v220
    v_mul_f32 v67, v67, v220
    v_mul_f32 v68, v68, v220
    v_mul_f32 v69, v69, v220
    v_mul_f32 v70, v70, v220
    v_mul_f32 v71, v71, v220
    v_mul_f32 v72, v72, v220
    v_mul_f32 v73, v73, v220
    v_mul_f32 v74, v74, v220
    v_mul_f32 v75, v75, v220
    v_mul_f32 v76, v76, v220
    v_mul_f32 v77, v77, v220
    v_mul_f32 v78, v78, v220
    v_mul_f32 v79, v79, v220
    s_waitcnt lgkmcnt(0)
    s_barrier
    v_mfma_f32_32x32x16_bf16 v[64:79], a[64:67], v[208:211], v[64:79]
    ds_read_b128 v[144:147], v29 offset:0
    v_mul_f32 v80, v80, v220
    v_mul_f32 v81, v81, v220
    ds_read_b128 v[148:151], v29 offset:1024
    s_waitcnt vmcnt(20)
    ds_write_b128 v26, a[192:195] offset:8192
    buffer_load_dwordx4 v[244:247], v21, s[32:35], s58 offen nt
    v_mul_f32 v82, v82, v220
    v_mul_f32 v83, v83, v220
    ds_read_b128 v[152:155], v29 offset:2048
    v_mul_f32 v84, v84, v220
    v_mfma_f32_32x32x16_bf16 v[64:79], a[68:71], v[212:215], v[64:79]
    v_mul_f32 v85, v85, v220
    ds_read_b128 v[156:159], v29 offset:3072
    v_mul_f32 v86, v86, v220
    s_waitcnt vmcnt(20)
    ds_write_b128 v26, a[196:199] offset:9216
    v_mul_f32 v87, v87, v220
    v_mul_f32 v88, v88, v220
    v_mul_f32 v89, v89, v220
    v_mul_f32 v90, v90, v220
    v_mul_f32 v91, v91, v220
    v_mul_f32 v92, v92, v220
    v_mul_f32 v93, v93, v220
    v_mul_f32 v94, v94, v220
    v_mul_f32 v95, v95, v220
    s_nop 1
    v_mfma_f32_32x32x16_bf16 v[80:95], a[72:75], v[208:211], v[80:95]
    ds_read_b128 v[160:163], v30 offset:0
    v_mul_f32 v96, v96, v220
    v_mul_f32 v97, v97, v220
    ds_read_b128 v[164:167], v30 offset:1024
    s_waitcnt vmcnt(19)
    ds_write_b128 v26, a[200:203] offset:10240
    buffer_load_dwordx4 v[248:251], v22, s[32:35], s58 offen nt
    v_mul_f32 v98, v98, v220
    v_mul_f32 v99, v99, v220
    ds_read_b128 v[168:171], v30 offset:2048
    v_mul_f32 v100, v100, v220
    v_mfma_f32_32x32x16_bf16 v[80:95], a[76:79], v[212:215], v[80:95]
    v_mul_f32 v101, v101, v220
    ds_read_b128 v[172:175], v30 offset:3072
    v_mul_f32 v102, v102, v220
    s_waitcnt vmcnt(19)
    ds_write_b128 v26, a[204:207] offset:11264
    v_mul_f32 v103, v103, v220
    v_mul_f32 v104, v104, v220
    v_mul_f32 v105, v105, v220
    v_mul_f32 v106, v106, v220
    v_mul_f32 v107, v107, v220
    v_mul_f32 v108, v108, v220
    v_mul_f32 v109, v109, v220
    v_mul_f32 v110, v110, v220
    v_mul_f32 v111, v111, v220
    s_nop 1
    v_mfma_f32_32x32x16_bf16 v[96:111], a[80:83], v[208:211], v[96:111]
    ds_read_b128 v[176:179], v31 offset:0
    v_mul_f32 v112, v112, v220
    v_mul_f32 v113, v113, v220
    ds_read_b128 v[180:183], v31 offset:1024
    s_waitcnt vmcnt(18)
    ds_write_b128 v26, a[208:211] offset:12288
    v_mul_f32 v114, v114, v220
    v_mul_f32 v115, v115, v220
    ds_read_b128 v[184:187], v31 offset:2048
    v_mul_f32 v116, v116, v220
    v_mfma_f32_32x32x16_bf16 v[96:111], a[84:87], v[212:215], v[96:111]
    v_mul_f32 v117, v117, v220
    ds_read_b128 v[188:191], v31 offset:3072
    v_mul_f32 v118, v118, v220
    s_waitcnt vmcnt(17)
    ds_write_b128 v26, a[212:215] offset:13312
    buffer_load_dwordx4 v[252:255], v23, s[32:35], s58 offen nt
    s_add_u32 s58, s58, 16384
    v_mul_f32 v119, v119, v220
    v_mul_f32 v120, v120, v220
    v_mul_f32 v121, v121, v220
    v_mul_f32 v122, v122, v220
    v_mul_f32 v123, v123, v220
    v_mul_f32 v124, v124, v220
    v_mul_f32 v125, v125, v220
    v_mul_f32 v126, v126, v220
    v_mul_f32 v127, v127, v220
    s_nop 1
    v_mfma_f32_32x32x16_bf16 v[112:127], a[88:91], v[208:211], v[112:127]
    v_add_f32 v192, v192, v200
    v_add_f32 v193, v193, v201
    v_add_f32 v194, v194, v202
    v_add_f32 v195, v195, v203
    s_waitcnt vmcnt(17)
    ds_write_b128 v26, a[216:219] offset:14336
    v_add_f32 v196, v196, v204
    v_add_f32 v197, v197, v205
    v_add_f32 v198, v198, v206
    v_add_f32 v199, v199, v207
    v_mfma_f32_32x32x16_bf16 v[112:127], a[92:95], v[212:215], v[112:127]
    v_add_f32 v192, v192, v196
    v_add_f32 v193, v193, v197
    v_add_f32 v194, v194, v198
    s_waitcnt vmcnt(16)
    ds_write_b128 v26, a[220:223] offset:15360
    v_add_f32 v195, v195, v199
    v_add_f32 v192, v192, v193
    v_add_f32 v194, v194, v195
    v_add_f32 v192, v192, v194
    v_add_f32 v217, v217, v192
    ds_read_b128 a[32:35], v32 offset:8192
    ds_read_b128 a[36:39], v33 offset:8192
    ds_read_b128 a[40:43], v34 offset:8192
    ds_read_b128 a[44:47], v35 offset:8192
    ds_read_b128 a[48:51], v36 offset:8192
    ds_read_b128 a[52:55], v37 offset:8192
    ds_read_b128 a[56:59], v38 offset:8192
    ds_read_b128 a[60:63], v39 offset:8192
    s_waitcnt lgkmcnt(8)
    v_add_f32 v144, v144, v128
    v_add_f32 v145, v145, v129
    v_add_f32 v146, v146, v130
    v_add_f32 v147, v147, v131
    v_add_f32 v148, v148, v132
    v_add_f32 v149, v149, v133
    v_add_f32 v150, v150, v134
    v_add_f32 v151, v151, v135
    v_add_f32 v152, v152, v136
    v_add_f32 v153, v153, v137
    v_add_f32 v154, v154, v138
    v_add_f32 v155, v155, v139
    v_add_f32 v156, v156, v140
    v_add_f32 v157, v157, v141
    v_add_f32 v158, v158, v142
    v_add_f32 v159, v159, v143
    s_waitcnt lgkmcnt(0)
    v_mfma_f32_32x32x16_bf16 v[128:143], a[32:35], a[0:3], 0
    ds_read_b64_tr_b16 a[64:65], v40 offset:0
    ds_read_b64_tr_b16 a[66:67], v41 offset:2048
    v_add_f32 v160, v160, v176
    v_add_f32 v161, v161, v177
    v_add_f32 v162, v162, v178
    v_add_f32 v163, v163, v179
    v_add_f32 v164, v164, v180
    v_mfma_f32_32x32x16_bf16 v[128:143], a[36:39], a[4:7], v[128:143]
    ds_read_b64_tr_b16 a[72:73], v42 offset:0
    ds_read_b64_tr_b16 a[74:75], v43 offset:2048
    v_add_f32 v165, v165, v181
    v_add_f32 v166, v166, v182
    v_add_f32 v167, v167, v183
    v_add_f32 v168, v168, v184
    v_add_f32 v169, v169, v185
    v_mfma_f32_32x32x16_bf16 v[128:143], a[40:43], a[8:11], v[128:143]
    ds_read_b64_tr_b16 a[80:81], v44 offset:0
    ds_read_b64_tr_b16 a[82:83], v45 offset:2048
    v_add_f32 v170, v170, v186
    v_add_f32 v171, v171, v187
    v_add_f32 v172, v172, v188
    v_add_f32 v173, v173, v189
    v_add_f32 v174, v174, v190
    v_mfma_f32_32x32x16_bf16 v[128:143], a[44:47], a[12:15], v[128:143]
    ds_read_b64_tr_b16 a[88:89], v46 offset:0
    ds_read_b64_tr_b16 a[90:91], v47 offset:2048
    v_add_f32 v175, v175, v191
    v_add_f32 v144, v144, v160
    v_add_f32 v145, v145, v161
    v_add_f32 v146, v146, v162
    v_add_f32 v147, v147, v163
    v_mfma_f32_32x32x16_bf16 v[128:143], a[48:51], a[16:19], v[128:143]
    ds_read_b64_tr_b16 a[68:69], v40 offset:4096
    ds_read_b64_tr_b16 a[70:71], v41 offset:6144
    v_add_f32 v148, v148, v164
    v_add_f32 v149, v149, v165
    v_add_f32 v150, v150, v166
    v_add_f32 v151, v151, v167
    v_add_f32 v152, v152, v168
    v_mfma_f32_32x32x16_bf16 v[128:143], a[52:55], a[20:23], v[128:143]
    ds_read_b64_tr_b16 a[76:77], v42 offset:4096
    ds_read_b64_tr_b16 a[78:79], v43 offset:6144
    v_add_f32 v153, v153, v169
    v_add_f32 v154, v154, v170
    v_add_f32 v155, v155, v171
    v_add_f32 v156, v156, v172
    v_add_f32 v157, v157, v173
    v_mfma_f32_32x32x16_bf16 v[128:143], a[56:59], a[24:27], v[128:143]
    ds_read_b64_tr_b16 a[84:85], v44 offset:4096
    ds_read_b64_tr_b16 a[86:87], v45 offset:6144
    v_add_f32 v158, v158, v174
    v_add_f32 v159, v159, v175
    v_max3_f32 v218, v144, v145, v146
    v_max3_f32 v219, v147, v148, v149
    v_max3_f32 v220, v150, v151, v152
    v_mfma_f32_32x32x16_bf16 v[128:143], a[60:63], a[28:31], v[128:143]
    ds_read_b64_tr_b16 a[92:93], v46 offset:4096
    ds_read_b64_tr_b16 a[94:95], v47 offset:6144
    v_max3_f32 v221, v153, v154, v155
    v_max3_f32 v218, v218, v156, v157
    v_max3_f32 v219, v219, v158, v159
    v_max3_f32 v218, v218, v219, v220
    v_max_f32 v218, v218, v221
    v_mov_b32 v219, v218
    s_nop 1
    v_permlane32_swap_b32 v218, v219
    v_max3_f32 v218, v218, v219, v216
    v_sub_f32 v220, v216, v218
    v_mov_b32 v216, v218
    v_exp_f32 v220, v220
    v_sub_f32 v192, v144, v218
    v_sub_f32 v193, v145, v218
    v_sub_f32 v194, v146, v218
    v_sub_f32 v195, v147, v218
    v_sub_f32 v196, v148, v218
    v_sub_f32 v197, v149, v218
    v_sub_f32 v198, v150, v218
    v_sub_f32 v199, v151, v218
    v_sub_f32 v200, v152, v218
    v_sub_f32 v201, v153, v218
    v_sub_f32 v202, v154, v218
    v_sub_f32 v203, v155, v218
    v_sub_f32 v204, v156, v218
    v_sub_f32 v205, v157, v218
    v_sub_f32 v206, v158, v218
    v_sub_f32 v207, v159, v218
    ds_write_b128 v28, v[128:131] offset:16384
    v_exp_f32 v192, v192
    v_exp_f32 v193, v193
    v_exp_f32 v194, v194
    v_exp_f32 v195, v195
    ds_write_b128 v28, v[132:135] offset:17408
    v_exp_f32 v196, v196
    v_exp_f32 v197, v197
    v_exp_f32 v198, v198
    v_exp_f32 v199, v199
    ds_write_b128 v28, v[136:139] offset:18432
    v_exp_f32 v200, v200
    v_exp_f32 v201, v201
    v_exp_f32 v202, v202
    v_exp_f32 v203, v203
    ds_write_b128 v28, v[140:143] offset:19456
    v_exp_f32 v204, v204
    v_exp_f32 v205, v205
    v_exp_f32 v206, v206
    v_exp_f32 v207, v207
    v_mul_f32 v217, v217, v220
    v_cvt_pk_bf16_f32 v208, v192, v193
    v_cvt_pk_bf16_f32 v209, v194, v195
    v_cvt_pk_bf16_f32 v210, v196, v197
    v_cvt_pk_bf16_f32 v211, v198, v199
    v_cvt_pk_bf16_f32 v212, v200, v201
    v_cvt_pk_bf16_f32 v213, v202, v203
    v_cvt_pk_bf16_f32 v214, v204, v205
    v_cvt_pk_bf16_f32 v215, v206, v207
    v_mul_f32 v64, v64, v220
    v_mul_f32 v65, v65, v220
    v_mul_f32 v66, v66, v220
    v_mul_f32 v67, v67, v220
    v_mul_f32 v68, v68, v220
    v_mul_f32 v69, v69, v220
    v_mul_f32 v70, v70, v220
    v_mul_f32 v71, v71, v220
    v_mul_f32 v72, v72, v220
    v_mul_f32 v73, v73, v220
    v_mul_f32 v74, v74, v220
    v_mul_f32 v75, v75, v220
    v_mul_f32 v76, v76, v220
    v_mul_f32 v77, v77, v220
    v_mul_f32 v78, v78, v220
    v_mul_f32 v79, v79, v220
    s_waitcnt lgkmcnt(0)
    s_barrier
    v_mfma_f32_32x32x16_bf16 v[64:79], a[64:67], v[208:211], v[64:79]
    ds_read_b128 v[144:147], v29 offset:16384
    v_mul_f32 v80, v80, v220
    v_mul_f32 v81, v81, v220
    ds_read_b128 v[148:151], v29 offset:17408
    s_waitcnt vmcnt(15)
    ds_write_b128 v26, a[224:227] offset:16384
    v_mul_f32 v82, v82, v220
    v_mul_f32 v83, v83, v220
    ds_read_b128 v[152:155], v29 offset:18432
    v_mul_f32 v84, v84, v220
    v_mfma_f32_32x32x16_bf16 v[64:79], a[68:71], v[212:215], v[64:79]
    v_mul_f32 v85, v85, v220
    ds_read_b128 v[156:159], v29 offset:19456
    v_mul_f32 v86, v86, v220
    s_waitcnt vmcnt(14)
    ds_write_b128 v26, a[228:231] offset:17408
    v_mul_f32 v87, v87, v220
    v_mul_f32 v88, v88, v220
    v_mul_f32 v89, v89, v220
    v_mul_f32 v90, v90, v220
    v_mul_f32 v91, v91, v220
    v_mul_f32 v92, v92, v220
    v_mul_f32 v93, v93, v220
    v_mul_f32 v94, v94, v220
    v_mul_f32 v95, v95, v220
    s_nop 1
    v_mfma_f32_32x32x16_bf16 v[80:95], a[72:75], v[208:211], v[80:95]
    ds_read_b128 v[160:163], v30 offset:16384
    v_mul_f32 v96, v96, v220
    v_mul_f32 v97, v97, v220
    ds_read_b128 v[164:167], v30 offset:17408
    s_waitcnt vmcnt(13)
    ds_write_b128 v26, a[232:235] offset:18432
    v_mul_f32 v98, v98, v220
    v_mul_f32 v99, v99, v220
    ds_read_b128 v[168:171], v30 offset:18432
    v_mul_f32 v100, v100, v220
    v_mfma_f32_32x32x16_bf16 v[80:95], a[76:79], v[212:215], v[80:95]
    v_mul_f32 v101, v101, v220
    ds_read_b128 v[172:175], v30 offset:19456
    v_mul_f32 v102, v102, v220
    s_waitcnt vmcnt(12)
    ds_write_b128 v26, a[236:239] offset:19456
    v_mul_f32 v103, v103, v220
    v_mul_f32 v104, v104, v220
    v_mul_f32 v105, v105, v220
    v_mul_f32 v106, v106, v220
    v_mul_f32 v107, v107, v220
    v_mul_f32 v108, v108, v220
    v_mul_f32 v109, v109, v220
    v_mul_f32 v110, v110, v220
    v_mul_f32 v111, v111, v220
    s_nop 1
    v_mfma_f32_32x32x16_bf16 v[96:111], a[80:83], v[208:211], v[96:111]
    ds_read_b128 v[176:179], v31 offset:16384
    v_mul_f32 v112, v112, v220
    v_mul_f32 v113, v113, v220
    ds_read_b128 v[180:183], v31 offset:17408
    s_waitcnt vmcnt(11)
    ds_write_b128 v26, a[240:243] offset:20480
    v_mul_f32 v114, v114, v220
    v_mul_f32 v115, v115, v220
    ds_read_b128 v[184:187], v31 offset:18432
    v_mul_f32 v116, v116, v220
    v_mfma_f32_32x32x16_bf16 v[96:111], a[84:87], v[212:215], v[96:111]
    v_mul_f32 v117, v117, v220
    ds_read_b128 v[188:191], v31 offset:19456
    v_mul_f32 v118, v118, v220
    s_waitcnt vmcnt(10)
    ds_write_b128 v26, a[244:247] offset:21504
    v_mul_f32 v119, v119, v220
    v_mul_f32 v120, v120, v220
    v_mul_f32 v121, v121, v220
    v_mul_f32 v122, v122, v220
    v_mul_f32 v123, v123, v220
    v_mul_f32 v124, v124, v220
    v_mul_f32 v125, v125, v220
    v_mul_f32 v126, v126, v220
    v_mul_f32 v127, v127, v220
    s_nop 1
    v_mfma_f32_32x32x16_bf16 v[112:127], a[88:91], v[208:211], v[112:127]
    v_add_f32 v192, v192, v200
    v_add_f32 v193, v193, v201
    v_add_f32 v194, v194, v202
    v_add_f32 v195, v195, v203
    s_waitcnt vmcnt(9)
    ds_write_b128 v26, a[248:251] offset:22528
    v_add_f32 v196, v196, v204
    v_add_f32 v197, v197, v205
    v_add_f32 v198, v198, v206
    v_add_f32 v199, v199, v207
    v_mfma_f32_32x32x16_bf16 v[112:127], a[92:95], v[212:215], v[112:127]
    v_add_f32 v192, v192, v196
    v_add_f32 v193, v193, v197
    v_add_f32 v194, v194, v198
    s_waitcnt vmcnt(8)
    ds_write_b128 v26, a[252:255] offset:23552
    v_add_f32 v195, v195, v199
    v_add_f32 v192, v192, v193
    v_add_f32 v194, v194, v195
    v_add_f32 v192, v192, v194
    v_add_f32 v217, v217, v192
    ds_read_b128 a[32:35], v32 offset:16384
    ds_read_b128 a[36:39], v33 offset:16384
    ds_read_b128 a[40:43], v34 offset:16384
    ds_read_b128 a[44:47], v35 offset:16384
    ds_read_b128 a[48:51], v36 offset:16384
    ds_read_b128 a[52:55], v37 offset:16384
    ds_read_b128 a[56:59], v38 offset:16384
    ds_read_b128 a[60:63], v39 offset:16384
    s_waitcnt lgkmcnt(8)
    v_add_f32 v144, v144, v128
    v_add_f32 v145, v145, v129
    v_add_f32 v146, v146, v130
    v_add_f32 v147, v147, v131
    v_add_f32 v148, v148, v132
    v_add_f32 v149, v149, v133
    v_add_f32 v150, v150, v134
    v_add_f32 v151, v151, v135
    v_add_f32 v152, v152, v136
    v_add_f32 v153, v153, v137
    v_add_f32 v154, v154, v138
    v_add_f32 v155, v155, v139
    v_add_f32 v156, v156, v140
    v_add_f32 v157, v157, v141
    v_add_f32 v158, v158, v142
    v_add_f32 v159, v159, v143
    s_waitcnt lgkmcnt(0)
    v_mfma_f32_32x32x16_bf16 v[128:143], a[32:35], a[0:3], 0
    ds_read_b64_tr_b16 a[64:65], v40 offset:8192
    ds_read_b64_tr_b16 a[66:67], v41 offset:10240
    v_add_f32 v160, v160, v176
    v_add_f32 v161, v161, v177
    v_add_f32 v162, v162, v178
    v_add_f32 v163, v163, v179
    v_add_f32 v164, v164, v180
    v_mfma_f32_32x32x16_bf16 v[128:143], a[36:39], a[4:7], v[128:143]
    ds_read_b64_tr_b16 a[72:73], v42 offset:8192
    ds_read_b64_tr_b16 a[74:75], v43 offset:10240
    v_add_f32 v165, v165, v181
    v_add_f32 v166, v166, v182
    v_add_f32 v167, v167, v183
    v_add_f32 v168, v168, v184
    v_add_f32 v169, v169, v185
    v_mfma_f32_32x32x16_bf16 v[128:143], a[40:43], a[8:11], v[128:143]
    ds_read_b64_tr_b16 a[80:81], v44 offset:8192
    ds_read_b64_tr_b16 a[82:83], v45 offset:10240
    v_add_f32 v170, v170, v186
    v_add_f32 v171, v171, v187
    v_add_f32 v172, v172, v188
    v_add_f32 v173, v173, v189
    v_add_f32 v174, v174, v190
    v_mfma_f32_32x32x16_bf16 v[128:143], a[44:47], a[12:15], v[128:143]
    ds_read_b64_tr_b16 a[88:89], v46 offset:8192
    ds_read_b64_tr_b16 a[90:91], v47 offset:10240
    v_add_f32 v175, v175, v191
    v_add_f32 v144, v144, v160
    v_add_f32 v145, v145, v161
    v_add_f32 v146, v146, v162
    v_add_f32 v147, v147, v163
    v_mfma_f32_32x32x16_bf16 v[128:143], a[48:51], a[16:19], v[128:143]
    ds_read_b64_tr_b16 a[68:69], v40 offset:12288
    ds_read_b64_tr_b16 a[70:71], v41 offset:14336
    v_add_f32 v148, v148, v164
    v_add_f32 v149, v149, v165
    v_add_f32 v150, v150, v166
    v_add_f32 v151, v151, v167
    v_add_f32 v152, v152, v168
    v_mfma_f32_32x32x16_bf16 v[128:143], a[52:55], a[20:23], v[128:143]
    ds_read_b64_tr_b16 a[76:77], v42 offset:12288
    ds_read_b64_tr_b16 a[78:79], v43 offset:14336
    v_add_f32 v153, v153, v169
    v_add_f32 v154, v154, v170
    v_add_f32 v155, v155, v171
    v_add_f32 v156, v156, v172
    v_add_f32 v157, v157, v173
    v_mfma_f32_32x32x16_bf16 v[128:143], a[56:59], a[24:27], v[128:143]
    ds_read_b64_tr_b16 a[84:85], v44 offset:12288
    ds_read_b64_tr_b16 a[86:87], v45 offset:14336
    v_add_f32 v158, v158, v174
    v_add_f32 v159, v159, v175
    v_max3_f32 v218, v144, v145, v146
    v_max3_f32 v219, v147, v148, v149
    v_max3_f32 v220, v150, v151, v152
    v_mfma_f32_32x32x16_bf16 v[128:143], a[60:63], a[28:31], v[128:143]
    ds_read_b64_tr_b16 a[92:93], v46 offset:12288
    ds_read_b64_tr_b16 a[94:95], v47 offset:14336
    v_max3_f32 v221, v153, v154, v155
    v_max3_f32 v218, v218, v156, v157
    v_max3_f32 v219, v219, v158, v159
    v_max3_f32 v218, v218, v219, v220
    v_max_f32 v218, v218, v221
    v_mov_b32 v219, v218
    s_nop 1
    v_permlane32_swap_b32 v218, v219
    v_max3_f32 v218, v218, v219, v216
    v_sub_f32 v220, v216, v218
    v_mov_b32 v216, v218
    v_exp_f32 v220, v220
    v_sub_f32 v192, v144, v218
    v_sub_f32 v193, v145, v218
    v_sub_f32 v194, v146, v218
    v_sub_f32 v195, v147, v218
    v_sub_f32 v196, v148, v218
    v_sub_f32 v197, v149, v218
    v_sub_f32 v198, v150, v218
    v_sub_f32 v199, v151, v218
    v_sub_f32 v200, v152, v218
    v_sub_f32 v201, v153, v218
    v_sub_f32 v202, v154, v218
    v_sub_f32 v203, v155, v218
    v_sub_f32 v204, v156, v218
    v_sub_f32 v205, v157, v218
    v_sub_f32 v206, v158, v218
    v_sub_f32 v207, v159, v218
    ds_write_b128 v28, v[128:131] offset:0
    v_exp_f32 v192, v192
    v_exp_f32 v193, v193
    v_exp_f32 v194, v194
    v_exp_f32 v195, v195
    ds_write_b128 v28, v[132:135] offset:1024
    v_exp_f32 v196, v196
    v_exp_f32 v197, v197
    v_exp_f32 v198, v198
    v_exp_f32 v199, v199
    ds_write_b128 v28, v[136:139] offset:2048
    v_exp_f32 v200, v200
    v_exp_f32 v201, v201
    v_exp_f32 v202, v202
    v_exp_f32 v203, v203
    ds_write_b128 v28, v[140:143] offset:3072
    v_exp_f32 v204, v204
    v_exp_f32 v205, v205
    v_exp_f32 v206, v206
    v_exp_f32 v207, v207
    v_mul_f32 v217, v217, v220
    v_cvt_pk_bf16_f32 v208, v192, v193
    v_cvt_pk_bf16_f32 v209, v194, v195
    v_cvt_pk_bf16_f32 v210, v196, v197
    v_cvt_pk_bf16_f32 v211, v198, v199
    v_cvt_pk_bf16_f32 v212, v200, v201
    v_cvt_pk_bf16_f32 v213, v202, v203
    v_cvt_pk_bf16_f32 v214, v204, v205
    v_cvt_pk_bf16_f32 v215, v206, v207
    v_mul_f32 v64, v64, v220
    v_mul_f32 v65, v65, v220
    v_mul_f32 v66, v66, v220
    v_mul_f32 v67, v67, v220
    v_mul_f32 v68, v68, v220
    v_mul_f32 v69, v69, v220
    v_mul_f32 v70, v70, v220
    v_mul_f32 v71, v71, v220
    v_mul_f32 v72, v72, v220
    v_mul_f32 v73, v73, v220
    v_mul_f32 v74, v74, v220
    v_mul_f32 v75, v75, v220
    v_mul_f32 v76, v76, v220
    v_mul_f32 v77, v77, v220
    v_mul_f32 v78, v78, v220
    v_mul_f32 v79, v79, v220
    s_waitcnt lgkmcnt(0)
    s_barrier
    v_mfma_f32_32x32x16_bf16 v[64:79], a[64:67], v[208:211], v[64:79]
    ds_read_b128 v[144:147], v29 offset:0
    v_mul_f32 v80, v80, v220
    v_mul_f32 v81, v81, v220
    ds_read_b128 v[148:151], v29 offset:1024
    s_waitcnt vmcnt(7)
    ds_write_b128 v26, v[224:227] offset:24576
    v_mul_f32 v82, v82, v220
    v_mul_f32 v83, v83, v220
    ds_read_b128 v[152:155], v29 offset:2048
    v_mul_f32 v84, v84, v220
    v_mfma_f32_32x32x16_bf16 v[64:79], a[68:71], v[212:215], v[64:79]
    v_mul_f32 v85, v85, v220
    ds_read_b128 v[156:159], v29 offset:3072
    v_mul_f32 v86, v86, v220
    s_waitcnt vmcnt(6)
    ds_write_b128 v26, v[228:231] offset:25600
    v_mul_f32 v87, v87, v220
    v_mul_f32 v88, v88, v220
    v_mul_f32 v89, v89, v220
    v_mul_f32 v90, v90, v220
    v_mul_f32 v91, v91, v220
    v_mul_f32 v92, v92, v220
    v_mul_f32 v93, v93, v220
    v_mul_f32 v94, v94, v220
    v_mul_f32 v95, v95, v220
    s_nop 1
    v_mfma_f32_32x32x16_bf16 v[80:95], a[72:75], v[208:211], v[80:95]
    ds_read_b128 v[160:163], v30 offset:0
    v_mul_f32 v96, v96, v220
    v_mul_f32 v97, v97, v220
    ds_read_b128 v[164:167], v30 offset:1024
    s_waitcnt vmcnt(5)
    ds_write_b128 v26, v[232:235] offset:26624
    v_mul_f32 v98, v98, v220
    v_mul_f32 v99, v99, v220
    ds_read_b128 v[168:171], v30 offset:2048
    v_mul_f32 v100, v100, v220
    v_mfma_f32_32x32x16_bf16 v[80:95], a[76:79], v[212:215], v[80:95]
    v_mul_f32 v101, v101, v220
    ds_read_b128 v[172:175], v30 offset:3072
    v_mul_f32 v102, v102, v220
    s_waitcnt vmcnt(4)
    ds_write_b128 v26, v[236:239] offset:27648
    v_mul_f32 v103, v103, v220
    v_mul_f32 v104, v104, v220
    v_mul_f32 v105, v105, v220
    v_mul_f32 v106, v106, v220
    v_mul_f32 v107, v107, v220
    v_mul_f32 v108, v108, v220
    v_mul_f32 v109, v109, v220
    v_mul_f32 v110, v110, v220
    v_mul_f32 v111, v111, v220
    s_nop 1
    v_mfma_f32_32x32x16_bf16 v[96:111], a[80:83], v[208:211], v[96:111]
    ds_read_b128 v[176:179], v31 offset:0
    v_mul_f32 v112, v112, v220
    v_mul_f32 v113, v113, v220
    ds_read_b128 v[180:183], v31 offset:1024
    s_waitcnt vmcnt(3)
    ds_write_b128 v26, v[240:243] offset:28672
    v_mul_f32 v114, v114, v220
    v_mul_f32 v115, v115, v220
    ds_read_b128 v[184:187], v31 offset:2048
    v_mul_f32 v116, v116, v220
    v_mfma_f32_32x32x16_bf16 v[96:111], a[84:87], v[212:215], v[96:111]
    v_mul_f32 v117, v117, v220
    ds_read_b128 v[188:191], v31 offset:3072
    v_mul_f32 v118, v118, v220
    s_waitcnt vmcnt(2)
    ds_write_b128 v26, v[244:247] offset:29696
    v_mul_f32 v119, v119, v220
    v_mul_f32 v120, v120, v220
    v_mul_f32 v121, v121, v220
    v_mul_f32 v122, v122, v220
    v_mul_f32 v123, v123, v220
    v_mul_f32 v124, v124, v220
    v_mul_f32 v125, v125, v220
    v_mul_f32 v126, v126, v220
    v_mul_f32 v127, v127, v220
    s_nop 1
    v_mfma_f32_32x32x16_bf16 v[112:127], a[88:91], v[208:211], v[112:127]
    v_add_f32 v192, v192, v200
    v_add_f32 v193, v193, v201
    v_add_f32 v194, v194, v202
    v_add_f32 v195, v195, v203
    s_waitcnt vmcnt(1)
    ds_write_b128 v26, v[248:251] offset:30720
    v_add_f32 v196, v196, v204
    v_add_f32 v197, v197, v205
    v_add_f32 v198, v198, v206
    v_add_f32 v199, v199, v207
    v_mfma_f32_32x32x16_bf16 v[112:127], a[92:95], v[212:215], v[112:127]
    v_add_f32 v192, v192, v196
    v_add_f32 v193, v193, v197
    v_add_f32 v194, v194, v198
    s_waitcnt vmcnt(0)
    ds_write_b128 v26, v[252:255] offset:31744
    v_add_f32 v195, v195, v199
    v_add_f32 v192, v192, v193
    v_add_f32 v194, v194, v195
    v_add_f32 v192, v192, v194
    v_add_f32 v217, v217, v192
    ds_read_b128 a[32:35], v32 offset:24576
    ds_read_b128 a[36:39], v33 offset:24576
    ds_read_b128 a[40:43], v34 offset:24576
    ds_read_b128 a[44:47], v35 offset:24576
    ds_read_b128 a[48:51], v36 offset:24576
    ds_read_b128 a[52:55], v37 offset:24576
    ds_read_b128 a[56:59], v38 offset:24576
    ds_read_b128 a[60:63], v39 offset:24576
    s_waitcnt lgkmcnt(8)
    v_add_f32 v144, v144, v128
    v_add_f32 v145, v145, v129
    v_add_f32 v146, v146, v130
    v_add_f32 v147, v147, v131
    v_add_f32 v148, v148, v132
    v_add_f32 v149, v149, v133
    v_add_f32 v150, v150, v134
    v_add_f32 v151, v151, v135
    v_add_f32 v152, v152, v136
    v_add_f32 v153, v153, v137
    v_add_f32 v154, v154, v138
    v_add_f32 v155, v155, v139
    v_add_f32 v156, v156, v140
    v_add_f32 v157, v157, v141
    v_add_f32 v158, v158, v142
    v_add_f32 v159, v159, v143
    s_waitcnt lgkmcnt(0)
    v_mfma_f32_32x32x16_bf16 v[128:143], a[32:35], a[0:3], 0
    ds_read_b64_tr_b16 a[64:65], v40 offset:16384
    ds_read_b64_tr_b16 a[66:67], v41 offset:18432
    v_add_f32 v160, v160, v176
    v_add_f32 v161, v161, v177
    v_add_f32 v162, v162, v178
    v_add_f32 v163, v163, v179
    v_add_f32 v164, v164, v180
    v_mfma_f32_32x32x16_bf16 v[128:143], a[36:39], a[4:7], v[128:143]
    ds_read_b64_tr_b16 a[72:73], v42 offset:16384
    ds_read_b64_tr_b16 a[74:75], v43 offset:18432
    v_add_f32 v165, v165, v181
    v_add_f32 v166, v166, v182
    v_add_f32 v167, v167, v183
    v_add_f32 v168, v168, v184
    v_add_f32 v169, v169, v185
    v_mfma_f32_32x32x16_bf16 v[128:143], a[40:43], a[8:11], v[128:143]
    ds_read_b64_tr_b16 a[80:81], v44 offset:16384
    ds_read_b64_tr_b16 a[82:83], v45 offset:18432
    v_add_f32 v170, v170, v186
    v_add_f32 v171, v171, v187
    v_add_f32 v172, v172, v188
    v_add_f32 v173, v173, v189
    v_add_f32 v174, v174, v190
    v_mfma_f32_32x32x16_bf16 v[128:143], a[44:47], a[12:15], v[128:143]
    ds_read_b64_tr_b16 a[88:89], v46 offset:16384
    ds_read_b64_tr_b16 a[90:91], v47 offset:18432
    v_add_f32 v175, v175, v191
    v_add_f32 v144, v144, v160
    v_add_f32 v145, v145, v161
    v_add_f32 v146, v146, v162
    v_add_f32 v147, v147, v163
    v_mfma_f32_32x32x16_bf16 v[128:143], a[48:51], a[16:19], v[128:143]
    ds_read_b64_tr_b16 a[68:69], v40 offset:20480
    ds_read_b64_tr_b16 a[70:71], v41 offset:22528
    v_add_f32 v148, v148, v164
    v_add_f32 v149, v149, v165
    v_add_f32 v150, v150, v166
    v_add_f32 v151, v151, v167
    v_add_f32 v152, v152, v168
    v_mfma_f32_32x32x16_bf16 v[128:143], a[52:55], a[20:23], v[128:143]
    ds_read_b64_tr_b16 a[76:77], v42 offset:20480
    ds_read_b64_tr_b16 a[78:79], v43 offset:22528
    v_add_f32 v153, v153, v169
    v_add_f32 v154, v154, v170
    v_add_f32 v155, v155, v171
    v_add_f32 v156, v156, v172
    v_add_f32 v157, v157, v173
    v_mfma_f32_32x32x16_bf16 v[128:143], a[56:59], a[24:27], v[128:143]
    ds_read_b64_tr_b16 a[84:85], v44 offset:20480
    ds_read_b64_tr_b16 a[86:87], v45 offset:22528
    v_add_f32 v158, v158, v174
    v_add_f32 v159, v159, v175
    v_max3_f32 v218, v144, v145, v146
    v_max3_f32 v219, v147, v148, v149
    v_max3_f32 v220, v150, v151, v152
    v_mfma_f32_32x32x16_bf16 v[128:143], a[60:63], a[28:31], v[128:143]
    ds_read_b64_tr_b16 a[92:93], v46 offset:20480
    ds_read_b64_tr_b16 a[94:95], v47 offset:22528
    v_max3_f32 v221, v153, v154, v155
    v_max3_f32 v218, v218, v156, v157
    v_max3_f32 v219, v219, v158, v159
    v_max3_f32 v218, v218, v219, v220
    v_max_f32 v218, v218, v221
    v_mov_b32 v219, v218
    s_nop 1
    v_permlane32_swap_b32 v218, v219
    v_max3_f32 v218, v218, v219, v216
    v_sub_f32 v220, v216, v218
    v_mov_b32 v216, v218
    v_exp_f32 v220, v220
    v_sub_f32 v192, v144, v218
    v_sub_f32 v193, v145, v218
    v_sub_f32 v194, v146, v218
    v_sub_f32 v195, v147, v218
    v_sub_f32 v196, v148, v218
    v_sub_f32 v197, v149, v218
    v_sub_f32 v198, v150, v218
    v_sub_f32 v199, v151, v218
    v_sub_f32 v200, v152, v218
    v_sub_f32 v201, v153, v218
    v_sub_f32 v202, v154, v218
    v_sub_f32 v203, v155, v218
    v_sub_f32 v204, v156, v218
    v_sub_f32 v205, v157, v218
    v_sub_f32 v206, v158, v218
    v_sub_f32 v207, v159, v218
    ds_write_b128 v28, v[128:131] offset:16384
    v_exp_f32 v192, v192
    v_exp_f32 v193, v193
    v_exp_f32 v194, v194
    v_exp_f32 v195, v195
    ds_write_b128 v28, v[132:135] offset:17408
    v_exp_f32 v196, v196
    v_exp_f32 v197, v197
    v_exp_f32 v198, v198
    v_exp_f32 v199, v199
    ds_write_b128 v28, v[136:139] offset:18432
    v_exp_f32 v200, v200
    v_exp_f32 v201, v201
    v_exp_f32 v202, v202
    v_exp_f32 v203, v203
    ds_write_b128 v28, v[140:143] offset:19456
    v_exp_f32 v204, v204
    v_exp_f32 v205, v205
    v_exp_f32 v206, v206
    v_exp_f32 v207, v207
    v_mul_f32 v217, v217, v220
    v_cvt_pk_bf16_f32 v208, v192, v193
    v_cvt_pk_bf16_f32 v209, v194, v195
    v_cvt_pk_bf16_f32 v210, v196, v197
    v_cvt_pk_bf16_f32 v211, v198, v199
    v_cvt_pk_bf16_f32 v212, v200, v201
    v_cvt_pk_bf16_f32 v213, v202, v203
    v_cvt_pk_bf16_f32 v214, v204, v205
    v_cvt_pk_bf16_f32 v215, v206, v207
    v_mul_f32 v64, v64, v220
    v_mul_f32 v65, v65, v220
    v_mul_f32 v66, v66, v220
    v_mul_f32 v67, v67, v220
    v_mul_f32 v68, v68, v220
    v_mul_f32 v69, v69, v220
    v_mul_f32 v70, v70, v220
    v_mul_f32 v71, v71, v220
    v_mul_f32 v72, v72, v220
    v_mul_f32 v73, v73, v220
    v_mul_f32 v74, v74, v220
    v_mul_f32 v75, v75, v220
    v_mul_f32 v76, v76, v220
    v_mul_f32 v77, v77, v220
    v_mul_f32 v78, v78, v220
    v_mul_f32 v79, v79, v220
    s_waitcnt lgkmcnt(0)
    s_barrier
    v_mfma_f32_32x32x16_bf16 v[64:79], a[64:67], v[208:211], v[64:79]
    ds_read_b128 v[144:147], v29 offset:16384
    v_mul_f32 v80, v80, v220
    v_mul_f32 v81, v81, v220
    ds_read_b128 v[148:151], v29 offset:17408
    v_mul_f32 v82, v82, v220
    v_mul_f32 v83, v83, v220
    ds_read_b128 v[152:155], v29 offset:18432
    v_mul_f32 v84, v84, v220
    v_mfma_f32_32x32x16_bf16 v[64:79], a[68:71], v[212:215], v[64:79]
    v_mul_f32 v85, v85, v220
    ds_read_b128 v[156:159], v29 offset:19456
    v_mul_f32 v86, v86, v220
    v_mul_f32 v87, v87, v220
    v_mul_f32 v88, v88, v220
    v_mul_f32 v89, v89, v220
    v_mul_f32 v90, v90, v220
    v_mul_f32 v91, v91, v220
    v_mul_f32 v92, v92, v220
    v_mul_f32 v93, v93, v220
    v_mul_f32 v94, v94, v220
    v_mul_f32 v95, v95, v220
    s_nop 1
    v_mfma_f32_32x32x16_bf16 v[80:95], a[72:75], v[208:211], v[80:95]
    ds_read_b128 v[160:163], v30 offset:16384
    v_mul_f32 v96, v96, v220
    v_mul_f32 v97, v97, v220
    ds_read_b128 v[164:167], v30 offset:17408
    v_mul_f32 v98, v98, v220
    v_mul_f32 v99, v99, v220
    ds_read_b128 v[168:171], v30 offset:18432
    v_mul_f32 v100, v100, v220
    v_mfma_f32_32x32x16_bf16 v[80:95], a[76:79], v[212:215], v[80:95]
    v_mul_f32 v101, v101, v220
    ds_read_b128 v[172:175], v30 offset:19456
    v_mul_f32 v102, v102, v220
    v_mul_f32 v103, v103, v220
    v_mul_f32 v104, v104, v220
    v_mul_f32 v105, v105, v220
    v_mul_f32 v106, v106, v220
    v_mul_f32 v107, v107, v220
    v_mul_f32 v108, v108, v220
    v_mul_f32 v109, v109, v220
    v_mul_f32 v110, v110, v220
    v_mul_f32 v111, v111, v220
    s_nop 1
    v_mfma_f32_32x32x16_bf16 v[96:111], a[80:83], v[208:211], v[96:111]
    ds_read_b128 v[176:179], v31 offset:16384
    v_mul_f32 v112, v112, v220
    v_mul_f32 v113, v113, v220
    ds_read_b128 v[180:183], v31 offset:17408
    v_mul_f32 v114, v114, v220
    v_mul_f32 v115, v115, v220
    ds_read_b128 v[184:187], v31 offset:18432
    v_mul_f32 v116, v116, v220
    v_mfma_f32_32x32x16_bf16 v[96:111], a[84:87], v[212:215], v[96:111]
    v_mul_f32 v117, v117, v220
    ds_read_b128 v[188:191], v31 offset:19456
    v_mul_f32 v118, v118, v220
    v_mul_f32 v119, v119, v220
    v_mul_f32 v120, v120, v220
    v_mul_f32 v121, v121, v220
    v_mul_f32 v122, v122, v220
    v_mul_f32 v123, v123, v220
    v_mul_f32 v124, v124, v220
    v_mul_f32 v125, v125, v220
    v_mul_f32 v126, v126, v220
    v_mul_f32 v127, v127, v220
    s_nop 1
    v_mfma_f32_32x32x16_bf16 v[112:127], a[88:91], v[208:211], v[112:127]
    v_add_f32 v192, v192, v200
    v_add_f32 v193, v193, v201
    v_add_f32 v194, v194, v202
    v_add_f32 v195, v195, v203
    v_add_f32 v196, v196, v204
    v_add_f32 v197, v197, v205
    v_add_f32 v198, v198, v206
    v_add_f32 v199, v199, v207
    v_mfma_f32_32x32x16_bf16 v[112:127], a[92:95], v[212:215], v[112:127]
    v_add_f32 v192, v192, v196
    v_add_f32 v193, v193, v197
    v_add_f32 v194, v194, v198
    v_add_f32 v195, v195, v199
    v_add_f32 v192, v192, v193
    v_add_f32 v194, v194, v195
    v_add_f32 v192, v192, v194
    v_add_f32 v217, v217, v192
    s_waitcnt lgkmcnt(0)
    v_add_f32 v144, v144, v128
    v_add_f32 v145, v145, v129
    v_add_f32 v146, v146, v130
    v_add_f32 v147, v147, v131
    v_add_f32 v148, v148, v132
    v_add_f32 v149, v149, v133
    v_add_f32 v150, v150, v134
    v_add_f32 v151, v151, v135
    v_add_f32 v152, v152, v136
    v_add_f32 v153, v153, v137
    v_add_f32 v154, v154, v138
    v_add_f32 v155, v155, v139
    v_add_f32 v156, v156, v140
    v_add_f32 v157, v157, v141
    v_add_f32 v158, v158, v142
    v_add_f32 v159, v159, v143
    s_waitcnt lgkmcnt(0)
    ds_read_b64_tr_b16 a[64:65], v40 offset:24576
    ds_read_b64_tr_b16 a[66:67], v41 offset:26624
    v_add_f32 v160, v160, v176
    v_add_f32 v161, v161, v177
    v_add_f32 v162, v162, v178
    v_add_f32 v163, v163, v179
    v_add_f32 v164, v164, v180
    ds_read_b64_tr_b16 a[72:73], v42 offset:24576
    ds_read_b64_tr_b16 a[74:75], v43 offset:26624
    v_add_f32 v165, v165, v181
    v_add_f32 v166, v166, v182
    v_add_f32 v167, v167, v183
    v_add_f32 v168, v168, v184
    v_add_f32 v169, v169, v185
    ds_read_b64_tr_b16 a[80:81], v44 offset:24576
    ds_read_b64_tr_b16 a[82:83], v45 offset:26624
    v_add_f32 v170, v170, v186
    v_add_f32 v171, v171, v187
    v_add_f32 v172, v172, v188
    v_add_f32 v173, v173, v189
    v_add_f32 v174, v174, v190
    ds_read_b64_tr_b16 a[88:89], v46 offset:24576
    ds_read_b64_tr_b16 a[90:91], v47 offset:26624
    v_add_f32 v175, v175, v191
    v_add_f32 v144, v144, v160
    v_add_f32 v145, v145, v161
    v_add_f32 v146, v146, v162
    v_add_f32 v147, v147, v163
    ds_read_b64_tr_b16 a[68:69], v40 offset:28672
    ds_read_b64_tr_b16 a[70:71], v41 offset:30720
    v_add_f32 v148, v148, v164
    v_add_f32 v149, v149, v165
    v_add_f32 v150, v150, v166
    v_add_f32 v151, v151, v167
    v_add_f32 v152, v152, v168
    ds_read_b64_tr_b16 a[76:77], v42 offset:28672
    ds_read_b64_tr_b16 a[78:79], v43 offset:30720
    v_add_f32 v153, v153, v169
    v_add_f32 v154, v154, v170
    v_add_f32 v155, v155, v171
    v_add_f32 v156, v156, v172
    v_add_f32 v157, v157, v173
    ds_read_b64_tr_b16 a[84:85], v44 offset:28672
    ds_read_b64_tr_b16 a[86:87], v45 offset:30720
    v_add_f32 v158, v158, v174
    v_add_f32 v159, v159, v175
    v_max3_f32 v218, v144, v145, v146
    v_max3_f32 v219, v147, v148, v149
    v_max3_f32 v220, v150, v151, v152
    ds_read_b64_tr_b16 a[92:93], v46 offset:28672
    ds_read_b64_tr_b16 a[94:95], v47 offset:30720
    v_max3_f32 v221, v153, v154, v155
    v_max3_f32 v218, v218, v156, v157
    v_max3_f32 v219, v219, v158, v159
    v_max3_f32 v218, v218, v219, v220
    v_max_f32 v218, v218, v221
    v_mov_b32 v219, v218
    s_nop 1
    v_permlane32_swap_b32 v218, v219
    v_max3_f32 v218, v218, v219, v216
    v_sub_f32 v220, v216, v218
    v_mov_b32 v216, v218
    v_exp_f32 v220, v220
    v_sub_f32 v192, v144, v218
    v_sub_f32 v193, v145, v218
    v_sub_f32 v194, v146, v218
    v_sub_f32 v195, v147, v218
    v_sub_f32 v196, v148, v218
    v_sub_f32 v197, v149, v218
    v_sub_f32 v198, v150, v218
    v_sub_f32 v199, v151, v218
    v_sub_f32 v200, v152, v218
    v_sub_f32 v201, v153, v218
    v_sub_f32 v202, v154, v218
    v_sub_f32 v203, v155, v218
    v_sub_f32 v204, v156, v218
    v_sub_f32 v205, v157, v218
    v_sub_f32 v206, v158, v218
    v_sub_f32 v207, v159, v218
    v_exp_f32 v192, v192
    v_exp_f32 v193, v193
    v_exp_f32 v194, v194
    v_exp_f32 v195, v195
    v_exp_f32 v196, v196
    v_exp_f32 v197, v197
    v_exp_f32 v198, v198
    v_exp_f32 v199, v199
    v_exp_f32 v200, v200
    v_exp_f32 v201, v201
    v_exp_f32 v202, v202
    v_exp_f32 v203, v203
    v_exp_f32 v204, v204
    v_exp_f32 v205, v205
    v_exp_f32 v206, v206
    v_exp_f32 v207, v207
    v_mul_f32 v217, v217, v220
    v_cvt_pk_bf16_f32 v208, v192, v193
    v_cvt_pk_bf16_f32 v209, v194, v195
    v_cvt_pk_bf16_f32 v210, v196, v197
    v_cvt_pk_bf16_f32 v211, v198, v199
    v_cvt_pk_bf16_f32 v212, v200, v201
    v_cvt_pk_bf16_f32 v213, v202, v203
    v_cvt_pk_bf16_f32 v214, v204, v205
    v_cvt_pk_bf16_f32 v215, v206, v207
    v_mul_f32 v64, v64, v220
    v_mul_f32 v65, v65, v220
    v_mul_f32 v66, v66, v220
    v_mul_f32 v67, v67, v220
    v_mul_f32 v68, v68, v220
    v_mul_f32 v69, v69, v220
    v_mul_f32 v70, v70, v220
    v_mul_f32 v71, v71, v220
    v_mul_f32 v72, v72, v220
    v_mul_f32 v73, v73, v220
    v_mul_f32 v74, v74, v220
    v_mul_f32 v75, v75, v220
    v_mul_f32 v76, v76, v220
    v_mul_f32 v77, v77, v220
    v_mul_f32 v78, v78, v220
    v_mul_f32 v79, v79, v220
    s_waitcnt lgkmcnt(0)
    s_nop 0
    v_mfma_f32_32x32x16_bf16 v[64:79], a[64:67], v[208:211], v[64:79]
    v_mul_f32 v80, v80, v220
    v_mul_f32 v81, v81, v220
    v_mul_f32 v82, v82, v220
    v_mul_f32 v83, v83, v220
    v_mul_f32 v84, v84, v220
    v_mul_f32 v85, v85, v220
    v_mul_f32 v86, v86, v220
    v_mul_f32 v87, v87, v220
    v_mfma_f32_32x32x16_bf16 v[64:79], a[68:71], v[212:215], v[64:79]
    v_mul_f32 v88, v88, v220
    v_mul_f32 v89, v89, v220
    v_mul_f32 v90, v90, v220
    v_mul_f32 v91, v91, v220
    v_mul_f32 v92, v92, v220
    v_mul_f32 v93, v93, v220
    v_mul_f32 v94, v94, v220
    v_mul_f32 v95, v95, v220
    s_nop 1
    v_mfma_f32_32x32x16_bf16 v[80:95], a[72:75], v[208:211], v[80:95]
    v_mul_f32 v96, v96, v220
    v_mul_f32 v97, v97, v220
    v_mul_f32 v98, v98, v220
    v_mul_f32 v99, v99, v220
    v_mul_f32 v100, v100, v220
    v_mul_f32 v101, v101, v220
    v_mul_f32 v102, v102, v220
    v_mul_f32 v103, v103, v220
    v_mfma_f32_32x32x16_bf16 v[80:95], a[76:79], v[212:215], v[80:95]
    v_mul_f32 v104, v104, v220
    v_mul_f32 v105, v105, v220
    v_mul_f32 v106, v106, v220
    v_mul_f32 v107, v107, v220
    v_mul_f32 v108, v108, v220
    v_mul_f32 v109, v109, v220
    v_mul_f32 v110, v110, v220
    v_mul_f32 v111, v111, v220
    s_nop 1
    v_mfma_f32_32x32x16_bf16 v[96:111], a[80:83], v[208:211], v[96:111]
    v_mul_f32 v112, v112, v220
    v_mul_f32 v113, v113, v220
    v_mul_f32 v114, v114, v220
    v_mul_f32 v115, v115, v220
    v_mul_f32 v116, v116, v220
    v_mul_f32 v117, v117, v220
    v_mul_f32 v118, v118, v220
    v_mul_f32 v119, v119, v220
    v_mfma_f32_32x32x16_bf16 v[96:111], a[84:87], v[212:215], v[96:111]
    v_mul_f32 v120, v120, v220
    v_mul_f32 v121, v121, v220
    v_mul_f32 v122, v122, v220
    v_mul_f32 v123, v123, v220
    v_mul_f32 v124, v124, v220
    v_mul_f32 v125, v125, v220
    v_mul_f32 v126, v126, v220
    v_mul_f32 v127, v127, v220
    s_nop 1
    v_mfma_f32_32x32x16_bf16 v[112:127], a[88:91], v[208:211], v[112:127]
    v_add_f32 v192, v192, v200
    v_add_f32 v193, v193, v201
    v_add_f32 v194, v194, v202
    v_add_f32 v195, v195, v203
    v_add_f32 v196, v196, v204
    v_add_f32 v197, v197, v205
    v_add_f32 v198, v198, v206
    v_add_f32 v199, v199, v207
    v_mfma_f32_32x32x16_bf16 v[112:127], a[92:95], v[212:215], v[112:127]
    v_add_f32 v192, v192, v196
    v_add_f32 v193, v193, v197
    v_add_f32 v194, v194, v198
    v_add_f32 v195, v195, v199
    v_add_f32 v192, v192, v193
    v_add_f32 v194, v194, v195
    v_add_f32 v192, v192, v194
    v_add_f32 v217, v217, v192
    s_waitcnt lgkmcnt(0)
    v_mov_b32 v219, v217
    s_nop 1
    v_permlane32_swap_b32 v217, v219
    v_add_f32 v217, v217, v219
    v_rcp_f32 v220, v217
    v_mul_u32_u24 v5, 272, v24
    v_lshl_add_u32 v5, v25, 3, v5
    v_add_u32 v5, s63, v5
    v_mul_f32 v64, v64, v220
    v_mul_f32 v65, v65, v220
    v_mul_f32 v66, v66, v220
    v_mul_f32 v67, v67, v220
    v_mul_f32 v68, v68, v220
    v_mul_f32 v69, v69, v220
    v_mul_f32 v70, v70, v220
    v_mul_f32 v71, v71, v220
    v_mul_f32 v72, v72, v220
    v_mul_f32 v73, v73, v220
    v_mul_f32 v74, v74, v220
    v_mul_f32 v75, v75, v220
    v_mul_f32 v76, v76, v220
    v_mul_f32 v77, v77, v220
    v_mul_f32 v78, v78, v220
    v_mul_f32 v79, v79, v220
    v_mul_f32 v80, v80, v220
    v_mul_f32 v81, v81, v220
    v_mul_f32 v82, v82, v220
    v_mul_f32 v83, v83, v220
    v_mul_f32 v84, v84, v220
    v_mul_f32 v85, v85, v220
    v_mul_f32 v86, v86, v220
    v_mul_f32 v87, v87, v220
    v_mul_f32 v88, v88, v220
    v_mul_f32 v89, v89, v220
    v_mul_f32 v90, v90, v220
    v_mul_f32 v91, v91, v220
    v_mul_f32 v92, v92, v220
    v_mul_f32 v93, v93, v220
    v_mul_f32 v94, v94, v220
    v_mul_f32 v95, v95, v220
    v_mul_f32 v96, v96, v220
    v_mul_f32 v97, v97, v220
    v_mul_f32 v98, v98, v220
    v_mul_f32 v99, v99, v220
    v_mul_f32 v100, v100, v220
    v_mul_f32 v101, v101, v220
    v_mul_f32 v102, v102, v220
    v_mul_f32 v103, v103, v220
    v_mul_f32 v104, v104, v220
    v_mul_f32 v105, v105, v220
    v_mul_f32 v106, v106, v220
    v_mul_f32 v107, v107, v220
    v_mul_f32 v108, v108, v220
    v_mul_f32 v109, v109, v220
    v_mul_f32 v110, v110, v220
    v_mul_f32 v111, v111, v220
    v_mul_f32 v112, v112, v220
    v_mul_f32 v113, v113, v220
    v_mul_f32 v114, v114, v220
    v_mul_f32 v115, v115, v220
    v_mul_f32 v116, v116, v220
    v_mul_f32 v117, v117, v220
    v_mul_f32 v118, v118, v220
    v_mul_f32 v119, v119, v220
    v_mul_f32 v120, v120, v220
    v_mul_f32 v121, v121, v220
    v_mul_f32 v122, v122, v220
    v_mul_f32 v123, v123, v220
    v_mul_f32 v124, v124, v220
    v_mul_f32 v125, v125, v220
    v_mul_f32 v126, v126, v220
    v_mul_f32 v127, v127, v220
    v_cvt_pk_bf16_f32 v128, v64, v65
    v_cvt_pk_bf16_f32 v129, v66, v67
    v_cvt_pk_bf16_f32 v130, v68, v69
    v_cvt_pk_bf16_f32 v131, v70, v71
    v_cvt_pk_bf16_f32 v132, v72, v73
    v_cvt_pk_bf16_f32 v133, v74, v75
    v_cvt_pk_bf16_f32 v134, v76, v77
    v_cvt_pk_bf16_f32 v135, v78, v79
    v_cvt_pk_bf16_f32 v136, v80, v81
    v_cvt_pk_bf16_f32 v137, v82, v83
    v_cvt_pk_bf16_f32 v138, v84, v85
    v_cvt_pk_bf16_f32 v139, v86, v87
    v_cvt_pk_bf16_f32 v140, v88, v89
    v_cvt_pk_bf16_f32 v141, v90, v91
    v_cvt_pk_bf16_f32 v142, v92, v93
    v_cvt_pk_bf16_f32 v143, v94, v95
    v_cvt_pk_bf16_f32 v144, v96, v97
    v_cvt_pk_bf16_f32 v145, v98, v99
    v_cvt_pk_bf16_f32 v146, v100, v101
    v_cvt_pk_bf16_f32 v147, v102, v103
    v_cvt_pk_bf16_f32 v148, v104, v105
    v_cvt_pk_bf16_f32 v149, v106, v107
    v_cvt_pk_bf16_f32 v150, v108, v109
    v_cvt_pk_bf16_f32 v151, v110, v111
    v_cvt_pk_bf16_f32 v152, v112, v113
    v_cvt_pk_bf16_f32 v153, v114, v115
    v_cvt_pk_bf16_f32 v154, v116, v117
    v_cvt_pk_bf16_f32 v155, v118, v119
    v_cvt_pk_bf16_f32 v156, v120, v121
    v_cvt_pk_bf16_f32 v157, v122, v123
    v_cvt_pk_bf16_f32 v158, v124, v125
    v_cvt_pk_bf16_f32 v159, v126, v127
    v_min_u32 v216, -2, v216
    v_min_u32 v217, -2, v217
    s_nop 0
    v_mov_b32_dpp v218, v216 quad_perm:[1,1,3,3] row_mask:0xf bank_mask:0xf
    v_mov_b32_dpp v219, v217 quad_perm:[1,1,3,3] row_mask:0xf bank_mask:0xf
    ds_write_b64 v5, v[128:129] offset:0
    ds_write_b64 v5, v[130:131] offset:16
    ds_write_b64 v5, v[132:133] offset:32
    ds_write_b64 v5, v[134:135] offset:48
    ds_write_b64 v5, v[136:137] offset:64
    ds_write_b64 v5, v[138:139] offset:80
    ds_write_b64 v5, v[140:141] offset:96
    ds_write_b64 v5, v[142:143] offset:112
    ds_write_b64 v5, v[144:145] offset:128
    ds_write_b64 v5, v[146:147] offset:144
    ds_write_b64 v5, v[148:149] offset:160
    ds_write_b64 v5, v[150:151] offset:176
    ds_write_b64 v5, v[152:153] offset:192
    ds_write_b64 v5, v[154:155] offset:208
    ds_write_b64 v5, v[156:157] offset:224
    ds_write_b64 v5, v[158:159] offset:240
    v_mul_u32_u24 v6, 272, v4
    v_lshl_add_u32 v6, v3, 4, v6
    v_add_u32 v6, s63, v6
    s_waitcnt lgkmcnt(0)
    ds_read_b128 v[64:67], v6 offset:0
    ds_read_b128 v[68:71], v6 offset:1088
    ds_read_b128 v[72:75], v6 offset:2176
    ds_read_b128 v[76:79], v6 offset:3264
    ds_read_b128 v[80:83], v6 offset:4352
    ds_read_b128 v[84:87], v6 offset:5440
    ds_read_b128 v[88:91], v6 offset:6528
    ds_read_b128 v[92:95], v6 offset:7616
    v_lshlrev_b32 v7, 10, v4
    v_lshl_add_u32 v7, v3, 4, v7
    s_lshl_b32 s54, s53, 15
    s_lshl_b32 s55, s3, 8
    s_add_u32 s54, s54, s55
    s_add_u32 s54, s54, 2097152
    s_waitcnt lgkmcnt(7)
    buffer_store_dwordx4 v[64:67], v7, s[44:47], s54 offen sc1
    s_add_u32 s54, s54, 4096
    s_waitcnt lgkmcnt(6)
    buffer_store_dwordx4 v[68:71], v7, s[44:47], s54 offen sc1
    s_add_u32 s54, s54, 4096
    s_waitcnt lgkmcnt(5)
    buffer_store_dwordx4 v[72:75], v7, s[44:47], s54 offen sc1
    s_add_u32 s54, s54, 4096
    s_waitcnt lgkmcnt(4)
    buffer_store_dwordx4 v[76:79], v7, s[44:47], s54 offen sc1
    s_add_u32 s54, s54, 4096
    s_waitcnt lgkmcnt(3)
    buffer_store_dwordx4 v[80:83], v7, s[44:47], s54 offen sc1
    s_add_u32 s54, s54, 4096
    s_waitcnt lgkmcnt(2)
    buffer_store_dwordx4 v[84:87], v7, s[44:47], s54 offen sc1
    s_add_u32 s54, s54, 4096
    s_waitcnt lgkmcnt(1)
    buffer_store_dwordx4 v[88:91], v7, s[44:47], s54 offen sc1
    s_add_u32 s54, s54, 4096
    s_waitcnt lgkmcnt(0)
    buffer_store_dwordx4 v[92:95], v7, s[44:47], s54 offen sc1
    s_add_u32 s54, s54, 4096
    v_lshlrev_b32 v5, 3, v1
    s_lshl_b32 s54, s53, 8
    s_add_u32 s54, s54, 3145728
    s_cmp_eq_u32 s3, 0
    s_cselect_b32 s56, 0x55555555, 0
    s_mov_b32 s57, 0
    s_waitcnt vmcnt(0)
    s_barrier
    s_mov_b64 exec, s[56:57]
    buffer_store_dwordx4 v[216:219], v5, s[44:47], s54 offen sc1
    s_mov_b64 exec, -1
    s_mov_b32 s48, s26
    s_mov_b32 s49, s27
    s_mov_b32 s50, 9216
    s_mov_b32 s51, 0x20000
    s_lshl_b32 s54, s3, 5
    s_add_u32 s54, s54, s53
    s_cmp_ge_u32 s54, 72
    s_cbranch_scc1 L_nored_38
    s_waitcnt vmcnt(0)
    v_mov_b32 v48, -1
    v_mov_b32 v49, -1
    v_mov_b32 v50, -1
    v_mov_b32 v51, -1
    v_mov_b32 v52, -1
    v_mov_b32 v53, -1
    v_mov_b32 v54, -1
    v_mov_b32 v55, -1
    v_mov_b32 v56, -1
    v_mov_b32 v57, -1
    v_mov_b32 v58, -1
    v_mov_b32 v59, -1
    v_mov_b32 v60, -1
    v_mov_b32 v61, -1
    v_mov_b32 v62, -1
    v_mov_b32 v63, -1
    s_lshl_b32 s55, s54, 12
    s_add_u32 s55, s55, 4194304
    s_mul_hi_u32 s56, s54, 238609295
    s_add_u32 s56, s56, 0
    s_mul_i32 s56, s56, 1152
    s_lshl_b32 s57, s54, 6
    s_add_u32 s56, s56, s57
    v_lshlrev_b32 v5, 3, v3
    v_lshl_add_u32 v5, v4, 1, v5
    v_mov_b32 v6, 0x4000
    v_cmp_gt_u32 vcc, 8, v3
    s_nop 1
    v_cndmask_b32 v5, v6, v5, vcc
    s_mov_b64 s[4:5], -1
    s_mov_b64 s[6:7], -1
    s_mov_b64 s[8:9], -1
    s_mov_b64 s[10:11], -1
L_mpoll_39:
    s_mov_b64 exec, s[4:5]
    buffer_load_dwordx4 v[48:51], v2, s[44:47], s55 offen offset:0 sc1
    s_mov_b64 exec, s[6:7]
    buffer_load_dwordx4 v[52:55], v2, s[44:47], s55 offen offset:1024 sc1
    s_mov_b64 exec, s[8:9]
    buffer_load_dwordx4 v[56:59], v2, s[44:47], s55 offen offset:2048 sc1
    s_mov_b64 exec, s[10:11]
    buffer_load_dwordx4 v[60:63], v2, s[44:47], s55 offen offset:3072 sc1
    s_mov_b64 exec, -1
    s_waitcnt vmcnt(4)
    v_max3_u32 v32, v48, v49, v50
    v_max3_u32 v33, v52, v53, v54
    v_max3_u32 v34, v56, v57, v58
    v_max3_u32 v35, v60, v61, v62
    v_max_u32 v32, v32, v51
    v_max_u32 v33, v33, v55
    v_max_u32 v34, v34, v59
    v_max_u32 v35, v35, v63
    v_cmp_eq_u32 s[4:5], -1, v32
    v_cmp_eq_u32 s[6:7], -1, v33
    v_cmp_eq_u32 s[8:9], -1, v34
    v_cmp_eq_u32 s[10:11], -1, v35
    s_or_b64 vcc, s[4:5], s[6:7]
    s_or_b64 vcc, vcc, s[8:9]
    s_or_b64 vcc, vcc, s[10:11]
    s_cbranch_scc0 L_mpollok_40
    s_and_b64 vcc, s[4:5], s[6:7]
    s_and_b64 vcc, vcc, s[8:9]
    s_and_b64 vcc, vcc, s[10:11]
    s_cmp_eq_u64 vcc, -1
    s_cbranch_scc0 L_mpoll_39_b
    s_sleep 4
L_mpoll_39_b:
    s_sub_u32 s101, s101, 1
    s_cbranch_scc0 L_mpoll_39
    s_mov_b32 s101, 0
L_mpollok_40:
    v_add_f32 v16, v48, v52
    v_add_f32 v24, v56, v60
    v_add_f32 v18, v50, v54
    v_add_f32 v26, v58, v62
    v_add_f32 v17, v49, v53
    v_add_f32 v25, v57, v61
    v_add_f32 v19, v51, v55
    v_add_f32 v27, v59, v63
    v_add_f32 v16, v16, v24
    v_add_f32 v18, v18, v26
    v_add_f32 v17, v17, v25
    v_add_f32 v19, v19, v27
    v_permlane32_swap_b32 v16, v18
    s_nop 0
    v_permlane32_swap_b32 v17, v19
    v_add_f32 v16, v16, v18
    v_add_f32 v17, v17, v19
    s_nop 1
    v_permlane16_swap_b32 v16, v17
    v_add_f32 v16, v16, v17
    s_nop 1
    v_add_f32_dpp v16, v16, v16 row_ror:8 row_mask:0xf bank_mask:0xf
    v_cvt_pk_bf16_f32 v16, v16, v16
    buffer_store_short v16, v5, s[48:51], s56 offen
L_nored_38:
    s_endpgm
L_roleC_end:
L_exit:
    s_endpgm
.section .rodata,"a"
.p2align 6
.amdhsa_kernel concat_heads__mha_block_cached__compressed_kv_cla__decode_kernel
  .amdhsa_next_free_vgpr 512
  .amdhsa_next_free_sgpr 102
  .amdhsa_accum_offset 256
  .amdhsa_group_segment_fixed_size 0
  .amdhsa_kernarg_size 112
  .amdhsa_user_sgpr_count 2
  .amdhsa_user_sgpr_kernarg_segment_ptr 1
  .amdhsa_system_sgpr_workgroup_id_x 1
.end_amdhsa_kernel
```
